```python
import torch

def _softmax(x, axis=-1):
    return torch.softmax(x, dim=axis)
def _gelu(x):
    return torch.nn.functional.gelu(x, approximate="tanh")
def _silu(x):
    return torch.nn.functional.silu(x)
def _sigmoid(x):
    return torch.sigmoid(x)
def _layernorm(x, axis=-1, eps=1e-5):
    m = x.mean(dim=axis, keepdim=True)
    v = x.var(dim=axis, keepdim=True, unbiased=False)
    return (x - m) / torch.sqrt(v + eps)
def _scatter_add(tgt, idx, src, axis=0):
    return tgt.clone().index_add_(axis, idx, src)
def _segment_sum(src, seg, n):
    out = torch.zeros((n,) + src.shape[1:], dtype=src.dtype)
    return out.index_add_(0, seg, src)
def _pad(x, pw):
    flat = tuple(v for pair in reversed(pw) for v in pair)
    return torch.nn.functional.pad(x, flat)

kernel_name = 'standalone__winograd__vision'

def setup_inputs():

    _w = (lambda a: (lambda t: t.to(torch.bfloat16) if t.is_floating_point() else t)(torch.as_tensor(a)))
    H = W = 512 // 2 * 2
    C = 192
    return {
        "x": _w((lambda *s: torch.randn(*s, dtype=torch.bfloat16) * 0.05)(1, H, W, C)),
        "w": _w((lambda *s: torch.randn(*s, dtype=torch.bfloat16) * 0.05)(3, 3, C, C)),
    }

def reference(x, w):
    N, H, W, C = x.shape
    K = w.shape[-1]
    G  = torch.as_tensor([[1.0,0.0,0.0],[0.5,0.5,0.5],[0.5,-0.5,0.5],[0.0,0.0,1.0]], dtype=x.dtype)
    Bt = torch.as_tensor([[1.0,0.0,-1.0,0.0],[0.0,1.0,1.0,0.0],[0.0,-1.0,1.0,0.0],[0.0,1.0,0.0,-1.0]], dtype=x.dtype)
    At = torch.as_tensor([[1.0,1.0,1.0,0.0],[0.0,1.0,-1.0,-1.0]], dtype=x.dtype)
    U = torch.einsum("ar,rsck,bs->abck", G, w, G)
    xp = _pad(x, ((0,0),(1,1),(1,1),(0,0)))
    nH, nW = H // 2, W // 2
    patches = []
    for i in range(4):
        for j in range(4):
            patches.append(xp[:, i:i + 2 * nH:2, j:j + 2 * nW:2, :])
    d = torch.stack(patches).reshape(4, 4, N * nH * nW, C)
    V = torch.einsum("ai,ijpc,bj->abpc", Bt, d, Bt)
    M = torch.einsum("abck,abpc->abpk", U, V)
    Y = torch.einsum("ma,abpk,nb->pmnk", At, M, At)
    Y = Y.reshape(N, nH, nW, 2, 2, K)
    Y = (lambda x, *d: x.permute(*d))(Y, 0, 1, 3, 2, 4, 5).reshape(N, H, W, K)
    return Y
```

```asm
; @launch kernel=wt_kernel grid=(216,1,1) block=(64,1,1) lds=0
; @launch kernel=wino_kernel grid=(256,1,1) block=(256,1,1) lds=163840
.amdgcn_target "amdgcn-amd-amdhsa--gfx950"
.text
.globl wt_kernel
.p2align 8
.type wt_kernel,@function
wt_kernel:
    s_cmp_ge_u32 s2, 216
    s_cbranch_scc1 wt_done
    s_load_dwordx2 s[4:5], s[0:1], 8
    s_load_dwordx2 s[6:7], s[0:1], 32
    s_mul_i32 s20, s2, 43691
    s_lshr_b32 s20, s20, 17
    s_mul_i32 s21, s20, 3
    s_sub_u32 s21, s2, s21
    s_and_b32 s22, s20, 3
    s_lshr_b32 s23, s20, 2
    s_mul_i32 s24, s23, 43691
    s_lshr_b32 s24, s24, 17
    s_mul_i32 s25, s24, 3
    s_sub_u32 s25, s23, s25
    v_and_b32 v1, 15, v0
    v_lshrrev_b32 v2, 4, v0
    v_and_b32 v3, 12, v1
    s_cmp_lt_u32 s21, 2
    s_cselect_b32 s26, 1, 0
    s_lshl_b32 s27, s21, 2
    s_cmp_lt_u32 s21, 2
    s_cselect_b32 s27, s27, 32
    v_mul_u32_u24 v3, s26, v3
    v_add_u32 v3, v3, v1
    s_mul_i32 s28, s22, 48
    s_add_u32 s27, s27, s28
    v_add_u32 v3, s27, v3
    v_lshlrev_b32 v3, 1, v3
    v_mul_u32_u24 v4, 3072, v2
    v_add_u32 v3, v3, v4
    s_mul_i32 s28, s25, 73728
    s_mul_i32 s29, s24, 12288
    s_add_u32 s28, s28, s29
    s_add_u32 s29, s28, 221184
    s_add_u32 s30, s28, 442368
    s_waitcnt lgkmcnt(0)
    s_mov_b32 s8, s4
    s_and_b32 s9, s5, 0xffff
    s_mov_b32 s10, 663552
    s_mov_b32 s11, 0x20000
    s_mov_b32 s12, s6
    s_and_b32 s13, s7, 0xffff
    s_mov_b32 s14, 1327104
    s_mov_b32 s15, 0x20000
    buffer_load_ushort v10, v3, s[8:11], s28 offen offset:0
    buffer_load_ushort v11, v3, s[8:11], s28 offen offset:384
    buffer_load_ushort v12, v3, s[8:11], s28 offen offset:768
    buffer_load_ushort v13, v3, s[8:11], s28 offen offset:1152
    buffer_load_ushort v14, v3, s[8:11], s28 offen offset:1536
    buffer_load_ushort v15, v3, s[8:11], s28 offen offset:1920
    buffer_load_ushort v16, v3, s[8:11], s28 offen offset:2304
    buffer_load_ushort v17, v3, s[8:11], s28 offen offset:2688
    buffer_load_ushort v18, v3, s[8:11], s29 offen offset:0
    buffer_load_ushort v19, v3, s[8:11], s29 offen offset:384
    buffer_load_ushort v20, v3, s[8:11], s29 offen offset:768
    buffer_load_ushort v21, v3, s[8:11], s29 offen offset:1152
    buffer_load_ushort v22, v3, s[8:11], s29 offen offset:1536
    buffer_load_ushort v23, v3, s[8:11], s29 offen offset:1920
    buffer_load_ushort v24, v3, s[8:11], s29 offen offset:2304
    buffer_load_ushort v25, v3, s[8:11], s29 offen offset:2688
    buffer_load_ushort v26, v3, s[8:11], s30 offen offset:0
    buffer_load_ushort v27, v3, s[8:11], s30 offen offset:384
    buffer_load_ushort v28, v3, s[8:11], s30 offen offset:768
    buffer_load_ushort v29, v3, s[8:11], s30 offen offset:1152
    buffer_load_ushort v30, v3, s[8:11], s30 offen offset:1536
    buffer_load_ushort v31, v3, s[8:11], s30 offen offset:1920
    buffer_load_ushort v32, v3, s[8:11], s30 offen offset:2304
    buffer_load_ushort v33, v3, s[8:11], s30 offen offset:2688
    s_mul_i32 s31, s22, 9216
    s_mul_i32 s32, s25, 3072
    s_add_u32 s31, s31, s32
    s_lshl_b32 s32, s21, 10
    s_add_u32 s31, s31, s32
    v_lshlrev_b32 v5, 4, v0
    v_add_u32 v5, s31, v5
    s_mul_i32 s33, s24, 36864
    s_lshl_b32 s34, s33, 2
    s_waitcnt vmcnt(0)
    v_lshlrev_b32 v10, 16, v10
    v_lshlrev_b32 v11, 16, v11
    v_lshlrev_b32 v12, 16, v12
    v_lshlrev_b32 v13, 16, v13
    v_lshlrev_b32 v14, 16, v14
    v_lshlrev_b32 v15, 16, v15
    v_lshlrev_b32 v16, 16, v16
    v_lshlrev_b32 v17, 16, v17
    v_lshlrev_b32 v18, 16, v18
    v_lshlrev_b32 v19, 16, v19
    v_lshlrev_b32 v20, 16, v20
    v_lshlrev_b32 v21, 16, v21
    v_lshlrev_b32 v22, 16, v22
    v_lshlrev_b32 v23, 16, v23
    v_lshlrev_b32 v24, 16, v24
    v_lshlrev_b32 v25, 16, v25
    v_lshlrev_b32 v26, 16, v26
    v_lshlrev_b32 v27, 16, v27
    v_lshlrev_b32 v28, 16, v28
    v_lshlrev_b32 v29, 16, v29
    v_lshlrev_b32 v30, 16, v30
    v_lshlrev_b32 v31, 16, v31
    v_lshlrev_b32 v32, 16, v32
    v_lshlrev_b32 v33, 16, v33
    v_cvt_pk_bf16_f32 v48, v10, v11
    v_cvt_pk_bf16_f32 v49, v12, v13
    v_cvt_pk_bf16_f32 v50, v14, v15
    v_cvt_pk_bf16_f32 v51, v16, v17
    s_add_u32 s35, s33, 884736
    buffer_store_dwordx4 v[48:51], v5, s[12:15], s35 offen
    v_mul_f32 v36, 0xbebccf65, v10
    v_fmac_f32 v36, 0xbe6c033f, v18
    v_fmac_f32 v36, 0xbe138207, v26
    v_mul_f32 v37, 0xbebccf65, v11
    v_fmac_f32 v37, 0xbe6c033f, v19
    v_fmac_f32 v37, 0xbe138207, v27
    v_mul_f32 v38, 0xbebccf65, v12
    v_fmac_f32 v38, 0xbe6c033f, v20
    v_fmac_f32 v38, 0xbe138207, v28
    v_mul_f32 v39, 0xbebccf65, v13
    v_fmac_f32 v39, 0xbe6c033f, v21
    v_fmac_f32 v39, 0xbe138207, v29
    v_mul_f32 v40, 0xbebccf65, v14
    v_fmac_f32 v40, 0xbe6c033f, v22
    v_fmac_f32 v40, 0xbe138207, v30
    v_mul_f32 v41, 0xbebccf65, v15
    v_fmac_f32 v41, 0xbe6c033f, v23
    v_fmac_f32 v41, 0xbe138207, v31
    v_mul_f32 v42, 0xbebccf65, v16
    v_fmac_f32 v42, 0xbe6c033f, v24
    v_fmac_f32 v42, 0xbe138207, v32
    v_mul_f32 v43, 0xbebccf65, v17
    v_fmac_f32 v43, 0xbe6c033f, v25
    v_fmac_f32 v43, 0xbe138207, v33
    v_cvt_pk_bf16_f32 v52, v36, v37
    v_cvt_pk_bf16_f32 v53, v38, v39
    v_cvt_pk_bf16_f32 v54, v40, v41
    v_cvt_pk_bf16_f32 v55, v42, v43
    s_add_u32 s35, s34, 0
    buffer_store_dwordx4 v[52:55], v5, s[12:15], s35 offen
    v_mul_f32 v36, 0xbebccf65, v10
    v_fmac_f32 v36, 0x3e6c033f, v18
    v_fmac_f32 v36, 0xbe138207, v26
    v_mul_f32 v37, 0xbebccf65, v11
    v_fmac_f32 v37, 0x3e6c033f, v19
    v_fmac_f32 v37, 0xbe138207, v27
    v_mul_f32 v38, 0xbebccf65, v12
    v_fmac_f32 v38, 0x3e6c033f, v20
    v_fmac_f32 v38, 0xbe138207, v28
    v_mul_f32 v39, 0xbebccf65, v13
    v_fmac_f32 v39, 0x3e6c033f, v21
    v_fmac_f32 v39, 0xbe138207, v29
    v_mul_f32 v40, 0xbebccf65, v14
    v_fmac_f32 v40, 0x3e6c033f, v22
    v_fmac_f32 v40, 0xbe138207, v30
    v_mul_f32 v41, 0xbebccf65, v15
    v_fmac_f32 v41, 0x3e6c033f, v23
    v_fmac_f32 v41, 0xbe138207, v31
    v_mul_f32 v42, 0xbebccf65, v16
    v_fmac_f32 v42, 0x3e6c033f, v24
    v_fmac_f32 v42, 0xbe138207, v32
    v_mul_f32 v43, 0xbebccf65, v17
    v_fmac_f32 v43, 0x3e6c033f, v25
    v_fmac_f32 v43, 0xbe138207, v33
    v_cvt_pk_bf16_f32 v56, v36, v37
    v_cvt_pk_bf16_f32 v57, v38, v39
    v_cvt_pk_bf16_f32 v58, v40, v41
    v_cvt_pk_bf16_f32 v59, v42, v43
    s_add_u32 s35, s34, 36864
    buffer_store_dwordx4 v[56:59], v5, s[12:15], s35 offen
    v_mul_f32 v36, 0x3ebccf65, v10
    v_fmac_f32 v36, 0x3f170c51, v18
    v_fmac_f32 v36, 0x3f71ad4f, v26
    v_mul_f32 v37, 0x3ebccf65, v11
    v_fmac_f32 v37, 0x3f170c51, v19
    v_fmac_f32 v37, 0x3f71ad4f, v27
    v_mul_f32 v38, 0x3ebccf65, v12
    v_fmac_f32 v38, 0x3f170c51, v20
    v_fmac_f32 v38, 0x3f71ad4f, v28
    v_mul_f32 v39, 0x3ebccf65, v13
    v_fmac_f32 v39, 0x3f170c51, v21
    v_fmac_f32 v39, 0x3f71ad4f, v29
    v_mul_f32 v40, 0x3ebccf65, v14
    v_fmac_f32 v40, 0x3f170c51, v22
    v_fmac_f32 v40, 0x3f71ad4f, v30
    v_mul_f32 v41, 0x3ebccf65, v15
    v_fmac_f32 v41, 0x3f170c51, v23
    v_fmac_f32 v41, 0x3f71ad4f, v31
    v_mul_f32 v42, 0x3ebccf65, v16
    v_fmac_f32 v42, 0x3f170c51, v24
    v_fmac_f32 v42, 0x3f71ad4f, v32
    v_mul_f32 v43, 0x3ebccf65, v17
    v_fmac_f32 v43, 0x3f170c51, v25
    v_fmac_f32 v43, 0x3f71ad4f, v33
    v_cvt_pk_bf16_f32 v60, v36, v37
    v_cvt_pk_bf16_f32 v61, v38, v39
    v_cvt_pk_bf16_f32 v62, v40, v41
    v_cvt_pk_bf16_f32 v63, v42, v43
    s_add_u32 s35, s34, 73728
    buffer_store_dwordx4 v[60:63], v5, s[12:15], s35 offen
    v_mul_f32 v36, 0x3ebccf65, v10
    v_fmac_f32 v36, 0xbf170c51, v18
    v_fmac_f32 v36, 0x3f71ad4f, v26
    v_mul_f32 v37, 0x3ebccf65, v11
    v_fmac_f32 v37, 0xbf170c51, v19
    v_fmac_f32 v37, 0x3f71ad4f, v27
    v_mul_f32 v38, 0x3ebccf65, v12
    v_fmac_f32 v38, 0xbf170c51, v20
    v_fmac_f32 v38, 0x3f71ad4f, v28
    v_mul_f32 v39, 0x3ebccf65, v13
    v_fmac_f32 v39, 0xbf170c51, v21
    v_fmac_f32 v39, 0x3f71ad4f, v29
    v_mul_f32 v40, 0x3ebccf65, v14
    v_fmac_f32 v40, 0xbf170c51, v22
    v_fmac_f32 v40, 0x3f71ad4f, v30
    v_mul_f32 v41, 0x3ebccf65, v15
    v_fmac_f32 v41, 0xbf170c51, v23
    v_fmac_f32 v41, 0x3f71ad4f, v31
    v_mul_f32 v42, 0x3ebccf65, v16
    v_fmac_f32 v42, 0xbf170c51, v24
    v_fmac_f32 v42, 0x3f71ad4f, v32
    v_mul_f32 v43, 0x3ebccf65, v17
    v_fmac_f32 v43, 0xbf170c51, v25
    v_fmac_f32 v43, 0x3f71ad4f, v33
    v_cvt_pk_bf16_f32 v64, v36, v37
    v_cvt_pk_bf16_f32 v65, v38, v39
    v_cvt_pk_bf16_f32 v66, v40, v41
    v_cvt_pk_bf16_f32 v67, v42, v43
    s_add_u32 s35, s34, 110592
    buffer_store_dwordx4 v[64:67], v5, s[12:15], s35 offen
    v_cvt_pk_bf16_f32 v68, v26, v27
    v_cvt_pk_bf16_f32 v69, v28, v29
    v_cvt_pk_bf16_f32 v70, v30, v31
    v_cvt_pk_bf16_f32 v71, v32, v33
    s_add_u32 s35, s33, 1105920
    buffer_store_dwordx4 v[68:71], v5, s[12:15], s35 offen
wt_done:
    s_endpgm
.globl wino_kernel
.p2align 8
.type wino_kernel,@function
wino_kernel:
    s_cmp_ge_u32 s2, 256
    s_cbranch_scc1 main_done
    s_load_dwordx2 s[16:17], s[0:1], 0
    s_load_dwordx2 s[18:19], s[0:1], 16
    s_load_dwordx2 s[20:21], s[0:1], 32
    v_lshrrev_b32 v1, 6, v0
    v_and_b32 v2, 63, v0
    v_readfirstlane_b32 s38, v1
    v_lshlrev_b32 v254, 4, v2
    v_lshrrev_b32 v3, 4, v2
    v_mul_u32_u24 v4, 40704, v3
    v_lshrrev_b32 v3, 1, v3
    v_lshl_add_u32 v4, v3, 6, v4
    v_and_b32 v3, 0xf0, v254
    v_add_u32 v253, v4, v3
    v_lshrrev_b32 v3, 3, v2
    v_and_b32 v4, 7, v2
    v_mul_u32_u24 v5, 3072, v3
    v_lshl_add_u32 v5, v4, 3, v5
    v_lshrrev_b32 v6, 1, v4
    v_mul_u32_u24 v7, 40704, v6
    v_lshrrev_b32 v6, 1, v6
    v_lshl_add_u32 v7, v6, 6, v7
    v_and_b32 v6, 1, v2
    v_lshl_add_u32 v7, v6, 3, v7
    v_lshl_add_u32 v7, v3, 4, v7
    s_and_b32 s42, s38, 1
    s_lshr_b32 s43, s38, 1
    s_lshl_b32 s44, s42, 7
    s_mul_i32 s45, s43, 1056
    s_add_u32 s44, s44, s45
    v_add_u32 v7, s44, v7
    v_lshl_or_b32 v255, v7, 15, v5
    s_lshr_b32 s44, s2, 3
    s_and_b32 s48, s44, 3
    s_lshr_b32 s44, s44, 2
    s_and_b32 s49, s2, 7
    s_lshl_b32 s49, s49, 4
    s_add_u32 s49, s49, s44
    s_mul_i32 s50, s42, 24576
    s_mul_i32 s45, s43, 1536
    s_add_u32 s50, s50, s45
    s_mul_i32 s53, s48, 49152
    s_add_u32 s53, s53, s50
    s_cmp_gt_u32 s48, 0
    s_cselect_b32 s45, 384, 0
    s_cselect_b32 s55, 0, 2130706432
    s_add_u32 s50, s50, s45
    s_add_u32 s54, s45, 49152
    s_cmp_eq_u32 s48, 3
    s_cselect_b32 s54, 2130706432, s54
    s_mul_i32 s52, s38, 96
    s_mul_i32 s51, s38, 40704
    s_lshl_b32 s45, s43, 6
    s_add_u32 s51, s51, s45
    s_lshl_b32 s45, s42, 4
    s_add_u32 s51, s51, s45
    s_mul_i32 s40, s49, 786432
    s_mul_i32 s45, s48, 49152
    s_add_u32 s40, s40, s45
    s_mul_i32 s45, s38, 12288
    s_add_u32 s40, s40, s45
    s_mov_b32 s41, 2130706432
    s_mov_b32 s39, 0
    s_lshl_b32 s45, s38, 4
    s_lshl_b64 s[46:47], 3, s45
    s_mov_b32 s56, 0xffff0000
    s_mov_b32 s57, 0
    s_mov_b32 s58, 0x0fff0fff
    s_mov_b32 s59, 0
    s_mov_b32 s23, 0xc03cd70a
    s_mov_b32 s24, 0xbec80000
    s_mov_b32 s25, 0xc023d70a
    s_mov_b32 s26, 0x3f200000
    s_mov_b32 s27, 0xbf200000
    s_mov_b32 s28, 0x3fcccccd
    s_mov_b32 s29, 0xbfcccccd
    s_mov_b32 s30, 0x3ec80000
    s_mov_b32 s31, 0x3ec80000
    s_mov_b32 s32, 0x3f200000
    s_mov_b32 s33, 0x3f200000
    s_mov_b32 s34, 0x3e7a0000
    s_mov_b32 s35, 0x3e7a0000
    s_mov_b32 s36, 0x3fcccccd
    s_mov_b32 s37, 0x3fcccccd
    s_mov_b32 s22, 0xffff0000
    s_mul_i32 s45, s38, 9216
    s_waitcnt lgkmcnt(0)
    s_mov_b32 s4, s16
    s_and_b32 s5, s17, 0xffff
    s_mov_b32 s6, 100663296
    s_mov_b32 s7, 0x20000
    s_mov_b32 s12, s18
    s_and_b32 s13, s19, 0xffff
    s_mov_b32 s14, 100663296
    s_mov_b32 s15, 0x20000
    s_add_u32 s20, s20, s45
    s_addc_u32 s21, s21, 0
    s_mov_b32 s8, s20
    s_and_b32 s9, s21, 0xffff
    s_mov_b32 s10, 1299456
    s_mov_b32 s11, 0x20000
    s_lshl_b32 s43, s49, 2
    s_mul_i32 s43, s43, 196608
    s_add_u32 s43, s43, s53
    s_cmp_ge_u32 s49, 128
    s_cselect_b32 s43, 2130706432, s43
    s_sub_u32 s16, s43, 196608
    s_cmp_eq_u32 s49, 0
    s_cselect_b32 s16, 2130706432, s16
    s_mov_b32 s17, s43
    s_add_u32 s18, s43, 196608
    s_add_u32 s19, s43, 393216
    s_add_u32 s20, s43, 589824
    s_add_u32 s21, s43, 786432
    v_and_b32 v67, 0xf0, v254
    v_lshrrev_b32 v67, 1, v67
    v_add_u32 v67, s52, v67
    v_mov_b32 v66, s54
    v_mov_b32 v65, s55
    v_cndmask_b32 v66, v66, v65, s[56:57]
    v_add_u32 v67, v67, v66
    s_sub_u32 s45, s16, s50
    buffer_load_dwordx2 v[56:57], v67, s[4:7], s45 offen
    s_sub_u32 s45, s17, s50
    buffer_load_dwordx2 v[58:59], v67, s[4:7], s45 offen
    s_sub_u32 s45, s18, s50
    buffer_load_dwordx2 v[60:61], v67, s[4:7], s45 offen
    s_sub_u32 s45, s19, s50
    buffer_load_dwordx2 v[62:63], v67, s[4:7], s45 offen
    s_sub_u32 s45, s20, s50
    buffer_load_dwordx2 v[64:65], v67, s[4:7], s45 offen
    s_sub_u32 s45, s21, s50
    buffer_load_dwordx2 v[66:67], v67, s[4:7], s45 offen
    v_and_b32 v19, 0x7fff, v255
    buffer_load_dwordx2 v[8:9], v19, s[4:7], s16 offen offset:0
    buffer_load_dwordx2 v[10:11], v19, s[4:7], s17 offen offset:0
    buffer_load_dwordx2 v[12:13], v19, s[4:7], s18 offen offset:0
    buffer_load_dwordx2 v[14:15], v19, s[4:7], s19 offen offset:0
    buffer_load_dwordx2 v[16:17], v19, s[4:7], s20 offen offset:0
    buffer_load_dwordx2 v[18:19], v19, s[4:7], s21 offen offset:0
    v_and_b32 v31, 0x7fff, v255
    buffer_load_dwordx2 v[20:21], v31, s[4:7], s16 offen offset:384
    buffer_load_dwordx2 v[22:23], v31, s[4:7], s17 offen offset:384
    buffer_load_dwordx2 v[24:25], v31, s[4:7], s18 offen offset:384
    buffer_load_dwordx2 v[26:27], v31, s[4:7], s19 offen offset:384
    buffer_load_dwordx2 v[28:29], v31, s[4:7], s20 offen offset:384
    buffer_load_dwordx2 v[30:31], v31, s[4:7], s21 offen offset:384
    v_and_b32 v43, 0x7fff, v255
    buffer_load_dwordx2 v[32:33], v43, s[4:7], s16 offen offset:768
    buffer_load_dwordx2 v[34:35], v43, s[4:7], s17 offen offset:768
    buffer_load_dwordx2 v[36:37], v43, s[4:7], s18 offen offset:768
    buffer_load_dwordx2 v[38:39], v43, s[4:7], s19 offen offset:768
    buffer_load_dwordx2 v[40:41], v43, s[4:7], s20 offen offset:768
    buffer_load_dwordx2 v[42:43], v43, s[4:7], s21 offen offset:768
    v_and_b32 v55, 0x7fff, v255
    buffer_load_dwordx2 v[44:45], v55, s[4:7], s16 offen offset:1152
    buffer_load_dwordx2 v[46:47], v55, s[4:7], s17 offen offset:1152
    buffer_load_dwordx2 v[48:49], v55, s[4:7], s18 offen offset:1152
    buffer_load_dwordx2 v[50:51], v55, s[4:7], s19 offen offset:1152
    buffer_load_dwordx2 v[52:53], v55, s[4:7], s20 offen offset:1152
    buffer_load_dwordx2 v[54:55], v55, s[4:7], s21 offen offset:1152
    s_mov_b32 s42, 0
    buffer_load_dwordx4 a[192:195], v254, s[8:11], s42 offen offset:0
    buffer_load_dwordx4 a[196:199], v254, s[8:11], s42 offen offset:1024
    buffer_load_dwordx4 a[200:203], v254, s[8:11], s42 offen offset:2048
    s_mov_b32 s42, 3072
    buffer_load_dwordx4 a[204:207], v254, s[8:11], s42 offen offset:0
    buffer_load_dwordx4 a[208:211], v254, s[8:11], s42 offen offset:1024
    buffer_load_dwordx4 a[212:215], v254, s[8:11], s42 offen offset:2048
    s_mov_b32 s42, 6144
    buffer_load_dwordx4 a[216:219], v254, s[8:11], s42 offen offset:0
    buffer_load_dwordx4 a[220:223], v254, s[8:11], s42 offen offset:1024
    buffer_load_dwordx4 a[224:227], v254, s[8:11], s42 offen offset:2048
    s_mov_b32 s42, 36864
    buffer_load_dwordx4 a[228:231], v254, s[8:11], s42 offen offset:0
    buffer_load_dwordx4 a[232:235], v254, s[8:11], s42 offen offset:1024
    buffer_load_dwordx4 a[236:239], v254, s[8:11], s42 offen offset:2048
    s_mov_b32 s42, 39936
    buffer_load_dwordx4 a[240:243], v254, s[8:11], s42 offen offset:0
    buffer_load_dwordx4 a[244:247], v254, s[8:11], s42 offen offset:1024
    buffer_load_dwordx4 a[248:251], v254, s[8:11], s42 offen offset:2048
    s_mov_b32 s42, 43008
    buffer_load_dwordx4 a[252:255], v254, s[8:11], s42 offen offset:0
    buffer_load_dwordx4 v[240:243], v254, s[8:11], s42 offen offset:1024
    buffer_load_dwordx4 v[244:247], v254, s[8:11], s42 offen offset:2048
    v_and_b32 v203, 0x7fff, v255
    buffer_load_dwordx2 v[192:193], v203, s[4:7], s16 offen offset:64
    buffer_load_dwordx2 v[194:195], v203, s[4:7], s17 offen offset:64
    buffer_load_dwordx2 v[196:197], v203, s[4:7], s18 offen offset:64
    buffer_load_dwordx2 v[198:199], v203, s[4:7], s19 offen offset:64
    buffer_load_dwordx2 v[200:201], v203, s[4:7], s20 offen offset:64
    buffer_load_dwordx2 v[202:203], v203, s[4:7], s21 offen offset:64
    v_and_b32 v215, 0x7fff, v255
    buffer_load_dwordx2 v[204:205], v215, s[4:7], s16 offen offset:448
    buffer_load_dwordx2 v[206:207], v215, s[4:7], s17 offen offset:448
    buffer_load_dwordx2 v[208:209], v215, s[4:7], s18 offen offset:448
    buffer_load_dwordx2 v[210:211], v215, s[4:7], s19 offen offset:448
    buffer_load_dwordx2 v[212:213], v215, s[4:7], s20 offen offset:448
    buffer_load_dwordx2 v[214:215], v215, s[4:7], s21 offen offset:448
    s_waitcnt vmcnt(54)
    v_lshlrev_b32 v248, 16, v58
    v_lshlrev_b32 v249, 16, v60
    v_lshlrev_b32 v250, 16, v62
    v_lshlrev_b32 v251, 16, v64
    v_and_b32 v58, s22, v58
    v_and_b32 v60, s22, v60
    v_and_b32 v62, s22, v62
    v_and_b32 v64, s22, v64
    v_lshlrev_b32 v252, 16, v56
    v_and_b32 v56, s22, v56
    v_add_f32 v252, v252, v251
    v_add_f32 v56, v56, v64
    v_fmac_f32 v252, s23, v249
    v_fmac_f32 v56, s23, v60
    v_cvt_pk_bf16_f32 v56, v252, v56
    v_lshlrev_b32 v252, 16, v66
    v_and_b32 v66, s22, v66
    v_add_f32 v252, v252, v248
    v_add_f32 v66, v66, v58
    v_fmac_f32 v252, s23, v250
    v_fmac_f32 v66, s23, v62
    v_cvt_pk_bf16_f32 v66, v252, v66
    v_fma_f32 v252, v249, s24, v251
    v_fmac_f32 v251, s25, v249
    v_fma_f32 v249, v248, s24, v250
    v_fmac_f32 v250, s25, v248
    v_fma_f32 v248, v250, s26, v251
    v_fmac_f32 v251, s27, v250
    v_fma_f32 v250, v249, s28, v252
    v_fmac_f32 v252, s29, v249
    v_fma_f32 v249, v60, s24, v64
    v_fmac_f32 v64, s25, v60
    v_fma_f32 v60, v58, s24, v62
    v_fmac_f32 v62, s25, v58
    v_fma_f32 v58, v62, s26, v64
    v_fmac_f32 v64, s27, v62
    v_fma_f32 v62, v60, s28, v249
    v_fmac_f32 v249, s29, v60
    v_cvt_pk_bf16_f32 v58, v248, v58
    v_cvt_pk_bf16_f32 v64, v251, v64
    v_cvt_pk_bf16_f32 v62, v250, v62
    v_cvt_pk_bf16_f32 v60, v252, v249
    v_lshlrev_b32 v248, 16, v59
    v_lshlrev_b32 v249, 16, v61
    v_lshlrev_b32 v250, 16, v63
    v_lshlrev_b32 v251, 16, v65
    v_and_b32 v59, s22, v59
    v_and_b32 v61, s22, v61
    v_and_b32 v63, s22, v63
    v_and_b32 v65, s22, v65
    v_lshlrev_b32 v252, 16, v57
    v_and_b32 v57, s22, v57
    v_add_f32 v252, v252, v251
    v_add_f32 v57, v57, v65
    v_fmac_f32 v252, s23, v249
    v_fmac_f32 v57, s23, v61
    v_cvt_pk_bf16_f32 v57, v252, v57
    v_lshlrev_b32 v252, 16, v67
    v_and_b32 v67, s22, v67
    v_add_f32 v252, v252, v248
    v_add_f32 v67, v67, v59
    v_fmac_f32 v252, s23, v250
    v_fmac_f32 v67, s23, v63
    v_cvt_pk_bf16_f32 v67, v252, v67
    v_fma_f32 v252, v249, s24, v251
    v_fmac_f32 v251, s25, v249
    v_fma_f32 v249, v248, s24, v250
    v_fmac_f32 v250, s25, v248
    v_fma_f32 v248, v250, s26, v251
    v_fmac_f32 v251, s27, v250
    v_fma_f32 v250, v249, s28, v252
    v_fmac_f32 v252, s29, v249
    v_fma_f32 v249, v61, s24, v65
    v_fmac_f32 v65, s25, v61
    v_fma_f32 v61, v59, s24, v63
    v_fmac_f32 v63, s25, v59
    v_fma_f32 v59, v63, s26, v65
    v_fmac_f32 v65, s27, v63
    v_fma_f32 v63, v61, s28, v249
    v_fmac_f32 v249, s29, v61
    v_cvt_pk_bf16_f32 v59, v248, v59
    v_cvt_pk_bf16_f32 v65, v251, v65
    v_cvt_pk_bf16_f32 v63, v250, v63
    v_cvt_pk_bf16_f32 v61, v252, v249
    v_and_b32 v248, 0xf0, v254
    v_lshrrev_b32 v248, 1, v248
    v_add_u32 v248, s52, v248
    v_and_b32 v252, 8, v248
    v_lshrrev_b32 v249, 6, v248
    v_mul_u32_u24 v249, 192, v249
    v_add_u32 v252, v252, v249
    v_bfe_u32 v249, v248, 4, 2
    v_mul_u32_u24 v249, 40704, v249
    v_add_u32 v252, v252, v249
    v_and_b32 v249, 32, v248
    v_lshl_add_u32 v252, v249, 1, v252
    v_bfe_u32 v249, v254, 8, 1
    v_lshl_add_u32 v252, v249, 4, v252
    v_mov_b32 v249, 123328
    v_cndmask_b32 v252, v249, v252, s[58:59]
    ds_write_b64 v252, v[56:57] offset:39520
    ds_write_b64 v252, v[58:59] offset:39552
    ds_write_b64 v252, v[64:65] offset:39584
    ds_write_b64 v252, v[62:63] offset:39616
    ds_write_b64 v252, v[60:61] offset:39648
    ds_write_b64 v252, v[66:67] offset:39680
    s_waitcnt lgkmcnt(0)
    s_barrier
    s_waitcnt vmcnt(48)
    v_lshlrev_b32 v248, 16, v10
    v_lshlrev_b32 v249, 16, v12
    v_lshlrev_b32 v250, 16, v14
    v_lshlrev_b32 v251, 16, v16
    v_and_b32 v10, s22, v10
    v_and_b32 v12, s22, v12
    v_and_b32 v14, s22, v14
    v_and_b32 v16, s22, v16
    v_lshlrev_b32 v252, 16, v8
    v_and_b32 v8, s22, v8
    v_add_f32 v252, v252, v251
    v_add_f32 v8, v8, v16
    v_fmac_f32 v252, s23, v249
    v_fmac_f32 v8, s23, v12
    v_cvt_pk_bf16_f32 v8, v252, v8
    v_lshlrev_b32 v252, 16, v18
    v_and_b32 v18, s22, v18
    v_add_f32 v252, v252, v248
    v_add_f32 v18, v18, v10
    v_fmac_f32 v252, s23, v250
    v_fmac_f32 v18, s23, v14
    v_cvt_pk_bf16_f32 v18, v252, v18
    v_fma_f32 v252, v249, s24, v251
    v_fmac_f32 v251, s25, v249
    v_fma_f32 v249, v248, s24, v250
    v_fmac_f32 v250, s25, v248
    v_fma_f32 v248, v250, s26, v251
    v_fmac_f32 v251, s27, v250
    v_fma_f32 v250, v249, s28, v252
    v_fmac_f32 v252, s29, v249
    v_fma_f32 v249, v12, s24, v16
    v_fmac_f32 v16, s25, v12
    v_fma_f32 v12, v10, s24, v14
    v_fmac_f32 v14, s25, v10
    v_fma_f32 v10, v14, s26, v16
    v_fmac_f32 v16, s27, v14
    v_fma_f32 v14, v12, s28, v249
    v_fmac_f32 v249, s29, v12
    v_cvt_pk_bf16_f32 v10, v248, v10
    v_cvt_pk_bf16_f32 v16, v251, v16
    v_cvt_pk_bf16_f32 v14, v250, v14
    v_cvt_pk_bf16_f32 v12, v252, v249
    v_lshlrev_b32 v248, 16, v11
    v_lshlrev_b32 v249, 16, v13
    v_lshlrev_b32 v250, 16, v15
    v_lshlrev_b32 v251, 16, v17
    v_and_b32 v11, s22, v11
    v_and_b32 v13, s22, v13
    v_and_b32 v15, s22, v15
    v_and_b32 v17, s22, v17
    v_lshlrev_b32 v252, 16, v9
    v_and_b32 v9, s22, v9
    v_add_f32 v252, v252, v251
    v_add_f32 v9, v9, v17
    v_fmac_f32 v252, s23, v249
    v_fmac_f32 v9, s23, v13
    v_cvt_pk_bf16_f32 v9, v252, v9
    v_lshlrev_b32 v252, 16, v19
    v_and_b32 v19, s22, v19
    v_add_f32 v252, v252, v248
    v_add_f32 v19, v19, v11
    v_fmac_f32 v252, s23, v250
    v_fmac_f32 v19, s23, v15
    v_cvt_pk_bf16_f32 v19, v252, v19
    v_fma_f32 v252, v249, s24, v251
    v_fmac_f32 v251, s25, v249
    v_fma_f32 v249, v248, s24, v250
    v_fmac_f32 v250, s25, v248
    v_fma_f32 v248, v250, s26, v251
    v_fmac_f32 v251, s27, v250
    v_fma_f32 v250, v249, s28, v252
    v_fmac_f32 v252, s29, v249
    v_fma_f32 v249, v13, s24, v17
    v_fmac_f32 v17, s25, v13
    v_fma_f32 v13, v11, s24, v15
    v_fmac_f32 v15, s25, v11
    v_fma_f32 v11, v15, s26, v17
    v_fmac_f32 v17, s27, v15
    v_fma_f32 v15, v13, s28, v249
    v_fmac_f32 v249, s29, v13
    v_cvt_pk_bf16_f32 v11, v248, v11
    v_cvt_pk_bf16_f32 v17, v251, v17
    v_cvt_pk_bf16_f32 v15, v250, v15
    v_cvt_pk_bf16_f32 v13, v252, v249
    v_lshrrev_b32 v252, 15, v255
    ds_write_b64 v252, v[8:9] offset:34048
    ds_write_b64 v252, v[10:11] offset:768
    ds_write_b64 v252, v[16:17] offset:2848
    ds_write_b64 v252, v[14:15] offset:4928
    ds_write_b64 v252, v[12:13] offset:7008
    ds_write_b64 v252, v[18:19] offset:38208
    s_waitcnt vmcnt(42)
    v_lshlrev_b32 v248, 16, v22
    v_lshlrev_b32 v249, 16, v24
    v_lshlrev_b32 v250, 16, v26
    v_lshlrev_b32 v251, 16, v28
    v_and_b32 v22, s22, v22
    v_and_b32 v24, s22, v24
    v_and_b32 v26, s22, v26
    v_and_b32 v28, s22, v28
    v_lshlrev_b32 v252, 16, v20
    v_and_b32 v20, s22, v20
    v_add_f32 v252, v252, v251
    v_add_f32 v20, v20, v28
    v_fmac_f32 v252, s23, v249
    v_fmac_f32 v20, s23, v24
    v_cvt_pk_bf16_f32 v20, v252, v20
    v_lshlrev_b32 v252, 16, v30
    v_and_b32 v30, s22, v30
    v_add_f32 v252, v252, v248
    v_add_f32 v30, v30, v22
    v_fmac_f32 v252, s23, v250
    v_fmac_f32 v30, s23, v26
    v_cvt_pk_bf16_f32 v30, v252, v30
    v_fma_f32 v252, v249, s24, v251
    v_fmac_f32 v251, s25, v249
    v_fma_f32 v249, v248, s24, v250
    v_fmac_f32 v250, s25, v248
    v_fma_f32 v248, v250, s26, v251
    v_fmac_f32 v251, s27, v250
    v_fma_f32 v250, v249, s28, v252
    v_fmac_f32 v252, s29, v249
    v_fma_f32 v249, v24, s24, v28
    v_fmac_f32 v28, s25, v24
    v_fma_f32 v24, v22, s24, v26
    v_fmac_f32 v26, s25, v22
    v_fma_f32 v22, v26, s26, v28
    v_fmac_f32 v28, s27, v26
    v_fma_f32 v26, v24, s28, v249
    v_fmac_f32 v249, s29, v24
    v_cvt_pk_bf16_f32 v22, v248, v22
    v_cvt_pk_bf16_f32 v28, v251, v28
    v_cvt_pk_bf16_f32 v26, v250, v26
    v_cvt_pk_bf16_f32 v24, v252, v249
    v_lshlrev_b32 v248, 16, v23
    v_lshlrev_b32 v249, 16, v25
    v_lshlrev_b32 v250, 16, v27
    v_lshlrev_b32 v251, 16, v29
    v_and_b32 v23, s22, v23
    v_and_b32 v25, s22, v25
    v_and_b32 v27, s22, v27
    v_and_b32 v29, s22, v29
    v_lshlrev_b32 v252, 16, v21
    v_and_b32 v21, s22, v21
    v_add_f32 v252, v252, v251
    v_add_f32 v21, v21, v29
    v_fmac_f32 v252, s23, v249
    v_fmac_f32 v21, s23, v25
    v_cvt_pk_bf16_f32 v21, v252, v21
    v_lshlrev_b32 v252, 16, v31
    v_and_b32 v31, s22, v31
    v_add_f32 v252, v252, v248
    v_add_f32 v31, v31, v23
    v_fmac_f32 v252, s23, v250
    v_fmac_f32 v31, s23, v27
    v_cvt_pk_bf16_f32 v31, v252, v31
    v_fma_f32 v252, v249, s24, v251
    v_fmac_f32 v251, s25, v249
    v_fma_f32 v249, v248, s24, v250
    v_fmac_f32 v250, s25, v248
    v_fma_f32 v248, v250, s26, v251
    v_fmac_f32 v251, s27, v250
    v_fma_f32 v250, v249, s28, v252
    v_fmac_f32 v252, s29, v249
    v_fma_f32 v249, v25, s24, v29
    v_fmac_f32 v29, s25, v25
    v_fma_f32 v25, v23, s24, v27
    v_fmac_f32 v27, s25, v23
    v_fma_f32 v23, v27, s26, v29
    v_fmac_f32 v29, s27, v27
    v_fma_f32 v27, v25, s28, v249
    v_fmac_f32 v249, s29, v25
    v_cvt_pk_bf16_f32 v23, v248, v23
    v_cvt_pk_bf16_f32 v29, v251, v29
    v_cvt_pk_bf16_f32 v27, v250, v27
    v_cvt_pk_bf16_f32 v25, v252, v249
    v_lshrrev_b32 v252, 15, v255
    ds_write_b64 v252, v[20:21] offset:33792
    ds_write_b64 v252, v[22:23] offset:512
    ds_write_b64 v252, v[28:29] offset:2592
    ds_write_b64 v252, v[26:27] offset:4672
    ds_write_b64 v252, v[24:25] offset:6752
    ds_write_b64 v252, v[30:31] offset:37952
    s_waitcnt vmcnt(36)
    v_lshlrev_b32 v248, 16, v34
    v_lshlrev_b32 v249, 16, v36
    v_lshlrev_b32 v250, 16, v38
    v_lshlrev_b32 v251, 16, v40
    v_and_b32 v34, s22, v34
    v_and_b32 v36, s22, v36
    v_and_b32 v38, s22, v38
    v_and_b32 v40, s22, v40
    v_lshlrev_b32 v252, 16, v32
    v_and_b32 v32, s22, v32
    v_add_f32 v252, v252, v251
    v_add_f32 v32, v32, v40
    v_fmac_f32 v252, s23, v249
    v_fmac_f32 v32, s23, v36
    v_cvt_pk_bf16_f32 v32, v252, v32
    v_lshlrev_b32 v252, 16, v42
    v_and_b32 v42, s22, v42
    v_add_f32 v252, v252, v248
    v_add_f32 v42, v42, v34
    v_fmac_f32 v252, s23, v250
    v_fmac_f32 v42, s23, v38
    v_cvt_pk_bf16_f32 v42, v252, v42
    v_fma_f32 v252, v249, s24, v251
    v_fmac_f32 v251, s25, v249
    v_fma_f32 v249, v248, s24, v250
    v_fmac_f32 v250, s25, v248
    v_fma_f32 v248, v250, s26, v251
    v_fmac_f32 v251, s27, v250
    v_fma_f32 v250, v249, s28, v252
    v_fmac_f32 v252, s29, v249
    v_fma_f32 v249, v36, s24, v40
    v_fmac_f32 v40, s25, v36
    v_fma_f32 v36, v34, s24, v38
    v_fmac_f32 v38, s25, v34
    v_fma_f32 v34, v38, s26, v40
    v_fmac_f32 v40, s27, v38
    v_fma_f32 v38, v36, s28, v249
    v_fmac_f32 v249, s29, v36
    v_cvt_pk_bf16_f32 v34, v248, v34
    v_cvt_pk_bf16_f32 v40, v251, v40
    v_cvt_pk_bf16_f32 v38, v250, v38
    v_cvt_pk_bf16_f32 v36, v252, v249
    v_lshlrev_b32 v248, 16, v35
    v_lshlrev_b32 v249, 16, v37
    v_lshlrev_b32 v250, 16, v39
    v_lshlrev_b32 v251, 16, v41
    v_and_b32 v35, s22, v35
    v_and_b32 v37, s22, v37
    v_and_b32 v39, s22, v39
    v_and_b32 v41, s22, v41
    v_lshlrev_b32 v252, 16, v33
    v_and_b32 v33, s22, v33
    v_add_f32 v252, v252, v251
    v_add_f32 v33, v33, v41
    v_fmac_f32 v252, s23, v249
    v_fmac_f32 v33, s23, v37
    v_cvt_pk_bf16_f32 v33, v252, v33
    v_lshlrev_b32 v252, 16, v43
    v_and_b32 v43, s22, v43
    v_add_f32 v252, v252, v248
    v_add_f32 v43, v43, v35
    v_fmac_f32 v252, s23, v250
    v_fmac_f32 v43, s23, v39
    v_cvt_pk_bf16_f32 v43, v252, v43
    v_fma_f32 v252, v249, s24, v251
    v_fmac_f32 v251, s25, v249
    v_fma_f32 v249, v248, s24, v250
    v_fmac_f32 v250, s25, v248
    v_fma_f32 v248, v250, s26, v251
    v_fmac_f32 v251, s27, v250
    v_fma_f32 v250, v249, s28, v252
    v_fmac_f32 v252, s29, v249
    v_fma_f32 v249, v37, s24, v41
    v_fmac_f32 v41, s25, v37
    v_fma_f32 v37, v35, s24, v39
    v_fmac_f32 v39, s25, v35
    v_fma_f32 v35, v39, s26, v41
    v_fmac_f32 v41, s27, v39
    v_fma_f32 v39, v37, s28, v249
    v_fmac_f32 v249, s29, v37
    v_cvt_pk_bf16_f32 v35, v248, v35
    v_cvt_pk_bf16_f32 v41, v251, v41
    v_cvt_pk_bf16_f32 v39, v250, v39
    v_cvt_pk_bf16_f32 v37, v252, v249
    v_lshrrev_b32 v252, 15, v255
    ds_write_b64 v252, v[32:33] offset:33536
    ds_write_b64 v252, v[34:35] offset:256
    ds_write_b64 v252, v[40:41] offset:2336
    ds_write_b64 v252, v[38:39] offset:4416
    ds_write_b64 v252, v[36:37] offset:6496
    ds_write_b64 v252, v[42:43] offset:37696
    s_waitcnt vmcnt(30)
    v_lshlrev_b32 v248, 16, v46
    v_lshlrev_b32 v249, 16, v48
    v_lshlrev_b32 v250, 16, v50
    v_lshlrev_b32 v251, 16, v52
    v_and_b32 v46, s22, v46
    v_and_b32 v48, s22, v48
    v_and_b32 v50, s22, v50
    v_and_b32 v52, s22, v52
    v_lshlrev_b32 v252, 16, v44
    v_and_b32 v44, s22, v44
    v_add_f32 v252, v252, v251
    v_add_f32 v44, v44, v52
    v_fmac_f32 v252, s23, v249
    v_fmac_f32 v44, s23, v48
    v_cvt_pk_bf16_f32 v44, v252, v44
    v_lshlrev_b32 v252, 16, v54
    v_and_b32 v54, s22, v54
    v_add_f32 v252, v252, v248
    v_add_f32 v54, v54, v46
    v_fmac_f32 v252, s23, v250
    v_fmac_f32 v54, s23, v50
    v_cvt_pk_bf16_f32 v54, v252, v54
    v_fma_f32 v252, v249, s24, v251
    v_fmac_f32 v251, s25, v249
    v_fma_f32 v249, v248, s24, v250
    v_fmac_f32 v250, s25, v248
    v_fma_f32 v248, v250, s26, v251
    v_fmac_f32 v251, s27, v250
    v_fma_f32 v250, v249, s28, v252
    v_fmac_f32 v252, s29, v249
    v_fma_f32 v249, v48, s24, v52
    v_fmac_f32 v52, s25, v48
    v_fma_f32 v48, v46, s24, v50
    v_fmac_f32 v50, s25, v46
    v_fma_f32 v46, v50, s26, v52
    v_fmac_f32 v52, s27, v50
    v_fma_f32 v50, v48, s28, v249
    v_fmac_f32 v249, s29, v48
    v_cvt_pk_bf16_f32 v46, v248, v46
    v_cvt_pk_bf16_f32 v52, v251, v52
    v_cvt_pk_bf16_f32 v50, v250, v50
    v_cvt_pk_bf16_f32 v48, v252, v249
    v_lshlrev_b32 v248, 16, v47
    v_lshlrev_b32 v249, 16, v49
    v_lshlrev_b32 v250, 16, v51
    v_lshlrev_b32 v251, 16, v53
    v_and_b32 v47, s22, v47
    v_and_b32 v49, s22, v49
    v_and_b32 v51, s22, v51
    v_and_b32 v53, s22, v53
    v_lshlrev_b32 v252, 16, v45
    v_and_b32 v45, s22, v45
    v_add_f32 v252, v252, v251
    v_add_f32 v45, v45, v53
    v_fmac_f32 v252, s23, v249
    v_fmac_f32 v45, s23, v49
    v_cvt_pk_bf16_f32 v45, v252, v45
    v_lshlrev_b32 v252, 16, v55
    v_and_b32 v55, s22, v55
    v_add_f32 v252, v252, v248
    v_add_f32 v55, v55, v47
    v_fmac_f32 v252, s23, v250
    v_fmac_f32 v55, s23, v51
    v_cvt_pk_bf16_f32 v55, v252, v55
    v_fma_f32 v252, v249, s24, v251
    v_fmac_f32 v251, s25, v249
    v_fma_f32 v249, v248, s24, v250
    v_fmac_f32 v250, s25, v248
    v_fma_f32 v248, v250, s26, v251
    v_fmac_f32 v251, s27, v250
    v_fma_f32 v250, v249, s28, v252
    v_fmac_f32 v252, s29, v249
    v_fma_f32 v249, v49, s24, v53
    v_fmac_f32 v53, s25, v49
    v_fma_f32 v49, v47, s24, v51
    v_fmac_f32 v51, s25, v47
    v_fma_f32 v47, v51, s26, v53
    v_fmac_f32 v53, s27, v51
    v_fma_f32 v51, v49, s28, v249
    v_fmac_f32 v249, s29, v49
    v_cvt_pk_bf16_f32 v47, v248, v47
    v_cvt_pk_bf16_f32 v53, v251, v53
    v_cvt_pk_bf16_f32 v51, v250, v51
    v_cvt_pk_bf16_f32 v49, v252, v249
    v_lshrrev_b32 v252, 15, v255
    ds_write_b64 v252, v[44:45] offset:33280
    ds_write_b64 v252, v[46:47] offset:0
    ds_write_b64 v252, v[52:53] offset:2080
    ds_write_b64 v252, v[50:51] offset:4160
    ds_write_b64 v252, v[48:49] offset:6240
    ds_write_b64 v252, v[54:55] offset:37440
    ds_read_b128 v[248:251], v253 offset:39520
    s_waitcnt lgkmcnt(0)
    s_lshl_b64 exec, s[46:47], 0
    ds_write_b128 v253, v[248:251] offset:34304
    s_mov_b64 exec, -1
    s_lshl_b64 exec, s[46:47], 2
    ds_write_b128 v253, v[248:251] offset:992
    s_mov_b64 exec, -1
    s_lshl_b64 exec, s[46:47], 4
    ds_write_b128 v253, v[248:251] offset:3040
    s_mov_b64 exec, -1
    s_lshl_b64 exec, s[46:47], 6
    ds_write_b128 v253, v[248:251] offset:5088
    s_mov_b64 exec, -1
    s_lshl_b64 exec, s[46:47], 8
    ds_write_b128 v253, v[248:251] offset:7136
    s_mov_b64 exec, -1
    s_lshl_b64 exec, s[46:47], 10
    ds_write_b128 v253, v[248:251] offset:38304
    s_mov_b64 exec, -1
    s_waitcnt lgkmcnt(0)
    s_barrier
    ds_read_b128 v[228:231], v253 offset:1040
    ds_read_b128 v[232:235], v253 offset:768
    ds_read_b128 v[236:239], v253 offset:512
    s_waitcnt vmcnt(0) lgkmcnt(0)
.p2align 6
blk_loop:
    s_waitcnt vmcnt(19) lgkmcnt(2)
    v_mfma_f32_16x16x32_bf16 a[0:3], a[192:195], v[228:231], 0
    v_lshlrev_b32 v248, 16, v194
    v_lshlrev_b32 v249, 16, v196
    v_mfma_f32_16x16x32_bf16 a[4:7], a[196:199], v[228:231], 0
    buffer_load_dwordx4 v[240:243], v254, s[8:11], s42 offen offset:1024
    v_lshlrev_b32 v250, 16, v198
    v_bfe_u32 v2, v254, 6, 2
    v_mfma_f32_16x16x32_bf16 a[8:11], a[200:203], v[228:231], 0
    ds_read_b128 v[228:231], v253 offset:256
    v_mul_u32_u24 v0, 40704, v2
    s_waitcnt lgkmcnt(2)
    v_mfma_f32_16x16x32_bf16 a[12:15], a[192:195], v[232:235], 0
    buffer_load_dwordx4 v[244:247], v254, s[8:11], s42 offen offset:2048
    v_lshlrev_b32 v251, 16, v200
    v_mfma_f32_16x16x32_bf16 a[16:19], a[196:199], v[232:235], 0
    v_and_b32 v194, s22, v194
    v_and_b32 v196, s22, v196
    v_and_b32 v2, 0x80, v254
    v_mfma_f32_16x16x32_bf16 a[20:23], a[200:203], v[232:235], 0
    v_and_b32 v198, s22, v198
    v_lshrrev_b32 v2, 1, v2
    s_waitcnt vmcnt(18)
    v_mfma_f32_16x16x32_bf16 a[0:3], a[204:207], v[232:235], a[0:3]
    v_and_b32 v227, 0x7fff, v255
    v_and_b32 v200, s22, v200
    v_mfma_f32_16x16x32_bf16 a[4:7], a[208:211], v[232:235], a[4:7]
    buffer_load_dwordx2 v[216:217], v227, s[4:7], s16 offen offset:832
    v_lshlrev_b32 v252, 16, v192
    v_add_u32 v0, v0, v2
    v_mfma_f32_16x16x32_bf16 a[8:11], a[212:215], v[232:235], a[8:11]
    ds_read_b128 v[232:235], v253 offset:0
    s_waitcnt lgkmcnt(2)
    v_mfma_f32_16x16x32_bf16 a[24:27], a[192:195], v[236:239], 0
    buffer_load_dwordx2 v[218:219], v227, s[4:7], s17 offen offset:832
    v_and_b32 v192, s22, v192
    v_and_b32 v2, 0x40, v254
    v_mfma_f32_16x16x32_bf16 a[28:31], a[196:199], v[236:239], 0
    buffer_load_dwordx2 v[220:221], v227, s[4:7], s18 offen offset:832
    v_add_f32 v252, v252, v251
    v_lshrrev_b32 v2, 2, v2
    v_mfma_f32_16x16x32_bf16 a[32:35], a[200:203], v[236:239], 0
    v_add_f32 v192, v192, v200
    v_fmac_f32 v252, s23, v249
    v_mfma_f32_16x16x32_bf16 a[12:15], a[204:207], v[236:239], a[12:15]
    buffer_load_dwordx2 v[222:223], v227, s[4:7], s19 offen offset:832
    v_fmac_f32 v192, s23, v196
    v_add_u32 v0, v0, v2
    v_mfma_f32_16x16x32_bf16 a[16:19], a[208:211], v[236:239], a[16:19]
    buffer_load_dwordx2 v[224:225], v227, s[4:7], s20 offen offset:832
    v_cvt_pk_bf16_f32 v192, v252, v192
    v_mfma_f32_16x16x32_bf16 a[20:23], a[212:215], v[236:239], a[20:23]
    v_lshlrev_b32 v252, 16, v202
    v_bfe_u32 v2, v254, 4, 2
    s_waitcnt vmcnt(20)
    v_mfma_f32_16x16x32_bf16 a[0:3], a[216:219], v[236:239], a[0:3]
    buffer_load_dwordx2 v[226:227], v227, s[4:7], s21 offen offset:832
    v_and_b32 v202, s22, v202
    v_mul_u32_u24 v2, 3104, v2
    v_mfma_f32_16x16x32_bf16 a[4:7], a[220:223], v[236:239], a[4:7]
    v_add_f32 v252, v252, v248
    v_add_f32 v202, v202, v194
    v_mfma_f32_16x16x32_bf16 a[8:11], a[224:227], v[236:239], a[8:11]
    ds_read_b128 v[236:239], v253 offset:1824
    v_add_u32 v0, v0, v2
    s_waitcnt lgkmcnt(2)
    v_mfma_f32_16x16x32_bf16 a[36:39], a[192:195], v[228:231], 0
    v_fmac_f32 v252, s23, v250
    v_fmac_f32 v202, s23, v198
    v_add_u32 v0, s52, v0
    v_mfma_f32_16x16x32_bf16 a[40:43], a[196:199], v[228:231], 0
    v_cvt_pk_bf16_f32 v202, v252, v202
    v_fma_f32 v252, v249, s24, v251
    v_mfma_f32_16x16x32_bf16 a[44:47], a[200:203], v[228:231], 0
    v_fmac_f32 v251, s25, v249
    v_fma_f32 v249, v248, s24, v250
    v_lshrrev_b32 v2, 8, v254
    v_mfma_f32_16x16x32_bf16 a[24:27], a[204:207], v[228:231], a[24:27]
    v_fmac_f32 v250, s25, v248
    v_fma_f32 v248, v250, s26, v251
    v_mfma_f32_16x16x32_bf16 a[28:31], a[208:211], v[228:231], a[28:31]
    v_fmac_f32 v251, s27, v250
    v_fma_f32 v250, v249, s28, v252
    v_lshl_add_u32 v1, v2, 3, v0
    v_mfma_f32_16x16x32_bf16 a[32:35], a[212:215], v[228:231], a[32:35]
    v_fmac_f32 v252, s29, v249
    v_fma_f32 v249, v196, s24, v200
    v_lshl_add_u32 v0, v2, 4, v0
    v_mfma_f32_16x16x32_bf16 a[12:15], a[216:219], v[228:231], a[12:15]
    v_fmac_f32 v200, s25, v196
    v_fma_f32 v196, v194, s24, v198
    v_mfma_f32_16x16x32_bf16 a[16:19], a[220:223], v[228:231], a[16:19]
    v_fmac_f32 v198, s25, v194
    v_fma_f32 v194, v198, s26, v200
    v_cvt_pk_bf16_f32 v96, v96, v97
    v_mfma_f32_16x16x32_bf16 a[20:23], a[224:227], v[228:231], a[20:23]
    ds_read_b128 v[228:231], v253 offset:1568
    s_waitcnt lgkmcnt(2)
    v_mfma_f32_16x16x32_bf16 a[48:51], a[192:195], v[232:235], 0
    v_fmac_f32 v200, s27, v198
    v_fma_f32 v198, v196, s28, v249
    v_cvt_pk_bf16_f32 v97, v98, v99
    v_mfma_f32_16x16x32_bf16 a[52:55], a[196:199], v[232:235], 0
    v_fmac_f32 v249, s29, v196
    v_cvt_pk_bf16_f32 v194, v248, v194
    v_cvt_pk_bf16_f32 v98, v100, v101
    v_mfma_f32_16x16x32_bf16 a[56:59], a[200:203], v[232:235], 0
    v_cvt_pk_bf16_f32 v200, v251, v200
    v_cvt_pk_bf16_f32 v198, v250, v198
    v_mfma_f32_16x16x32_bf16 a[36:39], a[204:207], v[232:235], a[36:39]
    v_cvt_pk_bf16_f32 v196, v252, v249
    v_lshlrev_b32 v248, 16, v195
    v_cvt_pk_bf16_f32 v99, v102, v103
    v_mfma_f32_16x16x32_bf16 a[40:43], a[208:211], v[232:235], a[40:43]
    v_lshlrev_b32 v249, 16, v197
    v_lshlrev_b32 v250, 16, v199
    v_mfma_f32_16x16x32_bf16 a[44:47], a[212:215], v[232:235], a[44:47]
    v_lshlrev_b32 v251, 16, v201
    v_and_b32 v195, s22, v195
    v_cvt_pk_bf16_f32 v104, v104, v105
    v_mfma_f32_16x16x32_bf16 a[24:27], a[216:219], v[232:235], a[24:27]
    v_and_b32 v197, s22, v197
    v_and_b32 v199, s22, v199
    v_cvt_pk_bf16_f32 v105, v106, v107
    v_mfma_f32_16x16x32_bf16 a[28:31], a[220:223], v[232:235], a[28:31]
    v_and_b32 v201, s22, v201
    v_lshlrev_b32 v252, 16, v193
    v_mfma_f32_16x16x32_bf16 a[32:35], a[224:227], v[232:235], a[32:35]
    ds_read_b128 v[232:235], v253 offset:1312
    ds_write_b128 v0, v[96:99] offset:14560
    s_waitcnt lgkmcnt(3)
    v_mfma_f32_16x16x32_bf16 a[60:63], a[192:195], v[236:239], 0
    v_and_b32 v193, s22, v193
    v_add_f32 v252, v252, v251
    ds_write_b64 v1, v[104:105] offset:14624
    v_mfma_f32_16x16x32_bf16 a[64:67], a[196:199], v[236:239], 0
    v_add_f32 v193, v193, v201
    v_fmac_f32 v252, s23, v249
    v_mfma_f32_16x16x32_bf16 a[68:71], a[200:203], v[236:239], 0
    v_fmac_f32 v193, s23, v197
    v_cvt_pk_bf16_f32 v193, v252, v193
    v_cvt_pk_bf16_f32 v108, v108, v109
    v_mfma_f32_16x16x32_bf16 a[48:51], a[204:207], v[236:239], a[48:51]
    v_lshlrev_b32 v252, 16, v203
    v_and_b32 v203, s22, v203
    v_mfma_f32_16x16x32_bf16 a[52:55], a[208:211], v[236:239], a[52:55]
    v_add_f32 v252, v252, v248
    v_add_f32 v203, v203, v195
    v_cvt_pk_bf16_f32 v109, v110, v111
    v_mfma_f32_16x16x32_bf16 a[56:59], a[212:215], v[236:239], a[56:59]
    v_fmac_f32 v252, s23, v250
    v_fmac_f32 v203, s23, v199
    v_cvt_pk_bf16_f32 v110, v112, v113
    v_mfma_f32_16x16x32_bf16 a[36:39], a[216:219], v[236:239], a[36:39]
    v_cvt_pk_bf16_f32 v203, v252, v203
    v_fma_f32 v252, v249, s24, v251
    v_mfma_f32_16x16x32_bf16 a[40:43], a[220:223], v[236:239], a[40:43]
    v_fmac_f32 v251, s25, v249
    v_fma_f32 v249, v248, s24, v250
    v_cvt_pk_bf16_f32 v111, v114, v115
    v_mfma_f32_16x16x32_bf16 a[44:47], a[224:227], v[236:239], a[44:47]
    ds_read_b128 v[236:239], v253 offset:1056
    s_waitcnt lgkmcnt(4)
    v_mfma_f32_16x16x32_bf16 a[72:75], a[192:195], v[228:231], 0
    v_fmac_f32 v250, s25, v248
    v_fma_f32 v248, v250, s26, v251
    v_cvt_pk_bf16_f32 v116, v116, v117
    v_mfma_f32_16x16x32_bf16 a[76:79], a[196:199], v[228:231], 0
    v_fmac_f32 v251, s27, v250
    v_fma_f32 v250, v249, s28, v252
    v_cvt_pk_bf16_f32 v117, v118, v119
    v_mfma_f32_16x16x32_bf16 a[80:83], a[200:203], v[228:231], 0
    v_fmac_f32 v252, s29, v249
    v_fma_f32 v249, v197, s24, v201
    v_mfma_f32_16x16x32_bf16 a[60:63], a[204:207], v[228:231], a[60:63]
    v_fmac_f32 v201, s25, v197
    v_fma_f32 v197, v195, s24, v199
    ds_write_b128 v0, v[108:111] offset:14944
    v_mfma_f32_16x16x32_bf16 a[64:67], a[208:211], v[228:231], a[64:67]
    v_fmac_f32 v199, s25, v195
    v_fma_f32 v195, v199, s26, v201
    v_mfma_f32_16x16x32_bf16 a[68:71], a[212:215], v[228:231], a[68:71]
    v_fmac_f32 v201, s27, v199
    v_fma_f32 v199, v197, s28, v249
    ds_write_b64 v1, v[116:117] offset:15008
    v_mfma_f32_16x16x32_bf16 a[48:51], a[216:219], v[228:231], a[48:51]
    v_fmac_f32 v249, s29, v197
    v_cvt_pk_bf16_f32 v195, v248, v195
    v_cvt_pk_bf16_f32 v120, v120, v121
    v_mfma_f32_16x16x32_bf16 a[52:55], a[220:223], v[228:231], a[52:55]
    v_cvt_pk_bf16_f32 v201, v251, v201
    v_cvt_pk_bf16_f32 v199, v250, v199
    v_mfma_f32_16x16x32_bf16 a[56:59], a[224:227], v[228:231], a[56:59]
    ds_read_b128 v[228:231], v253 offset:784
    v_cvt_pk_bf16_f32 v121, v122, v123
    s_waitcnt lgkmcnt(6)
    v_mfma_f32_16x16x32_bf16 a[84:87], a[192:195], v[232:235], 0
    v_cvt_pk_bf16_f32 v197, v252, v249
    v_lshrrev_b32 v252, 15, v255
    v_cvt_pk_bf16_f32 v122, v124, v125
    v_mfma_f32_16x16x32_bf16 a[88:91], a[196:199], v[232:235], 0
    ds_write_b64 v252, v[194:195] offset:9088
    ds_write_b64 v252, v[200:201] offset:11168
    v_mfma_f32_16x16x32_bf16 a[92:95], a[200:203], v[232:235], 0
    ds_write_b64 v252, v[198:199] offset:13248
    ds_write_b64 v252, v[192:193] offset:31968
    v_cvt_pk_bf16_f32 v123, v126, v127
    v_mfma_f32_16x16x32_bf16 a[72:75], a[204:207], v[232:235], a[72:75]
    s_mov_b32 s42, 73728
    buffer_load_dwordx4 a[192:195], v254, s[8:11], s42 offen offset:0
    v_mfma_f32_16x16x32_bf16 a[76:79], a[208:211], v[232:235], a[76:79]
    ds_write_b64 v252, v[202:203] offset:36128
    ds_write_b64 v252, v[196:197] offset:29888
    v_cvt_pk_bf16_f32 v128, v128, v129
    v_mfma_f32_16x16x32_bf16 a[80:83], a[212:215], v[232:235], a[80:83]
    buffer_load_dwordx4 a[196:199], v254, s[8:11], s42 offen offset:1024
    v_cvt_pk_bf16_f32 v129, v130, v131
    ds_write_b128 v0, v[120:123] offset:15328
    v_mfma_f32_16x16x32_bf16 a[60:63], a[216:219], v[232:235], a[60:63]
    ds_write_b64 v1, v[128:129] offset:15392
    v_cvt_pk_bf16_f32 v132, v132, v133
    v_mfma_f32_16x16x32_bf16 a[64:67], a[220:223], v[232:235], a[64:67]
    buffer_load_dwordx4 a[200:203], v254, s[8:11], s42 offen offset:2048
    v_cvt_pk_bf16_f32 v133, v134, v135
    v_cvt_pk_bf16_f32 v134, v136, v137
    v_mfma_f32_16x16x32_bf16 a[68:71], a[224:227], v[232:235], a[68:71]
    ds_read_b128 v[232:235], v253 offset:3120
    s_waitcnt lgkmcnt(12)
    v_mfma_f32_16x16x32_bf16 a[84:87], a[204:207], v[236:239], a[84:87]
    s_waitcnt vmcnt(18)
    v_lshlrev_b32 v248, 16, v206
    v_lshlrev_b32 v249, 16, v208
    v_lshlrev_b32 v250, 16, v210
    v_mfma_f32_16x16x32_bf16 a[88:91], a[208:211], v[236:239], a[88:91]
    v_lshlrev_b32 v251, 16, v212
    v_and_b32 v206, s22, v206
    v_cvt_pk_bf16_f32 v135, v138, v139
    v_mfma_f32_16x16x32_bf16 a[92:95], a[212:215], v[236:239], a[92:95]
    s_mov_b32 s42, 76800
    buffer_load_dwordx4 a[204:207], v254, s[8:11], s42 offen offset:0
    v_cvt_pk_bf16_f32 v140, v140, v141
    v_mfma_f32_16x16x32_bf16 a[72:75], a[216:219], v[236:239], a[72:75]
    v_and_b32 v208, s22, v208
    v_and_b32 v210, s22, v210
    v_mfma_f32_16x16x32_bf16 a[76:79], a[220:223], v[236:239], a[76:79]
    buffer_load_dwordx4 a[208:211], v254, s[8:11], s42 offen offset:1024
    v_and_b32 v212, s22, v212
    v_cvt_pk_bf16_f32 v141, v142, v143
    v_mfma_f32_16x16x32_bf16 a[80:83], a[224:227], v[236:239], a[80:83]
    ds_read_b128 v[236:239], v253 offset:2848
    ds_write_b128 v0, v[132:135] offset:15712
    s_waitcnt lgkmcnt(11)
    v_mfma_f32_16x16x32_bf16 a[84:87], a[216:219], v[228:231], a[84:87]
    buffer_load_dwordx4 a[212:215], v254, s[8:11], s42 offen offset:2048
    v_lshlrev_b32 v252, 16, v204
    v_mfma_f32_16x16x32_bf16 a[88:91], a[220:223], v[228:231], a[88:91]
    v_and_b32 v204, s22, v204
    v_add_f32 v252, v252, v251
    ds_write_b64 v1, v[140:141] offset:15776
    v_mfma_f32_16x16x32_bf16 a[92:95], a[224:227], v[228:231], a[92:95]
    ds_read_b128 v[228:231], v253 offset:2592
    s_mov_b32 s42, 79872
    buffer_load_dwordx4 a[216:219], v254, s[8:11], s42 offen offset:0
    s_waitcnt vmcnt(19) lgkmcnt(4)
    v_mfma_f32_16x16x32_bf16 a[96:99], a[228:231], v[232:235], 0
    v_add_f32 v204, v204, v212
    v_fmac_f32 v252, s23, v249
    v_fmac_f32 v204, s23, v208
    v_mfma_f32_16x16x32_bf16 a[100:103], a[232:235], v[232:235], 0
    buffer_load_dwordx4 a[220:223], v254, s[8:11], s42 offen offset:1024
    v_cvt_pk_bf16_f32 v204, v252, v204
    v_mfma_f32_16x16x32_bf16 a[104:107], a[236:239], v[232:235], 0
    ds_read_b128 v[232:235], v253 offset:2336
    v_cvt_pk_bf16_f32 v144, v144, v145
    s_waitcnt lgkmcnt(4)
    v_mfma_f32_16x16x32_bf16 a[108:111], a[228:231], v[236:239], 0
    buffer_load_dwordx4 a[224:227], v254, s[8:11], s42 offen offset:2048
    v_lshlrev_b32 v252, 16, v214
    v_cvt_pk_bf16_f32 v145, v146, v147
    v_mfma_f32_16x16x32_bf16 a[112:115], a[232:235], v[236:239], 0
    v_and_b32 v214, s22, v214
    v_add_f32 v252, v252, v248
    v_mfma_f32_16x16x32_bf16 a[116:119], a[236:239], v[236:239], 0
    v_add_f32 v214, v214, v206
    v_cvt_pk_bf16_f32 v146, v148, v149
    s_waitcnt vmcnt(18)
    v_mfma_f32_16x16x32_bf16 a[96:99], a[240:243], v[236:239], a[96:99]
    v_and_b32 v203, 0x7fff, v255
    v_fmac_f32 v252, s23, v250
    v_mfma_f32_16x16x32_bf16 a[100:103], a[244:247], v[236:239], a[100:103]
    buffer_load_dwordx2 v[192:193], v203, s[4:7], s16 offen offset:1216
    v_fmac_f32 v214, s23, v210
    v_cvt_pk_bf16_f32 v147, v150, v151
    v_mfma_f32_16x16x32_bf16 a[104:107], a[248:251], v[236:239], a[104:107]
    ds_read_b128 v[236:239], v253 offset:2080
    v_cvt_pk_bf16_f32 v152, v152, v153
    s_waitcnt lgkmcnt(2)
    v_mfma_f32_16x16x32_bf16 a[120:123], a[228:231], v[228:231], 0
    buffer_load_dwordx2 v[194:195], v203, s[4:7], s17 offen offset:1216
    v_cvt_pk_bf16_f32 v214, v252, v214
    v_fma_f32 v252, v249, s24, v251
    v_mfma_f32_16x16x32_bf16 a[124:127], a[232:235], v[228:231], 0
    buffer_load_dwordx2 v[196:197], v203, s[4:7], s18 offen offset:1216
    v_fmac_f32 v251, s25, v249
    v_mfma_f32_16x16x32_bf16 a[128:131], a[236:239], v[228:231], 0
    v_fma_f32 v249, v248, s24, v250
    v_fmac_f32 v250, s25, v248
    v_cvt_pk_bf16_f32 v153, v154, v155
    v_mfma_f32_16x16x32_bf16 a[108:111], a[240:243], v[228:231], a[108:111]
    buffer_load_dwordx2 v[198:199], v203, s[4:7], s19 offen offset:1216
    v_fma_f32 v248, v250, s26, v251
    v_mfma_f32_16x16x32_bf16 a[112:115], a[244:247], v[228:231], a[112:115]
    buffer_load_dwordx2 v[200:201], v203, s[4:7], s20 offen offset:1216
    v_fmac_f32 v251, s27, v250
    ds_write_b128 v0, v[144:147] offset:16096
    v_mfma_f32_16x16x32_bf16 a[116:119], a[248:251], v[228:231], a[116:119]
    v_fma_f32 v250, v249, s28, v252
    ds_write_b64 v1, v[152:153] offset:16160
    s_waitcnt vmcnt(20)
    v_mfma_f32_16x16x32_bf16 a[96:99], a[252:255], v[228:231], a[96:99]
    buffer_load_dwordx2 v[202:203], v203, s[4:7], s21 offen offset:1216
    v_fmac_f32 v252, s29, v249
    v_mfma_f32_16x16x32_bf16 a[100:103], v[240:243], v[228:231], a[100:103]
    v_fma_f32 v249, v208, s24, v212
    v_fmac_f32 v212, s25, v208
    v_cvt_pk_bf16_f32 v156, v156, v157
    v_mfma_f32_16x16x32_bf16 a[104:107], v[244:247], v[228:231], a[104:107]
    ds_read_b128 v[228:231], v253 offset:3904
    v_fma_f32 v208, v206, s24, v210
    s_waitcnt lgkmcnt(4)
    v_mfma_f32_16x16x32_bf16 a[132:135], a[228:231], v[232:235], 0
    v_fmac_f32 v210, s25, v206
    v_fma_f32 v206, v210, s26, v212
    v_cvt_pk_bf16_f32 v157, v158, v159
    v_mfma_f32_16x16x32_bf16 a[136:139], a[232:235], v[232:235], 0
    v_fmac_f32 v212, s27, v210
    v_fma_f32 v210, v208, s28, v249
    v_mfma_f32_16x16x32_bf16 a[140:143], a[236:239], v[232:235], 0
    v_fmac_f32 v249, s29, v208
    v_cvt_pk_bf16_f32 v206, v248, v206
    v_cvt_pk_bf16_f32 v158, v160, v161
    v_mfma_f32_16x16x32_bf16 a[120:123], a[240:243], v[232:235], a[120:123]
    v_cvt_pk_bf16_f32 v212, v251, v212
    v_cvt_pk_bf16_f32 v210, v250, v210
    v_mfma_f32_16x16x32_bf16 a[124:127], a[244:247], v[232:235], a[124:127]
    v_cvt_pk_bf16_f32 v208, v252, v249
    v_lshlrev_b32 v248, 16, v207
    v_cvt_pk_bf16_f32 v159, v162, v163
    v_mfma_f32_16x16x32_bf16 a[128:131], a[248:251], v[232:235], a[128:131]
    v_lshlrev_b32 v249, 16, v209
    v_lshlrev_b32 v250, 16, v211
    v_cvt_pk_bf16_f32 v164, v164, v165
    v_mfma_f32_16x16x32_bf16 a[108:111], a[252:255], v[232:235], a[108:111]
    v_lshlrev_b32 v251, 16, v213
    v_and_b32 v207, s22, v207
    v_mfma_f32_16x16x32_bf16 a[112:115], v[240:243], v[232:235], a[112:115]
    v_and_b32 v209, s22, v209
    v_and_b32 v211, s22, v211
    v_cvt_pk_bf16_f32 v165, v166, v167
    v_mfma_f32_16x16x32_bf16 a[116:119], v[244:247], v[232:235], a[116:119]
    ds_read_b128 v[232:235], v253 offset:3648
    v_and_b32 v213, s22, v213
    s_waitcnt lgkmcnt(4)
    v_mfma_f32_16x16x32_bf16 a[144:147], a[228:231], v[236:239], 0
    v_lshlrev_b32 v252, 16, v205
    v_and_b32 v205, s22, v205
    v_mfma_f32_16x16x32_bf16 a[148:151], a[232:235], v[236:239], 0
    v_add_f32 v252, v252, v251
    v_add_f32 v205, v205, v213
    ds_write_b128 v0, v[156:159] offset:16480
    v_mfma_f32_16x16x32_bf16 a[152:155], a[236:239], v[236:239], 0
    v_fmac_f32 v252, s23, v249
    v_fmac_f32 v205, s23, v209
    ds_write_b64 v1, v[164:165] offset:16544
    v_mfma_f32_16x16x32_bf16 a[132:135], a[240:243], v[236:239], a[132:135]
    v_cvt_pk_bf16_f32 v205, v252, v205
    v_lshlrev_b32 v252, 16, v215
    v_mfma_f32_16x16x32_bf16 a[136:139], a[244:247], v[236:239], a[136:139]
    v_and_b32 v215, s22, v215
    v_add_f32 v252, v252, v248
    v_cvt_pk_bf16_f32 v168, v168, v169
    v_mfma_f32_16x16x32_bf16 a[140:143], a[248:251], v[236:239], a[140:143]
    v_add_f32 v215, v215, v207
    v_fmac_f32 v252, s23, v250
    v_mfma_f32_16x16x32_bf16 a[120:123], a[252:255], v[236:239], a[120:123]
    v_fmac_f32 v215, s23, v211
    v_cvt_pk_bf16_f32 v215, v252, v215
    v_cvt_pk_bf16_f32 v169, v170, v171
    v_mfma_f32_16x16x32_bf16 a[124:127], v[240:243], v[236:239], a[124:127]
    v_fma_f32 v252, v249, s24, v251
    v_fmac_f32 v251, s25, v249
    v_fma_f32 v249, v248, s24, v250
    v_mfma_f32_16x16x32_bf16 a[128:131], v[244:247], v[236:239], a[128:131]
    ds_read_b128 v[236:239], v253 offset:3392
    v_cvt_pk_bf16_f32 v170, v172, v173
    s_waitcnt lgkmcnt(4)
    v_mfma_f32_16x16x32_bf16 a[156:159], a[228:231], v[228:231], 0
    v_fmac_f32 v250, s25, v248
    v_fma_f32 v248, v250, s26, v251
    v_mfma_f32_16x16x32_bf16 a[160:163], a[232:235], v[228:231], 0
    v_fmac_f32 v251, s27, v250
    v_fma_f32 v250, v249, s28, v252
    v_cvt_pk_bf16_f32 v171, v174, v175
    v_mfma_f32_16x16x32_bf16 a[164:167], a[236:239], v[228:231], 0
    v_fmac_f32 v252, s29, v249
    v_fma_f32 v249, v209, s24, v213
    v_cvt_pk_bf16_f32 v176, v176, v177
    v_mfma_f32_16x16x32_bf16 a[144:147], a[240:243], v[228:231], a[144:147]
    v_fmac_f32 v213, s25, v209
    v_fma_f32 v209, v207, s24, v211
    v_mfma_f32_16x16x32_bf16 a[148:151], a[244:247], v[228:231], a[148:151]
    v_fmac_f32 v211, s25, v207
    v_fma_f32 v207, v211, s26, v213
    v_cvt_pk_bf16_f32 v177, v178, v179
    v_mfma_f32_16x16x32_bf16 a[152:155], a[248:251], v[228:231], a[152:155]
    v_fmac_f32 v213, s27, v211
    v_fma_f32 v211, v209, s28, v249
    v_mfma_f32_16x16x32_bf16 a[132:135], a[252:255], v[228:231], a[132:135]
    v_fmac_f32 v249, s29, v209
    v_cvt_pk_bf16_f32 v207, v248, v207
    ds_write_b128 v0, v[168:171] offset:16864
    v_mfma_f32_16x16x32_bf16 a[136:139], v[240:243], v[228:231], a[136:139]
    v_cvt_pk_bf16_f32 v213, v251, v213
    v_cvt_pk_bf16_f32 v211, v250, v211
    v_cvt_pk_bf16_f32 v209, v252, v249
    v_mfma_f32_16x16x32_bf16 a[140:143], v[244:247], v[228:231], a[140:143]
    ds_read_b128 v[228:231], v253 offset:3136
    ds_write_b64 v1, v[176:177] offset:16928
    s_waitcnt lgkmcnt(6)
    v_mfma_f32_16x16x32_bf16 a[168:171], a[228:231], v[232:235], 0
    v_lshrrev_b32 v252, 15, v255
    ds_read_b128 v[248:251], v253 offset:39712
    v_mfma_f32_16x16x32_bf16 a[172:175], a[232:235], v[232:235], 0
    ds_write_b64 v252, v[206:207] offset:8832
    ds_write_b64 v252, v[212:213] offset:10912
    v_cvt_pk_bf16_f32 v180, v180, v181
    v_mfma_f32_16x16x32_bf16 a[176:179], a[236:239], v[232:235], 0
    ds_write_b64 v252, v[210:211] offset:12992
    ds_write_b64 v252, v[204:205] offset:31712
    v_mfma_f32_16x16x32_bf16 a[156:159], a[240:243], v[232:235], a[156:159]
    ds_write_b64 v252, v[214:215] offset:35872
    ds_write_b64 v252, v[208:209] offset:29632
    v_cvt_pk_bf16_f32 v181, v182, v183
    v_mfma_f32_16x16x32_bf16 a[160:163], a[244:247], v[232:235], a[160:163]
    s_waitcnt lgkmcnt(6)
    s_lshl_b64 exec, s[46:47], 0
    ds_write_b128 v253, v[248:251] offset:32224
    s_mov_b64 exec, -1
    v_mfma_f32_16x16x32_bf16 a[164:167], a[248:251], v[232:235], a[164:167]
    s_lshl_b64 exec, s[46:47], 2
    ds_write_b128 v253, v[248:251] offset:9312
    s_mov_b64 exec, -1
    v_mfma_f32_16x16x32_bf16 a[144:147], a[252:255], v[232:235], a[144:147]
    s_lshl_b64 exec, s[46:47], 4
    ds_write_b128 v253, v[248:251] offset:11360
    s_mov_b64 exec, -1
    v_mfma_f32_16x16x32_bf16 a[148:151], v[240:243], v[232:235], a[148:151]
    v_cvt_pk_bf16_f32 v182, v184, v185
    v_cvt_pk_bf16_f32 v183, v186, v187
    v_cvt_pk_bf16_f32 v188, v188, v189
    v_mfma_f32_16x16x32_bf16 a[152:155], v[244:247], v[232:235], a[152:155]
    ds_read_b128 v[232:235], v253 offset:2864
    v_mfma_f32_16x16x32_bf16 a[180:183], a[228:231], v[236:239], 0
    s_lshl_b64 exec, s[46:47], 6
    ds_write_b128 v253, v[248:251] offset:13408
    s_mov_b64 exec, -1
    v_mfma_f32_16x16x32_bf16 a[184:187], a[232:235], v[236:239], 0
    s_lshl_b64 exec, s[46:47], 8
    ds_write_b128 v253, v[248:251] offset:30016
    s_mov_b64 exec, -1
    v_mfma_f32_16x16x32_bf16 a[188:191], a[236:239], v[236:239], 0
    v_cvt_pk_bf16_f32 v189, v190, v191
    ds_write_b128 v0, v[180:183] offset:17248
    ds_write_b64 v1, v[188:189] offset:17312
    v_mfma_f32_16x16x32_bf16 a[168:171], a[240:243], v[236:239], a[168:171]
    s_mov_b32 s42, 110592
    buffer_load_dwordx4 a[228:231], v254, s[8:11], s42 offen offset:0
    v_mfma_f32_16x16x32_bf16 a[172:175], a[244:247], v[236:239], a[172:175]
    s_lshl_b64 exec, s[46:47], 10
    ds_write_b128 v253, v[248:251] offset:36224
    s_mov_b64 exec, -1
    v_mfma_f32_16x16x32_bf16 a[176:179], a[248:251], v[236:239], a[176:179]
    buffer_load_dwordx4 a[232:235], v254, s[8:11], s42 offen offset:1024
    v_mfma_f32_16x16x32_bf16 a[156:159], a[252:255], v[236:239], a[156:159]
    v_mfma_f32_16x16x32_bf16 a[160:163], v[240:243], v[236:239], a[160:163]
    buffer_load_dwordx4 a[236:239], v254, s[8:11], s42 offen offset:2048
    v_mfma_f32_16x16x32_bf16 a[164:167], v[244:247], v[236:239], a[164:167]
    s_waitcnt lgkmcnt(0)
    s_barrier
    ds_read_b128 v[236:239], v253 offset:5200
    v_mfma_f32_16x16x32_bf16 a[180:183], a[240:243], v[228:231], a[180:183]
    s_waitcnt vmcnt(18)
    v_lshlrev_b32 v248, 16, v218
    v_lshlrev_b32 v249, 16, v220
    v_mfma_f32_16x16x32_bf16 a[184:187], a[244:247], v[228:231], a[184:187]
    v_lshlrev_b32 v250, 16, v222
    v_lshlrev_b32 v251, 16, v224
    v_add_u32 v143, s51, v254
    v_mfma_f32_16x16x32_bf16 a[188:191], a[248:251], v[228:231], a[188:191]
    s_mov_b32 s42, 113664
    buffer_load_dwordx4 a[240:243], v254, s[8:11], s42 offen offset:0
    v_mfma_f32_16x16x32_bf16 a[168:171], a[252:255], v[228:231], a[168:171]
    v_and_b32 v218, s22, v218
    v_and_b32 v220, s22, v220
    v_mfma_f32_16x16x32_bf16 a[172:175], v[240:243], v[228:231], a[172:175]
    buffer_load_dwordx4 a[244:247], v254, s[8:11], s42 offen offset:1024
    v_and_b32 v222, s22, v222
    v_mfma_f32_16x16x32_bf16 a[176:179], v[244:247], v[228:231], a[176:179]
    ds_read_b128 v[228:231], v253 offset:4928
    ds_read_b128 v[144:147], v143 offset:14560
    v_mfma_f32_16x16x32_bf16 a[180:183], a[252:255], v[232:235], a[180:183]
    buffer_load_dwordx4 a[248:251], v254, s[8:11], s42 offen offset:2048
    v_and_b32 v224, s22, v224
    v_mfma_f32_16x16x32_bf16 a[184:187], v[240:243], v[232:235], a[184:187]
    v_lshlrev_b32 v252, 16, v216
    ds_read_b128 v[148:151], v143 offset:15584
    v_mfma_f32_16x16x32_bf16 a[188:191], v[244:247], v[232:235], a[188:191]
    ds_read_b128 v[232:235], v253 offset:4672
    s_mov_b32 s42, 116736
    buffer_load_dwordx4 a[252:255], v254, s[8:11], s42 offen offset:0
    s_waitcnt vmcnt(19) lgkmcnt(4)
    v_mfma_f32_16x16x32_bf16 v[0:3], a[192:195], v[236:239], 0
    v_and_b32 v216, s22, v216
    v_add_f32 v252, v252, v251
    v_mfma_f32_16x16x32_bf16 v[4:7], a[196:199], v[236:239], 0
    buffer_load_dwordx4 v[240:243], v254, s[8:11], s42 offen offset:1024
    v_add_f32 v216, v216, v224
    ds_read_b128 v[152:155], v143 offset:16608
    v_mfma_f32_16x16x32_bf16 v[8:11], a[200:203], v[236:239], 0
    ds_read_b128 v[236:239], v253 offset:4416
    s_waitcnt lgkmcnt(5)
    v_mfma_f32_16x16x32_bf16 v[12:15], a[192:195], v[228:231], 0
    buffer_load_dwordx4 v[244:247], v254, s[8:11], s42 offen offset:2048
    v_fmac_f32 v252, s23, v249
    v_mfma_f32_16x16x32_bf16 v[16:19], a[196:199], v[228:231], 0
    v_fmac_f32 v216, s23, v220
    v_cvt_pk_bf16_f32 v216, v252, v216
    v_mfma_f32_16x16x32_bf16 v[20:23], a[200:203], v[228:231], 0
    ds_read_b128 v[156:159], v143 offset:17664
    s_add_u32 s44, s41, 0
    s_waitcnt lgkmcnt(5)
    buffer_store_dwordx4 v[144:147], v254, s[12:15], s44 offen offset:0
    s_waitcnt vmcnt(19)
    v_mfma_f32_16x16x32_bf16 v[0:3], a[204:207], v[228:231], v[0:3]
    v_and_b32 v215, 0x7fff, v255
    v_lshlrev_b32 v252, 16, v226
    v_mfma_f32_16x16x32_bf16 v[4:7], a[208:211], v[228:231], v[4:7]
    buffer_load_dwordx2 v[204:205], v215, s[4:7], s16 offen offset:128
    v_and_b32 v226, s22, v226
    v_mfma_f32_16x16x32_bf16 v[8:11], a[212:215], v[228:231], v[8:11]
    ds_read_b128 v[228:231], v253 offset:4160
    s_waitcnt lgkmcnt(4)
    v_mfma_f32_16x16x32_bf16 v[24:27], a[192:195], v[232:235], 0
    buffer_load_dwordx2 v[206:207], v215, s[4:7], s17 offen offset:128
    v_add_f32 v252, v252, v248
    v_mfma_f32_16x16x32_bf16 v[28:31], a[196:199], v[232:235], 0
    buffer_load_dwordx2 v[208:209], v215, s[4:7], s18 offen offset:128
    v_add_f32 v226, v226, v218
    v_mfma_f32_16x16x32_bf16 v[32:35], a[200:203], v[232:235], 0
    v_fmac_f32 v252, s23, v250
    ds_read_b128 v[160:163], v143 offset:18688
    v_mfma_f32_16x16x32_bf16 v[12:15], a[204:207], v[232:235], v[12:15]
    buffer_load_dwordx2 v[210:211], v215, s[4:7], s19 offen offset:128
    v_fmac_f32 v226, s23, v222
    v_mfma_f32_16x16x32_bf16 v[16:19], a[208:211], v[232:235], v[16:19]
    buffer_load_dwordx2 v[212:213], v215, s[4:7], s20 offen offset:128
    v_cvt_pk_bf16_f32 v226, v252, v226
    v_mfma_f32_16x16x32_bf16 v[20:23], a[212:215], v[232:235], v[20:23]
    v_fma_f32 v252, v249, s24, v251
    buffer_store_dwordx4 v[148:151], v254, s[12:15], s44 offen offset:1024
    s_waitcnt vmcnt(22)
    v_mfma_f32_16x16x32_bf16 v[0:3], a[216:219], v[232:235], v[0:3]
    buffer_load_dwordx2 v[214:215], v215, s[4:7], s21 offen offset:128
    v_fmac_f32 v251, s25, v249
    v_mfma_f32_16x16x32_bf16 v[4:7], a[220:223], v[232:235], v[4:7]
    v_fma_f32 v249, v248, s24, v250
    v_fmac_f32 v250, s25, v248
    v_mfma_f32_16x16x32_bf16 v[8:11], a[224:227], v[232:235], v[8:11]
    ds_read_b128 v[232:235], v253 offset:5984
    s_waitcnt lgkmcnt(4)
    v_mfma_f32_16x16x32_bf16 v[36:39], a[192:195], v[236:239], 0
    v_fma_f32 v248, v250, s26, v251
    ds_read_b128 v[164:167], v143 offset:19712
    buffer_store_dwordx4 v[152:155], v254, s[12:15], s44 offen offset:2048
    v_mfma_f32_16x16x32_bf16 v[40:43], a[196:199], v[236:239], 0
    v_fmac_f32 v251, s27, v250
    v_fma_f32 v250, v249, s28, v252
    v_mfma_f32_16x16x32_bf16 v[44:47], a[200:203], v[236:239], 0
    v_fmac_f32 v252, s29, v249
    v_fma_f32 v249, v220, s24, v224
    v_mfma_f32_16x16x32_bf16 v[24:27], a[204:207], v[236:239], v[24:27]
    v_fmac_f32 v224, s25, v220
    v_fma_f32 v220, v218, s24, v222
    v_mfma_f32_16x16x32_bf16 v[28:31], a[208:211], v[236:239], v[28:31]
    v_fmac_f32 v222, s25, v218
    v_fma_f32 v218, v222, s26, v224
    ds_read_b128 v[168:171], v143 offset:20768
    v_mfma_f32_16x16x32_bf16 v[32:35], a[212:215], v[236:239], v[32:35]
    v_fmac_f32 v224, s27, v222
    s_add_u32 s44, s41, 3072
    s_waitcnt lgkmcnt(5)
    buffer_store_dwordx4 v[156:159], v254, s[12:15], s44 offen offset:0
    v_mfma_f32_16x16x32_bf16 v[12:15], a[216:219], v[236:239], v[12:15]
    v_fma_f32 v222, v220, s28, v249
    v_fmac_f32 v249, s29, v220
    v_mfma_f32_16x16x32_bf16 v[16:19], a[220:223], v[236:239], v[16:19]
    v_cvt_pk_bf16_f32 v218, v248, v218
    v_cvt_pk_bf16_f32 v224, v251, v224
    v_mfma_f32_16x16x32_bf16 v[20:23], a[224:227], v[236:239], v[20:23]
    ds_read_b128 v[236:239], v253 offset:5728
    s_waitcnt lgkmcnt(5)
    v_mfma_f32_16x16x32_bf16 v[48:51], a[192:195], v[228:231], 0
    v_cvt_pk_bf16_f32 v222, v250, v222
    v_cvt_pk_bf16_f32 v220, v252, v249
    v_mfma_f32_16x16x32_bf16 v[52:55], a[196:199], v[228:231], 0
    v_lshlrev_b32 v248, 16, v219
    v_lshlrev_b32 v249, 16, v221
    v_mfma_f32_16x16x32_bf16 v[56:59], a[200:203], v[228:231], 0
    v_lshlrev_b32 v250, 16, v223
    ds_read_b128 v[172:175], v143 offset:21792
    v_mfma_f32_16x16x32_bf16 v[36:39], a[204:207], v[228:231], v[36:39]
    v_lshlrev_b32 v251, 16, v225
    v_and_b32 v219, s22, v219
    v_mfma_f32_16x16x32_bf16 v[40:43], a[208:211], v[228:231], v[40:43]
    v_and_b32 v221, s22, v221
    v_and_b32 v223, s22, v223
    s_waitcnt lgkmcnt(5)
    buffer_store_dwordx4 v[160:163], v254, s[12:15], s44 offen offset:1024
    v_mfma_f32_16x16x32_bf16 v[44:47], a[212:215], v[228:231], v[44:47]
    v_and_b32 v225, s22, v225
    v_lshlrev_b32 v252, 16, v217
    v_mfma_f32_16x16x32_bf16 v[24:27], a[216:219], v[228:231], v[24:27]
    v_and_b32 v217, s22, v217
    v_add_f32 v252, v252, v251
    v_mfma_f32_16x16x32_bf16 v[28:31], a[220:223], v[228:231], v[28:31]
    v_add_f32 v217, v217, v225
    ds_read_b128 v[176:179], v143 offset:22816
    v_mfma_f32_16x16x32_bf16 v[32:35], a[224:227], v[228:231], v[32:35]
    ds_read_b128 v[228:231], v253 offset:5472
    s_waitcnt lgkmcnt(5)
    buffer_store_dwordx4 v[164:167], v254, s[12:15], s44 offen offset:2048
    v_mfma_f32_16x16x32_bf16 v[60:63], a[192:195], v[232:235], 0
    v_fmac_f32 v252, s23, v249
    v_fmac_f32 v217, s23, v221
    v_mfma_f32_16x16x32_bf16 v[64:67], a[196:199], v[232:235], 0
    v_cvt_pk_bf16_f32 v217, v252, v217
    v_lshlrev_b32 v252, 16, v227
    v_mfma_f32_16x16x32_bf16 v[68:71], a[200:203], v[232:235], 0
    v_and_b32 v227, s22, v227
    v_add_f32 v252, v252, v248
    v_mfma_f32_16x16x32_bf16 v[48:51], a[204:207], v[232:235], v[48:51]
    v_add_f32 v227, v227, v219
    v_fmac_f32 v252, s23, v250
    ds_read_b128 v[180:183], v143 offset:23872
    v_mfma_f32_16x16x32_bf16 v[52:55], a[208:211], v[232:235], v[52:55]
    v_fmac_f32 v227, s23, v223
    v_cvt_pk_bf16_f32 v227, v252, v227
    v_mfma_f32_16x16x32_bf16 v[56:59], a[212:215], v[232:235], v[56:59]
    v_fma_f32 v252, v249, s24, v251
    s_add_u32 s44, s41, 6144
    s_waitcnt lgkmcnt(5)
    buffer_store_dwordx4 v[168:171], v254, s[12:15], s44 offen offset:0
    v_mfma_f32_16x16x32_bf16 v[36:39], a[216:219], v[232:235], v[36:39]
    v_fmac_f32 v251, s25, v249
    v_fma_f32 v249, v248, s24, v250
    v_mfma_f32_16x16x32_bf16 v[40:43], a[220:223], v[232:235], v[40:43]
    v_fmac_f32 v250, s25, v248
    v_fma_f32 v248, v250, s26, v251
    v_mfma_f32_16x16x32_bf16 v[44:47], a[224:227], v[232:235], v[44:47]
    ds_read_b128 v[232:235], v253 offset:5216
    s_waitcnt lgkmcnt(5)
    v_mfma_f32_16x16x32_bf16 v[72:75], a[192:195], v[236:239], 0
    v_fmac_f32 v251, s27, v250
    v_fma_f32 v250, v249, s28, v252
    v_mfma_f32_16x16x32_bf16 v[76:79], a[196:199], v[236:239], 0
    v_fmac_f32 v252, s29, v249
    v_fma_f32 v249, v221, s24, v225
    v_mfma_f32_16x16x32_bf16 v[80:83], a[200:203], v[236:239], 0
    v_fmac_f32 v225, s25, v221
    ds_read_b128 v[184:187], v143 offset:24896
    v_mfma_f32_16x16x32_bf16 v[60:63], a[204:207], v[236:239], v[60:63]
    v_fma_f32 v221, v219, s24, v223
    v_fmac_f32 v223, s25, v219
    s_waitcnt lgkmcnt(5)
    buffer_store_dwordx4 v[172:175], v254, s[12:15], s44 offen offset:1024
    v_mfma_f32_16x16x32_bf16 v[64:67], a[208:211], v[236:239], v[64:67]
    v_fma_f32 v219, v223, s26, v225
    v_fmac_f32 v225, s27, v223
    v_mfma_f32_16x16x32_bf16 v[68:71], a[212:215], v[236:239], v[68:71]
    v_fma_f32 v223, v221, s28, v249
    v_fmac_f32 v249, s29, v221
    v_mfma_f32_16x16x32_bf16 v[48:51], a[216:219], v[236:239], v[48:51]
    v_cvt_pk_bf16_f32 v219, v248, v219
    v_cvt_pk_bf16_f32 v225, v251, v225
    v_mfma_f32_16x16x32_bf16 v[52:55], a[220:223], v[236:239], v[52:55]
    v_cvt_pk_bf16_f32 v223, v250, v223
    ds_read_b128 v[188:191], v143 offset:25920
    s_waitcnt lgkmcnt(5)
    buffer_store_dwordx4 v[176:179], v254, s[12:15], s44 offen offset:2048
    v_mfma_f32_16x16x32_bf16 v[56:59], a[224:227], v[236:239], v[56:59]
    ds_read_b128 v[236:239], v253 offset:4944
    s_waitcnt lgkmcnt(5)
    v_mfma_f32_16x16x32_bf16 v[84:87], a[192:195], v[228:231], 0
    v_cvt_pk_bf16_f32 v221, v252, v249
    v_lshrrev_b32 v252, 15, v255
    v_mfma_f32_16x16x32_bf16 v[88:91], a[196:199], v[228:231], 0
    ds_write_b64 v252, v[218:219] offset:8576
    ds_write_b64 v252, v[224:225] offset:10656
    v_mfma_f32_16x16x32_bf16 v[92:95], a[200:203], v[228:231], 0
    ds_write_b64 v252, v[222:223] offset:12736
    ds_write_b64 v252, v[216:217] offset:31456
    s_add_u32 s44, s41, 9216
    s_waitcnt lgkmcnt(8)
    buffer_store_dwordx4 v[180:183], v254, s[12:15], s44 offen offset:0
    v_mfma_f32_16x16x32_bf16 v[72:75], a[204:207], v[228:231], v[72:75]
    s_mov_b32 s42, 147456
    buffer_load_dwordx4 a[192:195], v254, s[8:11], s42 offen offset:0
    v_mfma_f32_16x16x32_bf16 v[76:79], a[208:211], v[228:231], v[76:79]
    ds_write_b64 v252, v[226:227] offset:35616
    ds_write_b64 v252, v[220:221] offset:29376
    v_mfma_f32_16x16x32_bf16 v[80:83], a[212:215], v[228:231], v[80:83]
    buffer_load_dwordx4 a[196:199], v254, s[8:11], s42 offen offset:1024
    v_mfma_f32_16x16x32_bf16 v[60:63], a[216:219], v[228:231], v[60:63]
    s_waitcnt lgkmcnt(8)
    buffer_store_dwordx4 v[184:187], v254, s[12:15], s44 offen offset:1024
    s_waitcnt lgkmcnt(7)
    buffer_store_dwordx4 v[188:191], v254, s[12:15], s44 offen offset:2048
    v_mfma_f32_16x16x32_bf16 v[64:67], a[220:223], v[228:231], v[64:67]
    buffer_load_dwordx4 a[200:203], v254, s[8:11], s42 offen offset:2048
    v_mfma_f32_16x16x32_bf16 v[68:71], a[224:227], v[228:231], v[68:71]
    ds_read_b128 v[228:231], v253 offset:7280
    v_mfma_f32_16x16x32_bf16 v[84:87], a[204:207], v[232:235], v[84:87]
    s_waitcnt vmcnt(30)
    v_lshlrev_b32 v248, 16, v194
    v_lshlrev_b32 v249, 16, v196
    v_mfma_f32_16x16x32_bf16 v[88:91], a[208:211], v[232:235], v[88:91]
    v_lshlrev_b32 v250, 16, v198
    v_lshlrev_b32 v251, 16, v200
    v_mfma_f32_16x16x32_bf16 v[92:95], a[212:215], v[232:235], v[92:95]
    s_mov_b32 s42, 150528
    buffer_load_dwordx4 a[204:207], v254, s[8:11], s42 offen offset:0
    v_mfma_f32_16x16x32_bf16 v[72:75], a[216:219], v[232:235], v[72:75]
    v_and_b32 v194, s22, v194
    v_and_b32 v196, s22, v196
    v_mfma_f32_16x16x32_bf16 v[76:79], a[220:223], v[232:235], v[76:79]
    buffer_load_dwordx4 a[208:211], v254, s[8:11], s42 offen offset:1024
    v_and_b32 v198, s22, v198
    v_mfma_f32_16x16x32_bf16 v[80:83], a[224:227], v[232:235], v[80:83]
    ds_read_b128 v[232:235], v253 offset:7008
    s_waitcnt lgkmcnt(8)
    v_mfma_f32_16x16x32_bf16 v[84:87], a[216:219], v[236:239], v[84:87]
    buffer_load_dwordx4 a[212:215], v254, s[8:11], s42 offen offset:2048
    v_and_b32 v200, s22, v200
    v_mfma_f32_16x16x32_bf16 v[88:91], a[220:223], v[236:239], v[88:91]
    v_lshlrev_b32 v252, 16, v192
    v_mfma_f32_16x16x32_bf16 v[92:95], a[224:227], v[236:239], v[92:95]
    ds_read_b128 v[236:239], v253 offset:6752
    s_mov_b32 s42, 153600
    buffer_load_dwordx4 a[216:219], v254, s[8:11], s42 offen offset:0
    s_waitcnt vmcnt(31) lgkmcnt(2)
    v_mfma_f32_16x16x32_bf16 v[96:99], a[228:231], v[228:231], 0
    v_and_b32 v192, s22, v192
    v_add_f32 v252, v252, v251
    v_mfma_f32_16x16x32_bf16 v[100:103], a[232:235], v[228:231], 0
    buffer_load_dwordx4 a[220:223], v254, s[8:11], s42 offen offset:1024
    v_add_f32 v192, v192, v200
    v_mfma_f32_16x16x32_bf16 v[104:107], a[236:239], v[228:231], 0
    ds_read_b128 v[228:231], v253 offset:6496
    s_waitcnt lgkmcnt(2)
    v_mfma_f32_16x16x32_bf16 v[108:111], a[228:231], v[232:235], 0
    buffer_load_dwordx4 a[224:227], v254, s[8:11], s42 offen offset:2048
    v_fmac_f32 v252, s23, v249
    v_mfma_f32_16x16x32_bf16 v[112:115], a[232:235], v[232:235], 0
    v_fmac_f32 v192, s23, v196
    v_cvt_pk_bf16_f32 v192, v252, v192
    v_mfma_f32_16x16x32_bf16 v[116:119], a[236:239], v[232:235], 0
    s_waitcnt vmcnt(30)
    v_mfma_f32_16x16x32_bf16 v[96:99], a[240:243], v[232:235], v[96:99]
    v_and_b32 v227, 0x7fff, v255
    v_lshlrev_b32 v252, 16, v202
    v_mfma_f32_16x16x32_bf16 v[100:103], a[244:247], v[232:235], v[100:103]
    buffer_load_dwordx2 v[216:217], v227, s[4:7], s16 offen offset:512
    v_and_b32 v202, s22, v202
    v_mfma_f32_16x16x32_bf16 v[104:107], a[248:251], v[232:235], v[104:107]
    ds_read_b128 v[232:235], v253 offset:6240
    s_waitcnt lgkmcnt(2)
    v_mfma_f32_16x16x32_bf16 v[120:123], a[228:231], v[236:239], 0
    buffer_load_dwordx2 v[218:219], v227, s[4:7], s17 offen offset:512
    v_add_f32 v252, v252, v248
    v_mfma_f32_16x16x32_bf16 v[124:127], a[232:235], v[236:239], 0
    buffer_load_dwordx2 v[220:221], v227, s[4:7], s18 offen offset:512
    v_add_f32 v202, v202, v194
    v_mfma_f32_16x16x32_bf16 v[128:131], a[236:239], v[236:239], 0
    v_fmac_f32 v252, s23, v250
    v_mfma_f32_16x16x32_bf16 v[108:111], a[240:243], v[236:239], v[108:111]
    buffer_load_dwordx2 v[222:223], v227, s[4:7], s19 offen offset:512
    v_fmac_f32 v202, s23, v198
    v_mfma_f32_16x16x32_bf16 v[112:115], a[244:247], v[236:239], v[112:115]
    buffer_load_dwordx2 v[224:225], v227, s[4:7], s20 offen offset:512
    v_cvt_pk_bf16_f32 v202, v252, v202
    v_mfma_f32_16x16x32_bf16 v[116:119], a[248:251], v[236:239], v[116:119]
    v_fma_f32 v252, v249, s24, v251
    s_waitcnt vmcnt(32)
    v_mfma_f32_16x16x32_bf16 v[96:99], a[252:255], v[236:239], v[96:99]
    buffer_load_dwordx2 v[226:227], v227, s[4:7], s21 offen offset:512
    v_fmac_f32 v251, s25, v249
    v_mfma_f32_16x16x32_bf16 v[100:103], v[240:243], v[236:239], v[100:103]
    v_fma_f32 v249, v248, s24, v250
    v_fmac_f32 v250, s25, v248
    v_mfma_f32_16x16x32_bf16 v[104:107], v[244:247], v[236:239], v[104:107]
    ds_read_b128 v[236:239], v253 offset:8064
    s_waitcnt lgkmcnt(2)
    v_mfma_f32_16x16x32_bf16 v[132:135], a[228:231], v[228:231], 0
    v_fma_f32 v248, v250, s26, v251
    v_mfma_f32_16x16x32_bf16 v[136:139], a[232:235], v[228:231], 0
    v_fmac_f32 v251, s27, v250
    v_fma_f32 v250, v249, s28, v252
    v_mfma_f32_16x16x32_bf16 v[140:143], a[236:239], v[228:231], 0
    v_fmac_f32 v252, s29, v249
    v_fma_f32 v249, v196, s24, v200
    v_mfma_f32_16x16x32_bf16 v[120:123], a[240:243], v[228:231], v[120:123]
    v_fmac_f32 v200, s25, v196
    v_fma_f32 v196, v194, s24, v198
    v_mfma_f32_16x16x32_bf16 v[124:127], a[244:247], v[228:231], v[124:127]
    v_fmac_f32 v198, s25, v194
    v_fma_f32 v194, v198, s26, v200
    v_mfma_f32_16x16x32_bf16 v[128:131], a[248:251], v[228:231], v[128:131]
    v_fmac_f32 v200, s27, v198
    v_mfma_f32_16x16x32_bf16 v[108:111], a[252:255], v[228:231], v[108:111]
    v_fma_f32 v198, v196, s28, v249
    v_fmac_f32 v249, s29, v196
    v_mfma_f32_16x16x32_bf16 v[112:115], v[240:243], v[228:231], v[112:115]
    v_cvt_pk_bf16_f32 v194, v248, v194
    v_cvt_pk_bf16_f32 v200, v251, v200
    v_mfma_f32_16x16x32_bf16 v[116:119], v[244:247], v[228:231], v[116:119]
    ds_read_b128 v[228:231], v253 offset:7808
    s_waitcnt lgkmcnt(2)
    v_mfma_f32_16x16x32_bf16 v[144:147], a[228:231], v[232:235], 0
    v_cvt_pk_bf16_f32 v198, v250, v198
    v_cvt_pk_bf16_f32 v196, v252, v249
    v_mfma_f32_16x16x32_bf16 v[148:151], a[232:235], v[232:235], 0
    v_lshlrev_b32 v248, 16, v195
    v_lshlrev_b32 v249, 16, v197
    v_mfma_f32_16x16x32_bf16 v[152:155], a[236:239], v[232:235], 0
    v_lshlrev_b32 v250, 16, v199
    v_mfma_f32_16x16x32_bf16 v[132:135], a[240:243], v[232:235], v[132:135]
    v_lshlrev_b32 v251, 16, v201
    v_and_b32 v195, s22, v195
    v_mfma_f32_16x16x32_bf16 v[136:139], a[244:247], v[232:235], v[136:139]
    v_and_b32 v197, s22, v197
    v_and_b32 v199, s22, v199
    v_mfma_f32_16x16x32_bf16 v[140:143], a[248:251], v[232:235], v[140:143]
    v_and_b32 v201, s22, v201
    v_lshlrev_b32 v252, 16, v193
    v_mfma_f32_16x16x32_bf16 v[120:123], a[252:255], v[232:235], v[120:123]
    v_and_b32 v193, s22, v193
    v_add_f32 v252, v252, v251
    v_mfma_f32_16x16x32_bf16 v[124:127], v[240:243], v[232:235], v[124:127]
    v_add_f32 v193, v193, v201
    v_mfma_f32_16x16x32_bf16 v[128:131], v[244:247], v[232:235], v[128:131]
    ds_read_b128 v[232:235], v253 offset:7552
    s_waitcnt lgkmcnt(2)
    v_mfma_f32_16x16x32_bf16 v[156:159], a[228:231], v[236:239], 0
    v_fmac_f32 v252, s23, v249
    v_fmac_f32 v193, s23, v197
    v_mfma_f32_16x16x32_bf16 v[160:163], a[232:235], v[236:239], 0
    v_cvt_pk_bf16_f32 v193, v252, v193
    v_lshlrev_b32 v252, 16, v203
    v_mfma_f32_16x16x32_bf16 v[164:167], a[236:239], v[236:239], 0
    v_and_b32 v203, s22, v203
    v_add_f32 v252, v252, v248
    v_mfma_f32_16x16x32_bf16 v[144:147], a[240:243], v[236:239], v[144:147]
    v_add_f32 v203, v203, v195
    v_fmac_f32 v252, s23, v250
    v_mfma_f32_16x16x32_bf16 v[148:151], a[244:247], v[236:239], v[148:151]
    v_fmac_f32 v203, s23, v199
    v_cvt_pk_bf16_f32 v203, v252, v203
    v_mfma_f32_16x16x32_bf16 v[152:155], a[248:251], v[236:239], v[152:155]
    v_fma_f32 v252, v249, s24, v251
    v_mfma_f32_16x16x32_bf16 v[132:135], a[252:255], v[236:239], v[132:135]
    v_fmac_f32 v251, s25, v249
    v_fma_f32 v249, v248, s24, v250
    v_mfma_f32_16x16x32_bf16 v[136:139], v[240:243], v[236:239], v[136:139]
    v_fmac_f32 v250, s25, v248
    v_fma_f32 v248, v250, s26, v251
    v_mfma_f32_16x16x32_bf16 v[140:143], v[244:247], v[236:239], v[140:143]
    ds_read_b128 v[236:239], v253 offset:7296
    s_waitcnt lgkmcnt(2)
    v_mfma_f32_16x16x32_bf16 v[168:171], a[228:231], v[228:231], 0
    v_fmac_f32 v251, s27, v250
    v_fma_f32 v250, v249, s28, v252
    v_mfma_f32_16x16x32_bf16 v[172:175], a[232:235], v[228:231], 0
    v_fmac_f32 v252, s29, v249
    v_fma_f32 v249, v197, s24, v201
    v_mfma_f32_16x16x32_bf16 v[176:179], a[236:239], v[228:231], 0
    v_fmac_f32 v201, s25, v197
    v_mfma_f32_16x16x32_bf16 v[156:159], a[240:243], v[228:231], v[156:159]
    v_fma_f32 v197, v195, s24, v199
    v_fmac_f32 v199, s25, v195
    v_mfma_f32_16x16x32_bf16 v[160:163], a[244:247], v[228:231], v[160:163]
    v_fma_f32 v195, v199, s26, v201
    v_fmac_f32 v201, s27, v199
    v_mfma_f32_16x16x32_bf16 v[164:167], a[248:251], v[228:231], v[164:167]
    v_fma_f32 v199, v197, s28, v249
    v_fmac_f32 v249, s29, v197
    v_mfma_f32_16x16x32_bf16 v[144:147], a[252:255], v[228:231], v[144:147]
    v_cvt_pk_bf16_f32 v195, v248, v195
    v_cvt_pk_bf16_f32 v201, v251, v201
    v_mfma_f32_16x16x32_bf16 v[148:151], v[240:243], v[228:231], v[148:151]
    v_cvt_pk_bf16_f32 v199, v250, v199
    v_mfma_f32_16x16x32_bf16 v[152:155], v[244:247], v[228:231], v[152:155]
    ds_read_b128 v[228:231], v253 offset:7024
    s_waitcnt lgkmcnt(2)
    v_mfma_f32_16x16x32_bf16 v[180:183], a[228:231], v[232:235], 0
    v_cvt_pk_bf16_f32 v197, v252, v249
    v_lshrrev_b32 v252, 15, v255
    v_mfma_f32_16x16x32_bf16 v[184:187], a[232:235], v[232:235], 0
    ds_write_b64 v252, v[194:195] offset:8320
    ds_write_b64 v252, v[200:201] offset:10400
    v_mfma_f32_16x16x32_bf16 v[188:191], a[236:239], v[232:235], 0
    ds_write_b64 v252, v[198:199] offset:12480
    ds_write_b64 v252, v[192:193] offset:31200
    v_mfma_f32_16x16x32_bf16 v[168:171], a[240:243], v[232:235], v[168:171]
    s_mov_b32 s42, 184320
    buffer_load_dwordx4 a[228:231], v254, s[8:11], s42 offen offset:0
    v_mfma_f32_16x16x32_bf16 v[172:175], a[244:247], v[232:235], v[172:175]
    ds_write_b64 v252, v[202:203] offset:35360
    ds_write_b64 v252, v[196:197] offset:29120
    v_mfma_f32_16x16x32_bf16 v[176:179], a[248:251], v[232:235], v[176:179]
    buffer_load_dwordx4 a[232:235], v254, s[8:11], s42 offen offset:1024
    v_mfma_f32_16x16x32_bf16 v[156:159], a[252:255], v[232:235], v[156:159]
    v_mfma_f32_16x16x32_bf16 v[160:163], v[240:243], v[232:235], v[160:163]
    buffer_load_dwordx4 a[236:239], v254, s[8:11], s42 offen offset:2048
    v_mfma_f32_16x16x32_bf16 v[164:167], v[244:247], v[232:235], v[164:167]
    s_waitcnt lgkmcnt(0)
    s_barrier
    ds_read_b128 v[232:235], v253 offset:9360
    v_mfma_f32_16x16x32_bf16 v[180:183], a[240:243], v[236:239], v[180:183]
    s_waitcnt vmcnt(28)
    v_lshlrev_b32 v248, 16, v206
    v_lshlrev_b32 v249, 16, v208
    v_mfma_f32_16x16x32_bf16 v[184:187], a[244:247], v[236:239], v[184:187]
    v_lshlrev_b32 v250, 16, v210
    v_lshlrev_b32 v251, 16, v212
    v_mfma_f32_16x16x32_bf16 v[188:191], a[248:251], v[236:239], v[188:191]
    s_mov_b32 s42, 187392
    buffer_load_dwordx4 a[240:243], v254, s[8:11], s42 offen offset:0
    v_mfma_f32_16x16x32_bf16 v[168:171], a[252:255], v[236:239], v[168:171]
    v_and_b32 v206, s22, v206
    v_and_b32 v208, s22, v208
    v_mfma_f32_16x16x32_bf16 v[172:175], v[240:243], v[236:239], v[172:175]
    buffer_load_dwordx4 a[244:247], v254, s[8:11], s42 offen offset:1024
    v_and_b32 v210, s22, v210
    v_mfma_f32_16x16x32_bf16 v[176:179], v[244:247], v[236:239], v[176:179]
    ds_read_b128 v[236:239], v253 offset:9088
    v_mfma_f32_16x16x32_bf16 v[180:183], a[252:255], v[228:231], v[180:183]
    buffer_load_dwordx4 a[248:251], v254, s[8:11], s42 offen offset:2048
    v_and_b32 v212, s22, v212
    v_mfma_f32_16x16x32_bf16 v[184:187], v[240:243], v[228:231], v[184:187]
    v_lshlrev_b32 v252, 16, v204
    v_mfma_f32_16x16x32_bf16 v[188:191], v[244:247], v[228:231], v[188:191]
    ds_read_b128 v[228:231], v253 offset:8832
    s_mov_b32 s42, 190464
    buffer_load_dwordx4 a[252:255], v254, s[8:11], s42 offen offset:0
    s_waitcnt vmcnt(19) lgkmcnt(2)
    v_mfma_f32_16x16x32_bf16 a[0:3], a[192:195], v[232:235], a[0:3]
    v_and_b32 v204, s22, v204
    v_add_f32 v252, v252, v251
    v_mfma_f32_16x16x32_bf16 a[4:7], a[196:199], v[232:235], a[4:7]
    buffer_load_dwordx4 v[240:243], v254, s[8:11], s42 offen offset:1024
    v_add_f32 v204, v204, v212
    v_mfma_f32_16x16x32_bf16 a[8:11], a[200:203], v[232:235], a[8:11]
    ds_read_b128 v[232:235], v253 offset:8576
    s_waitcnt lgkmcnt(2)
    v_mfma_f32_16x16x32_bf16 a[12:15], a[192:195], v[236:239], a[12:15]
    buffer_load_dwordx4 v[244:247], v254, s[8:11], s42 offen offset:2048
    v_fmac_f32 v252, s23, v249
    v_mfma_f32_16x16x32_bf16 a[16:19], a[196:199], v[236:239], a[16:19]
    v_fmac_f32 v204, s23, v208
    v_cvt_pk_bf16_f32 v204, v252, v204
    v_mfma_f32_16x16x32_bf16 a[20:23], a[200:203], v[236:239], a[20:23]
    s_waitcnt vmcnt(18)
    v_mfma_f32_16x16x32_bf16 a[0:3], a[204:207], v[236:239], a[0:3]
    v_and_b32 v203, 0x7fff, v255
    v_lshlrev_b32 v252, 16, v214
    v_mfma_f32_16x16x32_bf16 a[4:7], a[208:211], v[236:239], a[4:7]
    buffer_load_dwordx2 v[192:193], v203, s[4:7], s16 offen offset:896
    v_and_b32 v214, s22, v214
    v_mfma_f32_16x16x32_bf16 a[8:11], a[212:215], v[236:239], a[8:11]
    ds_read_b128 v[236:239], v253 offset:8320
    s_waitcnt lgkmcnt(2)
    v_mfma_f32_16x16x32_bf16 a[24:27], a[192:195], v[228:231], a[24:27]
    buffer_load_dwordx2 v[194:195], v203, s[4:7], s17 offen offset:896
    v_add_f32 v252, v252, v248
    v_mfma_f32_16x16x32_bf16 a[28:31], a[196:199], v[228:231], a[28:31]
    buffer_load_dwordx2 v[196:197], v203, s[4:7], s18 offen offset:896
    v_add_f32 v214, v214, v206
    v_mfma_f32_16x16x32_bf16 a[32:35], a[200:203], v[228:231], a[32:35]
    v_fmac_f32 v252, s23, v250
    v_mfma_f32_16x16x32_bf16 a[12:15], a[204:207], v[228:231], a[12:15]
    buffer_load_dwordx2 v[198:199], v203, s[4:7], s19 offen offset:896
    v_fmac_f32 v214, s23, v210
    v_mfma_f32_16x16x32_bf16 a[16:19], a[208:211], v[228:231], a[16:19]
    buffer_load_dwordx2 v[200:201], v203, s[4:7], s20 offen offset:896
    v_cvt_pk_bf16_f32 v214, v252, v214
    v_mfma_f32_16x16x32_bf16 a[20:23], a[212:215], v[228:231], a[20:23]
    v_fma_f32 v252, v249, s24, v251
    s_waitcnt vmcnt(20)
    v_mfma_f32_16x16x32_bf16 a[0:3], a[216:219], v[228:231], a[0:3]
    buffer_load_dwordx2 v[202:203], v203, s[4:7], s21 offen offset:896
    v_fmac_f32 v251, s25, v249
    v_mfma_f32_16x16x32_bf16 a[4:7], a[220:223], v[228:231], a[4:7]
    v_fma_f32 v249, v248, s24, v250
    v_fmac_f32 v250, s25, v248
    v_mfma_f32_16x16x32_bf16 a[8:11], a[224:227], v[228:231], a[8:11]
    ds_read_b128 v[228:231], v253 offset:10144
    s_waitcnt lgkmcnt(2)
    v_mfma_f32_16x16x32_bf16 a[36:39], a[192:195], v[232:235], a[36:39]
    v_fma_f32 v248, v250, s26, v251
    v_mfma_f32_16x16x32_bf16 a[40:43], a[196:199], v[232:235], a[40:43]
    v_fmac_f32 v251, s27, v250
    v_fma_f32 v250, v249, s28, v252
    v_mfma_f32_16x16x32_bf16 a[44:47], a[200:203], v[232:235], a[44:47]
    v_fmac_f32 v252, s29, v249
    v_fma_f32 v249, v208, s24, v212
    v_mfma_f32_16x16x32_bf16 a[24:27], a[204:207], v[232:235], a[24:27]
    v_fmac_f32 v212, s25, v208
    v_fma_f32 v208, v206, s24, v210
    v_mfma_f32_16x16x32_bf16 a[28:31], a[208:211], v[232:235], a[28:31]
    v_fmac_f32 v210, s25, v206
    v_fma_f32 v206, v210, s26, v212
    v_mfma_f32_16x16x32_bf16 a[32:35], a[212:215], v[232:235], a[32:35]
    v_fmac_f32 v212, s27, v210
    v_mfma_f32_16x16x32_bf16 a[12:15], a[216:219], v[232:235], a[12:15]
    v_fma_f32 v210, v208, s28, v249
    v_fmac_f32 v249, s29, v208
    v_mfma_f32_16x16x32_bf16 a[16:19], a[220:223], v[232:235], a[16:19]
    v_cvt_pk_bf16_f32 v206, v248, v206
    v_cvt_pk_bf16_f32 v212, v251, v212
    v_mfma_f32_16x16x32_bf16 a[20:23], a[224:227], v[232:235], a[20:23]
    ds_read_b128 v[232:235], v253 offset:9888
    s_waitcnt lgkmcnt(2)
    v_mfma_f32_16x16x32_bf16 a[48:51], a[192:195], v[236:239], a[48:51]
    v_cvt_pk_bf16_f32 v210, v250, v210
    v_cvt_pk_bf16_f32 v208, v252, v249
    v_mfma_f32_16x16x32_bf16 a[52:55], a[196:199], v[236:239], a[52:55]
    v_lshlrev_b32 v248, 16, v207
    v_lshlrev_b32 v249, 16, v209
    v_mfma_f32_16x16x32_bf16 a[56:59], a[200:203], v[236:239], a[56:59]
    v_lshlrev_b32 v250, 16, v211
    v_mfma_f32_16x16x32_bf16 a[36:39], a[204:207], v[236:239], a[36:39]
    v_lshlrev_b32 v251, 16, v213
    v_and_b32 v207, s22, v207
    v_mfma_f32_16x16x32_bf16 a[40:43], a[208:211], v[236:239], a[40:43]
    v_and_b32 v209, s22, v209
    v_and_b32 v211, s22, v211
    v_mfma_f32_16x16x32_bf16 a[44:47], a[212:215], v[236:239], a[44:47]
    v_and_b32 v213, s22, v213
    v_lshlrev_b32 v252, 16, v205
    v_mfma_f32_16x16x32_bf16 a[24:27], a[216:219], v[236:239], a[24:27]
    v_and_b32 v205, s22, v205
    v_add_f32 v252, v252, v251
    v_mfma_f32_16x16x32_bf16 a[28:31], a[220:223], v[236:239], a[28:31]
    v_add_f32 v205, v205, v213
    v_mfma_f32_16x16x32_bf16 a[32:35], a[224:227], v[236:239], a[32:35]
    ds_read_b128 v[236:239], v253 offset:9632
    s_waitcnt lgkmcnt(2)
    v_mfma_f32_16x16x32_bf16 a[60:63], a[192:195], v[228:231], a[60:63]
    v_fmac_f32 v252, s23, v249
    v_fmac_f32 v205, s23, v209
    v_mfma_f32_16x16x32_bf16 a[64:67], a[196:199], v[228:231], a[64:67]
    v_cvt_pk_bf16_f32 v205, v252, v205
    v_lshlrev_b32 v252, 16, v215
    v_mfma_f32_16x16x32_bf16 a[68:71], a[200:203], v[228:231], a[68:71]
    v_and_b32 v215, s22, v215
    v_add_f32 v252, v252, v248
    v_mfma_f32_16x16x32_bf16 a[48:51], a[204:207], v[228:231], a[48:51]
    v_add_f32 v215, v215, v207
    v_fmac_f32 v252, s23, v250
    v_mfma_f32_16x16x32_bf16 a[52:55], a[208:211], v[228:231], a[52:55]
    v_fmac_f32 v215, s23, v211
    v_cvt_pk_bf16_f32 v215, v252, v215
    v_mfma_f32_16x16x32_bf16 a[56:59], a[212:215], v[228:231], a[56:59]
    v_fma_f32 v252, v249, s24, v251
    v_mfma_f32_16x16x32_bf16 a[36:39], a[216:219], v[228:231], a[36:39]
    v_fmac_f32 v251, s25, v249
    v_fma_f32 v249, v248, s24, v250
    v_mfma_f32_16x16x32_bf16 a[40:43], a[220:223], v[228:231], a[40:43]
    v_fmac_f32 v250, s25, v248
    v_fma_f32 v248, v250, s26, v251
    v_mfma_f32_16x16x32_bf16 a[44:47], a[224:227], v[228:231], a[44:47]
    ds_read_b128 v[228:231], v253 offset:9376
    s_waitcnt lgkmcnt(2)
    v_mfma_f32_16x16x32_bf16 a[72:75], a[192:195], v[232:235], a[72:75]
    v_fmac_f32 v251, s27, v250
    v_fma_f32 v250, v249, s28, v252
    v_mfma_f32_16x16x32_bf16 a[76:79], a[196:199], v[232:235], a[76:79]
    v_fmac_f32 v252, s29, v249
    v_fma_f32 v249, v209, s24, v213
    v_mfma_f32_16x16x32_bf16 a[80:83], a[200:203], v[232:235], a[80:83]
    v_fmac_f32 v213, s25, v209
    v_mfma_f32_16x16x32_bf16 a[60:63], a[204:207], v[232:235], a[60:63]
    v_fma_f32 v209, v207, s24, v211
    v_fmac_f32 v211, s25, v207
    v_mfma_f32_16x16x32_bf16 a[64:67], a[208:211], v[232:235], a[64:67]
    v_fma_f32 v207, v211, s26, v213
    v_fmac_f32 v213, s27, v211
    v_mfma_f32_16x16x32_bf16 a[68:71], a[212:215], v[232:235], a[68:71]
    v_fma_f32 v211, v209, s28, v249
    v_fmac_f32 v249, s29, v209
    v_mfma_f32_16x16x32_bf16 a[48:51], a[216:219], v[232:235], a[48:51]
    v_cvt_pk_bf16_f32 v207, v248, v207
    v_cvt_pk_bf16_f32 v213, v251, v213
    v_mfma_f32_16x16x32_bf16 a[52:55], a[220:223], v[232:235], a[52:55]
    v_cvt_pk_bf16_f32 v211, v250, v211
    v_mfma_f32_16x16x32_bf16 a[56:59], a[224:227], v[232:235], a[56:59]
    ds_read_b128 v[232:235], v253 offset:9104
    s_waitcnt lgkmcnt(2)
    v_mfma_f32_16x16x32_bf16 a[84:87], a[192:195], v[236:239], a[84:87]
    v_cvt_pk_bf16_f32 v209, v252, v249
    v_lshrrev_b32 v252, 15, v255
    v_mfma_f32_16x16x32_bf16 a[88:91], a[196:199], v[236:239], a[88:91]
    ds_write_b64 v252, v[206:207] offset:768
    ds_write_b64 v252, v[212:213] offset:2848
    v_mfma_f32_16x16x32_bf16 a[92:95], a[200:203], v[236:239], a[92:95]
    ds_write_b64 v252, v[210:211] offset:4928
    ds_write_b64 v252, v[204:205] offset:21568
    v_mfma_f32_16x16x32_bf16 a[72:75], a[204:207], v[236:239], a[72:75]
    s_mov_b32 s42, 221184
    buffer_load_dwordx4 a[192:195], v254, s[8:11], s42 offen offset:0
    v_mfma_f32_16x16x32_bf16 a[76:79], a[208:211], v[236:239], a[76:79]
    ds_write_b64 v252, v[214:215] offset:23648
    ds_write_b64 v252, v[208:209] offset:7008
    v_mfma_f32_16x16x32_bf16 a[80:83], a[212:215], v[236:239], a[80:83]
    buffer_load_dwordx4 a[196:199], v254, s[8:11], s42 offen offset:1024
    v_mfma_f32_16x16x32_bf16 a[60:63], a[216:219], v[236:239], a[60:63]
    v_mfma_f32_16x16x32_bf16 a[64:67], a[220:223], v[236:239], a[64:67]
    buffer_load_dwordx4 a[200:203], v254, s[8:11], s42 offen offset:2048
    v_mfma_f32_16x16x32_bf16 a[68:71], a[224:227], v[236:239], a[68:71]
    ds_read_b128 v[236:239], v253 offset:11440
    s_waitcnt lgkmcnt(8)
    v_mfma_f32_16x16x32_bf16 a[84:87], a[204:207], v[228:231], a[84:87]
    s_waitcnt vmcnt(18)
    v_lshlrev_b32 v248, 16, v218
    v_lshlrev_b32 v249, 16, v220
    v_lshlrev_b32 v250, 16, v222
    v_mfma_f32_16x16x32_bf16 a[88:91], a[208:211], v[228:231], a[88:91]
    v_lshlrev_b32 v251, 16, v224
    v_and_b32 v218, s22, v218
    v_mfma_f32_16x16x32_bf16 a[92:95], a[212:215], v[228:231], a[92:95]
    s_mov_b32 s42, 224256
    buffer_load_dwordx4 a[204:207], v254, s[8:11], s42 offen offset:0
    v_mfma_f32_16x16x32_bf16 a[72:75], a[216:219], v[228:231], a[72:75]
    v_and_b32 v220, s22, v220
    v_and_b32 v222, s22, v222
    v_mfma_f32_16x16x32_bf16 a[76:79], a[220:223], v[228:231], a[76:79]
    buffer_load_dwordx4 a[208:211], v254, s[8:11], s42 offen offset:1024
    v_and_b32 v224, s22, v224
    v_mfma_f32_16x16x32_bf16 a[80:83], a[224:227], v[228:231], a[80:83]
    ds_read_b128 v[228:231], v253 offset:11168
    s_waitcnt lgkmcnt(8)
    v_mfma_f32_16x16x32_bf16 a[84:87], a[216:219], v[232:235], a[84:87]
    buffer_load_dwordx4 a[212:215], v254, s[8:11], s42 offen offset:2048
    v_lshlrev_b32 v252, 16, v216
    v_mfma_f32_16x16x32_bf16 a[88:91], a[220:223], v[232:235], a[88:91]
    v_and_b32 v216, s22, v216
    v_add_f32 v252, v252, v251
    v_mfma_f32_16x16x32_bf16 a[92:95], a[224:227], v[232:235], a[92:95]
    ds_read_b128 v[232:235], v253 offset:10912
    s_mov_b32 s42, 227328
    buffer_load_dwordx4 a[216:219], v254, s[8:11], s42 offen offset:0
    s_waitcnt vmcnt(19) lgkmcnt(2)
    v_mfma_f32_16x16x32_bf16 a[96:99], a[228:231], v[236:239], a[96:99]
    v_add_f32 v216, v216, v224
    v_fmac_f32 v252, s23, v249
    v_fmac_f32 v216, s23, v220
    v_mfma_f32_16x16x32_bf16 a[100:103], a[232:235], v[236:239], a[100:103]
    buffer_load_dwordx4 a[220:223], v254, s[8:11], s42 offen offset:1024
    v_cvt_pk_bf16_f32 v216, v252, v216
    v_mfma_f32_16x16x32_bf16 a[104:107], a[236:239], v[236:239], a[104:107]
    ds_read_b128 v[236:239], v253 offset:10656
    s_waitcnt lgkmcnt(2)
    v_mfma_f32_16x16x32_bf16 a[108:111], a[228:231], v[228:231], a[108:111]
    buffer_load_dwordx4 a[224:227], v254, s[8:11], s42 offen offset:2048
    v_lshlrev_b32 v252, 16, v226
    v_mfma_f32_16x16x32_bf16 a[112:115], a[232:235], v[228:231], a[112:115]
    v_and_b32 v226, s22, v226
    v_add_f32 v252, v252, v248
    v_mfma_f32_16x16x32_bf16 a[116:119], a[236:239], v[228:231], a[116:119]
    v_add_f32 v226, v226, v218
    s_waitcnt vmcnt(18)
    v_mfma_f32_16x16x32_bf16 a[96:99], a[240:243], v[228:231], a[96:99]
    v_and_b32 v215, 0x7fff, v255
    v_fmac_f32 v252, s23, v250
    v_mfma_f32_16x16x32_bf16 a[100:103], a[244:247], v[228:231], a[100:103]
    buffer_load_dwordx2 v[204:205], v215, s[4:7], s16 offen offset:1280
    v_fmac_f32 v226, s23, v222
    v_mfma_f32_16x16x32_bf16 a[104:107], a[248:251], v[228:231], a[104:107]
    ds_read_b128 v[228:231], v253 offset:10400
    s_waitcnt lgkmcnt(2)
    v_mfma_f32_16x16x32_bf16 a[120:123], a[228:231], v[232:235], a[120:123]
    buffer_load_dwordx2 v[206:207], v215, s[4:7], s17 offen offset:1280
    v_cvt_pk_bf16_f32 v226, v252, v226
    v_fma_f32 v252, v249, s24, v251
    v_mfma_f32_16x16x32_bf16 a[124:127], a[232:235], v[232:235], a[124:127]
    buffer_load_dwordx2 v[208:209], v215, s[4:7], s18 offen offset:1280
    v_fmac_f32 v251, s25, v249
    v_mfma_f32_16x16x32_bf16 a[128:131], a[236:239], v[232:235], a[128:131]
    v_fma_f32 v249, v248, s24, v250
    v_fmac_f32 v250, s25, v248
    v_mfma_f32_16x16x32_bf16 a[108:111], a[240:243], v[232:235], a[108:111]
    buffer_load_dwordx2 v[210:211], v215, s[4:7], s19 offen offset:1280
    v_fma_f32 v248, v250, s26, v251
    v_mfma_f32_16x16x32_bf16 a[112:115], a[244:247], v[232:235], a[112:115]
    buffer_load_dwordx2 v[212:213], v215, s[4:7], s20 offen offset:1280
    v_fmac_f32 v251, s27, v250
    v_mfma_f32_16x16x32_bf16 a[116:119], a[248:251], v[232:235], a[116:119]
    v_fma_f32 v250, v249, s28, v252
    s_waitcnt vmcnt(20)
    v_mfma_f32_16x16x32_bf16 a[96:99], a[252:255], v[232:235], a[96:99]
    buffer_load_dwordx2 v[214:215], v215, s[4:7], s21 offen offset:1280
    v_fmac_f32 v252, s29, v249
    v_mfma_f32_16x16x32_bf16 a[100:103], v[240:243], v[232:235], a[100:103]
    v_fma_f32 v249, v220, s24, v224
    v_fmac_f32 v224, s25, v220
    v_mfma_f32_16x16x32_bf16 a[104:107], v[244:247], v[232:235], a[104:107]
    ds_read_b128 v[232:235], v253 offset:12224
    v_fma_f32 v220, v218, s24, v222
    s_waitcnt lgkmcnt(2)
    v_mfma_f32_16x16x32_bf16 a[132:135], a[228:231], v[236:239], a[132:135]
    v_fmac_f32 v222, s25, v218
    v_fma_f32 v218, v222, s26, v224
    v_mfma_f32_16x16x32_bf16 a[136:139], a[232:235], v[236:239], a[136:139]
    v_fmac_f32 v224, s27, v222
    v_fma_f32 v222, v220, s28, v249
    v_mfma_f32_16x16x32_bf16 a[140:143], a[236:239], v[236:239], a[140:143]
    v_fmac_f32 v249, s29, v220
    v_cvt_pk_bf16_f32 v218, v248, v218
    v_mfma_f32_16x16x32_bf16 a[120:123], a[240:243], v[236:239], a[120:123]
    v_cvt_pk_bf16_f32 v224, v251, v224
    v_cvt_pk_bf16_f32 v222, v250, v222
    v_mfma_f32_16x16x32_bf16 a[124:127], a[244:247], v[236:239], a[124:127]
    v_cvt_pk_bf16_f32 v220, v252, v249
    v_lshlrev_b32 v248, 16, v219
    v_mfma_f32_16x16x32_bf16 a[128:131], a[248:251], v[236:239], a[128:131]
    v_lshlrev_b32 v249, 16, v221
    v_lshlrev_b32 v250, 16, v223
    v_mfma_f32_16x16x32_bf16 a[108:111], a[252:255], v[236:239], a[108:111]
    v_lshlrev_b32 v251, 16, v225
    v_and_b32 v219, s22, v219
    v_mfma_f32_16x16x32_bf16 a[112:115], v[240:243], v[236:239], a[112:115]
    v_and_b32 v221, s22, v221
    v_and_b32 v223, s22, v223
    v_mfma_f32_16x16x32_bf16 a[116:119], v[244:247], v[236:239], a[116:119]
    ds_read_b128 v[236:239], v253 offset:11968
    v_and_b32 v225, s22, v225
    s_waitcnt lgkmcnt(2)
    v_mfma_f32_16x16x32_bf16 a[144:147], a[228:231], v[228:231], a[144:147]
    v_lshlrev_b32 v252, 16, v217
    v_and_b32 v217, s22, v217
    v_mfma_f32_16x16x32_bf16 a[148:151], a[232:235], v[228:231], a[148:151]
    v_add_f32 v252, v252, v251
    v_add_f32 v217, v217, v225
    v_mfma_f32_16x16x32_bf16 a[152:155], a[236:239], v[228:231], a[152:155]
    v_fmac_f32 v252, s23, v249
    v_fmac_f32 v217, s23, v221
    v_mfma_f32_16x16x32_bf16 a[132:135], a[240:243], v[228:231], a[132:135]
    v_cvt_pk_bf16_f32 v217, v252, v217
    v_lshlrev_b32 v252, 16, v227
    v_mfma_f32_16x16x32_bf16 a[136:139], a[244:247], v[228:231], a[136:139]
    v_and_b32 v227, s22, v227
    v_add_f32 v252, v252, v248
    v_mfma_f32_16x16x32_bf16 a[140:143], a[248:251], v[228:231], a[140:143]
    v_add_f32 v227, v227, v219
    v_fmac_f32 v252, s23, v250
    v_mfma_f32_16x16x32_bf16 a[120:123], a[252:255], v[228:231], a[120:123]
    v_fmac_f32 v227, s23, v223
    v_cvt_pk_bf16_f32 v227, v252, v227
    v_mfma_f32_16x16x32_bf16 a[124:127], v[240:243], v[228:231], a[124:127]
    v_fma_f32 v252, v249, s24, v251
    v_fmac_f32 v251, s25, v249
    v_fma_f32 v249, v248, s24, v250
    v_mfma_f32_16x16x32_bf16 a[128:131], v[244:247], v[228:231], a[128:131]
    ds_read_b128 v[228:231], v253 offset:11712
    s_waitcnt lgkmcnt(2)
    v_mfma_f32_16x16x32_bf16 a[156:159], a[228:231], v[232:235], a[156:159]
    v_fmac_f32 v250, s25, v248
    v_fma_f32 v248, v250, s26, v251
    v_mfma_f32_16x16x32_bf16 a[160:163], a[232:235], v[232:235], a[160:163]
    v_fmac_f32 v251, s27, v250
    v_fma_f32 v250, v249, s28, v252
    v_mfma_f32_16x16x32_bf16 a[164:167], a[236:239], v[232:235], a[164:167]
    v_fmac_f32 v252, s29, v249
    v_fma_f32 v249, v221, s24, v225
    v_mfma_f32_16x16x32_bf16 a[144:147], a[240:243], v[232:235], a[144:147]
    v_fmac_f32 v225, s25, v221
    v_fma_f32 v221, v219, s24, v223
    v_mfma_f32_16x16x32_bf16 a[148:151], a[244:247], v[232:235], a[148:151]
    v_fmac_f32 v223, s25, v219
    v_fma_f32 v219, v223, s26, v225
    v_mfma_f32_16x16x32_bf16 a[152:155], a[248:251], v[232:235], a[152:155]
    v_fmac_f32 v225, s27, v223
    v_fma_f32 v223, v221, s28, v249
    v_mfma_f32_16x16x32_bf16 a[132:135], a[252:255], v[232:235], a[132:135]
    v_fmac_f32 v249, s29, v221
    v_cvt_pk_bf16_f32 v219, v248, v219
    v_mfma_f32_16x16x32_bf16 a[136:139], v[240:243], v[232:235], a[136:139]
    v_cvt_pk_bf16_f32 v225, v251, v225
    v_cvt_pk_bf16_f32 v223, v250, v223
    v_cvt_pk_bf16_f32 v221, v252, v249
    v_mfma_f32_16x16x32_bf16 a[140:143], v[244:247], v[232:235], a[140:143]
    ds_read_b128 v[232:235], v253 offset:11456
    s_waitcnt lgkmcnt(2)
    v_mfma_f32_16x16x32_bf16 a[168:171], a[228:231], v[236:239], a[168:171]
    v_lshrrev_b32 v252, 15, v255
    ds_read_b128 v[248:251], v253 offset:39904
    v_mfma_f32_16x16x32_bf16 a[172:175], a[232:235], v[236:239], a[172:175]
    ds_write_b64 v252, v[218:219] offset:512
    ds_write_b64 v252, v[224:225] offset:2592
    v_mfma_f32_16x16x32_bf16 a[176:179], a[236:239], v[236:239], a[176:179]
    ds_write_b64 v252, v[222:223] offset:4672
    ds_write_b64 v252, v[216:217] offset:21312
    v_mfma_f32_16x16x32_bf16 a[156:159], a[240:243], v[236:239], a[156:159]
    ds_write_b64 v252, v[226:227] offset:23392
    ds_write_b64 v252, v[220:221] offset:6752
    v_mfma_f32_16x16x32_bf16 a[160:163], a[244:247], v[236:239], a[160:163]
    s_waitcnt lgkmcnt(6)
    s_lshl_b64 exec, s[46:47], 0
    ds_write_b128 v253, v[248:251] offset:21824
    s_mov_b64 exec, -1
    v_mfma_f32_16x16x32_bf16 a[164:167], a[248:251], v[236:239], a[164:167]
    s_lshl_b64 exec, s[46:47], 2
    ds_write_b128 v253, v[248:251] offset:992
    s_mov_b64 exec, -1
    v_mfma_f32_16x16x32_bf16 a[144:147], a[252:255], v[236:239], a[144:147]
    s_lshl_b64 exec, s[46:47], 4
    ds_write_b128 v253, v[248:251] offset:3040
    s_mov_b64 exec, -1
    v_mfma_f32_16x16x32_bf16 a[148:151], v[240:243], v[236:239], a[148:151]
    v_mfma_f32_16x16x32_bf16 a[152:155], v[244:247], v[236:239], a[152:155]
    ds_read_b128 v[236:239], v253 offset:11184
    v_mfma_f32_16x16x32_bf16 a[180:183], a[228:231], v[228:231], a[180:183]
    s_lshl_b64 exec, s[46:47], 6
    ds_write_b128 v253, v[248:251] offset:5088
    s_mov_b64 exec, -1
    v_mfma_f32_16x16x32_bf16 a[184:187], a[232:235], v[228:231], a[184:187]
    s_lshl_b64 exec, s[46:47], 8
    ds_write_b128 v253, v[248:251] offset:7136
    s_mov_b64 exec, -1
    v_mfma_f32_16x16x32_bf16 a[188:191], a[236:239], v[228:231], a[188:191]
    v_mfma_f32_16x16x32_bf16 a[168:171], a[240:243], v[228:231], a[168:171]
    s_mov_b32 s42, 258048
    buffer_load_dwordx4 a[228:231], v254, s[8:11], s42 offen offset:0
    v_mfma_f32_16x16x32_bf16 a[172:175], a[244:247], v[228:231], a[172:175]
    s_lshl_b64 exec, s[46:47], 10
    ds_write_b128 v253, v[248:251] offset:23744
    s_mov_b64 exec, -1
    v_mfma_f32_16x16x32_bf16 a[176:179], a[248:251], v[228:231], a[176:179]
    buffer_load_dwordx4 a[232:235], v254, s[8:11], s42 offen offset:1024
    v_mfma_f32_16x16x32_bf16 a[156:159], a[252:255], v[228:231], a[156:159]
    v_mfma_f32_16x16x32_bf16 a[160:163], v[240:243], v[228:231], a[160:163]
    buffer_load_dwordx4 a[236:239], v254, s[8:11], s42 offen offset:2048
    v_mfma_f32_16x16x32_bf16 a[164:167], v[244:247], v[228:231], a[164:167]
    ds_read_b128 v[228:231], v253 offset:13520
    v_mfma_f32_16x16x32_bf16 a[180:183], a[240:243], v[232:235], a[180:183]
    s_waitcnt vmcnt(18)
    v_lshlrev_b32 v248, 16, v194
    v_lshlrev_b32 v249, 16, v196
    v_mfma_f32_16x16x32_bf16 a[184:187], a[244:247], v[232:235], a[184:187]
    v_lshlrev_b32 v250, 16, v198
    v_lshlrev_b32 v251, 16, v200
    v_mfma_f32_16x16x32_bf16 a[188:191], a[248:251], v[232:235], a[188:191]
    s_mov_b32 s42, 261120
    buffer_load_dwordx4 a[240:243], v254, s[8:11], s42 offen offset:0
    v_mfma_f32_16x16x32_bf16 a[168:171], a[252:255], v[232:235], a[168:171]
    v_and_b32 v194, s22, v194
    v_and_b32 v196, s22, v196
    v_mfma_f32_16x16x32_bf16 a[172:175], v[240:243], v[232:235], a[172:175]
    buffer_load_dwordx4 a[244:247], v254, s[8:11], s42 offen offset:1024
    v_and_b32 v198, s22, v198
    v_mfma_f32_16x16x32_bf16 a[176:179], v[244:247], v[232:235], a[176:179]
    ds_read_b128 v[232:235], v253 offset:13248
    s_waitcnt lgkmcnt(5)
    v_mfma_f32_16x16x32_bf16 a[180:183], a[252:255], v[236:239], a[180:183]
    buffer_load_dwordx4 a[248:251], v254, s[8:11], s42 offen offset:2048
    v_and_b32 v200, s22, v200
    v_mfma_f32_16x16x32_bf16 a[184:187], v[240:243], v[236:239], a[184:187]
    v_lshlrev_b32 v252, 16, v192
    v_mfma_f32_16x16x32_bf16 a[188:191], v[244:247], v[236:239], a[188:191]
    ds_read_b128 v[236:239], v253 offset:12992
    s_mov_b32 s42, 264192
    buffer_load_dwordx4 a[252:255], v254, s[8:11], s42 offen offset:0
    s_waitcnt vmcnt(19) lgkmcnt(2)
    v_mfma_f32_16x16x32_bf16 v[0:3], a[192:195], v[228:231], v[0:3]
    v_and_b32 v192, s22, v192
    v_add_f32 v252, v252, v251
    v_mfma_f32_16x16x32_bf16 v[4:7], a[196:199], v[228:231], v[4:7]
    buffer_load_dwordx4 v[240:243], v254, s[8:11], s42 offen offset:1024
    v_add_f32 v192, v192, v200
    v_mfma_f32_16x16x32_bf16 v[8:11], a[200:203], v[228:231], v[8:11]
    ds_read_b128 v[228:231], v253 offset:12736
    s_waitcnt lgkmcnt(2)
    v_mfma_f32_16x16x32_bf16 v[12:15], a[192:195], v[232:235], v[12:15]
    buffer_load_dwordx4 v[244:247], v254, s[8:11], s42 offen offset:2048
    v_fmac_f32 v252, s23, v249
    v_mfma_f32_16x16x32_bf16 v[16:19], a[196:199], v[232:235], v[16:19]
    v_fmac_f32 v192, s23, v196
    v_cvt_pk_bf16_f32 v192, v252, v192
    v_mfma_f32_16x16x32_bf16 v[20:23], a[200:203], v[232:235], v[20:23]
    s_waitcnt vmcnt(18)
    v_mfma_f32_16x16x32_bf16 v[0:3], a[204:207], v[232:235], v[0:3]
    v_and_b32 v227, 0x7fff, v255
    v_lshlrev_b32 v252, 16, v202
    v_mfma_f32_16x16x32_bf16 v[4:7], a[208:211], v[232:235], v[4:7]
    buffer_load_dwordx2 v[216:217], v227, s[4:7], s16 offen offset:192
    v_and_b32 v202, s22, v202
    v_mfma_f32_16x16x32_bf16 v[8:11], a[212:215], v[232:235], v[8:11]
    ds_read_b128 v[232:235], v253 offset:12480
    s_waitcnt lgkmcnt(2)
    v_mfma_f32_16x16x32_bf16 v[24:27], a[192:195], v[236:239], v[24:27]
    buffer_load_dwordx2 v[218:219], v227, s[4:7], s17 offen offset:192
    v_add_f32 v252, v252, v248
    v_mfma_f32_16x16x32_bf16 v[28:31], a[196:199], v[236:239], v[28:31]
    buffer_load_dwordx2 v[220:221], v227, s[4:7], s18 offen offset:192
    v_add_f32 v202, v202, v194
    v_mfma_f32_16x16x32_bf16 v[32:35], a[200:203], v[236:239], v[32:35]
    v_fmac_f32 v252, s23, v250
    v_mfma_f32_16x16x32_bf16 v[12:15], a[204:207], v[236:239], v[12:15]
    buffer_load_dwordx2 v[222:223], v227, s[4:7], s19 offen offset:192
    v_fmac_f32 v202, s23, v198
    v_mfma_f32_16x16x32_bf16 v[16:19], a[208:211], v[236:239], v[16:19]
    buffer_load_dwordx2 v[224:225], v227, s[4:7], s20 offen offset:192
    v_cvt_pk_bf16_f32 v202, v252, v202
    v_mfma_f32_16x16x32_bf16 v[20:23], a[212:215], v[236:239], v[20:23]
    v_fma_f32 v252, v249, s24, v251
    s_waitcnt vmcnt(20)
    v_mfma_f32_16x16x32_bf16 v[0:3], a[216:219], v[236:239], v[0:3]
    buffer_load_dwordx2 v[226:227], v227, s[4:7], s21 offen offset:192
    v_fmac_f32 v251, s25, v249
    v_mfma_f32_16x16x32_bf16 v[4:7], a[220:223], v[236:239], v[4:7]
    v_fma_f32 v249, v248, s24, v250
    v_fmac_f32 v250, s25, v248
    v_mfma_f32_16x16x32_bf16 v[8:11], a[224:227], v[236:239], v[8:11]
    ds_read_b128 v[236:239], v253 offset:14304
    s_waitcnt lgkmcnt(2)
    v_mfma_f32_16x16x32_bf16 v[36:39], a[192:195], v[228:231], v[36:39]
    v_fma_f32 v248, v250, s26, v251
    v_mfma_f32_16x16x32_bf16 v[40:43], a[196:199], v[228:231], v[40:43]
    v_fmac_f32 v251, s27, v250
    v_fma_f32 v250, v249, s28, v252
    v_mfma_f32_16x16x32_bf16 v[44:47], a[200:203], v[228:231], v[44:47]
    v_fmac_f32 v252, s29, v249
    v_fma_f32 v249, v196, s24, v200
    v_mfma_f32_16x16x32_bf16 v[24:27], a[204:207], v[228:231], v[24:27]
    v_fmac_f32 v200, s25, v196
    v_fma_f32 v196, v194, s24, v198
    v_mfma_f32_16x16x32_bf16 v[28:31], a[208:211], v[228:231], v[28:31]
    v_fmac_f32 v198, s25, v194
    v_fma_f32 v194, v198, s26, v200
    v_mfma_f32_16x16x32_bf16 v[32:35], a[212:215], v[228:231], v[32:35]
    v_fmac_f32 v200, s27, v198
    v_mfma_f32_16x16x32_bf16 v[12:15], a[216:219], v[228:231], v[12:15]
    v_fma_f32 v198, v196, s28, v249
    v_fmac_f32 v249, s29, v196
    v_mfma_f32_16x16x32_bf16 v[16:19], a[220:223], v[228:231], v[16:19]
    v_cvt_pk_bf16_f32 v194, v248, v194
    v_cvt_pk_bf16_f32 v200, v251, v200
    v_mfma_f32_16x16x32_bf16 v[20:23], a[224:227], v[228:231], v[20:23]
    ds_read_b128 v[228:231], v253 offset:14048
    s_waitcnt lgkmcnt(2)
    v_mfma_f32_16x16x32_bf16 v[48:51], a[192:195], v[232:235], v[48:51]
    v_cvt_pk_bf16_f32 v198, v250, v198
    v_cvt_pk_bf16_f32 v196, v252, v249
    v_mfma_f32_16x16x32_bf16 v[52:55], a[196:199], v[232:235], v[52:55]
    v_lshlrev_b32 v248, 16, v195
    v_lshlrev_b32 v249, 16, v197
    v_mfma_f32_16x16x32_bf16 v[56:59], a[200:203], v[232:235], v[56:59]
    v_lshlrev_b32 v250, 16, v199
    v_mfma_f32_16x16x32_bf16 v[36:39], a[204:207], v[232:235], v[36:39]
    v_lshlrev_b32 v251, 16, v201
    v_and_b32 v195, s22, v195
    v_mfma_f32_16x16x32_bf16 v[40:43], a[208:211], v[232:235], v[40:43]
    v_and_b32 v197, s22, v197
    v_and_b32 v199, s22, v199
    v_mfma_f32_16x16x32_bf16 v[44:47], a[212:215], v[232:235], v[44:47]
    v_and_b32 v201, s22, v201
    v_lshlrev_b32 v252, 16, v193
    v_mfma_f32_16x16x32_bf16 v[24:27], a[216:219], v[232:235], v[24:27]
    v_and_b32 v193, s22, v193
    v_add_f32 v252, v252, v251
    v_mfma_f32_16x16x32_bf16 v[28:31], a[220:223], v[232:235], v[28:31]
    v_add_f32 v193, v193, v201
    v_mfma_f32_16x16x32_bf16 v[32:35], a[224:227], v[232:235], v[32:35]
    ds_read_b128 v[232:235], v253 offset:13792
    s_waitcnt lgkmcnt(2)
    v_mfma_f32_16x16x32_bf16 v[60:63], a[192:195], v[236:239], v[60:63]
    v_fmac_f32 v252, s23, v249
    v_fmac_f32 v193, s23, v197
    v_mfma_f32_16x16x32_bf16 v[64:67], a[196:199], v[236:239], v[64:67]
    v_cvt_pk_bf16_f32 v193, v252, v193
    v_lshlrev_b32 v252, 16, v203
    v_mfma_f32_16x16x32_bf16 v[68:71], a[200:203], v[236:239], v[68:71]
    v_and_b32 v203, s22, v203
    v_add_f32 v252, v252, v248
    v_mfma_f32_16x16x32_bf16 v[48:51], a[204:207], v[236:239], v[48:51]
    v_add_f32 v203, v203, v195
    v_fmac_f32 v252, s23, v250
    v_mfma_f32_16x16x32_bf16 v[52:55], a[208:211], v[236:239], v[52:55]
    v_fmac_f32 v203, s23, v199
    v_cvt_pk_bf16_f32 v203, v252, v203
    v_mfma_f32_16x16x32_bf16 v[56:59], a[212:215], v[236:239], v[56:59]
    v_fma_f32 v252, v249, s24, v251
    v_mfma_f32_16x16x32_bf16 v[36:39], a[216:219], v[236:239], v[36:39]
    v_fmac_f32 v251, s25, v249
    v_fma_f32 v249, v248, s24, v250
    v_mfma_f32_16x16x32_bf16 v[40:43], a[220:223], v[236:239], v[40:43]
    v_fmac_f32 v250, s25, v248
    v_fma_f32 v248, v250, s26, v251
    v_mfma_f32_16x16x32_bf16 v[44:47], a[224:227], v[236:239], v[44:47]
    ds_read_b128 v[236:239], v253 offset:13536
    s_waitcnt lgkmcnt(2)
    v_mfma_f32_16x16x32_bf16 v[72:75], a[192:195], v[228:231], v[72:75]
    v_fmac_f32 v251, s27, v250
    v_fma_f32 v250, v249, s28, v252
    v_mfma_f32_16x16x32_bf16 v[76:79], a[196:199], v[228:231], v[76:79]
    v_fmac_f32 v252, s29, v249
    v_fma_f32 v249, v197, s24, v201
    v_mfma_f32_16x16x32_bf16 v[80:83], a[200:203], v[228:231], v[80:83]
    v_fmac_f32 v201, s25, v197
    v_mfma_f32_16x16x32_bf16 v[60:63], a[204:207], v[228:231], v[60:63]
    v_fma_f32 v197, v195, s24, v199
    v_fmac_f32 v199, s25, v195
    v_mfma_f32_16x16x32_bf16 v[64:67], a[208:211], v[228:231], v[64:67]
    v_fma_f32 v195, v199, s26, v201
    v_fmac_f32 v201, s27, v199
    v_mfma_f32_16x16x32_bf16 v[68:71], a[212:215], v[228:231], v[68:71]
    v_fma_f32 v199, v197, s28, v249
    v_fmac_f32 v249, s29, v197
    v_mfma_f32_16x16x32_bf16 v[48:51], a[216:219], v[228:231], v[48:51]
    v_cvt_pk_bf16_f32 v195, v248, v195
    v_cvt_pk_bf16_f32 v201, v251, v201
    v_mfma_f32_16x16x32_bf16 v[52:55], a[220:223], v[228:231], v[52:55]
    v_cvt_pk_bf16_f32 v199, v250, v199
    v_mfma_f32_16x16x32_bf16 v[56:59], a[224:227], v[228:231], v[56:59]
    ds_read_b128 v[228:231], v253 offset:13264
    s_waitcnt lgkmcnt(2)
    v_mfma_f32_16x16x32_bf16 v[84:87], a[192:195], v[232:235], v[84:87]
    v_cvt_pk_bf16_f32 v197, v252, v249
    v_lshrrev_b32 v252, 15, v255
    v_mfma_f32_16x16x32_bf16 v[88:91], a[196:199], v[232:235], v[88:91]
    ds_write_b64 v252, v[194:195] offset:256
    ds_write_b64 v252, v[200:201] offset:2336
    v_mfma_f32_16x16x32_bf16 v[92:95], a[200:203], v[232:235], v[92:95]
    ds_write_b64 v252, v[198:199] offset:4416
    ds_write_b64 v252, v[192:193] offset:21056
    v_mfma_f32_16x16x32_bf16 v[72:75], a[204:207], v[232:235], v[72:75]
    s_mov_b32 s42, 294912
    buffer_load_dwordx4 a[192:195], v254, s[8:11], s42 offen offset:0
    v_mfma_f32_16x16x32_bf16 v[76:79], a[208:211], v[232:235], v[76:79]
    ds_write_b64 v252, v[202:203] offset:23136
    ds_write_b64 v252, v[196:197] offset:6496
    v_mfma_f32_16x16x32_bf16 v[80:83], a[212:215], v[232:235], v[80:83]
    buffer_load_dwordx4 a[196:199], v254, s[8:11], s42 offen offset:1024
    v_mfma_f32_16x16x32_bf16 v[60:63], a[216:219], v[232:235], v[60:63]
    v_mfma_f32_16x16x32_bf16 v[64:67], a[220:223], v[232:235], v[64:67]
    buffer_load_dwordx4 a[200:203], v254, s[8:11], s42 offen offset:2048
    v_mfma_f32_16x16x32_bf16 v[68:71], a[224:227], v[232:235], v[68:71]
    ds_read_b128 v[232:235], v253 offset:30160
    s_waitcnt lgkmcnt(8)
    v_mfma_f32_16x16x32_bf16 v[84:87], a[204:207], v[236:239], v[84:87]
    s_waitcnt vmcnt(18)
    v_lshlrev_b32 v248, 16, v206
    v_lshlrev_b32 v249, 16, v208
    v_mfma_f32_16x16x32_bf16 v[88:91], a[208:211], v[236:239], v[88:91]
    v_lshlrev_b32 v250, 16, v210
    v_lshlrev_b32 v251, 16, v212
    v_mfma_f32_16x16x32_bf16 v[92:95], a[212:215], v[236:239], v[92:95]
    s_mov_b32 s42, 297984
    buffer_load_dwordx4 a[204:207], v254, s[8:11], s42 offen offset:0
    v_mfma_f32_16x16x32_bf16 v[72:75], a[216:219], v[236:239], v[72:75]
    v_and_b32 v206, s22, v206
    v_and_b32 v208, s22, v208
    v_mfma_f32_16x16x32_bf16 v[76:79], a[220:223], v[236:239], v[76:79]
    buffer_load_dwordx4 a[208:211], v254, s[8:11], s42 offen offset:1024
    v_and_b32 v210, s22, v210
    v_mfma_f32_16x16x32_bf16 v[80:83], a[224:227], v[236:239], v[80:83]
    ds_read_b128 v[236:239], v253 offset:29888
    s_waitcnt lgkmcnt(8)
    v_mfma_f32_16x16x32_bf16 v[84:87], a[216:219], v[228:231], v[84:87]
    buffer_load_dwordx4 a[212:215], v254, s[8:11], s42 offen offset:2048
    v_and_b32 v212, s22, v212
    v_mfma_f32_16x16x32_bf16 v[88:91], a[220:223], v[228:231], v[88:91]
    v_lshlrev_b32 v252, 16, v204
    v_mfma_f32_16x16x32_bf16 v[92:95], a[224:227], v[228:231], v[92:95]
    ds_read_b128 v[228:231], v253 offset:29632
    s_mov_b32 s42, 301056
    buffer_load_dwordx4 a[216:219], v254, s[8:11], s42 offen offset:0
    s_waitcnt vmcnt(19) lgkmcnt(2)
    v_mfma_f32_16x16x32_bf16 v[96:99], a[228:231], v[232:235], v[96:99]
    v_and_b32 v204, s22, v204
    v_add_f32 v252, v252, v251
    v_mfma_f32_16x16x32_bf16 v[100:103], a[232:235], v[232:235], v[100:103]
    buffer_load_dwordx4 a[220:223], v254, s[8:11], s42 offen offset:1024
    v_add_f32 v204, v204, v212
    v_mfma_f32_16x16x32_bf16 v[104:107], a[236:239], v[232:235], v[104:107]
    ds_read_b128 v[232:235], v253 offset:29376
    s_waitcnt lgkmcnt(2)
    v_mfma_f32_16x16x32_bf16 v[108:111], a[228:231], v[236:239], v[108:111]
    buffer_load_dwordx4 a[224:227], v254, s[8:11], s42 offen offset:2048
    v_fmac_f32 v252, s23, v249
    v_mfma_f32_16x16x32_bf16 v[112:115], a[232:235], v[236:239], v[112:115]
    v_fmac_f32 v204, s23, v208
    v_cvt_pk_bf16_f32 v204, v252, v204
    v_mfma_f32_16x16x32_bf16 v[116:119], a[236:239], v[236:239], v[116:119]
    s_waitcnt vmcnt(18)
    v_mfma_f32_16x16x32_bf16 v[96:99], a[240:243], v[236:239], v[96:99]
    v_and_b32 v203, 0x7fff, v255
    v_lshlrev_b32 v252, 16, v214
    v_mfma_f32_16x16x32_bf16 v[100:103], a[244:247], v[236:239], v[100:103]
    buffer_load_dwordx2 v[192:193], v203, s[4:7], s16 offen offset:576
    v_and_b32 v214, s22, v214
    v_mfma_f32_16x16x32_bf16 v[104:107], a[248:251], v[236:239], v[104:107]
    ds_read_b128 v[236:239], v253 offset:29120
    s_waitcnt lgkmcnt(2)
    v_mfma_f32_16x16x32_bf16 v[120:123], a[228:231], v[228:231], v[120:123]
    buffer_load_dwordx2 v[194:195], v203, s[4:7], s17 offen offset:576
    v_add_f32 v252, v252, v248
    v_mfma_f32_16x16x32_bf16 v[124:127], a[232:235], v[228:231], v[124:127]
    buffer_load_dwordx2 v[196:197], v203, s[4:7], s18 offen offset:576
    v_add_f32 v214, v214, v206
    v_mfma_f32_16x16x32_bf16 v[128:131], a[236:239], v[228:231], v[128:131]
    v_fmac_f32 v252, s23, v250
    v_mfma_f32_16x16x32_bf16 v[108:111], a[240:243], v[228:231], v[108:111]
    buffer_load_dwordx2 v[198:199], v203, s[4:7], s19 offen offset:576
    v_fmac_f32 v214, s23, v210
    v_mfma_f32_16x16x32_bf16 v[112:115], a[244:247], v[228:231], v[112:115]
    buffer_load_dwordx2 v[200:201], v203, s[4:7], s20 offen offset:576
    v_cvt_pk_bf16_f32 v214, v252, v214
    v_mfma_f32_16x16x32_bf16 v[116:119], a[248:251], v[228:231], v[116:119]
    v_fma_f32 v252, v249, s24, v251
    s_waitcnt vmcnt(20)
    v_mfma_f32_16x16x32_bf16 v[96:99], a[252:255], v[228:231], v[96:99]
    buffer_load_dwordx2 v[202:203], v203, s[4:7], s21 offen offset:576
    v_fmac_f32 v251, s25, v249
    v_mfma_f32_16x16x32_bf16 v[100:103], v[240:243], v[228:231], v[100:103]
    v_fma_f32 v249, v248, s24, v250
    v_fmac_f32 v250, s25, v248
    v_mfma_f32_16x16x32_bf16 v[104:107], v[244:247], v[228:231], v[104:107]
    ds_read_b128 v[228:231], v253 offset:30944
    s_waitcnt lgkmcnt(2)
    v_mfma_f32_16x16x32_bf16 v[132:135], a[228:231], v[232:235], v[132:135]
    v_fma_f32 v248, v250, s26, v251
    v_mfma_f32_16x16x32_bf16 v[136:139], a[232:235], v[232:235], v[136:139]
    v_fmac_f32 v251, s27, v250
    v_fma_f32 v250, v249, s28, v252
    v_mfma_f32_16x16x32_bf16 v[140:143], a[236:239], v[232:235], v[140:143]
    v_fmac_f32 v252, s29, v249
    v_fma_f32 v249, v208, s24, v212
    v_mfma_f32_16x16x32_bf16 v[120:123], a[240:243], v[232:235], v[120:123]
    v_fmac_f32 v212, s25, v208
    v_fma_f32 v208, v206, s24, v210
    v_mfma_f32_16x16x32_bf16 v[124:127], a[244:247], v[232:235], v[124:127]
    v_fmac_f32 v210, s25, v206
    v_fma_f32 v206, v210, s26, v212
    v_mfma_f32_16x16x32_bf16 v[128:131], a[248:251], v[232:235], v[128:131]
    v_fmac_f32 v212, s27, v210
    v_mfma_f32_16x16x32_bf16 v[108:111], a[252:255], v[232:235], v[108:111]
    v_fma_f32 v210, v208, s28, v249
    v_fmac_f32 v249, s29, v208
    v_mfma_f32_16x16x32_bf16 v[112:115], v[240:243], v[232:235], v[112:115]
    v_cvt_pk_bf16_f32 v206, v248, v206
    v_cvt_pk_bf16_f32 v212, v251, v212
    v_mfma_f32_16x16x32_bf16 v[116:119], v[244:247], v[232:235], v[116:119]
    ds_read_b128 v[232:235], v253 offset:30688
    s_waitcnt lgkmcnt(2)
    v_mfma_f32_16x16x32_bf16 v[144:147], a[228:231], v[236:239], v[144:147]
    v_cvt_pk_bf16_f32 v210, v250, v210
    v_cvt_pk_bf16_f32 v208, v252, v249
    v_mfma_f32_16x16x32_bf16 v[148:151], a[232:235], v[236:239], v[148:151]
    v_lshlrev_b32 v248, 16, v207
    v_lshlrev_b32 v249, 16, v209
    v_mfma_f32_16x16x32_bf16 v[152:155], a[236:239], v[236:239], v[152:155]
    v_lshlrev_b32 v250, 16, v211
    v_mfma_f32_16x16x32_bf16 v[132:135], a[240:243], v[236:239], v[132:135]
    v_lshlrev_b32 v251, 16, v213
    v_and_b32 v207, s22, v207
    v_mfma_f32_16x16x32_bf16 v[136:139], a[244:247], v[236:239], v[136:139]
    v_and_b32 v209, s22, v209
    v_and_b32 v211, s22, v211
    v_mfma_f32_16x16x32_bf16 v[140:143], a[248:251], v[236:239], v[140:143]
    v_and_b32 v213, s22, v213
    v_lshlrev_b32 v252, 16, v205
    v_mfma_f32_16x16x32_bf16 v[120:123], a[252:255], v[236:239], v[120:123]
    v_and_b32 v205, s22, v205
    v_add_f32 v252, v252, v251
    v_mfma_f32_16x16x32_bf16 v[124:127], v[240:243], v[236:239], v[124:127]
    v_add_f32 v205, v205, v213
    v_mfma_f32_16x16x32_bf16 v[128:131], v[244:247], v[236:239], v[128:131]
    ds_read_b128 v[236:239], v253 offset:30432
    s_waitcnt lgkmcnt(2)
    v_mfma_f32_16x16x32_bf16 v[156:159], a[228:231], v[228:231], v[156:159]
    v_fmac_f32 v252, s23, v249
    v_fmac_f32 v205, s23, v209
    v_mfma_f32_16x16x32_bf16 v[160:163], a[232:235], v[228:231], v[160:163]
    v_cvt_pk_bf16_f32 v205, v252, v205
    v_lshlrev_b32 v252, 16, v215
    v_mfma_f32_16x16x32_bf16 v[164:167], a[236:239], v[228:231], v[164:167]
    v_and_b32 v215, s22, v215
    v_add_f32 v252, v252, v248
    v_mfma_f32_16x16x32_bf16 v[144:147], a[240:243], v[228:231], v[144:147]
    v_add_f32 v215, v215, v207
    v_fmac_f32 v252, s23, v250
    v_mfma_f32_16x16x32_bf16 v[148:151], a[244:247], v[228:231], v[148:151]
    v_fmac_f32 v215, s23, v211
    v_cvt_pk_bf16_f32 v215, v252, v215
    v_mfma_f32_16x16x32_bf16 v[152:155], a[248:251], v[228:231], v[152:155]
    v_fma_f32 v252, v249, s24, v251
    v_mfma_f32_16x16x32_bf16 v[132:135], a[252:255], v[228:231], v[132:135]
    v_fmac_f32 v251, s25, v249
    v_fma_f32 v249, v248, s24, v250
    v_mfma_f32_16x16x32_bf16 v[136:139], v[240:243], v[228:231], v[136:139]
    v_fmac_f32 v250, s25, v248
    v_fma_f32 v248, v250, s26, v251
    v_mfma_f32_16x16x32_bf16 v[140:143], v[244:247], v[228:231], v[140:143]
    ds_read_b128 v[228:231], v253 offset:30176
    s_waitcnt lgkmcnt(2)
    v_mfma_f32_16x16x32_bf16 v[168:171], a[228:231], v[232:235], v[168:171]
    v_fmac_f32 v251, s27, v250
    v_fma_f32 v250, v249, s28, v252
    v_mfma_f32_16x16x32_bf16 v[172:175], a[232:235], v[232:235], v[172:175]
    v_fmac_f32 v252, s29, v249
    v_fma_f32 v249, v209, s24, v213
    v_mfma_f32_16x16x32_bf16 v[176:179], a[236:239], v[232:235], v[176:179]
    v_fmac_f32 v213, s25, v209
    v_mfma_f32_16x16x32_bf16 v[156:159], a[240:243], v[232:235], v[156:159]
    v_fma_f32 v209, v207, s24, v211
    v_fmac_f32 v211, s25, v207
    v_mfma_f32_16x16x32_bf16 v[160:163], a[244:247], v[232:235], v[160:163]
    v_fma_f32 v207, v211, s26, v213
    v_fmac_f32 v213, s27, v211
    v_mfma_f32_16x16x32_bf16 v[164:167], a[248:251], v[232:235], v[164:167]
    v_fma_f32 v211, v209, s28, v249
    v_fmac_f32 v249, s29, v209
    v_mfma_f32_16x16x32_bf16 v[144:147], a[252:255], v[232:235], v[144:147]
    v_cvt_pk_bf16_f32 v207, v248, v207
    v_cvt_pk_bf16_f32 v213, v251, v213
    v_mfma_f32_16x16x32_bf16 v[148:151], v[240:243], v[232:235], v[148:151]
    v_cvt_pk_bf16_f32 v211, v250, v211
    v_mfma_f32_16x16x32_bf16 v[152:155], v[244:247], v[232:235], v[152:155]
    ds_read_b128 v[232:235], v253 offset:29904
    s_waitcnt lgkmcnt(2)
    v_mfma_f32_16x16x32_bf16 v[180:183], a[228:231], v[236:239], v[180:183]
    v_cvt_pk_bf16_f32 v209, v252, v249
    v_lshrrev_b32 v252, 15, v255
    v_mfma_f32_16x16x32_bf16 v[184:187], a[232:235], v[236:239], v[184:187]
    ds_write_b64 v252, v[206:207] offset:0
    ds_write_b64 v252, v[212:213] offset:2080
    v_mfma_f32_16x16x32_bf16 v[188:191], a[236:239], v[236:239], v[188:191]
    ds_write_b64 v252, v[210:211] offset:4160
    ds_write_b64 v252, v[204:205] offset:20800
    v_mfma_f32_16x16x32_bf16 v[168:171], a[240:243], v[236:239], v[168:171]
    s_mov_b32 s42, 331776
    buffer_load_dwordx4 a[228:231], v254, s[8:11], s42 offen offset:0
    v_mfma_f32_16x16x32_bf16 v[172:175], a[244:247], v[236:239], v[172:175]
    ds_write_b64 v252, v[214:215] offset:22880
    ds_write_b64 v252, v[208:209] offset:6240
    v_mfma_f32_16x16x32_bf16 v[176:179], a[248:251], v[236:239], v[176:179]
    buffer_load_dwordx4 a[232:235], v254, s[8:11], s42 offen offset:1024
    v_mfma_f32_16x16x32_bf16 v[156:159], a[252:255], v[236:239], v[156:159]
    v_mfma_f32_16x16x32_bf16 v[160:163], v[240:243], v[236:239], v[160:163]
    buffer_load_dwordx4 a[236:239], v254, s[8:11], s42 offen offset:2048
    v_mfma_f32_16x16x32_bf16 v[164:167], v[244:247], v[236:239], v[164:167]
    s_waitcnt lgkmcnt(0)
    s_barrier
    ds_read_b128 v[236:239], v253 offset:1040
    v_mfma_f32_16x16x32_bf16 v[180:183], a[240:243], v[228:231], v[180:183]
    s_waitcnt vmcnt(18)
    v_lshlrev_b32 v248, 16, v218
    v_lshlrev_b32 v249, 16, v220
    v_mfma_f32_16x16x32_bf16 v[184:187], a[244:247], v[228:231], v[184:187]
    v_lshlrev_b32 v250, 16, v222
    v_lshlrev_b32 v251, 16, v224
    v_mfma_f32_16x16x32_bf16 v[188:191], a[248:251], v[228:231], v[188:191]
    s_mov_b32 s42, 334848
    buffer_load_dwordx4 a[240:243], v254, s[8:11], s42 offen offset:0
    v_mfma_f32_16x16x32_bf16 v[168:171], a[252:255], v[228:231], v[168:171]
    v_and_b32 v218, s22, v218
    v_and_b32 v220, s22, v220
    v_mfma_f32_16x16x32_bf16 v[172:175], v[240:243], v[228:231], v[172:175]
    buffer_load_dwordx4 a[244:247], v254, s[8:11], s42 offen offset:1024
    v_and_b32 v222, s22, v222
    v_mfma_f32_16x16x32_bf16 v[176:179], v[244:247], v[228:231], v[176:179]
    ds_read_b128 v[228:231], v253 offset:768
    v_mfma_f32_16x16x32_bf16 v[180:183], a[252:255], v[232:235], v[180:183]
    buffer_load_dwordx4 a[248:251], v254, s[8:11], s42 offen offset:2048
    v_and_b32 v224, s22, v224
    v_mfma_f32_16x16x32_bf16 v[184:187], v[240:243], v[232:235], v[184:187]
    v_lshlrev_b32 v252, 16, v216
    v_mfma_f32_16x16x32_bf16 v[188:191], v[244:247], v[232:235], v[188:191]
    ds_read_b128 v[232:235], v253 offset:512
    s_mov_b32 s42, 337920
    buffer_load_dwordx4 a[252:255], v254, s[8:11], s42 offen offset:0
    s_waitcnt vmcnt(19) lgkmcnt(2)
    v_mfma_f32_16x16x32_bf16 a[0:3], a[192:195], v[236:239], a[0:3]
    v_and_b32 v216, s22, v216
    v_add_f32 v252, v252, v251
    v_mfma_f32_16x16x32_bf16 a[4:7], a[196:199], v[236:239], a[4:7]
    buffer_load_dwordx4 v[240:243], v254, s[8:11], s42 offen offset:1024
    v_add_f32 v216, v216, v224
    v_mfma_f32_16x16x32_bf16 a[8:11], a[200:203], v[236:239], a[8:11]
    ds_read_b128 v[236:239], v253 offset:256
    s_waitcnt lgkmcnt(2)
    v_mfma_f32_16x16x32_bf16 a[12:15], a[192:195], v[228:231], a[12:15]
    buffer_load_dwordx4 v[244:247], v254, s[8:11], s42 offen offset:2048
    v_fmac_f32 v252, s23, v249
    v_mfma_f32_16x16x32_bf16 a[16:19], a[196:199], v[228:231], a[16:19]
    v_fmac_f32 v216, s23, v220
    v_cvt_pk_bf16_f32 v216, v252, v216
    v_mfma_f32_16x16x32_bf16 a[20:23], a[200:203], v[228:231], a[20:23]
    s_waitcnt vmcnt(18)
    v_mfma_f32_16x16x32_bf16 a[0:3], a[204:207], v[228:231], a[0:3]
    v_and_b32 v215, 0x7fff, v255
    v_lshlrev_b32 v252, 16, v226
    v_mfma_f32_16x16x32_bf16 a[4:7], a[208:211], v[228:231], a[4:7]
    buffer_load_dwordx2 v[204:205], v215, s[4:7], s16 offen offset:960
    v_and_b32 v226, s22, v226
    v_mfma_f32_16x16x32_bf16 a[8:11], a[212:215], v[228:231], a[8:11]
    ds_read_b128 v[228:231], v253 offset:0
    s_waitcnt lgkmcnt(2)
    v_mfma_f32_16x16x32_bf16 a[24:27], a[192:195], v[232:235], a[24:27]
    buffer_load_dwordx2 v[206:207], v215, s[4:7], s17 offen offset:960
    v_add_f32 v252, v252, v248
    v_mfma_f32_16x16x32_bf16 a[28:31], a[196:199], v[232:235], a[28:31]
    buffer_load_dwordx2 v[208:209], v215, s[4:7], s18 offen offset:960
    v_add_f32 v226, v226, v218
    v_mfma_f32_16x16x32_bf16 a[32:35], a[200:203], v[232:235], a[32:35]
    v_fmac_f32 v252, s23, v250
    v_mfma_f32_16x16x32_bf16 a[12:15], a[204:207], v[232:235], a[12:15]
    buffer_load_dwordx2 v[210:211], v215, s[4:7], s19 offen offset:960
    v_fmac_f32 v226, s23, v222
    v_mfma_f32_16x16x32_bf16 a[16:19], a[208:211], v[232:235], a[16:19]
    buffer_load_dwordx2 v[212:213], v215, s[4:7], s20 offen offset:960
    v_cvt_pk_bf16_f32 v226, v252, v226
    v_mfma_f32_16x16x32_bf16 a[20:23], a[212:215], v[232:235], a[20:23]
    v_fma_f32 v252, v249, s24, v251
    s_waitcnt vmcnt(20)
    v_mfma_f32_16x16x32_bf16 a[0:3], a[216:219], v[232:235], a[0:3]
    buffer_load_dwordx2 v[214:215], v215, s[4:7], s21 offen offset:960
    v_fmac_f32 v251, s25, v249
    v_mfma_f32_16x16x32_bf16 a[4:7], a[220:223], v[232:235], a[4:7]
    v_fma_f32 v249, v248, s24, v250
    v_fmac_f32 v250, s25, v248
    v_mfma_f32_16x16x32_bf16 a[8:11], a[224:227], v[232:235], a[8:11]
    ds_read_b128 v[232:235], v253 offset:1824
    s_waitcnt lgkmcnt(2)
    v_mfma_f32_16x16x32_bf16 a[36:39], a[192:195], v[236:239], a[36:39]
    v_fma_f32 v248, v250, s26, v251
    v_mfma_f32_16x16x32_bf16 a[40:43], a[196:199], v[236:239], a[40:43]
    v_fmac_f32 v251, s27, v250
    v_fma_f32 v250, v249, s28, v252
    v_mfma_f32_16x16x32_bf16 a[44:47], a[200:203], v[236:239], a[44:47]
    v_fmac_f32 v252, s29, v249
    v_fma_f32 v249, v220, s24, v224
    v_mfma_f32_16x16x32_bf16 a[24:27], a[204:207], v[236:239], a[24:27]
    v_fmac_f32 v224, s25, v220
    v_fma_f32 v220, v218, s24, v222
    v_mfma_f32_16x16x32_bf16 a[28:31], a[208:211], v[236:239], a[28:31]
    v_fmac_f32 v222, s25, v218
    v_fma_f32 v218, v222, s26, v224
    v_mfma_f32_16x16x32_bf16 a[32:35], a[212:215], v[236:239], a[32:35]
    v_fmac_f32 v224, s27, v222
    v_mfma_f32_16x16x32_bf16 a[12:15], a[216:219], v[236:239], a[12:15]
    v_fma_f32 v222, v220, s28, v249
    v_fmac_f32 v249, s29, v220
    v_mfma_f32_16x16x32_bf16 a[16:19], a[220:223], v[236:239], a[16:19]
    v_cvt_pk_bf16_f32 v218, v248, v218
    v_cvt_pk_bf16_f32 v224, v251, v224
    v_mfma_f32_16x16x32_bf16 a[20:23], a[224:227], v[236:239], a[20:23]
    ds_read_b128 v[236:239], v253 offset:1568
    s_waitcnt lgkmcnt(2)
    v_mfma_f32_16x16x32_bf16 a[48:51], a[192:195], v[228:231], a[48:51]
    v_cvt_pk_bf16_f32 v222, v250, v222
    v_cvt_pk_bf16_f32 v220, v252, v249
    v_mfma_f32_16x16x32_bf16 a[52:55], a[196:199], v[228:231], a[52:55]
    v_lshlrev_b32 v248, 16, v219
    v_lshlrev_b32 v249, 16, v221
    v_mfma_f32_16x16x32_bf16 a[56:59], a[200:203], v[228:231], a[56:59]
    v_lshlrev_b32 v250, 16, v223
    v_mfma_f32_16x16x32_bf16 a[36:39], a[204:207], v[228:231], a[36:39]
    v_lshlrev_b32 v251, 16, v225
    v_and_b32 v219, s22, v219
    v_mfma_f32_16x16x32_bf16 a[40:43], a[208:211], v[228:231], a[40:43]
    v_and_b32 v221, s22, v221
    v_and_b32 v223, s22, v223
    v_mfma_f32_16x16x32_bf16 a[44:47], a[212:215], v[228:231], a[44:47]
    v_and_b32 v225, s22, v225
    v_lshlrev_b32 v252, 16, v217
    v_mfma_f32_16x16x32_bf16 a[24:27], a[216:219], v[228:231], a[24:27]
    v_and_b32 v217, s22, v217
    v_add_f32 v252, v252, v251
    v_mfma_f32_16x16x32_bf16 a[28:31], a[220:223], v[228:231], a[28:31]
    v_add_f32 v217, v217, v225
    v_mfma_f32_16x16x32_bf16 a[32:35], a[224:227], v[228:231], a[32:35]
    ds_read_b128 v[228:231], v253 offset:1312
    s_waitcnt lgkmcnt(2)
    v_mfma_f32_16x16x32_bf16 a[60:63], a[192:195], v[232:235], a[60:63]
    v_fmac_f32 v252, s23, v249
    v_fmac_f32 v217, s23, v221
    v_mfma_f32_16x16x32_bf16 a[64:67], a[196:199], v[232:235], a[64:67]
    v_cvt_pk_bf16_f32 v217, v252, v217
    v_lshlrev_b32 v252, 16, v227
    v_mfma_f32_16x16x32_bf16 a[68:71], a[200:203], v[232:235], a[68:71]
    v_and_b32 v227, s22, v227
    v_add_f32 v252, v252, v248
    v_mfma_f32_16x16x32_bf16 a[48:51], a[204:207], v[232:235], a[48:51]
    v_add_f32 v227, v227, v219
    v_fmac_f32 v252, s23, v250
    v_mfma_f32_16x16x32_bf16 a[52:55], a[208:211], v[232:235], a[52:55]
    v_fmac_f32 v227, s23, v223
    v_cvt_pk_bf16_f32 v227, v252, v227
    v_mfma_f32_16x16x32_bf16 a[56:59], a[212:215], v[232:235], a[56:59]
    v_fma_f32 v252, v249, s24, v251
    v_mfma_f32_16x16x32_bf16 a[36:39], a[216:219], v[232:235], a[36:39]
    v_fmac_f32 v251, s25, v249
    v_fma_f32 v249, v248, s24, v250
    v_mfma_f32_16x16x32_bf16 a[40:43], a[220:223], v[232:235], a[40:43]
    v_fmac_f32 v250, s25, v248
    v_fma_f32 v248, v250, s26, v251
    v_mfma_f32_16x16x32_bf16 a[44:47], a[224:227], v[232:235], a[44:47]
    ds_read_b128 v[232:235], v253 offset:1056
    s_waitcnt lgkmcnt(2)
    v_mfma_f32_16x16x32_bf16 a[72:75], a[192:195], v[236:239], a[72:75]
    v_fmac_f32 v251, s27, v250
    v_fma_f32 v250, v249, s28, v252
    v_mfma_f32_16x16x32_bf16 a[76:79], a[196:199], v[236:239], a[76:79]
    v_fmac_f32 v252, s29, v249
    v_fma_f32 v249, v221, s24, v225
    v_mfma_f32_16x16x32_bf16 a[80:83], a[200:203], v[236:239], a[80:83]
    v_fmac_f32 v225, s25, v221
    v_mfma_f32_16x16x32_bf16 a[60:63], a[204:207], v[236:239], a[60:63]
    v_fma_f32 v221, v219, s24, v223
    v_fmac_f32 v223, s25, v219
    v_mfma_f32_16x16x32_bf16 a[64:67], a[208:211], v[236:239], a[64:67]
    v_fma_f32 v219, v223, s26, v225
    v_fmac_f32 v225, s27, v223
    v_mfma_f32_16x16x32_bf16 a[68:71], a[212:215], v[236:239], a[68:71]
    v_fma_f32 v223, v221, s28, v249
    v_fmac_f32 v249, s29, v221
    v_mfma_f32_16x16x32_bf16 a[48:51], a[216:219], v[236:239], a[48:51]
    v_cvt_pk_bf16_f32 v219, v248, v219
    v_cvt_pk_bf16_f32 v225, v251, v225
    v_mfma_f32_16x16x32_bf16 a[52:55], a[220:223], v[236:239], a[52:55]
    v_cvt_pk_bf16_f32 v223, v250, v223
    v_mfma_f32_16x16x32_bf16 a[56:59], a[224:227], v[236:239], a[56:59]
    ds_read_b128 v[236:239], v253 offset:784
    s_waitcnt lgkmcnt(2)
    v_mfma_f32_16x16x32_bf16 a[84:87], a[192:195], v[228:231], a[84:87]
    v_cvt_pk_bf16_f32 v221, v252, v249
    v_lshrrev_b32 v252, 15, v255
    v_mfma_f32_16x16x32_bf16 a[88:91], a[196:199], v[228:231], a[88:91]
    ds_write_b64 v252, v[218:219] offset:9088
    ds_write_b64 v252, v[224:225] offset:11168
    v_mfma_f32_16x16x32_bf16 a[92:95], a[200:203], v[228:231], a[92:95]
    ds_write_b64 v252, v[222:223] offset:13248
    ds_write_b64 v252, v[216:217] offset:19488
    v_mfma_f32_16x16x32_bf16 a[72:75], a[204:207], v[228:231], a[72:75]
    s_mov_b32 s42, 368640
    buffer_load_dwordx4 a[192:195], v254, s[8:11], s42 offen offset:0
    v_mfma_f32_16x16x32_bf16 a[76:79], a[208:211], v[228:231], a[76:79]
    ds_write_b64 v252, v[226:227] offset:25728
    ds_write_b64 v252, v[220:221] offset:29888
    v_mfma_f32_16x16x32_bf16 a[80:83], a[212:215], v[228:231], a[80:83]
    buffer_load_dwordx4 a[196:199], v254, s[8:11], s42 offen offset:1024
    v_mfma_f32_16x16x32_bf16 a[60:63], a[216:219], v[228:231], a[60:63]
    v_mfma_f32_16x16x32_bf16 a[64:67], a[220:223], v[228:231], a[64:67]
    buffer_load_dwordx4 a[200:203], v254, s[8:11], s42 offen offset:2048
    v_mfma_f32_16x16x32_bf16 a[68:71], a[224:227], v[228:231], a[68:71]
    ds_read_b128 v[228:231], v253 offset:3120
    s_waitcnt lgkmcnt(8)
    v_mfma_f32_16x16x32_bf16 a[84:87], a[204:207], v[232:235], a[84:87]
    s_waitcnt vmcnt(18)
    v_lshlrev_b32 v248, 16, v194
    v_lshlrev_b32 v249, 16, v196
    v_lshlrev_b32 v250, 16, v198
    v_mfma_f32_16x16x32_bf16 a[88:91], a[208:211], v[232:235], a[88:91]
    v_lshlrev_b32 v251, 16, v200
    v_and_b32 v194, s22, v194
    v_mfma_f32_16x16x32_bf16 a[92:95], a[212:215], v[232:235], a[92:95]
    s_mov_b32 s42, 371712
    buffer_load_dwordx4 a[204:207], v254, s[8:11], s42 offen offset:0
    v_mfma_f32_16x16x32_bf16 a[72:75], a[216:219], v[232:235], a[72:75]
    v_and_b32 v196, s22, v196
    v_and_b32 v198, s22, v198
    v_mfma_f32_16x16x32_bf16 a[76:79], a[220:223], v[232:235], a[76:79]
    buffer_load_dwordx4 a[208:211], v254, s[8:11], s42 offen offset:1024
    v_and_b32 v200, s22, v200
    v_mfma_f32_16x16x32_bf16 a[80:83], a[224:227], v[232:235], a[80:83]
    ds_read_b128 v[232:235], v253 offset:2848
    s_waitcnt lgkmcnt(8)
    v_mfma_f32_16x16x32_bf16 a[84:87], a[216:219], v[236:239], a[84:87]
    buffer_load_dwordx4 a[212:215], v254, s[8:11], s42 offen offset:2048
    v_lshlrev_b32 v252, 16, v192
    v_mfma_f32_16x16x32_bf16 a[88:91], a[220:223], v[236:239], a[88:91]
    v_and_b32 v192, s22, v192
    v_add_f32 v252, v252, v251
    v_mfma_f32_16x16x32_bf16 a[92:95], a[224:227], v[236:239], a[92:95]
    ds_read_b128 v[236:239], v253 offset:2592
    s_mov_b32 s42, 374784
    buffer_load_dwordx4 a[216:219], v254, s[8:11], s42 offen offset:0
    s_waitcnt vmcnt(19) lgkmcnt(2)
    v_mfma_f32_16x16x32_bf16 a[96:99], a[228:231], v[228:231], a[96:99]
    v_add_f32 v192, v192, v200
    v_fmac_f32 v252, s23, v249
    v_fmac_f32 v192, s23, v196
    v_mfma_f32_16x16x32_bf16 a[100:103], a[232:235], v[228:231], a[100:103]
    buffer_load_dwordx4 a[220:223], v254, s[8:11], s42 offen offset:1024
    v_cvt_pk_bf16_f32 v192, v252, v192
    v_mfma_f32_16x16x32_bf16 a[104:107], a[236:239], v[228:231], a[104:107]
    ds_read_b128 v[228:231], v253 offset:2336
    s_waitcnt lgkmcnt(2)
    v_mfma_f32_16x16x32_bf16 a[108:111], a[228:231], v[232:235], a[108:111]
    buffer_load_dwordx4 a[224:227], v254, s[8:11], s42 offen offset:2048
    v_lshlrev_b32 v252, 16, v202
    v_mfma_f32_16x16x32_bf16 a[112:115], a[232:235], v[232:235], a[112:115]
    v_and_b32 v202, s22, v202
    v_add_f32 v252, v252, v248
    v_mfma_f32_16x16x32_bf16 a[116:119], a[236:239], v[232:235], a[116:119]
    v_add_f32 v202, v202, v194
    s_waitcnt vmcnt(18)
    v_mfma_f32_16x16x32_bf16 a[96:99], a[240:243], v[232:235], a[96:99]
    v_and_b32 v227, 0x7fff, v255
    v_fmac_f32 v252, s23, v250
    v_mfma_f32_16x16x32_bf16 a[100:103], a[244:247], v[232:235], a[100:103]
    buffer_load_dwordx2 v[216:217], v227, s[4:7], s16 offen offset:1344
    v_fmac_f32 v202, s23, v198
    v_mfma_f32_16x16x32_bf16 a[104:107], a[248:251], v[232:235], a[104:107]
    ds_read_b128 v[232:235], v253 offset:2080
    s_waitcnt lgkmcnt(2)
    v_mfma_f32_16x16x32_bf16 a[120:123], a[228:231], v[236:239], a[120:123]
    buffer_load_dwordx2 v[218:219], v227, s[4:7], s17 offen offset:1344
    v_cvt_pk_bf16_f32 v202, v252, v202
    v_fma_f32 v252, v249, s24, v251
    v_mfma_f32_16x16x32_bf16 a[124:127], a[232:235], v[236:239], a[124:127]
    buffer_load_dwordx2 v[220:221], v227, s[4:7], s18 offen offset:1344
    v_fmac_f32 v251, s25, v249
    v_mfma_f32_16x16x32_bf16 a[128:131], a[236:239], v[236:239], a[128:131]
    v_fma_f32 v249, v248, s24, v250
    v_fmac_f32 v250, s25, v248
    v_mfma_f32_16x16x32_bf16 a[108:111], a[240:243], v[236:239], a[108:111]
    buffer_load_dwordx2 v[222:223], v227, s[4:7], s19 offen offset:1344
    v_fma_f32 v248, v250, s26, v251
    v_mfma_f32_16x16x32_bf16 a[112:115], a[244:247], v[236:239], a[112:115]
    buffer_load_dwordx2 v[224:225], v227, s[4:7], s20 offen offset:1344
    v_fmac_f32 v251, s27, v250
    v_mfma_f32_16x16x32_bf16 a[116:119], a[248:251], v[236:239], a[116:119]
    v_fma_f32 v250, v249, s28, v252
    s_waitcnt vmcnt(20)
    v_mfma_f32_16x16x32_bf16 a[96:99], a[252:255], v[236:239], a[96:99]
    buffer_load_dwordx2 v[226:227], v227, s[4:7], s21 offen offset:1344
    v_fmac_f32 v252, s29, v249
    v_mfma_f32_16x16x32_bf16 a[100:103], v[240:243], v[236:239], a[100:103]
    v_fma_f32 v249, v196, s24, v200
    v_fmac_f32 v200, s25, v196
    v_mfma_f32_16x16x32_bf16 a[104:107], v[244:247], v[236:239], a[104:107]
    ds_read_b128 v[236:239], v253 offset:3904
    v_fma_f32 v196, v194, s24, v198
    s_waitcnt lgkmcnt(2)
    v_mfma_f32_16x16x32_bf16 a[132:135], a[228:231], v[228:231], a[132:135]
    v_fmac_f32 v198, s25, v194
    v_fma_f32 v194, v198, s26, v200
    v_mfma_f32_16x16x32_bf16 a[136:139], a[232:235], v[228:231], a[136:139]
    v_fmac_f32 v200, s27, v198
    v_fma_f32 v198, v196, s28, v249
    v_mfma_f32_16x16x32_bf16 a[140:143], a[236:239], v[228:231], a[140:143]
    v_fmac_f32 v249, s29, v196
    v_cvt_pk_bf16_f32 v194, v248, v194
    v_mfma_f32_16x16x32_bf16 a[120:123], a[240:243], v[228:231], a[120:123]
    v_cvt_pk_bf16_f32 v200, v251, v200
    v_cvt_pk_bf16_f32 v198, v250, v198
    v_mfma_f32_16x16x32_bf16 a[124:127], a[244:247], v[228:231], a[124:127]
    v_cvt_pk_bf16_f32 v196, v252, v249
    v_lshlrev_b32 v248, 16, v195
    v_mfma_f32_16x16x32_bf16 a[128:131], a[248:251], v[228:231], a[128:131]
    v_lshlrev_b32 v249, 16, v197
    v_lshlrev_b32 v250, 16, v199
    v_mfma_f32_16x16x32_bf16 a[108:111], a[252:255], v[228:231], a[108:111]
    v_lshlrev_b32 v251, 16, v201
    v_and_b32 v195, s22, v195
    v_mfma_f32_16x16x32_bf16 a[112:115], v[240:243], v[228:231], a[112:115]
    v_and_b32 v197, s22, v197
    v_and_b32 v199, s22, v199
    v_mfma_f32_16x16x32_bf16 a[116:119], v[244:247], v[228:231], a[116:119]
    ds_read_b128 v[228:231], v253 offset:3648
    v_and_b32 v201, s22, v201
    s_waitcnt lgkmcnt(2)
    v_mfma_f32_16x16x32_bf16 a[144:147], a[228:231], v[232:235], a[144:147]
    v_lshlrev_b32 v252, 16, v193
    v_and_b32 v193, s22, v193
    v_mfma_f32_16x16x32_bf16 a[148:151], a[232:235], v[232:235], a[148:151]
    v_add_f32 v252, v252, v251
    v_add_f32 v193, v193, v201
    v_mfma_f32_16x16x32_bf16 a[152:155], a[236:239], v[232:235], a[152:155]
    v_fmac_f32 v252, s23, v249
    v_fmac_f32 v193, s23, v197
    v_mfma_f32_16x16x32_bf16 a[132:135], a[240:243], v[232:235], a[132:135]
    v_cvt_pk_bf16_f32 v193, v252, v193
    v_lshlrev_b32 v252, 16, v203
    v_mfma_f32_16x16x32_bf16 a[136:139], a[244:247], v[232:235], a[136:139]
    v_and_b32 v203, s22, v203
    v_add_f32 v252, v252, v248
    v_mfma_f32_16x16x32_bf16 a[140:143], a[248:251], v[232:235], a[140:143]
    v_add_f32 v203, v203, v195
    v_fmac_f32 v252, s23, v250
    v_mfma_f32_16x16x32_bf16 a[120:123], a[252:255], v[232:235], a[120:123]
    v_fmac_f32 v203, s23, v199
    v_cvt_pk_bf16_f32 v203, v252, v203
    v_mfma_f32_16x16x32_bf16 a[124:127], v[240:243], v[232:235], a[124:127]
    v_fma_f32 v252, v249, s24, v251
    v_fmac_f32 v251, s25, v249
    v_fma_f32 v249, v248, s24, v250
    v_mfma_f32_16x16x32_bf16 a[128:131], v[244:247], v[232:235], a[128:131]
    ds_read_b128 v[232:235], v253 offset:3392
    s_waitcnt lgkmcnt(2)
    v_mfma_f32_16x16x32_bf16 a[156:159], a[228:231], v[236:239], a[156:159]
    v_fmac_f32 v250, s25, v248
    v_fma_f32 v248, v250, s26, v251
    v_mfma_f32_16x16x32_bf16 a[160:163], a[232:235], v[236:239], a[160:163]
    v_fmac_f32 v251, s27, v250
    v_fma_f32 v250, v249, s28, v252
    v_mfma_f32_16x16x32_bf16 a[164:167], a[236:239], v[236:239], a[164:167]
    v_fmac_f32 v252, s29, v249
    v_fma_f32 v249, v197, s24, v201
    v_mfma_f32_16x16x32_bf16 a[144:147], a[240:243], v[236:239], a[144:147]
    v_fmac_f32 v201, s25, v197
    v_fma_f32 v197, v195, s24, v199
    v_mfma_f32_16x16x32_bf16 a[148:151], a[244:247], v[236:239], a[148:151]
    v_fmac_f32 v199, s25, v195
    v_fma_f32 v195, v199, s26, v201
    v_mfma_f32_16x16x32_bf16 a[152:155], a[248:251], v[236:239], a[152:155]
    v_fmac_f32 v201, s27, v199
    v_fma_f32 v199, v197, s28, v249
    v_mfma_f32_16x16x32_bf16 a[132:135], a[252:255], v[236:239], a[132:135]
    v_fmac_f32 v249, s29, v197
    v_cvt_pk_bf16_f32 v195, v248, v195
    v_mfma_f32_16x16x32_bf16 a[136:139], v[240:243], v[236:239], a[136:139]
    v_cvt_pk_bf16_f32 v201, v251, v201
    v_cvt_pk_bf16_f32 v199, v250, v199
    v_cvt_pk_bf16_f32 v197, v252, v249
    v_mfma_f32_16x16x32_bf16 a[140:143], v[244:247], v[236:239], a[140:143]
    ds_read_b128 v[236:239], v253 offset:3136
    s_waitcnt lgkmcnt(2)
    v_mfma_f32_16x16x32_bf16 a[168:171], a[228:231], v[228:231], a[168:171]
    v_lshrrev_b32 v252, 15, v255
    ds_read_b128 v[248:251], v253 offset:40096
    v_mfma_f32_16x16x32_bf16 a[172:175], a[232:235], v[228:231], a[172:175]
    ds_write_b64 v252, v[194:195] offset:8832
    ds_write_b64 v252, v[200:201] offset:10912
    v_mfma_f32_16x16x32_bf16 a[176:179], a[236:239], v[228:231], a[176:179]
    ds_write_b64 v252, v[198:199] offset:12992
    ds_write_b64 v252, v[192:193] offset:19232
    v_mfma_f32_16x16x32_bf16 a[156:159], a[240:243], v[228:231], a[156:159]
    ds_write_b64 v252, v[202:203] offset:25472
    ds_write_b64 v252, v[196:197] offset:29632
    v_mfma_f32_16x16x32_bf16 a[160:163], a[244:247], v[228:231], a[160:163]
    s_waitcnt lgkmcnt(6)
    s_lshl_b64 exec, s[46:47], 0
    ds_write_b128 v253, v[248:251] offset:19744
    s_mov_b64 exec, -1
    v_mfma_f32_16x16x32_bf16 a[164:167], a[248:251], v[228:231], a[164:167]
    s_lshl_b64 exec, s[46:47], 2
    ds_write_b128 v253, v[248:251] offset:9312
    s_mov_b64 exec, -1
    v_mfma_f32_16x16x32_bf16 a[144:147], a[252:255], v[228:231], a[144:147]
    s_lshl_b64 exec, s[46:47], 4
    ds_write_b128 v253, v[248:251] offset:11360
    s_mov_b64 exec, -1
    v_mfma_f32_16x16x32_bf16 a[148:151], v[240:243], v[228:231], a[148:151]
    v_mfma_f32_16x16x32_bf16 a[152:155], v[244:247], v[228:231], a[152:155]
    ds_read_b128 v[228:231], v253 offset:2864
    v_mfma_f32_16x16x32_bf16 a[180:183], a[228:231], v[232:235], a[180:183]
    s_lshl_b64 exec, s[46:47], 6
    ds_write_b128 v253, v[248:251] offset:13408
    s_mov_b64 exec, -1
    v_mfma_f32_16x16x32_bf16 a[184:187], a[232:235], v[232:235], a[184:187]
    s_lshl_b64 exec, s[46:47], 8
    ds_write_b128 v253, v[248:251] offset:30016
    s_mov_b64 exec, -1
    v_mfma_f32_16x16x32_bf16 a[188:191], a[236:239], v[232:235], a[188:191]
    v_mfma_f32_16x16x32_bf16 a[168:171], a[240:243], v[232:235], a[168:171]
    s_mov_b32 s42, 405504
    buffer_load_dwordx4 a[228:231], v254, s[8:11], s42 offen offset:0
    v_mfma_f32_16x16x32_bf16 a[172:175], a[244:247], v[232:235], a[172:175]
    s_lshl_b64 exec, s[46:47], 10
    ds_write_b128 v253, v[248:251] offset:25824
    s_mov_b64 exec, -1
    v_mfma_f32_16x16x32_bf16 a[176:179], a[248:251], v[232:235], a[176:179]
    buffer_load_dwordx4 a[232:235], v254, s[8:11], s42 offen offset:1024
    v_mfma_f32_16x16x32_bf16 a[156:159], a[252:255], v[232:235], a[156:159]
    v_mfma_f32_16x16x32_bf16 a[160:163], v[240:243], v[232:235], a[160:163]
    buffer_load_dwordx4 a[236:239], v254, s[8:11], s42 offen offset:2048
    v_mfma_f32_16x16x32_bf16 a[164:167], v[244:247], v[232:235], a[164:167]
    ds_read_b128 v[232:235], v253 offset:5200
    v_mfma_f32_16x16x32_bf16 a[180:183], a[240:243], v[236:239], a[180:183]
    s_waitcnt vmcnt(18)
    v_lshlrev_b32 v248, 16, v206
    v_lshlrev_b32 v249, 16, v208
    v_mfma_f32_16x16x32_bf16 a[184:187], a[244:247], v[236:239], a[184:187]
    v_lshlrev_b32 v250, 16, v210
    v_lshlrev_b32 v251, 16, v212
    v_mfma_f32_16x16x32_bf16 a[188:191], a[248:251], v[236:239], a[188:191]
    s_mov_b32 s42, 408576
    buffer_load_dwordx4 a[240:243], v254, s[8:11], s42 offen offset:0
    v_mfma_f32_16x16x32_bf16 a[168:171], a[252:255], v[236:239], a[168:171]
    v_and_b32 v206, s22, v206
    v_and_b32 v208, s22, v208
    v_mfma_f32_16x16x32_bf16 a[172:175], v[240:243], v[236:239], a[172:175]
    buffer_load_dwordx4 a[244:247], v254, s[8:11], s42 offen offset:1024
    v_and_b32 v210, s22, v210
    v_mfma_f32_16x16x32_bf16 a[176:179], v[244:247], v[236:239], a[176:179]
    ds_read_b128 v[236:239], v253 offset:4928
    s_waitcnt lgkmcnt(5)
    v_mfma_f32_16x16x32_bf16 a[180:183], a[252:255], v[228:231], a[180:183]
    buffer_load_dwordx4 a[248:251], v254, s[8:11], s42 offen offset:2048
    v_and_b32 v212, s22, v212
    v_mfma_f32_16x16x32_bf16 a[184:187], v[240:243], v[228:231], a[184:187]
    v_lshlrev_b32 v252, 16, v204
    v_mfma_f32_16x16x32_bf16 a[188:191], v[244:247], v[228:231], a[188:191]
    ds_read_b128 v[228:231], v253 offset:4672
    s_mov_b32 s42, 411648
    buffer_load_dwordx4 a[252:255], v254, s[8:11], s42 offen offset:0
    s_waitcnt vmcnt(19) lgkmcnt(2)
    v_mfma_f32_16x16x32_bf16 v[0:3], a[192:195], v[232:235], v[0:3]
    v_and_b32 v204, s22, v204
    v_add_f32 v252, v252, v251
    v_mfma_f32_16x16x32_bf16 v[4:7], a[196:199], v[232:235], v[4:7]
    buffer_load_dwordx4 v[240:243], v254, s[8:11], s42 offen offset:1024
    v_add_f32 v204, v204, v212
    v_mfma_f32_16x16x32_bf16 v[8:11], a[200:203], v[232:235], v[8:11]
    ds_read_b128 v[232:235], v253 offset:4416
    s_waitcnt lgkmcnt(2)
    v_mfma_f32_16x16x32_bf16 v[12:15], a[192:195], v[236:239], v[12:15]
    buffer_load_dwordx4 v[244:247], v254, s[8:11], s42 offen offset:2048
    v_fmac_f32 v252, s23, v249
    v_mfma_f32_16x16x32_bf16 v[16:19], a[196:199], v[236:239], v[16:19]
    v_fmac_f32 v204, s23, v208
    v_cvt_pk_bf16_f32 v204, v252, v204
    v_mfma_f32_16x16x32_bf16 v[20:23], a[200:203], v[236:239], v[20:23]
    s_waitcnt vmcnt(18)
    v_mfma_f32_16x16x32_bf16 v[0:3], a[204:207], v[236:239], v[0:3]
    v_and_b32 v203, 0x7fff, v255
    v_lshlrev_b32 v252, 16, v214
    v_mfma_f32_16x16x32_bf16 v[4:7], a[208:211], v[236:239], v[4:7]
    buffer_load_dwordx2 v[192:193], v203, s[4:7], s16 offen offset:256
    v_and_b32 v214, s22, v214
    v_mfma_f32_16x16x32_bf16 v[8:11], a[212:215], v[236:239], v[8:11]
    ds_read_b128 v[236:239], v253 offset:4160
    s_waitcnt lgkmcnt(2)
    v_mfma_f32_16x16x32_bf16 v[24:27], a[192:195], v[228:231], v[24:27]
    buffer_load_dwordx2 v[194:195], v203, s[4:7], s17 offen offset:256
    v_add_f32 v252, v252, v248
    v_mfma_f32_16x16x32_bf16 v[28:31], a[196:199], v[228:231], v[28:31]
    buffer_load_dwordx2 v[196:197], v203, s[4:7], s18 offen offset:256
    v_add_f32 v214, v214, v206
    v_mfma_f32_16x16x32_bf16 v[32:35], a[200:203], v[228:231], v[32:35]
    v_fmac_f32 v252, s23, v250
    v_mfma_f32_16x16x32_bf16 v[12:15], a[204:207], v[228:231], v[12:15]
    buffer_load_dwordx2 v[198:199], v203, s[4:7], s19 offen offset:256
    v_fmac_f32 v214, s23, v210
    v_mfma_f32_16x16x32_bf16 v[16:19], a[208:211], v[228:231], v[16:19]
    buffer_load_dwordx2 v[200:201], v203, s[4:7], s20 offen offset:256
    v_cvt_pk_bf16_f32 v214, v252, v214
    v_mfma_f32_16x16x32_bf16 v[20:23], a[212:215], v[228:231], v[20:23]
    v_fma_f32 v252, v249, s24, v251
    s_waitcnt vmcnt(20)
    v_mfma_f32_16x16x32_bf16 v[0:3], a[216:219], v[228:231], v[0:3]
    buffer_load_dwordx2 v[202:203], v203, s[4:7], s21 offen offset:256
    v_fmac_f32 v251, s25, v249
    v_mfma_f32_16x16x32_bf16 v[4:7], a[220:223], v[228:231], v[4:7]
    v_fma_f32 v249, v248, s24, v250
    v_fmac_f32 v250, s25, v248
    v_mfma_f32_16x16x32_bf16 v[8:11], a[224:227], v[228:231], v[8:11]
    ds_read_b128 v[228:231], v253 offset:5984
    s_waitcnt lgkmcnt(2)
    v_mfma_f32_16x16x32_bf16 v[36:39], a[192:195], v[232:235], v[36:39]
    v_fma_f32 v248, v250, s26, v251
    v_mfma_f32_16x16x32_bf16 v[40:43], a[196:199], v[232:235], v[40:43]
    v_fmac_f32 v251, s27, v250
    v_fma_f32 v250, v249, s28, v252
    v_mfma_f32_16x16x32_bf16 v[44:47], a[200:203], v[232:235], v[44:47]
    v_fmac_f32 v252, s29, v249
    v_fma_f32 v249, v208, s24, v212
    v_mfma_f32_16x16x32_bf16 v[24:27], a[204:207], v[232:235], v[24:27]
    v_fmac_f32 v212, s25, v208
    v_fma_f32 v208, v206, s24, v210
    v_mfma_f32_16x16x32_bf16 v[28:31], a[208:211], v[232:235], v[28:31]
    v_fmac_f32 v210, s25, v206
    v_fma_f32 v206, v210, s26, v212
    v_mfma_f32_16x16x32_bf16 v[32:35], a[212:215], v[232:235], v[32:35]
    v_fmac_f32 v212, s27, v210
    v_mfma_f32_16x16x32_bf16 v[12:15], a[216:219], v[232:235], v[12:15]
    v_fma_f32 v210, v208, s28, v249
    v_fmac_f32 v249, s29, v208
    v_mfma_f32_16x16x32_bf16 v[16:19], a[220:223], v[232:235], v[16:19]
    v_cvt_pk_bf16_f32 v206, v248, v206
    v_cvt_pk_bf16_f32 v212, v251, v212
    v_mfma_f32_16x16x32_bf16 v[20:23], a[224:227], v[232:235], v[20:23]
    ds_read_b128 v[232:235], v253 offset:5728
    s_waitcnt lgkmcnt(2)
    v_mfma_f32_16x16x32_bf16 v[48:51], a[192:195], v[236:239], v[48:51]
    v_cvt_pk_bf16_f32 v210, v250, v210
    v_cvt_pk_bf16_f32 v208, v252, v249
    v_mfma_f32_16x16x32_bf16 v[52:55], a[196:199], v[236:239], v[52:55]
    v_lshlrev_b32 v248, 16, v207
    v_lshlrev_b32 v249, 16, v209
    v_mfma_f32_16x16x32_bf16 v[56:59], a[200:203], v[236:239], v[56:59]
    v_lshlrev_b32 v250, 16, v211
    v_mfma_f32_16x16x32_bf16 v[36:39], a[204:207], v[236:239], v[36:39]
    v_lshlrev_b32 v251, 16, v213
    v_and_b32 v207, s22, v207
    v_mfma_f32_16x16x32_bf16 v[40:43], a[208:211], v[236:239], v[40:43]
    v_and_b32 v209, s22, v209
    v_and_b32 v211, s22, v211
    v_mfma_f32_16x16x32_bf16 v[44:47], a[212:215], v[236:239], v[44:47]
    v_and_b32 v213, s22, v213
    v_lshlrev_b32 v252, 16, v205
    v_mfma_f32_16x16x32_bf16 v[24:27], a[216:219], v[236:239], v[24:27]
    v_and_b32 v205, s22, v205
    v_add_f32 v252, v252, v251
    v_mfma_f32_16x16x32_bf16 v[28:31], a[220:223], v[236:239], v[28:31]
    v_add_f32 v205, v205, v213
    v_mfma_f32_16x16x32_bf16 v[32:35], a[224:227], v[236:239], v[32:35]
    ds_read_b128 v[236:239], v253 offset:5472
    s_waitcnt lgkmcnt(2)
    v_mfma_f32_16x16x32_bf16 v[60:63], a[192:195], v[228:231], v[60:63]
    v_fmac_f32 v252, s23, v249
    v_fmac_f32 v205, s23, v209
    v_mfma_f32_16x16x32_bf16 v[64:67], a[196:199], v[228:231], v[64:67]
    v_cvt_pk_bf16_f32 v205, v252, v205
    v_lshlrev_b32 v252, 16, v215
    v_mfma_f32_16x16x32_bf16 v[68:71], a[200:203], v[228:231], v[68:71]
    v_and_b32 v215, s22, v215
    v_add_f32 v252, v252, v248
    v_mfma_f32_16x16x32_bf16 v[48:51], a[204:207], v[228:231], v[48:51]
    v_add_f32 v215, v215, v207
    v_fmac_f32 v252, s23, v250
    v_mfma_f32_16x16x32_bf16 v[52:55], a[208:211], v[228:231], v[52:55]
    v_fmac_f32 v215, s23, v211
    v_cvt_pk_bf16_f32 v215, v252, v215
    v_mfma_f32_16x16x32_bf16 v[56:59], a[212:215], v[228:231], v[56:59]
    v_fma_f32 v252, v249, s24, v251
    v_mfma_f32_16x16x32_bf16 v[36:39], a[216:219], v[228:231], v[36:39]
    v_fmac_f32 v251, s25, v249
    v_fma_f32 v249, v248, s24, v250
    v_mfma_f32_16x16x32_bf16 v[40:43], a[220:223], v[228:231], v[40:43]
    v_fmac_f32 v250, s25, v248
    v_fma_f32 v248, v250, s26, v251
    v_mfma_f32_16x16x32_bf16 v[44:47], a[224:227], v[228:231], v[44:47]
    ds_read_b128 v[228:231], v253 offset:5216
    s_waitcnt lgkmcnt(2)
    v_mfma_f32_16x16x32_bf16 v[72:75], a[192:195], v[232:235], v[72:75]
    v_fmac_f32 v251, s27, v250
    v_fma_f32 v250, v249, s28, v252
    v_mfma_f32_16x16x32_bf16 v[76:79], a[196:199], v[232:235], v[76:79]
    v_fmac_f32 v252, s29, v249
    v_fma_f32 v249, v209, s24, v213
    v_mfma_f32_16x16x32_bf16 v[80:83], a[200:203], v[232:235], v[80:83]
    v_fmac_f32 v213, s25, v209
    v_mfma_f32_16x16x32_bf16 v[60:63], a[204:207], v[232:235], v[60:63]
    v_fma_f32 v209, v207, s24, v211
    v_fmac_f32 v211, s25, v207
    v_mfma_f32_16x16x32_bf16 v[64:67], a[208:211], v[232:235], v[64:67]
    v_fma_f32 v207, v211, s26, v213
    v_fmac_f32 v213, s27, v211
    v_mfma_f32_16x16x32_bf16 v[68:71], a[212:215], v[232:235], v[68:71]
    v_fma_f32 v211, v209, s28, v249
    v_fmac_f32 v249, s29, v209
    v_mfma_f32_16x16x32_bf16 v[48:51], a[216:219], v[232:235], v[48:51]
    v_cvt_pk_bf16_f32 v207, v248, v207
    v_cvt_pk_bf16_f32 v213, v251, v213
    v_mfma_f32_16x16x32_bf16 v[52:55], a[220:223], v[232:235], v[52:55]
    v_cvt_pk_bf16_f32 v211, v250, v211
    v_mfma_f32_16x16x32_bf16 v[56:59], a[224:227], v[232:235], v[56:59]
    ds_read_b128 v[232:235], v253 offset:4944
    s_waitcnt lgkmcnt(2)
    v_mfma_f32_16x16x32_bf16 v[84:87], a[192:195], v[236:239], v[84:87]
    v_cvt_pk_bf16_f32 v209, v252, v249
    v_lshrrev_b32 v252, 15, v255
    v_mfma_f32_16x16x32_bf16 v[88:91], a[196:199], v[236:239], v[88:91]
    ds_write_b64 v252, v[206:207] offset:8576
    ds_write_b64 v252, v[212:213] offset:10656
    v_mfma_f32_16x16x32_bf16 v[92:95], a[200:203], v[236:239], v[92:95]
    ds_write_b64 v252, v[210:211] offset:12736
    ds_write_b64 v252, v[204:205] offset:18976
    v_mfma_f32_16x16x32_bf16 v[72:75], a[204:207], v[236:239], v[72:75]
    s_mov_b32 s42, 442368
    buffer_load_dwordx4 a[192:195], v254, s[8:11], s42 offen offset:0
    v_mfma_f32_16x16x32_bf16 v[76:79], a[208:211], v[236:239], v[76:79]
    ds_write_b64 v252, v[214:215] offset:25216
    ds_write_b64 v252, v[208:209] offset:29376
    v_mfma_f32_16x16x32_bf16 v[80:83], a[212:215], v[236:239], v[80:83]
    buffer_load_dwordx4 a[196:199], v254, s[8:11], s42 offen offset:1024
    v_mfma_f32_16x16x32_bf16 v[60:63], a[216:219], v[236:239], v[60:63]
    v_mfma_f32_16x16x32_bf16 v[64:67], a[220:223], v[236:239], v[64:67]
    buffer_load_dwordx4 a[200:203], v254, s[8:11], s42 offen offset:2048
    v_mfma_f32_16x16x32_bf16 v[68:71], a[224:227], v[236:239], v[68:71]
    ds_read_b128 v[236:239], v253 offset:7280
    s_waitcnt lgkmcnt(8)
    v_mfma_f32_16x16x32_bf16 v[84:87], a[204:207], v[228:231], v[84:87]
    s_waitcnt vmcnt(18)
    v_lshlrev_b32 v248, 16, v218
    v_lshlrev_b32 v249, 16, v220
    v_mfma_f32_16x16x32_bf16 v[88:91], a[208:211], v[228:231], v[88:91]
    v_lshlrev_b32 v250, 16, v222
    v_lshlrev_b32 v251, 16, v224
    v_mfma_f32_16x16x32_bf16 v[92:95], a[212:215], v[228:231], v[92:95]
    s_mov_b32 s42, 445440
    buffer_load_dwordx4 a[204:207], v254, s[8:11], s42 offen offset:0
    v_mfma_f32_16x16x32_bf16 v[72:75], a[216:219], v[228:231], v[72:75]
    v_and_b32 v218, s22, v218
    v_and_b32 v220, s22, v220
    v_mfma_f32_16x16x32_bf16 v[76:79], a[220:223], v[228:231], v[76:79]
    buffer_load_dwordx4 a[208:211], v254, s[8:11], s42 offen offset:1024
    v_and_b32 v222, s22, v222
    v_mfma_f32_16x16x32_bf16 v[80:83], a[224:227], v[228:231], v[80:83]
    ds_read_b128 v[228:231], v253 offset:7008
    s_waitcnt lgkmcnt(8)
    v_mfma_f32_16x16x32_bf16 v[84:87], a[216:219], v[232:235], v[84:87]
    buffer_load_dwordx4 a[212:215], v254, s[8:11], s42 offen offset:2048
    v_and_b32 v224, s22, v224
    v_mfma_f32_16x16x32_bf16 v[88:91], a[220:223], v[232:235], v[88:91]
    v_lshlrev_b32 v252, 16, v216
    v_mfma_f32_16x16x32_bf16 v[92:95], a[224:227], v[232:235], v[92:95]
    ds_read_b128 v[232:235], v253 offset:6752
    s_mov_b32 s42, 448512
    buffer_load_dwordx4 a[216:219], v254, s[8:11], s42 offen offset:0
    s_waitcnt vmcnt(19) lgkmcnt(2)
    v_mfma_f32_16x16x32_bf16 v[96:99], a[228:231], v[236:239], v[96:99]
    v_and_b32 v216, s22, v216
    v_add_f32 v252, v252, v251
    v_mfma_f32_16x16x32_bf16 v[100:103], a[232:235], v[236:239], v[100:103]
    buffer_load_dwordx4 a[220:223], v254, s[8:11], s42 offen offset:1024
    v_add_f32 v216, v216, v224
    v_mfma_f32_16x16x32_bf16 v[104:107], a[236:239], v[236:239], v[104:107]
    ds_read_b128 v[236:239], v253 offset:6496
    s_waitcnt lgkmcnt(2)
    v_mfma_f32_16x16x32_bf16 v[108:111], a[228:231], v[228:231], v[108:111]
    buffer_load_dwordx4 a[224:227], v254, s[8:11], s42 offen offset:2048
    v_fmac_f32 v252, s23, v249
    v_mfma_f32_16x16x32_bf16 v[112:115], a[232:235], v[228:231], v[112:115]
    v_fmac_f32 v216, s23, v220
    v_cvt_pk_bf16_f32 v216, v252, v216
    v_mfma_f32_16x16x32_bf16 v[116:119], a[236:239], v[228:231], v[116:119]
    s_waitcnt vmcnt(18)
    v_mfma_f32_16x16x32_bf16 v[96:99], a[240:243], v[228:231], v[96:99]
    v_and_b32 v215, 0x7fff, v255
    v_lshlrev_b32 v252, 16, v226
    v_mfma_f32_16x16x32_bf16 v[100:103], a[244:247], v[228:231], v[100:103]
    buffer_load_dwordx2 v[204:205], v215, s[4:7], s16 offen offset:640
    v_and_b32 v226, s22, v226
    v_mfma_f32_16x16x32_bf16 v[104:107], a[248:251], v[228:231], v[104:107]
    ds_read_b128 v[228:231], v253 offset:6240
    s_waitcnt lgkmcnt(2)
    v_mfma_f32_16x16x32_bf16 v[120:123], a[228:231], v[232:235], v[120:123]
    buffer_load_dwordx2 v[206:207], v215, s[4:7], s17 offen offset:640
    v_add_f32 v252, v252, v248
    v_mfma_f32_16x16x32_bf16 v[124:127], a[232:235], v[232:235], v[124:127]
    buffer_load_dwordx2 v[208:209], v215, s[4:7], s18 offen offset:640
    v_add_f32 v226, v226, v218
    v_mfma_f32_16x16x32_bf16 v[128:131], a[236:239], v[232:235], v[128:131]
    v_fmac_f32 v252, s23, v250
    v_mfma_f32_16x16x32_bf16 v[108:111], a[240:243], v[232:235], v[108:111]
    buffer_load_dwordx2 v[210:211], v215, s[4:7], s19 offen offset:640
    v_fmac_f32 v226, s23, v222
    v_mfma_f32_16x16x32_bf16 v[112:115], a[244:247], v[232:235], v[112:115]
    buffer_load_dwordx2 v[212:213], v215, s[4:7], s20 offen offset:640
    v_cvt_pk_bf16_f32 v226, v252, v226
    v_mfma_f32_16x16x32_bf16 v[116:119], a[248:251], v[232:235], v[116:119]
    v_fma_f32 v252, v249, s24, v251
    s_waitcnt vmcnt(20)
    v_mfma_f32_16x16x32_bf16 v[96:99], a[252:255], v[232:235], v[96:99]
    buffer_load_dwordx2 v[214:215], v215, s[4:7], s21 offen offset:640
    v_fmac_f32 v251, s25, v249
    v_mfma_f32_16x16x32_bf16 v[100:103], v[240:243], v[232:235], v[100:103]
    v_fma_f32 v249, v248, s24, v250
    v_fmac_f32 v250, s25, v248
    v_mfma_f32_16x16x32_bf16 v[104:107], v[244:247], v[232:235], v[104:107]
    ds_read_b128 v[232:235], v253 offset:8064
    s_waitcnt lgkmcnt(2)
    v_mfma_f32_16x16x32_bf16 v[132:135], a[228:231], v[236:239], v[132:135]
    v_fma_f32 v248, v250, s26, v251
    v_mfma_f32_16x16x32_bf16 v[136:139], a[232:235], v[236:239], v[136:139]
    v_fmac_f32 v251, s27, v250
    v_fma_f32 v250, v249, s28, v252
    v_mfma_f32_16x16x32_bf16 v[140:143], a[236:239], v[236:239], v[140:143]
    v_fmac_f32 v252, s29, v249
    v_fma_f32 v249, v220, s24, v224
    v_mfma_f32_16x16x32_bf16 v[120:123], a[240:243], v[236:239], v[120:123]
    v_fmac_f32 v224, s25, v220
    v_fma_f32 v220, v218, s24, v222
    v_mfma_f32_16x16x32_bf16 v[124:127], a[244:247], v[236:239], v[124:127]
    v_fmac_f32 v222, s25, v218
    v_fma_f32 v218, v222, s26, v224
    v_mfma_f32_16x16x32_bf16 v[128:131], a[248:251], v[236:239], v[128:131]
    v_fmac_f32 v224, s27, v222
    v_mfma_f32_16x16x32_bf16 v[108:111], a[252:255], v[236:239], v[108:111]
    v_fma_f32 v222, v220, s28, v249
    v_fmac_f32 v249, s29, v220
    v_mfma_f32_16x16x32_bf16 v[112:115], v[240:243], v[236:239], v[112:115]
    v_cvt_pk_bf16_f32 v218, v248, v218
    v_cvt_pk_bf16_f32 v224, v251, v224
    v_mfma_f32_16x16x32_bf16 v[116:119], v[244:247], v[236:239], v[116:119]
    ds_read_b128 v[236:239], v253 offset:7808
    s_waitcnt lgkmcnt(2)
    v_mfma_f32_16x16x32_bf16 v[144:147], a[228:231], v[228:231], v[144:147]
    v_cvt_pk_bf16_f32 v222, v250, v222
    v_cvt_pk_bf16_f32 v220, v252, v249
    v_mfma_f32_16x16x32_bf16 v[148:151], a[232:235], v[228:231], v[148:151]
    v_lshlrev_b32 v248, 16, v219
    v_lshlrev_b32 v249, 16, v221
    v_mfma_f32_16x16x32_bf16 v[152:155], a[236:239], v[228:231], v[152:155]
    v_lshlrev_b32 v250, 16, v223
    v_mfma_f32_16x16x32_bf16 v[132:135], a[240:243], v[228:231], v[132:135]
    v_lshlrev_b32 v251, 16, v225
    v_and_b32 v219, s22, v219
    v_mfma_f32_16x16x32_bf16 v[136:139], a[244:247], v[228:231], v[136:139]
    v_and_b32 v221, s22, v221
    v_and_b32 v223, s22, v223
    v_mfma_f32_16x16x32_bf16 v[140:143], a[248:251], v[228:231], v[140:143]
    v_and_b32 v225, s22, v225
    v_lshlrev_b32 v252, 16, v217
    v_mfma_f32_16x16x32_bf16 v[120:123], a[252:255], v[228:231], v[120:123]
    v_and_b32 v217, s22, v217
    v_add_f32 v252, v252, v251
    v_mfma_f32_16x16x32_bf16 v[124:127], v[240:243], v[228:231], v[124:127]
    v_add_f32 v217, v217, v225
    v_mfma_f32_16x16x32_bf16 v[128:131], v[244:247], v[228:231], v[128:131]
    ds_read_b128 v[228:231], v253 offset:7552
    s_waitcnt lgkmcnt(2)
    v_mfma_f32_16x16x32_bf16 v[156:159], a[228:231], v[232:235], v[156:159]
    v_fmac_f32 v252, s23, v249
    v_fmac_f32 v217, s23, v221
    v_mfma_f32_16x16x32_bf16 v[160:163], a[232:235], v[232:235], v[160:163]
    v_cvt_pk_bf16_f32 v217, v252, v217
    v_lshlrev_b32 v252, 16, v227
    v_mfma_f32_16x16x32_bf16 v[164:167], a[236:239], v[232:235], v[164:167]
    v_and_b32 v227, s22, v227
    v_add_f32 v252, v252, v248
    v_mfma_f32_16x16x32_bf16 v[144:147], a[240:243], v[232:235], v[144:147]
    v_add_f32 v227, v227, v219
    v_fmac_f32 v252, s23, v250
    v_mfma_f32_16x16x32_bf16 v[148:151], a[244:247], v[232:235], v[148:151]
    v_fmac_f32 v227, s23, v223
    v_cvt_pk_bf16_f32 v227, v252, v227
    v_mfma_f32_16x16x32_bf16 v[152:155], a[248:251], v[232:235], v[152:155]
    v_fma_f32 v252, v249, s24, v251
    v_mfma_f32_16x16x32_bf16 v[132:135], a[252:255], v[232:235], v[132:135]
    v_fmac_f32 v251, s25, v249
    v_fma_f32 v249, v248, s24, v250
    v_mfma_f32_16x16x32_bf16 v[136:139], v[240:243], v[232:235], v[136:139]
    v_fmac_f32 v250, s25, v248
    v_fma_f32 v248, v250, s26, v251
    v_mfma_f32_16x16x32_bf16 v[140:143], v[244:247], v[232:235], v[140:143]
    ds_read_b128 v[232:235], v253 offset:7296
    s_waitcnt lgkmcnt(2)
    v_mfma_f32_16x16x32_bf16 v[168:171], a[228:231], v[236:239], v[168:171]
    v_fmac_f32 v251, s27, v250
    v_fma_f32 v250, v249, s28, v252
    v_mfma_f32_16x16x32_bf16 v[172:175], a[232:235], v[236:239], v[172:175]
    v_fmac_f32 v252, s29, v249
    v_fma_f32 v249, v221, s24, v225
    v_mfma_f32_16x16x32_bf16 v[176:179], a[236:239], v[236:239], v[176:179]
    v_fmac_f32 v225, s25, v221
    v_mfma_f32_16x16x32_bf16 v[156:159], a[240:243], v[236:239], v[156:159]
    v_fma_f32 v221, v219, s24, v223
    v_fmac_f32 v223, s25, v219
    v_mfma_f32_16x16x32_bf16 v[160:163], a[244:247], v[236:239], v[160:163]
    v_fma_f32 v219, v223, s26, v225
    v_fmac_f32 v225, s27, v223
    v_mfma_f32_16x16x32_bf16 v[164:167], a[248:251], v[236:239], v[164:167]
    v_fma_f32 v223, v221, s28, v249
    v_fmac_f32 v249, s29, v221
    v_mfma_f32_16x16x32_bf16 v[144:147], a[252:255], v[236:239], v[144:147]
    v_cvt_pk_bf16_f32 v219, v248, v219
    v_cvt_pk_bf16_f32 v225, v251, v225
    v_mfma_f32_16x16x32_bf16 v[148:151], v[240:243], v[236:239], v[148:151]
    v_cvt_pk_bf16_f32 v223, v250, v223
    v_mfma_f32_16x16x32_bf16 v[152:155], v[244:247], v[236:239], v[152:155]
    ds_read_b128 v[236:239], v253 offset:7024
    s_waitcnt lgkmcnt(2)
    v_mfma_f32_16x16x32_bf16 v[180:183], a[228:231], v[228:231], v[180:183]
    v_cvt_pk_bf16_f32 v221, v252, v249
    v_lshrrev_b32 v252, 15, v255
    v_mfma_f32_16x16x32_bf16 v[184:187], a[232:235], v[228:231], v[184:187]
    ds_write_b64 v252, v[218:219] offset:8320
    ds_write_b64 v252, v[224:225] offset:10400
    v_mfma_f32_16x16x32_bf16 v[188:191], a[236:239], v[228:231], v[188:191]
    ds_write_b64 v252, v[222:223] offset:12480
    ds_write_b64 v252, v[216:217] offset:18720
    v_mfma_f32_16x16x32_bf16 v[168:171], a[240:243], v[228:231], v[168:171]
    s_mov_b32 s42, 479232
    buffer_load_dwordx4 a[228:231], v254, s[8:11], s42 offen offset:0
    v_mfma_f32_16x16x32_bf16 v[172:175], a[244:247], v[228:231], v[172:175]
    ds_write_b64 v252, v[226:227] offset:24960
    ds_write_b64 v252, v[220:221] offset:29120
    v_mfma_f32_16x16x32_bf16 v[176:179], a[248:251], v[228:231], v[176:179]
    buffer_load_dwordx4 a[232:235], v254, s[8:11], s42 offen offset:1024
    v_mfma_f32_16x16x32_bf16 v[156:159], a[252:255], v[228:231], v[156:159]
    v_mfma_f32_16x16x32_bf16 v[160:163], v[240:243], v[228:231], v[160:163]
    buffer_load_dwordx4 a[236:239], v254, s[8:11], s42 offen offset:2048
    v_mfma_f32_16x16x32_bf16 v[164:167], v[244:247], v[228:231], v[164:167]
    s_waitcnt lgkmcnt(0)
    s_barrier
    ds_read_b128 v[228:231], v253 offset:9360
    v_mfma_f32_16x16x32_bf16 v[180:183], a[240:243], v[232:235], v[180:183]
    s_waitcnt vmcnt(18)
    v_lshlrev_b32 v248, 16, v194
    v_lshlrev_b32 v249, 16, v196
    v_mfma_f32_16x16x32_bf16 v[184:187], a[244:247], v[232:235], v[184:187]
    v_lshlrev_b32 v250, 16, v198
    v_lshlrev_b32 v251, 16, v200
    v_mfma_f32_16x16x32_bf16 v[188:191], a[248:251], v[232:235], v[188:191]
    s_mov_b32 s42, 482304
    buffer_load_dwordx4 a[240:243], v254, s[8:11], s42 offen offset:0
    v_mfma_f32_16x16x32_bf16 v[168:171], a[252:255], v[232:235], v[168:171]
    v_and_b32 v194, s22, v194
    v_and_b32 v196, s22, v196
    v_mfma_f32_16x16x32_bf16 v[172:175], v[240:243], v[232:235], v[172:175]
    buffer_load_dwordx4 a[244:247], v254, s[8:11], s42 offen offset:1024
    v_and_b32 v198, s22, v198
    v_mfma_f32_16x16x32_bf16 v[176:179], v[244:247], v[232:235], v[176:179]
    ds_read_b128 v[232:235], v253 offset:9088
    v_mfma_f32_16x16x32_bf16 v[180:183], a[252:255], v[236:239], v[180:183]
    buffer_load_dwordx4 a[248:251], v254, s[8:11], s42 offen offset:2048
    v_and_b32 v200, s22, v200
    v_mfma_f32_16x16x32_bf16 v[184:187], v[240:243], v[236:239], v[184:187]
    v_lshlrev_b32 v252, 16, v192
    v_mfma_f32_16x16x32_bf16 v[188:191], v[244:247], v[236:239], v[188:191]
    ds_read_b128 v[236:239], v253 offset:8832
    s_mov_b32 s42, 485376
    buffer_load_dwordx4 a[252:255], v254, s[8:11], s42 offen offset:0
    s_waitcnt vmcnt(19) lgkmcnt(2)
    v_mfma_f32_16x16x32_bf16 a[0:3], a[192:195], v[228:231], a[0:3]
    v_and_b32 v192, s22, v192
    v_add_f32 v252, v252, v251
    v_mfma_f32_16x16x32_bf16 a[4:7], a[196:199], v[228:231], a[4:7]
    buffer_load_dwordx4 v[240:243], v254, s[8:11], s42 offen offset:1024
    v_add_f32 v192, v192, v200
    v_mfma_f32_16x16x32_bf16 a[8:11], a[200:203], v[228:231], a[8:11]
    ds_read_b128 v[228:231], v253 offset:8576
    s_waitcnt lgkmcnt(2)
    v_mfma_f32_16x16x32_bf16 a[12:15], a[192:195], v[232:235], a[12:15]
    buffer_load_dwordx4 v[244:247], v254, s[8:11], s42 offen offset:2048
    v_fmac_f32 v252, s23, v249
    v_mfma_f32_16x16x32_bf16 a[16:19], a[196:199], v[232:235], a[16:19]
    v_fmac_f32 v192, s23, v196
    v_cvt_pk_bf16_f32 v192, v252, v192
    v_mfma_f32_16x16x32_bf16 a[20:23], a[200:203], v[232:235], a[20:23]
    s_waitcnt vmcnt(18)
    v_mfma_f32_16x16x32_bf16 a[0:3], a[204:207], v[232:235], a[0:3]
    v_and_b32 v227, 0x7fff, v255
    v_lshlrev_b32 v252, 16, v202
    v_mfma_f32_16x16x32_bf16 a[4:7], a[208:211], v[232:235], a[4:7]
    buffer_load_dwordx2 v[216:217], v227, s[4:7], s16 offen offset:1024
    v_and_b32 v202, s22, v202
    v_mfma_f32_16x16x32_bf16 a[8:11], a[212:215], v[232:235], a[8:11]
    ds_read_b128 v[232:235], v253 offset:8320
    s_waitcnt lgkmcnt(2)
    v_mfma_f32_16x16x32_bf16 a[24:27], a[192:195], v[236:239], a[24:27]
    buffer_load_dwordx2 v[218:219], v227, s[4:7], s17 offen offset:1024
    v_add_f32 v252, v252, v248
    v_mfma_f32_16x16x32_bf16 a[28:31], a[196:199], v[236:239], a[28:31]
    buffer_load_dwordx2 v[220:221], v227, s[4:7], s18 offen offset:1024
    v_add_f32 v202, v202, v194
    v_mfma_f32_16x16x32_bf16 a[32:35], a[200:203], v[236:239], a[32:35]
    v_fmac_f32 v252, s23, v250
    v_mfma_f32_16x16x32_bf16 a[12:15], a[204:207], v[236:239], a[12:15]
    buffer_load_dwordx2 v[222:223], v227, s[4:7], s19 offen offset:1024
    v_fmac_f32 v202, s23, v198
    v_mfma_f32_16x16x32_bf16 a[16:19], a[208:211], v[236:239], a[16:19]
    buffer_load_dwordx2 v[224:225], v227, s[4:7], s20 offen offset:1024
    v_cvt_pk_bf16_f32 v202, v252, v202
    v_mfma_f32_16x16x32_bf16 a[20:23], a[212:215], v[236:239], a[20:23]
    v_fma_f32 v252, v249, s24, v251
    s_waitcnt vmcnt(20)
    v_mfma_f32_16x16x32_bf16 a[0:3], a[216:219], v[236:239], a[0:3]
    buffer_load_dwordx2 v[226:227], v227, s[4:7], s21 offen offset:1024
    v_fmac_f32 v251, s25, v249
    v_mfma_f32_16x16x32_bf16 a[4:7], a[220:223], v[236:239], a[4:7]
    v_fma_f32 v249, v248, s24, v250
    v_fmac_f32 v250, s25, v248
    v_mfma_f32_16x16x32_bf16 a[8:11], a[224:227], v[236:239], a[8:11]
    ds_read_b128 v[236:239], v253 offset:10144
    s_waitcnt lgkmcnt(2)
    v_mfma_f32_16x16x32_bf16 a[36:39], a[192:195], v[228:231], a[36:39]
    v_fma_f32 v248, v250, s26, v251
    v_mfma_f32_16x16x32_bf16 a[40:43], a[196:199], v[228:231], a[40:43]
    v_fmac_f32 v251, s27, v250
    v_fma_f32 v250, v249, s28, v252
    v_mfma_f32_16x16x32_bf16 a[44:47], a[200:203], v[228:231], a[44:47]
    v_fmac_f32 v252, s29, v249
    v_fma_f32 v249, v196, s24, v200
    v_mfma_f32_16x16x32_bf16 a[24:27], a[204:207], v[228:231], a[24:27]
    v_fmac_f32 v200, s25, v196
    v_fma_f32 v196, v194, s24, v198
    v_mfma_f32_16x16x32_bf16 a[28:31], a[208:211], v[228:231], a[28:31]
    v_fmac_f32 v198, s25, v194
    v_fma_f32 v194, v198, s26, v200
    v_mfma_f32_16x16x32_bf16 a[32:35], a[212:215], v[228:231], a[32:35]
    v_fmac_f32 v200, s27, v198
    v_mfma_f32_16x16x32_bf16 a[12:15], a[216:219], v[228:231], a[12:15]
    v_fma_f32 v198, v196, s28, v249
    v_fmac_f32 v249, s29, v196
    v_mfma_f32_16x16x32_bf16 a[16:19], a[220:223], v[228:231], a[16:19]
    v_cvt_pk_bf16_f32 v194, v248, v194
    v_cvt_pk_bf16_f32 v200, v251, v200
    v_mfma_f32_16x16x32_bf16 a[20:23], a[224:227], v[228:231], a[20:23]
    ds_read_b128 v[228:231], v253 offset:9888
    s_waitcnt lgkmcnt(2)
    v_mfma_f32_16x16x32_bf16 a[48:51], a[192:195], v[232:235], a[48:51]
    v_cvt_pk_bf16_f32 v198, v250, v198
    v_cvt_pk_bf16_f32 v196, v252, v249
    v_mfma_f32_16x16x32_bf16 a[52:55], a[196:199], v[232:235], a[52:55]
    v_lshlrev_b32 v248, 16, v195
    v_lshlrev_b32 v249, 16, v197
    v_mfma_f32_16x16x32_bf16 a[56:59], a[200:203], v[232:235], a[56:59]
    v_lshlrev_b32 v250, 16, v199
    v_mfma_f32_16x16x32_bf16 a[36:39], a[204:207], v[232:235], a[36:39]
    v_lshlrev_b32 v251, 16, v201
    v_and_b32 v195, s22, v195
    v_mfma_f32_16x16x32_bf16 a[40:43], a[208:211], v[232:235], a[40:43]
    v_and_b32 v197, s22, v197
    v_and_b32 v199, s22, v199
    v_mfma_f32_16x16x32_bf16 a[44:47], a[212:215], v[232:235], a[44:47]
    v_and_b32 v201, s22, v201
    v_lshlrev_b32 v252, 16, v193
    v_mfma_f32_16x16x32_bf16 a[24:27], a[216:219], v[232:235], a[24:27]
    v_and_b32 v193, s22, v193
    v_add_f32 v252, v252, v251
    v_mfma_f32_16x16x32_bf16 a[28:31], a[220:223], v[232:235], a[28:31]
    v_add_f32 v193, v193, v201
    v_mfma_f32_16x16x32_bf16 a[32:35], a[224:227], v[232:235], a[32:35]
    ds_read_b128 v[232:235], v253 offset:9632
    s_waitcnt lgkmcnt(2)
    v_mfma_f32_16x16x32_bf16 a[60:63], a[192:195], v[236:239], a[60:63]
    v_fmac_f32 v252, s23, v249
    v_fmac_f32 v193, s23, v197
    v_mfma_f32_16x16x32_bf16 a[64:67], a[196:199], v[236:239], a[64:67]
    v_cvt_pk_bf16_f32 v193, v252, v193
    v_lshlrev_b32 v252, 16, v203
    v_mfma_f32_16x16x32_bf16 a[68:71], a[200:203], v[236:239], a[68:71]
    v_and_b32 v203, s22, v203
    v_add_f32 v252, v252, v248
    v_mfma_f32_16x16x32_bf16 a[48:51], a[204:207], v[236:239], a[48:51]
    v_add_f32 v203, v203, v195
    v_fmac_f32 v252, s23, v250
    v_mfma_f32_16x16x32_bf16 a[52:55], a[208:211], v[236:239], a[52:55]
    v_fmac_f32 v203, s23, v199
    v_cvt_pk_bf16_f32 v203, v252, v203
    v_mfma_f32_16x16x32_bf16 a[56:59], a[212:215], v[236:239], a[56:59]
    v_fma_f32 v252, v249, s24, v251
    v_mfma_f32_16x16x32_bf16 a[36:39], a[216:219], v[236:239], a[36:39]
    v_fmac_f32 v251, s25, v249
    v_fma_f32 v249, v248, s24, v250
    v_mfma_f32_16x16x32_bf16 a[40:43], a[220:223], v[236:239], a[40:43]
    v_fmac_f32 v250, s25, v248
    v_fma_f32 v248, v250, s26, v251
    v_mfma_f32_16x16x32_bf16 a[44:47], a[224:227], v[236:239], a[44:47]
    ds_read_b128 v[236:239], v253 offset:9376
    s_waitcnt lgkmcnt(2)
    v_mfma_f32_16x16x32_bf16 a[72:75], a[192:195], v[228:231], a[72:75]
    v_fmac_f32 v251, s27, v250
    v_fma_f32 v250, v249, s28, v252
    v_mfma_f32_16x16x32_bf16 a[76:79], a[196:199], v[228:231], a[76:79]
    v_fmac_f32 v252, s29, v249
    v_fma_f32 v249, v197, s24, v201
    v_mfma_f32_16x16x32_bf16 a[80:83], a[200:203], v[228:231], a[80:83]
    v_fmac_f32 v201, s25, v197
    v_mfma_f32_16x16x32_bf16 a[60:63], a[204:207], v[228:231], a[60:63]
    v_fma_f32 v197, v195, s24, v199
    v_fmac_f32 v199, s25, v195
    v_mfma_f32_16x16x32_bf16 a[64:67], a[208:211], v[228:231], a[64:67]
    v_fma_f32 v195, v199, s26, v201
    v_fmac_f32 v201, s27, v199
    v_mfma_f32_16x16x32_bf16 a[68:71], a[212:215], v[228:231], a[68:71]
    v_fma_f32 v199, v197, s28, v249
    v_fmac_f32 v249, s29, v197
    v_mfma_f32_16x16x32_bf16 a[48:51], a[216:219], v[228:231], a[48:51]
    v_cvt_pk_bf16_f32 v195, v248, v195
    v_cvt_pk_bf16_f32 v201, v251, v201
    v_mfma_f32_16x16x32_bf16 a[52:55], a[220:223], v[228:231], a[52:55]
    v_cvt_pk_bf16_f32 v199, v250, v199
    v_mfma_f32_16x16x32_bf16 a[56:59], a[224:227], v[228:231], a[56:59]
    ds_read_b128 v[228:231], v253 offset:9104
    s_waitcnt lgkmcnt(2)
    v_mfma_f32_16x16x32_bf16 a[84:87], a[192:195], v[232:235], a[84:87]
    v_cvt_pk_bf16_f32 v197, v252, v249
    v_lshrrev_b32 v252, 15, v255
    v_mfma_f32_16x16x32_bf16 a[88:91], a[196:199], v[232:235], a[88:91]
    ds_write_b64 v252, v[194:195] offset:768
    ds_write_b64 v252, v[200:201] offset:2848
    v_mfma_f32_16x16x32_bf16 a[92:95], a[200:203], v[232:235], a[92:95]
    ds_write_b64 v252, v[198:199] offset:4928
    ds_write_b64 v252, v[192:193] offset:17408
    v_mfma_f32_16x16x32_bf16 a[72:75], a[204:207], v[232:235], a[72:75]
    s_mov_b32 s42, 516096
    buffer_load_dwordx4 a[192:195], v254, s[8:11], s42 offen offset:0
    v_mfma_f32_16x16x32_bf16 a[76:79], a[208:211], v[232:235], a[76:79]
    ds_write_b64 v252, v[202:203] offset:27808
    ds_write_b64 v252, v[196:197] offset:7008
    v_mfma_f32_16x16x32_bf16 a[80:83], a[212:215], v[232:235], a[80:83]
    buffer_load_dwordx4 a[196:199], v254, s[8:11], s42 offen offset:1024
    v_mfma_f32_16x16x32_bf16 a[60:63], a[216:219], v[232:235], a[60:63]
    v_mfma_f32_16x16x32_bf16 a[64:67], a[220:223], v[232:235], a[64:67]
    buffer_load_dwordx4 a[200:203], v254, s[8:11], s42 offen offset:2048
    v_mfma_f32_16x16x32_bf16 a[68:71], a[224:227], v[232:235], a[68:71]
    ds_read_b128 v[232:235], v253 offset:11440
    s_waitcnt lgkmcnt(8)
    v_mfma_f32_16x16x32_bf16 a[84:87], a[204:207], v[236:239], a[84:87]
    s_waitcnt vmcnt(18)
    v_lshlrev_b32 v248, 16, v206
    v_lshlrev_b32 v249, 16, v208
    v_lshlrev_b32 v250, 16, v210
    v_mfma_f32_16x16x32_bf16 a[88:91], a[208:211], v[236:239], a[88:91]
    v_lshlrev_b32 v251, 16, v212
    v_and_b32 v206, s22, v206
    v_mfma_f32_16x16x32_bf16 a[92:95], a[212:215], v[236:239], a[92:95]
    s_mov_b32 s42, 519168
    buffer_load_dwordx4 a[204:207], v254, s[8:11], s42 offen offset:0
    v_mfma_f32_16x16x32_bf16 a[72:75], a[216:219], v[236:239], a[72:75]
    v_and_b32 v208, s22, v208
    v_and_b32 v210, s22, v210
    v_mfma_f32_16x16x32_bf16 a[76:79], a[220:223], v[236:239], a[76:79]
    buffer_load_dwordx4 a[208:211], v254, s[8:11], s42 offen offset:1024
    v_and_b32 v212, s22, v212
    v_mfma_f32_16x16x32_bf16 a[80:83], a[224:227], v[236:239], a[80:83]
    ds_read_b128 v[236:239], v253 offset:11168
    s_waitcnt lgkmcnt(8)
    v_mfma_f32_16x16x32_bf16 a[84:87], a[216:219], v[228:231], a[84:87]
    buffer_load_dwordx4 a[212:215], v254, s[8:11], s42 offen offset:2048
    v_lshlrev_b32 v252, 16, v204
    v_mfma_f32_16x16x32_bf16 a[88:91], a[220:223], v[228:231], a[88:91]
    v_and_b32 v204, s22, v204
    v_add_f32 v252, v252, v251
    v_mfma_f32_16x16x32_bf16 a[92:95], a[224:227], v[228:231], a[92:95]
    ds_read_b128 v[228:231], v253 offset:10912
    s_mov_b32 s42, 522240
    buffer_load_dwordx4 a[216:219], v254, s[8:11], s42 offen offset:0
    s_waitcnt vmcnt(19) lgkmcnt(2)
    v_mfma_f32_16x16x32_bf16 a[96:99], a[228:231], v[232:235], a[96:99]
    v_add_f32 v204, v204, v212
    v_fmac_f32 v252, s23, v249
    v_fmac_f32 v204, s23, v208
    v_mfma_f32_16x16x32_bf16 a[100:103], a[232:235], v[232:235], a[100:103]
    buffer_load_dwordx4 a[220:223], v254, s[8:11], s42 offen offset:1024
    v_cvt_pk_bf16_f32 v204, v252, v204
    v_mfma_f32_16x16x32_bf16 a[104:107], a[236:239], v[232:235], a[104:107]
    ds_read_b128 v[232:235], v253 offset:10656
    s_waitcnt lgkmcnt(2)
    v_mfma_f32_16x16x32_bf16 a[108:111], a[228:231], v[236:239], a[108:111]
    buffer_load_dwordx4 a[224:227], v254, s[8:11], s42 offen offset:2048
    v_lshlrev_b32 v252, 16, v214
    v_mfma_f32_16x16x32_bf16 a[112:115], a[232:235], v[236:239], a[112:115]
    v_and_b32 v214, s22, v214
    v_add_f32 v252, v252, v248
    v_mfma_f32_16x16x32_bf16 a[116:119], a[236:239], v[236:239], a[116:119]
    v_add_f32 v214, v214, v206
    s_waitcnt vmcnt(18)
    v_mfma_f32_16x16x32_bf16 a[96:99], a[240:243], v[236:239], a[96:99]
    v_and_b32 v203, 0x7fff, v255
    v_fmac_f32 v252, s23, v250
    v_mfma_f32_16x16x32_bf16 a[100:103], a[244:247], v[236:239], a[100:103]
    buffer_load_dwordx2 v[192:193], v203, s[4:7], s16 offen offset:1408
    v_fmac_f32 v214, s23, v210
    v_mfma_f32_16x16x32_bf16 a[104:107], a[248:251], v[236:239], a[104:107]
    ds_read_b128 v[236:239], v253 offset:10400
    s_waitcnt lgkmcnt(2)
    v_mfma_f32_16x16x32_bf16 a[120:123], a[228:231], v[228:231], a[120:123]
    buffer_load_dwordx2 v[194:195], v203, s[4:7], s17 offen offset:1408
    v_cvt_pk_bf16_f32 v214, v252, v214
    v_fma_f32 v252, v249, s24, v251
    v_mfma_f32_16x16x32_bf16 a[124:127], a[232:235], v[228:231], a[124:127]
    buffer_load_dwordx2 v[196:197], v203, s[4:7], s18 offen offset:1408
    v_fmac_f32 v251, s25, v249
    v_mfma_f32_16x16x32_bf16 a[128:131], a[236:239], v[228:231], a[128:131]
    v_fma_f32 v249, v248, s24, v250
    v_fmac_f32 v250, s25, v248
    v_mfma_f32_16x16x32_bf16 a[108:111], a[240:243], v[228:231], a[108:111]
    buffer_load_dwordx2 v[198:199], v203, s[4:7], s19 offen offset:1408
    v_fma_f32 v248, v250, s26, v251
    v_mfma_f32_16x16x32_bf16 a[112:115], a[244:247], v[228:231], a[112:115]
    buffer_load_dwordx2 v[200:201], v203, s[4:7], s20 offen offset:1408
    v_fmac_f32 v251, s27, v250
    v_mfma_f32_16x16x32_bf16 a[116:119], a[248:251], v[228:231], a[116:119]
    v_fma_f32 v250, v249, s28, v252
    s_waitcnt vmcnt(20)
    v_mfma_f32_16x16x32_bf16 a[96:99], a[252:255], v[228:231], a[96:99]
    buffer_load_dwordx2 v[202:203], v203, s[4:7], s21 offen offset:1408
    v_fmac_f32 v252, s29, v249
    v_mfma_f32_16x16x32_bf16 a[100:103], v[240:243], v[228:231], a[100:103]
    v_fma_f32 v249, v208, s24, v212
    v_fmac_f32 v212, s25, v208
    v_mfma_f32_16x16x32_bf16 a[104:107], v[244:247], v[228:231], a[104:107]
    ds_read_b128 v[228:231], v253 offset:12224
    v_fma_f32 v208, v206, s24, v210
    s_waitcnt lgkmcnt(2)
    v_mfma_f32_16x16x32_bf16 a[132:135], a[228:231], v[232:235], a[132:135]
    v_fmac_f32 v210, s25, v206
    v_fma_f32 v206, v210, s26, v212
    v_mfma_f32_16x16x32_bf16 a[136:139], a[232:235], v[232:235], a[136:139]
    v_fmac_f32 v212, s27, v210
    v_fma_f32 v210, v208, s28, v249
    v_mfma_f32_16x16x32_bf16 a[140:143], a[236:239], v[232:235], a[140:143]
    v_fmac_f32 v249, s29, v208
    v_cvt_pk_bf16_f32 v206, v248, v206
    v_mfma_f32_16x16x32_bf16 a[120:123], a[240:243], v[232:235], a[120:123]
    v_cvt_pk_bf16_f32 v212, v251, v212
    v_cvt_pk_bf16_f32 v210, v250, v210
    v_mfma_f32_16x16x32_bf16 a[124:127], a[244:247], v[232:235], a[124:127]
    v_cvt_pk_bf16_f32 v208, v252, v249
    v_lshlrev_b32 v248, 16, v207
    v_mfma_f32_16x16x32_bf16 a[128:131], a[248:251], v[232:235], a[128:131]
    v_lshlrev_b32 v249, 16, v209
    v_lshlrev_b32 v250, 16, v211
    v_mfma_f32_16x16x32_bf16 a[108:111], a[252:255], v[232:235], a[108:111]
    v_lshlrev_b32 v251, 16, v213
    v_and_b32 v207, s22, v207
    v_mfma_f32_16x16x32_bf16 a[112:115], v[240:243], v[232:235], a[112:115]
    v_and_b32 v209, s22, v209
    v_and_b32 v211, s22, v211
    v_mfma_f32_16x16x32_bf16 a[116:119], v[244:247], v[232:235], a[116:119]
    ds_read_b128 v[232:235], v253 offset:11968
    v_and_b32 v213, s22, v213
    s_waitcnt lgkmcnt(2)
    v_mfma_f32_16x16x32_bf16 a[144:147], a[228:231], v[236:239], a[144:147]
    v_lshlrev_b32 v252, 16, v205
    v_and_b32 v205, s22, v205
    v_mfma_f32_16x16x32_bf16 a[148:151], a[232:235], v[236:239], a[148:151]
    v_add_f32 v252, v252, v251
    v_add_f32 v205, v205, v213
    v_mfma_f32_16x16x32_bf16 a[152:155], a[236:239], v[236:239], a[152:155]
    v_fmac_f32 v252, s23, v249
    v_fmac_f32 v205, s23, v209
    v_mfma_f32_16x16x32_bf16 a[132:135], a[240:243], v[236:239], a[132:135]
    v_cvt_pk_bf16_f32 v205, v252, v205
    v_lshlrev_b32 v252, 16, v215
    v_mfma_f32_16x16x32_bf16 a[136:139], a[244:247], v[236:239], a[136:139]
    v_and_b32 v215, s22, v215
    v_add_f32 v252, v252, v248
    v_mfma_f32_16x16x32_bf16 a[140:143], a[248:251], v[236:239], a[140:143]
    v_add_f32 v215, v215, v207
    v_fmac_f32 v252, s23, v250
    v_mfma_f32_16x16x32_bf16 a[120:123], a[252:255], v[236:239], a[120:123]
    v_fmac_f32 v215, s23, v211
    v_cvt_pk_bf16_f32 v215, v252, v215
    v_mfma_f32_16x16x32_bf16 a[124:127], v[240:243], v[236:239], a[124:127]
    v_fma_f32 v252, v249, s24, v251
    v_fmac_f32 v251, s25, v249
    v_fma_f32 v249, v248, s24, v250
    v_mfma_f32_16x16x32_bf16 a[128:131], v[244:247], v[236:239], a[128:131]
    ds_read_b128 v[236:239], v253 offset:11712
    s_waitcnt lgkmcnt(2)
    v_mfma_f32_16x16x32_bf16 a[156:159], a[228:231], v[228:231], a[156:159]
    v_fmac_f32 v250, s25, v248
    v_fma_f32 v248, v250, s26, v251
    v_mfma_f32_16x16x32_bf16 a[160:163], a[232:235], v[228:231], a[160:163]
    v_fmac_f32 v251, s27, v250
    v_fma_f32 v250, v249, s28, v252
    v_mfma_f32_16x16x32_bf16 a[164:167], a[236:239], v[228:231], a[164:167]
    v_fmac_f32 v252, s29, v249
    v_fma_f32 v249, v209, s24, v213
    v_mfma_f32_16x16x32_bf16 a[144:147], a[240:243], v[228:231], a[144:147]
    v_fmac_f32 v213, s25, v209
    v_fma_f32 v209, v207, s24, v211
    v_mfma_f32_16x16x32_bf16 a[148:151], a[244:247], v[228:231], a[148:151]
    v_fmac_f32 v211, s25, v207
    v_fma_f32 v207, v211, s26, v213
    v_mfma_f32_16x16x32_bf16 a[152:155], a[248:251], v[228:231], a[152:155]
    v_fmac_f32 v213, s27, v211
    v_fma_f32 v211, v209, s28, v249
    v_mfma_f32_16x16x32_bf16 a[132:135], a[252:255], v[228:231], a[132:135]
    v_fmac_f32 v249, s29, v209
    v_cvt_pk_bf16_f32 v207, v248, v207
    v_mfma_f32_16x16x32_bf16 a[136:139], v[240:243], v[228:231], a[136:139]
    v_cvt_pk_bf16_f32 v213, v251, v213
    v_cvt_pk_bf16_f32 v211, v250, v211
    v_cvt_pk_bf16_f32 v209, v252, v249
    v_mfma_f32_16x16x32_bf16 a[140:143], v[244:247], v[228:231], a[140:143]
    ds_read_b128 v[228:231], v253 offset:11456
    s_waitcnt lgkmcnt(2)
    v_mfma_f32_16x16x32_bf16 a[168:171], a[228:231], v[232:235], a[168:171]
    v_lshrrev_b32 v252, 15, v255
    ds_read_b128 v[248:251], v253 offset:40288
    v_mfma_f32_16x16x32_bf16 a[172:175], a[232:235], v[232:235], a[172:175]
    ds_write_b64 v252, v[206:207] offset:512
    ds_write_b64 v252, v[212:213] offset:2592
    v_mfma_f32_16x16x32_bf16 a[176:179], a[236:239], v[232:235], a[176:179]
    ds_write_b64 v252, v[210:211] offset:4672
    ds_write_b64 v252, v[204:205] offset:17152
    v_mfma_f32_16x16x32_bf16 a[156:159], a[240:243], v[232:235], a[156:159]
    ds_write_b64 v252, v[214:215] offset:27552
    ds_write_b64 v252, v[208:209] offset:6752
    v_mfma_f32_16x16x32_bf16 a[160:163], a[244:247], v[232:235], a[160:163]
    s_waitcnt lgkmcnt(6)
    s_lshl_b64 exec, s[46:47], 0
    ds_write_b128 v253, v[248:251] offset:17664
    s_mov_b64 exec, -1
    v_mfma_f32_16x16x32_bf16 a[164:167], a[248:251], v[232:235], a[164:167]
    s_lshl_b64 exec, s[46:47], 2
    ds_write_b128 v253, v[248:251] offset:992
    s_mov_b64 exec, -1
    v_mfma_f32_16x16x32_bf16 a[144:147], a[252:255], v[232:235], a[144:147]
    s_lshl_b64 exec, s[46:47], 4
    ds_write_b128 v253, v[248:251] offset:3040
    s_mov_b64 exec, -1
    v_mfma_f32_16x16x32_bf16 a[148:151], v[240:243], v[232:235], a[148:151]
    v_mfma_f32_16x16x32_bf16 a[152:155], v[244:247], v[232:235], a[152:155]
    ds_read_b128 v[232:235], v253 offset:11184
    v_mfma_f32_16x16x32_bf16 a[180:183], a[228:231], v[236:239], a[180:183]
    s_lshl_b64 exec, s[46:47], 6
    ds_write_b128 v253, v[248:251] offset:5088
    s_mov_b64 exec, -1
    v_mfma_f32_16x16x32_bf16 a[184:187], a[232:235], v[236:239], a[184:187]
    s_lshl_b64 exec, s[46:47], 8
    ds_write_b128 v253, v[248:251] offset:7136
    s_mov_b64 exec, -1
    v_mfma_f32_16x16x32_bf16 a[188:191], a[236:239], v[236:239], a[188:191]
    v_mfma_f32_16x16x32_bf16 a[168:171], a[240:243], v[236:239], a[168:171]
    s_mov_b32 s42, 552960
    buffer_load_dwordx4 a[228:231], v254, s[8:11], s42 offen offset:0
    v_mfma_f32_16x16x32_bf16 a[172:175], a[244:247], v[236:239], a[172:175]
    s_lshl_b64 exec, s[46:47], 10
    ds_write_b128 v253, v[248:251] offset:27904
    s_mov_b64 exec, -1
    v_mfma_f32_16x16x32_bf16 a[176:179], a[248:251], v[236:239], a[176:179]
    buffer_load_dwordx4 a[232:235], v254, s[8:11], s42 offen offset:1024
    v_mfma_f32_16x16x32_bf16 a[156:159], a[252:255], v[236:239], a[156:159]
    v_mfma_f32_16x16x32_bf16 a[160:163], v[240:243], v[236:239], a[160:163]
    buffer_load_dwordx4 a[236:239], v254, s[8:11], s42 offen offset:2048
    v_mfma_f32_16x16x32_bf16 a[164:167], v[244:247], v[236:239], a[164:167]
    ds_read_b128 v[236:239], v253 offset:13520
    v_mfma_f32_16x16x32_bf16 a[180:183], a[240:243], v[228:231], a[180:183]
    s_waitcnt vmcnt(18)
    v_lshlrev_b32 v248, 16, v218
    v_lshlrev_b32 v249, 16, v220
    v_mfma_f32_16x16x32_bf16 a[184:187], a[244:247], v[228:231], a[184:187]
    v_lshlrev_b32 v250, 16, v222
    v_lshlrev_b32 v251, 16, v224
    v_mfma_f32_16x16x32_bf16 a[188:191], a[248:251], v[228:231], a[188:191]
    s_mov_b32 s42, 556032
    buffer_load_dwordx4 a[240:243], v254, s[8:11], s42 offen offset:0
    v_mfma_f32_16x16x32_bf16 a[168:171], a[252:255], v[228:231], a[168:171]
    v_and_b32 v218, s22, v218
    v_and_b32 v220, s22, v220
    v_mfma_f32_16x16x32_bf16 a[172:175], v[240:243], v[228:231], a[172:175]
    buffer_load_dwordx4 a[244:247], v254, s[8:11], s42 offen offset:1024
    v_and_b32 v222, s22, v222
    v_mfma_f32_16x16x32_bf16 a[176:179], v[244:247], v[228:231], a[176:179]
    ds_read_b128 v[228:231], v253 offset:13248
    s_waitcnt lgkmcnt(5)
    v_mfma_f32_16x16x32_bf16 a[180:183], a[252:255], v[232:235], a[180:183]
    buffer_load_dwordx4 a[248:251], v254, s[8:11], s42 offen offset:2048
    v_and_b32 v224, s22, v224
    v_mfma_f32_16x16x32_bf16 a[184:187], v[240:243], v[232:235], a[184:187]
    v_lshlrev_b32 v252, 16, v216
    v_mfma_f32_16x16x32_bf16 a[188:191], v[244:247], v[232:235], a[188:191]
    ds_read_b128 v[232:235], v253 offset:12992
    s_mov_b32 s42, 559104
    buffer_load_dwordx4 a[252:255], v254, s[8:11], s42 offen offset:0
    s_waitcnt vmcnt(19) lgkmcnt(2)
    v_mfma_f32_16x16x32_bf16 v[0:3], a[192:195], v[236:239], v[0:3]
    v_and_b32 v216, s22, v216
    v_add_f32 v252, v252, v251
    v_mfma_f32_16x16x32_bf16 v[4:7], a[196:199], v[236:239], v[4:7]
    buffer_load_dwordx4 v[240:243], v254, s[8:11], s42 offen offset:1024
    v_add_f32 v216, v216, v224
    v_mfma_f32_16x16x32_bf16 v[8:11], a[200:203], v[236:239], v[8:11]
    ds_read_b128 v[236:239], v253 offset:12736
    s_waitcnt lgkmcnt(2)
    v_mfma_f32_16x16x32_bf16 v[12:15], a[192:195], v[228:231], v[12:15]
    buffer_load_dwordx4 v[244:247], v254, s[8:11], s42 offen offset:2048
    v_fmac_f32 v252, s23, v249
    v_mfma_f32_16x16x32_bf16 v[16:19], a[196:199], v[228:231], v[16:19]
    v_fmac_f32 v216, s23, v220
    v_cvt_pk_bf16_f32 v216, v252, v216
    v_mfma_f32_16x16x32_bf16 v[20:23], a[200:203], v[228:231], v[20:23]
    s_waitcnt vmcnt(18)
    v_mfma_f32_16x16x32_bf16 v[0:3], a[204:207], v[228:231], v[0:3]
    v_and_b32 v215, 0x7fff, v255
    v_lshlrev_b32 v252, 16, v226
    v_mfma_f32_16x16x32_bf16 v[4:7], a[208:211], v[228:231], v[4:7]
    buffer_load_dwordx2 v[204:205], v215, s[4:7], s16 offen offset:320
    v_and_b32 v226, s22, v226
    v_mfma_f32_16x16x32_bf16 v[8:11], a[212:215], v[228:231], v[8:11]
    ds_read_b128 v[228:231], v253 offset:12480
    s_waitcnt lgkmcnt(2)
    v_mfma_f32_16x16x32_bf16 v[24:27], a[192:195], v[232:235], v[24:27]
    buffer_load_dwordx2 v[206:207], v215, s[4:7], s17 offen offset:320
    v_add_f32 v252, v252, v248
    v_mfma_f32_16x16x32_bf16 v[28:31], a[196:199], v[232:235], v[28:31]
    buffer_load_dwordx2 v[208:209], v215, s[4:7], s18 offen offset:320
    v_add_f32 v226, v226, v218
    v_mfma_f32_16x16x32_bf16 v[32:35], a[200:203], v[232:235], v[32:35]
    v_fmac_f32 v252, s23, v250
    v_mfma_f32_16x16x32_bf16 v[12:15], a[204:207], v[232:235], v[12:15]
    buffer_load_dwordx2 v[210:211], v215, s[4:7], s19 offen offset:320
    v_fmac_f32 v226, s23, v222
    v_mfma_f32_16x16x32_bf16 v[16:19], a[208:211], v[232:235], v[16:19]
    buffer_load_dwordx2 v[212:213], v215, s[4:7], s20 offen offset:320
    v_cvt_pk_bf16_f32 v226, v252, v226
    v_mfma_f32_16x16x32_bf16 v[20:23], a[212:215], v[232:235], v[20:23]
    v_fma_f32 v252, v249, s24, v251
    s_waitcnt vmcnt(20)
    v_mfma_f32_16x16x32_bf16 v[0:3], a[216:219], v[232:235], v[0:3]
    buffer_load_dwordx2 v[214:215], v215, s[4:7], s21 offen offset:320
    v_fmac_f32 v251, s25, v249
    v_mfma_f32_16x16x32_bf16 v[4:7], a[220:223], v[232:235], v[4:7]
    v_fma_f32 v249, v248, s24, v250
    v_fmac_f32 v250, s25, v248
    v_mfma_f32_16x16x32_bf16 v[8:11], a[224:227], v[232:235], v[8:11]
    ds_read_b128 v[232:235], v253 offset:14304
    s_waitcnt lgkmcnt(2)
    v_mfma_f32_16x16x32_bf16 v[36:39], a[192:195], v[236:239], v[36:39]
    v_fma_f32 v248, v250, s26, v251
    v_mfma_f32_16x16x32_bf16 v[40:43], a[196:199], v[236:239], v[40:43]
    v_fmac_f32 v251, s27, v250
    v_fma_f32 v250, v249, s28, v252
    v_mfma_f32_16x16x32_bf16 v[44:47], a[200:203], v[236:239], v[44:47]
    v_fmac_f32 v252, s29, v249
    v_fma_f32 v249, v220, s24, v224
    v_mfma_f32_16x16x32_bf16 v[24:27], a[204:207], v[236:239], v[24:27]
    v_fmac_f32 v224, s25, v220
    v_fma_f32 v220, v218, s24, v222
    v_mfma_f32_16x16x32_bf16 v[28:31], a[208:211], v[236:239], v[28:31]
    v_fmac_f32 v222, s25, v218
    v_fma_f32 v218, v222, s26, v224
    v_mfma_f32_16x16x32_bf16 v[32:35], a[212:215], v[236:239], v[32:35]
    v_fmac_f32 v224, s27, v222
    v_mfma_f32_16x16x32_bf16 v[12:15], a[216:219], v[236:239], v[12:15]
    v_fma_f32 v222, v220, s28, v249
    v_fmac_f32 v249, s29, v220
    v_mfma_f32_16x16x32_bf16 v[16:19], a[220:223], v[236:239], v[16:19]
    v_cvt_pk_bf16_f32 v218, v248, v218
    v_cvt_pk_bf16_f32 v224, v251, v224
    v_mfma_f32_16x16x32_bf16 v[20:23], a[224:227], v[236:239], v[20:23]
    ds_read_b128 v[236:239], v253 offset:14048
    s_waitcnt lgkmcnt(2)
    v_mfma_f32_16x16x32_bf16 v[48:51], a[192:195], v[228:231], v[48:51]
    v_cvt_pk_bf16_f32 v222, v250, v222
    v_cvt_pk_bf16_f32 v220, v252, v249
    v_mfma_f32_16x16x32_bf16 v[52:55], a[196:199], v[228:231], v[52:55]
    v_lshlrev_b32 v248, 16, v219
    v_lshlrev_b32 v249, 16, v221
    v_mfma_f32_16x16x32_bf16 v[56:59], a[200:203], v[228:231], v[56:59]
    v_lshlrev_b32 v250, 16, v223
    v_mfma_f32_16x16x32_bf16 v[36:39], a[204:207], v[228:231], v[36:39]
    v_lshlrev_b32 v251, 16, v225
    v_and_b32 v219, s22, v219
    v_mfma_f32_16x16x32_bf16 v[40:43], a[208:211], v[228:231], v[40:43]
    v_and_b32 v221, s22, v221
    v_and_b32 v223, s22, v223
    v_mfma_f32_16x16x32_bf16 v[44:47], a[212:215], v[228:231], v[44:47]
    v_and_b32 v225, s22, v225
    v_lshlrev_b32 v252, 16, v217
    v_mfma_f32_16x16x32_bf16 v[24:27], a[216:219], v[228:231], v[24:27]
    v_and_b32 v217, s22, v217
    v_add_f32 v252, v252, v251
    v_mfma_f32_16x16x32_bf16 v[28:31], a[220:223], v[228:231], v[28:31]
    v_add_f32 v217, v217, v225
    v_mfma_f32_16x16x32_bf16 v[32:35], a[224:227], v[228:231], v[32:35]
    ds_read_b128 v[228:231], v253 offset:13792
    s_waitcnt lgkmcnt(2)
    v_mfma_f32_16x16x32_bf16 v[60:63], a[192:195], v[232:235], v[60:63]
    v_fmac_f32 v252, s23, v249
    v_fmac_f32 v217, s23, v221
    v_mfma_f32_16x16x32_bf16 v[64:67], a[196:199], v[232:235], v[64:67]
    v_cvt_pk_bf16_f32 v217, v252, v217
    v_lshlrev_b32 v252, 16, v227
    v_mfma_f32_16x16x32_bf16 v[68:71], a[200:203], v[232:235], v[68:71]
    v_and_b32 v227, s22, v227
    v_add_f32 v252, v252, v248
    v_mfma_f32_16x16x32_bf16 v[48:51], a[204:207], v[232:235], v[48:51]
    v_add_f32 v227, v227, v219
    v_fmac_f32 v252, s23, v250
    v_mfma_f32_16x16x32_bf16 v[52:55], a[208:211], v[232:235], v[52:55]
    v_fmac_f32 v227, s23, v223
    v_cvt_pk_bf16_f32 v227, v252, v227
    v_mfma_f32_16x16x32_bf16 v[56:59], a[212:215], v[232:235], v[56:59]
    v_fma_f32 v252, v249, s24, v251
    v_mfma_f32_16x16x32_bf16 v[36:39], a[216:219], v[232:235], v[36:39]
    v_fmac_f32 v251, s25, v249
    v_fma_f32 v249, v248, s24, v250
    v_mfma_f32_16x16x32_bf16 v[40:43], a[220:223], v[232:235], v[40:43]
    v_fmac_f32 v250, s25, v248
    v_fma_f32 v248, v250, s26, v251
    v_mfma_f32_16x16x32_bf16 v[44:47], a[224:227], v[232:235], v[44:47]
    ds_read_b128 v[232:235], v253 offset:13536
    s_waitcnt lgkmcnt(2)
    v_mfma_f32_16x16x32_bf16 v[72:75], a[192:195], v[236:239], v[72:75]
    v_fmac_f32 v251, s27, v250
    v_fma_f32 v250, v249, s28, v252
    v_mfma_f32_16x16x32_bf16 v[76:79], a[196:199], v[236:239], v[76:79]
    v_fmac_f32 v252, s29, v249
    v_fma_f32 v249, v221, s24, v225
    v_mfma_f32_16x16x32_bf16 v[80:83], a[200:203], v[236:239], v[80:83]
    v_fmac_f32 v225, s25, v221
    v_mfma_f32_16x16x32_bf16 v[60:63], a[204:207], v[236:239], v[60:63]
    v_fma_f32 v221, v219, s24, v223
    v_fmac_f32 v223, s25, v219
    v_mfma_f32_16x16x32_bf16 v[64:67], a[208:211], v[236:239], v[64:67]
    v_fma_f32 v219, v223, s26, v225
    v_fmac_f32 v225, s27, v223
    v_mfma_f32_16x16x32_bf16 v[68:71], a[212:215], v[236:239], v[68:71]
    v_fma_f32 v223, v221, s28, v249
    v_fmac_f32 v249, s29, v221
    v_mfma_f32_16x16x32_bf16 v[48:51], a[216:219], v[236:239], v[48:51]
    v_cvt_pk_bf16_f32 v219, v248, v219
    v_cvt_pk_bf16_f32 v225, v251, v225
    v_mfma_f32_16x16x32_bf16 v[52:55], a[220:223], v[236:239], v[52:55]
    v_cvt_pk_bf16_f32 v223, v250, v223
    v_mfma_f32_16x16x32_bf16 v[56:59], a[224:227], v[236:239], v[56:59]
    ds_read_b128 v[236:239], v253 offset:13264
    s_waitcnt lgkmcnt(2)
    v_mfma_f32_16x16x32_bf16 v[84:87], a[192:195], v[228:231], v[84:87]
    v_cvt_pk_bf16_f32 v221, v252, v249
    v_lshrrev_b32 v252, 15, v255
    v_mfma_f32_16x16x32_bf16 v[88:91], a[196:199], v[228:231], v[88:91]
    ds_write_b64 v252, v[218:219] offset:256
    ds_write_b64 v252, v[224:225] offset:2336
    v_mfma_f32_16x16x32_bf16 v[92:95], a[200:203], v[228:231], v[92:95]
    ds_write_b64 v252, v[222:223] offset:4416
    ds_write_b64 v252, v[216:217] offset:16896
    v_mfma_f32_16x16x32_bf16 v[72:75], a[204:207], v[228:231], v[72:75]
    s_mov_b32 s42, 589824
    buffer_load_dwordx4 a[192:195], v254, s[8:11], s42 offen offset:0
    v_mfma_f32_16x16x32_bf16 v[76:79], a[208:211], v[228:231], v[76:79]
    ds_write_b64 v252, v[226:227] offset:27296
    ds_write_b64 v252, v[220:221] offset:6496
    v_mfma_f32_16x16x32_bf16 v[80:83], a[212:215], v[228:231], v[80:83]
    buffer_load_dwordx4 a[196:199], v254, s[8:11], s42 offen offset:1024
    v_mfma_f32_16x16x32_bf16 v[60:63], a[216:219], v[228:231], v[60:63]
    v_mfma_f32_16x16x32_bf16 v[64:67], a[220:223], v[228:231], v[64:67]
    buffer_load_dwordx4 a[200:203], v254, s[8:11], s42 offen offset:2048
    v_mfma_f32_16x16x32_bf16 v[68:71], a[224:227], v[228:231], v[68:71]
    ds_read_b128 v[228:231], v253 offset:30160
    s_waitcnt lgkmcnt(8)
    v_mfma_f32_16x16x32_bf16 v[84:87], a[204:207], v[232:235], v[84:87]
    s_waitcnt vmcnt(18)
    v_lshlrev_b32 v248, 16, v194
    v_lshlrev_b32 v249, 16, v196
    v_mfma_f32_16x16x32_bf16 v[88:91], a[208:211], v[232:235], v[88:91]
    v_lshlrev_b32 v250, 16, v198
    v_lshlrev_b32 v251, 16, v200
    v_mfma_f32_16x16x32_bf16 v[92:95], a[212:215], v[232:235], v[92:95]
    s_mov_b32 s42, 592896
    buffer_load_dwordx4 a[204:207], v254, s[8:11], s42 offen offset:0
    v_mfma_f32_16x16x32_bf16 v[72:75], a[216:219], v[232:235], v[72:75]
    v_and_b32 v194, s22, v194
    v_and_b32 v196, s22, v196
    v_mfma_f32_16x16x32_bf16 v[76:79], a[220:223], v[232:235], v[76:79]
    buffer_load_dwordx4 a[208:211], v254, s[8:11], s42 offen offset:1024
    v_and_b32 v198, s22, v198
    v_mfma_f32_16x16x32_bf16 v[80:83], a[224:227], v[232:235], v[80:83]
    ds_read_b128 v[232:235], v253 offset:29888
    s_waitcnt lgkmcnt(8)
    v_mfma_f32_16x16x32_bf16 v[84:87], a[216:219], v[236:239], v[84:87]
    buffer_load_dwordx4 a[212:215], v254, s[8:11], s42 offen offset:2048
    v_and_b32 v200, s22, v200
    v_mfma_f32_16x16x32_bf16 v[88:91], a[220:223], v[236:239], v[88:91]
    v_lshlrev_b32 v252, 16, v192
    v_mfma_f32_16x16x32_bf16 v[92:95], a[224:227], v[236:239], v[92:95]
    ds_read_b128 v[236:239], v253 offset:29632
    s_mov_b32 s42, 595968
    buffer_load_dwordx4 a[216:219], v254, s[8:11], s42 offen offset:0
    s_waitcnt vmcnt(19) lgkmcnt(2)
    v_mfma_f32_16x16x32_bf16 v[96:99], a[228:231], v[228:231], v[96:99]
    v_and_b32 v192, s22, v192
    v_add_f32 v252, v252, v251
    v_mfma_f32_16x16x32_bf16 v[100:103], a[232:235], v[228:231], v[100:103]
    buffer_load_dwordx4 a[220:223], v254, s[8:11], s42 offen offset:1024
    v_add_f32 v192, v192, v200
    v_mfma_f32_16x16x32_bf16 v[104:107], a[236:239], v[228:231], v[104:107]
    ds_read_b128 v[228:231], v253 offset:29376
    s_waitcnt lgkmcnt(2)
    v_mfma_f32_16x16x32_bf16 v[108:111], a[228:231], v[232:235], v[108:111]
    buffer_load_dwordx4 a[224:227], v254, s[8:11], s42 offen offset:2048
    v_fmac_f32 v252, s23, v249
    v_mfma_f32_16x16x32_bf16 v[112:115], a[232:235], v[232:235], v[112:115]
    v_fmac_f32 v192, s23, v196
    v_cvt_pk_bf16_f32 v192, v252, v192
    v_mfma_f32_16x16x32_bf16 v[116:119], a[236:239], v[232:235], v[116:119]
    s_waitcnt vmcnt(18)
    v_mfma_f32_16x16x32_bf16 v[96:99], a[240:243], v[232:235], v[96:99]
    v_and_b32 v227, 0x7fff, v255
    v_lshlrev_b32 v252, 16, v202
    v_mfma_f32_16x16x32_bf16 v[100:103], a[244:247], v[232:235], v[100:103]
    buffer_load_dwordx2 v[216:217], v227, s[4:7], s16 offen offset:704
    v_and_b32 v202, s22, v202
    v_mfma_f32_16x16x32_bf16 v[104:107], a[248:251], v[232:235], v[104:107]
    ds_read_b128 v[232:235], v253 offset:29120
    s_waitcnt lgkmcnt(2)
    v_mfma_f32_16x16x32_bf16 v[120:123], a[228:231], v[236:239], v[120:123]
    buffer_load_dwordx2 v[218:219], v227, s[4:7], s17 offen offset:704
    v_add_f32 v252, v252, v248
    v_mfma_f32_16x16x32_bf16 v[124:127], a[232:235], v[236:239], v[124:127]
    buffer_load_dwordx2 v[220:221], v227, s[4:7], s18 offen offset:704
    v_add_f32 v202, v202, v194
    v_mfma_f32_16x16x32_bf16 v[128:131], a[236:239], v[236:239], v[128:131]
    v_fmac_f32 v252, s23, v250
    v_mfma_f32_16x16x32_bf16 v[108:111], a[240:243], v[236:239], v[108:111]
    buffer_load_dwordx2 v[222:223], v227, s[4:7], s19 offen offset:704
    v_fmac_f32 v202, s23, v198
    v_mfma_f32_16x16x32_bf16 v[112:115], a[244:247], v[236:239], v[112:115]
    buffer_load_dwordx2 v[224:225], v227, s[4:7], s20 offen offset:704
    v_cvt_pk_bf16_f32 v202, v252, v202
    v_mfma_f32_16x16x32_bf16 v[116:119], a[248:251], v[236:239], v[116:119]
    v_fma_f32 v252, v249, s24, v251
    s_waitcnt vmcnt(20)
    v_mfma_f32_16x16x32_bf16 v[96:99], a[252:255], v[236:239], v[96:99]
    buffer_load_dwordx2 v[226:227], v227, s[4:7], s21 offen offset:704
    v_fmac_f32 v251, s25, v249
    v_mfma_f32_16x16x32_bf16 v[100:103], v[240:243], v[236:239], v[100:103]
    v_fma_f32 v249, v248, s24, v250
    v_fmac_f32 v250, s25, v248
    v_mfma_f32_16x16x32_bf16 v[104:107], v[244:247], v[236:239], v[104:107]
    ds_read_b128 v[236:239], v253 offset:30944
    s_waitcnt lgkmcnt(2)
    v_mfma_f32_16x16x32_bf16 v[132:135], a[228:231], v[228:231], v[132:135]
    v_fma_f32 v248, v250, s26, v251
    v_mfma_f32_16x16x32_bf16 v[136:139], a[232:235], v[228:231], v[136:139]
    v_fmac_f32 v251, s27, v250
    v_fma_f32 v250, v249, s28, v252
    v_mfma_f32_16x16x32_bf16 v[140:143], a[236:239], v[228:231], v[140:143]
    v_fmac_f32 v252, s29, v249
    v_fma_f32 v249, v196, s24, v200
    v_mfma_f32_16x16x32_bf16 v[120:123], a[240:243], v[228:231], v[120:123]
    v_fmac_f32 v200, s25, v196
    v_fma_f32 v196, v194, s24, v198
    v_mfma_f32_16x16x32_bf16 v[124:127], a[244:247], v[228:231], v[124:127]
    v_fmac_f32 v198, s25, v194
    v_fma_f32 v194, v198, s26, v200
    v_mfma_f32_16x16x32_bf16 v[128:131], a[248:251], v[228:231], v[128:131]
    v_fmac_f32 v200, s27, v198
    v_mfma_f32_16x16x32_bf16 v[108:111], a[252:255], v[228:231], v[108:111]
    v_fma_f32 v198, v196, s28, v249
    v_fmac_f32 v249, s29, v196
    v_mfma_f32_16x16x32_bf16 v[112:115], v[240:243], v[228:231], v[112:115]
    v_cvt_pk_bf16_f32 v194, v248, v194
    v_cvt_pk_bf16_f32 v200, v251, v200
    v_mfma_f32_16x16x32_bf16 v[116:119], v[244:247], v[228:231], v[116:119]
    ds_read_b128 v[228:231], v253 offset:30688
    s_waitcnt lgkmcnt(2)
    v_mfma_f32_16x16x32_bf16 v[144:147], a[228:231], v[232:235], v[144:147]
    v_cvt_pk_bf16_f32 v198, v250, v198
    v_cvt_pk_bf16_f32 v196, v252, v249
    v_mfma_f32_16x16x32_bf16 v[148:151], a[232:235], v[232:235], v[148:151]
    v_lshlrev_b32 v248, 16, v195
    v_lshlrev_b32 v249, 16, v197
    v_mfma_f32_16x16x32_bf16 v[152:155], a[236:239], v[232:235], v[152:155]
    v_lshlrev_b32 v250, 16, v199
    v_mfma_f32_16x16x32_bf16 v[132:135], a[240:243], v[232:235], v[132:135]
    v_lshlrev_b32 v251, 16, v201
    v_and_b32 v195, s22, v195
    v_mfma_f32_16x16x32_bf16 v[136:139], a[244:247], v[232:235], v[136:139]
    v_and_b32 v197, s22, v197
    v_and_b32 v199, s22, v199
    v_mfma_f32_16x16x32_bf16 v[140:143], a[248:251], v[232:235], v[140:143]
    v_and_b32 v201, s22, v201
    v_lshlrev_b32 v252, 16, v193
    v_mfma_f32_16x16x32_bf16 v[120:123], a[252:255], v[232:235], v[120:123]
    v_and_b32 v193, s22, v193
    v_add_f32 v252, v252, v251
    v_mfma_f32_16x16x32_bf16 v[124:127], v[240:243], v[232:235], v[124:127]
    v_add_f32 v193, v193, v201
    v_mfma_f32_16x16x32_bf16 v[128:131], v[244:247], v[232:235], v[128:131]
    ds_read_b128 v[232:235], v253 offset:30432
    s_waitcnt lgkmcnt(2)
    v_mfma_f32_16x16x32_bf16 v[156:159], a[228:231], v[236:239], v[156:159]
    v_fmac_f32 v252, s23, v249
    v_fmac_f32 v193, s23, v197
    v_mfma_f32_16x16x32_bf16 v[160:163], a[232:235], v[236:239], v[160:163]
    v_cvt_pk_bf16_f32 v193, v252, v193
    v_lshlrev_b32 v252, 16, v203
    v_mfma_f32_16x16x32_bf16 v[164:167], a[236:239], v[236:239], v[164:167]
    v_and_b32 v203, s22, v203
    v_add_f32 v252, v252, v248
    v_mfma_f32_16x16x32_bf16 v[144:147], a[240:243], v[236:239], v[144:147]
    v_add_f32 v203, v203, v195
    v_fmac_f32 v252, s23, v250
    v_mfma_f32_16x16x32_bf16 v[148:151], a[244:247], v[236:239], v[148:151]
    v_fmac_f32 v203, s23, v199
    v_cvt_pk_bf16_f32 v203, v252, v203
    v_mfma_f32_16x16x32_bf16 v[152:155], a[248:251], v[236:239], v[152:155]
    v_fma_f32 v252, v249, s24, v251
    v_mfma_f32_16x16x32_bf16 v[132:135], a[252:255], v[236:239], v[132:135]
    v_fmac_f32 v251, s25, v249
    v_fma_f32 v249, v248, s24, v250
    v_mfma_f32_16x16x32_bf16 v[136:139], v[240:243], v[236:239], v[136:139]
    v_fmac_f32 v250, s25, v248
    v_fma_f32 v248, v250, s26, v251
    v_mfma_f32_16x16x32_bf16 v[140:143], v[244:247], v[236:239], v[140:143]
    ds_read_b128 v[236:239], v253 offset:30176
    s_waitcnt lgkmcnt(2)
    v_mfma_f32_16x16x32_bf16 v[168:171], a[228:231], v[228:231], v[168:171]
    v_fmac_f32 v251, s27, v250
    v_fma_f32 v250, v249, s28, v252
    v_mfma_f32_16x16x32_bf16 v[172:175], a[232:235], v[228:231], v[172:175]
    v_fmac_f32 v252, s29, v249
    v_fma_f32 v249, v197, s24, v201
    v_mfma_f32_16x16x32_bf16 v[176:179], a[236:239], v[228:231], v[176:179]
    v_fmac_f32 v201, s25, v197
    v_mfma_f32_16x16x32_bf16 v[156:159], a[240:243], v[228:231], v[156:159]
    v_fma_f32 v197, v195, s24, v199
    v_fmac_f32 v199, s25, v195
    v_mfma_f32_16x16x32_bf16 v[160:163], a[244:247], v[228:231], v[160:163]
    v_fma_f32 v195, v199, s26, v201
    v_fmac_f32 v201, s27, v199
    v_mfma_f32_16x16x32_bf16 v[164:167], a[248:251], v[228:231], v[164:167]
    v_fma_f32 v199, v197, s28, v249
    v_fmac_f32 v249, s29, v197
    v_mfma_f32_16x16x32_bf16 v[144:147], a[252:255], v[228:231], v[144:147]
    v_cvt_pk_bf16_f32 v195, v248, v195
    v_cvt_pk_bf16_f32 v201, v251, v201
    v_mfma_f32_16x16x32_bf16 v[148:151], v[240:243], v[228:231], v[148:151]
    v_cvt_pk_bf16_f32 v199, v250, v199
    v_mfma_f32_16x16x32_bf16 v[152:155], v[244:247], v[228:231], v[152:155]
    ds_read_b128 v[228:231], v253 offset:29904
    s_waitcnt lgkmcnt(2)
    v_mfma_f32_16x16x32_bf16 v[180:183], a[228:231], v[232:235], v[180:183]
    v_cvt_pk_bf16_f32 v197, v252, v249
    v_lshrrev_b32 v252, 15, v255
    v_mfma_f32_16x16x32_bf16 v[184:187], a[232:235], v[232:235], v[184:187]
    ds_write_b64 v252, v[194:195] offset:0
    ds_write_b64 v252, v[200:201] offset:2080
    v_mfma_f32_16x16x32_bf16 v[188:191], a[236:239], v[232:235], v[188:191]
    ds_write_b64 v252, v[198:199] offset:4160
    ds_write_b64 v252, v[192:193] offset:16640
    v_mfma_f32_16x16x32_bf16 v[168:171], a[240:243], v[232:235], v[168:171]
    s_mov_b32 s42, 626688
    buffer_load_dwordx4 a[228:231], v254, s[8:11], s42 offen offset:0
    v_mfma_f32_16x16x32_bf16 v[172:175], a[244:247], v[232:235], v[172:175]
    ds_write_b64 v252, v[202:203] offset:27040
    ds_write_b64 v252, v[196:197] offset:6240
    v_mfma_f32_16x16x32_bf16 v[176:179], a[248:251], v[232:235], v[176:179]
    buffer_load_dwordx4 a[232:235], v254, s[8:11], s42 offen offset:1024
    v_mfma_f32_16x16x32_bf16 v[156:159], a[252:255], v[232:235], v[156:159]
    v_mfma_f32_16x16x32_bf16 v[160:163], v[240:243], v[232:235], v[160:163]
    buffer_load_dwordx4 a[236:239], v254, s[8:11], s42 offen offset:2048
    v_mfma_f32_16x16x32_bf16 v[164:167], v[244:247], v[232:235], v[164:167]
    s_waitcnt lgkmcnt(0)
    s_barrier
    ds_read_b128 v[232:235], v253 offset:1040
    v_mfma_f32_16x16x32_bf16 v[180:183], a[240:243], v[236:239], v[180:183]
    s_waitcnt vmcnt(18)
    v_lshlrev_b32 v248, 16, v206
    v_lshlrev_b32 v249, 16, v208
    v_mfma_f32_16x16x32_bf16 v[184:187], a[244:247], v[236:239], v[184:187]
    v_lshlrev_b32 v250, 16, v210
    v_lshlrev_b32 v251, 16, v212
    v_mfma_f32_16x16x32_bf16 v[188:191], a[248:251], v[236:239], v[188:191]
    s_mov_b32 s42, 629760
    buffer_load_dwordx4 a[240:243], v254, s[8:11], s42 offen offset:0
    v_mfma_f32_16x16x32_bf16 v[168:171], a[252:255], v[236:239], v[168:171]
    v_and_b32 v206, s22, v206
    v_and_b32 v208, s22, v208
    v_mfma_f32_16x16x32_bf16 v[172:175], v[240:243], v[236:239], v[172:175]
    buffer_load_dwordx4 a[244:247], v254, s[8:11], s42 offen offset:1024
    v_and_b32 v210, s22, v210
    v_mfma_f32_16x16x32_bf16 v[176:179], v[244:247], v[236:239], v[176:179]
    ds_read_b128 v[236:239], v253 offset:768
    v_mfma_f32_16x16x32_bf16 v[180:183], a[252:255], v[228:231], v[180:183]
    buffer_load_dwordx4 a[248:251], v254, s[8:11], s42 offen offset:2048
    v_mfma_f32_16x16x32_bf16 v[184:187], v[240:243], v[228:231], v[184:187]
    v_and_b32 v212, s22, v212
    v_lshlrev_b32 v252, 16, v204
    v_mfma_f32_16x16x32_bf16 v[188:191], v[244:247], v[228:231], v[188:191]
    ds_read_b128 v[228:231], v253 offset:512
    s_mov_b32 s42, 632832
    buffer_load_dwordx4 a[252:255], v254, s[8:11], s42 offen offset:0
    s_waitcnt vmcnt(19) lgkmcnt(2)
    v_mfma_f32_16x16x32_bf16 a[0:3], a[192:195], v[232:235], a[0:3]
    v_and_b32 v204, s22, v204
    v_add_f32 v252, v252, v251
    v_mfma_f32_16x16x32_bf16 a[4:7], a[196:199], v[232:235], a[4:7]
    buffer_load_dwordx4 v[240:243], v254, s[8:11], s42 offen offset:1024
    v_add_f32 v204, v204, v212
    v_mfma_f32_16x16x32_bf16 a[8:11], a[200:203], v[232:235], a[8:11]
    ds_read_b128 v[232:235], v253 offset:256
    s_waitcnt lgkmcnt(2)
    v_mfma_f32_16x16x32_bf16 a[12:15], a[192:195], v[236:239], a[12:15]
    buffer_load_dwordx4 v[244:247], v254, s[8:11], s42 offen offset:2048
    v_fmac_f32 v252, s23, v249
    v_mfma_f32_16x16x32_bf16 a[16:19], a[196:199], v[236:239], a[16:19]
    v_fmac_f32 v204, s23, v208
    v_mfma_f32_16x16x32_bf16 a[20:23], a[200:203], v[236:239], a[20:23]
    v_cvt_pk_bf16_f32 v204, v252, v204
    s_waitcnt vmcnt(18)
    v_mfma_f32_16x16x32_bf16 a[0:3], a[204:207], v[236:239], a[0:3]
    v_and_b32 v203, 0x7fff, v255
    v_lshlrev_b32 v252, 16, v214
    v_mfma_f32_16x16x32_bf16 a[4:7], a[208:211], v[236:239], a[4:7]
    buffer_load_dwordx2 v[192:193], v203, s[4:7], s16 offen offset:1088
    v_and_b32 v214, s22, v214
    v_mfma_f32_16x16x32_bf16 a[8:11], a[212:215], v[236:239], a[8:11]
    ds_read_b128 v[236:239], v253 offset:0
    s_waitcnt lgkmcnt(2)
    v_mfma_f32_16x16x32_bf16 a[24:27], a[192:195], v[228:231], a[24:27]
    buffer_load_dwordx2 v[194:195], v203, s[4:7], s17 offen offset:1088
    v_add_f32 v252, v252, v248
    v_mfma_f32_16x16x32_bf16 a[28:31], a[196:199], v[228:231], a[28:31]
    buffer_load_dwordx2 v[196:197], v203, s[4:7], s18 offen offset:1088
    v_mfma_f32_16x16x32_bf16 a[32:35], a[200:203], v[228:231], a[32:35]
    v_add_f32 v214, v214, v206
    v_fmac_f32 v252, s23, v250
    v_mfma_f32_16x16x32_bf16 a[12:15], a[204:207], v[228:231], a[12:15]
    buffer_load_dwordx2 v[198:199], v203, s[4:7], s19 offen offset:1088
    v_fmac_f32 v214, s23, v210
    v_mfma_f32_16x16x32_bf16 a[16:19], a[208:211], v[228:231], a[16:19]
    buffer_load_dwordx2 v[200:201], v203, s[4:7], s20 offen offset:1088
    v_cvt_pk_bf16_f32 v214, v252, v214
    v_mfma_f32_16x16x32_bf16 a[20:23], a[212:215], v[228:231], a[20:23]
    v_fma_f32 v252, v249, s24, v251
    s_waitcnt vmcnt(20)
    v_mfma_f32_16x16x32_bf16 a[0:3], a[216:219], v[228:231], a[0:3]
    buffer_load_dwordx2 v[202:203], v203, s[4:7], s21 offen offset:1088
    v_mfma_f32_16x16x32_bf16 a[4:7], a[220:223], v[228:231], a[4:7]
    v_fmac_f32 v251, s25, v249
    v_fma_f32 v249, v248, s24, v250
    v_mfma_f32_16x16x32_bf16 a[8:11], a[224:227], v[228:231], a[8:11]
    ds_read_b128 v[228:231], v253 offset:1824
    s_waitcnt lgkmcnt(2)
    v_mfma_f32_16x16x32_bf16 a[36:39], a[192:195], v[232:235], a[36:39]
    v_fmac_f32 v250, s25, v248
    v_fma_f32 v248, v250, s26, v251
    v_mfma_f32_16x16x32_bf16 a[40:43], a[196:199], v[232:235], a[40:43]
    v_fmac_f32 v251, s27, v250
    v_fma_f32 v250, v249, s28, v252
    v_mfma_f32_16x16x32_bf16 a[44:47], a[200:203], v[232:235], a[44:47]
    v_fmac_f32 v252, s29, v249
    v_fma_f32 v249, v208, s24, v212
    v_mfma_f32_16x16x32_bf16 a[24:27], a[204:207], v[232:235], a[24:27]
    v_fmac_f32 v212, s25, v208
    v_mfma_f32_16x16x32_bf16 a[28:31], a[208:211], v[232:235], a[28:31]
    v_fma_f32 v208, v206, s24, v210
    v_fmac_f32 v210, s25, v206
    v_mfma_f32_16x16x32_bf16 a[32:35], a[212:215], v[232:235], a[32:35]
    v_fma_f32 v206, v210, s26, v212
    v_fmac_f32 v212, s27, v210
    v_mfma_f32_16x16x32_bf16 a[12:15], a[216:219], v[232:235], a[12:15]
    v_fma_f32 v210, v208, s28, v249
    v_fmac_f32 v249, s29, v208
    v_mfma_f32_16x16x32_bf16 a[16:19], a[220:223], v[232:235], a[16:19]
    v_cvt_pk_bf16_f32 v206, v248, v206
    v_mfma_f32_16x16x32_bf16 a[20:23], a[224:227], v[232:235], a[20:23]
    ds_read_b128 v[232:235], v253 offset:1568
    s_waitcnt lgkmcnt(2)
    v_mfma_f32_16x16x32_bf16 a[48:51], a[192:195], v[236:239], a[48:51]
    v_cvt_pk_bf16_f32 v212, v251, v212
    v_cvt_pk_bf16_f32 v210, v250, v210
    v_mfma_f32_16x16x32_bf16 a[52:55], a[196:199], v[236:239], a[52:55]
    v_cvt_pk_bf16_f32 v208, v252, v249
    v_lshlrev_b32 v248, 16, v207
    v_mfma_f32_16x16x32_bf16 a[56:59], a[200:203], v[236:239], a[56:59]
    v_lshlrev_b32 v249, 16, v209
    v_lshlrev_b32 v250, 16, v211
    v_mfma_f32_16x16x32_bf16 a[36:39], a[204:207], v[236:239], a[36:39]
    v_lshlrev_b32 v251, 16, v213
    v_and_b32 v207, s22, v207
    v_mfma_f32_16x16x32_bf16 a[40:43], a[208:211], v[236:239], a[40:43]
    v_and_b32 v209, s22, v209
    v_mfma_f32_16x16x32_bf16 a[44:47], a[212:215], v[236:239], a[44:47]
    v_and_b32 v211, s22, v211
    v_and_b32 v213, s22, v213
    v_mfma_f32_16x16x32_bf16 a[24:27], a[216:219], v[236:239], a[24:27]
    v_lshlrev_b32 v252, 16, v205
    v_and_b32 v205, s22, v205
    v_mfma_f32_16x16x32_bf16 a[28:31], a[220:223], v[236:239], a[28:31]
    v_add_f32 v252, v252, v251
    v_add_f32 v205, v205, v213
    v_mfma_f32_16x16x32_bf16 a[32:35], a[224:227], v[236:239], a[32:35]
    ds_read_b128 v[236:239], v253 offset:1312
    s_waitcnt lgkmcnt(2)
    v_mfma_f32_16x16x32_bf16 a[60:63], a[192:195], v[228:231], a[60:63]
    v_fmac_f32 v252, s23, v249
    v_fmac_f32 v205, s23, v209
    v_mfma_f32_16x16x32_bf16 a[64:67], a[196:199], v[228:231], a[64:67]
    v_cvt_pk_bf16_f32 v205, v252, v205
    v_mfma_f32_16x16x32_bf16 a[68:71], a[200:203], v[228:231], a[68:71]
    v_lshlrev_b32 v252, 16, v215
    v_and_b32 v215, s22, v215
    v_mfma_f32_16x16x32_bf16 a[48:51], a[204:207], v[228:231], a[48:51]
    v_add_f32 v252, v252, v248
    v_add_f32 v215, v215, v207
    v_mfma_f32_16x16x32_bf16 a[52:55], a[208:211], v[228:231], a[52:55]
    v_fmac_f32 v252, s23, v250
    v_fmac_f32 v215, s23, v211
    v_mfma_f32_16x16x32_bf16 a[56:59], a[212:215], v[228:231], a[56:59]
    v_cvt_pk_bf16_f32 v215, v252, v215
    v_fma_f32 v252, v249, s24, v251
    v_mfma_f32_16x16x32_bf16 a[36:39], a[216:219], v[228:231], a[36:39]
    v_fmac_f32 v251, s25, v249
    v_mfma_f32_16x16x32_bf16 a[40:43], a[220:223], v[228:231], a[40:43]
    v_fma_f32 v249, v248, s24, v250
    v_fmac_f32 v250, s25, v248
    v_mfma_f32_16x16x32_bf16 a[44:47], a[224:227], v[228:231], a[44:47]
    ds_read_b128 v[228:231], v253 offset:1056
    s_waitcnt lgkmcnt(2)
    v_mfma_f32_16x16x32_bf16 a[72:75], a[192:195], v[232:235], a[72:75]
    v_fma_f32 v248, v250, s26, v251
    v_fmac_f32 v251, s27, v250
    v_mfma_f32_16x16x32_bf16 a[76:79], a[196:199], v[232:235], a[76:79]
    v_fma_f32 v250, v249, s28, v252
    v_fmac_f32 v252, s29, v249
    v_mfma_f32_16x16x32_bf16 a[80:83], a[200:203], v[232:235], a[80:83]
    v_fma_f32 v249, v209, s24, v213
    v_fmac_f32 v213, s25, v209
    v_mfma_f32_16x16x32_bf16 a[60:63], a[204:207], v[232:235], a[60:63]
    v_fma_f32 v209, v207, s24, v211
    v_mfma_f32_16x16x32_bf16 a[64:67], a[208:211], v[232:235], a[64:67]
    v_fmac_f32 v211, s25, v207
    v_fma_f32 v207, v211, s26, v213
    v_mfma_f32_16x16x32_bf16 a[68:71], a[212:215], v[232:235], a[68:71]
    v_fmac_f32 v213, s27, v211
    v_fma_f32 v211, v209, s28, v249
    v_mfma_f32_16x16x32_bf16 a[48:51], a[216:219], v[232:235], a[48:51]
    v_fmac_f32 v249, s29, v209
    v_cvt_pk_bf16_f32 v207, v248, v207
    v_mfma_f32_16x16x32_bf16 a[52:55], a[220:223], v[232:235], a[52:55]
    v_cvt_pk_bf16_f32 v213, v251, v213
    v_cvt_pk_bf16_f32 v211, v250, v211
    v_mfma_f32_16x16x32_bf16 a[56:59], a[224:227], v[232:235], a[56:59]
    ds_read_b128 v[232:235], v253 offset:784
    s_waitcnt lgkmcnt(2)
    v_mfma_f32_16x16x32_bf16 a[84:87], a[192:195], v[236:239], a[84:87]
    v_cvt_pk_bf16_f32 v209, v252, v249
    v_mfma_f32_16x16x32_bf16 a[88:91], a[196:199], v[236:239], a[88:91]
    v_lshrrev_b32 v252, 15, v255
    ds_write_b64 v252, v[206:207] offset:9088
    v_mfma_f32_16x16x32_bf16 a[92:95], a[200:203], v[236:239], a[92:95]
    ds_write_b64 v252, v[212:213] offset:11168
    ds_write_b64 v252, v[210:211] offset:13248
    v_mfma_f32_16x16x32_bf16 a[72:75], a[204:207], v[236:239], a[72:75]
    s_mov_b32 s42, 663552
    buffer_load_dwordx4 a[192:195], v254, s[8:11], s42 offen offset:0
    v_mfma_f32_16x16x32_bf16 a[76:79], a[208:211], v[236:239], a[76:79]
    ds_write_b64 v252, v[204:205] offset:15328
    ds_write_b64 v252, v[214:215] offset:29888
    v_mfma_f32_16x16x32_bf16 a[80:83], a[212:215], v[236:239], a[80:83]
    buffer_load_dwordx4 a[196:199], v254, s[8:11], s42 offen offset:1024
    v_mfma_f32_16x16x32_bf16 a[60:63], a[216:219], v[236:239], a[60:63]
    v_mfma_f32_16x16x32_bf16 a[64:67], a[220:223], v[236:239], a[64:67]
    buffer_load_dwordx4 a[200:203], v254, s[8:11], s42 offen offset:2048
    v_mfma_f32_16x16x32_bf16 a[68:71], a[224:227], v[236:239], a[68:71]
    s_waitcnt lgkmcnt(0)
    s_barrier
    ds_write_b64 v252, v[208:209] offset:768
    ds_read_b128 v[236:239], v253 offset:3120
    v_mfma_f32_16x16x32_bf16 a[84:87], a[204:207], v[228:231], a[84:87]
    s_waitcnt vmcnt(18)
    v_lshlrev_b32 v248, 16, v218
    v_lshlrev_b32 v249, 16, v220
    v_lshlrev_b32 v250, 16, v222
    v_mfma_f32_16x16x32_bf16 a[88:91], a[208:211], v[228:231], a[88:91]
    v_lshlrev_b32 v251, 16, v224
    v_and_b32 v218, s22, v218
    v_mfma_f32_16x16x32_bf16 a[92:95], a[212:215], v[228:231], a[92:95]
    s_mov_b32 s42, 666624
    buffer_load_dwordx4 a[204:207], v254, s[8:11], s42 offen offset:0
    v_mfma_f32_16x16x32_bf16 a[72:75], a[216:219], v[228:231], a[72:75]
    v_and_b32 v220, s22, v220
    v_and_b32 v222, s22, v222
    v_mfma_f32_16x16x32_bf16 a[76:79], a[220:223], v[228:231], a[76:79]
    buffer_load_dwordx4 a[208:211], v254, s[8:11], s42 offen offset:1024
    v_and_b32 v224, s22, v224
    v_mfma_f32_16x16x32_bf16 a[80:83], a[224:227], v[228:231], a[80:83]
    ds_read_b128 v[228:231], v253 offset:2848
    v_mfma_f32_16x16x32_bf16 a[84:87], a[216:219], v[232:235], a[84:87]
    buffer_load_dwordx4 a[212:215], v254, s[8:11], s42 offen offset:2048
    v_lshlrev_b32 v252, 16, v216
    v_mfma_f32_16x16x32_bf16 a[88:91], a[220:223], v[232:235], a[88:91]
    v_and_b32 v216, s22, v216
    v_add_f32 v252, v252, v251
    v_mfma_f32_16x16x32_bf16 a[92:95], a[224:227], v[232:235], a[92:95]
    ds_read_b128 v[232:235], v253 offset:2592
    s_mov_b32 s42, 669696
    buffer_load_dwordx4 a[216:219], v254, s[8:11], s42 offen offset:0
    s_waitcnt vmcnt(19) lgkmcnt(2)
    v_mfma_f32_16x16x32_bf16 a[96:99], a[228:231], v[236:239], a[96:99]
    v_add_f32 v216, v216, v224
    v_fmac_f32 v252, s23, v249
    v_fmac_f32 v216, s23, v220
    v_mfma_f32_16x16x32_bf16 a[100:103], a[232:235], v[236:239], a[100:103]
    buffer_load_dwordx4 a[220:223], v254, s[8:11], s42 offen offset:1024
    v_cvt_pk_bf16_f32 v216, v252, v216
    v_mfma_f32_16x16x32_bf16 a[104:107], a[236:239], v[236:239], a[104:107]
    ds_read_b128 v[236:239], v253 offset:2336
    s_waitcnt lgkmcnt(2)
    v_mfma_f32_16x16x32_bf16 a[108:111], a[228:231], v[228:231], a[108:111]
    buffer_load_dwordx4 a[224:227], v254, s[8:11], s42 offen offset:2048
    v_lshlrev_b32 v252, 16, v226
    v_mfma_f32_16x16x32_bf16 a[112:115], a[232:235], v[228:231], a[112:115]
    v_and_b32 v226, s22, v226
    v_add_f32 v252, v252, v248
    v_mfma_f32_16x16x32_bf16 a[116:119], a[236:239], v[228:231], a[116:119]
    v_add_f32 v226, v226, v218
    s_waitcnt vmcnt(18)
    v_mfma_f32_16x16x32_bf16 a[96:99], a[240:243], v[228:231], a[96:99]
    v_and_b32 v215, 0x7fff, v255
    v_fmac_f32 v252, s23, v250
    v_mfma_f32_16x16x32_bf16 a[100:103], a[244:247], v[228:231], a[100:103]
    buffer_load_dwordx2 v[204:205], v215, s[4:7], s16 offen offset:1472
    v_fmac_f32 v226, s23, v222
    v_mfma_f32_16x16x32_bf16 a[104:107], a[248:251], v[228:231], a[104:107]
    ds_read_b128 v[228:231], v253 offset:2080
    s_waitcnt lgkmcnt(2)
    v_mfma_f32_16x16x32_bf16 a[120:123], a[228:231], v[232:235], a[120:123]
    buffer_load_dwordx2 v[206:207], v215, s[4:7], s17 offen offset:1472
    v_cvt_pk_bf16_f32 v226, v252, v226
    v_fma_f32 v252, v249, s24, v251
    v_mfma_f32_16x16x32_bf16 a[124:127], a[232:235], v[232:235], a[124:127]
    buffer_load_dwordx2 v[208:209], v215, s[4:7], s18 offen offset:1472
    v_fmac_f32 v251, s25, v249
    v_mfma_f32_16x16x32_bf16 a[128:131], a[236:239], v[232:235], a[128:131]
    v_fma_f32 v249, v248, s24, v250
    v_fmac_f32 v250, s25, v248
    v_mfma_f32_16x16x32_bf16 a[108:111], a[240:243], v[232:235], a[108:111]
    buffer_load_dwordx2 v[210:211], v215, s[4:7], s19 offen offset:1472
    v_fma_f32 v248, v250, s26, v251
    v_mfma_f32_16x16x32_bf16 a[112:115], a[244:247], v[232:235], a[112:115]
    buffer_load_dwordx2 v[212:213], v215, s[4:7], s20 offen offset:1472
    v_fmac_f32 v251, s27, v250
    v_mfma_f32_16x16x32_bf16 a[116:119], a[248:251], v[232:235], a[116:119]
    v_fma_f32 v250, v249, s28, v252
    s_waitcnt vmcnt(20)
    v_mfma_f32_16x16x32_bf16 a[96:99], a[252:255], v[232:235], a[96:99]
    buffer_load_dwordx2 v[214:215], v215, s[4:7], s21 offen offset:1472
    v_fmac_f32 v252, s29, v249
    v_mfma_f32_16x16x32_bf16 a[100:103], v[240:243], v[232:235], a[100:103]
    v_fma_f32 v249, v220, s24, v224
    v_fmac_f32 v224, s25, v220
    v_mfma_f32_16x16x32_bf16 a[104:107], v[244:247], v[232:235], a[104:107]
    ds_read_b128 v[232:235], v253 offset:3904
    v_fma_f32 v220, v218, s24, v222
    s_waitcnt lgkmcnt(2)
    v_mfma_f32_16x16x32_bf16 a[132:135], a[228:231], v[236:239], a[132:135]
    v_fmac_f32 v222, s25, v218
    v_fma_f32 v218, v222, s26, v224
    v_mfma_f32_16x16x32_bf16 a[136:139], a[232:235], v[236:239], a[136:139]
    v_fmac_f32 v224, s27, v222
    v_fma_f32 v222, v220, s28, v249
    v_mfma_f32_16x16x32_bf16 a[140:143], a[236:239], v[236:239], a[140:143]
    v_fmac_f32 v249, s29, v220
    v_cvt_pk_bf16_f32 v218, v248, v218
    v_mfma_f32_16x16x32_bf16 a[120:123], a[240:243], v[236:239], a[120:123]
    v_cvt_pk_bf16_f32 v224, v251, v224
    v_cvt_pk_bf16_f32 v222, v250, v222
    v_mfma_f32_16x16x32_bf16 a[124:127], a[244:247], v[236:239], a[124:127]
    v_cvt_pk_bf16_f32 v220, v252, v249
    v_lshlrev_b32 v248, 16, v219
    v_mfma_f32_16x16x32_bf16 a[128:131], a[248:251], v[236:239], a[128:131]
    v_lshlrev_b32 v249, 16, v221
    v_lshlrev_b32 v250, 16, v223
    v_mfma_f32_16x16x32_bf16 a[108:111], a[252:255], v[236:239], a[108:111]
    v_lshlrev_b32 v251, 16, v225
    v_and_b32 v219, s22, v219
    v_mfma_f32_16x16x32_bf16 a[112:115], v[240:243], v[236:239], a[112:115]
    v_and_b32 v221, s22, v221
    v_and_b32 v223, s22, v223
    v_mfma_f32_16x16x32_bf16 a[116:119], v[244:247], v[236:239], a[116:119]
    ds_read_b128 v[236:239], v253 offset:3648
    v_and_b32 v225, s22, v225
    s_waitcnt lgkmcnt(2)
    v_mfma_f32_16x16x32_bf16 a[144:147], a[228:231], v[228:231], a[144:147]
    v_lshlrev_b32 v252, 16, v217
    v_and_b32 v217, s22, v217
    v_mfma_f32_16x16x32_bf16 a[148:151], a[232:235], v[228:231], a[148:151]
    v_add_f32 v252, v252, v251
    v_add_f32 v217, v217, v225
    v_mfma_f32_16x16x32_bf16 a[152:155], a[236:239], v[228:231], a[152:155]
    v_fmac_f32 v252, s23, v249
    v_fmac_f32 v217, s23, v221
    v_mfma_f32_16x16x32_bf16 a[132:135], a[240:243], v[228:231], a[132:135]
    v_cvt_pk_bf16_f32 v217, v252, v217
    v_lshlrev_b32 v252, 16, v227
    v_mfma_f32_16x16x32_bf16 a[136:139], a[244:247], v[228:231], a[136:139]
    v_and_b32 v227, s22, v227
    v_add_f32 v252, v252, v248
    v_mfma_f32_16x16x32_bf16 a[140:143], a[248:251], v[228:231], a[140:143]
    v_add_f32 v227, v227, v219
    v_fmac_f32 v252, s23, v250
    v_mfma_f32_16x16x32_bf16 a[120:123], a[252:255], v[228:231], a[120:123]
    v_fmac_f32 v227, s23, v223
    v_cvt_pk_bf16_f32 v227, v252, v227
    v_mfma_f32_16x16x32_bf16 a[124:127], v[240:243], v[228:231], a[124:127]
    v_fma_f32 v252, v249, s24, v251
    v_fmac_f32 v251, s25, v249
    v_fma_f32 v249, v248, s24, v250
    v_mfma_f32_16x16x32_bf16 a[128:131], v[244:247], v[228:231], a[128:131]
    ds_read_b128 v[228:231], v253 offset:3392
    s_waitcnt lgkmcnt(2)
    v_mfma_f32_16x16x32_bf16 a[156:159], a[228:231], v[232:235], a[156:159]
    v_fmac_f32 v250, s25, v248
    v_fma_f32 v248, v250, s26, v251
    v_mfma_f32_16x16x32_bf16 a[160:163], a[232:235], v[232:235], a[160:163]
    v_fmac_f32 v251, s27, v250
    v_fma_f32 v250, v249, s28, v252
    v_mfma_f32_16x16x32_bf16 a[164:167], a[236:239], v[232:235], a[164:167]
    v_fmac_f32 v252, s29, v249
    v_fma_f32 v249, v221, s24, v225
    v_mfma_f32_16x16x32_bf16 a[144:147], a[240:243], v[232:235], a[144:147]
    v_fmac_f32 v225, s25, v221
    v_fma_f32 v221, v219, s24, v223
    v_mfma_f32_16x16x32_bf16 a[148:151], a[244:247], v[232:235], a[148:151]
    v_fmac_f32 v223, s25, v219
    v_fma_f32 v219, v223, s26, v225
    v_mfma_f32_16x16x32_bf16 a[152:155], a[248:251], v[232:235], a[152:155]
    v_fmac_f32 v225, s27, v223
    v_fma_f32 v223, v221, s28, v249
    v_mfma_f32_16x16x32_bf16 a[132:135], a[252:255], v[232:235], a[132:135]
    v_fmac_f32 v249, s29, v221
    v_cvt_pk_bf16_f32 v219, v248, v219
    v_mfma_f32_16x16x32_bf16 a[136:139], v[240:243], v[232:235], a[136:139]
    v_cvt_pk_bf16_f32 v225, v251, v225
    v_cvt_pk_bf16_f32 v223, v250, v223
    v_cvt_pk_bf16_f32 v221, v252, v249
    v_mfma_f32_16x16x32_bf16 a[140:143], v[244:247], v[232:235], a[140:143]
    ds_read_b128 v[232:235], v253 offset:3136
    s_waitcnt lgkmcnt(2)
    v_mfma_f32_16x16x32_bf16 a[168:171], a[228:231], v[236:239], a[168:171]
    v_lshrrev_b32 v252, 15, v255
    ds_read_b128 v[248:251], v253 offset:40480
    v_mfma_f32_16x16x32_bf16 a[172:175], a[232:235], v[236:239], a[172:175]
    ds_write_b64 v252, v[218:219] offset:8832
    ds_write_b64 v252, v[224:225] offset:10912
    v_mfma_f32_16x16x32_bf16 a[176:179], a[236:239], v[236:239], a[176:179]
    ds_write_b64 v252, v[222:223] offset:12992
    ds_write_b64 v252, v[216:217] offset:15072
    v_mfma_f32_16x16x32_bf16 a[156:159], a[240:243], v[236:239], a[156:159]
    ds_write_b64 v252, v[226:227] offset:29632
    ds_write_b64 v252, v[220:221] offset:512
    v_mfma_f32_16x16x32_bf16 a[160:163], a[244:247], v[236:239], a[160:163]
    s_waitcnt lgkmcnt(6)
    s_lshl_b64 exec, s[46:47], 0
    ds_write_b128 v253, v[248:251] offset:15584
    s_mov_b64 exec, -1
    v_mfma_f32_16x16x32_bf16 a[164:167], a[248:251], v[236:239], a[164:167]
    s_lshl_b64 exec, s[46:47], 2
    ds_write_b128 v253, v[248:251] offset:9312
    s_mov_b64 exec, -1
    v_mfma_f32_16x16x32_bf16 a[144:147], a[252:255], v[236:239], a[144:147]
    s_lshl_b64 exec, s[46:47], 4
    ds_write_b128 v253, v[248:251] offset:11360
    s_mov_b64 exec, -1
    v_mfma_f32_16x16x32_bf16 a[148:151], v[240:243], v[236:239], a[148:151]
    v_mfma_f32_16x16x32_bf16 a[152:155], v[244:247], v[236:239], a[152:155]
    ds_read_b128 v[236:239], v253 offset:2864
    v_mfma_f32_16x16x32_bf16 a[180:183], a[228:231], v[228:231], a[180:183]
    s_lshl_b64 exec, s[46:47], 6
    ds_write_b128 v253, v[248:251] offset:13408
    s_mov_b64 exec, -1
    v_mfma_f32_16x16x32_bf16 a[184:187], a[232:235], v[228:231], a[184:187]
    s_lshl_b64 exec, s[46:47], 8
    ds_write_b128 v253, v[248:251] offset:896
    s_mov_b64 exec, -1
    v_mfma_f32_16x16x32_bf16 a[188:191], a[236:239], v[228:231], a[188:191]
    v_mfma_f32_16x16x32_bf16 a[168:171], a[240:243], v[228:231], a[168:171]
    s_mov_b32 s42, 700416
    buffer_load_dwordx4 a[228:231], v254, s[8:11], s42 offen offset:0
    v_mfma_f32_16x16x32_bf16 a[172:175], a[244:247], v[228:231], a[172:175]
    s_lshl_b64 exec, s[46:47], 10
    ds_write_b128 v253, v[248:251] offset:29984
    s_mov_b64 exec, -1
    v_mfma_f32_16x16x32_bf16 a[176:179], a[248:251], v[228:231], a[176:179]
    buffer_load_dwordx4 a[232:235], v254, s[8:11], s42 offen offset:1024
    v_mfma_f32_16x16x32_bf16 a[156:159], a[252:255], v[228:231], a[156:159]
    v_mfma_f32_16x16x32_bf16 a[160:163], v[240:243], v[228:231], a[160:163]
    buffer_load_dwordx4 a[236:239], v254, s[8:11], s42 offen offset:2048
    v_mfma_f32_16x16x32_bf16 a[164:167], v[244:247], v[228:231], a[164:167]
    ds_read_b128 v[228:231], v253 offset:5200
    v_mfma_f32_16x16x32_bf16 a[180:183], a[240:243], v[232:235], a[180:183]
    s_waitcnt vmcnt(18)
    v_lshlrev_b32 v248, 16, v194
    v_lshlrev_b32 v249, 16, v196
    v_mfma_f32_16x16x32_bf16 a[184:187], a[244:247], v[232:235], a[184:187]
    v_lshlrev_b32 v250, 16, v198
    v_lshlrev_b32 v251, 16, v200
    v_mfma_f32_16x16x32_bf16 a[188:191], a[248:251], v[232:235], a[188:191]
    s_mov_b32 s42, 703488
    buffer_load_dwordx4 a[240:243], v254, s[8:11], s42 offen offset:0
    v_mfma_f32_16x16x32_bf16 a[168:171], a[252:255], v[232:235], a[168:171]
    v_and_b32 v194, s22, v194
    v_and_b32 v196, s22, v196
    v_mfma_f32_16x16x32_bf16 a[172:175], v[240:243], v[232:235], a[172:175]
    buffer_load_dwordx4 a[244:247], v254, s[8:11], s42 offen offset:1024
    v_and_b32 v198, s22, v198
    v_mfma_f32_16x16x32_bf16 a[176:179], v[244:247], v[232:235], a[176:179]
    ds_read_b128 v[232:235], v253 offset:4928
    s_waitcnt lgkmcnt(5)
    v_mfma_f32_16x16x32_bf16 a[180:183], a[252:255], v[236:239], a[180:183]
    buffer_load_dwordx4 a[248:251], v254, s[8:11], s42 offen offset:2048
    v_and_b32 v200, s22, v200
    v_mfma_f32_16x16x32_bf16 a[184:187], v[240:243], v[236:239], a[184:187]
    v_lshlrev_b32 v252, 16, v192
    v_and_b32 v192, s22, v192
    v_mfma_f32_16x16x32_bf16 a[188:191], v[244:247], v[236:239], a[188:191]
    ds_read_b128 v[236:239], v253 offset:4672
    s_mov_b32 s42, 706560
    buffer_load_dwordx4 a[252:255], v254, s[8:11], s42 offen offset:0
    s_waitcnt vmcnt(19) lgkmcnt(2)
    v_mfma_f32_16x16x32_bf16 v[0:3], a[192:195], v[228:231], v[0:3]
    v_add_f32 v252, v252, v251
    v_add_f32 v192, v192, v200
    v_mfma_f32_16x16x32_bf16 v[4:7], a[196:199], v[228:231], v[4:7]
    buffer_load_dwordx4 v[240:243], v254, s[8:11], s42 offen offset:1024
    v_fmac_f32 v252, s23, v249
    v_mfma_f32_16x16x32_bf16 v[8:11], a[200:203], v[228:231], v[8:11]
    ds_read_b128 v[228:231], v253 offset:4416
    s_waitcnt lgkmcnt(2)
    v_mfma_f32_16x16x32_bf16 v[12:15], a[192:195], v[232:235], v[12:15]
    buffer_load_dwordx4 v[244:247], v254, s[8:11], s42 offen offset:2048
    v_fmac_f32 v192, s23, v196
    v_mfma_f32_16x16x32_bf16 v[16:19], a[196:199], v[232:235], v[16:19]
    v_cvt_pk_bf16_f32 v192, v252, v192
    v_lshlrev_b32 v252, 16, v202
    v_mfma_f32_16x16x32_bf16 v[20:23], a[200:203], v[232:235], v[20:23]
    s_waitcnt vmcnt(18)
    v_mfma_f32_16x16x32_bf16 v[0:3], a[204:207], v[232:235], v[0:3]
    v_and_b32 v202, s22, v202
    v_add_f32 v252, v252, v248
    v_mfma_f32_16x16x32_bf16 v[4:7], a[208:211], v[232:235], v[4:7]
    v_add_f32 v202, v202, v194
    v_fmac_f32 v252, s23, v250
    v_mfma_f32_16x16x32_bf16 v[8:11], a[212:215], v[232:235], v[8:11]
    ds_read_b128 v[232:235], v253 offset:4160
    s_waitcnt lgkmcnt(2)
    v_mfma_f32_16x16x32_bf16 v[24:27], a[192:195], v[236:239], v[24:27]
    v_fmac_f32 v202, s23, v198
    v_cvt_pk_bf16_f32 v202, v252, v202
    v_mfma_f32_16x16x32_bf16 v[28:31], a[196:199], v[236:239], v[28:31]
    v_fma_f32 v252, v249, s24, v251
    v_fmac_f32 v251, s25, v249
    v_mfma_f32_16x16x32_bf16 v[32:35], a[200:203], v[236:239], v[32:35]
    v_fma_f32 v249, v248, s24, v250
    v_fmac_f32 v250, s25, v248
    v_mfma_f32_16x16x32_bf16 v[12:15], a[204:207], v[236:239], v[12:15]
    v_fma_f32 v248, v250, s26, v251
    v_fmac_f32 v251, s27, v250
    v_mfma_f32_16x16x32_bf16 v[16:19], a[208:211], v[236:239], v[16:19]
    v_fma_f32 v250, v249, s28, v252
    v_fmac_f32 v252, s29, v249
    v_mfma_f32_16x16x32_bf16 v[20:23], a[212:215], v[236:239], v[20:23]
    v_fma_f32 v249, v196, s24, v200
    s_waitcnt vmcnt(15)
    v_mfma_f32_16x16x32_bf16 v[0:3], a[216:219], v[236:239], v[0:3]
    v_fmac_f32 v200, s25, v196
    v_fma_f32 v196, v194, s24, v198
    v_mfma_f32_16x16x32_bf16 v[4:7], a[220:223], v[236:239], v[4:7]
    v_fmac_f32 v198, s25, v194
    v_fma_f32 v194, v198, s26, v200
    v_mfma_f32_16x16x32_bf16 v[8:11], a[224:227], v[236:239], v[8:11]
    ds_read_b128 v[236:239], v253 offset:5984
    s_waitcnt lgkmcnt(2)
    v_mfma_f32_16x16x32_bf16 v[36:39], a[192:195], v[228:231], v[36:39]
    v_fmac_f32 v200, s27, v198
    v_mfma_f32_16x16x32_bf16 v[40:43], a[196:199], v[228:231], v[40:43]
    v_fma_f32 v198, v196, s28, v249
    v_fmac_f32 v249, s29, v196
    v_mfma_f32_16x16x32_bf16 v[44:47], a[200:203], v[228:231], v[44:47]
    s_add_u32 s49, s49, 8
    v_cvt_pk_bf16_f32 v194, v248, v194
    v_mfma_f32_16x16x32_bf16 v[24:27], a[204:207], v[228:231], v[24:27]
    v_cvt_pk_bf16_f32 v200, v251, v200
    v_cvt_pk_bf16_f32 v198, v250, v198
    v_mfma_f32_16x16x32_bf16 v[28:31], a[208:211], v[228:231], v[28:31]
    s_cmp_eq_u32 s39, 1
    s_cselect_b32 s49, 128, s49
    v_mfma_f32_16x16x32_bf16 v[32:35], a[212:215], v[228:231], v[32:35]
    v_cvt_pk_bf16_f32 v196, v252, v249
    v_lshlrev_b32 v248, 16, v195
    v_mfma_f32_16x16x32_bf16 v[12:15], a[216:219], v[228:231], v[12:15]
    s_lshl_b32 s43, s49, 2
    s_mul_i32 s43, s43, 196608
    s_add_u32 s43, s43, s53
    v_mfma_f32_16x16x32_bf16 v[16:19], a[220:223], v[228:231], v[16:19]
    s_cmp_ge_u32 s49, 128
    s_cselect_b32 s43, 2130706432, s43
    s_sub_u32 s16, s43, 196608
    v_mfma_f32_16x16x32_bf16 v[20:23], a[224:227], v[228:231], v[20:23]
    ds_read_b128 v[228:231], v253 offset:5728
    s_waitcnt lgkmcnt(2)
    v_mfma_f32_16x16x32_bf16 v[48:51], a[192:195], v[232:235], v[48:51]
    v_lshlrev_b32 v249, 16, v197
    v_lshlrev_b32 v250, 16, v199
    v_mfma_f32_16x16x32_bf16 v[52:55], a[196:199], v[232:235], v[52:55]
    s_cmp_eq_u32 s49, 0
    s_cselect_b32 s16, 2130706432, s16
    s_mov_b32 s17, s43
    v_mfma_f32_16x16x32_bf16 v[56:59], a[200:203], v[232:235], v[56:59]
    s_add_u32 s18, s43, 196608
    v_lshlrev_b32 v251, 16, v201
    v_mfma_f32_16x16x32_bf16 v[36:39], a[204:207], v[232:235], v[36:39]
    s_add_u32 s19, s43, 393216
    v_and_b32 v195, s22, v195
    v_mfma_f32_16x16x32_bf16 v[40:43], a[208:211], v[232:235], v[40:43]
    s_add_u32 s20, s43, 589824
    v_and_b32 v197, s22, v197
    v_mfma_f32_16x16x32_bf16 v[44:47], a[212:215], v[232:235], v[44:47]
    s_add_u32 s21, s43, 786432
    v_and_b32 v199, s22, v199
    v_mfma_f32_16x16x32_bf16 v[24:27], a[216:219], v[232:235], v[24:27]
    v_and_b32 v201, s22, v201
    v_lshlrev_b32 v252, 16, v193
    v_mfma_f32_16x16x32_bf16 v[28:31], a[220:223], v[232:235], v[28:31]
    v_and_b32 v193, s22, v193
    v_mfma_f32_16x16x32_bf16 v[32:35], a[224:227], v[232:235], v[32:35]
    ds_read_b128 v[232:235], v253 offset:5472
    s_waitcnt lgkmcnt(2)
    v_mfma_f32_16x16x32_bf16 v[60:63], a[192:195], v[236:239], v[60:63]
    v_add_f32 v252, v252, v251
    v_add_f32 v193, v193, v201
    v_mfma_f32_16x16x32_bf16 v[64:67], a[196:199], v[236:239], v[64:67]
    v_fmac_f32 v252, s23, v249
    v_fmac_f32 v193, s23, v197
    v_mfma_f32_16x16x32_bf16 v[68:71], a[200:203], v[236:239], v[68:71]
    v_cvt_pk_bf16_f32 v193, v252, v193
    v_lshlrev_b32 v252, 16, v203
    v_mfma_f32_16x16x32_bf16 v[48:51], a[204:207], v[236:239], v[48:51]
    v_and_b32 v203, s22, v203
    v_add_f32 v252, v252, v248
    v_mfma_f32_16x16x32_bf16 v[52:55], a[208:211], v[236:239], v[52:55]
    v_add_f32 v203, v203, v195
    v_fmac_f32 v252, s23, v250
    v_mfma_f32_16x16x32_bf16 v[56:59], a[212:215], v[236:239], v[56:59]
    v_fmac_f32 v203, s23, v199
    v_cvt_pk_bf16_f32 v203, v252, v203
    v_mfma_f32_16x16x32_bf16 v[36:39], a[216:219], v[236:239], v[36:39]
    v_fma_f32 v252, v249, s24, v251
    v_fmac_f32 v251, s25, v249
    v_mfma_f32_16x16x32_bf16 v[40:43], a[220:223], v[236:239], v[40:43]
    v_fma_f32 v249, v248, s24, v250
    v_fmac_f32 v250, s25, v248
    v_mfma_f32_16x16x32_bf16 v[44:47], a[224:227], v[236:239], v[44:47]
    ds_read_b128 v[236:239], v253 offset:5216
    s_waitcnt lgkmcnt(2)
    v_mfma_f32_16x16x32_bf16 v[72:75], a[192:195], v[228:231], v[72:75]
    v_fma_f32 v248, v250, s26, v251
    v_fmac_f32 v251, s27, v250
    v_mfma_f32_16x16x32_bf16 v[76:79], a[196:199], v[228:231], v[76:79]
    v_fma_f32 v250, v249, s28, v252
    v_fmac_f32 v252, s29, v249
    v_mfma_f32_16x16x32_bf16 v[80:83], a[200:203], v[228:231], v[80:83]
    v_fma_f32 v249, v197, s24, v201
    v_mfma_f32_16x16x32_bf16 v[60:63], a[204:207], v[228:231], v[60:63]
    v_fmac_f32 v201, s25, v197
    v_fma_f32 v197, v195, s24, v199
    v_mfma_f32_16x16x32_bf16 v[64:67], a[208:211], v[228:231], v[64:67]
    v_fmac_f32 v199, s25, v195
    v_fma_f32 v195, v199, s26, v201
    v_mfma_f32_16x16x32_bf16 v[68:71], a[212:215], v[228:231], v[68:71]
    v_fmac_f32 v201, s27, v199
    v_fma_f32 v199, v197, s28, v249
    v_mfma_f32_16x16x32_bf16 v[48:51], a[216:219], v[228:231], v[48:51]
    v_fmac_f32 v249, s29, v197
    v_cvt_pk_bf16_f32 v195, v248, v195
    v_mfma_f32_16x16x32_bf16 v[52:55], a[220:223], v[228:231], v[52:55]
    v_cvt_pk_bf16_f32 v201, v251, v201
    v_cvt_pk_bf16_f32 v199, v250, v199
    v_mfma_f32_16x16x32_bf16 v[56:59], a[224:227], v[228:231], v[56:59]
    ds_read_b128 v[228:231], v253 offset:4944
    s_waitcnt lgkmcnt(2)
    v_mfma_f32_16x16x32_bf16 v[84:87], a[192:195], v[232:235], v[84:87]
    v_cvt_pk_bf16_f32 v197, v252, v249
    v_lshrrev_b32 v252, 15, v255
    v_mfma_f32_16x16x32_bf16 v[88:91], a[196:199], v[232:235], v[88:91]
    ds_write_b64 v252, v[194:195] offset:8576
    ds_write_b64 v252, v[200:201] offset:10656
    v_mfma_f32_16x16x32_bf16 v[92:95], a[200:203], v[232:235], v[92:95]
    ds_write_b64 v252, v[198:199] offset:12736
    ds_write_b64 v252, v[192:193] offset:14816
    v_mfma_f32_16x16x32_bf16 v[72:75], a[204:207], v[232:235], v[72:75]
    s_mov_b32 s42, 737280
    buffer_load_dwordx4 a[192:195], v254, s[8:11], s42 offen offset:0
    v_mfma_f32_16x16x32_bf16 v[76:79], a[208:211], v[232:235], v[76:79]
    ds_write_b64 v252, v[202:203] offset:29376
    ds_write_b64 v252, v[196:197] offset:256
    v_mfma_f32_16x16x32_bf16 v[80:83], a[212:215], v[232:235], v[80:83]
    buffer_load_dwordx4 a[196:199], v254, s[8:11], s42 offen offset:1024
    v_mfma_f32_16x16x32_bf16 v[60:63], a[216:219], v[232:235], v[60:63]
    v_mfma_f32_16x16x32_bf16 v[64:67], a[220:223], v[232:235], v[64:67]
    buffer_load_dwordx4 a[200:203], v254, s[8:11], s42 offen offset:2048
    v_mfma_f32_16x16x32_bf16 v[68:71], a[224:227], v[232:235], v[68:71]
    ds_read_b128 v[232:235], v253 offset:7280
    s_waitcnt lgkmcnt(8)
    v_mfma_f32_16x16x32_bf16 v[84:87], a[204:207], v[236:239], v[84:87]
    s_waitcnt vmcnt(12)
    v_lshlrev_b32 v248, 16, v206
    v_lshlrev_b32 v249, 16, v208
    v_lshlrev_b32 v250, 16, v210
    v_mfma_f32_16x16x32_bf16 v[88:91], a[208:211], v[236:239], v[88:91]
    v_lshlrev_b32 v251, 16, v212
    v_and_b32 v206, s22, v206
    v_mfma_f32_16x16x32_bf16 v[92:95], a[212:215], v[236:239], v[92:95]
    s_mov_b32 s42, 740352
    buffer_load_dwordx4 a[204:207], v254, s[8:11], s42 offen offset:0
    v_mfma_f32_16x16x32_bf16 v[72:75], a[216:219], v[236:239], v[72:75]
    v_and_b32 v208, s22, v208
    v_and_b32 v210, s22, v210
    v_mfma_f32_16x16x32_bf16 v[76:79], a[220:223], v[236:239], v[76:79]
    buffer_load_dwordx4 a[208:211], v254, s[8:11], s42 offen offset:1024
    v_and_b32 v212, s22, v212
    v_mfma_f32_16x16x32_bf16 v[80:83], a[224:227], v[236:239], v[80:83]
    ds_read_b128 v[236:239], v253 offset:7008
    s_waitcnt lgkmcnt(8)
    v_mfma_f32_16x16x32_bf16 v[84:87], a[216:219], v[228:231], v[84:87]
    buffer_load_dwordx4 a[212:215], v254, s[8:11], s42 offen offset:2048
    v_lshlrev_b32 v252, 16, v204
    v_mfma_f32_16x16x32_bf16 v[88:91], a[220:223], v[228:231], v[88:91]
    v_and_b32 v204, s22, v204
    v_add_f32 v252, v252, v251
    v_mfma_f32_16x16x32_bf16 v[92:95], a[224:227], v[228:231], v[92:95]
    ds_read_b128 v[228:231], v253 offset:6752
    s_mov_b32 s42, 743424
    buffer_load_dwordx4 a[216:219], v254, s[8:11], s42 offen offset:0
    s_waitcnt vmcnt(13) lgkmcnt(2)
    v_mfma_f32_16x16x32_bf16 v[96:99], a[228:231], v[232:235], v[96:99]
    v_add_f32 v204, v204, v212
    v_fmac_f32 v252, s23, v249
    v_mfma_f32_16x16x32_bf16 v[100:103], a[232:235], v[232:235], v[100:103]
    buffer_load_dwordx4 a[220:223], v254, s[8:11], s42 offen offset:1024
    v_fmac_f32 v204, s23, v208
    v_mfma_f32_16x16x32_bf16 v[104:107], a[236:239], v[232:235], v[104:107]
    ds_read_b128 v[232:235], v253 offset:6496
    s_waitcnt lgkmcnt(2)
    v_mfma_f32_16x16x32_bf16 v[108:111], a[228:231], v[236:239], v[108:111]
    buffer_load_dwordx4 a[224:227], v254, s[8:11], s42 offen offset:2048
    v_cvt_pk_bf16_f32 v204, v252, v204
    v_mfma_f32_16x16x32_bf16 v[112:115], a[232:235], v[236:239], v[112:115]
    v_lshlrev_b32 v252, 16, v214
    v_and_b32 v214, s22, v214
    v_mfma_f32_16x16x32_bf16 v[116:119], a[236:239], v[236:239], v[116:119]
    v_and_b32 v203, 0xf0, v254
    s_waitcnt vmcnt(12)
    v_mfma_f32_16x16x32_bf16 v[96:99], a[240:243], v[236:239], v[96:99]
    v_lshrrev_b32 v203, 1, v203
    v_add_f32 v252, v252, v248
    v_mfma_f32_16x16x32_bf16 v[100:103], a[244:247], v[236:239], v[100:103]
    v_add_u32 v203, s52, v203
    v_add_f32 v214, v214, v206
    v_mfma_f32_16x16x32_bf16 v[104:107], a[248:251], v[236:239], v[104:107]
    ds_read_b128 v[236:239], v253 offset:6240
    s_waitcnt lgkmcnt(2)
    v_mfma_f32_16x16x32_bf16 v[120:123], a[228:231], v[228:231], v[120:123]
    v_mov_b32 v202, s54
    v_fmac_f32 v252, s23, v250
    v_mfma_f32_16x16x32_bf16 v[124:127], a[232:235], v[228:231], v[124:127]
    v_mov_b32 v201, s55
    v_fmac_f32 v214, s23, v210
    v_mfma_f32_16x16x32_bf16 v[128:131], a[236:239], v[228:231], v[128:131]
    v_cndmask_b32 v202, v202, v201, s[56:57]
    v_cvt_pk_bf16_f32 v214, v252, v214
    v_mfma_f32_16x16x32_bf16 v[108:111], a[240:243], v[228:231], v[108:111]
    v_add_u32 v203, v203, v202
    v_fma_f32 v252, v249, s24, v251
    v_mfma_f32_16x16x32_bf16 v[112:115], a[244:247], v[228:231], v[112:115]
    s_sub_u32 s45, s16, s50
    buffer_load_dwordx2 v[192:193], v203, s[4:7], s45 offen
    v_mfma_f32_16x16x32_bf16 v[116:119], a[248:251], v[228:231], v[116:119]
    v_fmac_f32 v251, s25, v249
    s_waitcnt vmcnt(10)
    v_mfma_f32_16x16x32_bf16 v[96:99], a[252:255], v[228:231], v[96:99]
    s_sub_u32 s45, s17, s50
    buffer_load_dwordx2 v[194:195], v203, s[4:7], s45 offen
    v_mfma_f32_16x16x32_bf16 v[100:103], v[240:243], v[228:231], v[100:103]
    v_fma_f32 v249, v248, s24, v250
    v_fmac_f32 v250, s25, v248
    v_mfma_f32_16x16x32_bf16 v[104:107], v[244:247], v[228:231], v[104:107]
    ds_read_b128 v[228:231], v253 offset:8064
    s_waitcnt lgkmcnt(2)
    v_mfma_f32_16x16x32_bf16 v[132:135], a[228:231], v[232:235], v[132:135]
    s_sub_u32 s45, s18, s50
    buffer_load_dwordx2 v[196:197], v203, s[4:7], s45 offen
    v_mfma_f32_16x16x32_bf16 v[136:139], a[232:235], v[232:235], v[136:139]
    v_fma_f32 v248, v250, s26, v251
    v_fmac_f32 v251, s27, v250
    v_mfma_f32_16x16x32_bf16 v[140:143], a[236:239], v[232:235], v[140:143]
    s_sub_u32 s45, s19, s50
    buffer_load_dwordx2 v[198:199], v203, s[4:7], s45 offen
    v_mfma_f32_16x16x32_bf16 v[120:123], a[240:243], v[232:235], v[120:123]
    v_fma_f32 v250, v249, s28, v252
    v_fmac_f32 v252, s29, v249
    v_mfma_f32_16x16x32_bf16 v[124:127], a[244:247], v[232:235], v[124:127]
    s_sub_u32 s45, s20, s50
    buffer_load_dwordx2 v[200:201], v203, s[4:7], s45 offen
    v_mfma_f32_16x16x32_bf16 v[128:131], a[248:251], v[232:235], v[128:131]
    v_fma_f32 v249, v208, s24, v212
    v_fmac_f32 v212, s25, v208
    v_mfma_f32_16x16x32_bf16 v[108:111], a[252:255], v[232:235], v[108:111]
    s_sub_u32 s45, s21, s50
    buffer_load_dwordx2 v[202:203], v203, s[4:7], s45 offen
    v_mfma_f32_16x16x32_bf16 v[112:115], v[240:243], v[232:235], v[112:115]
    v_fma_f32 v208, v206, s24, v210
    v_fmac_f32 v210, s25, v206
    v_mfma_f32_16x16x32_bf16 v[116:119], v[244:247], v[232:235], v[116:119]
    ds_read_b128 v[232:235], v253 offset:7808
    s_waitcnt lgkmcnt(2)
    v_mfma_f32_16x16x32_bf16 v[144:147], a[228:231], v[236:239], v[144:147]
    v_fma_f32 v206, v210, s26, v212
    v_fmac_f32 v212, s27, v210
    v_mfma_f32_16x16x32_bf16 v[148:151], a[232:235], v[236:239], v[148:151]
    v_fma_f32 v210, v208, s28, v249
    v_fmac_f32 v249, s29, v208
    v_mfma_f32_16x16x32_bf16 v[152:155], a[236:239], v[236:239], v[152:155]
    v_cvt_pk_bf16_f32 v206, v248, v206
    v_cvt_pk_bf16_f32 v212, v251, v212
    v_mfma_f32_16x16x32_bf16 v[132:135], a[240:243], v[236:239], v[132:135]
    v_cvt_pk_bf16_f32 v210, v250, v210
    v_cvt_pk_bf16_f32 v208, v252, v249
    v_mfma_f32_16x16x32_bf16 v[136:139], a[244:247], v[236:239], v[136:139]
    v_lshlrev_b32 v248, 16, v207
    v_lshlrev_b32 v249, 16, v209
    v_mfma_f32_16x16x32_bf16 v[140:143], a[248:251], v[236:239], v[140:143]
    v_lshlrev_b32 v250, 16, v211
    v_lshlrev_b32 v251, 16, v213
    v_mfma_f32_16x16x32_bf16 v[120:123], a[252:255], v[236:239], v[120:123]
    v_and_b32 v207, s22, v207
    v_and_b32 v209, s22, v209
    v_mfma_f32_16x16x32_bf16 v[124:127], v[240:243], v[236:239], v[124:127]
    v_and_b32 v211, s22, v211
    v_and_b32 v213, s22, v213
    v_mfma_f32_16x16x32_bf16 v[128:131], v[244:247], v[236:239], v[128:131]
    ds_read_b128 v[236:239], v253 offset:7552
    s_waitcnt lgkmcnt(2)
    v_mfma_f32_16x16x32_bf16 v[156:159], a[228:231], v[228:231], v[156:159]
    v_lshlrev_b32 v252, 16, v205
    v_and_b32 v205, s22, v205
    v_mfma_f32_16x16x32_bf16 v[160:163], a[232:235], v[228:231], v[160:163]
    v_add_f32 v252, v252, v251
    v_add_f32 v205, v205, v213
    v_mfma_f32_16x16x32_bf16 v[164:167], a[236:239], v[228:231], v[164:167]
    v_fmac_f32 v252, s23, v249
    v_fmac_f32 v205, s23, v209
    v_mfma_f32_16x16x32_bf16 v[144:147], a[240:243], v[228:231], v[144:147]
    v_cvt_pk_bf16_f32 v205, v252, v205
    v_lshlrev_b32 v252, 16, v215
    v_mfma_f32_16x16x32_bf16 v[148:151], a[244:247], v[228:231], v[148:151]
    v_and_b32 v215, s22, v215
    v_add_f32 v252, v252, v248
    v_mfma_f32_16x16x32_bf16 v[152:155], a[248:251], v[228:231], v[152:155]
    v_add_f32 v215, v215, v207
    v_fmac_f32 v252, s23, v250
    v_mfma_f32_16x16x32_bf16 v[132:135], a[252:255], v[228:231], v[132:135]
    v_fmac_f32 v215, s23, v211
    v_cvt_pk_bf16_f32 v215, v252, v215
    v_mfma_f32_16x16x32_bf16 v[136:139], v[240:243], v[228:231], v[136:139]
    v_fma_f32 v252, v249, s24, v251
    v_fmac_f32 v251, s25, v249
    v_mfma_f32_16x16x32_bf16 v[140:143], v[244:247], v[228:231], v[140:143]
    ds_read_b128 v[228:231], v253 offset:7296
    s_waitcnt lgkmcnt(2)
    v_mfma_f32_16x16x32_bf16 v[168:171], a[228:231], v[232:235], v[168:171]
    v_fma_f32 v249, v248, s24, v250
    v_fmac_f32 v250, s25, v248
    v_mfma_f32_16x16x32_bf16 v[172:175], a[232:235], v[232:235], v[172:175]
    v_fma_f32 v248, v250, s26, v251
    v_fmac_f32 v251, s27, v250
    v_mfma_f32_16x16x32_bf16 v[176:179], a[236:239], v[232:235], v[176:179]
    v_fma_f32 v250, v249, s28, v252
    v_fmac_f32 v252, s29, v249
    v_mfma_f32_16x16x32_bf16 v[156:159], a[240:243], v[232:235], v[156:159]
    v_fma_f32 v249, v209, s24, v213
    v_fmac_f32 v213, s25, v209
    v_mfma_f32_16x16x32_bf16 v[160:163], a[244:247], v[232:235], v[160:163]
    v_fma_f32 v209, v207, s24, v211
    v_fmac_f32 v211, s25, v207
    v_mfma_f32_16x16x32_bf16 v[164:167], a[248:251], v[232:235], v[164:167]
    v_fma_f32 v207, v211, s26, v213
    v_fmac_f32 v213, s27, v211
    v_mfma_f32_16x16x32_bf16 v[144:147], a[252:255], v[232:235], v[144:147]
    v_fma_f32 v211, v209, s28, v249
    v_fmac_f32 v249, s29, v209
    v_mfma_f32_16x16x32_bf16 v[148:151], v[240:243], v[232:235], v[148:151]
    v_cvt_pk_bf16_f32 v207, v248, v207
    v_cvt_pk_bf16_f32 v213, v251, v213
    v_mfma_f32_16x16x32_bf16 v[152:155], v[244:247], v[232:235], v[152:155]
    ds_read_b128 v[232:235], v253 offset:7024
    s_waitcnt lgkmcnt(2)
    v_mfma_f32_16x16x32_bf16 v[180:183], a[228:231], v[236:239], v[180:183]
    v_cvt_pk_bf16_f32 v211, v250, v211
    v_cvt_pk_bf16_f32 v209, v252, v249
    v_mfma_f32_16x16x32_bf16 v[184:187], a[232:235], v[236:239], v[184:187]
    v_lshrrev_b32 v252, 15, v255
    ds_write_b64 v252, v[206:207] offset:8320
    v_mfma_f32_16x16x32_bf16 v[188:191], a[236:239], v[236:239], v[188:191]
    ds_write_b64 v252, v[212:213] offset:10400
    ds_write_b64 v252, v[210:211] offset:12480
    v_mfma_f32_16x16x32_bf16 v[168:171], a[240:243], v[236:239], v[168:171]
    s_mov_b32 s42, 774144
    buffer_load_dwordx4 a[228:231], v254, s[8:11], s42 offen offset:0
    v_mfma_f32_16x16x32_bf16 v[172:175], a[244:247], v[236:239], v[172:175]
    ds_write_b64 v252, v[204:205] offset:14560
    ds_write_b64 v252, v[214:215] offset:29120
    v_mfma_f32_16x16x32_bf16 v[176:179], a[248:251], v[236:239], v[176:179]
    buffer_load_dwordx4 a[232:235], v254, s[8:11], s42 offen offset:1024
    ds_write_b64 v252, v[208:209] offset:0
    v_mfma_f32_16x16x32_bf16 v[156:159], a[252:255], v[236:239], v[156:159]
    v_mfma_f32_16x16x32_bf16 v[160:163], v[240:243], v[236:239], v[160:163]
    buffer_load_dwordx4 a[236:239], v254, s[8:11], s42 offen offset:2048
    v_mfma_f32_16x16x32_bf16 v[164:167], v[244:247], v[236:239], v[164:167]
    s_waitcnt lgkmcnt(0)
    s_barrier
    ds_read_b128 v[236:239], v253 offset:9360
    v_mfma_f32_16x16x32_bf16 v[180:183], a[240:243], v[228:231], v[180:183]
    v_mfma_f32_16x16x32_bf16 v[184:187], a[244:247], v[228:231], v[184:187]
    v_mfma_f32_16x16x32_bf16 v[188:191], a[248:251], v[228:231], v[188:191]
    s_mov_b32 s42, 777216
    buffer_load_dwordx4 a[240:243], v254, s[8:11], s42 offen offset:0
    v_mfma_f32_16x16x32_bf16 v[168:171], a[252:255], v[228:231], v[168:171]
    v_mfma_f32_16x16x32_bf16 v[172:175], v[240:243], v[228:231], v[172:175]
    buffer_load_dwordx4 a[244:247], v254, s[8:11], s42 offen offset:1024
    v_mfma_f32_16x16x32_bf16 v[176:179], v[244:247], v[228:231], v[176:179]
    ds_read_b128 v[228:231], v253 offset:9088
    v_mfma_f32_16x16x32_bf16 v[180:183], a[252:255], v[232:235], v[180:183]
    buffer_load_dwordx4 a[248:251], v254, s[8:11], s42 offen offset:2048
    v_mfma_f32_16x16x32_bf16 v[184:187], v[240:243], v[232:235], v[184:187]
    v_mfma_f32_16x16x32_bf16 v[188:191], v[244:247], v[232:235], v[188:191]
    ds_read_b128 v[232:235], v253 offset:8832
    s_mov_b32 s42, 780288
    buffer_load_dwordx4 a[252:255], v254, s[8:11], s42 offen offset:0
    s_waitcnt vmcnt(19) lgkmcnt(2)
    v_mfma_f32_16x16x32_bf16 a[0:3], a[192:195], v[236:239], a[0:3]
    v_mfma_f32_16x16x32_bf16 a[4:7], a[196:199], v[236:239], a[4:7]
    buffer_load_dwordx4 v[240:243], v254, s[8:11], s42 offen offset:1024
    v_mfma_f32_16x16x32_bf16 a[8:11], a[200:203], v[236:239], a[8:11]
    ds_read_b128 v[236:239], v253 offset:8576
    s_waitcnt lgkmcnt(2)
    v_mfma_f32_16x16x32_bf16 a[12:15], a[192:195], v[228:231], a[12:15]
    buffer_load_dwordx4 v[244:247], v254, s[8:11], s42 offen offset:2048
    v_mfma_f32_16x16x32_bf16 a[16:19], a[196:199], v[228:231], a[16:19]
    v_mfma_f32_16x16x32_bf16 a[20:23], a[200:203], v[228:231], a[20:23]
    s_waitcnt vmcnt(18)
    v_mfma_f32_16x16x32_bf16 a[0:3], a[204:207], v[228:231], a[0:3]
    v_mfma_f32_16x16x32_bf16 a[4:7], a[208:211], v[228:231], a[4:7]
    v_mfma_f32_16x16x32_bf16 a[8:11], a[212:215], v[228:231], a[8:11]
    ds_read_b128 v[228:231], v253 offset:8320
    s_waitcnt lgkmcnt(2)
    v_mfma_f32_16x16x32_bf16 a[24:27], a[192:195], v[232:235], a[24:27]
    v_mfma_f32_16x16x32_bf16 a[28:31], a[196:199], v[232:235], a[28:31]
    v_mfma_f32_16x16x32_bf16 a[32:35], a[200:203], v[232:235], a[32:35]
    v_mfma_f32_16x16x32_bf16 a[12:15], a[204:207], v[232:235], a[12:15]
    v_mfma_f32_16x16x32_bf16 a[16:19], a[208:211], v[232:235], a[16:19]
    v_mfma_f32_16x16x32_bf16 a[20:23], a[212:215], v[232:235], a[20:23]
    s_waitcnt vmcnt(15)
    v_mfma_f32_16x16x32_bf16 a[0:3], a[216:219], v[232:235], a[0:3]
    v_mfma_f32_16x16x32_bf16 a[4:7], a[220:223], v[232:235], a[4:7]
    v_mfma_f32_16x16x32_bf16 a[8:11], a[224:227], v[232:235], a[8:11]
    ds_read_b128 v[232:235], v253 offset:10144
    s_waitcnt lgkmcnt(2)
    v_mfma_f32_16x16x32_bf16 a[36:39], a[192:195], v[236:239], a[36:39]
    v_mfma_f32_16x16x32_bf16 a[40:43], a[196:199], v[236:239], a[40:43]
    v_mfma_f32_16x16x32_bf16 a[44:47], a[200:203], v[236:239], a[44:47]
    v_mfma_f32_16x16x32_bf16 a[24:27], a[204:207], v[236:239], a[24:27]
    v_mfma_f32_16x16x32_bf16 a[28:31], a[208:211], v[236:239], a[28:31]
    v_mfma_f32_16x16x32_bf16 a[32:35], a[212:215], v[236:239], a[32:35]
    v_mfma_f32_16x16x32_bf16 a[12:15], a[216:219], v[236:239], a[12:15]
    v_mfma_f32_16x16x32_bf16 a[16:19], a[220:223], v[236:239], a[16:19]
    v_mfma_f32_16x16x32_bf16 a[20:23], a[224:227], v[236:239], a[20:23]
    ds_read_b128 v[236:239], v253 offset:9888
    s_waitcnt lgkmcnt(2)
    v_mfma_f32_16x16x32_bf16 a[48:51], a[192:195], v[228:231], a[48:51]
    v_mfma_f32_16x16x32_bf16 a[52:55], a[196:199], v[228:231], a[52:55]
    v_mfma_f32_16x16x32_bf16 a[56:59], a[200:203], v[228:231], a[56:59]
    v_mfma_f32_16x16x32_bf16 a[36:39], a[204:207], v[228:231], a[36:39]
    v_mfma_f32_16x16x32_bf16 a[40:43], a[208:211], v[228:231], a[40:43]
    v_mfma_f32_16x16x32_bf16 a[44:47], a[212:215], v[228:231], a[44:47]
    v_mfma_f32_16x16x32_bf16 a[24:27], a[216:219], v[228:231], a[24:27]
    v_mfma_f32_16x16x32_bf16 a[28:31], a[220:223], v[228:231], a[28:31]
    v_mfma_f32_16x16x32_bf16 a[32:35], a[224:227], v[228:231], a[32:35]
    ds_read_b128 v[228:231], v253 offset:9632
    s_waitcnt lgkmcnt(2)
    v_mfma_f32_16x16x32_bf16 a[60:63], a[192:195], v[232:235], a[60:63]
    v_mfma_f32_16x16x32_bf16 a[64:67], a[196:199], v[232:235], a[64:67]
    v_mfma_f32_16x16x32_bf16 a[68:71], a[200:203], v[232:235], a[68:71]
    v_mfma_f32_16x16x32_bf16 a[48:51], a[204:207], v[232:235], a[48:51]
    v_mfma_f32_16x16x32_bf16 a[52:55], a[208:211], v[232:235], a[52:55]
    v_mfma_f32_16x16x32_bf16 a[56:59], a[212:215], v[232:235], a[56:59]
    v_mfma_f32_16x16x32_bf16 a[36:39], a[216:219], v[232:235], a[36:39]
    v_mfma_f32_16x16x32_bf16 a[40:43], a[220:223], v[232:235], a[40:43]
    v_mfma_f32_16x16x32_bf16 a[44:47], a[224:227], v[232:235], a[44:47]
    ds_read_b128 v[232:235], v253 offset:9376
    s_waitcnt lgkmcnt(2)
    v_mfma_f32_16x16x32_bf16 a[72:75], a[192:195], v[236:239], a[72:75]
    v_mfma_f32_16x16x32_bf16 a[76:79], a[196:199], v[236:239], a[76:79]
    v_mfma_f32_16x16x32_bf16 a[80:83], a[200:203], v[236:239], a[80:83]
    v_mfma_f32_16x16x32_bf16 a[60:63], a[204:207], v[236:239], a[60:63]
    v_mfma_f32_16x16x32_bf16 a[64:67], a[208:211], v[236:239], a[64:67]
    v_mfma_f32_16x16x32_bf16 a[68:71], a[212:215], v[236:239], a[68:71]
    v_mfma_f32_16x16x32_bf16 a[48:51], a[216:219], v[236:239], a[48:51]
    v_mfma_f32_16x16x32_bf16 a[52:55], a[220:223], v[236:239], a[52:55]
    v_mfma_f32_16x16x32_bf16 a[56:59], a[224:227], v[236:239], a[56:59]
    ds_read_b128 v[236:239], v253 offset:9104
    s_waitcnt lgkmcnt(2)
    v_mfma_f32_16x16x32_bf16 a[84:87], a[192:195], v[228:231], a[84:87]
    v_mfma_f32_16x16x32_bf16 a[88:91], a[196:199], v[228:231], a[88:91]
    v_mfma_f32_16x16x32_bf16 a[92:95], a[200:203], v[228:231], a[92:95]
    v_mfma_f32_16x16x32_bf16 a[72:75], a[204:207], v[228:231], a[72:75]
    s_mov_b32 s42, 811008
    buffer_load_dwordx4 a[192:195], v254, s[8:11], s42 offen offset:0
    v_mfma_f32_16x16x32_bf16 a[76:79], a[208:211], v[228:231], a[76:79]
    v_mfma_f32_16x16x32_bf16 a[80:83], a[212:215], v[228:231], a[80:83]
    buffer_load_dwordx4 a[196:199], v254, s[8:11], s42 offen offset:1024
    v_mfma_f32_16x16x32_bf16 a[60:63], a[216:219], v[228:231], a[60:63]
    v_mfma_f32_16x16x32_bf16 a[64:67], a[220:223], v[228:231], a[64:67]
    buffer_load_dwordx4 a[200:203], v254, s[8:11], s42 offen offset:2048
    v_mfma_f32_16x16x32_bf16 a[68:71], a[224:227], v[228:231], a[68:71]
    ds_read_b128 v[228:231], v253 offset:11440
    s_waitcnt lgkmcnt(2)
    v_mfma_f32_16x16x32_bf16 a[84:87], a[204:207], v[232:235], a[84:87]
    s_waitcnt vmcnt(12)
    v_lshlrev_b32 v248, 16, v194
    v_lshlrev_b32 v249, 16, v196
    v_mfma_f32_16x16x32_bf16 a[88:91], a[208:211], v[232:235], a[88:91]
    v_lshlrev_b32 v250, 16, v198
    v_lshlrev_b32 v251, 16, v200
    v_mfma_f32_16x16x32_bf16 a[92:95], a[212:215], v[232:235], a[92:95]
    s_mov_b32 s42, 814080
    buffer_load_dwordx4 a[204:207], v254, s[8:11], s42 offen offset:0
    v_mfma_f32_16x16x32_bf16 a[72:75], a[216:219], v[232:235], a[72:75]
    v_and_b32 v194, s22, v194
    v_and_b32 v196, s22, v196
    v_mfma_f32_16x16x32_bf16 a[76:79], a[220:223], v[232:235], a[76:79]
    buffer_load_dwordx4 a[208:211], v254, s[8:11], s42 offen offset:1024
    v_and_b32 v198, s22, v198
    v_mfma_f32_16x16x32_bf16 a[80:83], a[224:227], v[232:235], a[80:83]
    ds_read_b128 v[232:235], v253 offset:11168
    s_waitcnt lgkmcnt(2)
    v_mfma_f32_16x16x32_bf16 a[84:87], a[216:219], v[236:239], a[84:87]
    buffer_load_dwordx4 a[212:215], v254, s[8:11], s42 offen offset:2048
    v_and_b32 v200, s22, v200
    v_mfma_f32_16x16x32_bf16 a[88:91], a[220:223], v[236:239], a[88:91]
    v_lshlrev_b32 v252, 16, v192
    v_and_b32 v192, s22, v192
    v_mfma_f32_16x16x32_bf16 a[92:95], a[224:227], v[236:239], a[92:95]
    ds_read_b128 v[236:239], v253 offset:10912
    s_mov_b32 s42, 817152
    buffer_load_dwordx4 a[216:219], v254, s[8:11], s42 offen offset:0
    s_waitcnt vmcnt(13) lgkmcnt(2)
    v_mfma_f32_16x16x32_bf16 a[96:99], a[228:231], v[228:231], a[96:99]
    v_add_f32 v252, v252, v251
    v_add_f32 v192, v192, v200
    v_mfma_f32_16x16x32_bf16 a[100:103], a[232:235], v[228:231], a[100:103]
    buffer_load_dwordx4 a[220:223], v254, s[8:11], s42 offen offset:1024
    v_fmac_f32 v252, s23, v249
    v_mfma_f32_16x16x32_bf16 a[104:107], a[236:239], v[228:231], a[104:107]
    ds_read_b128 v[228:231], v253 offset:10656
    s_waitcnt lgkmcnt(2)
    v_mfma_f32_16x16x32_bf16 a[108:111], a[228:231], v[232:235], a[108:111]
    buffer_load_dwordx4 a[224:227], v254, s[8:11], s42 offen offset:2048
    v_fmac_f32 v192, s23, v196
    v_mfma_f32_16x16x32_bf16 a[112:115], a[232:235], v[232:235], a[112:115]
    v_cvt_pk_bf16_f32 v192, v252, v192
    v_lshlrev_b32 v252, 16, v202
    v_mfma_f32_16x16x32_bf16 a[116:119], a[236:239], v[232:235], a[116:119]
    v_and_b32 v202, s22, v202
    s_waitcnt vmcnt(12)
    v_mfma_f32_16x16x32_bf16 a[96:99], a[240:243], v[232:235], a[96:99]
    v_add_f32 v252, v252, v248
    v_add_f32 v202, v202, v194
    v_mfma_f32_16x16x32_bf16 a[100:103], a[244:247], v[232:235], a[100:103]
    v_fmac_f32 v252, s23, v250
    v_fmac_f32 v202, s23, v198
    v_mfma_f32_16x16x32_bf16 a[104:107], a[248:251], v[232:235], a[104:107]
    ds_read_b128 v[232:235], v253 offset:10400
    s_waitcnt lgkmcnt(2)
    v_mfma_f32_16x16x32_bf16 a[120:123], a[228:231], v[236:239], a[120:123]
    v_cvt_pk_bf16_f32 v202, v252, v202
    v_fma_f32 v252, v249, s24, v251
    v_mfma_f32_16x16x32_bf16 a[124:127], a[232:235], v[236:239], a[124:127]
    v_fmac_f32 v251, s25, v249
    v_fma_f32 v249, v248, s24, v250
    v_mfma_f32_16x16x32_bf16 a[128:131], a[236:239], v[236:239], a[128:131]
    v_fmac_f32 v250, s25, v248
    v_fma_f32 v248, v250, s26, v251
    v_mfma_f32_16x16x32_bf16 a[108:111], a[240:243], v[236:239], a[108:111]
    v_fmac_f32 v251, s27, v250
    v_fma_f32 v250, v249, s28, v252
    v_mfma_f32_16x16x32_bf16 a[112:115], a[244:247], v[236:239], a[112:115]
    v_fmac_f32 v252, s29, v249
    v_fma_f32 v249, v196, s24, v200
    v_mfma_f32_16x16x32_bf16 a[116:119], a[248:251], v[236:239], a[116:119]
    v_fmac_f32 v200, s25, v196
    s_waitcnt vmcnt(9)
    v_mfma_f32_16x16x32_bf16 a[96:99], a[252:255], v[236:239], a[96:99]
    v_fma_f32 v196, v194, s24, v198
    v_mfma_f32_16x16x32_bf16 a[100:103], v[240:243], v[236:239], a[100:103]
    v_fmac_f32 v198, s25, v194
    v_fma_f32 v194, v198, s26, v200
    v_mfma_f32_16x16x32_bf16 a[104:107], v[244:247], v[236:239], a[104:107]
    ds_read_b128 v[236:239], v253 offset:12224
    s_waitcnt lgkmcnt(2)
    v_mfma_f32_16x16x32_bf16 a[132:135], a[228:231], v[228:231], a[132:135]
    v_fmac_f32 v200, s27, v198
    v_fma_f32 v198, v196, s28, v249
    v_mfma_f32_16x16x32_bf16 a[136:139], a[232:235], v[228:231], a[136:139]
    v_fmac_f32 v249, s29, v196
    v_cvt_pk_bf16_f32 v194, v248, v194
    v_mfma_f32_16x16x32_bf16 a[140:143], a[236:239], v[228:231], a[140:143]
    v_cvt_pk_bf16_f32 v200, v251, v200
    v_cvt_pk_bf16_f32 v198, v250, v198
    v_mfma_f32_16x16x32_bf16 a[120:123], a[240:243], v[228:231], a[120:123]
    v_cvt_pk_bf16_f32 v196, v252, v249
    v_lshlrev_b32 v248, 16, v195
    v_mfma_f32_16x16x32_bf16 a[124:127], a[244:247], v[228:231], a[124:127]
    v_lshlrev_b32 v249, 16, v197
    v_lshlrev_b32 v250, 16, v199
    v_mfma_f32_16x16x32_bf16 a[128:131], a[248:251], v[228:231], a[128:131]
    v_lshlrev_b32 v251, 16, v201
    v_and_b32 v195, s22, v195
    v_mfma_f32_16x16x32_bf16 a[108:111], a[252:255], v[228:231], a[108:111]
    v_and_b32 v197, s22, v197
    v_and_b32 v199, s22, v199
    v_mfma_f32_16x16x32_bf16 a[112:115], v[240:243], v[228:231], a[112:115]
    v_and_b32 v201, s22, v201
    v_lshlrev_b32 v252, 16, v193
    v_mfma_f32_16x16x32_bf16 a[116:119], v[244:247], v[228:231], a[116:119]
    ds_read_b128 v[228:231], v253 offset:11968
    s_waitcnt lgkmcnt(2)
    v_mfma_f32_16x16x32_bf16 a[144:147], a[228:231], v[232:235], a[144:147]
    v_and_b32 v193, s22, v193
    v_add_f32 v252, v252, v251
    v_mfma_f32_16x16x32_bf16 a[148:151], a[232:235], v[232:235], a[148:151]
    v_add_f32 v193, v193, v201
    v_fmac_f32 v252, s23, v249
    v_mfma_f32_16x16x32_bf16 a[152:155], a[236:239], v[232:235], a[152:155]
    v_fmac_f32 v193, s23, v197
    v_cvt_pk_bf16_f32 v193, v252, v193
    v_mfma_f32_16x16x32_bf16 a[132:135], a[240:243], v[232:235], a[132:135]
    v_lshlrev_b32 v252, 16, v203
    v_and_b32 v203, s22, v203
    v_mfma_f32_16x16x32_bf16 a[136:139], a[244:247], v[232:235], a[136:139]
    v_add_f32 v252, v252, v248
    v_add_f32 v203, v203, v195
    v_mfma_f32_16x16x32_bf16 a[140:143], a[248:251], v[232:235], a[140:143]
    v_fmac_f32 v252, s23, v250
    v_fmac_f32 v203, s23, v199
    v_mfma_f32_16x16x32_bf16 a[120:123], a[252:255], v[232:235], a[120:123]
    v_cvt_pk_bf16_f32 v203, v252, v203
    v_fma_f32 v252, v249, s24, v251
    v_mfma_f32_16x16x32_bf16 a[124:127], v[240:243], v[232:235], a[124:127]
    v_fmac_f32 v251, s25, v249
    v_fma_f32 v249, v248, s24, v250
    v_mfma_f32_16x16x32_bf16 a[128:131], v[244:247], v[232:235], a[128:131]
    ds_read_b128 v[232:235], v253 offset:11712
    s_waitcnt lgkmcnt(2)
    v_mfma_f32_16x16x32_bf16 a[156:159], a[228:231], v[236:239], a[156:159]
    v_fmac_f32 v250, s25, v248
    v_fma_f32 v248, v250, s26, v251
    v_mfma_f32_16x16x32_bf16 a[160:163], a[232:235], v[236:239], a[160:163]
    v_fmac_f32 v251, s27, v250
    v_mfma_f32_16x16x32_bf16 a[164:167], a[236:239], v[236:239], a[164:167]
    v_fma_f32 v250, v249, s28, v252
    v_fmac_f32 v252, s29, v249
    v_mfma_f32_16x16x32_bf16 a[144:147], a[240:243], v[236:239], a[144:147]
    v_fma_f32 v249, v197, s24, v201
    v_fmac_f32 v201, s25, v197
    v_mfma_f32_16x16x32_bf16 a[148:151], a[244:247], v[236:239], a[148:151]
    v_fma_f32 v197, v195, s24, v199
    v_fmac_f32 v199, s25, v195
    v_mfma_f32_16x16x32_bf16 a[152:155], a[248:251], v[236:239], a[152:155]
    v_fma_f32 v195, v199, s26, v201
    v_fmac_f32 v201, s27, v199
    v_mfma_f32_16x16x32_bf16 a[132:135], a[252:255], v[236:239], a[132:135]
    v_fma_f32 v199, v197, s28, v249
    v_fmac_f32 v249, s29, v197
    v_mfma_f32_16x16x32_bf16 a[136:139], v[240:243], v[236:239], a[136:139]
    v_cvt_pk_bf16_f32 v195, v248, v195
    v_cvt_pk_bf16_f32 v201, v251, v201
    v_mfma_f32_16x16x32_bf16 a[140:143], v[244:247], v[236:239], a[140:143]
    ds_read_b128 v[236:239], v253 offset:11456
    s_waitcnt lgkmcnt(2)
    v_mfma_f32_16x16x32_bf16 a[168:171], a[228:231], v[228:231], a[168:171]
    v_cvt_pk_bf16_f32 v199, v250, v199
    v_cvt_pk_bf16_f32 v197, v252, v249
    v_mfma_f32_16x16x32_bf16 a[172:175], a[232:235], v[228:231], a[172:175]
    v_and_b32 v248, 0xf0, v254
    v_lshrrev_b32 v248, 1, v248
    v_mfma_f32_16x16x32_bf16 a[176:179], a[236:239], v[228:231], a[176:179]
    v_add_u32 v248, s52, v248
    v_and_b32 v252, 8, v248
    v_mfma_f32_16x16x32_bf16 a[156:159], a[240:243], v[228:231], a[156:159]
    v_lshrrev_b32 v249, 6, v248
    v_mul_u32_u24 v249, 192, v249
    v_mfma_f32_16x16x32_bf16 a[160:163], a[244:247], v[228:231], a[160:163]
    v_add_u32 v252, v252, v249
    v_bfe_u32 v249, v248, 4, 2
    v_mfma_f32_16x16x32_bf16 a[164:167], a[248:251], v[228:231], a[164:167]
    v_mul_u32_u24 v249, 40704, v249
    v_add_u32 v252, v252, v249
    v_mfma_f32_16x16x32_bf16 a[144:147], a[252:255], v[228:231], a[144:147]
    v_and_b32 v249, 32, v248
    v_lshl_add_u32 v252, v249, 1, v252
    v_mfma_f32_16x16x32_bf16 a[148:151], v[240:243], v[228:231], a[148:151]
    v_bfe_u32 v249, v254, 8, 1
    v_lshl_add_u32 v252, v249, 4, v252
    v_mfma_f32_16x16x32_bf16 a[152:155], v[244:247], v[228:231], a[152:155]
    ds_read_b128 v[228:231], v253 offset:11184
    s_waitcnt lgkmcnt(2)
    v_mfma_f32_16x16x32_bf16 a[180:183], a[228:231], v[232:235], a[180:183]
    v_mov_b32 v249, 123328
    v_cndmask_b32 v252, v249, v252, s[58:59]
    v_mfma_f32_16x16x32_bf16 a[184:187], a[232:235], v[232:235], a[184:187]
    ds_write_b64 v252, v[192:193] offset:39520
    ds_write_b64 v252, v[194:195] offset:39552
    v_mfma_f32_16x16x32_bf16 a[188:191], a[236:239], v[232:235], a[188:191]
    ds_write_b64 v252, v[200:201] offset:39584
    ds_write_b64 v252, v[198:199] offset:39616
    v_mfma_f32_16x16x32_bf16 a[168:171], a[240:243], v[232:235], a[168:171]
    s_mov_b32 s42, 847872
    buffer_load_dwordx4 a[228:231], v254, s[8:11], s42 offen offset:0
    v_mfma_f32_16x16x32_bf16 a[172:175], a[244:247], v[232:235], a[172:175]
    ds_write_b64 v252, v[196:197] offset:39648
    ds_write_b64 v252, v[202:203] offset:39680
    v_mfma_f32_16x16x32_bf16 a[176:179], a[248:251], v[232:235], a[176:179]
    buffer_load_dwordx4 a[232:235], v254, s[8:11], s42 offen offset:1024
    v_mfma_f32_16x16x32_bf16 a[156:159], a[252:255], v[232:235], a[156:159]
    v_mfma_f32_16x16x32_bf16 a[160:163], v[240:243], v[232:235], a[160:163]
    buffer_load_dwordx4 a[236:239], v254, s[8:11], s42 offen offset:2048
    v_mfma_f32_16x16x32_bf16 a[164:167], v[244:247], v[232:235], a[164:167]
    ds_read_b128 v[232:235], v253 offset:13520
    s_waitcnt lgkmcnt(8)
    v_mfma_f32_16x16x32_bf16 a[180:183], a[240:243], v[236:239], a[180:183]
    v_mfma_f32_16x16x32_bf16 a[184:187], a[244:247], v[236:239], a[184:187]
    v_mfma_f32_16x16x32_bf16 a[188:191], a[248:251], v[236:239], a[188:191]
    s_mov_b32 s42, 850944
    buffer_load_dwordx4 a[240:243], v254, s[8:11], s42 offen offset:0
    v_mfma_f32_16x16x32_bf16 a[168:171], a[252:255], v[236:239], a[168:171]
    v_mfma_f32_16x16x32_bf16 a[172:175], v[240:243], v[236:239], a[172:175]
    buffer_load_dwordx4 a[244:247], v254, s[8:11], s42 offen offset:1024
    v_mfma_f32_16x16x32_bf16 a[176:179], v[244:247], v[236:239], a[176:179]
    ds_read_b128 v[236:239], v253 offset:13248
    s_waitcnt lgkmcnt(8)
    v_mfma_f32_16x16x32_bf16 a[180:183], a[252:255], v[228:231], a[180:183]
    buffer_load_dwordx4 a[248:251], v254, s[8:11], s42 offen offset:2048
    v_mfma_f32_16x16x32_bf16 a[184:187], v[240:243], v[228:231], a[184:187]
    v_mfma_f32_16x16x32_bf16 a[188:191], v[244:247], v[228:231], a[188:191]
    ds_read_b128 v[228:231], v253 offset:12992
    s_mov_b32 s42, 854016
    buffer_load_dwordx4 a[252:255], v254, s[8:11], s42 offen offset:0
    s_waitcnt vmcnt(13) lgkmcnt(2)
    v_mfma_f32_16x16x32_bf16 v[0:3], a[192:195], v[232:235], v[0:3]
    v_mfma_f32_16x16x32_bf16 v[4:7], a[196:199], v[232:235], v[4:7]
    buffer_load_dwordx4 v[240:243], v254, s[8:11], s42 offen offset:1024
    v_mfma_f32_16x16x32_bf16 v[8:11], a[200:203], v[232:235], v[8:11]
    ds_read_b128 v[232:235], v253 offset:12736
    s_waitcnt lgkmcnt(2)
    v_mfma_f32_16x16x32_bf16 v[12:15], a[192:195], v[236:239], v[12:15]
    buffer_load_dwordx4 v[244:247], v254, s[8:11], s42 offen offset:2048
    v_mfma_f32_16x16x32_bf16 v[16:19], a[196:199], v[236:239], v[16:19]
    v_mfma_f32_16x16x32_bf16 v[20:23], a[200:203], v[236:239], v[20:23]
    s_waitcnt vmcnt(12)
    v_mfma_f32_16x16x32_bf16 v[0:3], a[204:207], v[236:239], v[0:3]
    v_mfma_f32_16x16x32_bf16 v[4:7], a[208:211], v[236:239], v[4:7]
    v_mfma_f32_16x16x32_bf16 v[8:11], a[212:215], v[236:239], v[8:11]
    ds_read_b128 v[236:239], v253 offset:12480
    s_waitcnt lgkmcnt(2)
    v_mfma_f32_16x16x32_bf16 v[24:27], a[192:195], v[228:231], v[24:27]
    v_mfma_f32_16x16x32_bf16 v[28:31], a[196:199], v[228:231], v[28:31]
    v_mfma_f32_16x16x32_bf16 v[32:35], a[200:203], v[228:231], v[32:35]
    v_mfma_f32_16x16x32_bf16 v[12:15], a[204:207], v[228:231], v[12:15]
    v_mfma_f32_16x16x32_bf16 v[16:19], a[208:211], v[228:231], v[16:19]
    v_mfma_f32_16x16x32_bf16 v[20:23], a[212:215], v[228:231], v[20:23]
    s_waitcnt vmcnt(9)
    v_mfma_f32_16x16x32_bf16 v[0:3], a[216:219], v[228:231], v[0:3]
    v_mfma_f32_16x16x32_bf16 v[4:7], a[220:223], v[228:231], v[4:7]
    v_mfma_f32_16x16x32_bf16 v[8:11], a[224:227], v[228:231], v[8:11]
    ds_read_b128 v[228:231], v253 offset:14304
    s_waitcnt lgkmcnt(2)
    v_mfma_f32_16x16x32_bf16 v[36:39], a[192:195], v[232:235], v[36:39]
    v_mfma_f32_16x16x32_bf16 v[40:43], a[196:199], v[232:235], v[40:43]
    v_mfma_f32_16x16x32_bf16 v[44:47], a[200:203], v[232:235], v[44:47]
    v_mfma_f32_16x16x32_bf16 v[24:27], a[204:207], v[232:235], v[24:27]
    v_mfma_f32_16x16x32_bf16 v[28:31], a[208:211], v[232:235], v[28:31]
    v_mfma_f32_16x16x32_bf16 v[32:35], a[212:215], v[232:235], v[32:35]
    v_mfma_f32_16x16x32_bf16 v[12:15], a[216:219], v[232:235], v[12:15]
    v_mfma_f32_16x16x32_bf16 v[16:19], a[220:223], v[232:235], v[16:19]
    v_mfma_f32_16x16x32_bf16 v[20:23], a[224:227], v[232:235], v[20:23]
    ds_read_b128 v[232:235], v253 offset:14048
    s_waitcnt lgkmcnt(2)
    v_mfma_f32_16x16x32_bf16 v[48:51], a[192:195], v[236:239], v[48:51]
    v_mfma_f32_16x16x32_bf16 v[52:55], a[196:199], v[236:239], v[52:55]
    v_mfma_f32_16x16x32_bf16 v[56:59], a[200:203], v[236:239], v[56:59]
    v_mfma_f32_16x16x32_bf16 v[36:39], a[204:207], v[236:239], v[36:39]
    v_mfma_f32_16x16x32_bf16 v[40:43], a[208:211], v[236:239], v[40:43]
    v_mfma_f32_16x16x32_bf16 v[44:47], a[212:215], v[236:239], v[44:47]
    v_mfma_f32_16x16x32_bf16 v[24:27], a[216:219], v[236:239], v[24:27]
    v_mfma_f32_16x16x32_bf16 v[28:31], a[220:223], v[236:239], v[28:31]
    v_mfma_f32_16x16x32_bf16 v[32:35], a[224:227], v[236:239], v[32:35]
    ds_read_b128 v[236:239], v253 offset:13792
    s_waitcnt lgkmcnt(2)
    v_mfma_f32_16x16x32_bf16 v[60:63], a[192:195], v[228:231], v[60:63]
    v_mfma_f32_16x16x32_bf16 v[64:67], a[196:199], v[228:231], v[64:67]
    v_mfma_f32_16x16x32_bf16 v[68:71], a[200:203], v[228:231], v[68:71]
    v_mfma_f32_16x16x32_bf16 v[48:51], a[204:207], v[228:231], v[48:51]
    v_mfma_f32_16x16x32_bf16 v[52:55], a[208:211], v[228:231], v[52:55]
    v_mfma_f32_16x16x32_bf16 v[56:59], a[212:215], v[228:231], v[56:59]
    v_mfma_f32_16x16x32_bf16 v[36:39], a[216:219], v[228:231], v[36:39]
    v_mfma_f32_16x16x32_bf16 v[40:43], a[220:223], v[228:231], v[40:43]
    v_mfma_f32_16x16x32_bf16 v[44:47], a[224:227], v[228:231], v[44:47]
    ds_read_b128 v[228:231], v253 offset:13536
    s_waitcnt lgkmcnt(2)
    v_mfma_f32_16x16x32_bf16 v[72:75], a[192:195], v[232:235], v[72:75]
    v_mfma_f32_16x16x32_bf16 v[76:79], a[196:199], v[232:235], v[76:79]
    v_mfma_f32_16x16x32_bf16 v[80:83], a[200:203], v[232:235], v[80:83]
    v_mfma_f32_16x16x32_bf16 v[60:63], a[204:207], v[232:235], v[60:63]
    v_mfma_f32_16x16x32_bf16 v[64:67], a[208:211], v[232:235], v[64:67]
    v_mfma_f32_16x16x32_bf16 v[68:71], a[212:215], v[232:235], v[68:71]
    v_mfma_f32_16x16x32_bf16 v[48:51], a[216:219], v[232:235], v[48:51]
    v_mfma_f32_16x16x32_bf16 v[52:55], a[220:223], v[232:235], v[52:55]
    v_mfma_f32_16x16x32_bf16 v[56:59], a[224:227], v[232:235], v[56:59]
    ds_read_b128 v[232:235], v253 offset:13264
    s_waitcnt lgkmcnt(2)
    v_mfma_f32_16x16x32_bf16 v[84:87], a[192:195], v[236:239], v[84:87]
    v_mfma_f32_16x16x32_bf16 v[88:91], a[196:199], v[236:239], v[88:91]
    v_mfma_f32_16x16x32_bf16 v[92:95], a[200:203], v[236:239], v[92:95]
    v_mfma_f32_16x16x32_bf16 v[72:75], a[204:207], v[236:239], v[72:75]
    s_mov_b32 s42, 884736
    buffer_load_dwordx4 a[192:195], v254, s[8:11], s42 offen offset:0
    v_mfma_f32_16x16x32_bf16 v[76:79], a[208:211], v[236:239], v[76:79]
    v_mfma_f32_16x16x32_bf16 v[80:83], a[212:215], v[236:239], v[80:83]
    buffer_load_dwordx4 a[196:199], v254, s[8:11], s42 offen offset:1024
    v_mfma_f32_16x16x32_bf16 v[60:63], a[216:219], v[236:239], v[60:63]
    v_mfma_f32_16x16x32_bf16 v[64:67], a[220:223], v[236:239], v[64:67]
    buffer_load_dwordx4 a[200:203], v254, s[8:11], s42 offen offset:2048
    v_mfma_f32_16x16x32_bf16 v[68:71], a[224:227], v[236:239], v[68:71]
    ds_read_b128 v[236:239], v253 offset:1040
    s_waitcnt lgkmcnt(2)
    v_mfma_f32_16x16x32_bf16 v[84:87], a[204:207], v[228:231], v[84:87]
    v_mfma_f32_16x16x32_bf16 v[88:91], a[208:211], v[228:231], v[88:91]
    v_mfma_f32_16x16x32_bf16 v[92:95], a[212:215], v[228:231], v[92:95]
    s_mov_b32 s42, 887808
    buffer_load_dwordx4 a[204:207], v254, s[8:11], s42 offen offset:0
    v_mfma_f32_16x16x32_bf16 v[72:75], a[216:219], v[228:231], v[72:75]
    v_mfma_f32_16x16x32_bf16 v[76:79], a[220:223], v[228:231], v[76:79]
    buffer_load_dwordx4 a[208:211], v254, s[8:11], s42 offen offset:1024
    v_mfma_f32_16x16x32_bf16 v[80:83], a[224:227], v[228:231], v[80:83]
    ds_read_b128 v[228:231], v253 offset:768
    s_waitcnt lgkmcnt(2)
    v_mfma_f32_16x16x32_bf16 v[84:87], a[216:219], v[232:235], v[84:87]
    buffer_load_dwordx4 a[212:215], v254, s[8:11], s42 offen offset:2048
    v_mfma_f32_16x16x32_bf16 v[88:91], a[220:223], v[232:235], v[88:91]
    v_mfma_f32_16x16x32_bf16 v[92:95], a[224:227], v[232:235], v[92:95]
    ds_read_b128 v[232:235], v253 offset:512
    s_mov_b32 s42, 890880
    buffer_load_dwordx4 a[216:219], v254, s[8:11], s42 offen offset:0
    s_waitcnt vmcnt(13) lgkmcnt(2)
    v_mfma_f32_16x16x32_bf16 v[96:99], a[228:231], v[236:239], v[96:99]
    v_mfma_f32_16x16x32_bf16 v[100:103], a[232:235], v[236:239], v[100:103]
    buffer_load_dwordx4 a[220:223], v254, s[8:11], s42 offen offset:1024
    v_mfma_f32_16x16x32_bf16 v[104:107], a[236:239], v[236:239], v[104:107]
    ds_read_b128 v[236:239], v253 offset:256
    s_waitcnt lgkmcnt(2)
    v_mfma_f32_16x16x32_bf16 v[108:111], a[228:231], v[228:231], v[108:111]
    buffer_load_dwordx4 a[224:227], v254, s[8:11], s42 offen offset:2048
    v_mfma_f32_16x16x32_bf16 v[112:115], a[232:235], v[228:231], v[112:115]
    v_mfma_f32_16x16x32_bf16 v[116:119], a[236:239], v[228:231], v[116:119]
    s_waitcnt vmcnt(12)
    v_mfma_f32_16x16x32_bf16 v[96:99], a[240:243], v[228:231], v[96:99]
    v_mfma_f32_16x16x32_bf16 v[100:103], a[244:247], v[228:231], v[100:103]
    v_mfma_f32_16x16x32_bf16 v[104:107], a[248:251], v[228:231], v[104:107]
    ds_read_b128 v[228:231], v253 offset:0
    s_waitcnt lgkmcnt(2)
    v_mfma_f32_16x16x32_bf16 v[120:123], a[228:231], v[232:235], v[120:123]
    v_mfma_f32_16x16x32_bf16 v[124:127], a[232:235], v[232:235], v[124:127]
    v_mfma_f32_16x16x32_bf16 v[128:131], a[236:239], v[232:235], v[128:131]
    v_mfma_f32_16x16x32_bf16 v[108:111], a[240:243], v[232:235], v[108:111]
    v_mfma_f32_16x16x32_bf16 v[112:115], a[244:247], v[232:235], v[112:115]
    v_mfma_f32_16x16x32_bf16 v[116:119], a[248:251], v[232:235], v[116:119]
    s_waitcnt vmcnt(9)
    v_mfma_f32_16x16x32_bf16 v[96:99], a[252:255], v[232:235], v[96:99]
    v_mfma_f32_16x16x32_bf16 v[100:103], v[240:243], v[232:235], v[100:103]
    v_mfma_f32_16x16x32_bf16 v[104:107], v[244:247], v[232:235], v[104:107]
    ds_read_b128 v[232:235], v253 offset:1824
    s_waitcnt lgkmcnt(2)
    v_mfma_f32_16x16x32_bf16 v[132:135], a[228:231], v[236:239], v[132:135]
    v_mfma_f32_16x16x32_bf16 v[136:139], a[232:235], v[236:239], v[136:139]
    v_mfma_f32_16x16x32_bf16 v[140:143], a[236:239], v[236:239], v[140:143]
    v_bfe_u32 v251, v254, 6, 2
    v_mfma_f32_16x16x32_bf16 v[120:123], a[240:243], v[236:239], v[120:123]
    v_mul_u32_u24 v248, 40704, v251
    v_mfma_f32_16x16x32_bf16 v[124:127], a[244:247], v[236:239], v[124:127]
    v_mfma_f32_16x16x32_bf16 v[128:131], a[248:251], v[236:239], v[128:131]
    v_and_b32 v251, 0x80, v254
    v_mfma_f32_16x16x32_bf16 v[108:111], a[252:255], v[236:239], v[108:111]
    v_mfma_f32_16x16x32_bf16 v[112:115], v[240:243], v[236:239], v[112:115]
    v_lshrrev_b32 v251, 1, v251
    v_mfma_f32_16x16x32_bf16 v[116:119], v[244:247], v[236:239], v[116:119]
    ds_read_b128 v[236:239], v253 offset:1568
    s_waitcnt lgkmcnt(2)
    v_mfma_f32_16x16x32_bf16 v[144:147], a[228:231], v[228:231], v[144:147]
    v_mfma_f32_16x16x32_bf16 v[148:151], a[232:235], v[228:231], v[148:151]
    v_add_u32 v248, v248, v251
    v_mfma_f32_16x16x32_bf16 v[152:155], a[236:239], v[228:231], v[152:155]
    v_mfma_f32_16x16x32_bf16 v[132:135], a[240:243], v[228:231], v[132:135]
    v_and_b32 v251, 0x40, v254
    v_mfma_f32_16x16x32_bf16 v[136:139], a[244:247], v[228:231], v[136:139]
    v_mfma_f32_16x16x32_bf16 v[140:143], a[248:251], v[228:231], v[140:143]
    v_lshrrev_b32 v251, 2, v251
    v_mfma_f32_16x16x32_bf16 v[120:123], a[252:255], v[228:231], v[120:123]
    v_mfma_f32_16x16x32_bf16 v[124:127], v[240:243], v[228:231], v[124:127]
    v_add_u32 v248, v248, v251
    v_mfma_f32_16x16x32_bf16 v[128:131], v[244:247], v[228:231], v[128:131]
    ds_read_b128 v[228:231], v253 offset:1312
    s_waitcnt lgkmcnt(2)
    v_mfma_f32_16x16x32_bf16 v[156:159], a[228:231], v[232:235], v[156:159]
    v_bfe_u32 v251, v254, 4, 2
    v_mfma_f32_16x16x32_bf16 v[160:163], a[232:235], v[232:235], v[160:163]
    v_mfma_f32_16x16x32_bf16 v[164:167], a[236:239], v[232:235], v[164:167]
    v_mul_u32_u24 v251, 3104, v251
    v_mfma_f32_16x16x32_bf16 v[144:147], a[240:243], v[232:235], v[144:147]
    v_mfma_f32_16x16x32_bf16 v[148:151], a[244:247], v[232:235], v[148:151]
    v_add_u32 v248, v248, v251
    v_mfma_f32_16x16x32_bf16 v[152:155], a[248:251], v[232:235], v[152:155]
    v_mfma_f32_16x16x32_bf16 v[132:135], a[252:255], v[232:235], v[132:135]
    v_add_u32 v248, s52, v248
    v_mfma_f32_16x16x32_bf16 v[136:139], v[240:243], v[232:235], v[136:139]
    v_mfma_f32_16x16x32_bf16 v[140:143], v[244:247], v[232:235], v[140:143]
    ds_read_b128 v[232:235], v253 offset:1056
    s_waitcnt lgkmcnt(2)
    v_mfma_f32_16x16x32_bf16 v[168:171], a[228:231], v[236:239], v[168:171]
    v_lshrrev_b32 v251, 8, v254
    v_mfma_f32_16x16x32_bf16 v[172:175], a[232:235], v[236:239], v[172:175]
    v_mfma_f32_16x16x32_bf16 v[176:179], a[236:239], v[236:239], v[176:179]
    v_lshl_add_u32 v249, v251, 3, v248
    v_mfma_f32_16x16x32_bf16 v[156:159], a[240:243], v[236:239], v[156:159]
    v_mfma_f32_16x16x32_bf16 v[160:163], a[244:247], v[236:239], v[160:163]
    v_lshl_add_u32 v248, v251, 4, v248
    v_mfma_f32_16x16x32_bf16 v[164:167], a[248:251], v[236:239], v[164:167]
    v_mfma_f32_16x16x32_bf16 v[144:147], a[252:255], v[236:239], v[144:147]
    v_mfma_f32_16x16x32_bf16 v[148:151], v[240:243], v[236:239], v[148:151]
    v_mfma_f32_16x16x32_bf16 v[152:155], v[244:247], v[236:239], v[152:155]
    ds_read_b128 v[236:239], v253 offset:784
    s_waitcnt lgkmcnt(2)
    v_mfma_f32_16x16x32_bf16 v[180:183], a[228:231], v[228:231], v[180:183]
    v_mfma_f32_16x16x32_bf16 v[184:187], a[232:235], v[228:231], v[184:187]
    v_mfma_f32_16x16x32_bf16 v[188:191], a[236:239], v[228:231], v[188:191]
    v_mfma_f32_16x16x32_bf16 v[168:171], a[240:243], v[228:231], v[168:171]
    s_mov_b32 s42, 921600
    buffer_load_dwordx4 a[228:231], v254, s[8:11], s42 offen offset:0
    v_mfma_f32_16x16x32_bf16 v[172:175], a[244:247], v[228:231], v[172:175]
    v_mfma_f32_16x16x32_bf16 v[176:179], a[248:251], v[228:231], v[176:179]
    buffer_load_dwordx4 a[232:235], v254, s[8:11], s42 offen offset:1024
    v_mfma_f32_16x16x32_bf16 v[156:159], a[252:255], v[228:231], v[156:159]
    v_mfma_f32_16x16x32_bf16 v[160:163], v[240:243], v[228:231], v[160:163]
    buffer_load_dwordx4 a[236:239], v254, s[8:11], s42 offen offset:2048
    v_mfma_f32_16x16x32_bf16 v[164:167], v[244:247], v[228:231], v[164:167]
    s_waitcnt lgkmcnt(0)
    s_barrier
    ds_read_b128 v[228:231], v253 offset:34320
    v_mfma_f32_16x16x32_bf16 v[180:183], a[240:243], v[232:235], v[180:183]
    v_mfma_f32_16x16x32_bf16 v[184:187], a[244:247], v[232:235], v[184:187]
    v_mfma_f32_16x16x32_bf16 v[188:191], a[248:251], v[232:235], v[188:191]
    s_mov_b32 s42, 924672
    buffer_load_dwordx4 a[240:243], v254, s[8:11], s42 offen offset:0
    v_mfma_f32_16x16x32_bf16 v[168:171], a[252:255], v[232:235], v[168:171]
    v_mfma_f32_16x16x32_bf16 v[172:175], v[240:243], v[232:235], v[172:175]
    buffer_load_dwordx4 a[244:247], v254, s[8:11], s42 offen offset:1024
    v_mfma_f32_16x16x32_bf16 v[176:179], v[244:247], v[232:235], v[176:179]
    ds_read_b128 v[232:235], v253 offset:34048
    v_mfma_f32_16x16x32_bf16 v[180:183], a[252:255], v[236:239], v[180:183]
    buffer_load_dwordx4 a[248:251], v254, s[8:11], s42 offen offset:2048
    v_mfma_f32_16x16x32_bf16 v[184:187], v[240:243], v[236:239], v[184:187]
    v_mfma_f32_16x16x32_bf16 v[188:191], v[244:247], v[236:239], v[188:191]
    ds_read_b128 v[236:239], v253 offset:33792
    s_mov_b32 s42, 927744
    buffer_load_dwordx4 a[252:255], v254, s[8:11], s42 offen offset:0
    s_nop 7
    v_accvgpr_read_b32 v192, a0
    v_accvgpr_read_b32 v193, a1
    v_accvgpr_read_b32 v194, a2
    v_accvgpr_read_b32 v195, a3
    v_accvgpr_read_b32 v196, a96
    v_accvgpr_read_b32 v197, a97
    v_accvgpr_read_b32 v198, a98
    v_accvgpr_read_b32 v199, a99
    v_pk_add_f32 v[200:201], v[192:193], v[196:197]
    v_pk_add_f32 v[202:203], v[194:195], v[198:199]
    v_pk_add_f32 v[192:193], v[192:193], v[196:197] neg_lo:[0,1] neg_hi:[0,1]
    v_pk_add_f32 v[194:195], v[194:195], v[198:199] neg_lo:[0,1] neg_hi:[0,1]
    v_pk_add_f32 v[196:197], v[0:1], v[96:97] neg_lo:[0,1] neg_hi:[0,1]
    v_pk_add_f32 v[198:199], v[2:3], v[98:99] neg_lo:[0,1] neg_hi:[0,1]
    v_pk_add_f32 v[0:1], v[0:1], v[96:97]
    v_pk_add_f32 v[2:3], v[2:3], v[98:99]
    v_pk_fma_f32 v[96:97], v[192:193], s[30:31], v[196:197]
    v_pk_fma_f32 v[98:99], v[194:195], s[30:31], v[198:199]
    v_pk_fma_f32 v[192:193], v[196:197], s[30:31], v[192:193]
    v_pk_fma_f32 v[194:195], v[198:199], s[30:31], v[194:195]
    v_pk_add_f32 v[196:197], v[200:201], v[0:1]
    v_pk_add_f32 v[198:199], v[202:203], v[2:3]
    v_pk_mul_f32 v[0:1], v[0:1], s[34:35]
    v_pk_mul_f32 v[2:3], v[2:3], s[34:35]
    v_pk_mul_f32 v[196:197], v[196:197], s[32:33]
    v_pk_mul_f32 v[198:199], v[198:199], s[32:33]
    v_pk_fma_f32 v[0:1], v[200:201], s[36:37], v[0:1]
    v_pk_fma_f32 v[2:3], v[202:203], s[36:37], v[2:3]
    v_cvt_pk_bf16_f32 v216, v192, v193
    v_cvt_pk_bf16_f32 v217, v194, v195
    v_cvt_pk_bf16_f32 v200, v196, v197
    v_cvt_pk_bf16_f32 v201, v198, v199
    v_accvgpr_write_b32 a0, v200
    v_accvgpr_write_b32 a1, v201
    v_accvgpr_read_b32 v204, a4
    v_accvgpr_read_b32 v205, a5
    v_accvgpr_read_b32 v206, a6
    v_accvgpr_read_b32 v207, a7
    v_accvgpr_read_b32 v208, a100
    v_accvgpr_read_b32 v209, a101
    v_accvgpr_read_b32 v210, a102
    v_accvgpr_read_b32 v211, a103
    v_pk_add_f32 v[212:213], v[204:205], v[208:209]
    v_pk_add_f32 v[214:215], v[206:207], v[210:211]
    v_pk_add_f32 v[204:205], v[204:205], v[208:209] neg_lo:[0,1] neg_hi:[0,1]
    v_pk_add_f32 v[206:207], v[206:207], v[210:211] neg_lo:[0,1] neg_hi:[0,1]
    v_pk_add_f32 v[208:209], v[4:5], v[100:101] neg_lo:[0,1] neg_hi:[0,1]
    v_pk_add_f32 v[210:211], v[6:7], v[102:103] neg_lo:[0,1] neg_hi:[0,1]
    v_pk_add_f32 v[4:5], v[4:5], v[100:101]
    v_pk_add_f32 v[6:7], v[6:7], v[102:103]
    v_pk_fma_f32 v[100:101], v[204:205], s[30:31], v[208:209]
    v_pk_fma_f32 v[102:103], v[206:207], s[30:31], v[210:211]
    v_pk_fma_f32 v[204:205], v[208:209], s[30:31], v[204:205]
    v_pk_fma_f32 v[206:207], v[210:211], s[30:31], v[206:207]
    v_pk_add_f32 v[208:209], v[212:213], v[4:5]
    v_pk_add_f32 v[210:211], v[214:215], v[6:7]
    v_pk_mul_f32 v[4:5], v[4:5], s[34:35]
    v_pk_mul_f32 v[6:7], v[6:7], s[34:35]
    v_pk_mul_f32 v[208:209], v[208:209], s[32:33]
    v_pk_mul_f32 v[210:211], v[210:211], s[32:33]
    v_pk_fma_f32 v[4:5], v[212:213], s[36:37], v[4:5]
    v_pk_fma_f32 v[6:7], v[214:215], s[36:37], v[6:7]
    v_cvt_pk_bf16_f32 v218, v204, v205
    v_cvt_pk_bf16_f32 v219, v206, v207
    v_cvt_pk_bf16_f32 v212, v208, v209
    v_cvt_pk_bf16_f32 v213, v210, v211
    v_accvgpr_write_b32 a2, v212
    v_accvgpr_write_b32 a3, v213
    v_accvgpr_read_b32 v192, a8
    v_accvgpr_read_b32 v193, a9
    v_accvgpr_read_b32 v194, a10
    v_accvgpr_read_b32 v195, a11
    v_accvgpr_read_b32 v196, a104
    v_accvgpr_read_b32 v197, a105
    v_accvgpr_read_b32 v198, a106
    v_accvgpr_read_b32 v199, a107
    v_pk_add_f32 v[200:201], v[192:193], v[196:197]
    v_pk_add_f32 v[202:203], v[194:195], v[198:199]
    v_pk_add_f32 v[192:193], v[192:193], v[196:197] neg_lo:[0,1] neg_hi:[0,1]
    v_pk_add_f32 v[194:195], v[194:195], v[198:199] neg_lo:[0,1] neg_hi:[0,1]
    v_pk_add_f32 v[196:197], v[8:9], v[104:105] neg_lo:[0,1] neg_hi:[0,1]
    v_pk_add_f32 v[198:199], v[10:11], v[106:107] neg_lo:[0,1] neg_hi:[0,1]
    v_pk_add_f32 v[8:9], v[8:9], v[104:105]
    v_pk_add_f32 v[10:11], v[10:11], v[106:107]
    v_pk_fma_f32 v[104:105], v[192:193], s[30:31], v[196:197]
    v_pk_fma_f32 v[106:107], v[194:195], s[30:31], v[198:199]
    v_pk_fma_f32 v[192:193], v[196:197], s[30:31], v[192:193]
    v_pk_fma_f32 v[194:195], v[198:199], s[30:31], v[194:195]
    v_pk_add_f32 v[196:197], v[200:201], v[8:9]
    v_pk_add_f32 v[198:199], v[202:203], v[10:11]
    v_pk_mul_f32 v[8:9], v[8:9], s[34:35]
    v_pk_mul_f32 v[10:11], v[10:11], s[34:35]
    v_pk_mul_f32 v[196:197], v[196:197], s[32:33]
    v_pk_mul_f32 v[198:199], v[198:199], s[32:33]
    v_pk_fma_f32 v[8:9], v[200:201], s[36:37], v[8:9]
    v_pk_fma_f32 v[10:11], v[202:203], s[36:37], v[10:11]
    v_cvt_pk_bf16_f32 v220, v192, v193
    v_cvt_pk_bf16_f32 v221, v194, v195
    v_cvt_pk_bf16_f32 v200, v196, v197
    v_cvt_pk_bf16_f32 v201, v198, v199
    v_accvgpr_write_b32 a4, v200
    v_accvgpr_write_b32 a5, v201
    ds_write_b128 v248, v[216:219] offset:0
    ds_write_b64 v249, v[220:221] offset:64
    v_accvgpr_read_b32 v192, a12
    v_accvgpr_read_b32 v193, a13
    v_accvgpr_read_b32 v194, a14
    v_accvgpr_read_b32 v195, a15
    v_accvgpr_read_b32 v196, a108
    v_accvgpr_read_b32 v197, a109
    v_accvgpr_read_b32 v198, a110
    v_accvgpr_read_b32 v199, a111
    v_pk_add_f32 v[200:201], v[192:193], v[196:197]
    v_pk_add_f32 v[202:203], v[194:195], v[198:199]
    v_pk_add_f32 v[192:193], v[192:193], v[196:197] neg_lo:[0,1] neg_hi:[0,1]
    v_pk_add_f32 v[194:195], v[194:195], v[198:199] neg_lo:[0,1] neg_hi:[0,1]
    v_pk_add_f32 v[196:197], v[12:13], v[108:109] neg_lo:[0,1] neg_hi:[0,1]
    v_pk_add_f32 v[198:199], v[14:15], v[110:111] neg_lo:[0,1] neg_hi:[0,1]
    v_pk_add_f32 v[12:13], v[12:13], v[108:109]
    v_pk_add_f32 v[14:15], v[14:15], v[110:111]
    v_pk_fma_f32 v[108:109], v[192:193], s[30:31], v[196:197]
    v_pk_fma_f32 v[110:111], v[194:195], s[30:31], v[198:199]
    v_pk_fma_f32 v[192:193], v[196:197], s[30:31], v[192:193]
    v_pk_fma_f32 v[194:195], v[198:199], s[30:31], v[194:195]
    v_pk_add_f32 v[196:197], v[200:201], v[12:13]
    v_pk_add_f32 v[198:199], v[202:203], v[14:15]
    v_pk_mul_f32 v[12:13], v[12:13], s[34:35]
    v_pk_mul_f32 v[14:15], v[14:15], s[34:35]
    v_pk_mul_f32 v[196:197], v[196:197], s[32:33]
    v_pk_mul_f32 v[198:199], v[198:199], s[32:33]
    v_pk_fma_f32 v[12:13], v[200:201], s[36:37], v[12:13]
    v_pk_fma_f32 v[14:15], v[202:203], s[36:37], v[14:15]
    v_cvt_pk_bf16_f32 v222, v192, v193
    v_cvt_pk_bf16_f32 v223, v194, v195
    v_cvt_pk_bf16_f32 v200, v196, v197
    v_cvt_pk_bf16_f32 v201, v198, v199
    v_accvgpr_write_b32 a12, v200
    v_accvgpr_write_b32 a13, v201
    v_accvgpr_read_b32 v204, a16
    v_accvgpr_read_b32 v205, a17
    v_accvgpr_read_b32 v206, a18
    v_accvgpr_read_b32 v207, a19
    v_accvgpr_read_b32 v208, a112
    v_accvgpr_read_b32 v209, a113
    v_accvgpr_read_b32 v210, a114
    v_accvgpr_read_b32 v211, a115
    v_pk_add_f32 v[212:213], v[204:205], v[208:209]
    v_pk_add_f32 v[214:215], v[206:207], v[210:211]
    v_pk_add_f32 v[204:205], v[204:205], v[208:209] neg_lo:[0,1] neg_hi:[0,1]
    v_pk_add_f32 v[206:207], v[206:207], v[210:211] neg_lo:[0,1] neg_hi:[0,1]
    v_pk_add_f32 v[208:209], v[16:17], v[112:113] neg_lo:[0,1] neg_hi:[0,1]
    v_pk_add_f32 v[210:211], v[18:19], v[114:115] neg_lo:[0,1] neg_hi:[0,1]
    v_pk_add_f32 v[16:17], v[16:17], v[112:113]
    v_pk_add_f32 v[18:19], v[18:19], v[114:115]
    v_pk_fma_f32 v[112:113], v[204:205], s[30:31], v[208:209]
    v_pk_fma_f32 v[114:115], v[206:207], s[30:31], v[210:211]
    v_pk_fma_f32 v[204:205], v[208:209], s[30:31], v[204:205]
    v_pk_fma_f32 v[206:207], v[210:211], s[30:31], v[206:207]
    v_pk_add_f32 v[208:209], v[212:213], v[16:17]
    v_pk_add_f32 v[210:211], v[214:215], v[18:19]
    v_pk_mul_f32 v[16:17], v[16:17], s[34:35]
    v_pk_mul_f32 v[18:19], v[18:19], s[34:35]
    v_pk_mul_f32 v[208:209], v[208:209], s[32:33]
    v_pk_mul_f32 v[210:211], v[210:211], s[32:33]
    v_pk_fma_f32 v[16:17], v[212:213], s[36:37], v[16:17]
    v_pk_fma_f32 v[18:19], v[214:215], s[36:37], v[18:19]
    v_cvt_pk_bf16_f32 v224, v204, v205
    v_cvt_pk_bf16_f32 v225, v206, v207
    v_cvt_pk_bf16_f32 v212, v208, v209
    v_cvt_pk_bf16_f32 v213, v210, v211
    v_accvgpr_write_b32 a14, v212
    v_accvgpr_write_b32 a15, v213
    v_accvgpr_read_b32 v192, a20
    v_accvgpr_read_b32 v193, a21
    v_accvgpr_read_b32 v194, a22
    v_accvgpr_read_b32 v195, a23
    v_accvgpr_read_b32 v196, a116
    v_accvgpr_read_b32 v197, a117
    v_accvgpr_read_b32 v198, a118
    v_accvgpr_read_b32 v199, a119
    v_pk_add_f32 v[200:201], v[192:193], v[196:197]
    v_pk_add_f32 v[202:203], v[194:195], v[198:199]
    v_pk_add_f32 v[192:193], v[192:193], v[196:197] neg_lo:[0,1] neg_hi:[0,1]
    v_pk_add_f32 v[194:195], v[194:195], v[198:199] neg_lo:[0,1] neg_hi:[0,1]
    v_pk_add_f32 v[196:197], v[20:21], v[116:117] neg_lo:[0,1] neg_hi:[0,1]
    v_pk_add_f32 v[198:199], v[22:23], v[118:119] neg_lo:[0,1] neg_hi:[0,1]
    v_pk_add_f32 v[20:21], v[20:21], v[116:117]
    v_pk_add_f32 v[22:23], v[22:23], v[118:119]
    v_pk_fma_f32 v[116:117], v[192:193], s[30:31], v[196:197]
    v_pk_fma_f32 v[118:119], v[194:195], s[30:31], v[198:199]
    v_pk_fma_f32 v[192:193], v[196:197], s[30:31], v[192:193]
    v_pk_fma_f32 v[194:195], v[198:199], s[30:31], v[194:195]
    v_pk_add_f32 v[196:197], v[200:201], v[20:21]
    v_pk_add_f32 v[198:199], v[202:203], v[22:23]
    v_pk_mul_f32 v[20:21], v[20:21], s[34:35]
    v_pk_mul_f32 v[22:23], v[22:23], s[34:35]
    v_pk_mul_f32 v[196:197], v[196:197], s[32:33]
    v_pk_mul_f32 v[198:199], v[198:199], s[32:33]
    v_pk_fma_f32 v[20:21], v[200:201], s[36:37], v[20:21]
    v_pk_fma_f32 v[22:23], v[202:203], s[36:37], v[22:23]
    v_cvt_pk_bf16_f32 v226, v192, v193
    v_cvt_pk_bf16_f32 v227, v194, v195
    v_cvt_pk_bf16_f32 v200, v196, v197
    v_cvt_pk_bf16_f32 v201, v198, v199
    v_accvgpr_write_b32 a16, v200
    v_accvgpr_write_b32 a17, v201
    ds_write_b128 v248, v[222:225] offset:384
    ds_write_b64 v249, v[226:227] offset:448
    v_accvgpr_read_b32 v192, a24
    v_accvgpr_read_b32 v193, a25
    v_accvgpr_read_b32 v194, a26
    v_accvgpr_read_b32 v195, a27
    v_accvgpr_read_b32 v196, a120
    v_accvgpr_read_b32 v197, a121
    v_accvgpr_read_b32 v198, a122
    v_accvgpr_read_b32 v199, a123
    v_pk_add_f32 v[200:201], v[192:193], v[196:197]
    v_pk_add_f32 v[202:203], v[194:195], v[198:199]
    v_pk_add_f32 v[192:193], v[192:193], v[196:197] neg_lo:[0,1] neg_hi:[0,1]
    v_pk_add_f32 v[194:195], v[194:195], v[198:199] neg_lo:[0,1] neg_hi:[0,1]
    v_pk_add_f32 v[196:197], v[24:25], v[120:121] neg_lo:[0,1] neg_hi:[0,1]
    v_pk_add_f32 v[198:199], v[26:27], v[122:123] neg_lo:[0,1] neg_hi:[0,1]
    v_pk_add_f32 v[24:25], v[24:25], v[120:121]
    v_pk_add_f32 v[26:27], v[26:27], v[122:123]
    v_pk_fma_f32 v[120:121], v[192:193], s[30:31], v[196:197]
    v_pk_fma_f32 v[122:123], v[194:195], s[30:31], v[198:199]
    v_pk_fma_f32 v[192:193], v[196:197], s[30:31], v[192:193]
    v_pk_fma_f32 v[194:195], v[198:199], s[30:31], v[194:195]
    v_pk_add_f32 v[196:197], v[200:201], v[24:25]
    v_pk_add_f32 v[198:199], v[202:203], v[26:27]
    v_pk_mul_f32 v[24:25], v[24:25], s[34:35]
    v_pk_mul_f32 v[26:27], v[26:27], s[34:35]
    v_pk_mul_f32 v[196:197], v[196:197], s[32:33]
    v_pk_mul_f32 v[198:199], v[198:199], s[32:33]
    v_pk_fma_f32 v[24:25], v[200:201], s[36:37], v[24:25]
    v_pk_fma_f32 v[26:27], v[202:203], s[36:37], v[26:27]
    v_cvt_pk_bf16_f32 v216, v192, v193
    v_cvt_pk_bf16_f32 v217, v194, v195
    v_cvt_pk_bf16_f32 v200, v196, v197
    v_cvt_pk_bf16_f32 v201, v198, v199
    v_accvgpr_write_b32 a24, v200
    v_accvgpr_write_b32 a25, v201
    v_accvgpr_read_b32 v204, a28
    v_accvgpr_read_b32 v205, a29
    v_accvgpr_read_b32 v206, a30
    v_accvgpr_read_b32 v207, a31
    v_accvgpr_read_b32 v208, a124
    v_accvgpr_read_b32 v209, a125
    v_accvgpr_read_b32 v210, a126
    v_accvgpr_read_b32 v211, a127
    v_pk_add_f32 v[212:213], v[204:205], v[208:209]
    v_pk_add_f32 v[214:215], v[206:207], v[210:211]
    v_pk_add_f32 v[204:205], v[204:205], v[208:209] neg_lo:[0,1] neg_hi:[0,1]
    v_pk_add_f32 v[206:207], v[206:207], v[210:211] neg_lo:[0,1] neg_hi:[0,1]
    v_pk_add_f32 v[208:209], v[28:29], v[124:125] neg_lo:[0,1] neg_hi:[0,1]
    v_pk_add_f32 v[210:211], v[30:31], v[126:127] neg_lo:[0,1] neg_hi:[0,1]
    v_pk_add_f32 v[28:29], v[28:29], v[124:125]
    v_pk_add_f32 v[30:31], v[30:31], v[126:127]
    v_pk_fma_f32 v[124:125], v[204:205], s[30:31], v[208:209]
    v_pk_fma_f32 v[126:127], v[206:207], s[30:31], v[210:211]
    v_pk_fma_f32 v[204:205], v[208:209], s[30:31], v[204:205]
    v_pk_fma_f32 v[206:207], v[210:211], s[30:31], v[206:207]
    v_pk_add_f32 v[208:209], v[212:213], v[28:29]
    v_pk_add_f32 v[210:211], v[214:215], v[30:31]
    v_pk_mul_f32 v[28:29], v[28:29], s[34:35]
    v_pk_mul_f32 v[30:31], v[30:31], s[34:35]
    v_pk_mul_f32 v[208:209], v[208:209], s[32:33]
    v_pk_mul_f32 v[210:211], v[210:211], s[32:33]
    v_pk_fma_f32 v[28:29], v[212:213], s[36:37], v[28:29]
    v_pk_fma_f32 v[30:31], v[214:215], s[36:37], v[30:31]
    v_cvt_pk_bf16_f32 v218, v204, v205
    v_cvt_pk_bf16_f32 v219, v206, v207
    v_cvt_pk_bf16_f32 v212, v208, v209
    v_cvt_pk_bf16_f32 v213, v210, v211
    v_accvgpr_write_b32 a26, v212
    v_accvgpr_write_b32 a27, v213
    v_accvgpr_read_b32 v192, a32
    v_accvgpr_read_b32 v193, a33
    v_accvgpr_read_b32 v194, a34
    v_accvgpr_read_b32 v195, a35
    v_accvgpr_read_b32 v196, a128
    v_accvgpr_read_b32 v197, a129
    v_accvgpr_read_b32 v198, a130
    v_accvgpr_read_b32 v199, a131
    v_pk_add_f32 v[200:201], v[192:193], v[196:197]
    v_pk_add_f32 v[202:203], v[194:195], v[198:199]
    v_pk_add_f32 v[192:193], v[192:193], v[196:197] neg_lo:[0,1] neg_hi:[0,1]
    v_pk_add_f32 v[194:195], v[194:195], v[198:199] neg_lo:[0,1] neg_hi:[0,1]
    v_pk_add_f32 v[196:197], v[32:33], v[128:129] neg_lo:[0,1] neg_hi:[0,1]
    v_pk_add_f32 v[198:199], v[34:35], v[130:131] neg_lo:[0,1] neg_hi:[0,1]
    v_pk_add_f32 v[32:33], v[32:33], v[128:129]
    v_pk_add_f32 v[34:35], v[34:35], v[130:131]
    v_pk_fma_f32 v[128:129], v[192:193], s[30:31], v[196:197]
    v_pk_fma_f32 v[130:131], v[194:195], s[30:31], v[198:199]
    v_pk_fma_f32 v[192:193], v[196:197], s[30:31], v[192:193]
    v_pk_fma_f32 v[194:195], v[198:199], s[30:31], v[194:195]
    v_pk_add_f32 v[196:197], v[200:201], v[32:33]
    v_pk_add_f32 v[198:199], v[202:203], v[34:35]
    v_pk_mul_f32 v[32:33], v[32:33], s[34:35]
    v_pk_mul_f32 v[34:35], v[34:35], s[34:35]
    v_pk_mul_f32 v[196:197], v[196:197], s[32:33]
    v_pk_mul_f32 v[198:199], v[198:199], s[32:33]
    v_pk_fma_f32 v[32:33], v[200:201], s[36:37], v[32:33]
    v_pk_fma_f32 v[34:35], v[202:203], s[36:37], v[34:35]
    v_cvt_pk_bf16_f32 v220, v192, v193
    v_cvt_pk_bf16_f32 v221, v194, v195
    v_cvt_pk_bf16_f32 v200, v196, v197
    v_cvt_pk_bf16_f32 v201, v198, v199
    v_accvgpr_write_b32 a28, v200
    v_accvgpr_write_b32 a29, v201
    ds_write_b128 v248, v[216:219] offset:768
    ds_write_b64 v249, v[220:221] offset:832
    v_accvgpr_read_b32 v192, a36
    v_accvgpr_read_b32 v193, a37
    v_accvgpr_read_b32 v194, a38
    v_accvgpr_read_b32 v195, a39
    v_accvgpr_read_b32 v196, a132
    v_accvgpr_read_b32 v197, a133
    v_accvgpr_read_b32 v198, a134
    v_accvgpr_read_b32 v199, a135
    v_pk_add_f32 v[200:201], v[192:193], v[196:197]
    v_pk_add_f32 v[202:203], v[194:195], v[198:199]
    v_pk_add_f32 v[192:193], v[192:193], v[196:197] neg_lo:[0,1] neg_hi:[0,1]
    v_pk_add_f32 v[194:195], v[194:195], v[198:199] neg_lo:[0,1] neg_hi:[0,1]
    v_pk_add_f32 v[196:197], v[36:37], v[132:133] neg_lo:[0,1] neg_hi:[0,1]
    v_pk_add_f32 v[198:199], v[38:39], v[134:135] neg_lo:[0,1] neg_hi:[0,1]
    v_pk_add_f32 v[36:37], v[36:37], v[132:133]
    v_pk_add_f32 v[38:39], v[38:39], v[134:135]
    v_pk_fma_f32 v[132:133], v[192:193], s[30:31], v[196:197]
    v_pk_fma_f32 v[134:135], v[194:195], s[30:31], v[198:199]
    v_pk_fma_f32 v[192:193], v[196:197], s[30:31], v[192:193]
    v_pk_fma_f32 v[194:195], v[198:199], s[30:31], v[194:195]
    v_pk_add_f32 v[196:197], v[200:201], v[36:37]
    v_pk_add_f32 v[198:199], v[202:203], v[38:39]
    v_pk_mul_f32 v[36:37], v[36:37], s[34:35]
    v_pk_mul_f32 v[38:39], v[38:39], s[34:35]
    v_pk_mul_f32 v[196:197], v[196:197], s[32:33]
    v_pk_mul_f32 v[198:199], v[198:199], s[32:33]
    v_pk_fma_f32 v[36:37], v[200:201], s[36:37], v[36:37]
    v_pk_fma_f32 v[38:39], v[202:203], s[36:37], v[38:39]
    v_cvt_pk_bf16_f32 v222, v192, v193
    v_cvt_pk_bf16_f32 v223, v194, v195
    v_cvt_pk_bf16_f32 v200, v196, v197
    v_cvt_pk_bf16_f32 v201, v198, v199
    v_accvgpr_write_b32 a36, v200
    v_accvgpr_write_b32 a37, v201
    v_accvgpr_read_b32 v204, a40
    v_accvgpr_read_b32 v205, a41
    v_accvgpr_read_b32 v206, a42
    v_accvgpr_read_b32 v207, a43
    v_accvgpr_read_b32 v208, a136
    v_accvgpr_read_b32 v209, a137
    v_accvgpr_read_b32 v210, a138
    v_accvgpr_read_b32 v211, a139
    v_pk_add_f32 v[212:213], v[204:205], v[208:209]
    v_pk_add_f32 v[214:215], v[206:207], v[210:211]
    v_pk_add_f32 v[204:205], v[204:205], v[208:209] neg_lo:[0,1] neg_hi:[0,1]
    v_pk_add_f32 v[206:207], v[206:207], v[210:211] neg_lo:[0,1] neg_hi:[0,1]
    v_pk_add_f32 v[208:209], v[40:41], v[136:137] neg_lo:[0,1] neg_hi:[0,1]
    v_pk_add_f32 v[210:211], v[42:43], v[138:139] neg_lo:[0,1] neg_hi:[0,1]
    v_pk_add_f32 v[40:41], v[40:41], v[136:137]
    v_pk_add_f32 v[42:43], v[42:43], v[138:139]
    v_pk_fma_f32 v[136:137], v[204:205], s[30:31], v[208:209]
    v_pk_fma_f32 v[138:139], v[206:207], s[30:31], v[210:211]
    v_pk_fma_f32 v[204:205], v[208:209], s[30:31], v[204:205]
    v_pk_fma_f32 v[206:207], v[210:211], s[30:31], v[206:207]
    v_pk_add_f32 v[208:209], v[212:213], v[40:41]
    v_pk_add_f32 v[210:211], v[214:215], v[42:43]
    v_pk_mul_f32 v[40:41], v[40:41], s[34:35]
    v_pk_mul_f32 v[42:43], v[42:43], s[34:35]
    v_pk_mul_f32 v[208:209], v[208:209], s[32:33]
    v_pk_mul_f32 v[210:211], v[210:211], s[32:33]
    v_pk_fma_f32 v[40:41], v[212:213], s[36:37], v[40:41]
    v_pk_fma_f32 v[42:43], v[214:215], s[36:37], v[42:43]
    v_cvt_pk_bf16_f32 v224, v204, v205
    v_cvt_pk_bf16_f32 v225, v206, v207
    v_cvt_pk_bf16_f32 v212, v208, v209
    v_cvt_pk_bf16_f32 v213, v210, v211
    v_accvgpr_write_b32 a38, v212
    v_accvgpr_write_b32 a39, v213
    v_accvgpr_read_b32 v192, a44
    v_accvgpr_read_b32 v193, a45
    v_accvgpr_read_b32 v194, a46
    v_accvgpr_read_b32 v195, a47
    v_accvgpr_read_b32 v196, a140
    v_accvgpr_read_b32 v197, a141
    v_accvgpr_read_b32 v198, a142
    v_accvgpr_read_b32 v199, a143
    v_pk_add_f32 v[200:201], v[192:193], v[196:197]
    v_pk_add_f32 v[202:203], v[194:195], v[198:199]
    v_pk_add_f32 v[192:193], v[192:193], v[196:197] neg_lo:[0,1] neg_hi:[0,1]
    v_pk_add_f32 v[194:195], v[194:195], v[198:199] neg_lo:[0,1] neg_hi:[0,1]
    v_pk_add_f32 v[196:197], v[44:45], v[140:141] neg_lo:[0,1] neg_hi:[0,1]
    v_pk_add_f32 v[198:199], v[46:47], v[142:143] neg_lo:[0,1] neg_hi:[0,1]
    v_pk_add_f32 v[44:45], v[44:45], v[140:141]
    v_pk_add_f32 v[46:47], v[46:47], v[142:143]
    v_pk_fma_f32 v[140:141], v[192:193], s[30:31], v[196:197]
    v_pk_fma_f32 v[142:143], v[194:195], s[30:31], v[198:199]
    v_pk_fma_f32 v[192:193], v[196:197], s[30:31], v[192:193]
    v_pk_fma_f32 v[194:195], v[198:199], s[30:31], v[194:195]
    v_pk_add_f32 v[196:197], v[200:201], v[44:45]
    v_pk_add_f32 v[198:199], v[202:203], v[46:47]
    v_pk_mul_f32 v[44:45], v[44:45], s[34:35]
    v_pk_mul_f32 v[46:47], v[46:47], s[34:35]
    v_pk_mul_f32 v[196:197], v[196:197], s[32:33]
    v_pk_mul_f32 v[198:199], v[198:199], s[32:33]
    v_pk_fma_f32 v[44:45], v[200:201], s[36:37], v[44:45]
    v_pk_fma_f32 v[46:47], v[202:203], s[36:37], v[46:47]
    v_cvt_pk_bf16_f32 v226, v192, v193
    v_cvt_pk_bf16_f32 v227, v194, v195
    v_cvt_pk_bf16_f32 v200, v196, v197
    v_cvt_pk_bf16_f32 v201, v198, v199
    v_accvgpr_write_b32 a40, v200
    v_accvgpr_write_b32 a41, v201
    ds_write_b128 v248, v[222:225] offset:1152
    ds_write_b64 v249, v[226:227] offset:1216
    v_accvgpr_read_b32 v192, a48
    v_accvgpr_read_b32 v193, a49
    v_accvgpr_read_b32 v194, a50
    v_accvgpr_read_b32 v195, a51
    v_accvgpr_read_b32 v196, a144
    v_accvgpr_read_b32 v197, a145
    v_accvgpr_read_b32 v198, a146
    v_accvgpr_read_b32 v199, a147
    v_pk_add_f32 v[200:201], v[192:193], v[196:197]
    v_pk_add_f32 v[202:203], v[194:195], v[198:199]
    v_pk_add_f32 v[192:193], v[192:193], v[196:197] neg_lo:[0,1] neg_hi:[0,1]
    v_pk_add_f32 v[194:195], v[194:195], v[198:199] neg_lo:[0,1] neg_hi:[0,1]
    v_pk_add_f32 v[196:197], v[48:49], v[144:145] neg_lo:[0,1] neg_hi:[0,1]
    v_pk_add_f32 v[198:199], v[50:51], v[146:147] neg_lo:[0,1] neg_hi:[0,1]
    v_pk_add_f32 v[48:49], v[48:49], v[144:145]
    v_pk_add_f32 v[50:51], v[50:51], v[146:147]
    v_pk_fma_f32 v[144:145], v[192:193], s[30:31], v[196:197]
    v_pk_fma_f32 v[146:147], v[194:195], s[30:31], v[198:199]
    v_pk_fma_f32 v[192:193], v[196:197], s[30:31], v[192:193]
    v_pk_fma_f32 v[194:195], v[198:199], s[30:31], v[194:195]
    v_pk_add_f32 v[196:197], v[200:201], v[48:49]
    v_pk_add_f32 v[198:199], v[202:203], v[50:51]
    v_pk_mul_f32 v[48:49], v[48:49], s[34:35]
    v_pk_mul_f32 v[50:51], v[50:51], s[34:35]
    v_pk_mul_f32 v[196:197], v[196:197], s[32:33]
    v_pk_mul_f32 v[198:199], v[198:199], s[32:33]
    v_pk_fma_f32 v[48:49], v[200:201], s[36:37], v[48:49]
    v_pk_fma_f32 v[50:51], v[202:203], s[36:37], v[50:51]
    v_cvt_pk_bf16_f32 v216, v192, v193
    v_cvt_pk_bf16_f32 v217, v194, v195
    v_cvt_pk_bf16_f32 v200, v196, v197
    v_cvt_pk_bf16_f32 v201, v198, v199
    v_accvgpr_write_b32 a48, v200
    v_accvgpr_write_b32 a49, v201
    v_accvgpr_read_b32 v204, a52
    v_accvgpr_read_b32 v205, a53
    v_accvgpr_read_b32 v206, a54
    v_accvgpr_read_b32 v207, a55
    v_accvgpr_read_b32 v208, a148
    v_accvgpr_read_b32 v209, a149
    v_accvgpr_read_b32 v210, a150
    v_accvgpr_read_b32 v211, a151
    v_pk_add_f32 v[212:213], v[204:205], v[208:209]
    v_pk_add_f32 v[214:215], v[206:207], v[210:211]
    v_pk_add_f32 v[204:205], v[204:205], v[208:209] neg_lo:[0,1] neg_hi:[0,1]
    v_pk_add_f32 v[206:207], v[206:207], v[210:211] neg_lo:[0,1] neg_hi:[0,1]
    v_pk_add_f32 v[208:209], v[52:53], v[148:149] neg_lo:[0,1] neg_hi:[0,1]
    v_pk_add_f32 v[210:211], v[54:55], v[150:151] neg_lo:[0,1] neg_hi:[0,1]
    v_pk_add_f32 v[52:53], v[52:53], v[148:149]
    v_pk_add_f32 v[54:55], v[54:55], v[150:151]
    v_pk_fma_f32 v[148:149], v[204:205], s[30:31], v[208:209]
    v_pk_fma_f32 v[150:151], v[206:207], s[30:31], v[210:211]
    v_pk_fma_f32 v[204:205], v[208:209], s[30:31], v[204:205]
    v_pk_fma_f32 v[206:207], v[210:211], s[30:31], v[206:207]
    v_pk_add_f32 v[208:209], v[212:213], v[52:53]
    v_pk_add_f32 v[210:211], v[214:215], v[54:55]
    v_pk_mul_f32 v[52:53], v[52:53], s[34:35]
    v_pk_mul_f32 v[54:55], v[54:55], s[34:35]
    v_pk_mul_f32 v[208:209], v[208:209], s[32:33]
    v_pk_mul_f32 v[210:211], v[210:211], s[32:33]
    v_pk_fma_f32 v[52:53], v[212:213], s[36:37], v[52:53]
    v_pk_fma_f32 v[54:55], v[214:215], s[36:37], v[54:55]
    v_cvt_pk_bf16_f32 v218, v204, v205
    v_cvt_pk_bf16_f32 v219, v206, v207
    v_cvt_pk_bf16_f32 v212, v208, v209
    v_cvt_pk_bf16_f32 v213, v210, v211
    v_accvgpr_write_b32 a50, v212
    v_accvgpr_write_b32 a51, v213
    v_accvgpr_read_b32 v192, a56
    v_accvgpr_read_b32 v193, a57
    v_accvgpr_read_b32 v194, a58
    v_accvgpr_read_b32 v195, a59
    v_accvgpr_read_b32 v196, a152
    v_accvgpr_read_b32 v197, a153
    v_accvgpr_read_b32 v198, a154
    v_accvgpr_read_b32 v199, a155
    v_pk_add_f32 v[200:201], v[192:193], v[196:197]
    v_pk_add_f32 v[202:203], v[194:195], v[198:199]
    v_pk_add_f32 v[192:193], v[192:193], v[196:197] neg_lo:[0,1] neg_hi:[0,1]
    v_pk_add_f32 v[194:195], v[194:195], v[198:199] neg_lo:[0,1] neg_hi:[0,1]
    v_pk_add_f32 v[196:197], v[56:57], v[152:153] neg_lo:[0,1] neg_hi:[0,1]
    v_pk_add_f32 v[198:199], v[58:59], v[154:155] neg_lo:[0,1] neg_hi:[0,1]
    v_pk_add_f32 v[56:57], v[56:57], v[152:153]
    v_pk_add_f32 v[58:59], v[58:59], v[154:155]
    v_pk_fma_f32 v[152:153], v[192:193], s[30:31], v[196:197]
    v_pk_fma_f32 v[154:155], v[194:195], s[30:31], v[198:199]
    v_pk_fma_f32 v[192:193], v[196:197], s[30:31], v[192:193]
    v_pk_fma_f32 v[194:195], v[198:199], s[30:31], v[194:195]
    v_pk_add_f32 v[196:197], v[200:201], v[56:57]
    v_pk_add_f32 v[198:199], v[202:203], v[58:59]
    v_pk_mul_f32 v[56:57], v[56:57], s[34:35]
    v_pk_mul_f32 v[58:59], v[58:59], s[34:35]
    v_pk_mul_f32 v[196:197], v[196:197], s[32:33]
    v_pk_mul_f32 v[198:199], v[198:199], s[32:33]
    v_pk_fma_f32 v[56:57], v[200:201], s[36:37], v[56:57]
    v_pk_fma_f32 v[58:59], v[202:203], s[36:37], v[58:59]
    v_cvt_pk_bf16_f32 v220, v192, v193
    v_cvt_pk_bf16_f32 v221, v194, v195
    v_cvt_pk_bf16_f32 v200, v196, v197
    v_cvt_pk_bf16_f32 v201, v198, v199
    v_accvgpr_write_b32 a52, v200
    v_accvgpr_write_b32 a53, v201
    ds_write_b128 v248, v[216:219] offset:1536
    ds_write_b64 v249, v[220:221] offset:1600
    v_accvgpr_read_b32 v192, a60
    v_accvgpr_read_b32 v193, a61
    v_accvgpr_read_b32 v194, a62
    v_accvgpr_read_b32 v195, a63
    v_accvgpr_read_b32 v196, a156
    v_accvgpr_read_b32 v197, a157
    v_accvgpr_read_b32 v198, a158
    v_accvgpr_read_b32 v199, a159
    v_pk_add_f32 v[200:201], v[192:193], v[196:197]
    v_pk_add_f32 v[202:203], v[194:195], v[198:199]
    v_pk_add_f32 v[192:193], v[192:193], v[196:197] neg_lo:[0,1] neg_hi:[0,1]
    v_pk_add_f32 v[194:195], v[194:195], v[198:199] neg_lo:[0,1] neg_hi:[0,1]
    v_pk_add_f32 v[196:197], v[60:61], v[156:157] neg_lo:[0,1] neg_hi:[0,1]
    v_pk_add_f32 v[198:199], v[62:63], v[158:159] neg_lo:[0,1] neg_hi:[0,1]
    v_pk_add_f32 v[60:61], v[60:61], v[156:157]
    v_pk_add_f32 v[62:63], v[62:63], v[158:159]
    v_pk_fma_f32 v[156:157], v[192:193], s[30:31], v[196:197]
    v_pk_fma_f32 v[158:159], v[194:195], s[30:31], v[198:199]
    v_pk_fma_f32 v[192:193], v[196:197], s[30:31], v[192:193]
    v_pk_fma_f32 v[194:195], v[198:199], s[30:31], v[194:195]
    v_pk_add_f32 v[196:197], v[200:201], v[60:61]
    v_pk_add_f32 v[198:199], v[202:203], v[62:63]
    v_pk_mul_f32 v[60:61], v[60:61], s[34:35]
    v_pk_mul_f32 v[62:63], v[62:63], s[34:35]
    v_pk_mul_f32 v[196:197], v[196:197], s[32:33]
    v_pk_mul_f32 v[198:199], v[198:199], s[32:33]
    v_pk_fma_f32 v[60:61], v[200:201], s[36:37], v[60:61]
    v_pk_fma_f32 v[62:63], v[202:203], s[36:37], v[62:63]
    v_cvt_pk_bf16_f32 v222, v192, v193
    v_cvt_pk_bf16_f32 v223, v194, v195
    v_cvt_pk_bf16_f32 v200, v196, v197
    v_cvt_pk_bf16_f32 v201, v198, v199
    v_accvgpr_write_b32 a60, v200
    v_accvgpr_write_b32 a61, v201
    v_accvgpr_read_b32 v204, a64
    v_accvgpr_read_b32 v205, a65
    v_accvgpr_read_b32 v206, a66
    v_accvgpr_read_b32 v207, a67
    v_accvgpr_read_b32 v208, a160
    v_accvgpr_read_b32 v209, a161
    v_accvgpr_read_b32 v210, a162
    v_accvgpr_read_b32 v211, a163
    v_pk_add_f32 v[212:213], v[204:205], v[208:209]
    v_pk_add_f32 v[214:215], v[206:207], v[210:211]
    v_pk_add_f32 v[204:205], v[204:205], v[208:209] neg_lo:[0,1] neg_hi:[0,1]
    v_pk_add_f32 v[206:207], v[206:207], v[210:211] neg_lo:[0,1] neg_hi:[0,1]
    v_pk_add_f32 v[208:209], v[64:65], v[160:161] neg_lo:[0,1] neg_hi:[0,1]
    v_pk_add_f32 v[210:211], v[66:67], v[162:163] neg_lo:[0,1] neg_hi:[0,1]
    v_pk_add_f32 v[64:65], v[64:65], v[160:161]
    v_pk_add_f32 v[66:67], v[66:67], v[162:163]
    v_pk_fma_f32 v[160:161], v[204:205], s[30:31], v[208:209]
    v_pk_fma_f32 v[162:163], v[206:207], s[30:31], v[210:211]
    v_pk_fma_f32 v[204:205], v[208:209], s[30:31], v[204:205]
    v_pk_fma_f32 v[206:207], v[210:211], s[30:31], v[206:207]
    v_pk_add_f32 v[208:209], v[212:213], v[64:65]
    v_pk_add_f32 v[210:211], v[214:215], v[66:67]
    v_pk_mul_f32 v[64:65], v[64:65], s[34:35]
    v_pk_mul_f32 v[66:67], v[66:67], s[34:35]
    v_pk_mul_f32 v[208:209], v[208:209], s[32:33]
    v_pk_mul_f32 v[210:211], v[210:211], s[32:33]
    v_pk_fma_f32 v[64:65], v[212:213], s[36:37], v[64:65]
    v_pk_fma_f32 v[66:67], v[214:215], s[36:37], v[66:67]
    v_cvt_pk_bf16_f32 v224, v204, v205
    v_cvt_pk_bf16_f32 v225, v206, v207
    v_cvt_pk_bf16_f32 v212, v208, v209
    v_cvt_pk_bf16_f32 v213, v210, v211
    v_accvgpr_write_b32 a62, v212
    v_accvgpr_write_b32 a63, v213
    v_accvgpr_read_b32 v192, a68
    v_accvgpr_read_b32 v193, a69
    v_accvgpr_read_b32 v194, a70
    v_accvgpr_read_b32 v195, a71
    v_accvgpr_read_b32 v196, a164
    v_accvgpr_read_b32 v197, a165
    v_accvgpr_read_b32 v198, a166
    v_accvgpr_read_b32 v199, a167
    v_pk_add_f32 v[200:201], v[192:193], v[196:197]
    v_pk_add_f32 v[202:203], v[194:195], v[198:199]
    v_pk_add_f32 v[192:193], v[192:193], v[196:197] neg_lo:[0,1] neg_hi:[0,1]
    v_pk_add_f32 v[194:195], v[194:195], v[198:199] neg_lo:[0,1] neg_hi:[0,1]
    v_pk_add_f32 v[196:197], v[68:69], v[164:165] neg_lo:[0,1] neg_hi:[0,1]
    v_pk_add_f32 v[198:199], v[70:71], v[166:167] neg_lo:[0,1] neg_hi:[0,1]
    v_pk_add_f32 v[68:69], v[68:69], v[164:165]
    v_pk_add_f32 v[70:71], v[70:71], v[166:167]
    v_pk_fma_f32 v[164:165], v[192:193], s[30:31], v[196:197]
    v_pk_fma_f32 v[166:167], v[194:195], s[30:31], v[198:199]
    v_pk_fma_f32 v[192:193], v[196:197], s[30:31], v[192:193]
    v_pk_fma_f32 v[194:195], v[198:199], s[30:31], v[194:195]
    v_pk_add_f32 v[196:197], v[200:201], v[68:69]
    v_pk_add_f32 v[198:199], v[202:203], v[70:71]
    v_pk_mul_f32 v[68:69], v[68:69], s[34:35]
    v_pk_mul_f32 v[70:71], v[70:71], s[34:35]
    v_pk_mul_f32 v[196:197], v[196:197], s[32:33]
    v_pk_mul_f32 v[198:199], v[198:199], s[32:33]
    v_pk_fma_f32 v[68:69], v[200:201], s[36:37], v[68:69]
    v_pk_fma_f32 v[70:71], v[202:203], s[36:37], v[70:71]
    v_cvt_pk_bf16_f32 v226, v192, v193
    v_cvt_pk_bf16_f32 v227, v194, v195
    v_cvt_pk_bf16_f32 v200, v196, v197
    v_cvt_pk_bf16_f32 v201, v198, v199
    v_accvgpr_write_b32 a64, v200
    v_accvgpr_write_b32 a65, v201
    ds_write_b128 v248, v[222:225] offset:1920
    ds_write_b64 v249, v[226:227] offset:1984
    v_accvgpr_read_b32 v192, a72
    v_accvgpr_read_b32 v193, a73
    v_accvgpr_read_b32 v194, a74
    v_accvgpr_read_b32 v195, a75
    v_accvgpr_read_b32 v196, a168
    v_accvgpr_read_b32 v197, a169
    v_accvgpr_read_b32 v198, a170
    v_accvgpr_read_b32 v199, a171
    v_pk_add_f32 v[200:201], v[192:193], v[196:197]
    v_pk_add_f32 v[202:203], v[194:195], v[198:199]
    v_pk_add_f32 v[192:193], v[192:193], v[196:197] neg_lo:[0,1] neg_hi:[0,1]
    v_pk_add_f32 v[194:195], v[194:195], v[198:199] neg_lo:[0,1] neg_hi:[0,1]
    v_pk_add_f32 v[196:197], v[72:73], v[168:169] neg_lo:[0,1] neg_hi:[0,1]
    v_pk_add_f32 v[198:199], v[74:75], v[170:171] neg_lo:[0,1] neg_hi:[0,1]
    v_pk_add_f32 v[72:73], v[72:73], v[168:169]
    v_pk_add_f32 v[74:75], v[74:75], v[170:171]
    v_pk_fma_f32 v[168:169], v[192:193], s[30:31], v[196:197]
    v_pk_fma_f32 v[170:171], v[194:195], s[30:31], v[198:199]
    v_pk_fma_f32 v[192:193], v[196:197], s[30:31], v[192:193]
    v_pk_fma_f32 v[194:195], v[198:199], s[30:31], v[194:195]
    v_pk_add_f32 v[196:197], v[200:201], v[72:73]
    v_pk_add_f32 v[198:199], v[202:203], v[74:75]
    v_pk_mul_f32 v[72:73], v[72:73], s[34:35]
    v_pk_mul_f32 v[74:75], v[74:75], s[34:35]
    v_pk_mul_f32 v[196:197], v[196:197], s[32:33]
    v_pk_mul_f32 v[198:199], v[198:199], s[32:33]
    v_pk_fma_f32 v[72:73], v[200:201], s[36:37], v[72:73]
    v_pk_fma_f32 v[74:75], v[202:203], s[36:37], v[74:75]
    v_cvt_pk_bf16_f32 v216, v192, v193
    v_cvt_pk_bf16_f32 v217, v194, v195
    v_cvt_pk_bf16_f32 v200, v196, v197
    v_cvt_pk_bf16_f32 v201, v198, v199
    v_accvgpr_write_b32 a72, v200
    v_accvgpr_write_b32 a73, v201
    v_accvgpr_read_b32 v204, a76
    v_accvgpr_read_b32 v205, a77
    v_accvgpr_read_b32 v206, a78
    v_accvgpr_read_b32 v207, a79
    v_accvgpr_read_b32 v208, a172
    v_accvgpr_read_b32 v209, a173
    v_accvgpr_read_b32 v210, a174
    v_accvgpr_read_b32 v211, a175
    v_pk_add_f32 v[212:213], v[204:205], v[208:209]
    v_pk_add_f32 v[214:215], v[206:207], v[210:211]
    v_pk_add_f32 v[204:205], v[204:205], v[208:209] neg_lo:[0,1] neg_hi:[0,1]
    v_pk_add_f32 v[206:207], v[206:207], v[210:211] neg_lo:[0,1] neg_hi:[0,1]
    v_pk_add_f32 v[208:209], v[76:77], v[172:173] neg_lo:[0,1] neg_hi:[0,1]
    v_pk_add_f32 v[210:211], v[78:79], v[174:175] neg_lo:[0,1] neg_hi:[0,1]
    v_pk_add_f32 v[76:77], v[76:77], v[172:173]
    v_pk_add_f32 v[78:79], v[78:79], v[174:175]
    v_pk_fma_f32 v[172:173], v[204:205], s[30:31], v[208:209]
    v_pk_fma_f32 v[174:175], v[206:207], s[30:31], v[210:211]
    v_pk_fma_f32 v[204:205], v[208:209], s[30:31], v[204:205]
    v_pk_fma_f32 v[206:207], v[210:211], s[30:31], v[206:207]
    v_pk_add_f32 v[208:209], v[212:213], v[76:77]
    v_pk_add_f32 v[210:211], v[214:215], v[78:79]
    v_pk_mul_f32 v[76:77], v[76:77], s[34:35]
    v_pk_mul_f32 v[78:79], v[78:79], s[34:35]
    v_pk_mul_f32 v[208:209], v[208:209], s[32:33]
    v_pk_mul_f32 v[210:211], v[210:211], s[32:33]
    v_pk_fma_f32 v[76:77], v[212:213], s[36:37], v[76:77]
    v_pk_fma_f32 v[78:79], v[214:215], s[36:37], v[78:79]
    v_cvt_pk_bf16_f32 v218, v204, v205
    v_cvt_pk_bf16_f32 v219, v206, v207
    v_cvt_pk_bf16_f32 v212, v208, v209
    v_cvt_pk_bf16_f32 v213, v210, v211
    v_accvgpr_write_b32 a74, v212
    v_accvgpr_write_b32 a75, v213
    v_accvgpr_read_b32 v192, a80
    v_accvgpr_read_b32 v193, a81
    v_accvgpr_read_b32 v194, a82
    v_accvgpr_read_b32 v195, a83
    v_accvgpr_read_b32 v196, a176
    v_accvgpr_read_b32 v197, a177
    v_accvgpr_read_b32 v198, a178
    v_accvgpr_read_b32 v199, a179
    v_pk_add_f32 v[200:201], v[192:193], v[196:197]
    v_pk_add_f32 v[202:203], v[194:195], v[198:199]
    v_pk_add_f32 v[192:193], v[192:193], v[196:197] neg_lo:[0,1] neg_hi:[0,1]
    v_pk_add_f32 v[194:195], v[194:195], v[198:199] neg_lo:[0,1] neg_hi:[0,1]
    v_pk_add_f32 v[196:197], v[80:81], v[176:177] neg_lo:[0,1] neg_hi:[0,1]
    v_pk_add_f32 v[198:199], v[82:83], v[178:179] neg_lo:[0,1] neg_hi:[0,1]
    v_pk_add_f32 v[80:81], v[80:81], v[176:177]
    v_pk_add_f32 v[82:83], v[82:83], v[178:179]
    v_pk_fma_f32 v[176:177], v[192:193], s[30:31], v[196:197]
    v_pk_fma_f32 v[178:179], v[194:195], s[30:31], v[198:199]
    v_pk_fma_f32 v[192:193], v[196:197], s[30:31], v[192:193]
    v_pk_fma_f32 v[194:195], v[198:199], s[30:31], v[194:195]
    v_pk_add_f32 v[196:197], v[200:201], v[80:81]
    v_pk_add_f32 v[198:199], v[202:203], v[82:83]
    v_pk_mul_f32 v[80:81], v[80:81], s[34:35]
    v_pk_mul_f32 v[82:83], v[82:83], s[34:35]
    v_pk_mul_f32 v[196:197], v[196:197], s[32:33]
    v_pk_mul_f32 v[198:199], v[198:199], s[32:33]
    v_pk_fma_f32 v[80:81], v[200:201], s[36:37], v[80:81]
    v_pk_fma_f32 v[82:83], v[202:203], s[36:37], v[82:83]
    v_cvt_pk_bf16_f32 v220, v192, v193
    v_cvt_pk_bf16_f32 v221, v194, v195
    v_cvt_pk_bf16_f32 v200, v196, v197
    v_cvt_pk_bf16_f32 v201, v198, v199
    v_accvgpr_write_b32 a76, v200
    v_accvgpr_write_b32 a77, v201
    ds_write_b128 v248, v[216:219] offset:2304
    ds_write_b64 v249, v[220:221] offset:2368
    v_accvgpr_read_b32 v192, a84
    v_accvgpr_read_b32 v193, a85
    v_accvgpr_read_b32 v194, a86
    v_accvgpr_read_b32 v195, a87
    v_accvgpr_read_b32 v196, a180
    v_accvgpr_read_b32 v197, a181
    v_accvgpr_read_b32 v198, a182
    v_accvgpr_read_b32 v199, a183
    v_pk_add_f32 v[200:201], v[192:193], v[196:197]
    v_pk_add_f32 v[202:203], v[194:195], v[198:199]
    v_pk_add_f32 v[192:193], v[192:193], v[196:197] neg_lo:[0,1] neg_hi:[0,1]
    v_pk_add_f32 v[194:195], v[194:195], v[198:199] neg_lo:[0,1] neg_hi:[0,1]
    v_pk_add_f32 v[196:197], v[84:85], v[180:181] neg_lo:[0,1] neg_hi:[0,1]
    v_pk_add_f32 v[198:199], v[86:87], v[182:183] neg_lo:[0,1] neg_hi:[0,1]
    v_pk_add_f32 v[84:85], v[84:85], v[180:181]
    v_pk_add_f32 v[86:87], v[86:87], v[182:183]
    v_pk_fma_f32 v[180:181], v[192:193], s[30:31], v[196:197]
    v_pk_fma_f32 v[182:183], v[194:195], s[30:31], v[198:199]
    v_pk_fma_f32 v[192:193], v[196:197], s[30:31], v[192:193]
    v_pk_fma_f32 v[194:195], v[198:199], s[30:31], v[194:195]
    v_pk_add_f32 v[196:197], v[200:201], v[84:85]
    v_pk_add_f32 v[198:199], v[202:203], v[86:87]
    v_pk_mul_f32 v[84:85], v[84:85], s[34:35]
    v_pk_mul_f32 v[86:87], v[86:87], s[34:35]
    v_pk_mul_f32 v[196:197], v[196:197], s[32:33]
    v_pk_mul_f32 v[198:199], v[198:199], s[32:33]
    v_pk_fma_f32 v[84:85], v[200:201], s[36:37], v[84:85]
    v_pk_fma_f32 v[86:87], v[202:203], s[36:37], v[86:87]
    v_cvt_pk_bf16_f32 v222, v192, v193
    v_cvt_pk_bf16_f32 v223, v194, v195
    v_cvt_pk_bf16_f32 v200, v196, v197
    v_cvt_pk_bf16_f32 v201, v198, v199
    v_accvgpr_write_b32 a84, v200
    v_accvgpr_write_b32 a85, v201
    v_accvgpr_read_b32 v204, a88
    v_accvgpr_read_b32 v205, a89
    v_accvgpr_read_b32 v206, a90
    v_accvgpr_read_b32 v207, a91
    v_accvgpr_read_b32 v208, a184
    v_accvgpr_read_b32 v209, a185
    v_accvgpr_read_b32 v210, a186
    v_accvgpr_read_b32 v211, a187
    v_pk_add_f32 v[212:213], v[204:205], v[208:209]
    v_pk_add_f32 v[214:215], v[206:207], v[210:211]
    v_pk_add_f32 v[204:205], v[204:205], v[208:209] neg_lo:[0,1] neg_hi:[0,1]
    v_pk_add_f32 v[206:207], v[206:207], v[210:211] neg_lo:[0,1] neg_hi:[0,1]
    v_pk_add_f32 v[208:209], v[88:89], v[184:185] neg_lo:[0,1] neg_hi:[0,1]
    v_pk_add_f32 v[210:211], v[90:91], v[186:187] neg_lo:[0,1] neg_hi:[0,1]
    v_pk_add_f32 v[88:89], v[88:89], v[184:185]
    v_pk_add_f32 v[90:91], v[90:91], v[186:187]
    v_pk_fma_f32 v[184:185], v[204:205], s[30:31], v[208:209]
    v_pk_fma_f32 v[186:187], v[206:207], s[30:31], v[210:211]
    v_pk_fma_f32 v[204:205], v[208:209], s[30:31], v[204:205]
    v_pk_fma_f32 v[206:207], v[210:211], s[30:31], v[206:207]
    v_pk_add_f32 v[208:209], v[212:213], v[88:89]
    v_pk_add_f32 v[210:211], v[214:215], v[90:91]
    v_pk_mul_f32 v[88:89], v[88:89], s[34:35]
    v_pk_mul_f32 v[90:91], v[90:91], s[34:35]
    v_pk_mul_f32 v[208:209], v[208:209], s[32:33]
    v_pk_mul_f32 v[210:211], v[210:211], s[32:33]
    v_pk_fma_f32 v[88:89], v[212:213], s[36:37], v[88:89]
    v_pk_fma_f32 v[90:91], v[214:215], s[36:37], v[90:91]
    v_cvt_pk_bf16_f32 v224, v204, v205
    v_cvt_pk_bf16_f32 v225, v206, v207
    v_cvt_pk_bf16_f32 v212, v208, v209
    v_cvt_pk_bf16_f32 v213, v210, v211
    v_accvgpr_write_b32 a86, v212
    v_accvgpr_write_b32 a87, v213
    v_accvgpr_read_b32 v192, a92
    v_accvgpr_read_b32 v193, a93
    v_accvgpr_read_b32 v194, a94
    v_accvgpr_read_b32 v195, a95
    v_accvgpr_read_b32 v196, a188
    v_accvgpr_read_b32 v197, a189
    v_accvgpr_read_b32 v198, a190
    v_accvgpr_read_b32 v199, a191
    v_pk_add_f32 v[200:201], v[192:193], v[196:197]
    v_pk_add_f32 v[202:203], v[194:195], v[198:199]
    v_pk_add_f32 v[192:193], v[192:193], v[196:197] neg_lo:[0,1] neg_hi:[0,1]
    v_pk_add_f32 v[194:195], v[194:195], v[198:199] neg_lo:[0,1] neg_hi:[0,1]
    v_pk_add_f32 v[196:197], v[92:93], v[188:189] neg_lo:[0,1] neg_hi:[0,1]
    v_pk_add_f32 v[198:199], v[94:95], v[190:191] neg_lo:[0,1] neg_hi:[0,1]
    v_pk_add_f32 v[92:93], v[92:93], v[188:189]
    v_pk_add_f32 v[94:95], v[94:95], v[190:191]
    v_pk_fma_f32 v[188:189], v[192:193], s[30:31], v[196:197]
    v_pk_fma_f32 v[190:191], v[194:195], s[30:31], v[198:199]
    v_pk_fma_f32 v[192:193], v[196:197], s[30:31], v[192:193]
    v_pk_fma_f32 v[194:195], v[198:199], s[30:31], v[194:195]
    v_pk_add_f32 v[196:197], v[200:201], v[92:93]
    v_pk_add_f32 v[198:199], v[202:203], v[94:95]
    v_pk_mul_f32 v[92:93], v[92:93], s[34:35]
    v_pk_mul_f32 v[94:95], v[94:95], s[34:35]
    v_pk_mul_f32 v[196:197], v[196:197], s[32:33]
    v_pk_mul_f32 v[198:199], v[198:199], s[32:33]
    v_pk_fma_f32 v[92:93], v[200:201], s[36:37], v[92:93]
    v_pk_fma_f32 v[94:95], v[202:203], s[36:37], v[94:95]
    v_cvt_pk_bf16_f32 v226, v192, v193
    v_cvt_pk_bf16_f32 v227, v194, v195
    v_cvt_pk_bf16_f32 v200, v196, v197
    v_cvt_pk_bf16_f32 v201, v198, v199
    v_accvgpr_write_b32 a88, v200
    v_accvgpr_write_b32 a89, v201
    ds_write_b128 v248, v[222:225] offset:2688
    ds_write_b64 v249, v[226:227] offset:2752
    s_waitcnt vmcnt(13) lgkmcnt(15)
    v_mfma_f32_16x16x32_bf16 v[0:3], a[192:195], v[228:231], v[0:3]
    v_mfma_f32_16x16x32_bf16 v[4:7], a[196:199], v[228:231], v[4:7]
    buffer_load_dwordx4 v[240:243], v254, s[8:11], s42 offen offset:1024
    v_mfma_f32_16x16x32_bf16 v[8:11], a[200:203], v[228:231], v[8:11]
    ds_read_b128 v[228:231], v253 offset:33536
    v_mfma_f32_16x16x32_bf16 v[12:15], a[192:195], v[232:235], v[12:15]
    buffer_load_dwordx4 v[244:247], v254, s[8:11], s42 offen offset:2048
    v_mfma_f32_16x16x32_bf16 v[16:19], a[196:199], v[232:235], v[16:19]
    v_mfma_f32_16x16x32_bf16 v[20:23], a[200:203], v[232:235], v[20:23]
    s_waitcnt vmcnt(12)
    v_mfma_f32_16x16x32_bf16 v[0:3], a[204:207], v[232:235], v[0:3]
    v_mfma_f32_16x16x32_bf16 v[4:7], a[208:211], v[232:235], v[4:7]
    v_mfma_f32_16x16x32_bf16 v[8:11], a[212:215], v[232:235], v[8:11]
    ds_read_b128 v[232:235], v253 offset:33280
    v_mfma_f32_16x16x32_bf16 v[24:27], a[192:195], v[236:239], v[24:27]
    v_mfma_f32_16x16x32_bf16 v[28:31], a[196:199], v[236:239], v[28:31]
    v_mfma_f32_16x16x32_bf16 v[32:35], a[200:203], v[236:239], v[32:35]
    v_mfma_f32_16x16x32_bf16 v[12:15], a[204:207], v[236:239], v[12:15]
    v_mfma_f32_16x16x32_bf16 v[16:19], a[208:211], v[236:239], v[16:19]
    v_mfma_f32_16x16x32_bf16 v[20:23], a[212:215], v[236:239], v[20:23]
    s_waitcnt vmcnt(9)
    v_mfma_f32_16x16x32_bf16 v[0:3], a[216:219], v[236:239], v[0:3]
    v_mfma_f32_16x16x32_bf16 v[4:7], a[220:223], v[236:239], v[4:7]
    v_mfma_f32_16x16x32_bf16 v[8:11], a[224:227], v[236:239], v[8:11]
    ds_read_b128 v[236:239], v253 offset:35104
    s_waitcnt lgkmcnt(2)
    v_mfma_f32_16x16x32_bf16 v[36:39], a[192:195], v[228:231], v[36:39]
    v_mfma_f32_16x16x32_bf16 v[40:43], a[196:199], v[228:231], v[40:43]
    v_mfma_f32_16x16x32_bf16 v[44:47], a[200:203], v[228:231], v[44:47]
    v_mfma_f32_16x16x32_bf16 v[24:27], a[204:207], v[228:231], v[24:27]
    v_mfma_f32_16x16x32_bf16 v[28:31], a[208:211], v[228:231], v[28:31]
    v_mfma_f32_16x16x32_bf16 v[32:35], a[212:215], v[228:231], v[32:35]
    v_mfma_f32_16x16x32_bf16 v[12:15], a[216:219], v[228:231], v[12:15]
    v_mfma_f32_16x16x32_bf16 v[16:19], a[220:223], v[228:231], v[16:19]
    v_mfma_f32_16x16x32_bf16 v[20:23], a[224:227], v[228:231], v[20:23]
    ds_read_b128 v[228:231], v253 offset:34848
    s_waitcnt lgkmcnt(2)
    v_mfma_f32_16x16x32_bf16 v[48:51], a[192:195], v[232:235], v[48:51]
    v_mfma_f32_16x16x32_bf16 v[52:55], a[196:199], v[232:235], v[52:55]
    v_mfma_f32_16x16x32_bf16 v[56:59], a[200:203], v[232:235], v[56:59]
    v_mfma_f32_16x16x32_bf16 v[36:39], a[204:207], v[232:235], v[36:39]
    v_mfma_f32_16x16x32_bf16 v[40:43], a[208:211], v[232:235], v[40:43]
    v_mfma_f32_16x16x32_bf16 v[44:47], a[212:215], v[232:235], v[44:47]
    v_mfma_f32_16x16x32_bf16 v[24:27], a[216:219], v[232:235], v[24:27]
    v_mfma_f32_16x16x32_bf16 v[28:31], a[220:223], v[232:235], v[28:31]
    v_mfma_f32_16x16x32_bf16 v[32:35], a[224:227], v[232:235], v[32:35]
    ds_read_b128 v[232:235], v253 offset:34592
    s_waitcnt lgkmcnt(2)
    v_mfma_f32_16x16x32_bf16 v[60:63], a[192:195], v[236:239], v[60:63]
    v_mfma_f32_16x16x32_bf16 v[64:67], a[196:199], v[236:239], v[64:67]
    v_mfma_f32_16x16x32_bf16 v[68:71], a[200:203], v[236:239], v[68:71]
    v_mfma_f32_16x16x32_bf16 v[48:51], a[204:207], v[236:239], v[48:51]
    v_mfma_f32_16x16x32_bf16 v[52:55], a[208:211], v[236:239], v[52:55]
    v_mfma_f32_16x16x32_bf16 v[56:59], a[212:215], v[236:239], v[56:59]
    v_mfma_f32_16x16x32_bf16 v[36:39], a[216:219], v[236:239], v[36:39]
    v_mfma_f32_16x16x32_bf16 v[40:43], a[220:223], v[236:239], v[40:43]
    v_mfma_f32_16x16x32_bf16 v[44:47], a[224:227], v[236:239], v[44:47]
    ds_read_b128 v[236:239], v253 offset:34336
    s_waitcnt lgkmcnt(2)
    v_mfma_f32_16x16x32_bf16 v[72:75], a[192:195], v[228:231], v[72:75]
    v_mfma_f32_16x16x32_bf16 v[76:79], a[196:199], v[228:231], v[76:79]
    v_mfma_f32_16x16x32_bf16 v[80:83], a[200:203], v[228:231], v[80:83]
    v_mfma_f32_16x16x32_bf16 v[60:63], a[204:207], v[228:231], v[60:63]
    v_mfma_f32_16x16x32_bf16 v[64:67], a[208:211], v[228:231], v[64:67]
    v_mfma_f32_16x16x32_bf16 v[68:71], a[212:215], v[228:231], v[68:71]
    v_mfma_f32_16x16x32_bf16 v[48:51], a[216:219], v[228:231], v[48:51]
    v_mfma_f32_16x16x32_bf16 v[52:55], a[220:223], v[228:231], v[52:55]
    v_mfma_f32_16x16x32_bf16 v[56:59], a[224:227], v[228:231], v[56:59]
    ds_read_b128 v[228:231], v253 offset:34064
    s_waitcnt lgkmcnt(2)
    v_mfma_f32_16x16x32_bf16 v[84:87], a[192:195], v[232:235], v[84:87]
    v_mfma_f32_16x16x32_bf16 v[88:91], a[196:199], v[232:235], v[88:91]
    v_mfma_f32_16x16x32_bf16 v[92:95], a[200:203], v[232:235], v[92:95]
    v_mfma_f32_16x16x32_bf16 v[72:75], a[204:207], v[232:235], v[72:75]
    s_mov_b32 s42, 958464
    buffer_load_dwordx4 a[192:195], v254, s[8:11], s42 offen offset:0
    v_mfma_f32_16x16x32_bf16 v[76:79], a[208:211], v[232:235], v[76:79]
    v_mfma_f32_16x16x32_bf16 v[80:83], a[212:215], v[232:235], v[80:83]
    buffer_load_dwordx4 a[196:199], v254, s[8:11], s42 offen offset:1024
    v_mfma_f32_16x16x32_bf16 v[60:63], a[216:219], v[232:235], v[60:63]
    v_mfma_f32_16x16x32_bf16 v[64:67], a[220:223], v[232:235], v[64:67]
    buffer_load_dwordx4 a[200:203], v254, s[8:11], s42 offen offset:2048
    v_mfma_f32_16x16x32_bf16 v[68:71], a[224:227], v[232:235], v[68:71]
    s_waitcnt lgkmcnt(0)
    s_barrier
    ds_read_b128 v[232:235], v253 offset:32240
    v_mfma_f32_16x16x32_bf16 v[84:87], a[204:207], v[236:239], v[84:87]
    v_mfma_f32_16x16x32_bf16 v[88:91], a[208:211], v[236:239], v[88:91]
    v_mfma_f32_16x16x32_bf16 v[92:95], a[212:215], v[236:239], v[92:95]
    s_mov_b32 s42, 961536
    buffer_load_dwordx4 a[204:207], v254, s[8:11], s42 offen offset:0
    v_mfma_f32_16x16x32_bf16 v[72:75], a[216:219], v[236:239], v[72:75]
    v_mfma_f32_16x16x32_bf16 v[76:79], a[220:223], v[236:239], v[76:79]
    buffer_load_dwordx4 a[208:211], v254, s[8:11], s42 offen offset:1024
    v_mfma_f32_16x16x32_bf16 v[80:83], a[224:227], v[236:239], v[80:83]
    ds_read_b128 v[236:239], v253 offset:31968
    v_mfma_f32_16x16x32_bf16 v[84:87], a[216:219], v[228:231], v[84:87]
    buffer_load_dwordx4 a[212:215], v254, s[8:11], s42 offen offset:2048
    v_mfma_f32_16x16x32_bf16 v[88:91], a[220:223], v[228:231], v[88:91]
    v_mfma_f32_16x16x32_bf16 v[92:95], a[224:227], v[228:231], v[92:95]
    ds_read_b128 v[228:231], v253 offset:31712
    s_mov_b32 s42, 964608
    buffer_load_dwordx4 a[216:219], v254, s[8:11], s42 offen offset:0
    s_waitcnt vmcnt(13) lgkmcnt(2)
    v_mfma_f32_16x16x32_bf16 v[0:3], a[228:231], v[232:235], v[0:3]
    v_mfma_f32_16x16x32_bf16 v[4:7], a[232:235], v[232:235], v[4:7]
    buffer_load_dwordx4 a[220:223], v254, s[8:11], s42 offen offset:1024
    v_mfma_f32_16x16x32_bf16 v[8:11], a[236:239], v[232:235], v[8:11]
    ds_read_b128 v[232:235], v253 offset:31456
    s_waitcnt lgkmcnt(2)
    v_mfma_f32_16x16x32_bf16 v[12:15], a[228:231], v[236:239], v[12:15]
    buffer_load_dwordx4 a[224:227], v254, s[8:11], s42 offen offset:2048
    v_mfma_f32_16x16x32_bf16 v[16:19], a[232:235], v[236:239], v[16:19]
    v_mfma_f32_16x16x32_bf16 v[20:23], a[236:239], v[236:239], v[20:23]
    s_waitcnt vmcnt(12)
    v_mfma_f32_16x16x32_bf16 v[0:3], a[240:243], v[236:239], v[0:3]
    v_add_u32 v250, s51, v254
    v_mfma_f32_16x16x32_bf16 v[4:7], a[244:247], v[236:239], v[4:7]
    ds_read_b128 a[96:99], v250 offset:0
    v_mfma_f32_16x16x32_bf16 v[8:11], a[248:251], v[236:239], v[8:11]
    ds_read_b128 v[236:239], v253 offset:31200
    s_waitcnt lgkmcnt(3)
    v_mfma_f32_16x16x32_bf16 v[24:27], a[228:231], v[228:231], v[24:27]
    ds_read_b128 a[100:103], v250 offset:1024
    v_mfma_f32_16x16x32_bf16 v[28:31], a[232:235], v[228:231], v[28:31]
    v_mfma_f32_16x16x32_bf16 v[32:35], a[236:239], v[228:231], v[32:35]
    ds_read_b128 a[104:107], v250 offset:2048
    v_mfma_f32_16x16x32_bf16 v[12:15], a[240:243], v[228:231], v[12:15]
    ds_read_b128 a[108:111], v250 offset:3104
    v_mfma_f32_16x16x32_bf16 v[16:19], a[244:247], v[228:231], v[16:19]
    s_add_u32 s44, s40, 196608
    s_waitcnt lgkmcnt(4)
    buffer_store_dwordx4 a[96:99], v254, s[12:15], s44 offen offset:0
    v_mfma_f32_16x16x32_bf16 v[20:23], a[248:251], v[228:231], v[20:23]
    s_waitcnt vmcnt(10)
    v_mfma_f32_16x16x32_bf16 v[0:3], a[252:255], v[228:231], v[0:3]
    v_mfma_f32_16x16x32_bf16 v[4:7], v[240:243], v[228:231], v[4:7]
    v_mfma_f32_16x16x32_bf16 v[8:11], v[244:247], v[228:231], v[8:11]
    ds_read_b128 v[228:231], v253 offset:33024
    v_mfma_f32_16x16x32_bf16 v[36:39], a[228:231], v[232:235], v[36:39]
    ds_read_b128 a[112:115], v250 offset:4128
    v_mfma_f32_16x16x32_bf16 v[40:43], a[232:235], v[232:235], v[40:43]
    s_waitcnt lgkmcnt(4)
    buffer_store_dwordx4 a[100:103], v254, s[12:15], s44 offen offset:1024
    v_mfma_f32_16x16x32_bf16 v[44:47], a[236:239], v[232:235], v[44:47]
    v_mfma_f32_16x16x32_bf16 v[24:27], a[240:243], v[232:235], v[24:27]
    ds_read_b128 a[116:119], v250 offset:5152
    v_mfma_f32_16x16x32_bf16 v[28:31], a[244:247], v[232:235], v[28:31]
    s_waitcnt lgkmcnt(4)
    buffer_store_dwordx4 a[104:107], v254, s[12:15], s44 offen offset:2048
    v_mfma_f32_16x16x32_bf16 v[32:35], a[248:251], v[232:235], v[32:35]
    ds_read_b128 a[120:123], v250 offset:6208
    v_mfma_f32_16x16x32_bf16 v[12:15], a[252:255], v[232:235], v[12:15]
    v_mfma_f32_16x16x32_bf16 v[16:19], v[240:243], v[232:235], v[16:19]
    s_add_u32 s44, s40, 199680
    s_waitcnt lgkmcnt(4)
    buffer_store_dwordx4 a[108:111], v254, s[12:15], s44 offen offset:0
    v_mfma_f32_16x16x32_bf16 v[20:23], v[244:247], v[232:235], v[20:23]
    ds_read_b128 v[232:235], v253 offset:32768
    v_mfma_f32_16x16x32_bf16 v[48:51], a[228:231], v[236:239], v[48:51]
    v_mfma_f32_16x16x32_bf16 v[52:55], a[232:235], v[236:239], v[52:55]
    ds_read_b128 a[124:127], v250 offset:7232
    v_mfma_f32_16x16x32_bf16 v[56:59], a[236:239], v[236:239], v[56:59]
    v_mfma_f32_16x16x32_bf16 v[36:39], a[240:243], v[236:239], v[36:39]
    s_waitcnt lgkmcnt(4)
    buffer_store_dwordx4 a[112:115], v254, s[12:15], s44 offen offset:1024
    v_mfma_f32_16x16x32_bf16 v[40:43], a[244:247], v[236:239], v[40:43]
    ds_read_b128 a[128:131], v250 offset:8256
    v_mfma_f32_16x16x32_bf16 v[44:47], a[248:251], v[236:239], v[44:47]
    s_waitcnt lgkmcnt(4)
    buffer_store_dwordx4 a[116:119], v254, s[12:15], s44 offen offset:2048
    v_mfma_f32_16x16x32_bf16 v[24:27], a[252:255], v[236:239], v[24:27]
    v_mfma_f32_16x16x32_bf16 v[28:31], v[240:243], v[236:239], v[28:31]
    ds_read_b128 a[132:135], v250 offset:9312
    v_mfma_f32_16x16x32_bf16 v[32:35], v[244:247], v[236:239], v[32:35]
    ds_read_b128 v[236:239], v253 offset:32512
    v_mfma_f32_16x16x32_bf16 v[60:63], a[228:231], v[228:231], v[60:63]
    s_add_u32 s44, s40, 202752
    s_waitcnt lgkmcnt(5)
    buffer_store_dwordx4 a[120:123], v254, s[12:15], s44 offen offset:0
    v_mfma_f32_16x16x32_bf16 v[64:67], a[232:235], v[228:231], v[64:67]
    v_mfma_f32_16x16x32_bf16 v[68:71], a[236:239], v[228:231], v[68:71]
    v_mfma_f32_16x16x32_bf16 v[48:51], a[240:243], v[228:231], v[48:51]
    ds_read_b128 a[136:139], v250 offset:10336
    v_mfma_f32_16x16x32_bf16 v[52:55], a[244:247], v[228:231], v[52:55]
    s_waitcnt lgkmcnt(4)
    buffer_store_dwordx4 a[124:127], v254, s[12:15], s44 offen offset:1024
    v_mfma_f32_16x16x32_bf16 v[56:59], a[248:251], v[228:231], v[56:59]
    ds_read_b128 a[140:143], v250 offset:11360
    v_mfma_f32_16x16x32_bf16 v[36:39], a[252:255], v[228:231], v[36:39]
    v_mfma_f32_16x16x32_bf16 v[40:43], v[240:243], v[228:231], v[40:43]
    s_waitcnt lgkmcnt(4)
    buffer_store_dwordx4 a[128:131], v254, s[12:15], s44 offen offset:2048
    v_mfma_f32_16x16x32_bf16 v[44:47], v[244:247], v[228:231], v[44:47]
    ds_read_b128 v[228:231], v253 offset:32256
    v_mfma_f32_16x16x32_bf16 v[72:75], a[228:231], v[232:235], v[72:75]
    s_add_u32 s44, s40, 205824
    s_waitcnt lgkmcnt(4)
    buffer_store_dwordx4 a[132:135], v254, s[12:15], s44 offen offset:0
    v_mfma_f32_16x16x32_bf16 v[76:79], a[232:235], v[232:235], v[76:79]
    v_mfma_f32_16x16x32_bf16 v[80:83], a[236:239], v[232:235], v[80:83]
    v_mfma_f32_16x16x32_bf16 v[60:63], a[240:243], v[232:235], v[60:63]
    s_waitcnt lgkmcnt(2)
    buffer_store_dwordx4 a[136:139], v254, s[12:15], s44 offen offset:1024
    v_mfma_f32_16x16x32_bf16 v[64:67], a[244:247], v[232:235], v[64:67]
    s_waitcnt lgkmcnt(1)
    buffer_store_dwordx4 a[140:143], v254, s[12:15], s44 offen offset:2048
    v_mfma_f32_16x16x32_bf16 v[68:71], a[248:251], v[232:235], v[68:71]
    v_mfma_f32_16x16x32_bf16 v[48:51], a[252:255], v[232:235], v[48:51]
    v_mfma_f32_16x16x32_bf16 v[52:55], v[240:243], v[232:235], v[52:55]
    v_mfma_f32_16x16x32_bf16 v[56:59], v[244:247], v[232:235], v[56:59]
    ds_read_b128 v[232:235], v253 offset:31984
    v_mfma_f32_16x16x32_bf16 v[84:87], a[228:231], v[236:239], v[84:87]
    v_mfma_f32_16x16x32_bf16 v[88:91], a[232:235], v[236:239], v[88:91]
    v_mfma_f32_16x16x32_bf16 v[92:95], a[236:239], v[236:239], v[92:95]
    v_mfma_f32_16x16x32_bf16 v[72:75], a[240:243], v[236:239], v[72:75]
    s_mov_b32 s42, 995328
    buffer_load_dwordx4 a[228:231], v254, s[8:11], s42 offen offset:0
    v_mfma_f32_16x16x32_bf16 v[76:79], a[244:247], v[236:239], v[76:79]
    v_mfma_f32_16x16x32_bf16 v[80:83], a[248:251], v[236:239], v[80:83]
    buffer_load_dwordx4 a[232:235], v254, s[8:11], s42 offen offset:1024
    v_mfma_f32_16x16x32_bf16 v[60:63], a[252:255], v[236:239], v[60:63]
    v_mfma_f32_16x16x32_bf16 v[64:67], v[240:243], v[236:239], v[64:67]
    buffer_load_dwordx4 a[236:239], v254, s[8:11], s42 offen offset:2048
    v_mfma_f32_16x16x32_bf16 v[68:71], v[244:247], v[236:239], v[68:71]
    s_waitcnt lgkmcnt(0)
    s_barrier
    ds_read_b128 v[236:239], v253 offset:21840
    v_mfma_f32_16x16x32_bf16 v[84:87], a[240:243], v[228:231], v[84:87]
    v_mfma_f32_16x16x32_bf16 v[88:91], a[244:247], v[228:231], v[88:91]
    ds_write_b128 v248, a[0:3] offset:0
    v_mfma_f32_16x16x32_bf16 v[92:95], a[248:251], v[228:231], v[92:95]
    s_mov_b32 s42, 998400
    buffer_load_dwordx4 a[240:243], v254, s[8:11], s42 offen offset:0
    v_mfma_f32_16x16x32_bf16 v[72:75], a[252:255], v[228:231], v[72:75]
    v_mfma_f32_16x16x32_bf16 v[76:79], v[240:243], v[228:231], v[76:79]
    buffer_load_dwordx4 a[244:247], v254, s[8:11], s42 offen offset:1024
    v_mfma_f32_16x16x32_bf16 v[80:83], v[244:247], v[228:231], v[80:83]
    ds_read_b128 v[228:231], v253 offset:21568
    v_mfma_f32_16x16x32_bf16 v[84:87], a[252:255], v[232:235], v[84:87]
    buffer_load_dwordx4 a[248:251], v254, s[8:11], s42 offen offset:2048
    v_mfma_f32_16x16x32_bf16 v[88:91], v[240:243], v[232:235], v[88:91]
    v_mfma_f32_16x16x32_bf16 v[92:95], v[244:247], v[232:235], v[92:95]
    ds_read_b128 v[232:235], v253 offset:21312
    s_mov_b32 s42, 1001472
    buffer_load_dwordx4 a[252:255], v254, s[8:11], s42 offen offset:0
    s_waitcnt vmcnt(25) lgkmcnt(3)
    v_mfma_f32_16x16x32_bf16 v[0:3], a[192:195], v[236:239], v[0:3]
    ds_write_b64 v249, a[4:5] offset:64
    v_mfma_f32_16x16x32_bf16 v[4:7], a[196:199], v[236:239], v[4:7]
    buffer_load_dwordx4 v[240:243], v254, s[8:11], s42 offen offset:1024
    v_mfma_f32_16x16x32_bf16 v[8:11], a[200:203], v[236:239], v[8:11]
    ds_read_b128 v[236:239], v253 offset:21056
    s_waitcnt lgkmcnt(3)
    v_mfma_f32_16x16x32_bf16 v[12:15], a[192:195], v[228:231], v[12:15]
    buffer_load_dwordx4 v[244:247], v254, s[8:11], s42 offen offset:2048
    v_mfma_f32_16x16x32_bf16 v[16:19], a[196:199], v[228:231], v[16:19]
    v_mfma_f32_16x16x32_bf16 v[20:23], a[200:203], v[228:231], v[20:23]
    s_waitcnt vmcnt(24)
    v_mfma_f32_16x16x32_bf16 v[0:3], a[204:207], v[228:231], v[0:3]
    v_mfma_f32_16x16x32_bf16 v[4:7], a[208:211], v[228:231], v[4:7]
    ds_write_b128 v248, a[12:15] offset:384
    v_mfma_f32_16x16x32_bf16 v[8:11], a[212:215], v[228:231], v[8:11]
    ds_read_b128 v[228:231], v253 offset:20800
    s_waitcnt lgkmcnt(4)
    v_mfma_f32_16x16x32_bf16 v[24:27], a[192:195], v[232:235], v[24:27]
    v_mfma_f32_16x16x32_bf16 v[28:31], a[196:199], v[232:235], v[28:31]
    v_mfma_f32_16x16x32_bf16 v[32:35], a[200:203], v[232:235], v[32:35]
    ds_write_b64 v249, a[16:17] offset:448
    v_mfma_f32_16x16x32_bf16 v[12:15], a[204:207], v[232:235], v[12:15]
    v_mfma_f32_16x16x32_bf16 v[16:19], a[208:211], v[232:235], v[16:19]
    v_mfma_f32_16x16x32_bf16 v[20:23], a[212:215], v[232:235], v[20:23]
    s_waitcnt vmcnt(21)
    v_mfma_f32_16x16x32_bf16 v[0:3], a[216:219], v[232:235], v[0:3]
    ds_write_b128 v248, a[24:27] offset:768
    v_mfma_f32_16x16x32_bf16 v[4:7], a[220:223], v[232:235], v[4:7]
    v_mfma_f32_16x16x32_bf16 v[8:11], a[224:227], v[232:235], v[8:11]
    ds_read_b128 v[232:235], v253 offset:22624
    s_waitcnt lgkmcnt(5)
    v_mfma_f32_16x16x32_bf16 v[36:39], a[192:195], v[236:239], v[36:39]
    v_mfma_f32_16x16x32_bf16 v[40:43], a[196:199], v[236:239], v[40:43]
    ds_write_b64 v249, a[28:29] offset:832
    v_mfma_f32_16x16x32_bf16 v[44:47], a[200:203], v[236:239], v[44:47]
    v_mfma_f32_16x16x32_bf16 v[24:27], a[204:207], v[236:239], v[24:27]
    v_mfma_f32_16x16x32_bf16 v[28:31], a[208:211], v[236:239], v[28:31]
    ds_write_b128 v248, a[36:39] offset:1152
    v_mfma_f32_16x16x32_bf16 v[32:35], a[212:215], v[236:239], v[32:35]
    v_mfma_f32_16x16x32_bf16 v[12:15], a[216:219], v[236:239], v[12:15]
    v_mfma_f32_16x16x32_bf16 v[16:19], a[220:223], v[236:239], v[16:19]
    ds_write_b64 v249, a[40:41] offset:1216
    v_mfma_f32_16x16x32_bf16 v[20:23], a[224:227], v[236:239], v[20:23]
    ds_read_b128 v[236:239], v253 offset:22368
    s_waitcnt lgkmcnt(7)
    v_mfma_f32_16x16x32_bf16 v[48:51], a[192:195], v[228:231], v[48:51]
    v_mfma_f32_16x16x32_bf16 v[52:55], a[196:199], v[228:231], v[52:55]
    v_mfma_f32_16x16x32_bf16 v[56:59], a[200:203], v[228:231], v[56:59]
    ds_write_b128 v248, a[48:51] offset:1536
    v_mfma_f32_16x16x32_bf16 v[36:39], a[204:207], v[228:231], v[36:39]
    v_mfma_f32_16x16x32_bf16 v[40:43], a[208:211], v[228:231], v[40:43]
    v_mfma_f32_16x16x32_bf16 v[44:47], a[212:215], v[228:231], v[44:47]
    ds_write_b64 v249, a[52:53] offset:1600
    v_mfma_f32_16x16x32_bf16 v[24:27], a[216:219], v[228:231], v[24:27]
    v_mfma_f32_16x16x32_bf16 v[28:31], a[220:223], v[228:231], v[28:31]
    v_mfma_f32_16x16x32_bf16 v[32:35], a[224:227], v[228:231], v[32:35]
    ds_read_b128 v[228:231], v253 offset:22112
    s_waitcnt lgkmcnt(7)
    v_mfma_f32_16x16x32_bf16 v[60:63], a[192:195], v[232:235], v[60:63]
    ds_write_b128 v248, a[60:63] offset:1920
    v_mfma_f32_16x16x32_bf16 v[64:67], a[196:199], v[232:235], v[64:67]
    v_mfma_f32_16x16x32_bf16 v[68:71], a[200:203], v[232:235], v[68:71]
    v_mfma_f32_16x16x32_bf16 v[48:51], a[204:207], v[232:235], v[48:51]
    ds_write_b64 v249, a[64:65] offset:1984
    v_mfma_f32_16x16x32_bf16 v[52:55], a[208:211], v[232:235], v[52:55]
    v_mfma_f32_16x16x32_bf16 v[56:59], a[212:215], v[232:235], v[56:59]
    v_mfma_f32_16x16x32_bf16 v[36:39], a[216:219], v[232:235], v[36:39]
    ds_write_b128 v248, a[72:75] offset:2304
    v_mfma_f32_16x16x32_bf16 v[40:43], a[220:223], v[232:235], v[40:43]
    v_mfma_f32_16x16x32_bf16 v[44:47], a[224:227], v[232:235], v[44:47]
    ds_read_b128 v[232:235], v253 offset:21856
    s_waitcnt lgkmcnt(7)
    v_mfma_f32_16x16x32_bf16 v[72:75], a[192:195], v[236:239], v[72:75]
    v_mfma_f32_16x16x32_bf16 v[76:79], a[196:199], v[236:239], v[76:79]
    ds_write_b64 v249, a[76:77] offset:2368
    v_mfma_f32_16x16x32_bf16 v[80:83], a[200:203], v[236:239], v[80:83]
    v_mfma_f32_16x16x32_bf16 v[60:63], a[204:207], v[236:239], v[60:63]
    v_mfma_f32_16x16x32_bf16 v[64:67], a[208:211], v[236:239], v[64:67]
    ds_write_b128 v248, a[84:87] offset:2688
    v_mfma_f32_16x16x32_bf16 v[68:71], a[212:215], v[236:239], v[68:71]
    v_mfma_f32_16x16x32_bf16 v[48:51], a[216:219], v[236:239], v[48:51]
    v_mfma_f32_16x16x32_bf16 v[52:55], a[220:223], v[236:239], v[52:55]
    ds_write_b64 v249, a[88:89] offset:2752
    v_mfma_f32_16x16x32_bf16 v[56:59], a[224:227], v[236:239], v[56:59]
    ds_read_b128 v[236:239], v253 offset:21584
    s_waitcnt lgkmcnt(8)
    v_mfma_f32_16x16x32_bf16 v[84:87], a[192:195], v[228:231], v[84:87]
    v_mfma_f32_16x16x32_bf16 v[88:91], a[196:199], v[228:231], v[88:91]
    v_mfma_f32_16x16x32_bf16 v[92:95], a[200:203], v[228:231], v[92:95]
    v_mfma_f32_16x16x32_bf16 v[72:75], a[204:207], v[228:231], v[72:75]
    s_mov_b32 s42, 1032192
    buffer_load_dwordx4 a[192:195], v254, s[8:11], s42 offen offset:0
    v_mfma_f32_16x16x32_bf16 v[76:79], a[208:211], v[228:231], v[76:79]
    v_mfma_f32_16x16x32_bf16 v[80:83], a[212:215], v[228:231], v[80:83]
    buffer_load_dwordx4 a[196:199], v254, s[8:11], s42 offen offset:1024
    v_mfma_f32_16x16x32_bf16 v[60:63], a[216:219], v[228:231], v[60:63]
    v_mfma_f32_16x16x32_bf16 v[64:67], a[220:223], v[228:231], v[64:67]
    buffer_load_dwordx4 a[200:203], v254, s[8:11], s42 offen offset:2048
    v_mfma_f32_16x16x32_bf16 v[68:71], a[224:227], v[228:231], v[68:71]
    s_waitcnt lgkmcnt(0)
    s_barrier
    ds_read_b128 v[228:231], v253 offset:19760
    v_mfma_f32_16x16x32_bf16 v[84:87], a[204:207], v[232:235], v[84:87]
    v_mfma_f32_16x16x32_bf16 v[88:91], a[208:211], v[232:235], v[88:91]
    v_mfma_f32_16x16x32_bf16 v[92:95], a[212:215], v[232:235], v[92:95]
    s_mov_b32 s42, 1035264
    buffer_load_dwordx4 a[204:207], v254, s[8:11], s42 offen offset:0
    v_mfma_f32_16x16x32_bf16 v[72:75], a[216:219], v[232:235], v[72:75]
    v_mfma_f32_16x16x32_bf16 v[76:79], a[220:223], v[232:235], v[76:79]
    buffer_load_dwordx4 a[208:211], v254, s[8:11], s42 offen offset:1024
    v_mfma_f32_16x16x32_bf16 v[80:83], a[224:227], v[232:235], v[80:83]
    ds_read_b128 v[232:235], v253 offset:19488
    v_mfma_f32_16x16x32_bf16 v[84:87], a[216:219], v[236:239], v[84:87]
    buffer_load_dwordx4 a[212:215], v254, s[8:11], s42 offen offset:2048
    v_mfma_f32_16x16x32_bf16 v[88:91], a[220:223], v[236:239], v[88:91]
    v_mfma_f32_16x16x32_bf16 v[92:95], a[224:227], v[236:239], v[92:95]
    ds_read_b128 v[236:239], v253 offset:19232
    s_mov_b32 s42, 1038336
    buffer_load_dwordx4 a[216:219], v254, s[8:11], s42 offen offset:0
    s_waitcnt vmcnt(13) lgkmcnt(2)
    v_mfma_f32_16x16x32_bf16 v[0:3], a[228:231], v[228:231], v[0:3]
    v_mfma_f32_16x16x32_bf16 v[4:7], a[232:235], v[228:231], v[4:7]
    buffer_load_dwordx4 a[220:223], v254, s[8:11], s42 offen offset:1024
    v_mfma_f32_16x16x32_bf16 v[8:11], a[236:239], v[228:231], v[8:11]
    ds_read_b128 v[228:231], v253 offset:18976
    s_waitcnt lgkmcnt(2)
    v_mfma_f32_16x16x32_bf16 v[12:15], a[228:231], v[232:235], v[12:15]
    buffer_load_dwordx4 a[224:227], v254, s[8:11], s42 offen offset:2048
    v_mfma_f32_16x16x32_bf16 v[16:19], a[232:235], v[232:235], v[16:19]
    v_mfma_f32_16x16x32_bf16 v[20:23], a[236:239], v[232:235], v[20:23]
    s_waitcnt vmcnt(12)
    v_mfma_f32_16x16x32_bf16 v[0:3], a[240:243], v[232:235], v[0:3]
    v_add_u32 v250, s51, v254
    v_mfma_f32_16x16x32_bf16 v[4:7], a[244:247], v[232:235], v[4:7]
    ds_read_b128 a[144:147], v250 offset:0
    v_mfma_f32_16x16x32_bf16 v[8:11], a[248:251], v[232:235], v[8:11]
    ds_read_b128 v[232:235], v253 offset:18720
    s_waitcnt lgkmcnt(3)
    v_mfma_f32_16x16x32_bf16 v[24:27], a[228:231], v[236:239], v[24:27]
    ds_read_b128 a[148:151], v250 offset:1024
    v_mfma_f32_16x16x32_bf16 v[28:31], a[232:235], v[236:239], v[28:31]
    v_mfma_f32_16x16x32_bf16 v[32:35], a[236:239], v[236:239], v[32:35]
    ds_read_b128 a[152:155], v250 offset:2048
    v_mfma_f32_16x16x32_bf16 v[12:15], a[240:243], v[236:239], v[12:15]
    ds_read_b128 a[156:159], v250 offset:3104
    v_mfma_f32_16x16x32_bf16 v[16:19], a[244:247], v[236:239], v[16:19]
    s_add_u32 s44, s40, 393216
    s_waitcnt lgkmcnt(4)
    buffer_store_dwordx4 a[144:147], v254, s[12:15], s44 offen offset:0
    v_mfma_f32_16x16x32_bf16 v[20:23], a[248:251], v[236:239], v[20:23]
    s_waitcnt vmcnt(10)
    v_mfma_f32_16x16x32_bf16 v[0:3], a[252:255], v[236:239], v[0:3]
    v_mfma_f32_16x16x32_bf16 v[4:7], v[240:243], v[236:239], v[4:7]
    v_mfma_f32_16x16x32_bf16 v[8:11], v[244:247], v[236:239], v[8:11]
    ds_read_b128 v[236:239], v253 offset:20544
    v_mfma_f32_16x16x32_bf16 v[36:39], a[228:231], v[228:231], v[36:39]
    ds_read_b128 a[160:163], v250 offset:4128
    v_mfma_f32_16x16x32_bf16 v[40:43], a[232:235], v[228:231], v[40:43]
    s_waitcnt lgkmcnt(4)
    buffer_store_dwordx4 a[148:151], v254, s[12:15], s44 offen offset:1024
    v_mfma_f32_16x16x32_bf16 v[44:47], a[236:239], v[228:231], v[44:47]
    v_mfma_f32_16x16x32_bf16 v[24:27], a[240:243], v[228:231], v[24:27]
    ds_read_b128 a[164:167], v250 offset:5152
    v_mfma_f32_16x16x32_bf16 v[28:31], a[244:247], v[228:231], v[28:31]
    s_waitcnt lgkmcnt(4)
    buffer_store_dwordx4 a[152:155], v254, s[12:15], s44 offen offset:2048
    v_mfma_f32_16x16x32_bf16 v[32:35], a[248:251], v[228:231], v[32:35]
    ds_read_b128 a[168:171], v250 offset:6208
    v_mfma_f32_16x16x32_bf16 v[12:15], a[252:255], v[228:231], v[12:15]
    v_mfma_f32_16x16x32_bf16 v[16:19], v[240:243], v[228:231], v[16:19]
    s_add_u32 s44, s40, 396288
    s_waitcnt lgkmcnt(4)
    buffer_store_dwordx4 a[156:159], v254, s[12:15], s44 offen offset:0
    v_mfma_f32_16x16x32_bf16 v[20:23], v[244:247], v[228:231], v[20:23]
    ds_read_b128 v[228:231], v253 offset:20288
    v_mfma_f32_16x16x32_bf16 v[48:51], a[228:231], v[232:235], v[48:51]
    v_mfma_f32_16x16x32_bf16 v[52:55], a[232:235], v[232:235], v[52:55]
    ds_read_b128 a[172:175], v250 offset:7232
    v_mfma_f32_16x16x32_bf16 v[56:59], a[236:239], v[232:235], v[56:59]
    v_mfma_f32_16x16x32_bf16 v[36:39], a[240:243], v[232:235], v[36:39]
    s_waitcnt lgkmcnt(4)
    buffer_store_dwordx4 a[160:163], v254, s[12:15], s44 offen offset:1024
    v_mfma_f32_16x16x32_bf16 v[40:43], a[244:247], v[232:235], v[40:43]
    ds_read_b128 a[176:179], v250 offset:8256
    v_mfma_f32_16x16x32_bf16 v[44:47], a[248:251], v[232:235], v[44:47]
    s_waitcnt lgkmcnt(4)
    buffer_store_dwordx4 a[164:167], v254, s[12:15], s44 offen offset:2048
    v_mfma_f32_16x16x32_bf16 v[24:27], a[252:255], v[232:235], v[24:27]
    v_mfma_f32_16x16x32_bf16 v[28:31], v[240:243], v[232:235], v[28:31]
    ds_read_b128 a[180:183], v250 offset:9312
    v_mfma_f32_16x16x32_bf16 v[32:35], v[244:247], v[232:235], v[32:35]
    ds_read_b128 v[232:235], v253 offset:20032
    v_mfma_f32_16x16x32_bf16 v[60:63], a[228:231], v[236:239], v[60:63]
    s_add_u32 s44, s40, 399360
    s_waitcnt lgkmcnt(5)
    buffer_store_dwordx4 a[168:171], v254, s[12:15], s44 offen offset:0
    v_mfma_f32_16x16x32_bf16 v[64:67], a[232:235], v[236:239], v[64:67]
    v_mfma_f32_16x16x32_bf16 v[68:71], a[236:239], v[236:239], v[68:71]
    v_mfma_f32_16x16x32_bf16 v[48:51], a[240:243], v[236:239], v[48:51]
    ds_read_b128 a[184:187], v250 offset:10336
    v_mfma_f32_16x16x32_bf16 v[52:55], a[244:247], v[236:239], v[52:55]
    s_waitcnt lgkmcnt(4)
    buffer_store_dwordx4 a[172:175], v254, s[12:15], s44 offen offset:1024
    v_mfma_f32_16x16x32_bf16 v[56:59], a[248:251], v[236:239], v[56:59]
    ds_read_b128 a[188:191], v250 offset:11360
    v_mfma_f32_16x16x32_bf16 v[36:39], a[252:255], v[236:239], v[36:39]
    v_mfma_f32_16x16x32_bf16 v[40:43], v[240:243], v[236:239], v[40:43]
    s_waitcnt lgkmcnt(4)
    buffer_store_dwordx4 a[176:179], v254, s[12:15], s44 offen offset:2048
    v_mfma_f32_16x16x32_bf16 v[44:47], v[244:247], v[236:239], v[44:47]
    ds_read_b128 v[236:239], v253 offset:19776
    v_mfma_f32_16x16x32_bf16 v[72:75], a[228:231], v[228:231], v[72:75]
    s_add_u32 s44, s40, 402432
    s_waitcnt lgkmcnt(4)
    buffer_store_dwordx4 a[180:183], v254, s[12:15], s44 offen offset:0
    v_mfma_f32_16x16x32_bf16 v[76:79], a[232:235], v[228:231], v[76:79]
    v_mfma_f32_16x16x32_bf16 v[80:83], a[236:239], v[228:231], v[80:83]
    v_mfma_f32_16x16x32_bf16 v[60:63], a[240:243], v[228:231], v[60:63]
    s_waitcnt lgkmcnt(2)
    buffer_store_dwordx4 a[184:187], v254, s[12:15], s44 offen offset:1024
    v_mfma_f32_16x16x32_bf16 v[64:67], a[244:247], v[228:231], v[64:67]
    s_waitcnt lgkmcnt(1)
    buffer_store_dwordx4 a[188:191], v254, s[12:15], s44 offen offset:2048
    v_mfma_f32_16x16x32_bf16 v[68:71], a[248:251], v[228:231], v[68:71]
    v_mfma_f32_16x16x32_bf16 v[48:51], a[252:255], v[228:231], v[48:51]
    v_mfma_f32_16x16x32_bf16 v[52:55], v[240:243], v[228:231], v[52:55]
    v_mfma_f32_16x16x32_bf16 v[56:59], v[244:247], v[228:231], v[56:59]
    ds_read_b128 v[228:231], v253 offset:19504
    v_mfma_f32_16x16x32_bf16 v[84:87], a[228:231], v[232:235], v[84:87]
    v_mfma_f32_16x16x32_bf16 v[88:91], a[232:235], v[232:235], v[88:91]
    v_mfma_f32_16x16x32_bf16 v[92:95], a[236:239], v[232:235], v[92:95]
    v_mfma_f32_16x16x32_bf16 v[72:75], a[240:243], v[232:235], v[72:75]
    s_mov_b32 s42, 1069056
    buffer_load_dwordx4 a[228:231], v254, s[8:11], s42 offen offset:0
    v_mfma_f32_16x16x32_bf16 v[76:79], a[244:247], v[232:235], v[76:79]
    v_mfma_f32_16x16x32_bf16 v[80:83], a[248:251], v[232:235], v[80:83]
    buffer_load_dwordx4 a[232:235], v254, s[8:11], s42 offen offset:1024
    v_mfma_f32_16x16x32_bf16 v[60:63], a[252:255], v[232:235], v[60:63]
    v_mfma_f32_16x16x32_bf16 v[64:67], v[240:243], v[232:235], v[64:67]
    buffer_load_dwordx4 a[236:239], v254, s[8:11], s42 offen offset:2048
    v_mfma_f32_16x16x32_bf16 v[68:71], v[244:247], v[232:235], v[68:71]
    ds_read_b128 v[232:235], v253 offset:17680
    s_waitcnt lgkmcnt(2)
    v_mfma_f32_16x16x32_bf16 v[84:87], a[240:243], v[236:239], v[84:87]
    v_mfma_f32_16x16x32_bf16 v[88:91], a[244:247], v[236:239], v[88:91]
    v_mfma_f32_16x16x32_bf16 v[92:95], a[248:251], v[236:239], v[92:95]
    s_mov_b32 s42, 1072128
    buffer_load_dwordx4 a[240:243], v254, s[8:11], s42 offen offset:0
    v_mfma_f32_16x16x32_bf16 v[72:75], a[252:255], v[236:239], v[72:75]
    v_mfma_f32_16x16x32_bf16 v[76:79], v[240:243], v[236:239], v[76:79]
    buffer_load_dwordx4 a[244:247], v254, s[8:11], s42 offen offset:1024
    v_mfma_f32_16x16x32_bf16 v[80:83], v[244:247], v[236:239], v[80:83]
    ds_read_b128 v[236:239], v253 offset:17408
    s_waitcnt lgkmcnt(2)
    v_mfma_f32_16x16x32_bf16 v[84:87], a[252:255], v[228:231], v[84:87]
    buffer_load_dwordx4 a[248:251], v254, s[8:11], s42 offen offset:2048
    v_mfma_f32_16x16x32_bf16 v[88:91], v[240:243], v[228:231], v[88:91]
    v_mfma_f32_16x16x32_bf16 v[92:95], v[244:247], v[228:231], v[92:95]
    ds_read_b128 v[228:231], v253 offset:17152
    s_mov_b32 s42, 1075200
    buffer_load_dwordx4 a[252:255], v254, s[8:11], s42 offen offset:0
    s_waitcnt vmcnt(25) lgkmcnt(2)
    v_mfma_f32_16x16x32_bf16 v[0:3], a[192:195], v[232:235], v[0:3]
    v_mfma_f32_16x16x32_bf16 v[4:7], a[196:199], v[232:235], v[4:7]
    buffer_load_dwordx4 v[240:243], v254, s[8:11], s42 offen offset:1024
    v_mfma_f32_16x16x32_bf16 v[8:11], a[200:203], v[232:235], v[8:11]
    ds_read_b128 v[232:235], v253 offset:16896
    s_waitcnt lgkmcnt(2)
    v_mfma_f32_16x16x32_bf16 v[12:15], a[192:195], v[236:239], v[12:15]
    buffer_load_dwordx4 v[244:247], v254, s[8:11], s42 offen offset:2048
    v_mfma_f32_16x16x32_bf16 v[16:19], a[196:199], v[236:239], v[16:19]
    v_mfma_f32_16x16x32_bf16 v[20:23], a[200:203], v[236:239], v[20:23]
    s_waitcnt vmcnt(24)
    v_mfma_f32_16x16x32_bf16 v[0:3], a[204:207], v[236:239], v[0:3]
    v_mfma_f32_16x16x32_bf16 v[4:7], a[208:211], v[236:239], v[4:7]
    v_mfma_f32_16x16x32_bf16 v[8:11], a[212:215], v[236:239], v[8:11]
    ds_read_b128 v[236:239], v253 offset:16640
    s_waitcnt lgkmcnt(2)
    v_mfma_f32_16x16x32_bf16 v[24:27], a[192:195], v[228:231], v[24:27]
    v_mfma_f32_16x16x32_bf16 v[28:31], a[196:199], v[228:231], v[28:31]
    v_mfma_f32_16x16x32_bf16 v[32:35], a[200:203], v[228:231], v[32:35]
    v_mfma_f32_16x16x32_bf16 v[12:15], a[204:207], v[228:231], v[12:15]
    v_mfma_f32_16x16x32_bf16 v[16:19], a[208:211], v[228:231], v[16:19]
    v_mfma_f32_16x16x32_bf16 v[20:23], a[212:215], v[228:231], v[20:23]
    s_waitcnt vmcnt(21)
    v_mfma_f32_16x16x32_bf16 v[0:3], a[216:219], v[228:231], v[0:3]
    v_mfma_f32_16x16x32_bf16 v[4:7], a[220:223], v[228:231], v[4:7]
    v_mfma_f32_16x16x32_bf16 v[8:11], a[224:227], v[228:231], v[8:11]
    ds_read_b128 v[228:231], v253 offset:18464
    s_waitcnt lgkmcnt(2)
    v_mfma_f32_16x16x32_bf16 v[36:39], a[192:195], v[232:235], v[36:39]
    v_mfma_f32_16x16x32_bf16 v[40:43], a[196:199], v[232:235], v[40:43]
    v_mfma_f32_16x16x32_bf16 v[44:47], a[200:203], v[232:235], v[44:47]
    v_mfma_f32_16x16x32_bf16 v[24:27], a[204:207], v[232:235], v[24:27]
    v_mfma_f32_16x16x32_bf16 v[28:31], a[208:211], v[232:235], v[28:31]
    v_mfma_f32_16x16x32_bf16 v[32:35], a[212:215], v[232:235], v[32:35]
    v_mfma_f32_16x16x32_bf16 v[12:15], a[216:219], v[232:235], v[12:15]
    v_mfma_f32_16x16x32_bf16 v[16:19], a[220:223], v[232:235], v[16:19]
    v_mfma_f32_16x16x32_bf16 v[20:23], a[224:227], v[232:235], v[20:23]
    ds_read_b128 v[232:235], v253 offset:18208
    s_waitcnt lgkmcnt(2)
    v_mfma_f32_16x16x32_bf16 v[48:51], a[192:195], v[236:239], v[48:51]
    v_mfma_f32_16x16x32_bf16 v[52:55], a[196:199], v[236:239], v[52:55]
    v_mfma_f32_16x16x32_bf16 v[56:59], a[200:203], v[236:239], v[56:59]
    v_mfma_f32_16x16x32_bf16 v[36:39], a[204:207], v[236:239], v[36:39]
    v_mfma_f32_16x16x32_bf16 v[40:43], a[208:211], v[236:239], v[40:43]
    v_mfma_f32_16x16x32_bf16 v[44:47], a[212:215], v[236:239], v[44:47]
    v_mfma_f32_16x16x32_bf16 v[24:27], a[216:219], v[236:239], v[24:27]
    v_mfma_f32_16x16x32_bf16 v[28:31], a[220:223], v[236:239], v[28:31]
    v_mfma_f32_16x16x32_bf16 v[32:35], a[224:227], v[236:239], v[32:35]
    ds_read_b128 v[236:239], v253 offset:17952
    s_waitcnt lgkmcnt(2)
    v_mfma_f32_16x16x32_bf16 v[60:63], a[192:195], v[228:231], v[60:63]
    v_mfma_f32_16x16x32_bf16 v[64:67], a[196:199], v[228:231], v[64:67]
    v_mfma_f32_16x16x32_bf16 v[68:71], a[200:203], v[228:231], v[68:71]
    v_mfma_f32_16x16x32_bf16 v[48:51], a[204:207], v[228:231], v[48:51]
    v_mfma_f32_16x16x32_bf16 v[52:55], a[208:211], v[228:231], v[52:55]
    v_mfma_f32_16x16x32_bf16 v[56:59], a[212:215], v[228:231], v[56:59]
    v_mfma_f32_16x16x32_bf16 v[36:39], a[216:219], v[228:231], v[36:39]
    v_mfma_f32_16x16x32_bf16 v[40:43], a[220:223], v[228:231], v[40:43]
    v_mfma_f32_16x16x32_bf16 v[44:47], a[224:227], v[228:231], v[44:47]
    ds_read_b128 v[228:231], v253 offset:17696
    s_waitcnt lgkmcnt(2)
    v_mfma_f32_16x16x32_bf16 v[72:75], a[192:195], v[232:235], v[72:75]
    v_mfma_f32_16x16x32_bf16 v[76:79], a[196:199], v[232:235], v[76:79]
    v_mfma_f32_16x16x32_bf16 v[80:83], a[200:203], v[232:235], v[80:83]
    v_mfma_f32_16x16x32_bf16 v[60:63], a[204:207], v[232:235], v[60:63]
    v_mfma_f32_16x16x32_bf16 v[64:67], a[208:211], v[232:235], v[64:67]
    v_mfma_f32_16x16x32_bf16 v[68:71], a[212:215], v[232:235], v[68:71]
    v_mfma_f32_16x16x32_bf16 v[48:51], a[216:219], v[232:235], v[48:51]
    v_mfma_f32_16x16x32_bf16 v[52:55], a[220:223], v[232:235], v[52:55]
    v_mfma_f32_16x16x32_bf16 v[56:59], a[224:227], v[232:235], v[56:59]
    ds_read_b128 v[232:235], v253 offset:17424
    s_waitcnt lgkmcnt(2)
    v_mfma_f32_16x16x32_bf16 v[84:87], a[192:195], v[236:239], v[84:87]
    v_mfma_f32_16x16x32_bf16 v[88:91], a[196:199], v[236:239], v[88:91]
    v_mfma_f32_16x16x32_bf16 v[92:95], a[200:203], v[236:239], v[92:95]
    v_mfma_f32_16x16x32_bf16 v[72:75], a[204:207], v[236:239], v[72:75]
    s_mov_b32 s42, 1105920
    buffer_load_dwordx4 a[192:195], v254, s[8:11], s42 offen offset:0
    v_mfma_f32_16x16x32_bf16 v[76:79], a[208:211], v[236:239], v[76:79]
    v_mfma_f32_16x16x32_bf16 v[80:83], a[212:215], v[236:239], v[80:83]
    buffer_load_dwordx4 a[196:199], v254, s[8:11], s42 offen offset:1024
    v_mfma_f32_16x16x32_bf16 v[60:63], a[216:219], v[236:239], v[60:63]
    v_mfma_f32_16x16x32_bf16 v[64:67], a[220:223], v[236:239], v[64:67]
    buffer_load_dwordx4 a[200:203], v254, s[8:11], s42 offen offset:2048
    v_mfma_f32_16x16x32_bf16 v[68:71], a[224:227], v[236:239], v[68:71]
    ds_read_b128 v[236:239], v253 offset:15600
    s_waitcnt lgkmcnt(2)
    v_mfma_f32_16x16x32_bf16 v[84:87], a[204:207], v[228:231], v[84:87]
    v_mfma_f32_16x16x32_bf16 v[88:91], a[208:211], v[228:231], v[88:91]
    v_mfma_f32_16x16x32_bf16 v[92:95], a[212:215], v[228:231], v[92:95]
    s_mov_b32 s42, 1108992
    buffer_load_dwordx4 a[204:207], v254, s[8:11], s42 offen offset:0
    v_mfma_f32_16x16x32_bf16 v[72:75], a[216:219], v[228:231], v[72:75]
    v_mfma_f32_16x16x32_bf16 v[76:79], a[220:223], v[228:231], v[76:79]
    buffer_load_dwordx4 a[208:211], v254, s[8:11], s42 offen offset:1024
    v_mfma_f32_16x16x32_bf16 v[80:83], a[224:227], v[228:231], v[80:83]
    ds_read_b128 v[228:231], v253 offset:15328
    s_waitcnt lgkmcnt(2)
    v_mfma_f32_16x16x32_bf16 v[84:87], a[216:219], v[232:235], v[84:87]
    buffer_load_dwordx4 a[212:215], v254, s[8:11], s42 offen offset:2048
    v_mfma_f32_16x16x32_bf16 v[88:91], a[220:223], v[232:235], v[88:91]
    v_mfma_f32_16x16x32_bf16 v[92:95], a[224:227], v[232:235], v[92:95]
    ds_read_b128 v[232:235], v253 offset:15072
    s_mov_b32 s42, 1112064
    buffer_load_dwordx4 a[216:219], v254, s[8:11], s42 offen offset:0
    s_waitcnt vmcnt(13) lgkmcnt(2)
    v_mfma_f32_16x16x32_bf16 v[0:3], a[228:231], v[236:239], v[0:3]
    v_mfma_f32_16x16x32_bf16 v[4:7], a[232:235], v[236:239], v[4:7]
    buffer_load_dwordx4 a[220:223], v254, s[8:11], s42 offen offset:1024
    v_mfma_f32_16x16x32_bf16 v[8:11], a[236:239], v[236:239], v[8:11]
    ds_read_b128 v[236:239], v253 offset:14816
    s_waitcnt lgkmcnt(2)
    v_mfma_f32_16x16x32_bf16 v[12:15], a[228:231], v[228:231], v[12:15]
    buffer_load_dwordx4 a[224:227], v254, s[8:11], s42 offen offset:2048
    v_mfma_f32_16x16x32_bf16 v[16:19], a[232:235], v[228:231], v[16:19]
    v_mfma_f32_16x16x32_bf16 v[20:23], a[236:239], v[228:231], v[20:23]
    s_waitcnt vmcnt(12)
    v_mfma_f32_16x16x32_bf16 v[0:3], a[240:243], v[228:231], v[0:3]
    v_mfma_f32_16x16x32_bf16 v[4:7], a[244:247], v[228:231], v[4:7]
    v_mfma_f32_16x16x32_bf16 v[8:11], a[248:251], v[228:231], v[8:11]
    ds_read_b128 v[228:231], v253 offset:14560
    s_waitcnt lgkmcnt(2)
    v_mfma_f32_16x16x32_bf16 v[24:27], a[228:231], v[232:235], v[24:27]
    v_mfma_f32_16x16x32_bf16 v[28:31], a[232:235], v[232:235], v[28:31]
    v_mfma_f32_16x16x32_bf16 v[32:35], a[236:239], v[232:235], v[32:35]
    v_mfma_f32_16x16x32_bf16 v[12:15], a[240:243], v[232:235], v[12:15]
    v_mfma_f32_16x16x32_bf16 v[16:19], a[244:247], v[232:235], v[16:19]
    v_mfma_f32_16x16x32_bf16 v[20:23], a[248:251], v[232:235], v[20:23]
    s_waitcnt vmcnt(9)
    v_mfma_f32_16x16x32_bf16 v[0:3], a[252:255], v[232:235], v[0:3]
    v_mfma_f32_16x16x32_bf16 v[4:7], v[240:243], v[232:235], v[4:7]
    v_mfma_f32_16x16x32_bf16 v[8:11], v[244:247], v[232:235], v[8:11]
    ds_read_b128 v[232:235], v253 offset:16384
    s_waitcnt lgkmcnt(2)
    v_mfma_f32_16x16x32_bf16 v[36:39], a[228:231], v[236:239], v[36:39]
    v_mfma_f32_16x16x32_bf16 v[40:43], a[232:235], v[236:239], v[40:43]
    v_mfma_f32_16x16x32_bf16 v[44:47], a[236:239], v[236:239], v[44:47]
    v_mfma_f32_16x16x32_bf16 v[24:27], a[240:243], v[236:239], v[24:27]
    v_mfma_f32_16x16x32_bf16 v[28:31], a[244:247], v[236:239], v[28:31]
    v_mfma_f32_16x16x32_bf16 v[32:35], a[248:251], v[236:239], v[32:35]
    v_mfma_f32_16x16x32_bf16 v[12:15], a[252:255], v[236:239], v[12:15]
    v_mfma_f32_16x16x32_bf16 v[16:19], v[240:243], v[236:239], v[16:19]
    v_mfma_f32_16x16x32_bf16 v[20:23], v[244:247], v[236:239], v[20:23]
    ds_read_b128 v[236:239], v253 offset:16128
    s_waitcnt lgkmcnt(2)
    v_mfma_f32_16x16x32_bf16 v[48:51], a[228:231], v[228:231], v[48:51]
    v_mfma_f32_16x16x32_bf16 v[52:55], a[232:235], v[228:231], v[52:55]
    v_mfma_f32_16x16x32_bf16 v[56:59], a[236:239], v[228:231], v[56:59]
    v_mfma_f32_16x16x32_bf16 v[36:39], a[240:243], v[228:231], v[36:39]
    v_mfma_f32_16x16x32_bf16 v[40:43], a[244:247], v[228:231], v[40:43]
    v_mfma_f32_16x16x32_bf16 v[44:47], a[248:251], v[228:231], v[44:47]
    v_mfma_f32_16x16x32_bf16 v[24:27], a[252:255], v[228:231], v[24:27]
    v_mfma_f32_16x16x32_bf16 v[28:31], v[240:243], v[228:231], v[28:31]
    v_mfma_f32_16x16x32_bf16 v[32:35], v[244:247], v[228:231], v[32:35]
    ds_read_b128 v[228:231], v253 offset:15872
    s_waitcnt lgkmcnt(2)
    v_mfma_f32_16x16x32_bf16 v[60:63], a[228:231], v[232:235], v[60:63]
    v_mfma_f32_16x16x32_bf16 v[64:67], a[232:235], v[232:235], v[64:67]
    v_mfma_f32_16x16x32_bf16 v[68:71], a[236:239], v[232:235], v[68:71]
    v_mfma_f32_16x16x32_bf16 v[48:51], a[240:243], v[232:235], v[48:51]
    v_mfma_f32_16x16x32_bf16 v[52:55], a[244:247], v[232:235], v[52:55]
    v_mfma_f32_16x16x32_bf16 v[56:59], a[248:251], v[232:235], v[56:59]
    v_mfma_f32_16x16x32_bf16 v[36:39], a[252:255], v[232:235], v[36:39]
    v_mfma_f32_16x16x32_bf16 v[40:43], v[240:243], v[232:235], v[40:43]
    v_mfma_f32_16x16x32_bf16 v[44:47], v[244:247], v[232:235], v[44:47]
    ds_read_b128 v[232:235], v253 offset:15616
    s_waitcnt lgkmcnt(2)
    v_mfma_f32_16x16x32_bf16 v[72:75], a[228:231], v[236:239], v[72:75]
    v_mfma_f32_16x16x32_bf16 v[76:79], a[232:235], v[236:239], v[76:79]
    v_mfma_f32_16x16x32_bf16 v[80:83], a[236:239], v[236:239], v[80:83]
    v_mfma_f32_16x16x32_bf16 v[60:63], a[240:243], v[236:239], v[60:63]
    v_mfma_f32_16x16x32_bf16 v[64:67], a[244:247], v[236:239], v[64:67]
    v_mfma_f32_16x16x32_bf16 v[68:71], a[248:251], v[236:239], v[68:71]
    v_mfma_f32_16x16x32_bf16 v[48:51], a[252:255], v[236:239], v[48:51]
    v_mfma_f32_16x16x32_bf16 v[52:55], v[240:243], v[236:239], v[52:55]
    v_mfma_f32_16x16x32_bf16 v[56:59], v[244:247], v[236:239], v[56:59]
    ds_read_b128 v[236:239], v253 offset:15344
    s_waitcnt lgkmcnt(2)
    v_mfma_f32_16x16x32_bf16 v[84:87], a[228:231], v[228:231], v[84:87]
    v_mfma_f32_16x16x32_bf16 v[88:91], a[232:235], v[228:231], v[88:91]
    v_mfma_f32_16x16x32_bf16 v[92:95], a[236:239], v[228:231], v[92:95]
    v_mfma_f32_16x16x32_bf16 v[72:75], a[240:243], v[228:231], v[72:75]
    s_mov_b32 s42, 1142784
    buffer_load_dwordx4 a[228:231], v254, s[8:11], s42 offen offset:0
    v_mfma_f32_16x16x32_bf16 v[76:79], a[244:247], v[228:231], v[76:79]
    v_mfma_f32_16x16x32_bf16 v[80:83], a[248:251], v[228:231], v[80:83]
    buffer_load_dwordx4 a[232:235], v254, s[8:11], s42 offen offset:1024
    v_mfma_f32_16x16x32_bf16 v[60:63], a[252:255], v[228:231], v[60:63]
    v_mfma_f32_16x16x32_bf16 v[64:67], v[240:243], v[228:231], v[64:67]
    buffer_load_dwordx4 a[236:239], v254, s[8:11], s42 offen offset:2048
    v_mfma_f32_16x16x32_bf16 v[68:71], v[244:247], v[228:231], v[68:71]
    s_waitcnt lgkmcnt(0)
    s_barrier
    ds_read_b128 v[228:231], v253 offset:38480
    v_mfma_f32_16x16x32_bf16 v[84:87], a[240:243], v[232:235], v[84:87]
    v_mfma_f32_16x16x32_bf16 v[88:91], a[244:247], v[232:235], v[88:91]
    v_mfma_f32_16x16x32_bf16 v[92:95], a[248:251], v[232:235], v[92:95]
    s_mov_b32 s42, 1145856
    buffer_load_dwordx4 a[240:243], v254, s[8:11], s42 offen offset:0
    v_mfma_f32_16x16x32_bf16 v[72:75], a[252:255], v[232:235], v[72:75]
    v_mfma_f32_16x16x32_bf16 v[76:79], v[240:243], v[232:235], v[76:79]
    buffer_load_dwordx4 a[244:247], v254, s[8:11], s42 offen offset:1024
    v_mfma_f32_16x16x32_bf16 v[80:83], v[244:247], v[232:235], v[80:83]
    ds_read_b128 v[232:235], v253 offset:38208
    v_mfma_f32_16x16x32_bf16 v[84:87], a[252:255], v[236:239], v[84:87]
    buffer_load_dwordx4 a[248:251], v254, s[8:11], s42 offen offset:2048
    v_mfma_f32_16x16x32_bf16 v[88:91], v[240:243], v[236:239], v[88:91]
    v_mfma_f32_16x16x32_bf16 v[92:95], v[244:247], v[236:239], v[92:95]
    ds_read_b128 v[236:239], v253 offset:37952
    s_mov_b32 s42, 1148928
    buffer_load_dwordx4 a[252:255], v254, s[8:11], s42 offen offset:0
    s_waitcnt vmcnt(13) lgkmcnt(2)
    v_mfma_f32_16x16x32_bf16 v[96:99], a[192:195], v[228:231], v[96:99]
    v_mfma_f32_16x16x32_bf16 v[100:103], a[196:199], v[228:231], v[100:103]
    buffer_load_dwordx4 v[240:243], v254, s[8:11], s42 offen offset:1024
    v_mfma_f32_16x16x32_bf16 v[104:107], a[200:203], v[228:231], v[104:107]
    ds_read_b128 v[228:231], v253 offset:37696
    s_waitcnt lgkmcnt(2)
    v_mfma_f32_16x16x32_bf16 v[108:111], a[192:195], v[232:235], v[108:111]
    buffer_load_dwordx4 v[244:247], v254, s[8:11], s42 offen offset:2048
    v_mfma_f32_16x16x32_bf16 v[112:115], a[196:199], v[232:235], v[112:115]
    v_cvt_pk_bf16_f32 v0, v0, v1
    v_mfma_f32_16x16x32_bf16 v[116:119], a[200:203], v[232:235], v[116:119]
    s_waitcnt vmcnt(12)
    v_mfma_f32_16x16x32_bf16 v[96:99], a[204:207], v[232:235], v[96:99]
    v_and_b32 v227, 0x7fff, v255
    v_mfma_f32_16x16x32_bf16 v[100:103], a[208:211], v[232:235], v[100:103]
    buffer_load_dwordx2 v[216:217], v227, s[4:7], s16 offen offset:0
    v_mfma_f32_16x16x32_bf16 v[104:107], a[212:215], v[232:235], v[104:107]
    ds_read_b128 v[232:235], v253 offset:37440
    s_waitcnt lgkmcnt(2)
    v_mfma_f32_16x16x32_bf16 v[120:123], a[192:195], v[236:239], v[120:123]
    buffer_load_dwordx2 v[218:219], v227, s[4:7], s17 offen offset:0
    v_mfma_f32_16x16x32_bf16 v[124:127], a[196:199], v[236:239], v[124:127]
    buffer_load_dwordx2 v[220:221], v227, s[4:7], s18 offen offset:0
    v_mfma_f32_16x16x32_bf16 v[128:131], a[200:203], v[236:239], v[128:131]
    v_cvt_pk_bf16_f32 v1, v2, v3
    v_mfma_f32_16x16x32_bf16 v[108:111], a[204:207], v[236:239], v[108:111]
    buffer_load_dwordx2 v[222:223], v227, s[4:7], s19 offen offset:0
    v_mfma_f32_16x16x32_bf16 v[112:115], a[208:211], v[236:239], v[112:115]
    buffer_load_dwordx2 v[224:225], v227, s[4:7], s20 offen offset:0
    v_mfma_f32_16x16x32_bf16 v[116:119], a[212:215], v[236:239], v[116:119]
    s_waitcnt vmcnt(14)
    v_mfma_f32_16x16x32_bf16 v[96:99], a[216:219], v[236:239], v[96:99]
    buffer_load_dwordx2 v[226:227], v227, s[4:7], s21 offen offset:0
    v_mfma_f32_16x16x32_bf16 v[100:103], a[220:223], v[236:239], v[100:103]
    v_cvt_pk_bf16_f32 v2, v4, v5
    v_mfma_f32_16x16x32_bf16 v[104:107], a[224:227], v[236:239], v[104:107]
    ds_read_b128 v[236:239], v253 offset:39264
    s_waitcnt lgkmcnt(2)
    v_mfma_f32_16x16x32_bf16 v[132:135], a[192:195], v[228:231], v[132:135]
    v_cvt_pk_bf16_f32 v3, v6, v7
    v_mfma_f32_16x16x32_bf16 v[136:139], a[196:199], v[228:231], v[136:139]
    v_mfma_f32_16x16x32_bf16 v[140:143], a[200:203], v[228:231], v[140:143]
    v_cvt_pk_bf16_f32 v8, v8, v9
    v_mfma_f32_16x16x32_bf16 v[120:123], a[204:207], v[228:231], v[120:123]
    v_cvt_pk_bf16_f32 v9, v10, v11
    v_mfma_f32_16x16x32_bf16 v[124:127], a[208:211], v[228:231], v[124:127]
    ds_write_b128 v248, v[0:3] offset:8320
    v_mfma_f32_16x16x32_bf16 v[128:131], a[212:215], v[228:231], v[128:131]
    ds_write_b64 v249, v[8:9] offset:8384
    v_mfma_f32_16x16x32_bf16 v[108:111], a[216:219], v[228:231], v[108:111]
    v_mfma_f32_16x16x32_bf16 v[112:115], a[220:223], v[228:231], v[112:115]
    v_cvt_pk_bf16_f32 v12, v12, v13
    v_mfma_f32_16x16x32_bf16 v[116:119], a[224:227], v[228:231], v[116:119]
    ds_read_b128 v[228:231], v253 offset:39008
    s_waitcnt lgkmcnt(4)
    v_mfma_f32_16x16x32_bf16 v[144:147], a[192:195], v[232:235], v[144:147]
    v_cvt_pk_bf16_f32 v13, v14, v15
    v_mfma_f32_16x16x32_bf16 v[148:151], a[196:199], v[232:235], v[148:151]
    v_cvt_pk_bf16_f32 v14, v16, v17
    v_mfma_f32_16x16x32_bf16 v[152:155], a[200:203], v[232:235], v[152:155]
    v_mfma_f32_16x16x32_bf16 v[132:135], a[204:207], v[232:235], v[132:135]
    v_cvt_pk_bf16_f32 v15, v18, v19
    v_mfma_f32_16x16x32_bf16 v[136:139], a[208:211], v[232:235], v[136:139]
    v_cvt_pk_bf16_f32 v20, v20, v21
    v_mfma_f32_16x16x32_bf16 v[140:143], a[212:215], v[232:235], v[140:143]
    v_cvt_pk_bf16_f32 v21, v22, v23
    v_mfma_f32_16x16x32_bf16 v[120:123], a[216:219], v[232:235], v[120:123]
    ds_write_b128 v248, v[12:15] offset:8704
    v_mfma_f32_16x16x32_bf16 v[124:127], a[220:223], v[232:235], v[124:127]
    v_mfma_f32_16x16x32_bf16 v[128:131], a[224:227], v[232:235], v[128:131]
    ds_read_b128 v[232:235], v253 offset:38752
    s_waitcnt lgkmcnt(5)
    v_mfma_f32_16x16x32_bf16 v[156:159], a[192:195], v[236:239], v[156:159]
    ds_write_b64 v249, v[20:21] offset:8768
    v_mfma_f32_16x16x32_bf16 v[160:163], a[196:199], v[236:239], v[160:163]
    v_cvt_pk_bf16_f32 v24, v24, v25
    v_mfma_f32_16x16x32_bf16 v[164:167], a[200:203], v[236:239], v[164:167]
    v_cvt_pk_bf16_f32 v25, v26, v27
    v_mfma_f32_16x16x32_bf16 v[144:147], a[204:207], v[236:239], v[144:147]
    v_mfma_f32_16x16x32_bf16 v[148:151], a[208:211], v[236:239], v[148:151]
    v_cvt_pk_bf16_f32 v26, v28, v29
    v_mfma_f32_16x16x32_bf16 v[152:155], a[212:215], v[236:239], v[152:155]
    v_cvt_pk_bf16_f32 v27, v30, v31
    v_mfma_f32_16x16x32_bf16 v[132:135], a[216:219], v[236:239], v[132:135]
    v_cvt_pk_bf16_f32 v32, v32, v33
    v_mfma_f32_16x16x32_bf16 v[136:139], a[220:223], v[236:239], v[136:139]
    v_cvt_pk_bf16_f32 v33, v34, v35
    v_mfma_f32_16x16x32_bf16 v[140:143], a[224:227], v[236:239], v[140:143]
    ds_read_b128 v[236:239], v253 offset:38496
    s_waitcnt lgkmcnt(4)
    v_mfma_f32_16x16x32_bf16 v[168:171], a[192:195], v[228:231], v[168:171]
    v_mfma_f32_16x16x32_bf16 v[172:175], a[196:199], v[228:231], v[172:175]
    ds_write_b128 v248, v[24:27] offset:9088
    v_mfma_f32_16x16x32_bf16 v[176:179], a[200:203], v[228:231], v[176:179]
    ds_write_b64 v249, v[32:33] offset:9152
    v_mfma_f32_16x16x32_bf16 v[156:159], a[204:207], v[228:231], v[156:159]
    v_cvt_pk_bf16_f32 v36, v36, v37
    v_mfma_f32_16x16x32_bf16 v[160:163], a[208:211], v[228:231], v[160:163]
    v_mfma_f32_16x16x32_bf16 v[164:167], a[212:215], v[228:231], v[164:167]
    v_cvt_pk_bf16_f32 v37, v38, v39
    v_mfma_f32_16x16x32_bf16 v[144:147], a[216:219], v[228:231], v[144:147]
    v_cvt_pk_bf16_f32 v38, v40, v41
    v_mfma_f32_16x16x32_bf16 v[148:151], a[220:223], v[228:231], v[148:151]
    v_cvt_pk_bf16_f32 v39, v42, v43
    v_mfma_f32_16x16x32_bf16 v[152:155], a[224:227], v[228:231], v[152:155]
    ds_read_b128 v[228:231], v253 offset:38224
    s_waitcnt lgkmcnt(5)
    v_mfma_f32_16x16x32_bf16 v[180:183], a[192:195], v[232:235], v[180:183]
    v_cvt_pk_bf16_f32 v44, v44, v45
    v_mfma_f32_16x16x32_bf16 v[184:187], a[196:199], v[232:235], v[184:187]
    v_mfma_f32_16x16x32_bf16 v[188:191], a[200:203], v[232:235], v[188:191]
    v_cvt_pk_bf16_f32 v45, v46, v47
    v_mfma_f32_16x16x32_bf16 v[168:171], a[204:207], v[232:235], v[168:171]
    s_mov_b32 s42, 1179648
    buffer_load_dwordx4 a[192:195], v254, s[8:11], s42 offen offset:0
    v_mfma_f32_16x16x32_bf16 v[172:175], a[208:211], v[232:235], v[172:175]
    ds_write_b128 v248, v[36:39] offset:9472
    v_mfma_f32_16x16x32_bf16 v[176:179], a[212:215], v[232:235], v[176:179]
    buffer_load_dwordx4 a[196:199], v254, s[8:11], s42 offen offset:1024
    v_mfma_f32_16x16x32_bf16 v[156:159], a[216:219], v[232:235], v[156:159]
    ds_write_b64 v249, v[44:45] offset:9536
    v_mfma_f32_16x16x32_bf16 v[160:163], a[220:223], v[232:235], v[160:163]
    buffer_load_dwordx4 a[200:203], v254, s[8:11], s42 offen offset:2048
    v_mfma_f32_16x16x32_bf16 v[164:167], a[224:227], v[232:235], v[164:167]
    ds_read_b128 v[232:235], v253 offset:36400
    s_waitcnt lgkmcnt(6)
    v_mfma_f32_16x16x32_bf16 v[180:183], a[204:207], v[236:239], v[180:183]
    v_mfma_f32_16x16x32_bf16 v[184:187], a[208:211], v[236:239], v[184:187]
    v_cvt_pk_bf16_f32 v48, v48, v49
    v_mfma_f32_16x16x32_bf16 v[188:191], a[212:215], v[236:239], v[188:191]
    s_mov_b32 s42, 1182720
    buffer_load_dwordx4 a[204:207], v254, s[8:11], s42 offen offset:0
    v_mfma_f32_16x16x32_bf16 v[168:171], a[216:219], v[236:239], v[168:171]
    v_cvt_pk_bf16_f32 v49, v50, v51
    v_mfma_f32_16x16x32_bf16 v[172:175], a[220:223], v[236:239], v[172:175]
    buffer_load_dwordx4 a[208:211], v254, s[8:11], s42 offen offset:1024
    v_mfma_f32_16x16x32_bf16 v[176:179], a[224:227], v[236:239], v[176:179]
    ds_read_b128 v[236:239], v253 offset:36128
    s_waitcnt lgkmcnt(4)
    v_mfma_f32_16x16x32_bf16 v[180:183], a[216:219], v[228:231], v[180:183]
    buffer_load_dwordx4 a[212:215], v254, s[8:11], s42 offen offset:2048
    v_mfma_f32_16x16x32_bf16 v[184:187], a[220:223], v[228:231], v[184:187]
    v_cvt_pk_bf16_f32 v50, v52, v53
    v_mfma_f32_16x16x32_bf16 v[188:191], a[224:227], v[228:231], v[188:191]
    ds_read_b128 v[228:231], v253 offset:35872
    s_mov_b32 s42, 1185792
    buffer_load_dwordx4 a[216:219], v254, s[8:11], s42 offen offset:0
    s_waitcnt vmcnt(19) lgkmcnt(2)
    v_mfma_f32_16x16x32_bf16 v[96:99], a[228:231], v[232:235], v[96:99]
    v_cvt_pk_bf16_f32 v51, v54, v55
    v_mfma_f32_16x16x32_bf16 v[100:103], a[232:235], v[232:235], v[100:103]
    buffer_load_dwordx4 a[220:223], v254, s[8:11], s42 offen offset:1024
    v_mfma_f32_16x16x32_bf16 v[104:107], a[236:239], v[232:235], v[104:107]
    ds_read_b128 v[232:235], v253 offset:35616
    s_waitcnt lgkmcnt(2)
    v_mfma_f32_16x16x32_bf16 v[108:111], a[228:231], v[236:239], v[108:111]
    buffer_load_dwordx4 a[224:227], v254, s[8:11], s42 offen offset:2048
    v_mfma_f32_16x16x32_bf16 v[112:115], a[232:235], v[236:239], v[112:115]
    v_mfma_f32_16x16x32_bf16 v[116:119], a[236:239], v[236:239], v[116:119]
    s_waitcnt vmcnt(18)
    v_mfma_f32_16x16x32_bf16 v[96:99], a[240:243], v[236:239], v[96:99]
    v_and_b32 v203, 0x7fff, v255
    v_mfma_f32_16x16x32_bf16 v[100:103], a[244:247], v[236:239], v[100:103]
    buffer_load_dwordx2 v[192:193], v203, s[4:7], s16 offen offset:384
    v_mfma_f32_16x16x32_bf16 v[104:107], a[248:251], v[236:239], v[104:107]
    ds_read_b128 v[236:239], v253 offset:35360
    s_waitcnt lgkmcnt(2)
    v_mfma_f32_16x16x32_bf16 v[120:123], a[228:231], v[228:231], v[120:123]
    buffer_load_dwordx2 v[194:195], v203, s[4:7], s17 offen offset:384
    v_mfma_f32_16x16x32_bf16 v[124:127], a[232:235], v[228:231], v[124:127]
    buffer_load_dwordx2 v[196:197], v203, s[4:7], s18 offen offset:384
    v_mfma_f32_16x16x32_bf16 v[128:131], a[236:239], v[228:231], v[128:131]
    v_cvt_pk_bf16_f32 v56, v56, v57
    v_mfma_f32_16x16x32_bf16 v[108:111], a[240:243], v[228:231], v[108:111]
    buffer_load_dwordx2 v[198:199], v203, s[4:7], s19 offen offset:384
    v_mfma_f32_16x16x32_bf16 v[112:115], a[244:247], v[228:231], v[112:115]
    buffer_load_dwordx2 v[200:201], v203, s[4:7], s20 offen offset:384
    v_mfma_f32_16x16x32_bf16 v[116:119], a[248:251], v[228:231], v[116:119]
    s_waitcnt vmcnt(20)
    v_mfma_f32_16x16x32_bf16 v[96:99], a[252:255], v[228:231], v[96:99]
    buffer_load_dwordx2 v[202:203], v203, s[4:7], s21 offen offset:384
    v_mfma_f32_16x16x32_bf16 v[100:103], v[240:243], v[228:231], v[100:103]
    v_cvt_pk_bf16_f32 v57, v58, v59
    v_mfma_f32_16x16x32_bf16 v[104:107], v[244:247], v[228:231], v[104:107]
    ds_read_b128 v[228:231], v253 offset:37184
    s_waitcnt lgkmcnt(2)
    v_mfma_f32_16x16x32_bf16 v[132:135], a[228:231], v[232:235], v[132:135]
    ds_write_b128 v248, v[48:51] offset:9856
    v_mfma_f32_16x16x32_bf16 v[136:139], a[232:235], v[232:235], v[136:139]
    ds_write_b64 v249, v[56:57] offset:9920
    v_mfma_f32_16x16x32_bf16 v[140:143], a[236:239], v[232:235], v[140:143]
    v_mfma_f32_16x16x32_bf16 v[120:123], a[240:243], v[232:235], v[120:123]
    v_cvt_pk_bf16_f32 v60, v60, v61
    v_mfma_f32_16x16x32_bf16 v[124:127], a[244:247], v[232:235], v[124:127]
    v_cvt_pk_bf16_f32 v61, v62, v63
    v_mfma_f32_16x16x32_bf16 v[128:131], a[248:251], v[232:235], v[128:131]
    v_cvt_pk_bf16_f32 v62, v64, v65
    v_mfma_f32_16x16x32_bf16 v[108:111], a[252:255], v[232:235], v[108:111]
    v_mfma_f32_16x16x32_bf16 v[112:115], v[240:243], v[232:235], v[112:115]
    v_cvt_pk_bf16_f32 v63, v66, v67
    v_mfma_f32_16x16x32_bf16 v[116:119], v[244:247], v[232:235], v[116:119]
    ds_read_b128 v[232:235], v253 offset:36928
    s_waitcnt lgkmcnt(4)
    v_mfma_f32_16x16x32_bf16 v[144:147], a[228:231], v[236:239], v[144:147]
    v_cvt_pk_bf16_f32 v68, v68, v69
    v_mfma_f32_16x16x32_bf16 v[148:151], a[232:235], v[236:239], v[148:151]
    v_cvt_pk_bf16_f32 v69, v70, v71
    v_mfma_f32_16x16x32_bf16 v[152:155], a[236:239], v[236:239], v[152:155]
    ds_write_b128 v248, v[60:63] offset:10240
    v_mfma_f32_16x16x32_bf16 v[132:135], a[240:243], v[236:239], v[132:135]
    v_mfma_f32_16x16x32_bf16 v[136:139], a[244:247], v[236:239], v[136:139]
    ds_write_b64 v249, v[68:69] offset:10304
    v_mfma_f32_16x16x32_bf16 v[140:143], a[248:251], v[236:239], v[140:143]
    v_cvt_pk_bf16_f32 v72, v72, v73
    v_mfma_f32_16x16x32_bf16 v[120:123], a[252:255], v[236:239], v[120:123]
    v_cvt_pk_bf16_f32 v73, v74, v75
    v_mfma_f32_16x16x32_bf16 v[124:127], v[240:243], v[236:239], v[124:127]
    v_mfma_f32_16x16x32_bf16 v[128:131], v[244:247], v[236:239], v[128:131]
    ds_read_b128 v[236:239], v253 offset:36672
    s_waitcnt lgkmcnt(6)
    v_mfma_f32_16x16x32_bf16 v[156:159], a[228:231], v[228:231], v[156:159]
    v_cvt_pk_bf16_f32 v74, v76, v77
    v_mfma_f32_16x16x32_bf16 v[160:163], a[232:235], v[228:231], v[160:163]
    v_cvt_pk_bf16_f32 v75, v78, v79
    v_mfma_f32_16x16x32_bf16 v[164:167], a[236:239], v[228:231], v[164:167]
    v_cvt_pk_bf16_f32 v80, v80, v81
    v_mfma_f32_16x16x32_bf16 v[144:147], a[240:243], v[228:231], v[144:147]
    v_cvt_pk_bf16_f32 v81, v82, v83
    v_mfma_f32_16x16x32_bf16 v[148:151], a[244:247], v[228:231], v[148:151]
    v_mfma_f32_16x16x32_bf16 v[152:155], a[248:251], v[228:231], v[152:155]
    ds_write_b128 v248, v[72:75] offset:10624
    v_mfma_f32_16x16x32_bf16 v[132:135], a[252:255], v[228:231], v[132:135]
    ds_write_b64 v249, v[80:81] offset:10688
    v_mfma_f32_16x16x32_bf16 v[136:139], v[240:243], v[228:231], v[136:139]
    v_cvt_pk_bf16_f32 v84, v84, v85
    v_mfma_f32_16x16x32_bf16 v[140:143], v[244:247], v[228:231], v[140:143]
    ds_read_b128 v[228:231], v253 offset:36416
    s_waitcnt lgkmcnt(6)
    v_mfma_f32_16x16x32_bf16 v[168:171], a[228:231], v[232:235], v[168:171]
    v_mfma_f32_16x16x32_bf16 v[172:175], a[232:235], v[232:235], v[172:175]
    v_cvt_pk_bf16_f32 v85, v86, v87
    v_mfma_f32_16x16x32_bf16 v[176:179], a[236:239], v[232:235], v[176:179]
    v_cvt_pk_bf16_f32 v86, v88, v89
    v_mfma_f32_16x16x32_bf16 v[156:159], a[240:243], v[232:235], v[156:159]
    v_cvt_pk_bf16_f32 v87, v90, v91
    v_mfma_f32_16x16x32_bf16 v[160:163], a[244:247], v[232:235], v[160:163]
    v_cvt_pk_bf16_f32 v92, v92, v93
    v_mfma_f32_16x16x32_bf16 v[164:167], a[248:251], v[232:235], v[164:167]
    v_mfma_f32_16x16x32_bf16 v[144:147], a[252:255], v[232:235], v[144:147]
    v_cvt_pk_bf16_f32 v93, v94, v95
    v_mfma_f32_16x16x32_bf16 v[148:151], v[240:243], v[232:235], v[148:151]
    ds_write_b128 v248, v[84:87] offset:11008
    v_mfma_f32_16x16x32_bf16 v[152:155], v[244:247], v[232:235], v[152:155]
    ds_read_b128 v[232:235], v253 offset:36144
    s_waitcnt lgkmcnt(5)
    v_mfma_f32_16x16x32_bf16 v[180:183], a[228:231], v[236:239], v[180:183]
    ds_write_b64 v249, v[92:93] offset:11072
    v_mfma_f32_16x16x32_bf16 v[184:187], a[232:235], v[236:239], v[184:187]
    v_mfma_f32_16x16x32_bf16 v[188:191], a[236:239], v[236:239], v[188:191]
    v_mfma_f32_16x16x32_bf16 v[168:171], a[240:243], v[236:239], v[168:171]
    s_mov_b32 s42, 1216512
    buffer_load_dwordx4 a[228:231], v254, s[8:11], s42 offen offset:0
    v_mfma_f32_16x16x32_bf16 v[172:175], a[244:247], v[236:239], v[172:175]
    v_mfma_f32_16x16x32_bf16 v[176:179], a[248:251], v[236:239], v[176:179]
    buffer_load_dwordx4 a[232:235], v254, s[8:11], s42 offen offset:1024
    v_mfma_f32_16x16x32_bf16 v[156:159], a[252:255], v[236:239], v[156:159]
    v_mfma_f32_16x16x32_bf16 v[160:163], v[240:243], v[236:239], v[160:163]
    buffer_load_dwordx4 a[236:239], v254, s[8:11], s42 offen offset:2048
    v_mfma_f32_16x16x32_bf16 v[164:167], v[244:247], v[236:239], v[164:167]
    s_waitcnt lgkmcnt(0)
    s_barrier
    ds_read_b128 v[236:239], v253 offset:23920
    v_mfma_f32_16x16x32_bf16 v[180:183], a[240:243], v[228:231], v[180:183]
    s_waitcnt vmcnt(18)
    v_lshlrev_b32 v248, 16, v218
    v_lshlrev_b32 v249, 16, v220
    v_mfma_f32_16x16x32_bf16 v[184:187], a[244:247], v[228:231], v[184:187]
    v_lshlrev_b32 v250, 16, v222
    v_lshlrev_b32 v251, 16, v224
    v_mfma_f32_16x16x32_bf16 v[188:191], a[248:251], v[228:231], v[188:191]
    s_mov_b32 s42, 1219584
    buffer_load_dwordx4 a[240:243], v254, s[8:11], s42 offen offset:0
    v_mfma_f32_16x16x32_bf16 v[168:171], a[252:255], v[228:231], v[168:171]
    v_and_b32 v218, s22, v218
    v_and_b32 v220, s22, v220
    v_mfma_f32_16x16x32_bf16 v[172:175], v[240:243], v[228:231], v[172:175]
    buffer_load_dwordx4 a[244:247], v254, s[8:11], s42 offen offset:1024
    v_and_b32 v222, s22, v222
    v_mfma_f32_16x16x32_bf16 v[176:179], v[244:247], v[228:231], v[176:179]
    ds_read_b128 v[228:231], v253 offset:23648
    v_mfma_f32_16x16x32_bf16 v[180:183], a[252:255], v[232:235], v[180:183]
    buffer_load_dwordx4 a[248:251], v254, s[8:11], s42 offen offset:2048
    v_and_b32 v224, s22, v224
    v_mfma_f32_16x16x32_bf16 v[184:187], v[240:243], v[232:235], v[184:187]
    v_lshlrev_b32 v252, 16, v216
    v_mfma_f32_16x16x32_bf16 v[188:191], v[244:247], v[232:235], v[188:191]
    ds_read_b128 v[232:235], v253 offset:23392
    s_mov_b32 s42, 1222656
    buffer_load_dwordx4 a[252:255], v254, s[8:11], s42 offen offset:0
    s_waitcnt vmcnt(19) lgkmcnt(2)
    v_mfma_f32_16x16x32_bf16 v[96:99], a[192:195], v[236:239], v[96:99]
    v_and_b32 v216, s22, v216
    v_add_f32 v252, v252, v251
    v_mfma_f32_16x16x32_bf16 v[100:103], a[196:199], v[236:239], v[100:103]
    buffer_load_dwordx4 v[240:243], v254, s[8:11], s42 offen offset:1024
    v_add_f32 v216, v216, v224
    v_mfma_f32_16x16x32_bf16 v[104:107], a[200:203], v[236:239], v[104:107]
    ds_read_b128 v[236:239], v253 offset:23136
    s_waitcnt lgkmcnt(2)
    v_mfma_f32_16x16x32_bf16 v[108:111], a[192:195], v[228:231], v[108:111]
    buffer_load_dwordx4 v[244:247], v254, s[8:11], s42 offen offset:2048
    v_fmac_f32 v252, s23, v249
    v_mfma_f32_16x16x32_bf16 v[112:115], a[196:199], v[228:231], v[112:115]
    v_fmac_f32 v216, s23, v220
    v_cvt_pk_bf16_f32 v216, v252, v216
    v_mfma_f32_16x16x32_bf16 v[116:119], a[200:203], v[228:231], v[116:119]
    s_waitcnt vmcnt(18)
    v_mfma_f32_16x16x32_bf16 v[96:99], a[204:207], v[228:231], v[96:99]
    v_and_b32 v215, 0x7fff, v255
    v_lshlrev_b32 v252, 16, v226
    v_mfma_f32_16x16x32_bf16 v[100:103], a[208:211], v[228:231], v[100:103]
    buffer_load_dwordx2 v[204:205], v215, s[4:7], s16 offen offset:768
    v_and_b32 v226, s22, v226
    v_mfma_f32_16x16x32_bf16 v[104:107], a[212:215], v[228:231], v[104:107]
    ds_read_b128 v[228:231], v253 offset:22880
    s_waitcnt lgkmcnt(2)
    v_mfma_f32_16x16x32_bf16 v[120:123], a[192:195], v[232:235], v[120:123]
    buffer_load_dwordx2 v[206:207], v215, s[4:7], s17 offen offset:768
    v_add_f32 v252, v252, v248
    v_mfma_f32_16x16x32_bf16 v[124:127], a[196:199], v[232:235], v[124:127]
    buffer_load_dwordx2 v[208:209], v215, s[4:7], s18 offen offset:768
    v_add_f32 v226, v226, v218
    v_mfma_f32_16x16x32_bf16 v[128:131], a[200:203], v[232:235], v[128:131]
    v_fmac_f32 v252, s23, v250
    v_mfma_f32_16x16x32_bf16 v[108:111], a[204:207], v[232:235], v[108:111]
    buffer_load_dwordx2 v[210:211], v215, s[4:7], s19 offen offset:768
    v_fmac_f32 v226, s23, v222
    v_mfma_f32_16x16x32_bf16 v[112:115], a[208:211], v[232:235], v[112:115]
    buffer_load_dwordx2 v[212:213], v215, s[4:7], s20 offen offset:768
    v_cvt_pk_bf16_f32 v226, v252, v226
    v_mfma_f32_16x16x32_bf16 v[116:119], a[212:215], v[232:235], v[116:119]
    v_fma_f32 v252, v249, s24, v251
    s_waitcnt vmcnt(20)
    v_mfma_f32_16x16x32_bf16 v[96:99], a[216:219], v[232:235], v[96:99]
    buffer_load_dwordx2 v[214:215], v215, s[4:7], s21 offen offset:768
    v_fmac_f32 v251, s25, v249
    v_mfma_f32_16x16x32_bf16 v[100:103], a[220:223], v[232:235], v[100:103]
    v_fma_f32 v249, v248, s24, v250
    v_fmac_f32 v250, s25, v248
    v_mfma_f32_16x16x32_bf16 v[104:107], a[224:227], v[232:235], v[104:107]
    ds_read_b128 v[232:235], v253 offset:24704
    s_waitcnt lgkmcnt(2)
    v_mfma_f32_16x16x32_bf16 v[132:135], a[192:195], v[236:239], v[132:135]
    v_fma_f32 v248, v250, s26, v251
    v_add_u32 v0, s51, v254
    ds_read_b128 a[96:99], v0 offset:8320
    v_mfma_f32_16x16x32_bf16 v[136:139], a[196:199], v[236:239], v[136:139]
    v_fmac_f32 v251, s27, v250
    v_fma_f32 v250, v249, s28, v252
    v_mfma_f32_16x16x32_bf16 v[140:143], a[200:203], v[236:239], v[140:143]
    v_fmac_f32 v252, s29, v249
    v_fma_f32 v249, v220, s24, v224
    v_mfma_f32_16x16x32_bf16 v[120:123], a[204:207], v[236:239], v[120:123]
    v_fmac_f32 v224, s25, v220
    v_fma_f32 v220, v218, s24, v222
    v_mfma_f32_16x16x32_bf16 v[124:127], a[208:211], v[236:239], v[124:127]
    v_fmac_f32 v222, s25, v218
    v_fma_f32 v218, v222, s26, v224
    v_mfma_f32_16x16x32_bf16 v[128:131], a[212:215], v[236:239], v[128:131]
    v_fmac_f32 v224, s27, v222
    ds_read_b128 a[100:103], v0 offset:9344
    ds_read_b128 a[104:107], v0 offset:10368
    v_mfma_f32_16x16x32_bf16 v[108:111], a[216:219], v[236:239], v[108:111]
    v_fma_f32 v222, v220, s28, v249
    v_fmac_f32 v249, s29, v220
    v_mfma_f32_16x16x32_bf16 v[112:115], a[220:223], v[236:239], v[112:115]
    v_cvt_pk_bf16_f32 v218, v248, v218
    v_cvt_pk_bf16_f32 v224, v251, v224
    v_mfma_f32_16x16x32_bf16 v[116:119], a[224:227], v[236:239], v[116:119]
    ds_read_b128 v[236:239], v253 offset:24448
    s_waitcnt lgkmcnt(5)
    v_mfma_f32_16x16x32_bf16 v[144:147], a[192:195], v[228:231], v[144:147]
    v_cvt_pk_bf16_f32 v222, v250, v222
    v_cvt_pk_bf16_f32 v220, v252, v249
    v_mfma_f32_16x16x32_bf16 v[148:151], a[196:199], v[228:231], v[148:151]
    v_lshlrev_b32 v248, 16, v219
    v_lshlrev_b32 v249, 16, v221
    ds_read_b128 a[108:111], v0 offset:11424
    v_mfma_f32_16x16x32_bf16 v[152:155], a[200:203], v[228:231], v[152:155]
    v_lshlrev_b32 v250, 16, v223
    s_add_u32 s44, s40, 0
    s_waitcnt lgkmcnt(4)
    buffer_store_dwordx4 a[96:99], v254, s[12:15], s44 offen offset:0
    v_mfma_f32_16x16x32_bf16 v[132:135], a[204:207], v[228:231], v[132:135]
    v_lshlrev_b32 v251, 16, v225
    v_and_b32 v219, s22, v219
    v_mfma_f32_16x16x32_bf16 v[136:139], a[208:211], v[228:231], v[136:139]
    v_and_b32 v221, s22, v221
    v_and_b32 v223, s22, v223
    v_mfma_f32_16x16x32_bf16 v[140:143], a[212:215], v[228:231], v[140:143]
    v_and_b32 v225, s22, v225
    v_lshlrev_b32 v252, 16, v217
    v_mfma_f32_16x16x32_bf16 v[120:123], a[216:219], v[228:231], v[120:123]
    v_and_b32 v217, s22, v217
    v_add_f32 v252, v252, v251
    v_mfma_f32_16x16x32_bf16 v[124:127], a[220:223], v[228:231], v[124:127]
    v_add_f32 v217, v217, v225
    ds_read_b128 a[112:115], v0 offset:12448
    v_mfma_f32_16x16x32_bf16 v[128:131], a[224:227], v[228:231], v[128:131]
    ds_read_b128 v[228:231], v253 offset:24192
    v_mfma_f32_16x16x32_bf16 v[156:159], a[192:195], v[232:235], v[156:159]
    v_fmac_f32 v252, s23, v249
    v_fmac_f32 v217, s23, v221
    v_mfma_f32_16x16x32_bf16 v[160:163], a[196:199], v[232:235], v[160:163]
    v_cvt_pk_bf16_f32 v217, v252, v217
    v_lshlrev_b32 v252, 16, v227
    v_mfma_f32_16x16x32_bf16 v[164:167], a[200:203], v[232:235], v[164:167]
    v_and_b32 v227, s22, v227
    v_add_f32 v252, v252, v248
    v_mfma_f32_16x16x32_bf16 v[144:147], a[204:207], v[232:235], v[144:147]
    v_add_f32 v227, v227, v219
    v_fmac_f32 v252, s23, v250
    s_waitcnt lgkmcnt(5)
    buffer_store_dwordx4 a[100:103], v254, s[12:15], s44 offen offset:1024
    v_mfma_f32_16x16x32_bf16 v[148:151], a[208:211], v[232:235], v[148:151]
    v_fmac_f32 v227, s23, v223
    v_cvt_pk_bf16_f32 v227, v252, v227
    v_mfma_f32_16x16x32_bf16 v[152:155], a[212:215], v[232:235], v[152:155]
    v_fma_f32 v252, v249, s24, v251
    ds_read_b128 a[116:119], v0 offset:13472
    v_mfma_f32_16x16x32_bf16 v[132:135], a[216:219], v[232:235], v[132:135]
    v_fmac_f32 v251, s25, v249
    v_fma_f32 v249, v248, s24, v250
    v_mfma_f32_16x16x32_bf16 v[136:139], a[220:223], v[232:235], v[136:139]
    v_fmac_f32 v250, s25, v248
    v_fma_f32 v248, v250, s26, v251
    v_mfma_f32_16x16x32_bf16 v[140:143], a[224:227], v[232:235], v[140:143]
    ds_read_b128 v[232:235], v253 offset:23936
    s_waitcnt lgkmcnt(6)
    buffer_store_dwordx4 a[104:107], v254, s[12:15], s44 offen offset:2048
    s_waitcnt lgkmcnt(5)
    v_mfma_f32_16x16x32_bf16 v[168:171], a[192:195], v[236:239], v[168:171]
    v_fmac_f32 v251, s27, v250
    v_fma_f32 v250, v249, s28, v252
    v_mfma_f32_16x16x32_bf16 v[172:175], a[196:199], v[236:239], v[172:175]
    v_fmac_f32 v252, s29, v249
    v_fma_f32 v249, v221, s24, v225
    v_mfma_f32_16x16x32_bf16 v[176:179], a[200:203], v[236:239], v[176:179]
    v_fmac_f32 v225, s25, v221
    ds_read_b128 a[120:123], v0 offset:14528
    v_mfma_f32_16x16x32_bf16 v[156:159], a[204:207], v[236:239], v[156:159]
    v_fma_f32 v221, v219, s24, v223
    v_fmac_f32 v223, s25, v219
    v_mfma_f32_16x16x32_bf16 v[160:163], a[208:211], v[236:239], v[160:163]
    v_fma_f32 v219, v223, s26, v225
    v_fmac_f32 v225, s27, v223
    s_add_u32 s44, s40, 3072
    s_waitcnt lgkmcnt(5)
    buffer_store_dwordx4 a[108:111], v254, s[12:15], s44 offen offset:0
    v_mfma_f32_16x16x32_bf16 v[164:167], a[212:215], v[236:239], v[164:167]
    v_fma_f32 v223, v221, s28, v249
    v_fmac_f32 v249, s29, v221
    v_mfma_f32_16x16x32_bf16 v[144:147], a[216:219], v[236:239], v[144:147]
    v_cvt_pk_bf16_f32 v219, v248, v219
    v_cvt_pk_bf16_f32 v225, v251, v225
    v_mfma_f32_16x16x32_bf16 v[148:151], a[220:223], v[236:239], v[148:151]
    v_cvt_pk_bf16_f32 v223, v250, v223
    v_mfma_f32_16x16x32_bf16 v[152:155], a[224:227], v[236:239], v[152:155]
    ds_read_b128 v[236:239], v253 offset:23664
    s_waitcnt lgkmcnt(4)
    v_mfma_f32_16x16x32_bf16 v[180:183], a[192:195], v[228:231], v[180:183]
    v_cvt_pk_bf16_f32 v221, v252, v249
    v_lshrrev_b32 v252, 15, v255
    ds_read_b128 a[124:127], v0 offset:15552
    v_mfma_f32_16x16x32_bf16 v[184:187], a[196:199], v[228:231], v[184:187]
    ds_write_b64 v252, v[218:219] offset:768
    ds_write_b64 v252, v[224:225] offset:2848
    v_mfma_f32_16x16x32_bf16 v[188:191], a[200:203], v[228:231], v[188:191]
    ds_write_b64 v252, v[222:223] offset:4928
    ds_write_b64 v252, v[216:217] offset:34048
    v_mfma_f32_16x16x32_bf16 v[168:171], a[204:207], v[228:231], v[168:171]
    s_mov_b32 s42, 1253376
    buffer_load_dwordx4 a[192:195], v254, s[8:11], s42 offen offset:0
    v_mfma_f32_16x16x32_bf16 v[172:175], a[208:211], v[228:231], v[172:175]
    ds_write_b64 v252, v[226:227] offset:38208
    ds_write_b64 v252, v[220:221] offset:7008
    v_mfma_f32_16x16x32_bf16 v[176:179], a[212:215], v[228:231], v[176:179]
    buffer_load_dwordx4 a[196:199], v254, s[8:11], s42 offen offset:1024
    buffer_store_dwordx4 a[112:115], v254, s[12:15], s44 offen offset:1024
    v_mfma_f32_16x16x32_bf16 v[156:159], a[216:219], v[228:231], v[156:159]
    ds_read_b128 a[128:131], v0 offset:16576
    s_waitcnt lgkmcnt(11)
    buffer_store_dwordx4 a[116:119], v254, s[12:15], s44 offen offset:2048
    ds_read_b128 a[132:135], v0 offset:17632
    v_mfma_f32_16x16x32_bf16 v[160:163], a[220:223], v[228:231], v[160:163]
    buffer_load_dwordx4 a[200:203], v254, s[8:11], s42 offen offset:2048
    s_add_u32 s44, s40, 6144
    s_waitcnt lgkmcnt(10)
    buffer_store_dwordx4 a[120:123], v254, s[12:15], s44 offen offset:0
    v_mfma_f32_16x16x32_bf16 v[164:167], a[224:227], v[228:231], v[164:167]
    ds_read_b128 v[228:231], v253 offset:26000
    v_mfma_f32_16x16x32_bf16 v[180:183], a[204:207], v[232:235], v[180:183]
    s_waitcnt vmcnt(25)
    v_lshlrev_b32 v248, 16, v194
    v_lshlrev_b32 v249, 16, v196
    v_lshlrev_b32 v250, 16, v198
    v_mfma_f32_16x16x32_bf16 v[184:187], a[208:211], v[232:235], v[184:187]
    v_lshlrev_b32 v251, 16, v200
    v_and_b32 v194, s22, v194
    v_mfma_f32_16x16x32_bf16 v[188:191], a[212:215], v[232:235], v[188:191]
    s_mov_b32 s42, 1256448
    buffer_load_dwordx4 a[204:207], v254, s[8:11], s42 offen offset:0
    v_mfma_f32_16x16x32_bf16 v[168:171], a[216:219], v[232:235], v[168:171]
    v_and_b32 v196, s22, v196
    v_and_b32 v198, s22, v198
    v_mfma_f32_16x16x32_bf16 v[172:175], a[220:223], v[232:235], v[172:175]
    buffer_load_dwordx4 a[208:211], v254, s[8:11], s42 offen offset:1024
    v_and_b32 v200, s22, v200
    v_mfma_f32_16x16x32_bf16 v[176:179], a[224:227], v[232:235], v[176:179]
    ds_read_b128 v[232:235], v253 offset:25728
    s_waitcnt lgkmcnt(11)
    v_mfma_f32_16x16x32_bf16 v[180:183], a[216:219], v[236:239], v[180:183]
    buffer_load_dwordx4 a[212:215], v254, s[8:11], s42 offen offset:2048
    v_lshlrev_b32 v252, 16, v192
    v_mfma_f32_16x16x32_bf16 v[184:187], a[220:223], v[236:239], v[184:187]
    v_and_b32 v192, s22, v192
    v_add_f32 v252, v252, v251
    v_mfma_f32_16x16x32_bf16 v[188:191], a[224:227], v[236:239], v[188:191]
    ds_read_b128 v[236:239], v253 offset:25472
    s_mov_b32 s42, 1259520
    buffer_load_dwordx4 a[216:219], v254, s[8:11], s42 offen offset:0
    s_waitcnt vmcnt(26) lgkmcnt(2)
    v_mfma_f32_16x16x32_bf16 v[96:99], a[228:231], v[228:231], v[96:99]
    v_add_f32 v192, v192, v200
    v_fmac_f32 v252, s23, v249
    v_fmac_f32 v192, s23, v196
    v_mfma_f32_16x16x32_bf16 v[100:103], a[232:235], v[228:231], v[100:103]
    buffer_load_dwordx4 a[220:223], v254, s[8:11], s42 offen offset:1024
    v_cvt_pk_bf16_f32 v192, v252, v192
    ds_read_b128 a[136:139], v0 offset:18656
    v_mfma_f32_16x16x32_bf16 v[104:107], a[236:239], v[228:231], v[104:107]
    ds_read_b128 v[228:231], v253 offset:25216
    s_waitcnt lgkmcnt(3)
    v_mfma_f32_16x16x32_bf16 v[108:111], a[228:231], v[232:235], v[108:111]
    buffer_load_dwordx4 a[224:227], v254, s[8:11], s42 offen offset:2048
    v_lshlrev_b32 v252, 16, v202
    v_mfma_f32_16x16x32_bf16 v[112:115], a[232:235], v[232:235], v[112:115]
    v_and_b32 v202, s22, v202
    v_add_f32 v252, v252, v248
    v_mfma_f32_16x16x32_bf16 v[116:119], a[236:239], v[232:235], v[116:119]
    v_add_f32 v202, v202, v194
    s_waitcnt vmcnt(25)
    v_mfma_f32_16x16x32_bf16 v[96:99], a[240:243], v[232:235], v[96:99]
    v_and_b32 v227, 0x7fff, v255
    v_fmac_f32 v252, s23, v250
    v_mfma_f32_16x16x32_bf16 v[100:103], a[244:247], v[232:235], v[100:103]
    buffer_load_dwordx2 v[216:217], v227, s[4:7], s16 offen offset:1152
    v_fmac_f32 v202, s23, v198
    buffer_store_dwordx4 a[124:127], v254, s[12:15], s44 offen offset:1024
    v_mfma_f32_16x16x32_bf16 v[104:107], a[248:251], v[232:235], v[104:107]
    ds_read_b128 v[232:235], v253 offset:24960
    s_waitcnt lgkmcnt(3)
    v_mfma_f32_16x16x32_bf16 v[120:123], a[228:231], v[236:239], v[120:123]
    buffer_load_dwordx2 v[218:219], v227, s[4:7], s17 offen offset:1152
    v_cvt_pk_bf16_f32 v202, v252, v202
    v_fma_f32 v252, v249, s24, v251
    v_mfma_f32_16x16x32_bf16 v[124:127], a[232:235], v[236:239], v[124:127]
    buffer_load_dwordx2 v[220:221], v227, s[4:7], s18 offen offset:1152
    v_fmac_f32 v251, s25, v249
    v_mfma_f32_16x16x32_bf16 v[128:131], a[236:239], v[236:239], v[128:131]
    v_fma_f32 v249, v248, s24, v250
    v_fmac_f32 v250, s25, v248
    v_mfma_f32_16x16x32_bf16 v[108:111], a[240:243], v[236:239], v[108:111]
    buffer_load_dwordx2 v[222:223], v227, s[4:7], s19 offen offset:1152
    v_fma_f32 v248, v250, s26, v251
    v_mfma_f32_16x16x32_bf16 v[112:115], a[244:247], v[236:239], v[112:115]
    buffer_load_dwordx2 v[224:225], v227, s[4:7], s20 offen offset:1152
    v_fmac_f32 v251, s27, v250
    ds_read_b128 a[140:143], v0 offset:19680
    v_mfma_f32_16x16x32_bf16 v[116:119], a[248:251], v[236:239], v[116:119]
    v_fma_f32 v250, v249, s28, v252
    s_waitcnt vmcnt(28)
    v_mfma_f32_16x16x32_bf16 v[96:99], a[252:255], v[236:239], v[96:99]
    buffer_load_dwordx2 v[226:227], v227, s[4:7], s21 offen offset:1152
    v_fmac_f32 v252, s29, v249
    v_mfma_f32_16x16x32_bf16 v[100:103], v[240:243], v[236:239], v[100:103]
    v_fma_f32 v249, v196, s24, v200
    v_fmac_f32 v200, s25, v196
    v_mfma_f32_16x16x32_bf16 v[104:107], v[244:247], v[236:239], v[104:107]
    ds_read_b128 v[236:239], v253 offset:26784
    v_fma_f32 v196, v194, s24, v198
    s_waitcnt lgkmcnt(3)
    v_mfma_f32_16x16x32_bf16 v[132:135], a[228:231], v[228:231], v[132:135]
    v_fmac_f32 v198, s25, v194
    v_fma_f32 v194, v198, s26, v200
    v_mfma_f32_16x16x32_bf16 v[136:139], a[232:235], v[228:231], v[136:139]
    v_fmac_f32 v200, s27, v198
    v_fma_f32 v198, v196, s28, v249
    buffer_store_dwordx4 a[128:131], v254, s[12:15], s44 offen offset:2048
    v_mfma_f32_16x16x32_bf16 v[140:143], a[236:239], v[228:231], v[140:143]
    v_fmac_f32 v249, s29, v196
    v_cvt_pk_bf16_f32 v194, v248, v194
    v_mfma_f32_16x16x32_bf16 v[120:123], a[240:243], v[228:231], v[120:123]
    v_cvt_pk_bf16_f32 v200, v251, v200
    v_cvt_pk_bf16_f32 v198, v250, v198
    v_mfma_f32_16x16x32_bf16 v[124:127], a[244:247], v[228:231], v[124:127]
    v_cvt_pk_bf16_f32 v196, v252, v249
    v_lshlrev_b32 v248, 16, v195
    v_mfma_f32_16x16x32_bf16 v[128:131], a[248:251], v[228:231], v[128:131]
    v_lshlrev_b32 v249, 16, v197
    v_lshlrev_b32 v250, 16, v199
    v_mfma_f32_16x16x32_bf16 v[108:111], a[252:255], v[228:231], v[108:111]
    v_lshlrev_b32 v251, 16, v201
    v_and_b32 v195, s22, v195
    s_add_u32 s44, s40, 9216
    buffer_store_dwordx4 a[132:135], v254, s[12:15], s44 offen offset:0
    v_mfma_f32_16x16x32_bf16 v[112:115], v[240:243], v[228:231], v[112:115]
    v_and_b32 v197, s22, v197
    v_and_b32 v199, s22, v199
    v_mfma_f32_16x16x32_bf16 v[116:119], v[244:247], v[228:231], v[116:119]
    ds_read_b128 v[228:231], v253 offset:26528
    v_and_b32 v201, s22, v201
    s_waitcnt lgkmcnt(3)
    v_mfma_f32_16x16x32_bf16 v[144:147], a[228:231], v[232:235], v[144:147]
    v_lshlrev_b32 v252, 16, v193
    v_and_b32 v193, s22, v193
    v_mfma_f32_16x16x32_bf16 v[148:151], a[232:235], v[232:235], v[148:151]
    v_add_f32 v252, v252, v251
    v_add_f32 v193, v193, v201
    v_mfma_f32_16x16x32_bf16 v[152:155], a[236:239], v[232:235], v[152:155]
    v_fmac_f32 v252, s23, v249
    v_fmac_f32 v193, s23, v197
    v_mfma_f32_16x16x32_bf16 v[132:135], a[240:243], v[232:235], v[132:135]
    v_cvt_pk_bf16_f32 v193, v252, v193
    v_lshlrev_b32 v252, 16, v203
    v_mfma_f32_16x16x32_bf16 v[136:139], a[244:247], v[232:235], v[136:139]
    v_and_b32 v203, s22, v203
    v_add_f32 v252, v252, v248
    v_mfma_f32_16x16x32_bf16 v[140:143], a[248:251], v[232:235], v[140:143]
    v_add_f32 v203, v203, v195
    v_fmac_f32 v252, s23, v250
    v_mfma_f32_16x16x32_bf16 v[120:123], a[252:255], v[232:235], v[120:123]
    v_fmac_f32 v203, s23, v199
    v_cvt_pk_bf16_f32 v203, v252, v203
    v_mfma_f32_16x16x32_bf16 v[124:127], v[240:243], v[232:235], v[124:127]
    v_fma_f32 v252, v249, s24, v251
    v_fmac_f32 v251, s25, v249
    v_fma_f32 v249, v248, s24, v250
    v_mfma_f32_16x16x32_bf16 v[128:131], v[244:247], v[232:235], v[128:131]
    ds_read_b128 v[232:235], v253 offset:26272
    s_waitcnt lgkmcnt(2)
    v_mfma_f32_16x16x32_bf16 v[156:159], a[228:231], v[236:239], v[156:159]
    v_fmac_f32 v250, s25, v248
    v_fma_f32 v248, v250, s26, v251
    v_mfma_f32_16x16x32_bf16 v[160:163], a[232:235], v[236:239], v[160:163]
    v_fmac_f32 v251, s27, v250
    v_fma_f32 v250, v249, s28, v252
    buffer_store_dwordx4 a[136:139], v254, s[12:15], s44 offen offset:1024
    v_mfma_f32_16x16x32_bf16 v[164:167], a[236:239], v[236:239], v[164:167]
    v_fmac_f32 v252, s29, v249
    v_fma_f32 v249, v197, s24, v201
    v_mfma_f32_16x16x32_bf16 v[144:147], a[240:243], v[236:239], v[144:147]
    v_fmac_f32 v201, s25, v197
    v_fma_f32 v197, v195, s24, v199
    v_mfma_f32_16x16x32_bf16 v[148:151], a[244:247], v[236:239], v[148:151]
    v_fmac_f32 v199, s25, v195
    v_fma_f32 v195, v199, s26, v201
    v_mfma_f32_16x16x32_bf16 v[152:155], a[248:251], v[236:239], v[152:155]
    v_fmac_f32 v201, s27, v199
    v_fma_f32 v199, v197, s28, v249
    v_mfma_f32_16x16x32_bf16 v[132:135], a[252:255], v[236:239], v[132:135]
    v_fmac_f32 v249, s29, v197
    v_cvt_pk_bf16_f32 v195, v248, v195
    buffer_store_dwordx4 a[140:143], v254, s[12:15], s44 offen offset:2048
    v_mfma_f32_16x16x32_bf16 v[136:139], v[240:243], v[236:239], v[136:139]
    v_cvt_pk_bf16_f32 v201, v251, v201
    v_cvt_pk_bf16_f32 v199, v250, v199
    v_cvt_pk_bf16_f32 v197, v252, v249
    v_mfma_f32_16x16x32_bf16 v[140:143], v[244:247], v[236:239], v[140:143]
    ds_read_b128 v[236:239], v253 offset:26016
    s_waitcnt lgkmcnt(2)
    v_mfma_f32_16x16x32_bf16 v[168:171], a[228:231], v[228:231], v[168:171]
    v_lshrrev_b32 v252, 15, v255
    ds_read_b128 v[248:251], v253 offset:39520
    v_mfma_f32_16x16x32_bf16 v[172:175], a[232:235], v[228:231], v[172:175]
    ds_write_b64 v252, v[194:195] offset:512
    ds_write_b64 v252, v[200:201] offset:2592
    v_mfma_f32_16x16x32_bf16 v[176:179], a[236:239], v[228:231], v[176:179]
    ds_write_b64 v252, v[198:199] offset:4672
    ds_write_b64 v252, v[192:193] offset:33792
    v_mfma_f32_16x16x32_bf16 v[156:159], a[240:243], v[228:231], v[156:159]
    ds_write_b64 v252, v[202:203] offset:37952
    ds_write_b64 v252, v[196:197] offset:6752
    v_mfma_f32_16x16x32_bf16 v[160:163], a[244:247], v[228:231], v[160:163]
    s_waitcnt lgkmcnt(6)
    s_lshl_b64 exec, s[46:47], 0
    ds_write_b128 v253, v[248:251] offset:34304
    s_mov_b64 exec, -1
    v_mfma_f32_16x16x32_bf16 v[164:167], a[248:251], v[228:231], v[164:167]
    s_lshl_b64 exec, s[46:47], 2
    ds_write_b128 v253, v[248:251] offset:992
    s_mov_b64 exec, -1
    v_mfma_f32_16x16x32_bf16 v[144:147], a[252:255], v[228:231], v[144:147]
    s_lshl_b64 exec, s[46:47], 4
    ds_write_b128 v253, v[248:251] offset:3040
    s_mov_b64 exec, -1
    v_mfma_f32_16x16x32_bf16 v[148:151], v[240:243], v[228:231], v[148:151]
    v_mfma_f32_16x16x32_bf16 v[152:155], v[244:247], v[228:231], v[152:155]
    ds_read_b128 v[228:231], v253 offset:25744
    v_mfma_f32_16x16x32_bf16 v[180:183], a[228:231], v[232:235], v[180:183]
    s_lshl_b64 exec, s[46:47], 6
    ds_write_b128 v253, v[248:251] offset:5088
    s_mov_b64 exec, -1
    v_mfma_f32_16x16x32_bf16 v[184:187], a[232:235], v[232:235], v[184:187]
    s_lshl_b64 exec, s[46:47], 8
    ds_write_b128 v253, v[248:251] offset:7136
    s_mov_b64 exec, -1
    v_mfma_f32_16x16x32_bf16 v[188:191], a[236:239], v[232:235], v[188:191]
    v_mfma_f32_16x16x32_bf16 v[168:171], a[240:243], v[232:235], v[168:171]
    s_mov_b32 s42, 1290240
    buffer_load_dwordx4 a[228:231], v254, s[8:11], s42 offen offset:0
    v_mfma_f32_16x16x32_bf16 v[172:175], a[244:247], v[232:235], v[172:175]
    s_lshl_b64 exec, s[46:47], 10
    ds_write_b128 v253, v[248:251] offset:38304
    s_mov_b64 exec, -1
    v_mfma_f32_16x16x32_bf16 v[176:179], a[248:251], v[232:235], v[176:179]
    buffer_load_dwordx4 a[232:235], v254, s[8:11], s42 offen offset:1024
    v_mfma_f32_16x16x32_bf16 v[156:159], a[252:255], v[232:235], v[156:159]
    v_mfma_f32_16x16x32_bf16 v[160:163], v[240:243], v[232:235], v[160:163]
    buffer_load_dwordx4 a[236:239], v254, s[8:11], s42 offen offset:2048
    v_mfma_f32_16x16x32_bf16 v[164:167], v[244:247], v[232:235], v[164:167]
    ds_read_b128 v[232:235], v253 offset:28080
    v_mfma_f32_16x16x32_bf16 v[180:183], a[240:243], v[236:239], v[180:183]
    s_waitcnt vmcnt(30)
    v_lshlrev_b32 v248, 16, v206
    v_lshlrev_b32 v249, 16, v208
    v_mfma_f32_16x16x32_bf16 v[184:187], a[244:247], v[236:239], v[184:187]
    v_lshlrev_b32 v250, 16, v210
    v_lshlrev_b32 v251, 16, v212
    v_mfma_f32_16x16x32_bf16 v[188:191], a[248:251], v[236:239], v[188:191]
    s_mov_b32 s42, 1293312
    buffer_load_dwordx4 a[240:243], v254, s[8:11], s42 offen offset:0
    v_mfma_f32_16x16x32_bf16 v[168:171], a[252:255], v[236:239], v[168:171]
    v_and_b32 v206, s22, v206
    v_and_b32 v208, s22, v208
    v_mfma_f32_16x16x32_bf16 v[172:175], v[240:243], v[236:239], v[172:175]
    buffer_load_dwordx4 a[244:247], v254, s[8:11], s42 offen offset:1024
    v_and_b32 v210, s22, v210
    v_mfma_f32_16x16x32_bf16 v[176:179], v[244:247], v[236:239], v[176:179]
    ds_read_b128 v[236:239], v253 offset:27808
    s_waitcnt lgkmcnt(5)
    v_mfma_f32_16x16x32_bf16 v[180:183], a[252:255], v[228:231], v[180:183]
    buffer_load_dwordx4 a[248:251], v254, s[8:11], s42 offen offset:2048
    v_and_b32 v212, s22, v212
    v_mfma_f32_16x16x32_bf16 v[184:187], v[240:243], v[228:231], v[184:187]
    v_lshlrev_b32 v252, 16, v204
    v_mfma_f32_16x16x32_bf16 v[188:191], v[244:247], v[228:231], v[188:191]
    ds_read_b128 v[228:231], v253 offset:27552
    s_mov_b32 s42, 1296384
    buffer_load_dwordx4 a[252:255], v254, s[8:11], s42 offen offset:0
    s_waitcnt vmcnt(25) lgkmcnt(2)
    v_mfma_f32_16x16x32_bf16 v[96:99], a[192:195], v[232:235], v[96:99]
    v_and_b32 v204, s22, v204
    v_add_f32 v252, v252, v251
    v_mfma_f32_16x16x32_bf16 v[100:103], a[196:199], v[232:235], v[100:103]
    buffer_load_dwordx4 v[240:243], v254, s[8:11], s42 offen offset:1024
    v_add_f32 v204, v204, v212
    v_mfma_f32_16x16x32_bf16 v[104:107], a[200:203], v[232:235], v[104:107]
    ds_read_b128 v[232:235], v253 offset:27296
    s_waitcnt lgkmcnt(2)
    v_mfma_f32_16x16x32_bf16 v[108:111], a[192:195], v[236:239], v[108:111]
    buffer_load_dwordx4 v[244:247], v254, s[8:11], s42 offen offset:2048
    v_fmac_f32 v252, s23, v249
    v_mfma_f32_16x16x32_bf16 v[112:115], a[196:199], v[236:239], v[112:115]
    v_fmac_f32 v204, s23, v208
    v_cvt_pk_bf16_f32 v204, v252, v204
    v_mfma_f32_16x16x32_bf16 v[116:119], a[200:203], v[236:239], v[116:119]
    s_waitcnt vmcnt(23)
    v_mfma_f32_16x16x32_bf16 v[96:99], a[204:207], v[236:239], v[96:99]
    v_and_b32 v203, 0x7fff, v255
    v_lshlrev_b32 v252, 16, v214
    v_mfma_f32_16x16x32_bf16 v[100:103], a[208:211], v[236:239], v[100:103]
    buffer_load_dwordx2 v[192:193], v203, s[4:7], s16 offen offset:64
    v_and_b32 v214, s22, v214
    v_mfma_f32_16x16x32_bf16 v[104:107], a[212:215], v[236:239], v[104:107]
    ds_read_b128 v[236:239], v253 offset:27040
    s_waitcnt lgkmcnt(2)
    v_mfma_f32_16x16x32_bf16 v[120:123], a[192:195], v[228:231], v[120:123]
    buffer_load_dwordx2 v[194:195], v203, s[4:7], s17 offen offset:64
    v_add_f32 v252, v252, v248
    v_mfma_f32_16x16x32_bf16 v[124:127], a[196:199], v[228:231], v[124:127]
    buffer_load_dwordx2 v[196:197], v203, s[4:7], s18 offen offset:64
    v_add_f32 v214, v214, v206
    v_mfma_f32_16x16x32_bf16 v[128:131], a[200:203], v[228:231], v[128:131]
    v_fmac_f32 v252, s23, v250
    v_mfma_f32_16x16x32_bf16 v[108:111], a[204:207], v[228:231], v[108:111]
    buffer_load_dwordx2 v[198:199], v203, s[4:7], s19 offen offset:64
    v_fmac_f32 v214, s23, v210
    v_mfma_f32_16x16x32_bf16 v[112:115], a[208:211], v[228:231], v[112:115]
    buffer_load_dwordx2 v[200:201], v203, s[4:7], s20 offen offset:64
    v_cvt_pk_bf16_f32 v214, v252, v214
    v_mfma_f32_16x16x32_bf16 v[116:119], a[212:215], v[228:231], v[116:119]
    v_fma_f32 v252, v249, s24, v251
    s_waitcnt vmcnt(25)
    v_mfma_f32_16x16x32_bf16 v[96:99], a[216:219], v[228:231], v[96:99]
    buffer_load_dwordx2 v[202:203], v203, s[4:7], s21 offen offset:64
    v_fmac_f32 v251, s25, v249
    v_mfma_f32_16x16x32_bf16 v[100:103], a[220:223], v[228:231], v[100:103]
    v_fma_f32 v249, v248, s24, v250
    v_fmac_f32 v250, s25, v248
    v_mfma_f32_16x16x32_bf16 v[104:107], a[224:227], v[228:231], v[104:107]
    ds_read_b128 v[228:231], v253 offset:28864
    s_waitcnt lgkmcnt(2)
    v_mfma_f32_16x16x32_bf16 v[132:135], a[192:195], v[232:235], v[132:135]
    v_fma_f32 v248, v250, s26, v251
    v_mfma_f32_16x16x32_bf16 v[136:139], a[196:199], v[232:235], v[136:139]
    v_fmac_f32 v251, s27, v250
    v_fma_f32 v250, v249, s28, v252
    v_mfma_f32_16x16x32_bf16 v[140:143], a[200:203], v[232:235], v[140:143]
    v_fmac_f32 v252, s29, v249
    v_fma_f32 v249, v208, s24, v212
    v_mfma_f32_16x16x32_bf16 v[120:123], a[204:207], v[232:235], v[120:123]
    v_fmac_f32 v212, s25, v208
    v_fma_f32 v208, v206, s24, v210
    v_mfma_f32_16x16x32_bf16 v[124:127], a[208:211], v[232:235], v[124:127]
    v_fmac_f32 v210, s25, v206
    v_fma_f32 v206, v210, s26, v212
    v_mfma_f32_16x16x32_bf16 v[128:131], a[212:215], v[232:235], v[128:131]
    v_fmac_f32 v212, s27, v210
    v_mfma_f32_16x16x32_bf16 v[108:111], a[216:219], v[232:235], v[108:111]
    v_fma_f32 v210, v208, s28, v249
    v_fmac_f32 v249, s29, v208
    v_mfma_f32_16x16x32_bf16 v[112:115], a[220:223], v[232:235], v[112:115]
    v_cvt_pk_bf16_f32 v206, v248, v206
    v_cvt_pk_bf16_f32 v212, v251, v212
    v_mfma_f32_16x16x32_bf16 v[116:119], a[224:227], v[232:235], v[116:119]
    ds_read_b128 v[232:235], v253 offset:28608
    s_waitcnt lgkmcnt(2)
    v_mfma_f32_16x16x32_bf16 v[144:147], a[192:195], v[236:239], v[144:147]
    v_cvt_pk_bf16_f32 v210, v250, v210
    v_cvt_pk_bf16_f32 v208, v252, v249
    v_mfma_f32_16x16x32_bf16 v[148:151], a[196:199], v[236:239], v[148:151]
    v_lshlrev_b32 v248, 16, v207
    v_lshlrev_b32 v249, 16, v209
    v_mfma_f32_16x16x32_bf16 v[152:155], a[200:203], v[236:239], v[152:155]
    v_lshlrev_b32 v250, 16, v211
    v_mfma_f32_16x16x32_bf16 v[132:135], a[204:207], v[236:239], v[132:135]
    v_lshlrev_b32 v251, 16, v213
    v_and_b32 v207, s22, v207
    v_mfma_f32_16x16x32_bf16 v[136:139], a[208:211], v[236:239], v[136:139]
    v_and_b32 v209, s22, v209
    v_and_b32 v211, s22, v211
    v_mfma_f32_16x16x32_bf16 v[140:143], a[212:215], v[236:239], v[140:143]
    v_and_b32 v213, s22, v213
    v_lshlrev_b32 v252, 16, v205
    v_mfma_f32_16x16x32_bf16 v[120:123], a[216:219], v[236:239], v[120:123]
    v_and_b32 v205, s22, v205
    v_add_f32 v252, v252, v251
    v_mfma_f32_16x16x32_bf16 v[124:127], a[220:223], v[236:239], v[124:127]
    v_add_f32 v205, v205, v213
    v_mfma_f32_16x16x32_bf16 v[128:131], a[224:227], v[236:239], v[128:131]
    ds_read_b128 v[236:239], v253 offset:28352
    s_waitcnt lgkmcnt(2)
    v_mfma_f32_16x16x32_bf16 v[156:159], a[192:195], v[228:231], v[156:159]
    v_fmac_f32 v252, s23, v249
    v_fmac_f32 v205, s23, v209
    v_mfma_f32_16x16x32_bf16 v[160:163], a[196:199], v[228:231], v[160:163]
    v_cvt_pk_bf16_f32 v205, v252, v205
    v_lshlrev_b32 v252, 16, v215
    v_mfma_f32_16x16x32_bf16 v[164:167], a[200:203], v[228:231], v[164:167]
    v_and_b32 v215, s22, v215
    v_add_f32 v252, v252, v248
    v_mfma_f32_16x16x32_bf16 v[144:147], a[204:207], v[228:231], v[144:147]
    v_add_f32 v215, v215, v207
    v_fmac_f32 v252, s23, v250
    v_mfma_f32_16x16x32_bf16 v[148:151], a[208:211], v[228:231], v[148:151]
    v_fmac_f32 v215, s23, v211
    v_cvt_pk_bf16_f32 v215, v252, v215
    v_mfma_f32_16x16x32_bf16 v[152:155], a[212:215], v[228:231], v[152:155]
    v_fma_f32 v252, v249, s24, v251
    v_mfma_f32_16x16x32_bf16 v[132:135], a[216:219], v[228:231], v[132:135]
    v_fmac_f32 v251, s25, v249
    v_fma_f32 v249, v248, s24, v250
    v_mfma_f32_16x16x32_bf16 v[136:139], a[220:223], v[228:231], v[136:139]
    v_fmac_f32 v250, s25, v248
    v_fma_f32 v248, v250, s26, v251
    v_mfma_f32_16x16x32_bf16 v[140:143], a[224:227], v[228:231], v[140:143]
    ds_read_b128 v[228:231], v253 offset:28096
    s_waitcnt lgkmcnt(2)
    v_mfma_f32_16x16x32_bf16 v[168:171], a[192:195], v[232:235], v[168:171]
    v_fmac_f32 v251, s27, v250
    v_fma_f32 v250, v249, s28, v252
    v_mfma_f32_16x16x32_bf16 v[172:175], a[196:199], v[232:235], v[172:175]
    v_fmac_f32 v252, s29, v249
    v_fma_f32 v249, v209, s24, v213
    v_mfma_f32_16x16x32_bf16 v[176:179], a[200:203], v[232:235], v[176:179]
    v_fmac_f32 v213, s25, v209
    v_mfma_f32_16x16x32_bf16 v[156:159], a[204:207], v[232:235], v[156:159]
    v_fma_f32 v209, v207, s24, v211
    v_fmac_f32 v211, s25, v207
    v_mfma_f32_16x16x32_bf16 v[160:163], a[208:211], v[232:235], v[160:163]
    v_fma_f32 v207, v211, s26, v213
    v_fmac_f32 v213, s27, v211
    v_mfma_f32_16x16x32_bf16 v[164:167], a[212:215], v[232:235], v[164:167]
    v_fma_f32 v211, v209, s28, v249
    v_fmac_f32 v249, s29, v209
    v_mfma_f32_16x16x32_bf16 v[144:147], a[216:219], v[232:235], v[144:147]
    v_cvt_pk_bf16_f32 v207, v248, v207
    v_cvt_pk_bf16_f32 v213, v251, v213
    v_mfma_f32_16x16x32_bf16 v[148:151], a[220:223], v[232:235], v[148:151]
    v_cvt_pk_bf16_f32 v211, v250, v211
    v_mfma_f32_16x16x32_bf16 v[152:155], a[224:227], v[232:235], v[152:155]
    ds_read_b128 v[232:235], v253 offset:27824
    s_waitcnt lgkmcnt(2)
    v_mfma_f32_16x16x32_bf16 v[180:183], a[192:195], v[236:239], v[180:183]
    v_cvt_pk_bf16_f32 v209, v252, v249
    v_lshrrev_b32 v252, 15, v255
    v_mfma_f32_16x16x32_bf16 v[184:187], a[196:199], v[236:239], v[184:187]
    ds_write_b64 v252, v[206:207] offset:256
    ds_write_b64 v252, v[212:213] offset:2336
    v_mfma_f32_16x16x32_bf16 v[188:191], a[200:203], v[236:239], v[188:191]
    ds_write_b64 v252, v[210:211] offset:4416
    ds_write_b64 v252, v[204:205] offset:33536
    v_mfma_f32_16x16x32_bf16 v[168:171], a[204:207], v[236:239], v[168:171]
    s_mov_b32 s42, 0
    buffer_load_dwordx4 a[192:195], v254, s[8:11], s42 offen offset:0
    v_mfma_f32_16x16x32_bf16 v[172:175], a[208:211], v[236:239], v[172:175]
    ds_write_b64 v252, v[214:215] offset:37696
    ds_write_b64 v252, v[208:209] offset:6496
    v_mfma_f32_16x16x32_bf16 v[176:179], a[212:215], v[236:239], v[176:179]
    buffer_load_dwordx4 a[196:199], v254, s[8:11], s42 offen offset:1024
    v_mfma_f32_16x16x32_bf16 v[156:159], a[216:219], v[236:239], v[156:159]
    v_mfma_f32_16x16x32_bf16 v[160:163], a[220:223], v[236:239], v[160:163]
    buffer_load_dwordx4 a[200:203], v254, s[8:11], s42 offen offset:2048
    v_mfma_f32_16x16x32_bf16 v[164:167], a[224:227], v[236:239], v[164:167]
    ds_read_b128 v[236:239], v253 offset:30160
    s_waitcnt lgkmcnt(8)
    v_mfma_f32_16x16x32_bf16 v[180:183], a[204:207], v[228:231], v[180:183]
    s_waitcnt vmcnt(22)
    v_lshlrev_b32 v248, 16, v218
    v_lshlrev_b32 v249, 16, v220
    v_mfma_f32_16x16x32_bf16 v[184:187], a[208:211], v[228:231], v[184:187]
    v_lshlrev_b32 v250, 16, v222
    v_lshlrev_b32 v251, 16, v224
    v_mfma_f32_16x16x32_bf16 v[188:191], a[212:215], v[228:231], v[188:191]
    s_mov_b32 s42, 3072
    buffer_load_dwordx4 a[204:207], v254, s[8:11], s42 offen offset:0
    v_mfma_f32_16x16x32_bf16 v[168:171], a[216:219], v[228:231], v[168:171]
    v_and_b32 v218, s22, v218
    v_and_b32 v220, s22, v220
    v_mfma_f32_16x16x32_bf16 v[172:175], a[220:223], v[228:231], v[172:175]
    buffer_load_dwordx4 a[208:211], v254, s[8:11], s42 offen offset:1024
    v_and_b32 v222, s22, v222
    v_mfma_f32_16x16x32_bf16 v[176:179], a[224:227], v[228:231], v[176:179]
    ds_read_b128 v[228:231], v253 offset:29888
    s_waitcnt lgkmcnt(8)
    v_mfma_f32_16x16x32_bf16 v[180:183], a[216:219], v[232:235], v[180:183]
    buffer_load_dwordx4 a[212:215], v254, s[8:11], s42 offen offset:2048
    v_and_b32 v224, s22, v224
    v_mfma_f32_16x16x32_bf16 v[184:187], a[220:223], v[232:235], v[184:187]
    v_lshlrev_b32 v252, 16, v216
    v_mfma_f32_16x16x32_bf16 v[188:191], a[224:227], v[232:235], v[188:191]
    ds_read_b128 v[232:235], v253 offset:29632
    s_mov_b32 s42, 6144
    buffer_load_dwordx4 a[216:219], v254, s[8:11], s42 offen offset:0
    s_waitcnt vmcnt(19) lgkmcnt(2)
    v_mfma_f32_16x16x32_bf16 v[96:99], a[228:231], v[236:239], v[96:99]
    v_and_b32 v216, s22, v216
    v_add_f32 v252, v252, v251
    v_mfma_f32_16x16x32_bf16 v[100:103], a[232:235], v[236:239], v[100:103]
    buffer_load_dwordx4 a[220:223], v254, s[8:11], s42 offen offset:1024
    v_add_f32 v216, v216, v224
    v_mfma_f32_16x16x32_bf16 v[104:107], a[236:239], v[236:239], v[104:107]
    ds_read_b128 v[236:239], v253 offset:29376
    s_waitcnt lgkmcnt(2)
    v_mfma_f32_16x16x32_bf16 v[108:111], a[228:231], v[228:231], v[108:111]
    buffer_load_dwordx4 a[224:227], v254, s[8:11], s42 offen offset:2048
    v_fmac_f32 v252, s23, v249
    v_mfma_f32_16x16x32_bf16 v[112:115], a[232:235], v[228:231], v[112:115]
    v_fmac_f32 v216, s23, v220
    v_cvt_pk_bf16_f32 v216, v252, v216
    v_mfma_f32_16x16x32_bf16 v[116:119], a[236:239], v[228:231], v[116:119]
    s_waitcnt vmcnt(18)
    v_mfma_f32_16x16x32_bf16 v[96:99], a[240:243], v[228:231], v[96:99]
    v_and_b32 v215, 0x7fff, v255
    v_lshlrev_b32 v252, 16, v226
    v_mfma_f32_16x16x32_bf16 v[100:103], a[244:247], v[228:231], v[100:103]
    buffer_load_dwordx2 v[204:205], v215, s[4:7], s16 offen offset:448
    v_and_b32 v226, s22, v226
    v_mfma_f32_16x16x32_bf16 v[104:107], a[248:251], v[228:231], v[104:107]
    ds_read_b128 v[228:231], v253 offset:29120
    s_waitcnt lgkmcnt(2)
    v_mfma_f32_16x16x32_bf16 v[120:123], a[228:231], v[232:235], v[120:123]
    buffer_load_dwordx2 v[206:207], v215, s[4:7], s17 offen offset:448
    v_add_f32 v252, v252, v248
    v_mfma_f32_16x16x32_bf16 v[124:127], a[232:235], v[232:235], v[124:127]
    buffer_load_dwordx2 v[208:209], v215, s[4:7], s18 offen offset:448
    v_add_f32 v226, v226, v218
    v_mfma_f32_16x16x32_bf16 v[128:131], a[236:239], v[232:235], v[128:131]
    v_fmac_f32 v252, s23, v250
    v_mfma_f32_16x16x32_bf16 v[108:111], a[240:243], v[232:235], v[108:111]
    buffer_load_dwordx2 v[210:211], v215, s[4:7], s19 offen offset:448
    v_fmac_f32 v226, s23, v222
    v_mfma_f32_16x16x32_bf16 v[112:115], a[244:247], v[232:235], v[112:115]
    buffer_load_dwordx2 v[212:213], v215, s[4:7], s20 offen offset:448
    v_cvt_pk_bf16_f32 v226, v252, v226
    v_mfma_f32_16x16x32_bf16 v[116:119], a[248:251], v[232:235], v[116:119]
    v_fma_f32 v252, v249, s24, v251
    s_waitcnt vmcnt(20)
    v_mfma_f32_16x16x32_bf16 v[96:99], a[252:255], v[232:235], v[96:99]
    buffer_load_dwordx2 v[214:215], v215, s[4:7], s21 offen offset:448
    v_fmac_f32 v251, s25, v249
    v_mfma_f32_16x16x32_bf16 v[100:103], v[240:243], v[232:235], v[100:103]
    v_fma_f32 v249, v248, s24, v250
    v_fmac_f32 v250, s25, v248
    v_mfma_f32_16x16x32_bf16 v[104:107], v[244:247], v[232:235], v[104:107]
    ds_read_b128 v[232:235], v253 offset:30944
    s_waitcnt lgkmcnt(2)
    v_mfma_f32_16x16x32_bf16 v[132:135], a[228:231], v[236:239], v[132:135]
    v_fma_f32 v248, v250, s26, v251
    v_mfma_f32_16x16x32_bf16 v[136:139], a[232:235], v[236:239], v[136:139]
    v_fmac_f32 v251, s27, v250
    v_fma_f32 v250, v249, s28, v252
    v_mfma_f32_16x16x32_bf16 v[140:143], a[236:239], v[236:239], v[140:143]
    v_fmac_f32 v252, s29, v249
    v_fma_f32 v249, v220, s24, v224
    v_mfma_f32_16x16x32_bf16 v[120:123], a[240:243], v[236:239], v[120:123]
    v_fmac_f32 v224, s25, v220
    v_fma_f32 v220, v218, s24, v222
    v_mfma_f32_16x16x32_bf16 v[124:127], a[244:247], v[236:239], v[124:127]
    v_fmac_f32 v222, s25, v218
    v_fma_f32 v218, v222, s26, v224
    v_mfma_f32_16x16x32_bf16 v[128:131], a[248:251], v[236:239], v[128:131]
    v_fmac_f32 v224, s27, v222
    v_mfma_f32_16x16x32_bf16 v[108:111], a[252:255], v[236:239], v[108:111]
    v_fma_f32 v222, v220, s28, v249
    v_fmac_f32 v249, s29, v220
    v_mfma_f32_16x16x32_bf16 v[112:115], v[240:243], v[236:239], v[112:115]
    v_cvt_pk_bf16_f32 v218, v248, v218
    v_cvt_pk_bf16_f32 v224, v251, v224
    v_mfma_f32_16x16x32_bf16 v[116:119], v[244:247], v[236:239], v[116:119]
    ds_read_b128 v[236:239], v253 offset:30688
    s_waitcnt lgkmcnt(2)
    v_mfma_f32_16x16x32_bf16 v[144:147], a[228:231], v[228:231], v[144:147]
    v_cvt_pk_bf16_f32 v222, v250, v222
    v_cvt_pk_bf16_f32 v220, v252, v249
    v_mfma_f32_16x16x32_bf16 v[148:151], a[232:235], v[228:231], v[148:151]
    v_lshlrev_b32 v248, 16, v219
    v_lshlrev_b32 v249, 16, v221
    v_mfma_f32_16x16x32_bf16 v[152:155], a[236:239], v[228:231], v[152:155]
    v_lshlrev_b32 v250, 16, v223
    v_mfma_f32_16x16x32_bf16 v[132:135], a[240:243], v[228:231], v[132:135]
    v_lshlrev_b32 v251, 16, v225
    v_and_b32 v219, s22, v219
    v_mfma_f32_16x16x32_bf16 v[136:139], a[244:247], v[228:231], v[136:139]
    v_and_b32 v221, s22, v221
    v_and_b32 v223, s22, v223
    v_mfma_f32_16x16x32_bf16 v[140:143], a[248:251], v[228:231], v[140:143]
    v_and_b32 v225, s22, v225
    v_lshlrev_b32 v252, 16, v217
    v_mfma_f32_16x16x32_bf16 v[120:123], a[252:255], v[228:231], v[120:123]
    v_and_b32 v217, s22, v217
    v_add_f32 v252, v252, v251
    v_mfma_f32_16x16x32_bf16 v[124:127], v[240:243], v[228:231], v[124:127]
    v_add_f32 v217, v217, v225
    v_mfma_f32_16x16x32_bf16 v[128:131], v[244:247], v[228:231], v[128:131]
    ds_read_b128 v[228:231], v253 offset:30432
    s_waitcnt lgkmcnt(2)
    v_mfma_f32_16x16x32_bf16 v[156:159], a[228:231], v[232:235], v[156:159]
    v_fmac_f32 v252, s23, v249
    v_fmac_f32 v217, s23, v221
    v_mfma_f32_16x16x32_bf16 v[160:163], a[232:235], v[232:235], v[160:163]
    v_cvt_pk_bf16_f32 v217, v252, v217
    v_lshlrev_b32 v252, 16, v227
    v_mfma_f32_16x16x32_bf16 v[164:167], a[236:239], v[232:235], v[164:167]
    v_and_b32 v227, s22, v227
    v_add_f32 v252, v252, v248
    v_mfma_f32_16x16x32_bf16 v[144:147], a[240:243], v[232:235], v[144:147]
    v_add_f32 v227, v227, v219
    v_fmac_f32 v252, s23, v250
    v_mfma_f32_16x16x32_bf16 v[148:151], a[244:247], v[232:235], v[148:151]
    v_fmac_f32 v227, s23, v223
    v_cvt_pk_bf16_f32 v227, v252, v227
    v_mfma_f32_16x16x32_bf16 v[152:155], a[248:251], v[232:235], v[152:155]
    v_fma_f32 v252, v249, s24, v251
    v_mfma_f32_16x16x32_bf16 v[132:135], a[252:255], v[232:235], v[132:135]
    v_fmac_f32 v251, s25, v249
    v_fma_f32 v249, v248, s24, v250
    v_mfma_f32_16x16x32_bf16 v[136:139], v[240:243], v[232:235], v[136:139]
    v_fmac_f32 v250, s25, v248
    v_fma_f32 v248, v250, s26, v251
    v_mfma_f32_16x16x32_bf16 v[140:143], v[244:247], v[232:235], v[140:143]
    ds_read_b128 v[232:235], v253 offset:30176
    s_waitcnt lgkmcnt(2)
    v_mfma_f32_16x16x32_bf16 v[168:171], a[228:231], v[236:239], v[168:171]
    v_fmac_f32 v251, s27, v250
    v_fma_f32 v250, v249, s28, v252
    v_mfma_f32_16x16x32_bf16 v[172:175], a[232:235], v[236:239], v[172:175]
    v_fmac_f32 v252, s29, v249
    v_fma_f32 v249, v221, s24, v225
    v_mfma_f32_16x16x32_bf16 v[176:179], a[236:239], v[236:239], v[176:179]
    v_fmac_f32 v225, s25, v221
    v_mfma_f32_16x16x32_bf16 v[156:159], a[240:243], v[236:239], v[156:159]
    v_fma_f32 v221, v219, s24, v223
    v_fmac_f32 v223, s25, v219
    v_mfma_f32_16x16x32_bf16 v[160:163], a[244:247], v[236:239], v[160:163]
    v_fma_f32 v219, v223, s26, v225
    v_fmac_f32 v225, s27, v223
    v_mfma_f32_16x16x32_bf16 v[164:167], a[248:251], v[236:239], v[164:167]
    v_fma_f32 v223, v221, s28, v249
    v_fmac_f32 v249, s29, v221
    v_mfma_f32_16x16x32_bf16 v[144:147], a[252:255], v[236:239], v[144:147]
    v_cvt_pk_bf16_f32 v219, v248, v219
    v_cvt_pk_bf16_f32 v225, v251, v225
    v_mfma_f32_16x16x32_bf16 v[148:151], v[240:243], v[236:239], v[148:151]
    v_cvt_pk_bf16_f32 v223, v250, v223
    v_mfma_f32_16x16x32_bf16 v[152:155], v[244:247], v[236:239], v[152:155]
    ds_read_b128 v[236:239], v253 offset:29904
    s_waitcnt lgkmcnt(2)
    v_mfma_f32_16x16x32_bf16 v[180:183], a[228:231], v[228:231], v[180:183]
    v_cvt_pk_bf16_f32 v221, v252, v249
    v_lshrrev_b32 v252, 15, v255
    v_mfma_f32_16x16x32_bf16 v[184:187], a[232:235], v[228:231], v[184:187]
    ds_write_b64 v252, v[218:219] offset:0
    ds_write_b64 v252, v[224:225] offset:2080
    v_mfma_f32_16x16x32_bf16 v[188:191], a[236:239], v[228:231], v[188:191]
    ds_write_b64 v252, v[222:223] offset:4160
    ds_write_b64 v252, v[216:217] offset:33280
    v_mfma_f32_16x16x32_bf16 v[168:171], a[240:243], v[228:231], v[168:171]
    s_mov_b32 s42, 36864
    buffer_load_dwordx4 a[228:231], v254, s[8:11], s42 offen offset:0
    v_mfma_f32_16x16x32_bf16 v[172:175], a[244:247], v[228:231], v[172:175]
    ds_write_b64 v252, v[226:227] offset:37440
    ds_write_b64 v252, v[220:221] offset:6240
    v_mfma_f32_16x16x32_bf16 v[176:179], a[248:251], v[228:231], v[176:179]
    buffer_load_dwordx4 a[232:235], v254, s[8:11], s42 offen offset:1024
    v_mfma_f32_16x16x32_bf16 v[156:159], a[252:255], v[228:231], v[156:159]
    v_mfma_f32_16x16x32_bf16 v[160:163], v[240:243], v[228:231], v[160:163]
    buffer_load_dwordx4 a[236:239], v254, s[8:11], s42 offen offset:2048
    v_mfma_f32_16x16x32_bf16 v[164:167], v[244:247], v[228:231], v[164:167]
    s_waitcnt lgkmcnt(0)
    s_barrier
    ds_read_b128 v[228:231], v253 offset:1040
    v_mfma_f32_16x16x32_bf16 v[180:183], a[240:243], v[232:235], v[180:183]
    v_mfma_f32_16x16x32_bf16 v[184:187], a[244:247], v[232:235], v[184:187]
    v_mfma_f32_16x16x32_bf16 v[188:191], a[248:251], v[232:235], v[188:191]
    s_mov_b32 s42, 39936
    buffer_load_dwordx4 a[240:243], v254, s[8:11], s42 offen offset:0
    v_mfma_f32_16x16x32_bf16 v[168:171], a[252:255], v[232:235], v[168:171]
    v_mfma_f32_16x16x32_bf16 v[172:175], v[240:243], v[232:235], v[172:175]
    buffer_load_dwordx4 a[244:247], v254, s[8:11], s42 offen offset:1024
    v_mfma_f32_16x16x32_bf16 v[176:179], v[244:247], v[232:235], v[176:179]
    ds_read_b128 v[232:235], v253 offset:768
    v_mfma_f32_16x16x32_bf16 v[180:183], a[252:255], v[236:239], v[180:183]
    buffer_load_dwordx4 a[248:251], v254, s[8:11], s42 offen offset:2048
    v_mfma_f32_16x16x32_bf16 v[184:187], v[240:243], v[236:239], v[184:187]
    v_mfma_f32_16x16x32_bf16 v[188:191], v[244:247], v[236:239], v[188:191]
    ds_read_b128 v[236:239], v253 offset:512
    s_mov_b32 s42, 43008
    buffer_load_dwordx4 a[252:255], v254, s[8:11], s42 offen offset:0
    s_add_u32 s41, s40, 589824
    s_add_u32 s40, s40, 6291456
    s_add_u32 s39, s39, 1
    s_cmp_lt_u32 s39, 2
    s_cbranch_scc1 blk_loop
    v_bfe_u32 v2, v254, 6, 2
    v_mul_u32_u24 v0, 40704, v2
    v_and_b32 v2, 0x80, v254
    v_lshrrev_b32 v2, 1, v2
    v_add_u32 v0, v0, v2
    v_and_b32 v2, 0x40, v254
    v_lshrrev_b32 v2, 2, v2
    v_add_u32 v0, v0, v2
    v_bfe_u32 v2, v254, 4, 2
    v_mul_u32_u24 v2, 3104, v2
    v_add_u32 v0, v0, v2
    v_add_u32 v0, s52, v0
    v_lshrrev_b32 v2, 8, v254
    v_lshl_add_u32 v1, v2, 3, v0
    v_lshl_add_u32 v0, v2, 4, v0
    v_cvt_pk_bf16_f32 v96, v96, v97
    v_cvt_pk_bf16_f32 v97, v98, v99
    v_cvt_pk_bf16_f32 v98, v100, v101
    v_cvt_pk_bf16_f32 v99, v102, v103
    v_cvt_pk_bf16_f32 v104, v104, v105
    v_cvt_pk_bf16_f32 v105, v106, v107
    ds_write_b128 v0, v[96:99] offset:14560
    ds_write_b64 v1, v[104:105] offset:14624
    v_cvt_pk_bf16_f32 v108, v108, v109
    v_cvt_pk_bf16_f32 v109, v110, v111
    v_cvt_pk_bf16_f32 v110, v112, v113
    v_cvt_pk_bf16_f32 v111, v114, v115
    v_cvt_pk_bf16_f32 v116, v116, v117
    v_cvt_pk_bf16_f32 v117, v118, v119
    ds_write_b128 v0, v[108:111] offset:14944
    ds_write_b64 v1, v[116:117] offset:15008
    v_cvt_pk_bf16_f32 v120, v120, v121
    v_cvt_pk_bf16_f32 v121, v122, v123
    v_cvt_pk_bf16_f32 v122, v124, v125
    v_cvt_pk_bf16_f32 v123, v126, v127
    v_cvt_pk_bf16_f32 v128, v128, v129
    v_cvt_pk_bf16_f32 v129, v130, v131
    ds_write_b128 v0, v[120:123] offset:15328
    ds_write_b64 v1, v[128:129] offset:15392
    v_cvt_pk_bf16_f32 v132, v132, v133
    v_cvt_pk_bf16_f32 v133, v134, v135
    v_cvt_pk_bf16_f32 v134, v136, v137
    v_cvt_pk_bf16_f32 v135, v138, v139
    v_cvt_pk_bf16_f32 v140, v140, v141
    v_cvt_pk_bf16_f32 v141, v142, v143
    ds_write_b128 v0, v[132:135] offset:15712
    ds_write_b64 v1, v[140:141] offset:15776
    v_cvt_pk_bf16_f32 v144, v144, v145
    v_cvt_pk_bf16_f32 v145, v146, v147
    v_cvt_pk_bf16_f32 v146, v148, v149
    v_cvt_pk_bf16_f32 v147, v150, v151
    v_cvt_pk_bf16_f32 v152, v152, v153
    v_cvt_pk_bf16_f32 v153, v154, v155
    ds_write_b128 v0, v[144:147] offset:16096
    ds_write_b64 v1, v[152:153] offset:16160
    v_cvt_pk_bf16_f32 v156, v156, v157
    v_cvt_pk_bf16_f32 v157, v158, v159
    v_cvt_pk_bf16_f32 v158, v160, v161
    v_cvt_pk_bf16_f32 v159, v162, v163
    v_cvt_pk_bf16_f32 v164, v164, v165
    v_cvt_pk_bf16_f32 v165, v166, v167
    ds_write_b128 v0, v[156:159] offset:16480
    ds_write_b64 v1, v[164:165] offset:16544
    v_cvt_pk_bf16_f32 v168, v168, v169
    v_cvt_pk_bf16_f32 v169, v170, v171
    v_cvt_pk_bf16_f32 v170, v172, v173
    v_cvt_pk_bf16_f32 v171, v174, v175
    v_cvt_pk_bf16_f32 v176, v176, v177
    v_cvt_pk_bf16_f32 v177, v178, v179
    ds_write_b128 v0, v[168:171] offset:16864
    ds_write_b64 v1, v[176:177] offset:16928
    v_cvt_pk_bf16_f32 v180, v180, v181
    v_cvt_pk_bf16_f32 v181, v182, v183
    v_cvt_pk_bf16_f32 v182, v184, v185
    v_cvt_pk_bf16_f32 v183, v186, v187
    v_cvt_pk_bf16_f32 v188, v188, v189
    v_cvt_pk_bf16_f32 v189, v190, v191
    ds_write_b128 v0, v[180:183] offset:17248
    ds_write_b64 v1, v[188:189] offset:17312
    s_waitcnt lgkmcnt(0)
    s_barrier
    v_add_u32 v143, s51, v254
    ds_read_b128 v[144:147], v143 offset:14560
    ds_read_b128 v[148:151], v143 offset:15584
    ds_read_b128 v[152:155], v143 offset:16608
    ds_read_b128 v[156:159], v143 offset:17664
    ds_read_b128 v[160:163], v143 offset:18688
    ds_read_b128 v[164:167], v143 offset:19712
    ds_read_b128 v[168:171], v143 offset:20768
    ds_read_b128 v[172:175], v143 offset:21792
    ds_read_b128 v[176:179], v143 offset:22816
    ds_read_b128 v[180:183], v143 offset:23872
    ds_read_b128 v[184:187], v143 offset:24896
    ds_read_b128 v[188:191], v143 offset:25920
    s_add_u32 s44, s41, 0
    s_waitcnt lgkmcnt(11)
    buffer_store_dwordx4 v[144:147], v254, s[12:15], s44 offen offset:0
    s_waitcnt lgkmcnt(10)
    buffer_store_dwordx4 v[148:151], v254, s[12:15], s44 offen offset:1024
    s_waitcnt lgkmcnt(9)
    buffer_store_dwordx4 v[152:155], v254, s[12:15], s44 offen offset:2048
    s_add_u32 s44, s41, 3072
    s_waitcnt lgkmcnt(8)
    buffer_store_dwordx4 v[156:159], v254, s[12:15], s44 offen offset:0
    s_waitcnt lgkmcnt(7)
    buffer_store_dwordx4 v[160:163], v254, s[12:15], s44 offen offset:1024
    s_waitcnt lgkmcnt(6)
    buffer_store_dwordx4 v[164:167], v254, s[12:15], s44 offen offset:2048
    s_add_u32 s44, s41, 6144
    s_waitcnt lgkmcnt(5)
    buffer_store_dwordx4 v[168:171], v254, s[12:15], s44 offen offset:0
    s_waitcnt lgkmcnt(4)
    buffer_store_dwordx4 v[172:175], v254, s[12:15], s44 offen offset:1024
    s_waitcnt lgkmcnt(3)
    buffer_store_dwordx4 v[176:179], v254, s[12:15], s44 offen offset:2048
    s_add_u32 s44, s41, 9216
    s_waitcnt lgkmcnt(2)
    buffer_store_dwordx4 v[180:183], v254, s[12:15], s44 offen offset:0
    s_waitcnt lgkmcnt(1)
    buffer_store_dwordx4 v[184:187], v254, s[12:15], s44 offen offset:1024
    s_waitcnt lgkmcnt(0)
    buffer_store_dwordx4 v[188:191], v254, s[12:15], s44 offen offset:2048
main_done:
    s_endpgm
.section .rodata,"a"
.p2align 6
.amdhsa_kernel wt_kernel
  .amdhsa_next_free_vgpr 72
  .amdhsa_next_free_sgpr 40
  .amdhsa_accum_offset 72
  .amdhsa_group_segment_fixed_size 0
  .amdhsa_kernarg_size 40
  .amdhsa_user_sgpr_count 2
  .amdhsa_user_sgpr_kernarg_segment_ptr 1
  .amdhsa_system_sgpr_workgroup_id_x 1
  .amdhsa_float_denorm_mode_32 3
.end_amdhsa_kernel
.p2align 6
.amdhsa_kernel wino_kernel
  .amdhsa_next_free_vgpr 512
  .amdhsa_next_free_sgpr 102
  .amdhsa_accum_offset 256
  .amdhsa_group_segment_fixed_size 0
  .amdhsa_kernarg_size 40
  .amdhsa_user_sgpr_count 2
  .amdhsa_user_sgpr_kernarg_segment_ptr 1
  .amdhsa_system_sgpr_workgroup_id_x 1
  .amdhsa_float_denorm_mode_32 3
.end_amdhsa_kernel
```

```asm
; @launch kernel=wt_kernel grid=(216,1,1) block=(64,1,1) lds=0
; @launch kernel=wino_kernel grid=(256,1,1) block=(256,1,1) lds=163840
.amdgcn_target "amdgcn-amd-amdhsa--gfx950"
.text
.globl wt_kernel
.p2align 8
.type wt_kernel,@function
wt_kernel:
    s_cmp_ge_u32 s2, 216
    s_cbranch_scc1 wt_done
    s_load_dwordx2 s[4:5], s[0:1], 8
    s_load_dwordx2 s[6:7], s[0:1], 32
    s_mul_i32 s20, s2, 43691
    s_lshr_b32 s20, s20, 17
    s_mul_i32 s21, s20, 3
    s_sub_u32 s21, s2, s21
    s_and_b32 s22, s20, 3
    s_lshr_b32 s23, s20, 2
    s_mul_i32 s24, s23, 43691
    s_lshr_b32 s24, s24, 17
    s_mul_i32 s25, s24, 3
    s_sub_u32 s25, s23, s25
    v_and_b32 v1, 15, v0
    v_lshrrev_b32 v2, 4, v0
    v_and_b32 v3, 12, v1
    s_cmp_lt_u32 s21, 2
    s_cselect_b32 s26, 1, 0
    s_lshl_b32 s27, s21, 2
    s_cmp_lt_u32 s21, 2
    s_cselect_b32 s27, s27, 32
    v_mul_u32_u24 v3, s26, v3
    v_add_u32 v3, v3, v1
    s_mul_i32 s28, s22, 48
    s_add_u32 s27, s27, s28
    v_add_u32 v3, s27, v3
    v_lshlrev_b32 v3, 1, v3
    v_mul_u32_u24 v4, 3072, v2
    v_add_u32 v3, v3, v4
    s_mul_i32 s28, s25, 73728
    s_mul_i32 s29, s24, 12288
    s_add_u32 s28, s28, s29
    s_add_u32 s29, s28, 221184
    s_add_u32 s30, s28, 442368
    s_waitcnt lgkmcnt(0)
    s_mov_b32 s8, s4
    s_and_b32 s9, s5, 0xffff
    s_mov_b32 s10, 663552
    s_mov_b32 s11, 0x20000
    s_mov_b32 s12, s6
    s_and_b32 s13, s7, 0xffff
    s_mov_b32 s14, 1327104
    s_mov_b32 s15, 0x20000
    buffer_load_ushort v10, v3, s[8:11], s28 offen offset:0
    buffer_load_ushort v11, v3, s[8:11], s28 offen offset:384
    buffer_load_ushort v12, v3, s[8:11], s28 offen offset:768
    buffer_load_ushort v13, v3, s[8:11], s28 offen offset:1152
    buffer_load_ushort v14, v3, s[8:11], s28 offen offset:1536
    buffer_load_ushort v15, v3, s[8:11], s28 offen offset:1920
    buffer_load_ushort v16, v3, s[8:11], s28 offen offset:2304
    buffer_load_ushort v17, v3, s[8:11], s28 offen offset:2688
    buffer_load_ushort v18, v3, s[8:11], s29 offen offset:0
    buffer_load_ushort v19, v3, s[8:11], s29 offen offset:384
    buffer_load_ushort v20, v3, s[8:11], s29 offen offset:768
    buffer_load_ushort v21, v3, s[8:11], s29 offen offset:1152
    buffer_load_ushort v22, v3, s[8:11], s29 offen offset:1536
    buffer_load_ushort v23, v3, s[8:11], s29 offen offset:1920
    buffer_load_ushort v24, v3, s[8:11], s29 offen offset:2304
    buffer_load_ushort v25, v3, s[8:11], s29 offen offset:2688
    buffer_load_ushort v26, v3, s[8:11], s30 offen offset:0
    buffer_load_ushort v27, v3, s[8:11], s30 offen offset:384
    buffer_load_ushort v28, v3, s[8:11], s30 offen offset:768
    buffer_load_ushort v29, v3, s[8:11], s30 offen offset:1152
    buffer_load_ushort v30, v3, s[8:11], s30 offen offset:1536
    buffer_load_ushort v31, v3, s[8:11], s30 offen offset:1920
    buffer_load_ushort v32, v3, s[8:11], s30 offen offset:2304
    buffer_load_ushort v33, v3, s[8:11], s30 offen offset:2688
    s_mul_i32 s31, s22, 9216
    s_mul_i32 s32, s25, 3072
    s_add_u32 s31, s31, s32
    s_lshl_b32 s32, s21, 10
    s_add_u32 s31, s31, s32
    v_lshlrev_b32 v5, 4, v0
    v_add_u32 v5, s31, v5
    s_mul_i32 s33, s24, 36864
    s_lshl_b32 s34, s33, 2
    s_waitcnt vmcnt(0)
    v_lshlrev_b32 v10, 16, v10
    v_lshlrev_b32 v11, 16, v11
    v_lshlrev_b32 v12, 16, v12
    v_lshlrev_b32 v13, 16, v13
    v_lshlrev_b32 v14, 16, v14
    v_lshlrev_b32 v15, 16, v15
    v_lshlrev_b32 v16, 16, v16
    v_lshlrev_b32 v17, 16, v17
    v_lshlrev_b32 v18, 16, v18
    v_lshlrev_b32 v19, 16, v19
    v_lshlrev_b32 v20, 16, v20
    v_lshlrev_b32 v21, 16, v21
    v_lshlrev_b32 v22, 16, v22
    v_lshlrev_b32 v23, 16, v23
    v_lshlrev_b32 v24, 16, v24
    v_lshlrev_b32 v25, 16, v25
    v_lshlrev_b32 v26, 16, v26
    v_lshlrev_b32 v27, 16, v27
    v_lshlrev_b32 v28, 16, v28
    v_lshlrev_b32 v29, 16, v29
    v_lshlrev_b32 v30, 16, v30
    v_lshlrev_b32 v31, 16, v31
    v_lshlrev_b32 v32, 16, v32
    v_lshlrev_b32 v33, 16, v33
    v_cvt_pk_bf16_f32 v48, v10, v11
    v_cvt_pk_bf16_f32 v49, v12, v13
    v_cvt_pk_bf16_f32 v50, v14, v15
    v_cvt_pk_bf16_f32 v51, v16, v17
    s_add_u32 s35, s33, 884736
    buffer_store_dwordx4 v[48:51], v5, s[12:15], s35 offen
    v_mul_f32 v36, 0xbf170c51, v10
    v_fmac_f32 v36, 0xbebccf65, v18
    v_fmac_f32 v36, 0xbe6c033f, v26
    v_mul_f32 v37, 0xbf170c51, v11
    v_fmac_f32 v37, 0xbebccf65, v19
    v_fmac_f32 v37, 0xbe6c033f, v27
    v_mul_f32 v38, 0xbf170c51, v12
    v_fmac_f32 v38, 0xbebccf65, v20
    v_fmac_f32 v38, 0xbe6c033f, v28
    v_mul_f32 v39, 0xbf170c51, v13
    v_fmac_f32 v39, 0xbebccf65, v21
    v_fmac_f32 v39, 0xbe6c033f, v29
    v_mul_f32 v40, 0xbf170c51, v14
    v_fmac_f32 v40, 0xbebccf65, v22
    v_fmac_f32 v40, 0xbe6c033f, v30
    v_mul_f32 v41, 0xbf170c51, v15
    v_fmac_f32 v41, 0xbebccf65, v23
    v_fmac_f32 v41, 0xbe6c033f, v31
    v_mul_f32 v42, 0xbf170c51, v16
    v_fmac_f32 v42, 0xbebccf65, v24
    v_fmac_f32 v42, 0xbe6c033f, v32
    v_mul_f32 v43, 0xbf170c51, v17
    v_fmac_f32 v43, 0xbebccf65, v25
    v_fmac_f32 v43, 0xbe6c033f, v33
    v_cvt_pk_bf16_f32 v52, v36, v37
    v_cvt_pk_bf16_f32 v53, v38, v39
    v_cvt_pk_bf16_f32 v54, v40, v41
    v_cvt_pk_bf16_f32 v55, v42, v43
    s_add_u32 s35, s34, 0
    buffer_store_dwordx4 v[52:55], v5, s[12:15], s35 offen
    v_mul_f32 v36, 0xbf170c51, v10
    v_fmac_f32 v36, 0x3ebccf65, v18
    v_fmac_f32 v36, 0xbe6c033f, v26
    v_mul_f32 v37, 0xbf170c51, v11
    v_fmac_f32 v37, 0x3ebccf65, v19
    v_fmac_f32 v37, 0xbe6c033f, v27
    v_mul_f32 v38, 0xbf170c51, v12
    v_fmac_f32 v38, 0x3ebccf65, v20
    v_fmac_f32 v38, 0xbe6c033f, v28
    v_mul_f32 v39, 0xbf170c51, v13
    v_fmac_f32 v39, 0x3ebccf65, v21
    v_fmac_f32 v39, 0xbe6c033f, v29
    v_mul_f32 v40, 0xbf170c51, v14
    v_fmac_f32 v40, 0x3ebccf65, v22
    v_fmac_f32 v40, 0xbe6c033f, v30
    v_mul_f32 v41, 0xbf170c51, v15
    v_fmac_f32 v41, 0x3ebccf65, v23
    v_fmac_f32 v41, 0xbe6c033f, v31
    v_mul_f32 v42, 0xbf170c51, v16
    v_fmac_f32 v42, 0x3ebccf65, v24
    v_fmac_f32 v42, 0xbe6c033f, v32
    v_mul_f32 v43, 0xbf170c51, v17
    v_fmac_f32 v43, 0x3ebccf65, v25
    v_fmac_f32 v43, 0xbe6c033f, v33
    v_cvt_pk_bf16_f32 v56, v36, v37
    v_cvt_pk_bf16_f32 v57, v38, v39
    v_cvt_pk_bf16_f32 v58, v40, v41
    v_cvt_pk_bf16_f32 v59, v42, v43
    s_add_u32 s35, s34, 36864
    buffer_store_dwordx4 v[56:59], v5, s[12:15], s35 offen
    v_mul_f32 v36, 0x3e6c033f, v10
    v_fmac_f32 v36, 0x3ebccf65, v18
    v_fmac_f32 v36, 0x3f170c51, v26
    v_mul_f32 v37, 0x3e6c033f, v11
    v_fmac_f32 v37, 0x3ebccf65, v19
    v_fmac_f32 v37, 0x3f170c51, v27
    v_mul_f32 v38, 0x3e6c033f, v12
    v_fmac_f32 v38, 0x3ebccf65, v20
    v_fmac_f32 v38, 0x3f170c51, v28
    v_mul_f32 v39, 0x3e6c033f, v13
    v_fmac_f32 v39, 0x3ebccf65, v21
    v_fmac_f32 v39, 0x3f170c51, v29
    v_mul_f32 v40, 0x3e6c033f, v14
    v_fmac_f32 v40, 0x3ebccf65, v22
    v_fmac_f32 v40, 0x3f170c51, v30
    v_mul_f32 v41, 0x3e6c033f, v15
    v_fmac_f32 v41, 0x3ebccf65, v23
    v_fmac_f32 v41, 0x3f170c51, v31
    v_mul_f32 v42, 0x3e6c033f, v16
    v_fmac_f32 v42, 0x3ebccf65, v24
    v_fmac_f32 v42, 0x3f170c51, v32
    v_mul_f32 v43, 0x3e6c033f, v17
    v_fmac_f32 v43, 0x3ebccf65, v25
    v_fmac_f32 v43, 0x3f170c51, v33
    v_cvt_pk_bf16_f32 v60, v36, v37
    v_cvt_pk_bf16_f32 v61, v38, v39
    v_cvt_pk_bf16_f32 v62, v40, v41
    v_cvt_pk_bf16_f32 v63, v42, v43
    s_add_u32 s35, s34, 73728
    buffer_store_dwordx4 v[60:63], v5, s[12:15], s35 offen
    v_mul_f32 v36, 0x3e6c033f, v10
    v_fmac_f32 v36, 0xbebccf65, v18
    v_fmac_f32 v36, 0x3f170c51, v26
    v_mul_f32 v37, 0x3e6c033f, v11
    v_fmac_f32 v37, 0xbebccf65, v19
    v_fmac_f32 v37, 0x3f170c51, v27
    v_mul_f32 v38, 0x3e6c033f, v12
    v_fmac_f32 v38, 0xbebccf65, v20
    v_fmac_f32 v38, 0x3f170c51, v28
    v_mul_f32 v39, 0x3e6c033f, v13
    v_fmac_f32 v39, 0xbebccf65, v21
    v_fmac_f32 v39, 0x3f170c51, v29
    v_mul_f32 v40, 0x3e6c033f, v14
    v_fmac_f32 v40, 0xbebccf65, v22
    v_fmac_f32 v40, 0x3f170c51, v30
    v_mul_f32 v41, 0x3e6c033f, v15
    v_fmac_f32 v41, 0xbebccf65, v23
    v_fmac_f32 v41, 0x3f170c51, v31
    v_mul_f32 v42, 0x3e6c033f, v16
    v_fmac_f32 v42, 0xbebccf65, v24
    v_fmac_f32 v42, 0x3f170c51, v32
    v_mul_f32 v43, 0x3e6c033f, v17
    v_fmac_f32 v43, 0xbebccf65, v25
    v_fmac_f32 v43, 0x3f170c51, v33
    v_cvt_pk_bf16_f32 v64, v36, v37
    v_cvt_pk_bf16_f32 v65, v38, v39
    v_cvt_pk_bf16_f32 v66, v40, v41
    v_cvt_pk_bf16_f32 v67, v42, v43
    s_add_u32 s35, s34, 110592
    buffer_store_dwordx4 v[64:67], v5, s[12:15], s35 offen
    v_cvt_pk_bf16_f32 v68, v26, v27
    v_cvt_pk_bf16_f32 v69, v28, v29
    v_cvt_pk_bf16_f32 v70, v30, v31
    v_cvt_pk_bf16_f32 v71, v32, v33
    s_add_u32 s35, s33, 1105920
    buffer_store_dwordx4 v[68:71], v5, s[12:15], s35 offen
wt_done:
    s_endpgm
.globl wino_kernel
.p2align 8
.type wino_kernel,@function
wino_kernel:
    s_cmp_ge_u32 s2, 256
    s_cbranch_scc1 main_done
    s_load_dwordx2 s[4:5], s[0:1], 0
    s_load_dwordx2 s[12:13], s[0:1], 16
    s_load_dwordx2 s[8:9], s[0:1], 32
    v_lshrrev_b32 v1, 6, v0
    v_and_b32 v2, 63, v0
    v_readfirstlane_b32 s38, v1
    v_lshlrev_b32 v254, 4, v2
    v_lshrrev_b32 v3, 3, v2
    v_and_b32 v4, 7, v2
    v_mul_u32_u24 v5, 3072, v3
    v_lshl_add_u32 v255, v4, 3, v5
    s_lshr_b32 s44, s2, 3
    s_and_b32 s48, s44, 3
    s_lshr_b32 s44, s44, 2
    s_and_b32 s49, s2, 7
    s_lshl_b32 s49, s49, 4
    s_add_u32 s49, s49, s44
    s_and_b32 s90, s38, 1
    s_lshr_b32 s91, s38, 1
    s_mul_i32 s50, s90, 24576
    s_mul_i32 s45, s91, 1536
    s_add_u32 s50, s50, s45
    s_mul_i32 s101, s38, 196608
    s_sub_u32 s101, s101, s50
    s_mul_i32 s53, s48, 49152
    s_add_u32 s53, s53, s50
    s_cmp_gt_u32 s48, 0
    s_cselect_b32 s45, 384, 0
    s_cselect_b32 s55, 0, 2130706432
    s_add_u32 s50, s50, s45
    s_add_u32 s54, s45, 49152
    s_cmp_eq_u32 s48, 3
    s_cselect_b32 s54, 2130706432, s54
    s_mul_i32 s52, s38, 96
    s_mov_b32 s56, 0xffff0000
    s_mov_b32 s57, 0
    s_mul_i32 s43, s49, 786432
    s_add_u32 s43, s43, s53
    s_cmp_ge_u32 s49, 128
    s_cselect_b32 s43, 2130706432, s43
    s_sub_u32 s16, s43, 196608
    s_cmp_eq_u32 s49, 0
    s_cselect_b32 s16, 2130706432, s16
    s_mov_b32 s17, s43
    s_add_u32 s18, s43, 196608
    s_add_u32 s19, s43, 393216
    s_add_u32 s20, s43, 589824
    s_add_u32 s21, s43, 786432
    s_add_u32 s100, s43, s101
    v_and_b32 v67, 0xf0, v254
    v_lshrrev_b32 v67, 1, v67
    v_add_u32 v67, s52, v67
    v_mov_b32 v66, s54
    v_mov_b32 v65, s55
    v_cndmask_b32 v66, v66, v65, s[56:57]
    v_add_u32 v67, v67, v66
    s_mul_i32 s44, s38, 9216
    s_waitcnt lgkmcnt(0)
    s_and_b32 s5, s5, 0xffff
    s_mov_b32 s6, 100663296
    s_mov_b32 s7, 0x20000
    s_sub_u32 s45, s16, s50
    buffer_load_dwordx2 v[56:57], v67, s[4:7], s45 offen
    s_sub_u32 s45, s17, s50
    buffer_load_dwordx2 v[58:59], v67, s[4:7], s45 offen
    s_sub_u32 s45, s18, s50
    buffer_load_dwordx2 v[60:61], v67, s[4:7], s45 offen
    s_sub_u32 s45, s19, s50
    buffer_load_dwordx2 v[62:63], v67, s[4:7], s45 offen
    s_sub_u32 s45, s20, s50
    buffer_load_dwordx2 v[64:65], v67, s[4:7], s45 offen
    s_sub_u32 s45, s21, s50
    buffer_load_dwordx2 v[66:67], v67, s[4:7], s45 offen
    v_and_b32 v19, 0x7fff, v255
    buffer_load_dwordx2 v[8:9], v19, s[4:7], s16 offen offset:0
    buffer_load_dwordx2 v[10:11], v19, s[4:7], s17 offen offset:0
    buffer_load_dwordx2 v[12:13], v19, s[4:7], s18 offen offset:0
    buffer_load_dwordx2 v[14:15], v19, s[4:7], s19 offen offset:0
    buffer_load_dwordx2 v[16:17], v19, s[4:7], s20 offen offset:0
    buffer_load_dwordx2 v[18:19], v19, s[4:7], s21 offen offset:0
    v_and_b32 v31, 0x7fff, v255
    buffer_load_dwordx2 v[20:21], v31, s[4:7], s16 offen offset:384
    buffer_load_dwordx2 v[22:23], v31, s[4:7], s17 offen offset:384
    buffer_load_dwordx2 v[24:25], v31, s[4:7], s18 offen offset:384
    buffer_load_dwordx2 v[26:27], v31, s[4:7], s19 offen offset:384
    buffer_load_dwordx2 v[28:29], v31, s[4:7], s20 offen offset:384
    buffer_load_dwordx2 v[30:31], v31, s[4:7], s21 offen offset:384
    v_and_b32 v43, 0x7fff, v255
    buffer_load_dwordx2 v[32:33], v43, s[4:7], s16 offen offset:768
    buffer_load_dwordx2 v[34:35], v43, s[4:7], s17 offen offset:768
    buffer_load_dwordx2 v[36:37], v43, s[4:7], s18 offen offset:768
    buffer_load_dwordx2 v[38:39], v43, s[4:7], s19 offen offset:768
    buffer_load_dwordx2 v[40:41], v43, s[4:7], s20 offen offset:768
    buffer_load_dwordx2 v[42:43], v43, s[4:7], s21 offen offset:768
    v_and_b32 v55, 0x7fff, v255
    buffer_load_dwordx2 v[44:45], v55, s[4:7], s16 offen offset:1152
    buffer_load_dwordx2 v[46:47], v55, s[4:7], s17 offen offset:1152
    buffer_load_dwordx2 v[48:49], v55, s[4:7], s18 offen offset:1152
    buffer_load_dwordx2 v[50:51], v55, s[4:7], s19 offen offset:1152
    buffer_load_dwordx2 v[52:53], v55, s[4:7], s20 offen offset:1152
    buffer_load_dwordx2 v[54:55], v55, s[4:7], s21 offen offset:1152
    s_add_u32 s8, s8, s44
    s_addc_u32 s9, s9, 0
    s_and_b32 s9, s9, 0xffff
    s_mov_b32 s10, 1299456
    s_mov_b32 s11, 0x20000
    s_mov_b32 s42, 0
    buffer_load_dwordx4 a[192:195], v254, s[8:11], s42 offen offset:0
    buffer_load_dwordx4 a[196:199], v254, s[8:11], s42 offen offset:1024
    buffer_load_dwordx4 a[200:203], v254, s[8:11], s42 offen offset:2048
    s_mov_b32 s42, 3072
    buffer_load_dwordx4 a[204:207], v254, s[8:11], s42 offen offset:0
    buffer_load_dwordx4 a[208:211], v254, s[8:11], s42 offen offset:1024
    buffer_load_dwordx4 a[212:215], v254, s[8:11], s42 offen offset:2048
    s_mov_b32 s42, 6144
    buffer_load_dwordx4 a[216:219], v254, s[8:11], s42 offen offset:0
    buffer_load_dwordx4 a[220:223], v254, s[8:11], s42 offen offset:1024
    buffer_load_dwordx4 a[224:227], v254, s[8:11], s42 offen offset:2048
    v_and_b32 v203, 0x7fff, v255
    buffer_load_dwordx2 v[192:193], v203, s[4:7], s16 offen offset:64
    buffer_load_dwordx2 v[194:195], v203, s[4:7], s17 offen offset:64
    buffer_load_dwordx2 v[196:197], v203, s[4:7], s18 offen offset:64
    buffer_load_dwordx2 v[198:199], v203, s[4:7], s19 offen offset:64
    buffer_load_dwordx2 v[200:201], v203, s[4:7], s20 offen offset:64
    buffer_load_dwordx2 v[202:203], v203, s[4:7], s21 offen offset:64
    v_and_b32 v215, 0x7fff, v255
    buffer_load_dwordx2 v[204:205], v215, s[4:7], s16 offen offset:448
    buffer_load_dwordx2 v[206:207], v215, s[4:7], s17 offen offset:448
    buffer_load_dwordx2 v[208:209], v215, s[4:7], s18 offen offset:448
    buffer_load_dwordx2 v[210:211], v215, s[4:7], s19 offen offset:448
    buffer_load_dwordx2 v[212:213], v215, s[4:7], s20 offen offset:448
    buffer_load_dwordx2 v[214:215], v215, s[4:7], s21 offen offset:448
    s_mov_b32 s42, 36864
    buffer_load_dwordx4 a[228:231], v254, s[8:11], s42 offen offset:0
    buffer_load_dwordx4 a[232:235], v254, s[8:11], s42 offen offset:1024
    buffer_load_dwordx4 a[236:239], v254, s[8:11], s42 offen offset:2048
    s_mov_b32 s42, 39936
    buffer_load_dwordx4 a[240:243], v254, s[8:11], s42 offen offset:0
    buffer_load_dwordx4 a[244:247], v254, s[8:11], s42 offen offset:1024
    buffer_load_dwordx4 a[248:251], v254, s[8:11], s42 offen offset:2048
    s_mov_b32 s42, 43008
    buffer_load_dwordx4 a[252:255], v254, s[8:11], s42 offen offset:0
    buffer_load_dwordx4 v[240:243], v254, s[8:11], s42 offen offset:1024
    buffer_load_dwordx4 v[244:247], v254, s[8:11], s42 offen offset:2048
    s_and_b32 s13, s13, 0xffff
    s_mov_b32 s14, 100663296
    s_mov_b32 s15, 0x20000
    v_lshrrev_b32 v5, 4, v2
    v_mul_u32_u24 v6, 40704, v5
    v_lshrrev_b32 v5, 1, v5
    v_lshl_add_u32 v6, v5, 6, v6
    v_and_b32 v5, 0xf0, v254
    v_add_u32 v253, v6, v5
    v_lshrrev_b32 v6, 1, v4
    v_mul_u32_u24 v7, 40704, v6
    v_lshrrev_b32 v6, 1, v6
    v_lshl_add_u32 v7, v6, 6, v7
    v_and_b32 v6, 1, v2
    v_lshl_add_u32 v7, v6, 3, v7
    v_lshl_add_u32 v7, v3, 4, v7
    s_lshl_b32 s44, s90, 7
    s_mul_i32 s45, s91, 1056
    s_add_u32 s44, s44, s45
    v_add_u32 v7, s44, v7
    v_lshl_or_b32 v255, v7, 15, v255
    s_mul_i32 s51, s38, 40704
    s_lshl_b32 s45, s91, 6
    s_add_u32 s51, s51, s45
    s_lshl_b32 s45, s90, 4
    s_add_u32 s51, s51, s45
    s_mul_i32 s40, s49, 786432
    s_mul_i32 s45, s48, 49152
    s_add_u32 s40, s40, s45
    s_mul_i32 s45, s38, 12288
    s_add_u32 s40, s40, s45
    s_mov_b32 s41, 2130706432
    s_mov_b32 s39, 0
    s_lshl_b32 s45, s38, 4
    s_mov_b32 s46, 0xfff
    s_mov_b32 s47, 0
    s_lshl_b64 s[46:47], s[46:47], s45
    s_mov_b32 s58, 0x0fff0fff
    s_mov_b32 s59, 0
    s_mov_b32 s23, 0xc03cd70a
    s_mov_b32 s24, 0xbec80000
    s_mov_b32 s25, 0xc023d70a
    s_mov_b32 s26, 0x3f200000
    s_mov_b32 s27, 0xbf200000
    s_mov_b32 s28, 0x3fcccccd
    s_mov_b32 s29, 0xbfcccccd
    s_mov_b32 s30, 0x3ec80000
    s_mov_b32 s31, 0x3ec80000
    s_mov_b32 s34, 0x3e7a0000
    s_mov_b32 s22, 0xffff0000
    s_add_u32 s33, s100, 6291456
    s_mov_b32 s32, s100
    s_lshr_b32 s36, s2, 3
    s_lshl_b32 s36, s36, 2
    s_add_u32 s36, s36, s38
    s_lshl_b32 s36, s36, 7
    s_getpc_b64 s[92:93]
pcref:
    v_lshlrev_b32 v70, 7, v0
    v_add_u32 v71, 0x8000, v70
    v_min_u32 v71, code_end-pcref-4, v71
    v_mov_b32 v73, s93
    v_add_co_u32 v72, vcc, s92, v70
    s_nop 1
    v_addc_co_u32 v73, vcc, 0, v73, vcc
    v_mov_b32 v75, s93
    v_add_co_u32 v74, vcc, s92, v71
    s_nop 1
    v_addc_co_u32 v75, vcc, 0, v75, vcc
    global_load_dword v76, v[72:73], off
    global_load_dword v77, v[74:75], off
    v_bfe_u32 v6, v254, 6, 2
    v_mul_u32_u24 v4, 40704, v6
    v_and_b32 v6, 0x80, v254
    v_lshrrev_b32 v6, 1, v6
    v_add_u32 v4, v4, v6
    v_and_b32 v6, 0x40, v254
    v_lshrrev_b32 v6, 2, v6
    v_add_u32 v4, v4, v6
    v_bfe_u32 v6, v254, 4, 2
    v_mul_u32_u24 v6, 3104, v6
    v_add_u32 v4, v4, v6
    v_add_u32 v4, s52, v4
    v_lshrrev_b32 v6, 8, v254
    v_lshl_add_u32 v5, v6, 3, v4
    v_lshl_add_u32 v4, v6, 4, v4
    v_add_u32 v6, s51, v254
    s_waitcnt vmcnt(56)
    v_lshlrev_b32 v248, 16, v58
    v_lshlrev_b32 v249, 16, v60
    v_lshlrev_b32 v250, 16, v62
    v_lshlrev_b32 v251, 16, v64
    v_and_b32 v58, s22, v58
    v_and_b32 v60, s22, v60
    v_and_b32 v62, s22, v62
    v_and_b32 v64, s22, v64
    v_lshlrev_b32 v252, 16, v56
    v_and_b32 v56, s22, v56
    v_add_f32 v252, v252, v251
    v_add_f32 v56, v56, v64
    v_fmac_f32 v252, s23, v249
    v_fmac_f32 v56, s23, v60
    v_cvt_pk_bf16_f32 v56, v252, v56
    v_lshlrev_b32 v252, 16, v66
    v_and_b32 v66, s22, v66
    v_add_f32 v252, v252, v248
    v_add_f32 v66, v66, v58
    v_fmac_f32 v252, s23, v250
    v_fmac_f32 v66, s23, v62
    v_cvt_pk_bf16_f32 v66, v252, v66
    v_fma_f32 v252, v249, s24, v251
    v_fmac_f32 v251, s25, v249
    v_fma_f32 v249, v248, s24, v250
    v_fmac_f32 v250, s25, v248
    v_fma_f32 v248, v250, s26, v251
    v_fmac_f32 v251, s27, v250
    v_fma_f32 v250, v249, s28, v252
    v_fmac_f32 v252, s29, v249
    v_fma_f32 v249, v60, s24, v64
    v_fmac_f32 v64, s25, v60
    v_fma_f32 v60, v58, s24, v62
    v_fmac_f32 v62, s25, v58
    v_fma_f32 v58, v62, s26, v64
    v_fmac_f32 v64, s27, v62
    v_fma_f32 v62, v60, s28, v249
    v_fmac_f32 v249, s29, v60
    v_cvt_pk_bf16_f32 v58, v248, v58
    v_cvt_pk_bf16_f32 v64, v251, v64
    v_cvt_pk_bf16_f32 v62, v250, v62
    v_cvt_pk_bf16_f32 v60, v252, v249
    v_lshlrev_b32 v248, 16, v59
    v_lshlrev_b32 v249, 16, v61
    v_lshlrev_b32 v250, 16, v63
    v_lshlrev_b32 v251, 16, v65
    v_and_b32 v59, s22, v59
    v_and_b32 v61, s22, v61
    v_and_b32 v63, s22, v63
    v_and_b32 v65, s22, v65
    v_lshlrev_b32 v252, 16, v57
    v_and_b32 v57, s22, v57
    v_add_f32 v252, v252, v251
    v_add_f32 v57, v57, v65
    v_fmac_f32 v252, s23, v249
    v_fmac_f32 v57, s23, v61
    v_cvt_pk_bf16_f32 v57, v252, v57
    v_lshlrev_b32 v252, 16, v67
    v_and_b32 v67, s22, v67
    v_add_f32 v252, v252, v248
    v_add_f32 v67, v67, v59
    v_fmac_f32 v252, s23, v250
    v_fmac_f32 v67, s23, v63
    v_cvt_pk_bf16_f32 v67, v252, v67
    v_fma_f32 v252, v249, s24, v251
    v_fmac_f32 v251, s25, v249
    v_fma_f32 v249, v248, s24, v250
    v_fmac_f32 v250, s25, v248
    v_fma_f32 v248, v250, s26, v251
    v_fmac_f32 v251, s27, v250
    v_fma_f32 v250, v249, s28, v252
    v_fmac_f32 v252, s29, v249
    v_fma_f32 v249, v61, s24, v65
    v_fmac_f32 v65, s25, v61
    v_fma_f32 v61, v59, s24, v63
    v_fmac_f32 v63, s25, v59
    v_fma_f32 v59, v63, s26, v65
    v_fmac_f32 v65, s27, v63
    v_fma_f32 v63, v61, s28, v249
    v_fmac_f32 v249, s29, v61
    v_cvt_pk_bf16_f32 v59, v248, v59
    v_cvt_pk_bf16_f32 v65, v251, v65
    v_cvt_pk_bf16_f32 v63, v250, v63
    v_cvt_pk_bf16_f32 v61, v252, v249
    v_and_b32 v248, 0xf0, v254
    v_lshrrev_b32 v248, 1, v248
    v_add_u32 v248, s52, v248
    v_and_b32 v252, 8, v248
    v_lshrrev_b32 v249, 6, v248
    v_mul_u32_u24 v249, 192, v249
    v_add_u32 v252, v252, v249
    v_bfe_u32 v249, v248, 4, 2
    v_mul_u32_u24 v249, 40704, v249
    v_add_u32 v252, v252, v249
    v_and_b32 v249, 32, v248
    v_lshl_add_u32 v252, v249, 1, v252
    v_bfe_u32 v249, v254, 8, 1
    v_lshl_add_u32 v252, v249, 4, v252
    v_mov_b32 v249, 123328
    v_cndmask_b32 v252, v249, v252, s[58:59]
    ds_write_b64 v252, v[56:57] offset:39520
    ds_write_b64 v252, v[58:59] offset:39552
    ds_write_b64 v252, v[64:65] offset:39584
    ds_write_b64 v252, v[62:63] offset:39616
    ds_write_b64 v252, v[60:61] offset:39648
    ds_write_b64 v252, v[66:67] offset:39680
    s_waitcnt lgkmcnt(0)
    s_barrier
    s_waitcnt vmcnt(50)
    v_lshlrev_b32 v248, 16, v10
    v_lshlrev_b32 v249, 16, v12
    v_lshlrev_b32 v250, 16, v14
    v_lshlrev_b32 v251, 16, v16
    v_and_b32 v10, s22, v10
    v_and_b32 v12, s22, v12
    v_and_b32 v14, s22, v14
    v_and_b32 v16, s22, v16
    v_lshlrev_b32 v252, 16, v8
    v_and_b32 v8, s22, v8
    v_add_f32 v252, v252, v251
    v_add_f32 v8, v8, v16
    v_fmac_f32 v252, s23, v249
    v_fmac_f32 v8, s23, v12
    v_cvt_pk_bf16_f32 v8, v252, v8
    v_lshlrev_b32 v252, 16, v18
    v_and_b32 v18, s22, v18
    v_add_f32 v252, v252, v248
    v_add_f32 v18, v18, v10
    v_fmac_f32 v252, s23, v250
    v_fmac_f32 v18, s23, v14
    v_cvt_pk_bf16_f32 v18, v252, v18
    v_fma_f32 v252, v249, s24, v251
    v_fmac_f32 v251, s25, v249
    v_fma_f32 v249, v248, s24, v250
    v_fmac_f32 v250, s25, v248
    v_fma_f32 v248, v250, s26, v251
    v_fmac_f32 v251, s27, v250
    v_fma_f32 v250, v249, s28, v252
    v_fmac_f32 v252, s29, v249
    v_fma_f32 v249, v12, s24, v16
    v_fmac_f32 v16, s25, v12
    v_fma_f32 v12, v10, s24, v14
    v_fmac_f32 v14, s25, v10
    v_fma_f32 v10, v14, s26, v16
    v_fmac_f32 v16, s27, v14
    v_fma_f32 v14, v12, s28, v249
    v_fmac_f32 v249, s29, v12
    v_cvt_pk_bf16_f32 v10, v248, v10
    v_cvt_pk_bf16_f32 v16, v251, v16
    v_cvt_pk_bf16_f32 v14, v250, v14
    v_cvt_pk_bf16_f32 v12, v252, v249
    v_lshlrev_b32 v248, 16, v11
    v_lshlrev_b32 v249, 16, v13
    v_lshlrev_b32 v250, 16, v15
    v_lshlrev_b32 v251, 16, v17
    v_and_b32 v11, s22, v11
    v_and_b32 v13, s22, v13
    v_and_b32 v15, s22, v15
    v_and_b32 v17, s22, v17
    v_lshlrev_b32 v252, 16, v9
    v_and_b32 v9, s22, v9
    v_add_f32 v252, v252, v251
    v_add_f32 v9, v9, v17
    v_fmac_f32 v252, s23, v249
    v_fmac_f32 v9, s23, v13
    v_cvt_pk_bf16_f32 v9, v252, v9
    v_lshlrev_b32 v252, 16, v19
    v_and_b32 v19, s22, v19
    v_add_f32 v252, v252, v248
    v_add_f32 v19, v19, v11
    v_fmac_f32 v252, s23, v250
    v_fmac_f32 v19, s23, v15
    v_cvt_pk_bf16_f32 v19, v252, v19
    v_fma_f32 v252, v249, s24, v251
    v_fmac_f32 v251, s25, v249
    v_fma_f32 v249, v248, s24, v250
    v_fmac_f32 v250, s25, v248
    v_fma_f32 v248, v250, s26, v251
    v_fmac_f32 v251, s27, v250
    v_fma_f32 v250, v249, s28, v252
    v_fmac_f32 v252, s29, v249
    v_fma_f32 v249, v13, s24, v17
    v_fmac_f32 v17, s25, v13
    v_fma_f32 v13, v11, s24, v15
    v_fmac_f32 v15, s25, v11
    v_fma_f32 v11, v15, s26, v17
    v_fmac_f32 v17, s27, v15
    v_fma_f32 v15, v13, s28, v249
    v_fmac_f32 v249, s29, v13
    v_cvt_pk_bf16_f32 v11, v248, v11
    v_cvt_pk_bf16_f32 v17, v251, v17
    v_cvt_pk_bf16_f32 v15, v250, v15
    v_cvt_pk_bf16_f32 v13, v252, v249
    v_lshrrev_b32 v252, 15, v255
    ds_write_b64 v252, v[8:9] offset:34048
    ds_write_b64 v252, v[10:11] offset:768
    ds_write_b64 v252, v[16:17] offset:2848
    ds_write_b64 v252, v[14:15] offset:4928
    ds_write_b64 v252, v[12:13] offset:7008
    ds_write_b64 v252, v[18:19] offset:36128
    ds_read_b128 v[56:59], v253 offset:39520
    s_mov_b32 s45, 573637648
    v_bfe_u32 v60, v254, 5, 3
    v_mul_u32_u24 v61, 5, v60
    v_bfe_u32 v61, s45, v61, 5
    v_mul_u32_u24 v61, 65, v61
    v_sub_u32 v61, v61, v60
    v_lshl_add_u32 v60, v61, 5, v253
    s_waitcnt lgkmcnt(0)
    s_mov_b64 exec, s[46:47]
    ds_write_b128 v60, v[56:59] offset:1024
    s_mov_b64 exec, -1
    s_waitcnt vmcnt(44)
    v_lshlrev_b32 v248, 16, v22
    v_lshlrev_b32 v249, 16, v24
    v_lshlrev_b32 v250, 16, v26
    v_lshlrev_b32 v251, 16, v28
    v_and_b32 v22, s22, v22
    v_and_b32 v24, s22, v24
    v_and_b32 v26, s22, v26
    v_and_b32 v28, s22, v28
    v_lshlrev_b32 v252, 16, v20
    v_and_b32 v20, s22, v20
    v_add_f32 v252, v252, v251
    v_add_f32 v20, v20, v28
    v_fmac_f32 v252, s23, v249
    v_fmac_f32 v20, s23, v24
    v_cvt_pk_bf16_f32 v20, v252, v20
    v_lshlrev_b32 v252, 16, v30
    v_and_b32 v30, s22, v30
    v_add_f32 v252, v252, v248
    v_add_f32 v30, v30, v22
    v_fmac_f32 v252, s23, v250
    v_fmac_f32 v30, s23, v26
    v_cvt_pk_bf16_f32 v30, v252, v30
    v_fma_f32 v252, v249, s24, v251
    v_fmac_f32 v251, s25, v249
    v_fma_f32 v249, v248, s24, v250
    v_fmac_f32 v250, s25, v248
    v_fma_f32 v248, v250, s26, v251
    v_fmac_f32 v251, s27, v250
    v_fma_f32 v250, v249, s28, v252
    v_fmac_f32 v252, s29, v249
    v_fma_f32 v249, v24, s24, v28
    v_fmac_f32 v28, s25, v24
    v_fma_f32 v24, v22, s24, v26
    v_fmac_f32 v26, s25, v22
    v_fma_f32 v22, v26, s26, v28
    v_fmac_f32 v28, s27, v26
    v_fma_f32 v26, v24, s28, v249
    v_fmac_f32 v249, s29, v24
    v_cvt_pk_bf16_f32 v22, v248, v22
    v_cvt_pk_bf16_f32 v28, v251, v28
    v_cvt_pk_bf16_f32 v26, v250, v26
    v_cvt_pk_bf16_f32 v24, v252, v249
    v_lshlrev_b32 v248, 16, v23
    v_lshlrev_b32 v249, 16, v25
    v_lshlrev_b32 v250, 16, v27
    v_lshlrev_b32 v251, 16, v29
    v_and_b32 v23, s22, v23
    v_and_b32 v25, s22, v25
    v_and_b32 v27, s22, v27
    v_and_b32 v29, s22, v29
    v_lshlrev_b32 v252, 16, v21
    v_and_b32 v21, s22, v21
    v_add_f32 v252, v252, v251
    v_add_f32 v21, v21, v29
    v_fmac_f32 v252, s23, v249
    v_fmac_f32 v21, s23, v25
    v_cvt_pk_bf16_f32 v21, v252, v21
    v_lshlrev_b32 v252, 16, v31
    v_and_b32 v31, s22, v31
    v_add_f32 v252, v252, v248
    v_add_f32 v31, v31, v23
    v_fmac_f32 v252, s23, v250
    v_fmac_f32 v31, s23, v27
    v_cvt_pk_bf16_f32 v31, v252, v31
    v_fma_f32 v252, v249, s24, v251
    v_fmac_f32 v251, s25, v249
    v_fma_f32 v249, v248, s24, v250
    v_fmac_f32 v250, s25, v248
    v_fma_f32 v248, v250, s26, v251
    v_fmac_f32 v251, s27, v250
    v_fma_f32 v250, v249, s28, v252
    v_fmac_f32 v252, s29, v249
    v_fma_f32 v249, v25, s24, v29
    v_fmac_f32 v29, s25, v25
    v_fma_f32 v25, v23, s24, v27
    v_fmac_f32 v27, s25, v23
    v_fma_f32 v23, v27, s26, v29
    v_fmac_f32 v29, s27, v27
    v_fma_f32 v27, v25, s28, v249
    v_fmac_f32 v249, s29, v25
    v_cvt_pk_bf16_f32 v23, v248, v23
    v_cvt_pk_bf16_f32 v29, v251, v29
    v_cvt_pk_bf16_f32 v27, v250, v27
    v_cvt_pk_bf16_f32 v25, v252, v249
    v_lshrrev_b32 v252, 15, v255
    ds_write_b64 v252, v[20:21] offset:33792
    ds_write_b64 v252, v[22:23] offset:512
    ds_write_b64 v252, v[28:29] offset:2592
    ds_write_b64 v252, v[26:27] offset:4672
    ds_write_b64 v252, v[24:25] offset:6752
    ds_write_b64 v252, v[30:31] offset:35872
    s_waitcnt vmcnt(38)
    v_lshlrev_b32 v248, 16, v34
    v_lshlrev_b32 v249, 16, v36
    v_lshlrev_b32 v250, 16, v38
    v_lshlrev_b32 v251, 16, v40
    v_and_b32 v34, s22, v34
    v_and_b32 v36, s22, v36
    v_and_b32 v38, s22, v38
    v_and_b32 v40, s22, v40
    v_lshlrev_b32 v252, 16, v32
    v_and_b32 v32, s22, v32
    v_add_f32 v252, v252, v251
    v_add_f32 v32, v32, v40
    v_fmac_f32 v252, s23, v249
    v_fmac_f32 v32, s23, v36
    v_cvt_pk_bf16_f32 v32, v252, v32
    v_lshlrev_b32 v252, 16, v42
    v_and_b32 v42, s22, v42
    v_add_f32 v252, v252, v248
    v_add_f32 v42, v42, v34
    v_fmac_f32 v252, s23, v250
    v_fmac_f32 v42, s23, v38
    v_cvt_pk_bf16_f32 v42, v252, v42
    v_fma_f32 v252, v249, s24, v251
    v_fmac_f32 v251, s25, v249
    v_fma_f32 v249, v248, s24, v250
    v_fmac_f32 v250, s25, v248
    v_fma_f32 v248, v250, s26, v251
    v_fmac_f32 v251, s27, v250
    v_fma_f32 v250, v249, s28, v252
    v_fmac_f32 v252, s29, v249
    v_fma_f32 v249, v36, s24, v40
    v_fmac_f32 v40, s25, v36
    v_fma_f32 v36, v34, s24, v38
    v_fmac_f32 v38, s25, v34
    v_fma_f32 v34, v38, s26, v40
    v_fmac_f32 v40, s27, v38
    v_fma_f32 v38, v36, s28, v249
    v_fmac_f32 v249, s29, v36
    v_cvt_pk_bf16_f32 v34, v248, v34
    v_cvt_pk_bf16_f32 v40, v251, v40
    v_cvt_pk_bf16_f32 v38, v250, v38
    v_cvt_pk_bf16_f32 v36, v252, v249
    v_lshlrev_b32 v248, 16, v35
    v_lshlrev_b32 v249, 16, v37
    v_lshlrev_b32 v250, 16, v39
    v_lshlrev_b32 v251, 16, v41
    v_and_b32 v35, s22, v35
    v_and_b32 v37, s22, v37
    v_and_b32 v39, s22, v39
    v_and_b32 v41, s22, v41
    v_lshlrev_b32 v252, 16, v33
    v_and_b32 v33, s22, v33
    v_add_f32 v252, v252, v251
    v_add_f32 v33, v33, v41
    v_fmac_f32 v252, s23, v249
    v_fmac_f32 v33, s23, v37
    v_cvt_pk_bf16_f32 v33, v252, v33
    v_lshlrev_b32 v252, 16, v43
    v_and_b32 v43, s22, v43
    v_add_f32 v252, v252, v248
    v_add_f32 v43, v43, v35
    v_fmac_f32 v252, s23, v250
    v_fmac_f32 v43, s23, v39
    v_cvt_pk_bf16_f32 v43, v252, v43
    v_fma_f32 v252, v249, s24, v251
    v_fmac_f32 v251, s25, v249
    v_fma_f32 v249, v248, s24, v250
    v_fmac_f32 v250, s25, v248
    v_fma_f32 v248, v250, s26, v251
    v_fmac_f32 v251, s27, v250
    v_fma_f32 v250, v249, s28, v252
    v_fmac_f32 v252, s29, v249
    v_fma_f32 v249, v37, s24, v41
    v_fmac_f32 v41, s25, v37
    v_fma_f32 v37, v35, s24, v39
    v_fmac_f32 v39, s25, v35
    v_fma_f32 v35, v39, s26, v41
    v_fmac_f32 v41, s27, v39
    v_fma_f32 v39, v37, s28, v249
    v_fmac_f32 v249, s29, v37
    v_cvt_pk_bf16_f32 v35, v248, v35
    v_cvt_pk_bf16_f32 v41, v251, v41
    v_cvt_pk_bf16_f32 v39, v250, v39
    v_cvt_pk_bf16_f32 v37, v252, v249
    v_lshrrev_b32 v252, 15, v255
    ds_write_b64 v252, v[32:33] offset:33536
    ds_write_b64 v252, v[34:35] offset:256
    ds_write_b64 v252, v[40:41] offset:2336
    ds_write_b64 v252, v[38:39] offset:4416
    ds_write_b64 v252, v[36:37] offset:6496
    ds_write_b64 v252, v[42:43] offset:35616
    s_waitcnt vmcnt(32)
    v_lshlrev_b32 v248, 16, v46
    v_lshlrev_b32 v249, 16, v48
    v_lshlrev_b32 v250, 16, v50
    v_lshlrev_b32 v251, 16, v52
    v_and_b32 v46, s22, v46
    v_and_b32 v48, s22, v48
    v_and_b32 v50, s22, v50
    v_and_b32 v52, s22, v52
    v_lshlrev_b32 v252, 16, v44
    v_and_b32 v44, s22, v44
    v_add_f32 v252, v252, v251
    v_add_f32 v44, v44, v52
    v_fmac_f32 v252, s23, v249
    v_fmac_f32 v44, s23, v48
    v_cvt_pk_bf16_f32 v44, v252, v44
    v_lshlrev_b32 v252, 16, v54
    v_and_b32 v54, s22, v54
    v_add_f32 v252, v252, v248
    v_add_f32 v54, v54, v46
    v_fmac_f32 v252, s23, v250
    v_fmac_f32 v54, s23, v50
    v_cvt_pk_bf16_f32 v54, v252, v54
    v_fma_f32 v252, v249, s24, v251
    v_fmac_f32 v251, s25, v249
    v_fma_f32 v249, v248, s24, v250
    v_fmac_f32 v250, s25, v248
    v_fma_f32 v248, v250, s26, v251
    v_fmac_f32 v251, s27, v250
    v_fma_f32 v250, v249, s28, v252
    v_fmac_f32 v252, s29, v249
    v_fma_f32 v249, v48, s24, v52
    v_fmac_f32 v52, s25, v48
    v_fma_f32 v48, v46, s24, v50
    v_fmac_f32 v50, s25, v46
    v_fma_f32 v46, v50, s26, v52
    v_fmac_f32 v52, s27, v50
    v_fma_f32 v50, v48, s28, v249
    v_fmac_f32 v249, s29, v48
    v_cvt_pk_bf16_f32 v46, v248, v46
    v_cvt_pk_bf16_f32 v52, v251, v52
    v_cvt_pk_bf16_f32 v50, v250, v50
    v_cvt_pk_bf16_f32 v48, v252, v249
    v_lshlrev_b32 v248, 16, v47
    v_lshlrev_b32 v249, 16, v49
    v_lshlrev_b32 v250, 16, v51
    v_lshlrev_b32 v251, 16, v53
    v_and_b32 v47, s22, v47
    v_and_b32 v49, s22, v49
    v_and_b32 v51, s22, v51
    v_and_b32 v53, s22, v53
    v_lshlrev_b32 v252, 16, v45
    v_and_b32 v45, s22, v45
    v_add_f32 v252, v252, v251
    v_add_f32 v45, v45, v53
    v_fmac_f32 v252, s23, v249
    v_fmac_f32 v45, s23, v49
    v_cvt_pk_bf16_f32 v45, v252, v45
    v_lshlrev_b32 v252, 16, v55
    v_and_b32 v55, s22, v55
    v_add_f32 v252, v252, v248
    v_add_f32 v55, v55, v47
    v_fmac_f32 v252, s23, v250
    v_fmac_f32 v55, s23, v51
    v_cvt_pk_bf16_f32 v55, v252, v55
    v_fma_f32 v252, v249, s24, v251
    v_fmac_f32 v251, s25, v249
    v_fma_f32 v249, v248, s24, v250
    v_fmac_f32 v250, s25, v248
    v_fma_f32 v248, v250, s26, v251
    v_fmac_f32 v251, s27, v250
    v_fma_f32 v250, v249, s28, v252
    v_fmac_f32 v252, s29, v249
    v_fma_f32 v249, v49, s24, v53
    v_fmac_f32 v53, s25, v49
    v_fma_f32 v49, v47, s24, v51
    v_fmac_f32 v51, s25, v47
    v_fma_f32 v47, v51, s26, v53
    v_fmac_f32 v53, s27, v51
    v_fma_f32 v51, v49, s28, v249
    v_fmac_f32 v249, s29, v49
    v_cvt_pk_bf16_f32 v47, v248, v47
    v_cvt_pk_bf16_f32 v53, v251, v53
    v_cvt_pk_bf16_f32 v51, v250, v51
    v_cvt_pk_bf16_f32 v49, v252, v249
    v_lshrrev_b32 v252, 15, v255
    ds_write_b64 v252, v[44:45] offset:33280
    ds_write_b64 v252, v[46:47] offset:0
    ds_write_b64 v252, v[52:53] offset:2080
    ds_write_b64 v252, v[50:51] offset:4160
    ds_write_b64 v252, v[48:49] offset:6240
    ds_write_b64 v252, v[54:55] offset:35360
    s_waitcnt lgkmcnt(0)
    s_barrier
    ds_read_b128 v[228:231], v253 offset:1040
    ds_read_b128 v[232:235], v253 offset:768
    ds_read_b128 v[236:239], v253 offset:512
    s_mov_b32 s42, 39936
    s_waitcnt vmcnt(2) lgkmcnt(0)
.p2align 6
blk_loop:
    v_mfma_f32_16x16x32_bf16 a[0:3], a[192:195], v[228:231], 0
    s_waitcnt lgkmcnt(2)
    v_cvt_pk_bf16_f32 v164, v164, v165
    v_cvt_pk_bf16_f32 v165, v166, v167
    v_lshlrev_b32 v248, 16, v194
    v_mfma_f32_16x16x32_bf16 a[4:7], a[196:199], v[228:231], 0
    buffer_load_dwordx4 a[244:247], v254, s[8:11], s42 offen offset:1024
    v_lshlrev_b32 v249, 16, v196
    v_mfma_f32_16x16x32_bf16 a[8:11], a[200:203], v[228:231], 0
    ds_read_b128 v[228:231], v253 offset:256
    v_lshlrev_b32 v250, 16, v198
    v_lshlrev_b32 v251, 16, v200
    v_and_b32 v194, s22, v194
    v_mfma_f32_16x16x32_bf16 a[12:15], a[192:195], v[232:235], 0
    ds_write_b64 v5, v[164:165] offset:18624
    v_and_b32 v196, s22, v196
    v_mfma_f32_16x16x32_bf16 a[16:19], a[196:199], v[232:235], 0
    s_waitcnt vmcnt(17)
    v_cvt_pk_bf16_f32 v156, v156, v157
    v_cvt_pk_bf16_f32 v157, v158, v159
    v_and_b32 v198, s22, v198
    v_mfma_f32_16x16x32_bf16 a[20:23], a[200:203], v[232:235], 0
    buffer_load_dwordx4 a[248:251], v254, s[8:11], s42 offen offset:2048
    v_cvt_pk_bf16_f32 v158, v160, v161
    v_and_b32 v200, s22, v200
    v_mfma_f32_16x16x32_bf16 a[0:3], a[204:207], v[232:235], a[0:3]
    s_waitcnt lgkmcnt(2)
    v_cvt_pk_bf16_f32 v159, v162, v163
    v_lshlrev_b32 v252, 16, v192
    v_and_b32 v192, s22, v192
    v_mfma_f32_16x16x32_bf16 a[4:7], a[208:211], v[232:235], a[4:7]
    s_mov_b32 s42, 43008
    v_add_f32 v252, v252, v251
    v_add_f32 v192, v192, v200
    v_fmac_f32 v252, s23, v249
    v_mfma_f32_16x16x32_bf16 a[8:11], a[212:215], v[232:235], a[8:11]
    ds_read_b128 v[232:235], v253 offset:0
    v_fmac_f32 v192, s23, v196
    v_cvt_pk_bf16_f32 v192, v252, v192
    v_lshlrev_b32 v252, 16, v202
    v_mfma_f32_16x16x32_bf16 a[24:27], a[192:195], v[236:239], 0
    buffer_load_dwordx4 a[252:255], v254, s[8:11], s42 offen offset:0
    v_and_b32 v202, s22, v202
    v_mfma_f32_16x16x32_bf16 a[28:31], a[196:199], v[236:239], 0
    ds_write_b128 v4, v[156:159] offset:18560
    v_add_f32 v252, v252, v248
    v_mfma_f32_16x16x32_bf16 a[32:35], a[200:203], v[236:239], 0
    v_cvt_pk_bf16_f32 v176, v176, v177
    v_cvt_pk_bf16_f32 v177, v178, v179
    v_add_f32 v202, v202, v194
    v_fmac_f32 v252, s23, v250
    v_mfma_f32_16x16x32_bf16 a[12:15], a[204:207], v[236:239], a[12:15]
    s_waitcnt vmcnt(16)
    v_fmac_f32 v202, s23, v198
    v_cvt_pk_bf16_f32 v202, v252, v202
    v_fma_f32 v252, v249, s24, v251
    v_mfma_f32_16x16x32_bf16 a[16:19], a[208:211], v[236:239], a[16:19]
    buffer_load_dwordx4 v[240:243], v254, s[8:11], s42 offen offset:1024
    v_fmac_f32 v251, s25, v249
    v_mfma_f32_16x16x32_bf16 a[20:23], a[212:215], v[236:239], a[20:23]
    ds_write_b64 v5, v[176:177] offset:19008
    v_cvt_pk_bf16_f32 v168, v168, v169
    v_fma_f32 v249, v248, s24, v250
    v_mfma_f32_16x16x32_bf16 a[0:3], a[216:219], v[236:239], a[0:3]
    s_waitcnt lgkmcnt(4)
    v_cvt_pk_bf16_f32 v169, v170, v171
    v_cvt_pk_bf16_f32 v170, v172, v173
    v_fmac_f32 v250, s25, v248
    v_mfma_f32_16x16x32_bf16 a[4:7], a[220:223], v[236:239], a[4:7]
    buffer_load_dwordx4 v[244:247], v254, s[8:11], s42 offen offset:2048
    v_fma_f32 v248, v250, s26, v251
    v_mfma_f32_16x16x32_bf16 a[8:11], a[224:227], v[236:239], a[8:11]
    ds_read_b128 v[236:239], v253 offset:1824
    v_and_b32 v227, 0x7fff, v255
    v_cvt_pk_bf16_f32 v171, v174, v175
    v_fmac_f32 v251, s27, v250
    v_mfma_f32_16x16x32_bf16 a[36:39], a[192:195], v[228:231], 0
    ds_write_b128 v4, v[168:171] offset:18944
    v_fma_f32 v250, v249, s28, v252
    v_mfma_f32_16x16x32_bf16 a[40:43], a[196:199], v[228:231], 0
    buffer_load_dwordx2 v[216:217], v227, s[4:7], s16 offen offset:832
    v_cvt_pk_bf16_f32 v188, v188, v189
    v_fmac_f32 v252, s29, v249
    v_mfma_f32_16x16x32_bf16 a[44:47], a[200:203], v[228:231], 0
    v_cvt_pk_bf16_f32 v189, v190, v191
    v_fma_f32 v249, v196, s24, v200
    v_fmac_f32 v200, s25, v196
    v_mfma_f32_16x16x32_bf16 a[24:27], a[204:207], v[228:231], a[24:27]
    v_fma_f32 v196, v194, s24, v198
    v_fmac_f32 v198, s25, v194
    v_fma_f32 v194, v198, s26, v200
    v_mfma_f32_16x16x32_bf16 a[28:31], a[208:211], v[228:231], a[28:31]
    buffer_load_dwordx2 v[218:219], v227, s[4:7], s17 offen offset:832
    v_fmac_f32 v200, s27, v198
    v_fma_f32 v198, v196, s28, v249
    v_mfma_f32_16x16x32_bf16 a[32:35], a[212:215], v[228:231], a[32:35]
    ds_write_b64 v5, v[188:189] offset:19392
    v_fmac_f32 v249, s29, v196
    v_mfma_f32_16x16x32_bf16 a[12:15], a[216:219], v[228:231], a[12:15]
    s_waitcnt lgkmcnt(5)
    v_cvt_pk_bf16_f32 v180, v180, v181
    v_cvt_pk_bf16_f32 v181, v182, v183
    v_cvt_pk_bf16_f32 v194, v248, v194
    v_mfma_f32_16x16x32_bf16 a[16:19], a[220:223], v[228:231], a[16:19]
    buffer_load_dwordx2 v[220:221], v227, s[4:7], s18 offen offset:832
    v_cvt_pk_bf16_f32 v182, v184, v185
    v_cvt_pk_bf16_f32 v200, v251, v200
    v_mfma_f32_16x16x32_bf16 a[20:23], a[224:227], v[228:231], a[20:23]
    ds_read_b128 v[228:231], v253 offset:1568
    v_cvt_pk_bf16_f32 v183, v186, v187
    v_cvt_pk_bf16_f32 v198, v250, v198
    v_mfma_f32_16x16x32_bf16 a[48:51], a[192:195], v[232:235], 0
    ds_write_b128 v4, v[180:183] offset:19328
    v_cvt_pk_bf16_f32 v196, v252, v249
    v_mfma_f32_16x16x32_bf16 a[52:55], a[196:199], v[232:235], 0
    s_waitcnt lgkmcnt(0)
    v_lshlrev_b32 v248, 16, v195
    v_lshlrev_b32 v249, 16, v197
    v_lshlrev_b32 v250, 16, v199
    v_lshlrev_b32 v251, 16, v201
    v_mfma_f32_16x16x32_bf16 a[56:59], a[200:203], v[232:235], 0
    s_barrier
    v_and_b32 v195, s22, v195
    v_mfma_f32_16x16x32_bf16 a[36:39], a[204:207], v[232:235], a[36:39]
    buffer_load_dwordx2 v[222:223], v227, s[4:7], s19 offen offset:832
    v_and_b32 v197, s22, v197
    v_mfma_f32_16x16x32_bf16 a[40:43], a[208:211], v[232:235], a[40:43]
    ds_read_b128 v[144:147], v6 offset:16640
    v_and_b32 v199, s22, v199
    v_and_b32 v201, s22, v201
    v_lshlrev_b32 v252, 16, v193
    v_mfma_f32_16x16x32_bf16 a[44:47], a[212:215], v[232:235], a[44:47]
    v_and_b32 v193, s22, v193
    v_add_f32 v252, v252, v251
    v_add_f32 v193, v193, v201
    v_mfma_f32_16x16x32_bf16 a[24:27], a[216:219], v[232:235], a[24:27]
    buffer_load_dwordx2 v[224:225], v227, s[4:7], s20 offen offset:832
    v_fmac_f32 v252, s23, v249
    v_mfma_f32_16x16x32_bf16 a[28:31], a[220:223], v[232:235], a[28:31]
    v_fmac_f32 v193, s23, v197
    v_cvt_pk_bf16_f32 v193, v252, v193
    v_lshlrev_b32 v252, 16, v203
    v_and_b32 v203, s22, v203
    v_mfma_f32_16x16x32_bf16 a[32:35], a[224:227], v[232:235], a[32:35]
    ds_read_b128 v[232:235], v253 offset:1312
    s_add_u32 s44, s41, 0
    v_add_f32 v252, v252, v248
    v_mfma_f32_16x16x32_bf16 a[60:63], a[192:195], v[236:239], 0
    buffer_load_dwordx2 v[226:227], v227, s[4:7], s21 offen offset:832
    v_add_f32 v203, v203, v195
    v_mfma_f32_16x16x32_bf16 a[64:67], a[196:199], v[236:239], 0
    v_fmac_f32 v252, s23, v250
    v_fmac_f32 v203, s23, v199
    v_cvt_pk_bf16_f32 v203, v252, v203
    v_fma_f32 v252, v249, s24, v251
    v_mfma_f32_16x16x32_bf16 a[68:71], a[200:203], v[236:239], 0
    v_fmac_f32 v251, s25, v249
    v_fma_f32 v249, v248, s24, v250
    v_fmac_f32 v250, s25, v248
    v_mfma_f32_16x16x32_bf16 a[48:51], a[204:207], v[236:239], a[48:51]
    ds_read_b128 v[148:151], v6 offset:17664
    v_fma_f32 v248, v250, s26, v251
    v_fmac_f32 v251, s27, v250
    v_fma_f32 v250, v249, s28, v252
    v_mfma_f32_16x16x32_bf16 a[52:55], a[208:211], v[236:239], a[52:55]
    s_waitcnt lgkmcnt(2)
    v_fmac_f32 v252, s29, v249
    v_fma_f32 v249, v197, s24, v201
    v_fmac_f32 v201, s25, v197
    v_mfma_f32_16x16x32_bf16 a[56:59], a[212:215], v[236:239], a[56:59]
    v_fma_f32 v197, v195, s24, v199
    v_fmac_f32 v199, s25, v195
    v_fma_f32 v195, v199, s26, v201
    v_mfma_f32_16x16x32_bf16 a[36:39], a[216:219], v[236:239], a[36:39]
    v_fmac_f32 v201, s27, v199
    v_fma_f32 v199, v197, s28, v249
    v_fmac_f32 v249, s29, v197
    v_cvt_pk_bf16_f32 v195, v248, v195
    v_mfma_f32_16x16x32_bf16 a[40:43], a[220:223], v[236:239], a[40:43]
    v_cvt_pk_bf16_f32 v201, v251, v201
    v_cvt_pk_bf16_f32 v199, v250, v199
    v_cvt_pk_bf16_f32 v197, v252, v249
    v_mfma_f32_16x16x32_bf16 a[44:47], a[224:227], v[236:239], a[44:47]
    ds_read_b128 v[236:239], v253 offset:1056
    v_lshrrev_b32 v252, 15, v255
    v_mfma_f32_16x16x32_bf16 a[72:75], a[192:195], v[228:231], 0
    ds_write_b64 v252, v[194:195] offset:9088
    s_waitcnt vmcnt(18)
    v_lshlrev_b32 v248, 16, v206
    v_mfma_f32_16x16x32_bf16 a[76:79], a[196:199], v[228:231], 0
    buffer_store_dwordx4 v[144:147], v254, s[12:15], s44 offen sc1
    v_lshlrev_b32 v249, 16, v208
    v_mfma_f32_16x16x32_bf16 a[80:83], a[200:203], v[228:231], 0
    ds_write_b64 v252, v[200:201] offset:11168
    v_lshlrev_b32 v250, 16, v210
    v_mfma_f32_16x16x32_bf16 a[60:63], a[204:207], v[228:231], a[60:63]
    ds_read_b128 v[152:155], v6 offset:18688
    v_lshlrev_b32 v251, 16, v212
    v_mfma_f32_16x16x32_bf16 a[64:67], a[208:211], v[228:231], a[64:67]
    ds_write_b64 v252, v[198:199] offset:13248
    v_and_b32 v206, s22, v206
    v_mfma_f32_16x16x32_bf16 a[68:71], a[212:215], v[228:231], a[68:71]
    s_waitcnt lgkmcnt(6)
    v_and_b32 v208, s22, v208
    v_mfma_f32_16x16x32_bf16 a[48:51], a[216:219], v[228:231], a[48:51]
    s_add_u32 s44, s41, 1024
    v_mfma_f32_16x16x32_bf16 a[52:55], a[220:223], v[228:231], a[52:55]
    ds_write_b64 v252, v[192:193] offset:15328
    v_and_b32 v210, s22, v210
    v_mfma_f32_16x16x32_bf16 a[56:59], a[224:227], v[228:231], a[56:59]
    ds_read_b128 v[228:231], v253 offset:784
    v_and_b32 v212, s22, v212
    v_mfma_f32_16x16x32_bf16 a[84:87], a[192:195], v[232:235], 0
    ds_write_b64 v252, v[202:203] offset:38208
    v_mfma_f32_16x16x32_bf16 a[88:91], a[196:199], v[232:235], 0
    v_mfma_f32_16x16x32_bf16 a[92:95], a[200:203], v[232:235], 0
    s_mov_b32 s42, 73728
    v_mfma_f32_16x16x32_bf16 a[72:75], a[204:207], v[232:235], a[72:75]
    buffer_load_dwordx4 a[192:195], v254, s[8:11], s42 offen offset:0
    v_mfma_f32_16x16x32_bf16 a[76:79], a[208:211], v[232:235], a[76:79]
    ds_read_b128 v[156:159], v6 offset:19744
    s_waitcnt lgkmcnt(9)
    v_mfma_f32_16x16x32_bf16 a[80:83], a[212:215], v[232:235], a[80:83]
    ds_write_b64 v252, v[196:197] offset:31968
    v_mfma_f32_16x16x32_bf16 a[60:63], a[216:219], v[232:235], a[60:63]
    buffer_load_dwordx4 a[196:199], v254, s[8:11], s42 offen offset:1024
    v_mfma_f32_16x16x32_bf16 a[64:67], a[220:223], v[232:235], a[64:67]
    v_lshlrev_b32 v252, 16, v204
    v_and_b32 v204, s22, v204
    v_mfma_f32_16x16x32_bf16 a[68:71], a[224:227], v[232:235], a[68:71]
    s_waitcnt lgkmcnt(9)
    v_add_f32 v252, v252, v251
    v_add_f32 v204, v204, v212
    v_mfma_f32_16x16x32_bf16 a[84:87], a[204:207], v[236:239], a[84:87]
    ds_read_b128 v[232:235], v253 offset:3120
    v_fmac_f32 v252, s23, v249
    v_fmac_f32 v204, s23, v208
    v_mfma_f32_16x16x32_bf16 a[88:91], a[208:211], v[236:239], a[88:91]
    s_waitcnt lgkmcnt(4)
    v_cvt_pk_bf16_f32 v204, v252, v204
    v_lshlrev_b32 v252, 16, v214
    v_mfma_f32_16x16x32_bf16 a[92:95], a[212:215], v[236:239], a[92:95]
    buffer_load_dwordx4 a[200:203], v254, s[8:11], s42 offen offset:2048
    v_mfma_f32_16x16x32_bf16 a[72:75], a[216:219], v[236:239], a[72:75]
    ds_read_b128 v[160:163], v6 offset:20768
    v_and_b32 v214, s22, v214
    v_add_f32 v252, v252, v248
    v_mfma_f32_16x16x32_bf16 a[76:79], a[220:223], v[236:239], a[76:79]
    s_mov_b32 s42, 76800
    v_add_f32 v214, v214, v206
    v_fmac_f32 v252, s23, v250
    v_mfma_f32_16x16x32_bf16 a[80:83], a[224:227], v[236:239], a[80:83]
    ds_read_b128 v[236:239], v253 offset:2848
    v_fmac_f32 v214, s23, v210
    v_mfma_f32_16x16x32_bf16 a[84:87], a[216:219], v[228:231], a[84:87]
    buffer_load_dwordx4 a[204:207], v254, s[8:11], s42 offen offset:0
    v_cvt_pk_bf16_f32 v214, v252, v214
    v_mfma_f32_16x16x32_bf16 a[88:91], a[220:223], v[228:231], a[88:91]
    s_waitcnt vmcnt(17) lgkmcnt(2)
    v_fma_f32 v252, v249, s24, v251
    v_fmac_f32 v251, s25, v249
    v_mfma_f32_16x16x32_bf16 a[92:95], a[224:227], v[228:231], a[92:95]
    ds_read_b128 v[228:231], v253 offset:2592
    v_fma_f32 v249, v248, s24, v250
    v_mfma_f32_16x16x32_bf16 a[96:99], a[228:231], v[232:235], 0
    s_waitcnt lgkmcnt(1)
    v_fmac_f32 v250, s25, v248
    v_fma_f32 v248, v250, s26, v251
    v_mfma_f32_16x16x32_bf16 a[100:103], a[232:235], v[232:235], 0
    buffer_load_dwordx4 a[208:211], v254, s[8:11], s42 offen offset:1024
    v_fmac_f32 v251, s27, v250
    v_mfma_f32_16x16x32_bf16 a[104:107], a[236:239], v[232:235], 0
    ds_read_b128 v[232:235], v253 offset:2336
    v_fma_f32 v250, v249, s28, v252
    v_mfma_f32_16x16x32_bf16 a[108:111], a[228:231], v[236:239], 0
    ds_read_b128 v[164:167], v6 offset:21792
    v_fmac_f32 v252, s29, v249
    v_mfma_f32_16x16x32_bf16 a[112:115], a[232:235], v[236:239], 0
    s_waitcnt vmcnt(15)
    v_fma_f32 v249, v208, s24, v212
    v_fmac_f32 v212, s25, v208
    v_fma_f32 v208, v206, s24, v210
    v_mfma_f32_16x16x32_bf16 a[116:119], a[236:239], v[236:239], 0
    buffer_load_dwordx4 a[212:215], v254, s[8:11], s42 offen offset:2048
    v_mfma_f32_16x16x32_bf16 a[96:99], a[240:243], v[236:239], a[96:99]
    s_waitcnt lgkmcnt(2)
    v_fmac_f32 v210, s25, v206
    v_fma_f32 v206, v210, s26, v212
    v_mfma_f32_16x16x32_bf16 a[100:103], a[244:247], v[236:239], a[100:103]
    s_mov_b32 s42, 79872
    v_fmac_f32 v212, s27, v210
    v_fma_f32 v210, v208, s28, v249
    v_fmac_f32 v249, s29, v208
    v_mfma_f32_16x16x32_bf16 a[104:107], a[248:251], v[236:239], a[104:107]
    ds_read_b128 v[236:239], v253 offset:2080
    v_cvt_pk_bf16_f32 v206, v248, v206
    v_mfma_f32_16x16x32_bf16 a[120:123], a[228:231], v[228:231], 0
    buffer_load_dwordx4 a[216:219], v254, s[8:11], s42 offen offset:0
    v_mfma_f32_16x16x32_bf16 a[124:127], a[232:235], v[228:231], 0
    v_cvt_pk_bf16_f32 v212, v251, v212
    v_cvt_pk_bf16_f32 v210, v250, v210
    v_mfma_f32_16x16x32_bf16 a[128:131], a[236:239], v[228:231], 0
    v_cvt_pk_bf16_f32 v208, v252, v249
    v_lshlrev_b32 v248, 16, v207
    v_lshlrev_b32 v249, 16, v209
    v_mfma_f32_16x16x32_bf16 a[108:111], a[240:243], v[228:231], a[108:111]
    s_waitcnt vmcnt(14)
    v_lshlrev_b32 v250, 16, v211
    v_lshlrev_b32 v251, 16, v213
    v_mfma_f32_16x16x32_bf16 a[112:115], a[244:247], v[228:231], a[112:115]
    buffer_load_dwordx4 a[220:223], v254, s[8:11], s42 offen offset:1024
    v_mfma_f32_16x16x32_bf16 a[116:119], a[248:251], v[228:231], a[116:119]
    ds_read_b128 v[168:171], v6 offset:22848
    v_and_b32 v207, s22, v207
    v_and_b32 v209, s22, v209
    v_mfma_f32_16x16x32_bf16 a[96:99], a[252:255], v[228:231], a[96:99]
    s_waitcnt lgkmcnt(3)
    v_and_b32 v211, s22, v211
    v_and_b32 v213, s22, v213
    v_mfma_f32_16x16x32_bf16 a[100:103], v[240:243], v[228:231], a[100:103]
    buffer_load_dwordx4 a[224:227], v254, s[8:11], s42 offen offset:2048
    v_mfma_f32_16x16x32_bf16 a[104:107], v[244:247], v[228:231], a[104:107]
    ds_read_b128 v[228:231], v253 offset:3904
    v_and_b32 v203, 0x7fff, v255
    v_lshlrev_b32 v252, 16, v205
    v_mfma_f32_16x16x32_bf16 a[132:135], a[228:231], v[232:235], 0
    v_and_b32 v205, s22, v205
    v_add_f32 v252, v252, v251
    v_mfma_f32_16x16x32_bf16 a[136:139], a[232:235], v[232:235], 0
    buffer_load_dwordx2 v[192:193], v203, s[4:7], s16 offen offset:1216
    v_mfma_f32_16x16x32_bf16 a[140:143], a[236:239], v[232:235], 0
    v_add_f32 v205, v205, v213
    v_fmac_f32 v252, s23, v249
    v_mfma_f32_16x16x32_bf16 a[120:123], a[240:243], v[232:235], a[120:123]
    v_fmac_f32 v205, s23, v209
    v_cvt_pk_bf16_f32 v205, v252, v205
    v_lshlrev_b32 v252, 16, v215
    v_mfma_f32_16x16x32_bf16 a[124:127], a[244:247], v[232:235], a[124:127]
    buffer_load_dwordx2 v[194:195], v203, s[4:7], s17 offen offset:1216
    v_mfma_f32_16x16x32_bf16 a[128:131], a[248:251], v[232:235], a[128:131]
    ds_read_b128 v[172:175], v6 offset:23872
    v_and_b32 v215, s22, v215
    v_mfma_f32_16x16x32_bf16 a[108:111], a[252:255], v[232:235], a[108:111]
    s_waitcnt lgkmcnt(3)
    v_add_f32 v252, v252, v248
    v_add_f32 v215, v215, v207
    v_fmac_f32 v252, s23, v250
    v_mfma_f32_16x16x32_bf16 a[112:115], v[240:243], v[232:235], a[112:115]
    buffer_load_dwordx2 v[196:197], v203, s[4:7], s18 offen offset:1216
    v_mfma_f32_16x16x32_bf16 a[116:119], v[244:247], v[232:235], a[116:119]
    ds_read_b128 v[232:235], v253 offset:3648
    v_fmac_f32 v215, s23, v211
    v_mfma_f32_16x16x32_bf16 a[144:147], a[228:231], v[236:239], 0
    v_cvt_pk_bf16_f32 v215, v252, v215
    v_fma_f32 v252, v249, s24, v251
    v_fmac_f32 v251, s25, v249
    v_mfma_f32_16x16x32_bf16 a[148:151], a[232:235], v[236:239], 0
    buffer_load_dwordx2 v[198:199], v203, s[4:7], s19 offen offset:1216
    v_mfma_f32_16x16x32_bf16 a[152:155], a[236:239], v[236:239], 0
    v_fma_f32 v249, v248, s24, v250
    v_fmac_f32 v250, s25, v248
    v_mfma_f32_16x16x32_bf16 a[132:135], a[240:243], v[236:239], a[132:135]
    v_fma_f32 v248, v250, s26, v251
    v_fmac_f32 v251, s27, v250
    v_mfma_f32_16x16x32_bf16 a[136:139], a[244:247], v[236:239], a[136:139]
    buffer_load_dwordx2 v[200:201], v203, s[4:7], s20 offen offset:1216
    v_fma_f32 v250, v249, s28, v252
    v_mfma_f32_16x16x32_bf16 a[140:143], a[248:251], v[236:239], a[140:143]
    ds_read_b128 v[176:179], v6 offset:24896
    v_fmac_f32 v252, s29, v249
    v_mfma_f32_16x16x32_bf16 a[120:123], a[252:255], v[236:239], a[120:123]
    s_waitcnt lgkmcnt(3)
    v_fma_f32 v249, v209, s24, v213
    v_fmac_f32 v213, s25, v209
    v_mfma_f32_16x16x32_bf16 a[124:127], v[240:243], v[236:239], a[124:127]
    buffer_load_dwordx2 v[202:203], v203, s[4:7], s21 offen offset:1216
    v_fma_f32 v209, v207, s24, v211
    v_mfma_f32_16x16x32_bf16 a[128:131], v[244:247], v[236:239], a[128:131]
    ds_read_b128 v[236:239], v253 offset:3392
    v_fmac_f32 v211, s25, v207
    v_mfma_f32_16x16x32_bf16 a[156:159], a[228:231], v[228:231], 0
    v_fma_f32 v207, v211, s26, v213
    v_fmac_f32 v213, s27, v211
    v_mfma_f32_16x16x32_bf16 a[160:163], a[232:235], v[228:231], 0
    buffer_store_dwordx4 v[148:151], v254, s[12:15], s44 offen sc1
    s_add_u32 s44, s41, 2048
    v_fma_f32 v211, v209, s28, v249
    v_mfma_f32_16x16x32_bf16 a[164:167], a[236:239], v[228:231], 0
    v_fmac_f32 v249, s29, v209
    v_cvt_pk_bf16_f32 v207, v248, v207
    v_mfma_f32_16x16x32_bf16 a[144:147], a[240:243], v[228:231], a[144:147]
    v_cvt_pk_bf16_f32 v213, v251, v213
    v_cvt_pk_bf16_f32 v211, v250, v211
    v_mfma_f32_16x16x32_bf16 a[148:151], a[244:247], v[228:231], a[148:151]
    ds_read_b128 v[180:183], v6 offset:25952
    v_cvt_pk_bf16_f32 v209, v252, v249
    v_mfma_f32_16x16x32_bf16 a[152:155], a[248:251], v[228:231], a[152:155]
    buffer_store_dwordx4 v[152:155], v254, s[12:15], s44 offen sc1
    s_add_u32 s44, s41, 3072
    v_lshrrev_b32 v252, 15, v255
    v_mfma_f32_16x16x32_bf16 a[132:135], a[252:255], v[228:231], a[132:135]
    ds_write_b64 v252, v[206:207] offset:8832
    v_mfma_f32_16x16x32_bf16 a[136:139], v[240:243], v[228:231], a[136:139]
    s_waitcnt vmcnt(18) lgkmcnt(4)
    v_lshlrev_b32 v248, 16, v218
    v_lshlrev_b32 v249, 16, v220
    v_mfma_f32_16x16x32_bf16 a[140:143], v[244:247], v[228:231], a[140:143]
    ds_read_b128 v[228:231], v253 offset:3136
    v_mfma_f32_16x16x32_bf16 a[168:171], a[228:231], v[232:235], 0
    buffer_store_dwordx4 v[156:159], v254, s[12:15], s44 offen sc1
    s_add_u32 s44, s41, 4096
    v_mfma_f32_16x16x32_bf16 a[172:175], a[232:235], v[232:235], 0
    ds_write_b64 v252, v[212:213] offset:10912
    v_mfma_f32_16x16x32_bf16 a[176:179], a[236:239], v[232:235], 0
    v_lshlrev_b32 v250, 16, v222
    v_lshlrev_b32 v251, 16, v224
    v_mfma_f32_16x16x32_bf16 a[156:159], a[240:243], v[232:235], a[156:159]
    buffer_store_dwordx4 v[160:163], v254, s[12:15], s44 offen sc1
    s_add_u32 s44, s41, 5120
    v_mfma_f32_16x16x32_bf16 a[160:163], a[244:247], v[232:235], a[160:163]
    ds_read_b128 v[184:187], v6 offset:26976
    v_mfma_f32_16x16x32_bf16 a[164:167], a[248:251], v[232:235], a[164:167]
    ds_write_b64 v252, v[210:211] offset:12992
    v_mfma_f32_16x16x32_bf16 a[144:147], a[252:255], v[232:235], a[144:147]
    s_waitcnt lgkmcnt(6)
    v_and_b32 v218, s22, v218
    v_and_b32 v220, s22, v220
    v_mfma_f32_16x16x32_bf16 a[148:151], v[240:243], v[232:235], a[148:151]
    ds_write_b64 v252, v[204:205] offset:15072
    v_mfma_f32_16x16x32_bf16 a[152:155], v[244:247], v[232:235], a[152:155]
    ds_read_b128 v[232:235], v253 offset:2864
    v_and_b32 v222, s22, v222
    v_mfma_f32_16x16x32_bf16 a[180:183], a[228:231], v[236:239], 0
    v_and_b32 v224, s22, v224
    v_mfma_f32_16x16x32_bf16 a[184:187], a[232:235], v[236:239], 0
    ds_write_b64 v252, v[214:215] offset:37952
    v_mfma_f32_16x16x32_bf16 a[188:191], a[236:239], v[236:239], 0
    s_mov_b32 s42, 110592
    v_mfma_f32_16x16x32_bf16 a[168:171], a[240:243], v[236:239], a[168:171]
    buffer_load_dwordx4 a[228:231], v254, s[8:11], s42 offen offset:0
    v_mfma_f32_16x16x32_bf16 a[172:175], a[244:247], v[236:239], a[172:175]
    ds_read_b128 v[188:191], v6 offset:28000
    v_mfma_f32_16x16x32_bf16 a[176:179], a[248:251], v[236:239], a[176:179]
    ds_write_b64 v252, v[208:209] offset:31712
    v_mfma_f32_16x16x32_bf16 a[156:159], a[252:255], v[236:239], a[156:159]
    buffer_load_dwordx4 a[232:235], v254, s[8:11], s42 offen offset:1024
    v_mfma_f32_16x16x32_bf16 a[160:163], v[240:243], v[236:239], a[160:163]
    v_lshlrev_b32 v252, 16, v216
    v_and_b32 v216, s22, v216
    v_add_f32 v252, v252, v251
    v_mfma_f32_16x16x32_bf16 a[164:167], v[244:247], v[236:239], a[164:167]
    s_waitcnt lgkmcnt(3)
    v_add_f32 v216, v216, v224
    v_fmac_f32 v252, s23, v249
    v_mfma_f32_16x16x32_bf16 a[180:183], a[240:243], v[228:231], a[180:183]
    ds_read_b128 v[236:239], v253 offset:5200
    v_fmac_f32 v216, s23, v220
    v_mfma_f32_16x16x32_bf16 a[184:187], a[244:247], v[228:231], a[184:187]
    ds_read_b128 v[204:207], v253 offset:39712
    v_cvt_pk_bf16_f32 v216, v252, v216
    v_lshlrev_b32 v252, 16, v226
    v_mfma_f32_16x16x32_bf16 a[188:191], a[248:251], v[228:231], a[188:191]
    buffer_load_dwordx4 a[236:239], v254, s[8:11], s42 offen offset:2048
    v_mfma_f32_16x16x32_bf16 a[168:171], a[252:255], v[228:231], a[168:171]
    s_mov_b32 s45, 619910279
    v_and_b32 v226, s22, v226
    v_add_f32 v252, v252, v248
    v_mfma_f32_16x16x32_bf16 a[172:175], v[240:243], v[228:231], a[172:175]
    s_mov_b32 s42, 113664
    v_add_f32 v226, v226, v218
    v_fmac_f32 v252, s23, v250
    v_fmac_f32 v226, s23, v222
    v_mfma_f32_16x16x32_bf16 a[176:179], v[244:247], v[228:231], a[176:179]
    ds_read_b128 v[228:231], v253 offset:4928
    v_bfe_u32 v208, v254, 5, 3
    v_mfma_f32_16x16x32_bf16 a[180:183], a[252:255], v[232:235], a[180:183]
    buffer_load_dwordx4 a[240:243], v254, s[8:11], s42 offen offset:0
    v_mfma_f32_16x16x32_bf16 a[184:187], v[240:243], v[232:235], a[184:187]
    s_waitcnt vmcnt(20) lgkmcnt(2)
    v_cvt_pk_bf16_f32 v226, v252, v226
    v_fma_f32 v252, v249, s24, v251
    v_mfma_f32_16x16x32_bf16 a[188:191], v[244:247], v[232:235], a[188:191]
    ds_read_b128 v[232:235], v253 offset:4672
    v_mul_u32_u24 v209, 5, v208
    v_fmac_f32 v251, s25, v249
    v_mfma_f32_16x16x32_bf16 v[0:3], a[192:195], v[236:239], 0
    s_waitcnt lgkmcnt(1)
    v_fma_f32 v249, v248, s24, v250
    v_fmac_f32 v250, s25, v248
    v_mfma_f32_16x16x32_bf16 v[4:7], a[196:199], v[236:239], 0
    buffer_load_dwordx4 a[244:247], v254, s[8:11], s42 offen offset:1024
    v_mfma_f32_16x16x32_bf16 v[8:11], a[200:203], v[236:239], 0
    ds_read_b128 v[236:239], v253 offset:4416
    v_bfe_u32 v209, s45, v209, 5
    v_fma_f32 v248, v250, s26, v251
    v_mfma_f32_16x16x32_bf16 v[12:15], a[192:195], v[228:231], 0
    v_fmac_f32 v251, s27, v250
    v_fma_f32 v250, v249, s28, v252
    v_mfma_f32_16x16x32_bf16 v[16:19], a[196:199], v[228:231], 0
    s_waitcnt vmcnt(18)
    v_mul_u32_u24 v209, 65, v209
    v_fmac_f32 v252, s29, v249
    v_mfma_f32_16x16x32_bf16 v[20:23], a[200:203], v[228:231], 0
    buffer_load_dwordx4 a[248:251], v254, s[8:11], s42 offen offset:2048
    v_fma_f32 v249, v220, s24, v224
    v_mfma_f32_16x16x32_bf16 v[0:3], a[204:207], v[228:231], v[0:3]
    s_waitcnt lgkmcnt(1)
    v_sub_u32 v209, v209, v208
    v_fmac_f32 v224, s25, v220
    v_mfma_f32_16x16x32_bf16 v[4:7], a[208:211], v[228:231], v[4:7]
    s_mov_b32 s42, 116736
    v_fma_f32 v220, v218, s24, v222
    v_fmac_f32 v222, s25, v218
    v_mfma_f32_16x16x32_bf16 v[8:11], a[212:215], v[228:231], v[8:11]
    ds_read_b128 v[228:231], v253 offset:4160
    v_lshl_add_u32 v208, v209, 5, v253
    v_mfma_f32_16x16x32_bf16 v[24:27], a[192:195], v[232:235], 0
    buffer_load_dwordx4 a[252:255], v254, s[8:11], s42 offen offset:0
    v_fma_f32 v218, v222, s26, v224
    v_mfma_f32_16x16x32_bf16 v[28:31], a[196:199], v[232:235], 0
    v_fmac_f32 v224, s27, v222
    v_fma_f32 v222, v220, s28, v249
    v_mfma_f32_16x16x32_bf16 v[32:35], a[200:203], v[232:235], 0
    v_fmac_f32 v249, s29, v220
    v_cvt_pk_bf16_f32 v218, v248, v218
    v_mfma_f32_16x16x32_bf16 v[12:15], a[204:207], v[232:235], v[12:15]
    s_waitcnt vmcnt(17)
    v_cvt_pk_bf16_f32 v224, v251, v224
    v_cvt_pk_bf16_f32 v222, v250, v222
    v_cvt_pk_bf16_f32 v220, v252, v249
    v_mfma_f32_16x16x32_bf16 v[16:19], a[208:211], v[232:235], v[16:19]
    buffer_load_dwordx4 v[240:243], v254, s[8:11], s42 offen offset:1024
    v_mfma_f32_16x16x32_bf16 v[20:23], a[212:215], v[232:235], v[20:23]
    s_mov_b64 exec, s[46:47]
    ds_write_b128 v208, v[204:207] offset:1024
    s_mov_b64 exec, -1
    v_mfma_f32_16x16x32_bf16 v[0:3], a[216:219], v[232:235], v[0:3]
    s_waitcnt lgkmcnt(2)
    v_lshlrev_b32 v248, 16, v219
    v_lshlrev_b32 v249, 16, v221
    v_lshlrev_b32 v250, 16, v223
    v_mfma_f32_16x16x32_bf16 v[4:7], a[220:223], v[232:235], v[4:7]
    buffer_load_dwordx4 v[244:247], v254, s[8:11], s42 offen offset:2048
    v_mfma_f32_16x16x32_bf16 v[8:11], a[224:227], v[232:235], v[8:11]
    ds_read_b128 v[232:235], v253 offset:5984
    v_and_b32 v215, 0x7fff, v255
    v_mfma_f32_16x16x32_bf16 v[36:39], a[192:195], v[236:239], 0
    v_lshlrev_b32 v251, 16, v225
    v_and_b32 v219, s22, v219
    v_mfma_f32_16x16x32_bf16 v[40:43], a[196:199], v[236:239], 0
    buffer_load_dwordx2 v[204:205], v215, s[4:7], s16 offen offset:128
    v_and_b32 v221, s22, v221
    v_mfma_f32_16x16x32_bf16 v[44:47], a[200:203], v[236:239], 0
    v_and_b32 v223, s22, v223
    v_and_b32 v225, s22, v225
    v_mfma_f32_16x16x32_bf16 v[24:27], a[204:207], v[236:239], v[24:27]
    v_lshlrev_b32 v252, 16, v217
    v_and_b32 v217, s22, v217
    v_mfma_f32_16x16x32_bf16 v[28:31], a[208:211], v[236:239], v[28:31]
    buffer_load_dwordx2 v[206:207], v215, s[4:7], s17 offen offset:128
    v_add_f32 v252, v252, v251
    v_mfma_f32_16x16x32_bf16 v[32:35], a[212:215], v[236:239], v[32:35]
    v_add_f32 v217, v217, v225
    v_fmac_f32 v252, s23, v249
    v_mfma_f32_16x16x32_bf16 v[12:15], a[216:219], v[236:239], v[12:15]
    s_waitcnt lgkmcnt(2)
    v_fmac_f32 v217, s23, v221
    v_cvt_pk_bf16_f32 v217, v252, v217
    v_mfma_f32_16x16x32_bf16 v[16:19], a[220:223], v[236:239], v[16:19]
    buffer_load_dwordx2 v[208:209], v215, s[4:7], s18 offen offset:128
    v_lshlrev_b32 v252, 16, v227
    v_mfma_f32_16x16x32_bf16 v[20:23], a[224:227], v[236:239], v[20:23]
    ds_read_b128 v[236:239], v253 offset:5728
    v_and_b32 v227, s22, v227
    v_mfma_f32_16x16x32_bf16 v[48:51], a[192:195], v[228:231], 0
    v_add_f32 v252, v252, v248
    v_add_f32 v227, v227, v219
    v_mfma_f32_16x16x32_bf16 v[52:55], a[196:199], v[228:231], 0
    buffer_load_dwordx2 v[210:211], v215, s[4:7], s19 offen offset:128
    v_mfma_f32_16x16x32_bf16 v[56:59], a[200:203], v[228:231], 0
    v_fmac_f32 v252, s23, v250
    v_fmac_f32 v227, s23, v223
    v_cvt_pk_bf16_f32 v227, v252, v227
    v_mfma_f32_16x16x32_bf16 v[36:39], a[204:207], v[228:231], v[36:39]
    v_fma_f32 v252, v249, s24, v251
    v_fmac_f32 v251, s25, v249
    v_mfma_f32_16x16x32_bf16 v[40:43], a[208:211], v[228:231], v[40:43]
    buffer_load_dwordx2 v[212:213], v215, s[4:7], s20 offen offset:128
    v_mfma_f32_16x16x32_bf16 v[44:47], a[212:215], v[228:231], v[44:47]
    v_fma_f32 v249, v248, s24, v250
    v_fmac_f32 v250, s25, v248
    v_fma_f32 v248, v250, s26, v251
    v_mfma_f32_16x16x32_bf16 v[24:27], a[216:219], v[228:231], v[24:27]
    s_waitcnt lgkmcnt(1)
    v_fmac_f32 v251, s27, v250
    v_fma_f32 v250, v249, s28, v252
    v_mfma_f32_16x16x32_bf16 v[28:31], a[220:223], v[228:231], v[28:31]
    buffer_load_dwordx2 v[214:215], v215, s[4:7], s21 offen offset:128
    v_mfma_f32_16x16x32_bf16 v[32:35], a[224:227], v[228:231], v[32:35]
    ds_read_b128 v[228:231], v253 offset:5472
    v_fmac_f32 v252, s29, v249
    v_fma_f32 v249, v221, s24, v225
    v_mfma_f32_16x16x32_bf16 v[60:63], a[192:195], v[232:235], 0
    v_fmac_f32 v225, s25, v221
    v_fma_f32 v221, v219, s24, v223
    v_mfma_f32_16x16x32_bf16 v[64:67], a[196:199], v[232:235], 0
    buffer_store_dwordx4 v[164:167], v254, s[12:15], s44 offen sc1
    s_add_u32 s44, s41, 6144
    v_mfma_f32_16x16x32_bf16 v[68:71], a[200:203], v[232:235], 0
    v_fmac_f32 v223, s25, v219
    v_fma_f32 v219, v223, s26, v225
    v_mfma_f32_16x16x32_bf16 v[48:51], a[204:207], v[232:235], v[48:51]
    v_fmac_f32 v225, s27, v223
    v_fma_f32 v223, v221, s28, v249
    v_fmac_f32 v249, s29, v221
    v_mfma_f32_16x16x32_bf16 v[52:55], a[208:211], v[232:235], v[52:55]
    buffer_store_dwordx4 v[168:171], v254, s[12:15], s44 offen sc1
    s_add_u32 s44, s41, 7168
    v_mfma_f32_16x16x32_bf16 v[56:59], a[212:215], v[232:235], v[56:59]
    v_cvt_pk_bf16_f32 v219, v248, v219
    v_cvt_pk_bf16_f32 v225, v251, v225
    v_mfma_f32_16x16x32_bf16 v[36:39], a[216:219], v[232:235], v[36:39]
    s_waitcnt lgkmcnt(1)
    v_cvt_pk_bf16_f32 v223, v250, v223
    v_cvt_pk_bf16_f32 v221, v252, v249
    v_lshrrev_b32 v252, 15, v255
    v_mfma_f32_16x16x32_bf16 v[40:43], a[220:223], v[232:235], v[40:43]
    buffer_store_dwordx4 v[172:175], v254, s[12:15], s44 offen sc1
    s_add_u32 s44, s41, 8192
    v_mfma_f32_16x16x32_bf16 v[44:47], a[224:227], v[232:235], v[44:47]
    ds_read_b128 v[232:235], v253 offset:5216
    v_mfma_f32_16x16x32_bf16 v[72:75], a[192:195], v[236:239], 0
    ds_write_b64 v252, v[218:219] offset:8576
    s_waitcnt vmcnt(22)
    v_mfma_f32_16x16x32_bf16 v[76:79], a[196:199], v[236:239], 0
    buffer_store_dwordx4 v[176:179], v254, s[12:15], s44 offen sc1
    s_add_u32 s44, s41, 9216
    v_mfma_f32_16x16x32_bf16 v[80:83], a[200:203], v[236:239], 0
    v_lshlrev_b32 v248, 16, v194
    v_lshlrev_b32 v249, 16, v196
    v_mfma_f32_16x16x32_bf16 v[60:63], a[204:207], v[236:239], v[60:63]
    ds_write_b64 v252, v[224:225] offset:10656
    v_mfma_f32_16x16x32_bf16 v[64:67], a[208:211], v[236:239], v[64:67]
    s_waitcnt lgkmcnt(3)
    v_lshlrev_b32 v250, 16, v198
    v_lshlrev_b32 v251, 16, v200
    v_mfma_f32_16x16x32_bf16 v[68:71], a[212:215], v[236:239], v[68:71]
    ds_write_b64 v252, v[222:223] offset:12736
    v_mfma_f32_16x16x32_bf16 v[48:51], a[216:219], v[236:239], v[48:51]
    buffer_store_dwordx4 v[180:183], v254, s[12:15], s44 offen sc1
    v_and_b32 v194, s22, v194
    v_and_b32 v196, s22, v196
    v_mfma_f32_16x16x32_bf16 v[52:55], a[220:223], v[236:239], v[52:55]
    ds_write_b64 v252, v[216:217] offset:14816
    v_and_b32 v198, s22, v198
    v_mfma_f32_16x16x32_bf16 v[56:59], a[224:227], v[236:239], v[56:59]
    ds_read_b128 v[236:239], v253 offset:4944
    v_and_b32 v200, s22, v200
    v_mfma_f32_16x16x32_bf16 v[84:87], a[192:195], v[228:231], 0
    ds_write_b64 v252, v[226:227] offset:37696
    v_mfma_f32_16x16x32_bf16 v[88:91], a[196:199], v[228:231], 0
    v_mfma_f32_16x16x32_bf16 v[92:95], a[200:203], v[228:231], 0
    s_mov_b32 s42, 147456
    s_add_u32 s44, s41, 10240
    v_mfma_f32_16x16x32_bf16 v[72:75], a[204:207], v[228:231], v[72:75]
    buffer_load_dwordx4 a[192:195], v254, s[8:11], s42 offen offset:0
    v_mfma_f32_16x16x32_bf16 v[76:79], a[208:211], v[228:231], v[76:79]
    ds_write_b64 v252, v[220:221] offset:31456
    v_mfma_f32_16x16x32_bf16 v[80:83], a[212:215], v[228:231], v[80:83]
    v_mfma_f32_16x16x32_bf16 v[60:63], a[216:219], v[228:231], v[60:63]
    buffer_load_dwordx4 a[196:199], v254, s[8:11], s42 offen offset:1024
    v_mfma_f32_16x16x32_bf16 v[64:67], a[220:223], v[228:231], v[64:67]
    v_lshlrev_b32 v252, 16, v192
    v_and_b32 v192, s22, v192
    v_mfma_f32_16x16x32_bf16 v[68:71], a[224:227], v[228:231], v[68:71]
    s_waitcnt lgkmcnt(7)
    v_add_f32 v252, v252, v251
    v_add_f32 v192, v192, v200
    v_mfma_f32_16x16x32_bf16 v[84:87], a[204:207], v[232:235], v[84:87]
    ds_read_b128 v[228:231], v253 offset:7280
    v_fmac_f32 v252, s23, v249
    v_mfma_f32_16x16x32_bf16 v[88:91], a[208:211], v[232:235], v[88:91]
    v_fmac_f32 v192, s23, v196
    v_cvt_pk_bf16_f32 v192, v252, v192
    v_mfma_f32_16x16x32_bf16 v[92:95], a[212:215], v[232:235], v[92:95]
    buffer_load_dwordx4 a[200:203], v254, s[8:11], s42 offen offset:2048
    v_mfma_f32_16x16x32_bf16 v[72:75], a[216:219], v[232:235], v[72:75]
    s_waitcnt lgkmcnt(3)
    v_lshlrev_b32 v252, 16, v202
    v_and_b32 v202, s22, v202
    v_mfma_f32_16x16x32_bf16 v[76:79], a[220:223], v[232:235], v[76:79]
    s_mov_b32 s42, 150528
    v_add_f32 v252, v252, v248
    v_add_f32 v202, v202, v194
    v_mfma_f32_16x16x32_bf16 v[80:83], a[224:227], v[232:235], v[80:83]
    ds_read_b128 v[232:235], v253 offset:7008
    v_fmac_f32 v252, s23, v250
    v_mfma_f32_16x16x32_bf16 v[84:87], a[216:219], v[236:239], v[84:87]
    buffer_load_dwordx4 a[204:207], v254, s[8:11], s42 offen offset:0
    v_mfma_f32_16x16x32_bf16 v[88:91], a[220:223], v[236:239], v[88:91]
    s_waitcnt vmcnt(21) lgkmcnt(1)
    v_fmac_f32 v202, s23, v198
    v_cvt_pk_bf16_f32 v202, v252, v202
    v_mfma_f32_16x16x32_bf16 v[92:95], a[224:227], v[236:239], v[92:95]
    ds_read_b128 v[236:239], v253 offset:6752
    v_fma_f32 v252, v249, s24, v251
    v_mfma_f32_16x16x32_bf16 v[96:99], a[228:231], v[228:231], 0
    s_waitcnt lgkmcnt(1)
    v_fmac_f32 v251, s25, v249
    v_fma_f32 v249, v248, s24, v250
    v_mfma_f32_16x16x32_bf16 v[100:103], a[232:235], v[228:231], 0
    buffer_load_dwordx4 a[208:211], v254, s[8:11], s42 offen offset:1024
    v_mfma_f32_16x16x32_bf16 v[104:107], a[236:239], v[228:231], 0
    ds_read_b128 v[228:231], v253 offset:6496
    v_fmac_f32 v250, s25, v248
    v_mfma_f32_16x16x32_bf16 v[108:111], a[228:231], v[232:235], 0
    v_fma_f32 v248, v250, s26, v251
    v_fmac_f32 v251, s27, v250
    v_fma_f32 v250, v249, s28, v252
    v_mfma_f32_16x16x32_bf16 v[112:115], a[232:235], v[232:235], 0
    s_waitcnt vmcnt(19)
    v_fmac_f32 v252, s29, v249
    v_fma_f32 v249, v196, s24, v200
    v_mfma_f32_16x16x32_bf16 v[116:119], a[236:239], v[232:235], 0
    buffer_load_dwordx4 a[212:215], v254, s[8:11], s42 offen offset:2048
    v_mfma_f32_16x16x32_bf16 v[96:99], a[240:243], v[232:235], v[96:99]
    s_waitcnt lgkmcnt(1)
    v_fmac_f32 v200, s25, v196
    v_fma_f32 v196, v194, s24, v198
    v_mfma_f32_16x16x32_bf16 v[100:103], a[244:247], v[232:235], v[100:103]
    s_mov_b32 s42, 153600
    v_fmac_f32 v198, s25, v194
    v_fma_f32 v194, v198, s26, v200
    v_mfma_f32_16x16x32_bf16 v[104:107], a[248:251], v[232:235], v[104:107]
    ds_read_b128 v[232:235], v253 offset:6240
    v_fmac_f32 v200, s27, v198
    v_mfma_f32_16x16x32_bf16 v[120:123], a[228:231], v[236:239], 0
    buffer_load_dwordx4 a[216:219], v254, s[8:11], s42 offen offset:0
    v_mfma_f32_16x16x32_bf16 v[124:127], a[232:235], v[236:239], 0
    v_fma_f32 v198, v196, s28, v249
    v_fmac_f32 v249, s29, v196
    v_mfma_f32_16x16x32_bf16 v[128:131], a[236:239], v[236:239], 0
    v_cvt_pk_bf16_f32 v194, v248, v194
    v_cvt_pk_bf16_f32 v200, v251, v200
    v_mfma_f32_16x16x32_bf16 v[108:111], a[240:243], v[236:239], v[108:111]
    v_cvt_pk_bf16_f32 v198, v250, v198
    v_cvt_pk_bf16_f32 v196, v252, v249
    v_mfma_f32_16x16x32_bf16 v[112:115], a[244:247], v[236:239], v[112:115]
    buffer_load_dwordx4 a[220:223], v254, s[8:11], s42 offen offset:1024
    v_mfma_f32_16x16x32_bf16 v[116:119], a[248:251], v[236:239], v[116:119]
    s_waitcnt vmcnt(19)
    v_lshlrev_b32 v248, 16, v195
    v_lshlrev_b32 v249, 16, v197
    v_mfma_f32_16x16x32_bf16 v[96:99], a[252:255], v[236:239], v[96:99]
    s_waitcnt lgkmcnt(1)
    v_lshlrev_b32 v250, 16, v199
    v_lshlrev_b32 v251, 16, v201
    v_mfma_f32_16x16x32_bf16 v[100:103], v[240:243], v[236:239], v[100:103]
    buffer_load_dwordx4 a[224:227], v254, s[8:11], s42 offen offset:2048
    v_mfma_f32_16x16x32_bf16 v[104:107], v[244:247], v[236:239], v[104:107]
    ds_read_b128 v[236:239], v253 offset:8064
    v_and_b32 v227, 0x7fff, v255
    v_mfma_f32_16x16x32_bf16 v[132:135], a[228:231], v[228:231], 0
    v_and_b32 v195, s22, v195
    v_and_b32 v197, s22, v197
    v_mfma_f32_16x16x32_bf16 v[136:139], a[232:235], v[228:231], 0
    buffer_load_dwordx2 v[216:217], v227, s[4:7], s16 offen offset:512
    v_mfma_f32_16x16x32_bf16 v[140:143], a[236:239], v[228:231], 0
    v_and_b32 v199, s22, v199
    v_and_b32 v201, s22, v201
    v_mfma_f32_16x16x32_bf16 v[120:123], a[240:243], v[228:231], v[120:123]
    v_lshlrev_b32 v252, 16, v193
    v_and_b32 v193, s22, v193
    v_mfma_f32_16x16x32_bf16 v[124:127], a[244:247], v[228:231], v[124:127]
    buffer_load_dwordx2 v[218:219], v227, s[4:7], s17 offen offset:512
    v_mfma_f32_16x16x32_bf16 v[128:131], a[248:251], v[228:231], v[128:131]
    v_add_f32 v252, v252, v251
    v_add_f32 v193, v193, v201
    v_fmac_f32 v252, s23, v249
    v_mfma_f32_16x16x32_bf16 v[108:111], a[252:255], v[228:231], v[108:111]
    s_waitcnt lgkmcnt(1)
    v_fmac_f32 v193, s23, v197
    v_cvt_pk_bf16_f32 v193, v252, v193
    v_mfma_f32_16x16x32_bf16 v[112:115], v[240:243], v[228:231], v[112:115]
    buffer_load_dwordx2 v[220:221], v227, s[4:7], s18 offen offset:512
    v_mfma_f32_16x16x32_bf16 v[116:119], v[244:247], v[228:231], v[116:119]
    ds_read_b128 v[228:231], v253 offset:7808
    v_lshlrev_b32 v252, 16, v203
    v_mfma_f32_16x16x32_bf16 v[144:147], a[228:231], v[232:235], 0
    v_and_b32 v203, s22, v203
    v_add_f32 v252, v252, v248
    v_mfma_f32_16x16x32_bf16 v[148:151], a[232:235], v[232:235], 0
    buffer_load_dwordx2 v[222:223], v227, s[4:7], s19 offen offset:512
    v_mfma_f32_16x16x32_bf16 v[152:155], a[236:239], v[232:235], 0
    v_add_f32 v203, v203, v195
    v_fmac_f32 v252, s23, v250
    v_mfma_f32_16x16x32_bf16 v[132:135], a[240:243], v[232:235], v[132:135]
    v_fmac_f32 v203, s23, v199
    v_cvt_pk_bf16_f32 v203, v252, v203
    v_mfma_f32_16x16x32_bf16 v[136:139], a[244:247], v[232:235], v[136:139]
    buffer_load_dwordx2 v[224:225], v227, s[4:7], s20 offen offset:512
    v_mfma_f32_16x16x32_bf16 v[140:143], a[248:251], v[232:235], v[140:143]
    v_fma_f32 v252, v249, s24, v251
    v_fmac_f32 v251, s25, v249
    v_mfma_f32_16x16x32_bf16 v[120:123], a[252:255], v[232:235], v[120:123]
    s_waitcnt lgkmcnt(1)
    v_fma_f32 v249, v248, s24, v250
    v_fmac_f32 v250, s25, v248
    v_mfma_f32_16x16x32_bf16 v[124:127], v[240:243], v[232:235], v[124:127]
    buffer_load_dwordx2 v[226:227], v227, s[4:7], s21 offen offset:512
    v_mfma_f32_16x16x32_bf16 v[128:131], v[244:247], v[232:235], v[128:131]
    ds_read_b128 v[232:235], v253 offset:7552
    v_fma_f32 v248, v250, s26, v251
    v_mfma_f32_16x16x32_bf16 v[156:159], a[228:231], v[236:239], 0
    v_fmac_f32 v251, s27, v250
    v_fma_f32 v250, v249, s28, v252
    v_mfma_f32_16x16x32_bf16 v[160:163], a[232:235], v[236:239], 0
    buffer_store_dwordx4 v[184:187], v254, s[12:15], s44 offen sc1
    s_add_u32 s44, s41, 11264
    v_mfma_f32_16x16x32_bf16 v[164:167], a[236:239], v[236:239], 0
    v_fmac_f32 v252, s29, v249
    v_fma_f32 v249, v197, s24, v201
    v_mfma_f32_16x16x32_bf16 v[144:147], a[240:243], v[236:239], v[144:147]
    v_fmac_f32 v201, s25, v197
    v_fma_f32 v197, v195, s24, v199
    v_mfma_f32_16x16x32_bf16 v[148:151], a[244:247], v[236:239], v[148:151]
    buffer_store_dwordx4 v[188:191], v254, s[12:15], s44 offen sc1
    v_fmac_f32 v199, s25, v195
    v_fma_f32 v195, v199, s26, v201
    v_mfma_f32_16x16x32_bf16 v[152:155], a[248:251], v[236:239], v[152:155]
    v_fmac_f32 v201, s27, v199
    v_fma_f32 v199, v197, s28, v249
    v_mfma_f32_16x16x32_bf16 v[132:135], a[252:255], v[236:239], v[132:135]
    v_fmac_f32 v249, s29, v197
    v_cvt_pk_bf16_f32 v195, v248, v195
    v_mfma_f32_16x16x32_bf16 v[136:139], v[240:243], v[236:239], v[136:139]
    s_waitcnt lgkmcnt(1)
    v_cvt_pk_bf16_f32 v201, v251, v201
    v_cvt_pk_bf16_f32 v199, v250, v199
    v_cvt_pk_bf16_f32 v197, v252, v249
    v_mfma_f32_16x16x32_bf16 v[140:143], v[244:247], v[236:239], v[140:143]
    ds_read_b128 v[236:239], v253 offset:7296
    v_lshrrev_b32 v252, 15, v255
    v_mfma_f32_16x16x32_bf16 v[168:171], a[228:231], v[228:231], 0
    ds_write_b64 v252, v[194:195] offset:8320
    v_mfma_f32_16x16x32_bf16 v[172:175], a[232:235], v[228:231], 0
    s_waitcnt vmcnt(22)
    v_lshlrev_b32 v248, 16, v206
    v_lshlrev_b32 v249, 16, v208
    v_mfma_f32_16x16x32_bf16 v[176:179], a[236:239], v[228:231], 0
    ds_write_b64 v252, v[200:201] offset:10400
    v_mfma_f32_16x16x32_bf16 v[156:159], a[240:243], v[228:231], v[156:159]
    v_lshlrev_b32 v250, 16, v210
    v_lshlrev_b32 v251, 16, v212
    v_mfma_f32_16x16x32_bf16 v[160:163], a[244:247], v[228:231], v[160:163]
    ds_write_b64 v252, v[198:199] offset:12480
    v_mfma_f32_16x16x32_bf16 v[164:167], a[248:251], v[228:231], v[164:167]
    v_and_b32 v206, s22, v206
    v_and_b32 v208, s22, v208
    v_mfma_f32_16x16x32_bf16 v[144:147], a[252:255], v[228:231], v[144:147]
    ds_write_b64 v252, v[192:193] offset:14560
    v_mfma_f32_16x16x32_bf16 v[148:151], v[240:243], v[228:231], v[148:151]
    s_waitcnt lgkmcnt(5)
    v_and_b32 v210, s22, v210
    v_and_b32 v212, s22, v212
    v_mfma_f32_16x16x32_bf16 v[152:155], v[244:247], v[228:231], v[152:155]
    ds_read_b128 v[228:231], v253 offset:7024
    v_mfma_f32_16x16x32_bf16 v[180:183], a[228:231], v[232:235], 0
    ds_write_b64 v252, v[202:203] offset:37440
    v_mfma_f32_16x16x32_bf16 v[184:187], a[232:235], v[232:235], 0
    v_mfma_f32_16x16x32_bf16 v[188:191], a[236:239], v[232:235], 0
    s_mov_b32 s42, 184320
    v_mfma_f32_16x16x32_bf16 v[168:171], a[240:243], v[232:235], v[168:171]
    buffer_load_dwordx4 a[228:231], v254, s[8:11], s42 offen offset:0
    v_mfma_f32_16x16x32_bf16 v[172:175], a[244:247], v[232:235], v[172:175]
    ds_write_b64 v252, v[196:197] offset:31200
    v_mfma_f32_16x16x32_bf16 v[176:179], a[248:251], v[232:235], v[176:179]
    s_waitcnt lgkmcnt(7)
    v_mfma_f32_16x16x32_bf16 v[156:159], a[252:255], v[232:235], v[156:159]
    buffer_load_dwordx4 a[232:235], v254, s[8:11], s42 offen offset:1024
    v_mfma_f32_16x16x32_bf16 v[160:163], v[240:243], v[232:235], v[160:163]
    s_waitcnt lgkmcnt(0)
    v_lshlrev_b32 v252, 16, v204
    v_and_b32 v204, s22, v204
    v_mfma_f32_16x16x32_bf16 v[164:167], v[244:247], v[232:235], v[164:167]
    s_barrier
    v_mfma_f32_16x16x32_bf16 v[180:183], a[240:243], v[236:239], v[180:183]
    ds_read_b128 v[232:235], v253 offset:9360
    v_add_f32 v252, v252, v251
    v_add_f32 v204, v204, v212
    v_mfma_f32_16x16x32_bf16 v[184:187], a[244:247], v[236:239], v[184:187]
    v_fmac_f32 v252, s23, v249
    v_fmac_f32 v204, s23, v208
    v_mfma_f32_16x16x32_bf16 v[188:191], a[248:251], v[236:239], v[188:191]
    buffer_load_dwordx4 a[236:239], v254, s[8:11], s42 offen offset:2048
    v_mfma_f32_16x16x32_bf16 v[168:171], a[252:255], v[236:239], v[168:171]
    v_cvt_pk_bf16_f32 v204, v252, v204
    v_lshlrev_b32 v252, 16, v214
    v_mfma_f32_16x16x32_bf16 v[172:175], v[240:243], v[236:239], v[172:175]
    s_mov_b32 s42, 187392
    v_and_b32 v214, s22, v214
    v_add_f32 v252, v252, v248
    v_mfma_f32_16x16x32_bf16 v[176:179], v[244:247], v[236:239], v[176:179]
    ds_read_b128 v[236:239], v253 offset:9088
    v_add_f32 v214, v214, v206
    v_mfma_f32_16x16x32_bf16 v[180:183], a[252:255], v[228:231], v[180:183]
    buffer_load_dwordx4 a[240:243], v254, s[8:11], s42 offen offset:0
    v_mfma_f32_16x16x32_bf16 v[184:187], v[240:243], v[228:231], v[184:187]
    s_waitcnt vmcnt(18) lgkmcnt(1)
    v_fmac_f32 v252, s23, v250
    v_fmac_f32 v214, s23, v210
    v_mfma_f32_16x16x32_bf16 v[188:191], v[244:247], v[228:231], v[188:191]
    ds_read_b128 v[228:231], v253 offset:8832
    v_cvt_pk_bf16_f32 v214, v252, v214
    v_mfma_f32_16x16x32_bf16 a[0:3], a[192:195], v[232:235], a[0:3]
    s_waitcnt lgkmcnt(1)
    v_fma_f32 v252, v249, s24, v251
    v_fmac_f32 v251, s25, v249
    v_mfma_f32_16x16x32_bf16 a[4:7], a[196:199], v[232:235], a[4:7]
    buffer_load_dwordx4 a[244:247], v254, s[8:11], s42 offen offset:1024
    v_mfma_f32_16x16x32_bf16 a[8:11], a[200:203], v[232:235], a[8:11]
    ds_read_b128 v[232:235], v253 offset:8576
    v_fma_f32 v249, v248, s24, v250
    v_mfma_f32_16x16x32_bf16 a[12:15], a[192:195], v[236:239], a[12:15]
    v_fmac_f32 v250, s25, v248
    v_fma_f32 v248, v250, s26, v251
    v_mfma_f32_16x16x32_bf16 a[16:19], a[196:199], v[236:239], a[16:19]
    s_waitcnt vmcnt(16)
    v_fmac_f32 v251, s27, v250
    v_fma_f32 v250, v249, s28, v252
    v_mfma_f32_16x16x32_bf16 a[20:23], a[200:203], v[236:239], a[20:23]
    buffer_load_dwordx4 a[248:251], v254, s[8:11], s42 offen offset:2048
    v_mfma_f32_16x16x32_bf16 a[0:3], a[204:207], v[236:239], a[0:3]
    s_waitcnt lgkmcnt(1)
    v_fmac_f32 v252, s29, v249
    v_fma_f32 v249, v208, s24, v212
    v_mfma_f32_16x16x32_bf16 a[4:7], a[208:211], v[236:239], a[4:7]
    s_mov_b32 s42, 190464
    v_fmac_f32 v212, s25, v208
    v_fma_f32 v208, v206, s24, v210
    v_mfma_f32_16x16x32_bf16 a[8:11], a[212:215], v[236:239], a[8:11]
    ds_read_b128 v[236:239], v253 offset:8320
    v_fmac_f32 v210, s25, v206
    v_mfma_f32_16x16x32_bf16 a[24:27], a[192:195], v[228:231], a[24:27]
    buffer_load_dwordx4 a[252:255], v254, s[8:11], s42 offen offset:0
    v_mfma_f32_16x16x32_bf16 a[28:31], a[196:199], v[228:231], a[28:31]
    v_fma_f32 v206, v210, s26, v212
    v_fmac_f32 v212, s27, v210
    v_mfma_f32_16x16x32_bf16 a[32:35], a[200:203], v[228:231], a[32:35]
    v_fma_f32 v210, v208, s28, v249
    v_fmac_f32 v249, s29, v208
    v_cvt_pk_bf16_f32 v206, v248, v206
    v_mfma_f32_16x16x32_bf16 a[12:15], a[204:207], v[228:231], a[12:15]
    v_cvt_pk_bf16_f32 v212, v251, v212
    v_cvt_pk_bf16_f32 v210, v250, v210
    v_mfma_f32_16x16x32_bf16 a[16:19], a[208:211], v[228:231], a[16:19]
    buffer_load_dwordx4 v[240:243], v254, s[8:11], s42 offen offset:1024
    v_mfma_f32_16x16x32_bf16 a[20:23], a[212:215], v[228:231], a[20:23]
    s_waitcnt vmcnt(16)
    v_cvt_pk_bf16_f32 v208, v252, v249
    v_lshlrev_b32 v248, 16, v207
    v_mfma_f32_16x16x32_bf16 a[0:3], a[216:219], v[228:231], a[0:3]
    s_waitcnt lgkmcnt(1)
    v_lshlrev_b32 v249, 16, v209
    v_lshlrev_b32 v250, 16, v211
    v_mfma_f32_16x16x32_bf16 a[4:7], a[220:223], v[228:231], a[4:7]
    buffer_load_dwordx4 v[244:247], v254, s[8:11], s42 offen offset:2048
    v_mfma_f32_16x16x32_bf16 a[8:11], a[224:227], v[228:231], a[8:11]
    ds_read_b128 v[228:231], v253 offset:10144
    v_and_b32 v203, 0x7fff, v255
    v_mfma_f32_16x16x32_bf16 a[36:39], a[192:195], v[232:235], a[36:39]
    v_lshlrev_b32 v251, 16, v213
    v_and_b32 v207, s22, v207
    v_mfma_f32_16x16x32_bf16 a[40:43], a[196:199], v[232:235], a[40:43]
    buffer_load_dwordx2 v[192:193], v203, s[4:7], s16 offen offset:896
    v_mfma_f32_16x16x32_bf16 a[44:47], a[200:203], v[232:235], a[44:47]
    v_and_b32 v209, s22, v209
    v_and_b32 v211, s22, v211
    v_mfma_f32_16x16x32_bf16 a[24:27], a[204:207], v[232:235], a[24:27]
    v_and_b32 v213, s22, v213
    v_lshlrev_b32 v252, 16, v205
    v_mfma_f32_16x16x32_bf16 a[28:31], a[208:211], v[232:235], a[28:31]
    buffer_load_dwordx2 v[194:195], v203, s[4:7], s17 offen offset:896
    v_mfma_f32_16x16x32_bf16 a[32:35], a[212:215], v[232:235], a[32:35]
    v_and_b32 v205, s22, v205
    v_add_f32 v252, v252, v251
    v_mfma_f32_16x16x32_bf16 a[12:15], a[216:219], v[232:235], a[12:15]
    s_waitcnt lgkmcnt(1)
    v_add_f32 v205, v205, v213
    v_fmac_f32 v252, s23, v249
    v_mfma_f32_16x16x32_bf16 a[16:19], a[220:223], v[232:235], a[16:19]
    buffer_load_dwordx2 v[196:197], v203, s[4:7], s18 offen offset:896
    v_mfma_f32_16x16x32_bf16 a[20:23], a[224:227], v[232:235], a[20:23]
    ds_read_b128 v[232:235], v253 offset:9888
    v_fmac_f32 v205, s23, v209
    v_mfma_f32_16x16x32_bf16 a[48:51], a[192:195], v[236:239], a[48:51]
    v_cvt_pk_bf16_f32 v205, v252, v205
    v_lshlrev_b32 v252, 16, v215
    v_mfma_f32_16x16x32_bf16 a[52:55], a[196:199], v[236:239], a[52:55]
    buffer_load_dwordx2 v[198:199], v203, s[4:7], s19 offen offset:896
    v_mfma_f32_16x16x32_bf16 a[56:59], a[200:203], v[236:239], a[56:59]
    v_and_b32 v215, s22, v215
    v_add_f32 v252, v252, v248
    v_mfma_f32_16x16x32_bf16 a[36:39], a[204:207], v[236:239], a[36:39]
    v_add_f32 v215, v215, v207
    v_fmac_f32 v252, s23, v250
    v_mfma_f32_16x16x32_bf16 a[40:43], a[208:211], v[236:239], a[40:43]
    buffer_load_dwordx2 v[200:201], v203, s[4:7], s20 offen offset:896
    v_fmac_f32 v215, s23, v211
    v_mfma_f32_16x16x32_bf16 a[44:47], a[212:215], v[236:239], a[44:47]
    v_cvt_pk_bf16_f32 v215, v252, v215
    v_fma_f32 v252, v249, s24, v251
    v_mfma_f32_16x16x32_bf16 a[24:27], a[216:219], v[236:239], a[24:27]
    s_waitcnt lgkmcnt(1)
    v_fmac_f32 v251, s25, v249
    v_fma_f32 v249, v248, s24, v250
    v_mfma_f32_16x16x32_bf16 a[28:31], a[220:223], v[236:239], a[28:31]
    buffer_load_dwordx2 v[202:203], v203, s[4:7], s21 offen offset:896
    v_mfma_f32_16x16x32_bf16 a[32:35], a[224:227], v[236:239], a[32:35]
    ds_read_b128 v[236:239], v253 offset:9632
    v_fmac_f32 v250, s25, v248
    v_mfma_f32_16x16x32_bf16 a[60:63], a[192:195], v[228:231], a[60:63]
    v_fma_f32 v248, v250, s26, v251
    v_fmac_f32 v251, s27, v250
    v_mfma_f32_16x16x32_bf16 a[64:67], a[196:199], v[228:231], a[64:67]
    v_fma_f32 v250, v249, s28, v252
    v_fmac_f32 v252, s29, v249
    v_mfma_f32_16x16x32_bf16 a[68:71], a[200:203], v[228:231], a[68:71]
    v_fma_f32 v249, v209, s24, v213
    v_fmac_f32 v213, s25, v209
    v_mfma_f32_16x16x32_bf16 a[48:51], a[204:207], v[228:231], a[48:51]
    v_fma_f32 v209, v207, s24, v211
    v_fmac_f32 v211, s25, v207
    v_mfma_f32_16x16x32_bf16 a[52:55], a[208:211], v[228:231], a[52:55]
    v_fma_f32 v207, v211, s26, v213
    v_fmac_f32 v213, s27, v211
    v_mfma_f32_16x16x32_bf16 a[56:59], a[212:215], v[228:231], a[56:59]
    v_fma_f32 v211, v209, s28, v249
    v_fmac_f32 v249, s29, v209
    v_mfma_f32_16x16x32_bf16 a[36:39], a[216:219], v[228:231], a[36:39]
    v_cvt_pk_bf16_f32 v207, v248, v207
    v_cvt_pk_bf16_f32 v213, v251, v213
    v_mfma_f32_16x16x32_bf16 a[40:43], a[220:223], v[228:231], a[40:43]
    s_waitcnt lgkmcnt(1)
    v_cvt_pk_bf16_f32 v211, v250, v211
    v_cvt_pk_bf16_f32 v209, v252, v249
    v_mfma_f32_16x16x32_bf16 a[44:47], a[224:227], v[228:231], a[44:47]
    ds_read_b128 v[228:231], v253 offset:9376
    v_lshrrev_b32 v252, 15, v255
    v_mfma_f32_16x16x32_bf16 a[72:75], a[192:195], v[232:235], a[72:75]
    ds_write_b64 v252, v[206:207] offset:768
    v_mfma_f32_16x16x32_bf16 a[76:79], a[196:199], v[232:235], a[76:79]
    s_waitcnt vmcnt(17)
    v_lshlrev_b32 v248, 16, v218
    v_lshlrev_b32 v249, 16, v220
    v_mfma_f32_16x16x32_bf16 a[80:83], a[200:203], v[232:235], a[80:83]
    ds_write_b64 v252, v[212:213] offset:2848
    v_mfma_f32_16x16x32_bf16 a[60:63], a[204:207], v[232:235], a[60:63]
    v_lshlrev_b32 v250, 16, v222
    v_lshlrev_b32 v251, 16, v224
    v_mfma_f32_16x16x32_bf16 a[64:67], a[208:211], v[232:235], a[64:67]
    ds_write_b64 v252, v[210:211] offset:4928
    v_mfma_f32_16x16x32_bf16 a[68:71], a[212:215], v[232:235], a[68:71]
    v_and_b32 v218, s22, v218
    v_and_b32 v220, s22, v220
    v_mfma_f32_16x16x32_bf16 a[48:51], a[216:219], v[232:235], a[48:51]
    ds_write_b64 v252, v[204:205] offset:17408
    v_and_b32 v222, s22, v222
    v_mfma_f32_16x16x32_bf16 a[52:55], a[220:223], v[232:235], a[52:55]
    s_waitcnt lgkmcnt(5)
    v_and_b32 v224, s22, v224
    v_mfma_f32_16x16x32_bf16 a[56:59], a[224:227], v[232:235], a[56:59]
    ds_read_b128 v[232:235], v253 offset:9104
    v_mfma_f32_16x16x32_bf16 a[84:87], a[192:195], v[236:239], a[84:87]
    ds_write_b64 v252, v[214:215] offset:25728
    v_mfma_f32_16x16x32_bf16 a[88:91], a[196:199], v[236:239], a[88:91]
    v_mfma_f32_16x16x32_bf16 a[92:95], a[200:203], v[236:239], a[92:95]
    s_mov_b32 s42, 221184
    v_mfma_f32_16x16x32_bf16 a[72:75], a[204:207], v[236:239], a[72:75]
    buffer_load_dwordx4 a[192:195], v254, s[8:11], s42 offen offset:0
    v_mfma_f32_16x16x32_bf16 a[76:79], a[208:211], v[236:239], a[76:79]
    ds_write_b64 v252, v[208:209] offset:7008
    v_mfma_f32_16x16x32_bf16 a[80:83], a[212:215], v[236:239], a[80:83]
    v_mfma_f32_16x16x32_bf16 a[60:63], a[216:219], v[236:239], a[60:63]
    buffer_load_dwordx4 a[196:199], v254, s[8:11], s42 offen offset:1024
    v_mfma_f32_16x16x32_bf16 a[64:67], a[220:223], v[236:239], a[64:67]
    v_lshlrev_b32 v252, 16, v216
    v_and_b32 v216, s22, v216
    v_mfma_f32_16x16x32_bf16 a[68:71], a[224:227], v[236:239], a[68:71]
    s_waitcnt lgkmcnt(7)
    v_add_f32 v252, v252, v251
    v_add_f32 v216, v216, v224
    v_mfma_f32_16x16x32_bf16 a[84:87], a[204:207], v[228:231], a[84:87]
    ds_read_b128 v[236:239], v253 offset:11440
    v_fmac_f32 v252, s23, v249
    v_mfma_f32_16x16x32_bf16 a[88:91], a[208:211], v[228:231], a[88:91]
    v_fmac_f32 v216, s23, v220
    v_cvt_pk_bf16_f32 v216, v252, v216
    v_mfma_f32_16x16x32_bf16 a[92:95], a[212:215], v[228:231], a[92:95]
    buffer_load_dwordx4 a[200:203], v254, s[8:11], s42 offen offset:2048
    v_mfma_f32_16x16x32_bf16 a[72:75], a[216:219], v[228:231], a[72:75]
    s_waitcnt lgkmcnt(3)
    v_lshlrev_b32 v252, 16, v226
    v_and_b32 v226, s22, v226
    v_mfma_f32_16x16x32_bf16 a[76:79], a[220:223], v[228:231], a[76:79]
    s_mov_b32 s42, 224256
    v_add_f32 v252, v252, v248
    v_add_f32 v226, v226, v218
    v_mfma_f32_16x16x32_bf16 a[80:83], a[224:227], v[228:231], a[80:83]
    ds_read_b128 v[228:231], v253 offset:11168
    v_fmac_f32 v252, s23, v250
    v_mfma_f32_16x16x32_bf16 a[84:87], a[216:219], v[232:235], a[84:87]
    buffer_load_dwordx4 a[204:207], v254, s[8:11], s42 offen offset:0
    v_mfma_f32_16x16x32_bf16 a[88:91], a[220:223], v[232:235], a[88:91]
    s_waitcnt vmcnt(16) lgkmcnt(1)
    v_fmac_f32 v226, s23, v222
    v_cvt_pk_bf16_f32 v226, v252, v226
    v_mfma_f32_16x16x32_bf16 a[92:95], a[224:227], v[232:235], a[92:95]
    ds_read_b128 v[232:235], v253 offset:10912
    v_fma_f32 v252, v249, s24, v251
    v_mfma_f32_16x16x32_bf16 a[96:99], a[228:231], v[236:239], a[96:99]
    s_waitcnt lgkmcnt(1)
    v_fmac_f32 v251, s25, v249
    v_fma_f32 v249, v248, s24, v250
    v_mfma_f32_16x16x32_bf16 a[100:103], a[232:235], v[236:239], a[100:103]
    buffer_load_dwordx4 a[208:211], v254, s[8:11], s42 offen offset:1024
    v_mfma_f32_16x16x32_bf16 a[104:107], a[236:239], v[236:239], a[104:107]
    ds_read_b128 v[236:239], v253 offset:10656
    v_fmac_f32 v250, s25, v248
    v_mfma_f32_16x16x32_bf16 a[108:111], a[228:231], v[228:231], a[108:111]
    v_fma_f32 v248, v250, s26, v251
    v_fmac_f32 v251, s27, v250
    v_mfma_f32_16x16x32_bf16 a[112:115], a[232:235], v[228:231], a[112:115]
    s_waitcnt vmcnt(14)
    v_fma_f32 v250, v249, s28, v252
    v_fmac_f32 v252, s29, v249
    v_mfma_f32_16x16x32_bf16 a[116:119], a[236:239], v[228:231], a[116:119]
    buffer_load_dwordx4 a[212:215], v254, s[8:11], s42 offen offset:2048
    v_mfma_f32_16x16x32_bf16 a[96:99], a[240:243], v[228:231], a[96:99]
    s_waitcnt lgkmcnt(1)
    v_fma_f32 v249, v220, s24, v224
    v_fmac_f32 v224, s25, v220
    v_mfma_f32_16x16x32_bf16 a[100:103], a[244:247], v[228:231], a[100:103]
    s_mov_b32 s42, 227328
    v_fma_f32 v220, v218, s24, v222
    v_fmac_f32 v222, s25, v218
    v_mfma_f32_16x16x32_bf16 a[104:107], a[248:251], v[228:231], a[104:107]
    ds_read_b128 v[228:231], v253 offset:10400
    v_fma_f32 v218, v222, s26, v224
    v_mfma_f32_16x16x32_bf16 a[120:123], a[228:231], v[232:235], a[120:123]
    buffer_load_dwordx4 a[216:219], v254, s[8:11], s42 offen offset:0
    v_mfma_f32_16x16x32_bf16 a[124:127], a[232:235], v[232:235], a[124:127]
    v_fmac_f32 v224, s27, v222
    v_fma_f32 v222, v220, s28, v249
    v_mfma_f32_16x16x32_bf16 a[128:131], a[236:239], v[232:235], a[128:131]
    v_fmac_f32 v249, s29, v220
    v_cvt_pk_bf16_f32 v218, v248, v218
    v_mfma_f32_16x16x32_bf16 a[108:111], a[240:243], v[232:235], a[108:111]
    v_cvt_pk_bf16_f32 v224, v251, v224
    v_cvt_pk_bf16_f32 v222, v250, v222
    v_mfma_f32_16x16x32_bf16 a[112:115], a[244:247], v[232:235], a[112:115]
    buffer_load_dwordx4 a[220:223], v254, s[8:11], s42 offen offset:1024
    v_mfma_f32_16x16x32_bf16 a[116:119], a[248:251], v[232:235], a[116:119]
    s_waitcnt vmcnt(14)
    v_cvt_pk_bf16_f32 v220, v252, v249
    v_lshlrev_b32 v248, 16, v219
    v_mfma_f32_16x16x32_bf16 a[96:99], a[252:255], v[232:235], a[96:99]
    s_waitcnt lgkmcnt(1)
    v_lshlrev_b32 v249, 16, v221
    v_lshlrev_b32 v250, 16, v223
    v_mfma_f32_16x16x32_bf16 a[100:103], v[240:243], v[232:235], a[100:103]
    buffer_load_dwordx4 a[224:227], v254, s[8:11], s42 offen offset:2048
    v_mfma_f32_16x16x32_bf16 a[104:107], v[244:247], v[232:235], a[104:107]
    ds_read_b128 v[232:235], v253 offset:12224
    v_and_b32 v215, 0x7fff, v255
    v_mfma_f32_16x16x32_bf16 a[132:135], a[228:231], v[236:239], a[132:135]
    v_lshlrev_b32 v251, 16, v225
    v_and_b32 v219, s22, v219
    v_mfma_f32_16x16x32_bf16 a[136:139], a[232:235], v[236:239], a[136:139]
    buffer_load_dwordx2 v[204:205], v215, s[4:7], s16 offen offset:1280
    v_mfma_f32_16x16x32_bf16 a[140:143], a[236:239], v[236:239], a[140:143]
    v_and_b32 v221, s22, v221
    v_and_b32 v223, s22, v223
    v_mfma_f32_16x16x32_bf16 a[120:123], a[240:243], v[236:239], a[120:123]
    v_and_b32 v225, s22, v225
    v_lshlrev_b32 v252, 16, v217
    v_mfma_f32_16x16x32_bf16 a[124:127], a[244:247], v[236:239], a[124:127]
    buffer_load_dwordx2 v[206:207], v215, s[4:7], s17 offen offset:1280
    v_mfma_f32_16x16x32_bf16 a[128:131], a[248:251], v[236:239], a[128:131]
    v_and_b32 v217, s22, v217
    v_add_f32 v252, v252, v251
    v_mfma_f32_16x16x32_bf16 a[108:111], a[252:255], v[236:239], a[108:111]
    s_waitcnt lgkmcnt(1)
    v_add_f32 v217, v217, v225
    v_fmac_f32 v252, s23, v249
    v_mfma_f32_16x16x32_bf16 a[112:115], v[240:243], v[236:239], a[112:115]
    buffer_load_dwordx2 v[208:209], v215, s[4:7], s18 offen offset:1280
    v_mfma_f32_16x16x32_bf16 a[116:119], v[244:247], v[236:239], a[116:119]
    ds_read_b128 v[236:239], v253 offset:11968
    v_fmac_f32 v217, s23, v221
    v_mfma_f32_16x16x32_bf16 a[144:147], a[228:231], v[228:231], a[144:147]
    v_cvt_pk_bf16_f32 v217, v252, v217
    v_lshlrev_b32 v252, 16, v227
    v_mfma_f32_16x16x32_bf16 a[148:151], a[232:235], v[228:231], a[148:151]
    buffer_load_dwordx2 v[210:211], v215, s[4:7], s19 offen offset:1280
    v_mfma_f32_16x16x32_bf16 a[152:155], a[236:239], v[228:231], a[152:155]
    v_and_b32 v227, s22, v227
    v_add_f32 v252, v252, v248
    v_mfma_f32_16x16x32_bf16 a[132:135], a[240:243], v[228:231], a[132:135]
    v_add_f32 v227, v227, v219
    v_fmac_f32 v252, s23, v250
    v_mfma_f32_16x16x32_bf16 a[136:139], a[244:247], v[228:231], a[136:139]
    buffer_load_dwordx2 v[212:213], v215, s[4:7], s20 offen offset:1280
    v_mfma_f32_16x16x32_bf16 a[140:143], a[248:251], v[228:231], a[140:143]
    v_fmac_f32 v227, s23, v223
    v_cvt_pk_bf16_f32 v227, v252, v227
    v_mfma_f32_16x16x32_bf16 a[120:123], a[252:255], v[228:231], a[120:123]
    s_waitcnt lgkmcnt(1)
    v_fma_f32 v252, v249, s24, v251
    v_fmac_f32 v251, s25, v249
    v_mfma_f32_16x16x32_bf16 a[124:127], v[240:243], v[228:231], a[124:127]
    buffer_load_dwordx2 v[214:215], v215, s[4:7], s21 offen offset:1280
    v_mfma_f32_16x16x32_bf16 a[128:131], v[244:247], v[228:231], a[128:131]
    ds_read_b128 v[228:231], v253 offset:11712
    v_fma_f32 v249, v248, s24, v250
    v_mfma_f32_16x16x32_bf16 a[156:159], a[228:231], v[232:235], a[156:159]
    v_fmac_f32 v250, s25, v248
    v_fma_f32 v248, v250, s26, v251
    v_mfma_f32_16x16x32_bf16 a[160:163], a[232:235], v[232:235], a[160:163]
    v_fmac_f32 v251, s27, v250
    v_fma_f32 v250, v249, s28, v252
    v_mfma_f32_16x16x32_bf16 a[164:167], a[236:239], v[232:235], a[164:167]
    v_fmac_f32 v252, s29, v249
    v_fma_f32 v249, v221, s24, v225
    v_mfma_f32_16x16x32_bf16 a[144:147], a[240:243], v[232:235], a[144:147]
    v_fmac_f32 v225, s25, v221
    v_fma_f32 v221, v219, s24, v223
    v_mfma_f32_16x16x32_bf16 a[148:151], a[244:247], v[232:235], a[148:151]
    v_fmac_f32 v223, s25, v219
    v_fma_f32 v219, v223, s26, v225
    v_mfma_f32_16x16x32_bf16 a[152:155], a[248:251], v[232:235], a[152:155]
    v_fmac_f32 v225, s27, v223
    v_fma_f32 v223, v221, s28, v249
    v_mfma_f32_16x16x32_bf16 a[132:135], a[252:255], v[232:235], a[132:135]
    v_fmac_f32 v249, s29, v221
    v_cvt_pk_bf16_f32 v219, v248, v219
    v_mfma_f32_16x16x32_bf16 a[136:139], v[240:243], v[232:235], a[136:139]
    s_waitcnt lgkmcnt(1)
    v_cvt_pk_bf16_f32 v225, v251, v225
    v_cvt_pk_bf16_f32 v223, v250, v223
    v_mfma_f32_16x16x32_bf16 a[140:143], v[244:247], v[232:235], a[140:143]
    ds_read_b128 v[232:235], v253 offset:11456
    v_cvt_pk_bf16_f32 v221, v252, v249
    v_mfma_f32_16x16x32_bf16 a[168:171], a[228:231], v[236:239], a[168:171]
    v_lshrrev_b32 v252, 15, v255
    v_mfma_f32_16x16x32_bf16 a[172:175], a[232:235], v[236:239], a[172:175]
    ds_write_b64 v252, v[218:219] offset:512
    v_mfma_f32_16x16x32_bf16 a[176:179], a[236:239], v[236:239], a[176:179]
    s_waitcnt vmcnt(15)
    v_lshlrev_b32 v248, 16, v194
    v_lshlrev_b32 v249, 16, v196
    v_mfma_f32_16x16x32_bf16 a[156:159], a[240:243], v[236:239], a[156:159]
    ds_write_b64 v252, v[224:225] offset:2592
    v_mfma_f32_16x16x32_bf16 a[160:163], a[244:247], v[236:239], a[160:163]
    v_lshlrev_b32 v250, 16, v198
    v_lshlrev_b32 v251, 16, v200
    v_mfma_f32_16x16x32_bf16 a[164:167], a[248:251], v[236:239], a[164:167]
    ds_write_b64 v252, v[222:223] offset:4672
    v_mfma_f32_16x16x32_bf16 a[144:147], a[252:255], v[236:239], a[144:147]
    s_waitcnt lgkmcnt(4)
    v_and_b32 v194, s22, v194
    v_and_b32 v196, s22, v196
    v_mfma_f32_16x16x32_bf16 a[148:151], v[240:243], v[236:239], a[148:151]
    ds_write_b64 v252, v[216:217] offset:17152
    v_mfma_f32_16x16x32_bf16 a[152:155], v[244:247], v[236:239], a[152:155]
    ds_read_b128 v[236:239], v253 offset:11184
    v_and_b32 v198, s22, v198
    v_mfma_f32_16x16x32_bf16 a[180:183], a[228:231], v[228:231], a[180:183]
    v_and_b32 v200, s22, v200
    v_mfma_f32_16x16x32_bf16 a[184:187], a[232:235], v[228:231], a[184:187]
    ds_write_b64 v252, v[226:227] offset:25472
    v_mfma_f32_16x16x32_bf16 a[188:191], a[236:239], v[228:231], a[188:191]
    s_mov_b32 s42, 258048
    v_mfma_f32_16x16x32_bf16 a[168:171], a[240:243], v[228:231], a[168:171]
    buffer_load_dwordx4 a[228:231], v254, s[8:11], s42 offen offset:0
    v_mfma_f32_16x16x32_bf16 a[172:175], a[244:247], v[228:231], a[172:175]
    ds_write_b64 v252, v[220:221] offset:6752
    v_mfma_f32_16x16x32_bf16 a[176:179], a[248:251], v[228:231], a[176:179]
    v_mfma_f32_16x16x32_bf16 a[156:159], a[252:255], v[228:231], a[156:159]
    buffer_load_dwordx4 a[232:235], v254, s[8:11], s42 offen offset:1024
    v_mfma_f32_16x16x32_bf16 a[160:163], v[240:243], v[228:231], a[160:163]
    v_lshlrev_b32 v252, 16, v192
    v_and_b32 v192, s22, v192
    v_mfma_f32_16x16x32_bf16 a[164:167], v[244:247], v[228:231], a[164:167]
    s_waitcnt lgkmcnt(2)
    v_add_f32 v252, v252, v251
    v_add_f32 v192, v192, v200
    v_mfma_f32_16x16x32_bf16 a[180:183], a[240:243], v[232:235], a[180:183]
    ds_read_b128 v[228:231], v253 offset:13520
    v_fmac_f32 v252, s23, v249
    v_mfma_f32_16x16x32_bf16 a[184:187], a[244:247], v[232:235], a[184:187]
    ds_read_b128 v[216:219], v253 offset:39904
    v_fmac_f32 v192, s23, v196
    v_mfma_f32_16x16x32_bf16 a[188:191], a[248:251], v[232:235], a[188:191]
    buffer_load_dwordx4 a[236:239], v254, s[8:11], s42 offen offset:2048
    v_mfma_f32_16x16x32_bf16 a[168:171], a[252:255], v[232:235], a[168:171]
    s_mov_b32 s45, 405865480
    v_cvt_pk_bf16_f32 v192, v252, v192
    v_lshlrev_b32 v252, 16, v202
    v_and_b32 v202, s22, v202
    v_mfma_f32_16x16x32_bf16 a[172:175], v[240:243], v[232:235], a[172:175]
    s_mov_b32 s42, 261120
    v_add_f32 v252, v252, v248
    v_add_f32 v202, v202, v194
    v_mfma_f32_16x16x32_bf16 a[176:179], v[244:247], v[232:235], a[176:179]
    ds_read_b128 v[232:235], v253 offset:13248
    v_bfe_u32 v220, v254, 5, 3
    v_mfma_f32_16x16x32_bf16 a[180:183], a[252:255], v[236:239], a[180:183]
    buffer_load_dwordx4 a[240:243], v254, s[8:11], s42 offen offset:0
    v_mfma_f32_16x16x32_bf16 a[184:187], v[240:243], v[236:239], a[184:187]
    s_waitcnt vmcnt(16) lgkmcnt(2)
    v_fmac_f32 v252, s23, v250
    v_fmac_f32 v202, s23, v198
    v_mfma_f32_16x16x32_bf16 a[188:191], v[244:247], v[236:239], a[188:191]
    ds_read_b128 v[236:239], v253 offset:12992
    v_mul_u32_u24 v221, 5, v220
    v_mfma_f32_16x16x32_bf16 v[0:3], a[192:195], v[228:231], v[0:3]
    s_waitcnt lgkmcnt(1)
    v_cvt_pk_bf16_f32 v202, v252, v202
    v_fma_f32 v252, v249, s24, v251
    v_mfma_f32_16x16x32_bf16 v[4:7], a[196:199], v[228:231], v[4:7]
    buffer_load_dwordx4 a[244:247], v254, s[8:11], s42 offen offset:1024
    v_fmac_f32 v251, s25, v249
    v_mfma_f32_16x16x32_bf16 v[8:11], a[200:203], v[228:231], v[8:11]
    ds_read_b128 v[228:231], v253 offset:12736
    v_bfe_u32 v221, s45, v221, 5
    v_mfma_f32_16x16x32_bf16 v[12:15], a[192:195], v[232:235], v[12:15]
    v_fma_f32 v249, v248, s24, v250
    v_fmac_f32 v250, s25, v248
    v_mfma_f32_16x16x32_bf16 v[16:19], a[196:199], v[232:235], v[16:19]
    s_waitcnt vmcnt(14)
    v_mul_u32_u24 v221, 65, v221
    v_fma_f32 v248, v250, s26, v251
    v_mfma_f32_16x16x32_bf16 v[20:23], a[200:203], v[232:235], v[20:23]
    buffer_load_dwordx4 a[248:251], v254, s[8:11], s42 offen offset:2048
    v_mfma_f32_16x16x32_bf16 v[0:3], a[204:207], v[232:235], v[0:3]
    s_waitcnt lgkmcnt(1)
    v_sub_u32 v221, v221, v220
    v_fmac_f32 v251, s27, v250
    v_mfma_f32_16x16x32_bf16 v[4:7], a[208:211], v[232:235], v[4:7]
    s_mov_b32 s42, 264192
    v_fma_f32 v250, v249, s28, v252
    v_fmac_f32 v252, s29, v249
    v_fma_f32 v249, v196, s24, v200
    v_mfma_f32_16x16x32_bf16 v[8:11], a[212:215], v[232:235], v[8:11]
    ds_read_b128 v[232:235], v253 offset:12480
    v_lshl_add_u32 v220, v221, 5, v253
    v_mfma_f32_16x16x32_bf16 v[24:27], a[192:195], v[236:239], v[24:27]
    buffer_load_dwordx4 a[252:255], v254, s[8:11], s42 offen offset:0
    v_mfma_f32_16x16x32_bf16 v[28:31], a[196:199], v[236:239], v[28:31]
    v_fmac_f32 v200, s25, v196
    v_fma_f32 v196, v194, s24, v198
    v_mfma_f32_16x16x32_bf16 v[32:35], a[200:203], v[236:239], v[32:35]
    v_fmac_f32 v198, s25, v194
    v_fma_f32 v194, v198, s26, v200
    v_mfma_f32_16x16x32_bf16 v[12:15], a[204:207], v[236:239], v[12:15]
    s_waitcnt vmcnt(13)
    v_fmac_f32 v200, s27, v198
    v_fma_f32 v198, v196, s28, v249
    v_mfma_f32_16x16x32_bf16 v[16:19], a[208:211], v[236:239], v[16:19]
    buffer_load_dwordx4 v[240:243], v254, s[8:11], s42 offen offset:1024
    v_mfma_f32_16x16x32_bf16 v[20:23], a[212:215], v[236:239], v[20:23]
    s_mov_b64 exec, s[46:47]
    ds_write_b128 v220, v[216:219] offset:1024
    s_mov_b64 exec, -1
    v_fmac_f32 v249, s29, v196
    v_mfma_f32_16x16x32_bf16 v[0:3], a[216:219], v[236:239], v[0:3]
    s_waitcnt lgkmcnt(2)
    v_cvt_pk_bf16_f32 v194, v248, v194
    v_cvt_pk_bf16_f32 v200, v251, v200
    v_mfma_f32_16x16x32_bf16 v[4:7], a[220:223], v[236:239], v[4:7]
    buffer_load_dwordx4 v[244:247], v254, s[8:11], s42 offen offset:2048
    v_mfma_f32_16x16x32_bf16 v[8:11], a[224:227], v[236:239], v[8:11]
    ds_read_b128 v[236:239], v253 offset:14304
    v_and_b32 v227, 0x7fff, v255
    v_mfma_f32_16x16x32_bf16 v[36:39], a[192:195], v[228:231], v[36:39]
    v_cvt_pk_bf16_f32 v198, v250, v198
    v_cvt_pk_bf16_f32 v196, v252, v249
    v_mfma_f32_16x16x32_bf16 v[40:43], a[196:199], v[228:231], v[40:43]
    buffer_load_dwordx2 v[216:217], v227, s[4:7], s16 offen offset:192
    v_mfma_f32_16x16x32_bf16 v[44:47], a[200:203], v[228:231], v[44:47]
    v_lshlrev_b32 v248, 16, v195
    v_lshlrev_b32 v249, 16, v197
    v_mfma_f32_16x16x32_bf16 v[24:27], a[204:207], v[228:231], v[24:27]
    v_lshlrev_b32 v250, 16, v199
    v_lshlrev_b32 v251, 16, v201
    v_and_b32 v195, s22, v195
    v_mfma_f32_16x16x32_bf16 v[28:31], a[208:211], v[228:231], v[28:31]
    buffer_load_dwordx2 v[218:219], v227, s[4:7], s17 offen offset:192
    v_mfma_f32_16x16x32_bf16 v[32:35], a[212:215], v[228:231], v[32:35]
    v_and_b32 v197, s22, v197
    v_and_b32 v199, s22, v199
    v_mfma_f32_16x16x32_bf16 v[12:15], a[216:219], v[228:231], v[12:15]
    s_waitcnt lgkmcnt(2)
    v_and_b32 v201, s22, v201
    v_lshlrev_b32 v252, 16, v193
    v_mfma_f32_16x16x32_bf16 v[16:19], a[220:223], v[228:231], v[16:19]
    buffer_load_dwordx2 v[220:221], v227, s[4:7], s18 offen offset:192
    v_mfma_f32_16x16x32_bf16 v[20:23], a[224:227], v[228:231], v[20:23]
    ds_read_b128 v[228:231], v253 offset:14048
    v_and_b32 v193, s22, v193
    v_mfma_f32_16x16x32_bf16 v[48:51], a[192:195], v[232:235], v[48:51]
    v_add_f32 v252, v252, v251
    v_add_f32 v193, v193, v201
    v_fmac_f32 v252, s23, v249
    v_mfma_f32_16x16x32_bf16 v[52:55], a[196:199], v[232:235], v[52:55]
    buffer_load_dwordx2 v[222:223], v227, s[4:7], s19 offen offset:192
    v_mfma_f32_16x16x32_bf16 v[56:59], a[200:203], v[232:235], v[56:59]
    v_fmac_f32 v193, s23, v197
    v_cvt_pk_bf16_f32 v193, v252, v193
    v_mfma_f32_16x16x32_bf16 v[36:39], a[204:207], v[232:235], v[36:39]
    v_lshlrev_b32 v252, 16, v203
    v_and_b32 v203, s22, v203
    v_mfma_f32_16x16x32_bf16 v[40:43], a[208:211], v[232:235], v[40:43]
    buffer_load_dwordx2 v[224:225], v227, s[4:7], s20 offen offset:192
    v_mfma_f32_16x16x32_bf16 v[44:47], a[212:215], v[232:235], v[44:47]
    v_add_f32 v252, v252, v248
    v_add_f32 v203, v203, v195
    v_mfma_f32_16x16x32_bf16 v[24:27], a[216:219], v[232:235], v[24:27]
    s_waitcnt lgkmcnt(1)
    v_fmac_f32 v252, s23, v250
    v_fmac_f32 v203, s23, v199
    v_mfma_f32_16x16x32_bf16 v[28:31], a[220:223], v[232:235], v[28:31]
    buffer_load_dwordx2 v[226:227], v227, s[4:7], s21 offen offset:192
    v_cvt_pk_bf16_f32 v203, v252, v203
    v_mfma_f32_16x16x32_bf16 v[32:35], a[224:227], v[232:235], v[32:35]
    ds_read_b128 v[232:235], v253 offset:13792
    v_fma_f32 v252, v249, s24, v251
    v_mfma_f32_16x16x32_bf16 v[60:63], a[192:195], v[236:239], v[60:63]
    v_fmac_f32 v251, s25, v249
    v_fma_f32 v249, v248, s24, v250
    v_mfma_f32_16x16x32_bf16 v[64:67], a[196:199], v[236:239], v[64:67]
    v_fmac_f32 v250, s25, v248
    v_fma_f32 v248, v250, s26, v251
    v_mfma_f32_16x16x32_bf16 v[68:71], a[200:203], v[236:239], v[68:71]
    v_fmac_f32 v251, s27, v250
    v_fma_f32 v250, v249, s28, v252
    v_mfma_f32_16x16x32_bf16 v[48:51], a[204:207], v[236:239], v[48:51]
    v_fmac_f32 v252, s29, v249
    v_fma_f32 v249, v197, s24, v201
    v_mfma_f32_16x16x32_bf16 v[52:55], a[208:211], v[236:239], v[52:55]
    v_fmac_f32 v201, s25, v197
    v_fma_f32 v197, v195, s24, v199
    v_mfma_f32_16x16x32_bf16 v[56:59], a[212:215], v[236:239], v[56:59]
    v_fmac_f32 v199, s25, v195
    v_fma_f32 v195, v199, s26, v201
    v_fmac_f32 v201, s27, v199
    v_mfma_f32_16x16x32_bf16 v[36:39], a[216:219], v[236:239], v[36:39]
    v_fma_f32 v199, v197, s28, v249
    v_fmac_f32 v249, s29, v197
    v_mfma_f32_16x16x32_bf16 v[40:43], a[220:223], v[236:239], v[40:43]
    s_waitcnt lgkmcnt(1)
    v_cvt_pk_bf16_f32 v195, v248, v195
    v_cvt_pk_bf16_f32 v201, v251, v201
    v_mfma_f32_16x16x32_bf16 v[44:47], a[224:227], v[236:239], v[44:47]
    ds_read_b128 v[236:239], v253 offset:13536
    v_cvt_pk_bf16_f32 v199, v250, v199
    v_mfma_f32_16x16x32_bf16 v[72:75], a[192:195], v[228:231], v[72:75]
    v_cvt_pk_bf16_f32 v197, v252, v249
    v_lshrrev_b32 v252, 15, v255
    v_mfma_f32_16x16x32_bf16 v[76:79], a[196:199], v[228:231], v[76:79]
    ds_write_b64 v252, v[194:195] offset:256
    v_mfma_f32_16x16x32_bf16 v[80:83], a[200:203], v[228:231], v[80:83]
    s_waitcnt vmcnt(15)
    v_lshlrev_b32 v248, 16, v206
    v_lshlrev_b32 v249, 16, v208
    v_mfma_f32_16x16x32_bf16 v[60:63], a[204:207], v[228:231], v[60:63]
    ds_write_b64 v252, v[200:201] offset:2336
    v_mfma_f32_16x16x32_bf16 v[64:67], a[208:211], v[228:231], v[64:67]
    v_lshlrev_b32 v250, 16, v210
    v_lshlrev_b32 v251, 16, v212
    v_mfma_f32_16x16x32_bf16 v[68:71], a[212:215], v[228:231], v[68:71]
    ds_write_b64 v252, v[198:199] offset:4416
    v_mfma_f32_16x16x32_bf16 v[48:51], a[216:219], v[228:231], v[48:51]
    s_waitcnt lgkmcnt(4)
    v_and_b32 v206, s22, v206
    v_and_b32 v208, s22, v208
    v_mfma_f32_16x16x32_bf16 v[52:55], a[220:223], v[228:231], v[52:55]
    ds_write_b64 v252, v[192:193] offset:16896
    v_mfma_f32_16x16x32_bf16 v[56:59], a[224:227], v[228:231], v[56:59]
    ds_read_b128 v[228:231], v253 offset:13264
    v_and_b32 v210, s22, v210
    v_mfma_f32_16x16x32_bf16 v[84:87], a[192:195], v[232:235], v[84:87]
    v_and_b32 v212, s22, v212
    v_mfma_f32_16x16x32_bf16 v[88:91], a[196:199], v[232:235], v[88:91]
    ds_write_b64 v252, v[202:203] offset:25216
    v_mfma_f32_16x16x32_bf16 v[92:95], a[200:203], v[232:235], v[92:95]
    s_mov_b32 s42, 294912
    v_mfma_f32_16x16x32_bf16 v[72:75], a[204:207], v[232:235], v[72:75]
    buffer_load_dwordx4 a[192:195], v254, s[8:11], s42 offen offset:0
    v_mfma_f32_16x16x32_bf16 v[76:79], a[208:211], v[232:235], v[76:79]
    ds_write_b64 v252, v[196:197] offset:6496
    v_mfma_f32_16x16x32_bf16 v[80:83], a[212:215], v[232:235], v[80:83]
    v_mfma_f32_16x16x32_bf16 v[60:63], a[216:219], v[232:235], v[60:63]
    buffer_load_dwordx4 a[196:199], v254, s[8:11], s42 offen offset:1024
    v_mfma_f32_16x16x32_bf16 v[64:67], a[220:223], v[232:235], v[64:67]
    v_lshlrev_b32 v252, 16, v204
    v_and_b32 v204, s22, v204
    v_mfma_f32_16x16x32_bf16 v[68:71], a[224:227], v[232:235], v[68:71]
    s_waitcnt lgkmcnt(7)
    v_add_f32 v252, v252, v251
    v_add_f32 v204, v204, v212
    v_mfma_f32_16x16x32_bf16 v[84:87], a[204:207], v[236:239], v[84:87]
    ds_read_b128 v[232:235], v253 offset:32240
    v_fmac_f32 v252, s23, v249
    v_mfma_f32_16x16x32_bf16 v[88:91], a[208:211], v[236:239], v[88:91]
    v_fmac_f32 v204, s23, v208
    v_cvt_pk_bf16_f32 v204, v252, v204
    v_mfma_f32_16x16x32_bf16 v[92:95], a[212:215], v[236:239], v[92:95]
    buffer_load_dwordx4 a[200:203], v254, s[8:11], s42 offen offset:2048
    v_mfma_f32_16x16x32_bf16 v[72:75], a[216:219], v[236:239], v[72:75]
    s_waitcnt lgkmcnt(3)
    v_lshlrev_b32 v252, 16, v214
    v_and_b32 v214, s22, v214
    v_mfma_f32_16x16x32_bf16 v[76:79], a[220:223], v[236:239], v[76:79]
    s_mov_b32 s42, 297984
    v_add_f32 v252, v252, v248
    v_add_f32 v214, v214, v206
    v_mfma_f32_16x16x32_bf16 v[80:83], a[224:227], v[236:239], v[80:83]
    ds_read_b128 v[236:239], v253 offset:31968
    v_fmac_f32 v252, s23, v250
    v_mfma_f32_16x16x32_bf16 v[84:87], a[216:219], v[228:231], v[84:87]
    buffer_load_dwordx4 a[204:207], v254, s[8:11], s42 offen offset:0
    v_mfma_f32_16x16x32_bf16 v[88:91], a[220:223], v[228:231], v[88:91]
    s_waitcnt vmcnt(16) lgkmcnt(1)
    v_fmac_f32 v214, s23, v210
    v_cvt_pk_bf16_f32 v214, v252, v214
    v_mfma_f32_16x16x32_bf16 v[92:95], a[224:227], v[228:231], v[92:95]
    ds_read_b128 v[228:231], v253 offset:31712
    v_fma_f32 v252, v249, s24, v251
    v_mfma_f32_16x16x32_bf16 v[96:99], a[228:231], v[232:235], v[96:99]
    s_waitcnt lgkmcnt(1)
    v_fmac_f32 v251, s25, v249
    v_fma_f32 v249, v248, s24, v250
    v_mfma_f32_16x16x32_bf16 v[100:103], a[232:235], v[232:235], v[100:103]
    buffer_load_dwordx4 a[208:211], v254, s[8:11], s42 offen offset:1024
    v_mfma_f32_16x16x32_bf16 v[104:107], a[236:239], v[232:235], v[104:107]
    ds_read_b128 v[232:235], v253 offset:31456
    v_fmac_f32 v250, s25, v248
    v_mfma_f32_16x16x32_bf16 v[108:111], a[228:231], v[236:239], v[108:111]
    v_fma_f32 v248, v250, s26, v251
    v_fmac_f32 v251, s27, v250
    v_mfma_f32_16x16x32_bf16 v[112:115], a[232:235], v[236:239], v[112:115]
    s_waitcnt vmcnt(14)
    v_fma_f32 v250, v249, s28, v252
    v_fmac_f32 v252, s29, v249
    v_mfma_f32_16x16x32_bf16 v[116:119], a[236:239], v[236:239], v[116:119]
    buffer_load_dwordx4 a[212:215], v254, s[8:11], s42 offen offset:2048
    v_mfma_f32_16x16x32_bf16 v[96:99], a[240:243], v[236:239], v[96:99]
    s_waitcnt lgkmcnt(1)
    v_fma_f32 v249, v208, s24, v212
    v_fmac_f32 v212, s25, v208
    v_mfma_f32_16x16x32_bf16 v[100:103], a[244:247], v[236:239], v[100:103]
    s_mov_b32 s42, 301056
    v_fma_f32 v208, v206, s24, v210
    v_fmac_f32 v210, s25, v206
    v_mfma_f32_16x16x32_bf16 v[104:107], a[248:251], v[236:239], v[104:107]
    ds_read_b128 v[236:239], v253 offset:31200
    v_fma_f32 v206, v210, s26, v212
    v_mfma_f32_16x16x32_bf16 v[120:123], a[228:231], v[228:231], v[120:123]
    buffer_load_dwordx4 a[216:219], v254, s[8:11], s42 offen offset:0
    v_mfma_f32_16x16x32_bf16 v[124:127], a[232:235], v[228:231], v[124:127]
    v_fmac_f32 v212, s27, v210
    v_fma_f32 v210, v208, s28, v249
    v_mfma_f32_16x16x32_bf16 v[128:131], a[236:239], v[228:231], v[128:131]
    v_fmac_f32 v249, s29, v208
    v_cvt_pk_bf16_f32 v206, v248, v206
    v_mfma_f32_16x16x32_bf16 v[108:111], a[240:243], v[228:231], v[108:111]
    v_cvt_pk_bf16_f32 v212, v251, v212
    v_cvt_pk_bf16_f32 v210, v250, v210
    v_mfma_f32_16x16x32_bf16 v[112:115], a[244:247], v[228:231], v[112:115]
    buffer_load_dwordx4 a[220:223], v254, s[8:11], s42 offen offset:1024
    v_mfma_f32_16x16x32_bf16 v[116:119], a[248:251], v[228:231], v[116:119]
    s_waitcnt vmcnt(14)
    v_cvt_pk_bf16_f32 v208, v252, v249
    v_lshlrev_b32 v248, 16, v207
    v_mfma_f32_16x16x32_bf16 v[96:99], a[252:255], v[228:231], v[96:99]
    s_waitcnt lgkmcnt(1)
    v_lshlrev_b32 v249, 16, v209
    v_lshlrev_b32 v250, 16, v211
    v_mfma_f32_16x16x32_bf16 v[100:103], v[240:243], v[228:231], v[100:103]
    buffer_load_dwordx4 a[224:227], v254, s[8:11], s42 offen offset:2048
    v_mfma_f32_16x16x32_bf16 v[104:107], v[244:247], v[228:231], v[104:107]
    ds_read_b128 v[228:231], v253 offset:33024
    v_and_b32 v203, 0x7fff, v255
    v_mfma_f32_16x16x32_bf16 v[132:135], a[228:231], v[232:235], v[132:135]
    v_lshlrev_b32 v251, 16, v213
    v_and_b32 v207, s22, v207
    v_mfma_f32_16x16x32_bf16 v[136:139], a[232:235], v[232:235], v[136:139]
    buffer_load_dwordx2 v[192:193], v203, s[4:7], s16 offen offset:576
    v_mfma_f32_16x16x32_bf16 v[140:143], a[236:239], v[232:235], v[140:143]
    v_and_b32 v209, s22, v209
    v_and_b32 v211, s22, v211
    v_mfma_f32_16x16x32_bf16 v[120:123], a[240:243], v[232:235], v[120:123]
    v_and_b32 v213, s22, v213
    v_lshlrev_b32 v252, 16, v205
    v_mfma_f32_16x16x32_bf16 v[124:127], a[244:247], v[232:235], v[124:127]
    buffer_load_dwordx2 v[194:195], v203, s[4:7], s17 offen offset:576
    v_mfma_f32_16x16x32_bf16 v[128:131], a[248:251], v[232:235], v[128:131]
    v_and_b32 v205, s22, v205
    v_add_f32 v252, v252, v251
    v_mfma_f32_16x16x32_bf16 v[108:111], a[252:255], v[232:235], v[108:111]
    s_waitcnt lgkmcnt(1)
    v_add_f32 v205, v205, v213
    v_fmac_f32 v252, s23, v249
    v_mfma_f32_16x16x32_bf16 v[112:115], v[240:243], v[232:235], v[112:115]
    buffer_load_dwordx2 v[196:197], v203, s[4:7], s18 offen offset:576
    v_mfma_f32_16x16x32_bf16 v[116:119], v[244:247], v[232:235], v[116:119]
    ds_read_b128 v[232:235], v253 offset:32768
    v_fmac_f32 v205, s23, v209
    v_mfma_f32_16x16x32_bf16 v[144:147], a[228:231], v[236:239], v[144:147]
    v_cvt_pk_bf16_f32 v205, v252, v205
    v_lshlrev_b32 v252, 16, v215
    v_mfma_f32_16x16x32_bf16 v[148:151], a[232:235], v[236:239], v[148:151]
    buffer_load_dwordx2 v[198:199], v203, s[4:7], s19 offen offset:576
    v_mfma_f32_16x16x32_bf16 v[152:155], a[236:239], v[236:239], v[152:155]
    v_and_b32 v215, s22, v215
    v_add_f32 v252, v252, v248
    v_mfma_f32_16x16x32_bf16 v[132:135], a[240:243], v[236:239], v[132:135]
    v_add_f32 v215, v215, v207
    v_fmac_f32 v252, s23, v250
    v_mfma_f32_16x16x32_bf16 v[136:139], a[244:247], v[236:239], v[136:139]
    buffer_load_dwordx2 v[200:201], v203, s[4:7], s20 offen offset:576
    v_mfma_f32_16x16x32_bf16 v[140:143], a[248:251], v[236:239], v[140:143]
    v_fmac_f32 v215, s23, v211
    v_cvt_pk_bf16_f32 v215, v252, v215
    v_mfma_f32_16x16x32_bf16 v[120:123], a[252:255], v[236:239], v[120:123]
    s_waitcnt lgkmcnt(1)
    v_fma_f32 v252, v249, s24, v251
    v_fmac_f32 v251, s25, v249
    v_mfma_f32_16x16x32_bf16 v[124:127], v[240:243], v[236:239], v[124:127]
    buffer_load_dwordx2 v[202:203], v203, s[4:7], s21 offen offset:576
    v_mfma_f32_16x16x32_bf16 v[128:131], v[244:247], v[236:239], v[128:131]
    ds_read_b128 v[236:239], v253 offset:32512
    v_fma_f32 v249, v248, s24, v250
    v_mfma_f32_16x16x32_bf16 v[156:159], a[228:231], v[228:231], v[156:159]
    v_fmac_f32 v250, s25, v248
    v_fma_f32 v248, v250, s26, v251
    v_mfma_f32_16x16x32_bf16 v[160:163], a[232:235], v[228:231], v[160:163]
    v_fmac_f32 v251, s27, v250
    v_fma_f32 v250, v249, s28, v252
    v_mfma_f32_16x16x32_bf16 v[164:167], a[236:239], v[228:231], v[164:167]
    v_fmac_f32 v252, s29, v249
    v_fma_f32 v249, v209, s24, v213
    v_mfma_f32_16x16x32_bf16 v[144:147], a[240:243], v[228:231], v[144:147]
    v_fmac_f32 v213, s25, v209
    v_fma_f32 v209, v207, s24, v211
    v_mfma_f32_16x16x32_bf16 v[148:151], a[244:247], v[228:231], v[148:151]
    v_fmac_f32 v211, s25, v207
    v_fma_f32 v207, v211, s26, v213
    v_mfma_f32_16x16x32_bf16 v[152:155], a[248:251], v[228:231], v[152:155]
    v_fmac_f32 v213, s27, v211
    v_fma_f32 v211, v209, s28, v249
    v_mfma_f32_16x16x32_bf16 v[132:135], a[252:255], v[228:231], v[132:135]
    v_fmac_f32 v249, s29, v209
    v_cvt_pk_bf16_f32 v207, v248, v207
    v_mfma_f32_16x16x32_bf16 v[136:139], v[240:243], v[228:231], v[136:139]
    s_waitcnt lgkmcnt(1)
    v_cvt_pk_bf16_f32 v213, v251, v213
    v_cvt_pk_bf16_f32 v211, v250, v211
    v_mfma_f32_16x16x32_bf16 v[140:143], v[244:247], v[228:231], v[140:143]
    ds_read_b128 v[228:231], v253 offset:32256
    v_cvt_pk_bf16_f32 v209, v252, v249
    v_mfma_f32_16x16x32_bf16 v[168:171], a[228:231], v[232:235], v[168:171]
    v_lshrrev_b32 v252, 15, v255
    v_mfma_f32_16x16x32_bf16 v[172:175], a[232:235], v[232:235], v[172:175]
    ds_write_b64 v252, v[206:207] offset:0
    v_mfma_f32_16x16x32_bf16 v[176:179], a[236:239], v[232:235], v[176:179]
    s_waitcnt vmcnt(15)
    v_lshlrev_b32 v248, 16, v218
    v_lshlrev_b32 v249, 16, v220
    v_mfma_f32_16x16x32_bf16 v[156:159], a[240:243], v[232:235], v[156:159]
    ds_write_b64 v252, v[212:213] offset:2080
    v_mfma_f32_16x16x32_bf16 v[160:163], a[244:247], v[232:235], v[160:163]
    v_lshlrev_b32 v250, 16, v222
    v_lshlrev_b32 v251, 16, v224
    v_mfma_f32_16x16x32_bf16 v[164:167], a[248:251], v[232:235], v[164:167]
    ds_write_b64 v252, v[210:211] offset:4160
    v_mfma_f32_16x16x32_bf16 v[144:147], a[252:255], v[232:235], v[144:147]
    s_waitcnt lgkmcnt(4)
    v_and_b32 v218, s22, v218
    v_and_b32 v220, s22, v220
    v_mfma_f32_16x16x32_bf16 v[148:151], v[240:243], v[232:235], v[148:151]
    ds_write_b64 v252, v[204:205] offset:16640
    v_mfma_f32_16x16x32_bf16 v[152:155], v[244:247], v[232:235], v[152:155]
    ds_read_b128 v[232:235], v253 offset:31984
    v_and_b32 v222, s22, v222
    v_mfma_f32_16x16x32_bf16 v[180:183], a[228:231], v[236:239], v[180:183]
    v_and_b32 v224, s22, v224
    v_mfma_f32_16x16x32_bf16 v[184:187], a[232:235], v[236:239], v[184:187]
    ds_write_b64 v252, v[214:215] offset:24960
    v_mfma_f32_16x16x32_bf16 v[188:191], a[236:239], v[236:239], v[188:191]
    s_mov_b32 s42, 331776
    v_mfma_f32_16x16x32_bf16 v[168:171], a[240:243], v[236:239], v[168:171]
    buffer_load_dwordx4 a[228:231], v254, s[8:11], s42 offen offset:0
    v_mfma_f32_16x16x32_bf16 v[172:175], a[244:247], v[236:239], v[172:175]
    ds_write_b64 v252, v[208:209] offset:6240
    v_mfma_f32_16x16x32_bf16 v[176:179], a[248:251], v[236:239], v[176:179]
    s_waitcnt lgkmcnt(7)
    v_mfma_f32_16x16x32_bf16 v[156:159], a[252:255], v[236:239], v[156:159]
    buffer_load_dwordx4 a[232:235], v254, s[8:11], s42 offen offset:1024
    v_mfma_f32_16x16x32_bf16 v[160:163], v[240:243], v[236:239], v[160:163]
    s_waitcnt lgkmcnt(0)
    v_lshlrev_b32 v252, 16, v216
    v_and_b32 v216, s22, v216
    v_mfma_f32_16x16x32_bf16 v[164:167], v[244:247], v[236:239], v[164:167]
    s_barrier
    v_mfma_f32_16x16x32_bf16 v[180:183], a[240:243], v[228:231], v[180:183]
    ds_read_b128 v[236:239], v253 offset:1040
    v_add_f32 v252, v252, v251
    v_mfma_f32_16x16x32_bf16 v[184:187], a[244:247], v[228:231], v[184:187]
    v_add_f32 v216, v216, v224
    v_fmac_f32 v252, s23, v249
    v_mfma_f32_16x16x32_bf16 v[188:191], a[248:251], v[228:231], v[188:191]
    buffer_load_dwordx4 a[236:239], v254, s[8:11], s42 offen offset:2048
    v_mfma_f32_16x16x32_bf16 v[168:171], a[252:255], v[228:231], v[168:171]
    v_fmac_f32 v216, s23, v220
    v_cvt_pk_bf16_f32 v216, v252, v216
    v_mfma_f32_16x16x32_bf16 v[172:175], v[240:243], v[228:231], v[172:175]
    s_mov_b32 s42, 334848
    v_lshlrev_b32 v252, 16, v226
    v_and_b32 v226, s22, v226
    v_mfma_f32_16x16x32_bf16 v[176:179], v[244:247], v[228:231], v[176:179]
    ds_read_b128 v[228:231], v253 offset:768
    v_add_f32 v252, v252, v248
    v_mfma_f32_16x16x32_bf16 v[180:183], a[252:255], v[232:235], v[180:183]
    buffer_load_dwordx4 a[240:243], v254, s[8:11], s42 offen offset:0
    v_mfma_f32_16x16x32_bf16 v[184:187], v[240:243], v[232:235], v[184:187]
    s_waitcnt vmcnt(16) lgkmcnt(1)
    v_add_f32 v226, v226, v218
    v_fmac_f32 v252, s23, v250
    v_mfma_f32_16x16x32_bf16 v[188:191], v[244:247], v[232:235], v[188:191]
    ds_read_b128 v[232:235], v253 offset:512
    v_fmac_f32 v226, s23, v222
    v_mfma_f32_16x16x32_bf16 a[0:3], a[192:195], v[236:239], a[0:3]
    s_waitcnt lgkmcnt(1)
    v_cvt_pk_bf16_f32 v226, v252, v226
    v_fma_f32 v252, v249, s24, v251
    v_mfma_f32_16x16x32_bf16 a[4:7], a[196:199], v[236:239], a[4:7]
    buffer_load_dwordx4 a[244:247], v254, s[8:11], s42 offen offset:1024
    v_mfma_f32_16x16x32_bf16 a[8:11], a[200:203], v[236:239], a[8:11]
    ds_read_b128 v[236:239], v253 offset:256
    v_fmac_f32 v251, s25, v249
    v_mfma_f32_16x16x32_bf16 a[12:15], a[192:195], v[228:231], a[12:15]
    v_fma_f32 v249, v248, s24, v250
    v_fmac_f32 v250, s25, v248
    v_fma_f32 v248, v250, s26, v251
    v_mfma_f32_16x16x32_bf16 a[16:19], a[196:199], v[228:231], a[16:19]
    s_waitcnt vmcnt(14)
    v_fmac_f32 v251, s27, v250
    v_fma_f32 v250, v249, s28, v252
    v_mfma_f32_16x16x32_bf16 a[20:23], a[200:203], v[228:231], a[20:23]
    buffer_load_dwordx4 a[248:251], v254, s[8:11], s42 offen offset:2048
    v_mfma_f32_16x16x32_bf16 a[0:3], a[204:207], v[228:231], a[0:3]
    s_waitcnt lgkmcnt(1)
    v_fmac_f32 v252, s29, v249
    v_fma_f32 v249, v220, s24, v224
    v_mfma_f32_16x16x32_bf16 a[4:7], a[208:211], v[228:231], a[4:7]
    s_mov_b32 s42, 337920
    v_fmac_f32 v224, s25, v220
    v_fma_f32 v220, v218, s24, v222
    v_mfma_f32_16x16x32_bf16 a[8:11], a[212:215], v[228:231], a[8:11]
    ds_read_b128 v[228:231], v253 offset:0
    v_fmac_f32 v222, s25, v218
    v_mfma_f32_16x16x32_bf16 a[24:27], a[192:195], v[232:235], a[24:27]
    buffer_load_dwordx4 a[252:255], v254, s[8:11], s42 offen offset:0
    v_mfma_f32_16x16x32_bf16 a[28:31], a[196:199], v[232:235], a[28:31]
    v_fma_f32 v218, v222, s26, v224
    v_fmac_f32 v224, s27, v222
    v_mfma_f32_16x16x32_bf16 a[32:35], a[200:203], v[232:235], a[32:35]
    v_fma_f32 v222, v220, s28, v249
    v_fmac_f32 v249, s29, v220
    v_mfma_f32_16x16x32_bf16 a[12:15], a[204:207], v[232:235], a[12:15]
    v_cvt_pk_bf16_f32 v218, v248, v218
    v_cvt_pk_bf16_f32 v224, v251, v224
    v_mfma_f32_16x16x32_bf16 a[16:19], a[208:211], v[232:235], a[16:19]
    buffer_load_dwordx4 v[240:243], v254, s[8:11], s42 offen offset:1024
    v_mfma_f32_16x16x32_bf16 a[20:23], a[212:215], v[232:235], a[20:23]
    s_waitcnt vmcnt(14)
    v_cvt_pk_bf16_f32 v222, v250, v222
    v_cvt_pk_bf16_f32 v220, v252, v249
    v_mfma_f32_16x16x32_bf16 a[0:3], a[216:219], v[232:235], a[0:3]
    s_waitcnt lgkmcnt(1)
    v_lshlrev_b32 v248, 16, v219
    v_lshlrev_b32 v249, 16, v221
    v_mfma_f32_16x16x32_bf16 a[4:7], a[220:223], v[232:235], a[4:7]
    buffer_load_dwordx4 v[244:247], v254, s[8:11], s42 offen offset:2048
    v_mfma_f32_16x16x32_bf16 a[8:11], a[224:227], v[232:235], a[8:11]
    ds_read_b128 v[232:235], v253 offset:1824
    v_and_b32 v215, 0x7fff, v255
    v_mfma_f32_16x16x32_bf16 a[36:39], a[192:195], v[236:239], a[36:39]
    v_lshlrev_b32 v250, 16, v223
    v_lshlrev_b32 v251, 16, v225
    v_mfma_f32_16x16x32_bf16 a[40:43], a[196:199], v[236:239], a[40:43]
    buffer_load_dwordx2 v[204:205], v215, s[4:7], s16 offen offset:960
    v_mfma_f32_16x16x32_bf16 a[44:47], a[200:203], v[236:239], a[44:47]
    v_and_b32 v219, s22, v219
    v_and_b32 v221, s22, v221
    v_mfma_f32_16x16x32_bf16 a[24:27], a[204:207], v[236:239], a[24:27]
    v_and_b32 v223, s22, v223
    v_and_b32 v225, s22, v225
    v_mfma_f32_16x16x32_bf16 a[28:31], a[208:211], v[236:239], a[28:31]
    buffer_load_dwordx2 v[206:207], v215, s[4:7], s17 offen offset:960
    v_mfma_f32_16x16x32_bf16 a[32:35], a[212:215], v[236:239], a[32:35]
    v_lshlrev_b32 v252, 16, v217
    v_and_b32 v217, s22, v217
    v_add_f32 v252, v252, v251
    v_mfma_f32_16x16x32_bf16 a[12:15], a[216:219], v[236:239], a[12:15]
    s_waitcnt lgkmcnt(1)
    v_add_f32 v217, v217, v225
    v_fmac_f32 v252, s23, v249
    v_mfma_f32_16x16x32_bf16 a[16:19], a[220:223], v[236:239], a[16:19]
    buffer_load_dwordx2 v[208:209], v215, s[4:7], s18 offen offset:960
    v_mfma_f32_16x16x32_bf16 a[20:23], a[224:227], v[236:239], a[20:23]
    ds_read_b128 v[236:239], v253 offset:1568
    v_fmac_f32 v217, s23, v221
    v_mfma_f32_16x16x32_bf16 a[48:51], a[192:195], v[228:231], a[48:51]
    v_cvt_pk_bf16_f32 v217, v252, v217
    v_lshlrev_b32 v252, 16, v227
    v_mfma_f32_16x16x32_bf16 a[52:55], a[196:199], v[228:231], a[52:55]
    buffer_load_dwordx2 v[210:211], v215, s[4:7], s19 offen offset:960
    v_mfma_f32_16x16x32_bf16 a[56:59], a[200:203], v[228:231], a[56:59]
    v_and_b32 v227, s22, v227
    v_add_f32 v252, v252, v248
    v_mfma_f32_16x16x32_bf16 a[36:39], a[204:207], v[228:231], a[36:39]
    v_add_f32 v227, v227, v219
    v_fmac_f32 v252, s23, v250
    v_mfma_f32_16x16x32_bf16 a[40:43], a[208:211], v[228:231], a[40:43]
    buffer_load_dwordx2 v[212:213], v215, s[4:7], s20 offen offset:960
    v_mfma_f32_16x16x32_bf16 a[44:47], a[212:215], v[228:231], a[44:47]
    v_fmac_f32 v227, s23, v223
    v_cvt_pk_bf16_f32 v227, v252, v227
    v_mfma_f32_16x16x32_bf16 a[24:27], a[216:219], v[228:231], a[24:27]
    s_waitcnt lgkmcnt(1)
    v_fma_f32 v252, v249, s24, v251
    v_fmac_f32 v251, s25, v249
    v_mfma_f32_16x16x32_bf16 a[28:31], a[220:223], v[228:231], a[28:31]
    buffer_load_dwordx2 v[214:215], v215, s[4:7], s21 offen offset:960
    v_mfma_f32_16x16x32_bf16 a[32:35], a[224:227], v[228:231], a[32:35]
    ds_read_b128 v[228:231], v253 offset:1312
    v_fma_f32 v249, v248, s24, v250
    v_mfma_f32_16x16x32_bf16 a[60:63], a[192:195], v[232:235], a[60:63]
    v_fmac_f32 v250, s25, v248
    v_fma_f32 v248, v250, s26, v251
    v_mfma_f32_16x16x32_bf16 a[64:67], a[196:199], v[232:235], a[64:67]
    v_fmac_f32 v251, s27, v250
    v_fma_f32 v250, v249, s28, v252
    v_mfma_f32_16x16x32_bf16 a[68:71], a[200:203], v[232:235], a[68:71]
    v_fmac_f32 v252, s29, v249
    v_fma_f32 v249, v221, s24, v225
    v_mfma_f32_16x16x32_bf16 a[48:51], a[204:207], v[232:235], a[48:51]
    v_fmac_f32 v225, s25, v221
    v_fma_f32 v221, v219, s24, v223
    v_mfma_f32_16x16x32_bf16 a[52:55], a[208:211], v[232:235], a[52:55]
    v_fmac_f32 v223, s25, v219
    v_fma_f32 v219, v223, s26, v225
    v_mfma_f32_16x16x32_bf16 a[56:59], a[212:215], v[232:235], a[56:59]
    v_fmac_f32 v225, s27, v223
    v_fma_f32 v223, v221, s28, v249
    v_mfma_f32_16x16x32_bf16 a[36:39], a[216:219], v[232:235], a[36:39]
    v_fmac_f32 v249, s29, v221
    v_cvt_pk_bf16_f32 v219, v248, v219
    v_mfma_f32_16x16x32_bf16 a[40:43], a[220:223], v[232:235], a[40:43]
    s_waitcnt lgkmcnt(1)
    v_cvt_pk_bf16_f32 v225, v251, v225
    v_cvt_pk_bf16_f32 v223, v250, v223
    v_cvt_pk_bf16_f32 v221, v252, v249
    v_mfma_f32_16x16x32_bf16 a[44:47], a[224:227], v[232:235], a[44:47]
    ds_read_b128 v[232:235], v253 offset:1056
    v_lshrrev_b32 v252, 15, v255
    v_mfma_f32_16x16x32_bf16 a[72:75], a[192:195], v[236:239], a[72:75]
    ds_write_b64 v252, v[218:219] offset:9088
    v_mfma_f32_16x16x32_bf16 a[76:79], a[196:199], v[236:239], a[76:79]
    s_waitcnt vmcnt(15)
    v_lshlrev_b32 v248, 16, v194
    v_lshlrev_b32 v249, 16, v196
    v_mfma_f32_16x16x32_bf16 a[80:83], a[200:203], v[236:239], a[80:83]
    ds_write_b64 v252, v[224:225] offset:11168
    v_mfma_f32_16x16x32_bf16 a[60:63], a[204:207], v[236:239], a[60:63]
    v_lshlrev_b32 v250, 16, v198
    v_lshlrev_b32 v251, 16, v200
    v_mfma_f32_16x16x32_bf16 a[64:67], a[208:211], v[236:239], a[64:67]
    ds_write_b64 v252, v[222:223] offset:13248
    v_mfma_f32_16x16x32_bf16 a[68:71], a[212:215], v[236:239], a[68:71]
    v_and_b32 v194, s22, v194
    v_and_b32 v196, s22, v196
    v_mfma_f32_16x16x32_bf16 a[48:51], a[216:219], v[236:239], a[48:51]
    ds_write_b64 v252, v[216:217] offset:19488
    v_mfma_f32_16x16x32_bf16 a[52:55], a[220:223], v[236:239], a[52:55]
    s_waitcnt lgkmcnt(5)
    v_and_b32 v198, s22, v198
    v_and_b32 v200, s22, v200
    v_mfma_f32_16x16x32_bf16 a[56:59], a[224:227], v[236:239], a[56:59]
    ds_read_b128 v[236:239], v253 offset:784
    v_mfma_f32_16x16x32_bf16 a[84:87], a[192:195], v[228:231], a[84:87]
    ds_write_b64 v252, v[226:227] offset:27808
    v_mfma_f32_16x16x32_bf16 a[88:91], a[196:199], v[228:231], a[88:91]
    v_mfma_f32_16x16x32_bf16 a[92:95], a[200:203], v[228:231], a[92:95]
    s_mov_b32 s42, 368640
    v_mfma_f32_16x16x32_bf16 a[72:75], a[204:207], v[228:231], a[72:75]
    buffer_load_dwordx4 a[192:195], v254, s[8:11], s42 offen offset:0
    v_mfma_f32_16x16x32_bf16 a[76:79], a[208:211], v[228:231], a[76:79]
    ds_write_b64 v252, v[220:221] offset:31968
    v_mfma_f32_16x16x32_bf16 a[80:83], a[212:215], v[228:231], a[80:83]
    v_mfma_f32_16x16x32_bf16 a[60:63], a[216:219], v[228:231], a[60:63]
    buffer_load_dwordx4 a[196:199], v254, s[8:11], s42 offen offset:1024
    v_mfma_f32_16x16x32_bf16 a[64:67], a[220:223], v[228:231], a[64:67]
    v_lshlrev_b32 v252, 16, v192
    v_and_b32 v192, s22, v192
    v_mfma_f32_16x16x32_bf16 a[68:71], a[224:227], v[228:231], a[68:71]
    s_waitcnt lgkmcnt(7)
    v_add_f32 v252, v252, v251
    v_add_f32 v192, v192, v200
    v_mfma_f32_16x16x32_bf16 a[84:87], a[204:207], v[232:235], a[84:87]
    ds_read_b128 v[228:231], v253 offset:3120
    v_fmac_f32 v252, s23, v249
    v_mfma_f32_16x16x32_bf16 a[88:91], a[208:211], v[232:235], a[88:91]
    v_fmac_f32 v192, s23, v196
    v_cvt_pk_bf16_f32 v192, v252, v192
    v_mfma_f32_16x16x32_bf16 a[92:95], a[212:215], v[232:235], a[92:95]
    buffer_load_dwordx4 a[200:203], v254, s[8:11], s42 offen offset:2048
    v_mfma_f32_16x16x32_bf16 a[72:75], a[216:219], v[232:235], a[72:75]
    s_waitcnt lgkmcnt(3)
    v_lshlrev_b32 v252, 16, v202
    v_and_b32 v202, s22, v202
    v_mfma_f32_16x16x32_bf16 a[76:79], a[220:223], v[232:235], a[76:79]
    s_mov_b32 s42, 371712
    v_add_f32 v252, v252, v248
    v_add_f32 v202, v202, v194
    v_mfma_f32_16x16x32_bf16 a[80:83], a[224:227], v[232:235], a[80:83]
    ds_read_b128 v[232:235], v253 offset:2848
    v_fmac_f32 v252, s23, v250
    v_mfma_f32_16x16x32_bf16 a[84:87], a[216:219], v[236:239], a[84:87]
    buffer_load_dwordx4 a[204:207], v254, s[8:11], s42 offen offset:0
    v_mfma_f32_16x16x32_bf16 a[88:91], a[220:223], v[236:239], a[88:91]
    s_waitcnt vmcnt(16) lgkmcnt(1)
    v_fmac_f32 v202, s23, v198
    v_cvt_pk_bf16_f32 v202, v252, v202
    v_mfma_f32_16x16x32_bf16 a[92:95], a[224:227], v[236:239], a[92:95]
    ds_read_b128 v[236:239], v253 offset:2592
    v_fma_f32 v252, v249, s24, v251
    v_mfma_f32_16x16x32_bf16 a[96:99], a[228:231], v[228:231], a[96:99]
    s_waitcnt lgkmcnt(1)
    v_fmac_f32 v251, s25, v249
    v_fma_f32 v249, v248, s24, v250
    v_mfma_f32_16x16x32_bf16 a[100:103], a[232:235], v[228:231], a[100:103]
    buffer_load_dwordx4 a[208:211], v254, s[8:11], s42 offen offset:1024
    v_mfma_f32_16x16x32_bf16 a[104:107], a[236:239], v[228:231], a[104:107]
    ds_read_b128 v[228:231], v253 offset:2336
    v_fmac_f32 v250, s25, v248
    v_mfma_f32_16x16x32_bf16 a[108:111], a[228:231], v[232:235], a[108:111]
    v_fma_f32 v248, v250, s26, v251
    v_fmac_f32 v251, s27, v250
    v_mfma_f32_16x16x32_bf16 a[112:115], a[232:235], v[232:235], a[112:115]
    s_waitcnt vmcnt(14)
    v_fma_f32 v250, v249, s28, v252
    v_fmac_f32 v252, s29, v249
    v_mfma_f32_16x16x32_bf16 a[116:119], a[236:239], v[232:235], a[116:119]
    buffer_load_dwordx4 a[212:215], v254, s[8:11], s42 offen offset:2048
    v_mfma_f32_16x16x32_bf16 a[96:99], a[240:243], v[232:235], a[96:99]
    s_waitcnt lgkmcnt(1)
    v_fma_f32 v249, v196, s24, v200
    v_fmac_f32 v200, s25, v196
    v_mfma_f32_16x16x32_bf16 a[100:103], a[244:247], v[232:235], a[100:103]
    s_mov_b32 s42, 374784
    v_fma_f32 v196, v194, s24, v198
    v_fmac_f32 v198, s25, v194
    v_mfma_f32_16x16x32_bf16 a[104:107], a[248:251], v[232:235], a[104:107]
    ds_read_b128 v[232:235], v253 offset:2080
    v_fma_f32 v194, v198, s26, v200
    v_mfma_f32_16x16x32_bf16 a[120:123], a[228:231], v[236:239], a[120:123]
    buffer_load_dwordx4 a[216:219], v254, s[8:11], s42 offen offset:0
    v_mfma_f32_16x16x32_bf16 a[124:127], a[232:235], v[236:239], a[124:127]
    v_fmac_f32 v200, s27, v198
    v_fma_f32 v198, v196, s28, v249
    v_mfma_f32_16x16x32_bf16 a[128:131], a[236:239], v[236:239], a[128:131]
    v_fmac_f32 v249, s29, v196
    v_cvt_pk_bf16_f32 v194, v248, v194
    v_mfma_f32_16x16x32_bf16 a[108:111], a[240:243], v[236:239], a[108:111]
    v_cvt_pk_bf16_f32 v200, v251, v200
    v_cvt_pk_bf16_f32 v198, v250, v198
    v_mfma_f32_16x16x32_bf16 a[112:115], a[244:247], v[236:239], a[112:115]
    buffer_load_dwordx4 a[220:223], v254, s[8:11], s42 offen offset:1024
    v_mfma_f32_16x16x32_bf16 a[116:119], a[248:251], v[236:239], a[116:119]
    s_waitcnt vmcnt(14)
    v_cvt_pk_bf16_f32 v196, v252, v249
    v_lshlrev_b32 v248, 16, v195
    v_mfma_f32_16x16x32_bf16 a[96:99], a[252:255], v[236:239], a[96:99]
    s_waitcnt lgkmcnt(1)
    v_lshlrev_b32 v249, 16, v197
    v_lshlrev_b32 v250, 16, v199
    v_mfma_f32_16x16x32_bf16 a[100:103], v[240:243], v[236:239], a[100:103]
    buffer_load_dwordx4 a[224:227], v254, s[8:11], s42 offen offset:2048
    v_mfma_f32_16x16x32_bf16 a[104:107], v[244:247], v[236:239], a[104:107]
    ds_read_b128 v[236:239], v253 offset:3904
    v_and_b32 v227, 0x7fff, v255
    v_mfma_f32_16x16x32_bf16 a[132:135], a[228:231], v[228:231], a[132:135]
    v_lshlrev_b32 v251, 16, v201
    v_and_b32 v195, s22, v195
    v_mfma_f32_16x16x32_bf16 a[136:139], a[232:235], v[228:231], a[136:139]
    buffer_load_dwordx2 v[216:217], v227, s[4:7], s16 offen offset:1344
    v_mfma_f32_16x16x32_bf16 a[140:143], a[236:239], v[228:231], a[140:143]
    v_and_b32 v197, s22, v197
    v_and_b32 v199, s22, v199
    v_mfma_f32_16x16x32_bf16 a[120:123], a[240:243], v[228:231], a[120:123]
    v_and_b32 v201, s22, v201
    v_lshlrev_b32 v252, 16, v193
    v_mfma_f32_16x16x32_bf16 a[124:127], a[244:247], v[228:231], a[124:127]
    buffer_load_dwordx2 v[218:219], v227, s[4:7], s17 offen offset:1344
    v_mfma_f32_16x16x32_bf16 a[128:131], a[248:251], v[228:231], a[128:131]
    v_and_b32 v193, s22, v193
    v_add_f32 v252, v252, v251
    v_mfma_f32_16x16x32_bf16 a[108:111], a[252:255], v[228:231], a[108:111]
    s_waitcnt lgkmcnt(1)
    v_add_f32 v193, v193, v201
    v_fmac_f32 v252, s23, v249
    v_mfma_f32_16x16x32_bf16 a[112:115], v[240:243], v[228:231], a[112:115]
    buffer_load_dwordx2 v[220:221], v227, s[4:7], s18 offen offset:1344
    v_mfma_f32_16x16x32_bf16 a[116:119], v[244:247], v[228:231], a[116:119]
    ds_read_b128 v[228:231], v253 offset:3648
    v_fmac_f32 v193, s23, v197
    v_mfma_f32_16x16x32_bf16 a[144:147], a[228:231], v[232:235], a[144:147]
    v_cvt_pk_bf16_f32 v193, v252, v193
    v_lshlrev_b32 v252, 16, v203
    v_mfma_f32_16x16x32_bf16 a[148:151], a[232:235], v[232:235], a[148:151]
    buffer_load_dwordx2 v[222:223], v227, s[4:7], s19 offen offset:1344
    v_mfma_f32_16x16x32_bf16 a[152:155], a[236:239], v[232:235], a[152:155]
    v_and_b32 v203, s22, v203
    v_add_f32 v252, v252, v248
    v_mfma_f32_16x16x32_bf16 a[132:135], a[240:243], v[232:235], a[132:135]
    v_add_f32 v203, v203, v195
    v_fmac_f32 v252, s23, v250
    v_mfma_f32_16x16x32_bf16 a[136:139], a[244:247], v[232:235], a[136:139]
    buffer_load_dwordx2 v[224:225], v227, s[4:7], s20 offen offset:1344
    v_mfma_f32_16x16x32_bf16 a[140:143], a[248:251], v[232:235], a[140:143]
    v_fmac_f32 v203, s23, v199
    v_cvt_pk_bf16_f32 v203, v252, v203
    v_mfma_f32_16x16x32_bf16 a[120:123], a[252:255], v[232:235], a[120:123]
    s_waitcnt lgkmcnt(1)
    v_fma_f32 v252, v249, s24, v251
    v_fmac_f32 v251, s25, v249
    v_mfma_f32_16x16x32_bf16 a[124:127], v[240:243], v[232:235], a[124:127]
    buffer_load_dwordx2 v[226:227], v227, s[4:7], s21 offen offset:1344
    v_mfma_f32_16x16x32_bf16 a[128:131], v[244:247], v[232:235], a[128:131]
    ds_read_b128 v[232:235], v253 offset:3392
    v_fma_f32 v249, v248, s24, v250
    v_mfma_f32_16x16x32_bf16 a[156:159], a[228:231], v[236:239], a[156:159]
    v_fmac_f32 v250, s25, v248
    v_fma_f32 v248, v250, s26, v251
    v_mfma_f32_16x16x32_bf16 a[160:163], a[232:235], v[236:239], a[160:163]
    v_fmac_f32 v251, s27, v250
    v_fma_f32 v250, v249, s28, v252
    v_mfma_f32_16x16x32_bf16 a[164:167], a[236:239], v[236:239], a[164:167]
    v_fmac_f32 v252, s29, v249
    v_fma_f32 v249, v197, s24, v201
    v_mfma_f32_16x16x32_bf16 a[144:147], a[240:243], v[236:239], a[144:147]
    v_fmac_f32 v201, s25, v197
    v_fma_f32 v197, v195, s24, v199
    v_mfma_f32_16x16x32_bf16 a[148:151], a[244:247], v[236:239], a[148:151]
    v_fmac_f32 v199, s25, v195
    v_fma_f32 v195, v199, s26, v201
    v_mfma_f32_16x16x32_bf16 a[152:155], a[248:251], v[236:239], a[152:155]
    v_fmac_f32 v201, s27, v199
    v_fma_f32 v199, v197, s28, v249
    v_mfma_f32_16x16x32_bf16 a[132:135], a[252:255], v[236:239], a[132:135]
    v_fmac_f32 v249, s29, v197
    v_cvt_pk_bf16_f32 v195, v248, v195
    v_mfma_f32_16x16x32_bf16 a[136:139], v[240:243], v[236:239], a[136:139]
    s_waitcnt lgkmcnt(1)
    v_cvt_pk_bf16_f32 v201, v251, v201
    v_cvt_pk_bf16_f32 v199, v250, v199
    v_mfma_f32_16x16x32_bf16 a[140:143], v[244:247], v[236:239], a[140:143]
    ds_read_b128 v[236:239], v253 offset:3136
    v_cvt_pk_bf16_f32 v197, v252, v249
    v_mfma_f32_16x16x32_bf16 a[168:171], a[228:231], v[228:231], a[168:171]
    v_lshrrev_b32 v252, 15, v255
    v_mfma_f32_16x16x32_bf16 a[172:175], a[232:235], v[228:231], a[172:175]
    ds_write_b64 v252, v[194:195] offset:8832
    v_mfma_f32_16x16x32_bf16 a[176:179], a[236:239], v[228:231], a[176:179]
    s_waitcnt vmcnt(15)
    v_lshlrev_b32 v248, 16, v206
    v_lshlrev_b32 v249, 16, v208
    v_mfma_f32_16x16x32_bf16 a[156:159], a[240:243], v[228:231], a[156:159]
    ds_write_b64 v252, v[200:201] offset:10912
    v_mfma_f32_16x16x32_bf16 a[160:163], a[244:247], v[228:231], a[160:163]
    v_lshlrev_b32 v250, 16, v210
    v_lshlrev_b32 v251, 16, v212
    v_mfma_f32_16x16x32_bf16 a[164:167], a[248:251], v[228:231], a[164:167]
    ds_write_b64 v252, v[198:199] offset:12992
    v_mfma_f32_16x16x32_bf16 a[144:147], a[252:255], v[228:231], a[144:147]
    s_waitcnt lgkmcnt(4)
    v_and_b32 v206, s22, v206
    v_and_b32 v208, s22, v208
    v_mfma_f32_16x16x32_bf16 a[148:151], v[240:243], v[228:231], a[148:151]
    ds_write_b64 v252, v[192:193] offset:19232
    v_mfma_f32_16x16x32_bf16 a[152:155], v[244:247], v[228:231], a[152:155]
    ds_read_b128 v[228:231], v253 offset:2864
    v_and_b32 v210, s22, v210
    v_mfma_f32_16x16x32_bf16 a[180:183], a[228:231], v[232:235], a[180:183]
    v_and_b32 v212, s22, v212
    v_mfma_f32_16x16x32_bf16 a[184:187], a[232:235], v[232:235], a[184:187]
    ds_write_b64 v252, v[202:203] offset:27552
    v_mfma_f32_16x16x32_bf16 a[188:191], a[236:239], v[232:235], a[188:191]
    s_mov_b32 s42, 405504
    v_mfma_f32_16x16x32_bf16 a[168:171], a[240:243], v[232:235], a[168:171]
    buffer_load_dwordx4 a[228:231], v254, s[8:11], s42 offen offset:0
    v_mfma_f32_16x16x32_bf16 a[172:175], a[244:247], v[232:235], a[172:175]
    ds_write_b64 v252, v[196:197] offset:31712
    v_mfma_f32_16x16x32_bf16 a[176:179], a[248:251], v[232:235], a[176:179]
    v_mfma_f32_16x16x32_bf16 a[156:159], a[252:255], v[232:235], a[156:159]
    buffer_load_dwordx4 a[232:235], v254, s[8:11], s42 offen offset:1024
    v_mfma_f32_16x16x32_bf16 a[160:163], v[240:243], v[232:235], a[160:163]
    v_lshlrev_b32 v252, 16, v204
    v_and_b32 v204, s22, v204
    v_mfma_f32_16x16x32_bf16 a[164:167], v[244:247], v[232:235], a[164:167]
    s_waitcnt lgkmcnt(2)
    v_add_f32 v252, v252, v251
    v_add_f32 v204, v204, v212
    v_mfma_f32_16x16x32_bf16 a[180:183], a[240:243], v[236:239], a[180:183]
    ds_read_b128 v[232:235], v253 offset:5200
    v_fmac_f32 v252, s23, v249
    v_mfma_f32_16x16x32_bf16 a[184:187], a[244:247], v[236:239], a[184:187]
    ds_read_b128 v[192:195], v253 offset:40096
    v_fmac_f32 v204, s23, v208
    v_mfma_f32_16x16x32_bf16 a[188:191], a[248:251], v[236:239], a[188:191]
    buffer_load_dwordx4 a[236:239], v254, s[8:11], s42 offen offset:2048
    v_cvt_pk_bf16_f32 v204, v252, v204
    v_mfma_f32_16x16x32_bf16 a[168:171], a[252:255], v[236:239], a[168:171]
    s_mov_b32 s45, 452138121
    v_lshlrev_b32 v252, 16, v214
    v_and_b32 v214, s22, v214
    v_mfma_f32_16x16x32_bf16 a[172:175], v[240:243], v[236:239], a[172:175]
    s_mov_b32 s42, 408576
    v_add_f32 v252, v252, v248
    v_add_f32 v214, v214, v206
    v_mfma_f32_16x16x32_bf16 a[176:179], v[244:247], v[236:239], a[176:179]
    ds_read_b128 v[236:239], v253 offset:4928
    v_bfe_u32 v196, v254, 5, 3
    v_mfma_f32_16x16x32_bf16 a[180:183], a[252:255], v[228:231], a[180:183]
    buffer_load_dwordx4 a[240:243], v254, s[8:11], s42 offen offset:0
    v_mfma_f32_16x16x32_bf16 a[184:187], v[240:243], v[228:231], a[184:187]
    s_waitcnt vmcnt(16) lgkmcnt(2)
    v_fmac_f32 v252, s23, v250
    v_fmac_f32 v214, s23, v210
    v_mfma_f32_16x16x32_bf16 a[188:191], v[244:247], v[228:231], a[188:191]
    ds_read_b128 v[228:231], v253 offset:4672
    v_mul_u32_u24 v197, 5, v196
    v_cvt_pk_bf16_f32 v214, v252, v214
    v_mfma_f32_16x16x32_bf16 v[0:3], a[192:195], v[232:235], v[0:3]
    s_waitcnt lgkmcnt(1)
    v_fma_f32 v252, v249, s24, v251
    v_fmac_f32 v251, s25, v249
    v_mfma_f32_16x16x32_bf16 v[4:7], a[196:199], v[232:235], v[4:7]
    buffer_load_dwordx4 a[244:247], v254, s[8:11], s42 offen offset:1024
    v_mfma_f32_16x16x32_bf16 v[8:11], a[200:203], v[232:235], v[8:11]
    ds_read_b128 v[232:235], v253 offset:4416
    v_bfe_u32 v197, s45, v197, 5
    v_mfma_f32_16x16x32_bf16 v[12:15], a[192:195], v[236:239], v[12:15]
    v_fma_f32 v249, v248, s24, v250
    v_fmac_f32 v250, s25, v248
    v_mfma_f32_16x16x32_bf16 v[16:19], a[196:199], v[236:239], v[16:19]
    s_waitcnt vmcnt(14)
    v_mul_u32_u24 v197, 65, v197
    v_fma_f32 v248, v250, s26, v251
    v_mfma_f32_16x16x32_bf16 v[20:23], a[200:203], v[236:239], v[20:23]
    buffer_load_dwordx4 a[248:251], v254, s[8:11], s42 offen offset:2048
    v_mfma_f32_16x16x32_bf16 v[0:3], a[204:207], v[236:239], v[0:3]
    s_waitcnt lgkmcnt(1)
    v_sub_u32 v197, v197, v196
    v_fmac_f32 v251, s27, v250
    v_fma_f32 v250, v249, s28, v252
    v_mfma_f32_16x16x32_bf16 v[4:7], a[208:211], v[236:239], v[4:7]
    s_mov_b32 s42, 411648
    v_fmac_f32 v252, s29, v249
    v_fma_f32 v249, v208, s24, v212
    v_mfma_f32_16x16x32_bf16 v[8:11], a[212:215], v[236:239], v[8:11]
    ds_read_b128 v[236:239], v253 offset:4160
    v_lshl_add_u32 v196, v197, 5, v253
    v_mfma_f32_16x16x32_bf16 v[24:27], a[192:195], v[228:231], v[24:27]
    buffer_load_dwordx4 a[252:255], v254, s[8:11], s42 offen offset:0
    v_mfma_f32_16x16x32_bf16 v[28:31], a[196:199], v[228:231], v[28:31]
    v_fmac_f32 v212, s25, v208
    v_fma_f32 v208, v206, s24, v210
    v_mfma_f32_16x16x32_bf16 v[32:35], a[200:203], v[228:231], v[32:35]
    v_fmac_f32 v210, s25, v206
    v_fma_f32 v206, v210, s26, v212
    v_mfma_f32_16x16x32_bf16 v[12:15], a[204:207], v[228:231], v[12:15]
    s_waitcnt vmcnt(13)
    v_fmac_f32 v212, s27, v210
    v_fma_f32 v210, v208, s28, v249
    v_mfma_f32_16x16x32_bf16 v[16:19], a[208:211], v[228:231], v[16:19]
    buffer_load_dwordx4 v[240:243], v254, s[8:11], s42 offen offset:1024
    v_fmac_f32 v249, s29, v208
    v_mfma_f32_16x16x32_bf16 v[20:23], a[212:215], v[228:231], v[20:23]
    s_mov_b64 exec, s[46:47]
    ds_write_b128 v196, v[192:195] offset:1024
    s_mov_b64 exec, -1
    v_mfma_f32_16x16x32_bf16 v[0:3], a[216:219], v[228:231], v[0:3]
    s_waitcnt lgkmcnt(2)
    v_cvt_pk_bf16_f32 v206, v248, v206
    v_cvt_pk_bf16_f32 v212, v251, v212
    v_mfma_f32_16x16x32_bf16 v[4:7], a[220:223], v[228:231], v[4:7]
    buffer_load_dwordx4 v[244:247], v254, s[8:11], s42 offen offset:2048
    v_mfma_f32_16x16x32_bf16 v[8:11], a[224:227], v[228:231], v[8:11]
    ds_read_b128 v[228:231], v253 offset:5984
    v_and_b32 v203, 0x7fff, v255
    v_mfma_f32_16x16x32_bf16 v[36:39], a[192:195], v[232:235], v[36:39]
    v_cvt_pk_bf16_f32 v210, v250, v210
    v_cvt_pk_bf16_f32 v208, v252, v249
    v_mfma_f32_16x16x32_bf16 v[40:43], a[196:199], v[232:235], v[40:43]
    buffer_load_dwordx2 v[192:193], v203, s[4:7], s16 offen offset:256
    v_lshlrev_b32 v248, 16, v207
    v_mfma_f32_16x16x32_bf16 v[44:47], a[200:203], v[232:235], v[44:47]
    v_lshlrev_b32 v249, 16, v209
    v_lshlrev_b32 v250, 16, v211
    v_mfma_f32_16x16x32_bf16 v[24:27], a[204:207], v[232:235], v[24:27]
    v_lshlrev_b32 v251, 16, v213
    v_and_b32 v207, s22, v207
    v_mfma_f32_16x16x32_bf16 v[28:31], a[208:211], v[232:235], v[28:31]
    buffer_load_dwordx2 v[194:195], v203, s[4:7], s17 offen offset:256
    v_mfma_f32_16x16x32_bf16 v[32:35], a[212:215], v[232:235], v[32:35]
    v_and_b32 v209, s22, v209
    v_and_b32 v211, s22, v211
    v_mfma_f32_16x16x32_bf16 v[12:15], a[216:219], v[232:235], v[12:15]
    s_waitcnt lgkmcnt(2)
    v_and_b32 v213, s22, v213
    v_lshlrev_b32 v252, 16, v205
    v_mfma_f32_16x16x32_bf16 v[16:19], a[220:223], v[232:235], v[16:19]
    buffer_load_dwordx2 v[196:197], v203, s[4:7], s18 offen offset:256
    v_mfma_f32_16x16x32_bf16 v[20:23], a[224:227], v[232:235], v[20:23]
    ds_read_b128 v[232:235], v253 offset:5728
    v_and_b32 v205, s22, v205
    v_add_f32 v252, v252, v251
    v_mfma_f32_16x16x32_bf16 v[48:51], a[192:195], v[236:239], v[48:51]
    v_add_f32 v205, v205, v213
    v_fmac_f32 v252, s23, v249
    v_mfma_f32_16x16x32_bf16 v[52:55], a[196:199], v[236:239], v[52:55]
    buffer_load_dwordx2 v[198:199], v203, s[4:7], s19 offen offset:256
    v_mfma_f32_16x16x32_bf16 v[56:59], a[200:203], v[236:239], v[56:59]
    v_fmac_f32 v205, s23, v209
    v_cvt_pk_bf16_f32 v205, v252, v205
    v_mfma_f32_16x16x32_bf16 v[36:39], a[204:207], v[236:239], v[36:39]
    v_lshlrev_b32 v252, 16, v215
    v_and_b32 v215, s22, v215
    v_mfma_f32_16x16x32_bf16 v[40:43], a[208:211], v[236:239], v[40:43]
    buffer_load_dwordx2 v[200:201], v203, s[4:7], s20 offen offset:256
    v_mfma_f32_16x16x32_bf16 v[44:47], a[212:215], v[236:239], v[44:47]
    v_add_f32 v252, v252, v248
    v_add_f32 v215, v215, v207
    v_mfma_f32_16x16x32_bf16 v[24:27], a[216:219], v[236:239], v[24:27]
    s_waitcnt lgkmcnt(1)
    v_fmac_f32 v252, s23, v250
    v_fmac_f32 v215, s23, v211
    v_cvt_pk_bf16_f32 v215, v252, v215
    v_mfma_f32_16x16x32_bf16 v[28:31], a[220:223], v[236:239], v[28:31]
    buffer_load_dwordx2 v[202:203], v203, s[4:7], s21 offen offset:256
    v_mfma_f32_16x16x32_bf16 v[32:35], a[224:227], v[236:239], v[32:35]
    ds_read_b128 v[236:239], v253 offset:5472
    v_fma_f32 v252, v249, s24, v251
    v_mfma_f32_16x16x32_bf16 v[60:63], a[192:195], v[228:231], v[60:63]
    v_fmac_f32 v251, s25, v249
    v_fma_f32 v249, v248, s24, v250
    v_mfma_f32_16x16x32_bf16 v[64:67], a[196:199], v[228:231], v[64:67]
    v_fmac_f32 v250, s25, v248
    v_fma_f32 v248, v250, s26, v251
    v_mfma_f32_16x16x32_bf16 v[68:71], a[200:203], v[228:231], v[68:71]
    v_fmac_f32 v251, s27, v250
    v_fma_f32 v250, v249, s28, v252
    v_mfma_f32_16x16x32_bf16 v[48:51], a[204:207], v[228:231], v[48:51]
    v_fmac_f32 v252, s29, v249
    v_fma_f32 v249, v209, s24, v213
    v_fmac_f32 v213, s25, v209
    v_mfma_f32_16x16x32_bf16 v[52:55], a[208:211], v[228:231], v[52:55]
    v_fma_f32 v209, v207, s24, v211
    v_fmac_f32 v211, s25, v207
    v_mfma_f32_16x16x32_bf16 v[56:59], a[212:215], v[228:231], v[56:59]
    v_fma_f32 v207, v211, s26, v213
    v_fmac_f32 v213, s27, v211
    v_mfma_f32_16x16x32_bf16 v[36:39], a[216:219], v[228:231], v[36:39]
    v_fma_f32 v211, v209, s28, v249
    v_fmac_f32 v249, s29, v209
    v_mfma_f32_16x16x32_bf16 v[40:43], a[220:223], v[228:231], v[40:43]
    s_waitcnt lgkmcnt(1)
    v_cvt_pk_bf16_f32 v207, v248, v207
    v_cvt_pk_bf16_f32 v213, v251, v213
    v_mfma_f32_16x16x32_bf16 v[44:47], a[224:227], v[228:231], v[44:47]
    ds_read_b128 v[228:231], v253 offset:5216
    v_cvt_pk_bf16_f32 v211, v250, v211
    v_mfma_f32_16x16x32_bf16 v[72:75], a[192:195], v[232:235], v[72:75]
    v_cvt_pk_bf16_f32 v209, v252, v249
    v_lshrrev_b32 v252, 15, v255
    v_mfma_f32_16x16x32_bf16 v[76:79], a[196:199], v[232:235], v[76:79]
    ds_write_b64 v252, v[206:207] offset:8576
    s_waitcnt vmcnt(15)
    v_mfma_f32_16x16x32_bf16 v[80:83], a[200:203], v[232:235], v[80:83]
    v_lshlrev_b32 v248, 16, v218
    v_lshlrev_b32 v249, 16, v220
    v_mfma_f32_16x16x32_bf16 v[60:63], a[204:207], v[232:235], v[60:63]
    ds_write_b64 v252, v[212:213] offset:10656
    v_mfma_f32_16x16x32_bf16 v[64:67], a[208:211], v[232:235], v[64:67]
    v_lshlrev_b32 v250, 16, v222
    v_lshlrev_b32 v251, 16, v224
    v_mfma_f32_16x16x32_bf16 v[68:71], a[212:215], v[232:235], v[68:71]
    ds_write_b64 v252, v[210:211] offset:12736
    v_mfma_f32_16x16x32_bf16 v[48:51], a[216:219], v[232:235], v[48:51]
    s_waitcnt lgkmcnt(4)
    v_and_b32 v218, s22, v218
    v_and_b32 v220, s22, v220
    v_mfma_f32_16x16x32_bf16 v[52:55], a[220:223], v[232:235], v[52:55]
    ds_write_b64 v252, v[204:205] offset:18976
    v_mfma_f32_16x16x32_bf16 v[56:59], a[224:227], v[232:235], v[56:59]
    ds_read_b128 v[232:235], v253 offset:4944
    v_and_b32 v222, s22, v222
    v_and_b32 v224, s22, v224
    v_mfma_f32_16x16x32_bf16 v[84:87], a[192:195], v[236:239], v[84:87]
    ds_write_b64 v252, v[214:215] offset:27296
    v_mfma_f32_16x16x32_bf16 v[88:91], a[196:199], v[236:239], v[88:91]
    v_mfma_f32_16x16x32_bf16 v[92:95], a[200:203], v[236:239], v[92:95]
    s_mov_b32 s42, 442368
    v_mfma_f32_16x16x32_bf16 v[72:75], a[204:207], v[236:239], v[72:75]
    buffer_load_dwordx4 a[192:195], v254, s[8:11], s42 offen offset:0
    v_mfma_f32_16x16x32_bf16 v[76:79], a[208:211], v[236:239], v[76:79]
    ds_write_b64 v252, v[208:209] offset:31456
    v_mfma_f32_16x16x32_bf16 v[80:83], a[212:215], v[236:239], v[80:83]
    v_mfma_f32_16x16x32_bf16 v[60:63], a[216:219], v[236:239], v[60:63]
    buffer_load_dwordx4 a[196:199], v254, s[8:11], s42 offen offset:1024
    v_mfma_f32_16x16x32_bf16 v[64:67], a[220:223], v[236:239], v[64:67]
    v_lshlrev_b32 v252, 16, v216
    v_and_b32 v216, s22, v216
    v_mfma_f32_16x16x32_bf16 v[68:71], a[224:227], v[236:239], v[68:71]
    s_waitcnt lgkmcnt(7)
    v_add_f32 v252, v252, v251
    v_add_f32 v216, v216, v224
    v_mfma_f32_16x16x32_bf16 v[84:87], a[204:207], v[228:231], v[84:87]
    ds_read_b128 v[236:239], v253 offset:7280
    v_fmac_f32 v252, s23, v249
    v_mfma_f32_16x16x32_bf16 v[88:91], a[208:211], v[228:231], v[88:91]
    v_fmac_f32 v216, s23, v220
    v_cvt_pk_bf16_f32 v216, v252, v216
    v_mfma_f32_16x16x32_bf16 v[92:95], a[212:215], v[228:231], v[92:95]
    buffer_load_dwordx4 a[200:203], v254, s[8:11], s42 offen offset:2048
    v_mfma_f32_16x16x32_bf16 v[72:75], a[216:219], v[228:231], v[72:75]
    s_waitcnt lgkmcnt(3)
    v_lshlrev_b32 v252, 16, v226
    v_and_b32 v226, s22, v226
    v_mfma_f32_16x16x32_bf16 v[76:79], a[220:223], v[228:231], v[76:79]
    s_mov_b32 s42, 445440
    v_add_f32 v252, v252, v248
    v_add_f32 v226, v226, v218
    v_mfma_f32_16x16x32_bf16 v[80:83], a[224:227], v[228:231], v[80:83]
    ds_read_b128 v[228:231], v253 offset:7008
    v_fmac_f32 v252, s23, v250
    v_mfma_f32_16x16x32_bf16 v[84:87], a[216:219], v[232:235], v[84:87]
    buffer_load_dwordx4 a[204:207], v254, s[8:11], s42 offen offset:0
    v_mfma_f32_16x16x32_bf16 v[88:91], a[220:223], v[232:235], v[88:91]
    s_waitcnt vmcnt(16) lgkmcnt(1)
    v_fmac_f32 v226, s23, v222
    v_cvt_pk_bf16_f32 v226, v252, v226
    v_mfma_f32_16x16x32_bf16 v[92:95], a[224:227], v[232:235], v[92:95]
    ds_read_b128 v[232:235], v253 offset:6752
    v_fma_f32 v252, v249, s24, v251
    v_mfma_f32_16x16x32_bf16 v[96:99], a[228:231], v[236:239], v[96:99]
    s_waitcnt lgkmcnt(1)
    v_fmac_f32 v251, s25, v249
    v_fma_f32 v249, v248, s24, v250
    v_mfma_f32_16x16x32_bf16 v[100:103], a[232:235], v[236:239], v[100:103]
    buffer_load_dwordx4 a[208:211], v254, s[8:11], s42 offen offset:1024
    v_mfma_f32_16x16x32_bf16 v[104:107], a[236:239], v[236:239], v[104:107]
    ds_read_b128 v[236:239], v253 offset:6496
    v_fmac_f32 v250, s25, v248
    v_mfma_f32_16x16x32_bf16 v[108:111], a[228:231], v[228:231], v[108:111]
    v_fma_f32 v248, v250, s26, v251
    v_fmac_f32 v251, s27, v250
    v_mfma_f32_16x16x32_bf16 v[112:115], a[232:235], v[228:231], v[112:115]
    s_waitcnt vmcnt(14)
    v_fma_f32 v250, v249, s28, v252
    v_fmac_f32 v252, s29, v249
    v_mfma_f32_16x16x32_bf16 v[116:119], a[236:239], v[228:231], v[116:119]
    buffer_load_dwordx4 a[212:215], v254, s[8:11], s42 offen offset:2048
    v_mfma_f32_16x16x32_bf16 v[96:99], a[240:243], v[228:231], v[96:99]
    s_waitcnt lgkmcnt(1)
    v_fma_f32 v249, v220, s24, v224
    v_fmac_f32 v224, s25, v220
    v_mfma_f32_16x16x32_bf16 v[100:103], a[244:247], v[228:231], v[100:103]
    s_mov_b32 s42, 448512
    v_fma_f32 v220, v218, s24, v222
    v_fmac_f32 v222, s25, v218
    v_mfma_f32_16x16x32_bf16 v[104:107], a[248:251], v[228:231], v[104:107]
    ds_read_b128 v[228:231], v253 offset:6240
    v_fma_f32 v218, v222, s26, v224
    v_mfma_f32_16x16x32_bf16 v[120:123], a[228:231], v[232:235], v[120:123]
    buffer_load_dwordx4 a[216:219], v254, s[8:11], s42 offen offset:0
    v_mfma_f32_16x16x32_bf16 v[124:127], a[232:235], v[232:235], v[124:127]
    v_fmac_f32 v224, s27, v222
    v_fma_f32 v222, v220, s28, v249
    v_mfma_f32_16x16x32_bf16 v[128:131], a[236:239], v[232:235], v[128:131]
    v_fmac_f32 v249, s29, v220
    v_cvt_pk_bf16_f32 v218, v248, v218
    v_mfma_f32_16x16x32_bf16 v[108:111], a[240:243], v[232:235], v[108:111]
    v_cvt_pk_bf16_f32 v224, v251, v224
    v_cvt_pk_bf16_f32 v222, v250, v222
    v_mfma_f32_16x16x32_bf16 v[112:115], a[244:247], v[232:235], v[112:115]
    buffer_load_dwordx4 a[220:223], v254, s[8:11], s42 offen offset:1024
    v_mfma_f32_16x16x32_bf16 v[116:119], a[248:251], v[232:235], v[116:119]
    s_waitcnt vmcnt(14)
    v_cvt_pk_bf16_f32 v220, v252, v249
    v_lshlrev_b32 v248, 16, v219
    v_mfma_f32_16x16x32_bf16 v[96:99], a[252:255], v[232:235], v[96:99]
    s_waitcnt lgkmcnt(1)
    v_lshlrev_b32 v249, 16, v221
    v_lshlrev_b32 v250, 16, v223
    v_mfma_f32_16x16x32_bf16 v[100:103], v[240:243], v[232:235], v[100:103]
    buffer_load_dwordx4 a[224:227], v254, s[8:11], s42 offen offset:2048
    v_mfma_f32_16x16x32_bf16 v[104:107], v[244:247], v[232:235], v[104:107]
    ds_read_b128 v[232:235], v253 offset:8064
    v_and_b32 v215, 0x7fff, v255
    v_mfma_f32_16x16x32_bf16 v[132:135], a[228:231], v[236:239], v[132:135]
    v_lshlrev_b32 v251, 16, v225
    v_and_b32 v219, s22, v219
    v_mfma_f32_16x16x32_bf16 v[136:139], a[232:235], v[236:239], v[136:139]
    buffer_load_dwordx2 v[204:205], v215, s[4:7], s16 offen offset:640
    v_mfma_f32_16x16x32_bf16 v[140:143], a[236:239], v[236:239], v[140:143]
    v_and_b32 v221, s22, v221
    v_and_b32 v223, s22, v223
    v_mfma_f32_16x16x32_bf16 v[120:123], a[240:243], v[236:239], v[120:123]
    v_and_b32 v225, s22, v225
    v_lshlrev_b32 v252, 16, v217
    v_mfma_f32_16x16x32_bf16 v[124:127], a[244:247], v[236:239], v[124:127]
    buffer_load_dwordx2 v[206:207], v215, s[4:7], s17 offen offset:640
    v_mfma_f32_16x16x32_bf16 v[128:131], a[248:251], v[236:239], v[128:131]
    v_and_b32 v217, s22, v217
    v_add_f32 v252, v252, v251
    v_mfma_f32_16x16x32_bf16 v[108:111], a[252:255], v[236:239], v[108:111]
    s_waitcnt lgkmcnt(1)
    v_add_f32 v217, v217, v225
    v_fmac_f32 v252, s23, v249
    v_mfma_f32_16x16x32_bf16 v[112:115], v[240:243], v[236:239], v[112:115]
    buffer_load_dwordx2 v[208:209], v215, s[4:7], s18 offen offset:640
    v_mfma_f32_16x16x32_bf16 v[116:119], v[244:247], v[236:239], v[116:119]
    ds_read_b128 v[236:239], v253 offset:7808
    v_fmac_f32 v217, s23, v221
    v_mfma_f32_16x16x32_bf16 v[144:147], a[228:231], v[228:231], v[144:147]
    v_cvt_pk_bf16_f32 v217, v252, v217
    v_lshlrev_b32 v252, 16, v227
    v_mfma_f32_16x16x32_bf16 v[148:151], a[232:235], v[228:231], v[148:151]
    buffer_load_dwordx2 v[210:211], v215, s[4:7], s19 offen offset:640
    v_mfma_f32_16x16x32_bf16 v[152:155], a[236:239], v[228:231], v[152:155]
    v_and_b32 v227, s22, v227
    v_add_f32 v252, v252, v248
    v_mfma_f32_16x16x32_bf16 v[132:135], a[240:243], v[228:231], v[132:135]
    v_add_f32 v227, v227, v219
    v_fmac_f32 v252, s23, v250
    v_mfma_f32_16x16x32_bf16 v[136:139], a[244:247], v[228:231], v[136:139]
    buffer_load_dwordx2 v[212:213], v215, s[4:7], s20 offen offset:640
    v_mfma_f32_16x16x32_bf16 v[140:143], a[248:251], v[228:231], v[140:143]
    v_fmac_f32 v227, s23, v223
    v_cvt_pk_bf16_f32 v227, v252, v227
    v_mfma_f32_16x16x32_bf16 v[120:123], a[252:255], v[228:231], v[120:123]
    s_waitcnt lgkmcnt(1)
    v_fma_f32 v252, v249, s24, v251
    v_fmac_f32 v251, s25, v249
    v_mfma_f32_16x16x32_bf16 v[124:127], v[240:243], v[228:231], v[124:127]
    buffer_load_dwordx2 v[214:215], v215, s[4:7], s21 offen offset:640
    v_mfma_f32_16x16x32_bf16 v[128:131], v[244:247], v[228:231], v[128:131]
    ds_read_b128 v[228:231], v253 offset:7552
    v_fma_f32 v249, v248, s24, v250
    v_mfma_f32_16x16x32_bf16 v[156:159], a[228:231], v[232:235], v[156:159]
    v_fmac_f32 v250, s25, v248
    v_fma_f32 v248, v250, s26, v251
    v_mfma_f32_16x16x32_bf16 v[160:163], a[232:235], v[232:235], v[160:163]
    v_fmac_f32 v251, s27, v250
    v_fma_f32 v250, v249, s28, v252
    v_mfma_f32_16x16x32_bf16 v[164:167], a[236:239], v[232:235], v[164:167]
    v_fmac_f32 v252, s29, v249
    v_fma_f32 v249, v221, s24, v225
    v_mfma_f32_16x16x32_bf16 v[144:147], a[240:243], v[232:235], v[144:147]
    v_fmac_f32 v225, s25, v221
    v_fma_f32 v221, v219, s24, v223
    v_mfma_f32_16x16x32_bf16 v[148:151], a[244:247], v[232:235], v[148:151]
    v_fmac_f32 v223, s25, v219
    v_fma_f32 v219, v223, s26, v225
    v_mfma_f32_16x16x32_bf16 v[152:155], a[248:251], v[232:235], v[152:155]
    v_fmac_f32 v225, s27, v223
    v_fma_f32 v223, v221, s28, v249
    v_mfma_f32_16x16x32_bf16 v[132:135], a[252:255], v[232:235], v[132:135]
    v_fmac_f32 v249, s29, v221
    v_cvt_pk_bf16_f32 v219, v248, v219
    v_mfma_f32_16x16x32_bf16 v[136:139], v[240:243], v[232:235], v[136:139]
    s_waitcnt lgkmcnt(1)
    v_cvt_pk_bf16_f32 v225, v251, v225
    v_cvt_pk_bf16_f32 v223, v250, v223
    v_mfma_f32_16x16x32_bf16 v[140:143], v[244:247], v[232:235], v[140:143]
    ds_read_b128 v[232:235], v253 offset:7296
    v_cvt_pk_bf16_f32 v221, v252, v249
    v_mfma_f32_16x16x32_bf16 v[168:171], a[228:231], v[236:239], v[168:171]
    v_lshrrev_b32 v252, 15, v255
    v_mfma_f32_16x16x32_bf16 v[172:175], a[232:235], v[236:239], v[172:175]
    ds_write_b64 v252, v[218:219] offset:8320
    v_mfma_f32_16x16x32_bf16 v[176:179], a[236:239], v[236:239], v[176:179]
    s_waitcnt vmcnt(15)
    v_lshlrev_b32 v248, 16, v194
    v_lshlrev_b32 v249, 16, v196
    v_mfma_f32_16x16x32_bf16 v[156:159], a[240:243], v[236:239], v[156:159]
    ds_write_b64 v252, v[224:225] offset:10400
    v_mfma_f32_16x16x32_bf16 v[160:163], a[244:247], v[236:239], v[160:163]
    v_lshlrev_b32 v250, 16, v198
    v_lshlrev_b32 v251, 16, v200
    v_mfma_f32_16x16x32_bf16 v[164:167], a[248:251], v[236:239], v[164:167]
    ds_write_b64 v252, v[222:223] offset:12480
    v_mfma_f32_16x16x32_bf16 v[144:147], a[252:255], v[236:239], v[144:147]
    s_waitcnt lgkmcnt(4)
    v_and_b32 v194, s22, v194
    v_and_b32 v196, s22, v196
    v_mfma_f32_16x16x32_bf16 v[148:151], v[240:243], v[236:239], v[148:151]
    ds_write_b64 v252, v[216:217] offset:18720
    v_mfma_f32_16x16x32_bf16 v[152:155], v[244:247], v[236:239], v[152:155]
    ds_read_b128 v[236:239], v253 offset:7024
    v_and_b32 v198, s22, v198
    v_mfma_f32_16x16x32_bf16 v[180:183], a[228:231], v[228:231], v[180:183]
    v_and_b32 v200, s22, v200
    v_mfma_f32_16x16x32_bf16 v[184:187], a[232:235], v[228:231], v[184:187]
    ds_write_b64 v252, v[226:227] offset:27040
    v_mfma_f32_16x16x32_bf16 v[188:191], a[236:239], v[228:231], v[188:191]
    s_mov_b32 s42, 479232
    v_mfma_f32_16x16x32_bf16 v[168:171], a[240:243], v[228:231], v[168:171]
    buffer_load_dwordx4 a[228:231], v254, s[8:11], s42 offen offset:0
    v_mfma_f32_16x16x32_bf16 v[172:175], a[244:247], v[228:231], v[172:175]
    ds_write_b64 v252, v[220:221] offset:31200
    v_mfma_f32_16x16x32_bf16 v[176:179], a[248:251], v[228:231], v[176:179]
    s_waitcnt lgkmcnt(7)
    v_mfma_f32_16x16x32_bf16 v[156:159], a[252:255], v[228:231], v[156:159]
    buffer_load_dwordx4 a[232:235], v254, s[8:11], s42 offen offset:1024
    v_mfma_f32_16x16x32_bf16 v[160:163], v[240:243], v[228:231], v[160:163]
    s_waitcnt lgkmcnt(0)
    v_lshlrev_b32 v252, 16, v192
    v_and_b32 v192, s22, v192
    v_mfma_f32_16x16x32_bf16 v[164:167], v[244:247], v[228:231], v[164:167]
    s_barrier
    v_mfma_f32_16x16x32_bf16 v[180:183], a[240:243], v[232:235], v[180:183]
    ds_read_b128 v[228:231], v253 offset:9360
    v_add_f32 v252, v252, v251
    v_mfma_f32_16x16x32_bf16 v[184:187], a[244:247], v[232:235], v[184:187]
    v_add_f32 v192, v192, v200
    v_fmac_f32 v252, s23, v249
    v_mfma_f32_16x16x32_bf16 v[188:191], a[248:251], v[232:235], v[188:191]
    buffer_load_dwordx4 a[236:239], v254, s[8:11], s42 offen offset:2048
    v_mfma_f32_16x16x32_bf16 v[168:171], a[252:255], v[232:235], v[168:171]
    v_fmac_f32 v192, s23, v196
    v_cvt_pk_bf16_f32 v192, v252, v192
    v_mfma_f32_16x16x32_bf16 v[172:175], v[240:243], v[232:235], v[172:175]
    s_mov_b32 s42, 482304
    v_lshlrev_b32 v252, 16, v202
    v_and_b32 v202, s22, v202
    v_add_f32 v252, v252, v248
    v_mfma_f32_16x16x32_bf16 v[176:179], v[244:247], v[232:235], v[176:179]
    ds_read_b128 v[232:235], v253 offset:9088
    v_add_f32 v202, v202, v194
    v_mfma_f32_16x16x32_bf16 v[180:183], a[252:255], v[236:239], v[180:183]
    buffer_load_dwordx4 a[240:243], v254, s[8:11], s42 offen offset:0
    v_mfma_f32_16x16x32_bf16 v[184:187], v[240:243], v[236:239], v[184:187]
    s_waitcnt vmcnt(16) lgkmcnt(1)
    v_fmac_f32 v252, s23, v250
    v_fmac_f32 v202, s23, v198
    v_mfma_f32_16x16x32_bf16 v[188:191], v[244:247], v[236:239], v[188:191]
    ds_read_b128 v[236:239], v253 offset:8832
    v_cvt_pk_bf16_f32 v202, v252, v202
    v_mfma_f32_16x16x32_bf16 a[0:3], a[192:195], v[228:231], a[0:3]
    s_waitcnt lgkmcnt(1)
    v_fma_f32 v252, v249, s24, v251
    v_fmac_f32 v251, s25, v249
    v_mfma_f32_16x16x32_bf16 a[4:7], a[196:199], v[228:231], a[4:7]
    buffer_load_dwordx4 a[244:247], v254, s[8:11], s42 offen offset:1024
    v_mfma_f32_16x16x32_bf16 a[8:11], a[200:203], v[228:231], a[8:11]
    ds_read_b128 v[228:231], v253 offset:8576
    v_fma_f32 v249, v248, s24, v250
    v_mfma_f32_16x16x32_bf16 a[12:15], a[192:195], v[232:235], a[12:15]
    v_fmac_f32 v250, s25, v248
    v_fma_f32 v248, v250, s26, v251
    v_mfma_f32_16x16x32_bf16 a[16:19], a[196:199], v[232:235], a[16:19]
    s_waitcnt vmcnt(14)
    v_fmac_f32 v251, s27, v250
    v_fma_f32 v250, v249, s28, v252
    v_mfma_f32_16x16x32_bf16 a[20:23], a[200:203], v[232:235], a[20:23]
    buffer_load_dwordx4 a[248:251], v254, s[8:11], s42 offen offset:2048
    v_mfma_f32_16x16x32_bf16 a[0:3], a[204:207], v[232:235], a[0:3]
    s_waitcnt lgkmcnt(1)
    v_fmac_f32 v252, s29, v249
    v_fma_f32 v249, v196, s24, v200
    v_mfma_f32_16x16x32_bf16 a[4:7], a[208:211], v[232:235], a[4:7]
    s_mov_b32 s42, 485376
    v_fmac_f32 v200, s25, v196
    v_fma_f32 v196, v194, s24, v198
    v_mfma_f32_16x16x32_bf16 a[8:11], a[212:215], v[232:235], a[8:11]
    ds_read_b128 v[232:235], v253 offset:8320
    v_fmac_f32 v198, s25, v194
    v_mfma_f32_16x16x32_bf16 a[24:27], a[192:195], v[236:239], a[24:27]
    buffer_load_dwordx4 a[252:255], v254, s[8:11], s42 offen offset:0
    v_mfma_f32_16x16x32_bf16 a[28:31], a[196:199], v[236:239], a[28:31]
    v_fma_f32 v194, v198, s26, v200
    v_fmac_f32 v200, s27, v198
    v_mfma_f32_16x16x32_bf16 a[32:35], a[200:203], v[236:239], a[32:35]
    v_fma_f32 v198, v196, s28, v249
    v_fmac_f32 v249, s29, v196
    v_mfma_f32_16x16x32_bf16 a[12:15], a[204:207], v[236:239], a[12:15]
    v_cvt_pk_bf16_f32 v194, v248, v194
    v_cvt_pk_bf16_f32 v200, v251, v200
    v_mfma_f32_16x16x32_bf16 a[16:19], a[208:211], v[236:239], a[16:19]
    buffer_load_dwordx4 v[240:243], v254, s[8:11], s42 offen offset:1024
    v_mfma_f32_16x16x32_bf16 a[20:23], a[212:215], v[236:239], a[20:23]
    s_waitcnt vmcnt(14)
    v_cvt_pk_bf16_f32 v198, v250, v198
    v_cvt_pk_bf16_f32 v196, v252, v249
    v_mfma_f32_16x16x32_bf16 a[0:3], a[216:219], v[236:239], a[0:3]
    s_waitcnt lgkmcnt(1)
    v_lshlrev_b32 v248, 16, v195
    v_lshlrev_b32 v249, 16, v197
    v_lshlrev_b32 v250, 16, v199
    v_mfma_f32_16x16x32_bf16 a[4:7], a[220:223], v[236:239], a[4:7]
    buffer_load_dwordx4 v[244:247], v254, s[8:11], s42 offen offset:2048
    v_mfma_f32_16x16x32_bf16 a[8:11], a[224:227], v[236:239], a[8:11]
    ds_read_b128 v[236:239], v253 offset:10144
    v_and_b32 v227, 0x7fff, v255
    v_mfma_f32_16x16x32_bf16 a[36:39], a[192:195], v[228:231], a[36:39]
    v_lshlrev_b32 v251, 16, v201
    v_and_b32 v195, s22, v195
    v_mfma_f32_16x16x32_bf16 a[40:43], a[196:199], v[228:231], a[40:43]
    buffer_load_dwordx2 v[216:217], v227, s[4:7], s16 offen offset:1024
    v_mfma_f32_16x16x32_bf16 a[44:47], a[200:203], v[228:231], a[44:47]
    v_and_b32 v197, s22, v197
    v_and_b32 v199, s22, v199
    v_mfma_f32_16x16x32_bf16 a[24:27], a[204:207], v[228:231], a[24:27]
    v_and_b32 v201, s22, v201
    v_lshlrev_b32 v252, 16, v193
    v_mfma_f32_16x16x32_bf16 a[28:31], a[208:211], v[228:231], a[28:31]
    buffer_load_dwordx2 v[218:219], v227, s[4:7], s17 offen offset:1024
    v_mfma_f32_16x16x32_bf16 a[32:35], a[212:215], v[228:231], a[32:35]
    v_and_b32 v193, s22, v193
    v_add_f32 v252, v252, v251
    v_mfma_f32_16x16x32_bf16 a[12:15], a[216:219], v[228:231], a[12:15]
    s_waitcnt lgkmcnt(1)
    v_add_f32 v193, v193, v201
    v_fmac_f32 v252, s23, v249
    v_mfma_f32_16x16x32_bf16 a[16:19], a[220:223], v[228:231], a[16:19]
    buffer_load_dwordx2 v[220:221], v227, s[4:7], s18 offen offset:1024
    v_mfma_f32_16x16x32_bf16 a[20:23], a[224:227], v[228:231], a[20:23]
    ds_read_b128 v[228:231], v253 offset:9888
    v_fmac_f32 v193, s23, v197
    v_mfma_f32_16x16x32_bf16 a[48:51], a[192:195], v[232:235], a[48:51]
    v_cvt_pk_bf16_f32 v193, v252, v193
    v_lshlrev_b32 v252, 16, v203
    v_mfma_f32_16x16x32_bf16 a[52:55], a[196:199], v[232:235], a[52:55]
    buffer_load_dwordx2 v[222:223], v227, s[4:7], s19 offen offset:1024
    v_mfma_f32_16x16x32_bf16 a[56:59], a[200:203], v[232:235], a[56:59]
    v_and_b32 v203, s22, v203
    v_add_f32 v252, v252, v248
    v_mfma_f32_16x16x32_bf16 a[36:39], a[204:207], v[232:235], a[36:39]
    v_add_f32 v203, v203, v195
    v_fmac_f32 v252, s23, v250
    v_mfma_f32_16x16x32_bf16 a[40:43], a[208:211], v[232:235], a[40:43]
    buffer_load_dwordx2 v[224:225], v227, s[4:7], s20 offen offset:1024
    v_mfma_f32_16x16x32_bf16 a[44:47], a[212:215], v[232:235], a[44:47]
    v_fmac_f32 v203, s23, v199
    v_cvt_pk_bf16_f32 v203, v252, v203
    v_mfma_f32_16x16x32_bf16 a[24:27], a[216:219], v[232:235], a[24:27]
    s_waitcnt lgkmcnt(1)
    v_fma_f32 v252, v249, s24, v251
    v_fmac_f32 v251, s25, v249
    v_mfma_f32_16x16x32_bf16 a[28:31], a[220:223], v[232:235], a[28:31]
    buffer_load_dwordx2 v[226:227], v227, s[4:7], s21 offen offset:1024
    v_mfma_f32_16x16x32_bf16 a[32:35], a[224:227], v[232:235], a[32:35]
    ds_read_b128 v[232:235], v253 offset:9632
    v_fma_f32 v249, v248, s24, v250
    v_fmac_f32 v250, s25, v248
    v_mfma_f32_16x16x32_bf16 a[60:63], a[192:195], v[236:239], a[60:63]
    v_fma_f32 v248, v250, s26, v251
    v_fmac_f32 v251, s27, v250
    v_mfma_f32_16x16x32_bf16 a[64:67], a[196:199], v[236:239], a[64:67]
    v_fma_f32 v250, v249, s28, v252
    v_fmac_f32 v252, s29, v249
    v_mfma_f32_16x16x32_bf16 a[68:71], a[200:203], v[236:239], a[68:71]
    v_fma_f32 v249, v197, s24, v201
    v_fmac_f32 v201, s25, v197
    v_mfma_f32_16x16x32_bf16 a[48:51], a[204:207], v[236:239], a[48:51]
    v_fma_f32 v197, v195, s24, v199
    v_fmac_f32 v199, s25, v195
    v_mfma_f32_16x16x32_bf16 a[52:55], a[208:211], v[236:239], a[52:55]
    v_fma_f32 v195, v199, s26, v201
    v_fmac_f32 v201, s27, v199
    v_mfma_f32_16x16x32_bf16 a[56:59], a[212:215], v[236:239], a[56:59]
    v_fma_f32 v199, v197, s28, v249
    v_fmac_f32 v249, s29, v197
    v_mfma_f32_16x16x32_bf16 a[36:39], a[216:219], v[236:239], a[36:39]
    v_cvt_pk_bf16_f32 v195, v248, v195
    v_cvt_pk_bf16_f32 v201, v251, v201
    v_mfma_f32_16x16x32_bf16 a[40:43], a[220:223], v[236:239], a[40:43]
    s_waitcnt lgkmcnt(1)
    v_cvt_pk_bf16_f32 v199, v250, v199
    v_cvt_pk_bf16_f32 v197, v252, v249
    v_mfma_f32_16x16x32_bf16 a[44:47], a[224:227], v[236:239], a[44:47]
    ds_read_b128 v[236:239], v253 offset:9376
    v_lshrrev_b32 v252, 15, v255
    v_mfma_f32_16x16x32_bf16 a[72:75], a[192:195], v[228:231], a[72:75]
    ds_write_b64 v252, v[194:195] offset:768
    v_mfma_f32_16x16x32_bf16 a[76:79], a[196:199], v[228:231], a[76:79]
    s_waitcnt vmcnt(15)
    v_lshlrev_b32 v248, 16, v206
    v_lshlrev_b32 v249, 16, v208
    v_mfma_f32_16x16x32_bf16 a[80:83], a[200:203], v[228:231], a[80:83]
    ds_write_b64 v252, v[200:201] offset:2848
    v_mfma_f32_16x16x32_bf16 a[60:63], a[204:207], v[228:231], a[60:63]
    v_lshlrev_b32 v250, 16, v210
    v_lshlrev_b32 v251, 16, v212
    v_mfma_f32_16x16x32_bf16 a[64:67], a[208:211], v[228:231], a[64:67]
    ds_write_b64 v252, v[198:199] offset:4928
    v_mfma_f32_16x16x32_bf16 a[68:71], a[212:215], v[228:231], a[68:71]
    v_and_b32 v206, s22, v206
    v_and_b32 v208, s22, v208
    v_mfma_f32_16x16x32_bf16 a[48:51], a[216:219], v[228:231], a[48:51]
    ds_write_b64 v252, v[192:193] offset:21568
    v_mfma_f32_16x16x32_bf16 a[52:55], a[220:223], v[228:231], a[52:55]
    s_waitcnt lgkmcnt(5)
    v_and_b32 v210, s22, v210
    v_and_b32 v212, s22, v212
    v_mfma_f32_16x16x32_bf16 a[56:59], a[224:227], v[228:231], a[56:59]
    ds_read_b128 v[228:231], v253 offset:9104
    v_mfma_f32_16x16x32_bf16 a[84:87], a[192:195], v[232:235], a[84:87]
    ds_write_b64 v252, v[202:203] offset:29888
    v_mfma_f32_16x16x32_bf16 a[88:91], a[196:199], v[232:235], a[88:91]
    v_mfma_f32_16x16x32_bf16 a[92:95], a[200:203], v[232:235], a[92:95]
    s_mov_b32 s42, 516096
    v_mfma_f32_16x16x32_bf16 a[72:75], a[204:207], v[232:235], a[72:75]
    buffer_load_dwordx4 a[192:195], v254, s[8:11], s42 offen offset:0
    v_mfma_f32_16x16x32_bf16 a[76:79], a[208:211], v[232:235], a[76:79]
    ds_write_b64 v252, v[196:197] offset:7008
    v_mfma_f32_16x16x32_bf16 a[80:83], a[212:215], v[232:235], a[80:83]
    v_mfma_f32_16x16x32_bf16 a[60:63], a[216:219], v[232:235], a[60:63]
    buffer_load_dwordx4 a[196:199], v254, s[8:11], s42 offen offset:1024
    v_mfma_f32_16x16x32_bf16 a[64:67], a[220:223], v[232:235], a[64:67]
    v_lshlrev_b32 v252, 16, v204
    v_and_b32 v204, s22, v204
    v_mfma_f32_16x16x32_bf16 a[68:71], a[224:227], v[232:235], a[68:71]
    s_waitcnt lgkmcnt(7)
    v_add_f32 v252, v252, v251
    v_add_f32 v204, v204, v212
    v_mfma_f32_16x16x32_bf16 a[84:87], a[204:207], v[236:239], a[84:87]
    ds_read_b128 v[232:235], v253 offset:11440
    v_fmac_f32 v252, s23, v249
    v_mfma_f32_16x16x32_bf16 a[88:91], a[208:211], v[236:239], a[88:91]
    v_fmac_f32 v204, s23, v208
    v_cvt_pk_bf16_f32 v204, v252, v204
    v_mfma_f32_16x16x32_bf16 a[92:95], a[212:215], v[236:239], a[92:95]
    buffer_load_dwordx4 a[200:203], v254, s[8:11], s42 offen offset:2048
    v_mfma_f32_16x16x32_bf16 a[72:75], a[216:219], v[236:239], a[72:75]
    s_waitcnt lgkmcnt(3)
    v_lshlrev_b32 v252, 16, v214
    v_and_b32 v214, s22, v214
    v_mfma_f32_16x16x32_bf16 a[76:79], a[220:223], v[236:239], a[76:79]
    s_mov_b32 s42, 519168
    v_add_f32 v252, v252, v248
    v_add_f32 v214, v214, v206
    v_mfma_f32_16x16x32_bf16 a[80:83], a[224:227], v[236:239], a[80:83]
    ds_read_b128 v[236:239], v253 offset:11168
    v_fmac_f32 v252, s23, v250
    v_mfma_f32_16x16x32_bf16 a[84:87], a[216:219], v[228:231], a[84:87]
    buffer_load_dwordx4 a[204:207], v254, s[8:11], s42 offen offset:0
    v_mfma_f32_16x16x32_bf16 a[88:91], a[220:223], v[228:231], a[88:91]
    s_waitcnt vmcnt(16) lgkmcnt(1)
    v_fmac_f32 v214, s23, v210
    v_cvt_pk_bf16_f32 v214, v252, v214
    v_mfma_f32_16x16x32_bf16 a[92:95], a[224:227], v[228:231], a[92:95]
    ds_read_b128 v[228:231], v253 offset:10912
    v_fma_f32 v252, v249, s24, v251
    v_mfma_f32_16x16x32_bf16 a[96:99], a[228:231], v[232:235], a[96:99]
    s_waitcnt lgkmcnt(1)
    v_fmac_f32 v251, s25, v249
    v_fma_f32 v249, v248, s24, v250
    v_mfma_f32_16x16x32_bf16 a[100:103], a[232:235], v[232:235], a[100:103]
    buffer_load_dwordx4 a[208:211], v254, s[8:11], s42 offen offset:1024
    v_mfma_f32_16x16x32_bf16 a[104:107], a[236:239], v[232:235], a[104:107]
    ds_read_b128 v[232:235], v253 offset:10656
    v_fmac_f32 v250, s25, v248
    v_mfma_f32_16x16x32_bf16 a[108:111], a[228:231], v[236:239], a[108:111]
    v_fma_f32 v248, v250, s26, v251
    v_fmac_f32 v251, s27, v250
    v_mfma_f32_16x16x32_bf16 a[112:115], a[232:235], v[236:239], a[112:115]
    s_waitcnt vmcnt(14)
    v_fma_f32 v250, v249, s28, v252
    v_fmac_f32 v252, s29, v249
    v_mfma_f32_16x16x32_bf16 a[116:119], a[236:239], v[236:239], a[116:119]
    buffer_load_dwordx4 a[212:215], v254, s[8:11], s42 offen offset:2048
    v_mfma_f32_16x16x32_bf16 a[96:99], a[240:243], v[236:239], a[96:99]
    s_waitcnt lgkmcnt(1)
    v_fma_f32 v249, v208, s24, v212
    v_fmac_f32 v212, s25, v208
    v_mfma_f32_16x16x32_bf16 a[100:103], a[244:247], v[236:239], a[100:103]
    s_mov_b32 s42, 522240
    v_fma_f32 v208, v206, s24, v210
    v_fmac_f32 v210, s25, v206
    v_mfma_f32_16x16x32_bf16 a[104:107], a[248:251], v[236:239], a[104:107]
    ds_read_b128 v[236:239], v253 offset:10400
    v_fma_f32 v206, v210, s26, v212
    v_mfma_f32_16x16x32_bf16 a[120:123], a[228:231], v[228:231], a[120:123]
    buffer_load_dwordx4 a[216:219], v254, s[8:11], s42 offen offset:0
    v_mfma_f32_16x16x32_bf16 a[124:127], a[232:235], v[228:231], a[124:127]
    v_fmac_f32 v212, s27, v210
    v_fma_f32 v210, v208, s28, v249
    v_mfma_f32_16x16x32_bf16 a[128:131], a[236:239], v[228:231], a[128:131]
    v_fmac_f32 v249, s29, v208
    v_cvt_pk_bf16_f32 v206, v248, v206
    v_mfma_f32_16x16x32_bf16 a[108:111], a[240:243], v[228:231], a[108:111]
    v_cvt_pk_bf16_f32 v212, v251, v212
    v_cvt_pk_bf16_f32 v210, v250, v210
    v_mfma_f32_16x16x32_bf16 a[112:115], a[244:247], v[228:231], a[112:115]
    buffer_load_dwordx4 a[220:223], v254, s[8:11], s42 offen offset:1024
    v_mfma_f32_16x16x32_bf16 a[116:119], a[248:251], v[228:231], a[116:119]
    s_waitcnt vmcnt(14)
    v_cvt_pk_bf16_f32 v208, v252, v249
    v_lshlrev_b32 v248, 16, v207
    v_mfma_f32_16x16x32_bf16 a[96:99], a[252:255], v[228:231], a[96:99]
    s_waitcnt lgkmcnt(1)
    v_lshlrev_b32 v249, 16, v209
    v_lshlrev_b32 v250, 16, v211
    v_mfma_f32_16x16x32_bf16 a[100:103], v[240:243], v[228:231], a[100:103]
    buffer_load_dwordx4 a[224:227], v254, s[8:11], s42 offen offset:2048
    v_mfma_f32_16x16x32_bf16 a[104:107], v[244:247], v[228:231], a[104:107]
    ds_read_b128 v[228:231], v253 offset:12224
    v_and_b32 v203, 0x7fff, v255
    v_mfma_f32_16x16x32_bf16 a[132:135], a[228:231], v[232:235], a[132:135]
    v_lshlrev_b32 v251, 16, v213
    v_and_b32 v207, s22, v207
    v_mfma_f32_16x16x32_bf16 a[136:139], a[232:235], v[232:235], a[136:139]
    buffer_load_dwordx2 v[192:193], v203, s[4:7], s16 offen offset:1408
    v_mfma_f32_16x16x32_bf16 a[140:143], a[236:239], v[232:235], a[140:143]
    v_and_b32 v209, s22, v209
    v_and_b32 v211, s22, v211
    v_mfma_f32_16x16x32_bf16 a[120:123], a[240:243], v[232:235], a[120:123]
    v_and_b32 v213, s22, v213
    v_lshlrev_b32 v252, 16, v205
    v_mfma_f32_16x16x32_bf16 a[124:127], a[244:247], v[232:235], a[124:127]
    buffer_load_dwordx2 v[194:195], v203, s[4:7], s17 offen offset:1408
    v_mfma_f32_16x16x32_bf16 a[128:131], a[248:251], v[232:235], a[128:131]
    v_and_b32 v205, s22, v205
    v_add_f32 v252, v252, v251
    v_mfma_f32_16x16x32_bf16 a[108:111], a[252:255], v[232:235], a[108:111]
    s_waitcnt lgkmcnt(1)
    v_add_f32 v205, v205, v213
    v_fmac_f32 v252, s23, v249
    v_mfma_f32_16x16x32_bf16 a[112:115], v[240:243], v[232:235], a[112:115]
    buffer_load_dwordx2 v[196:197], v203, s[4:7], s18 offen offset:1408
    v_mfma_f32_16x16x32_bf16 a[116:119], v[244:247], v[232:235], a[116:119]
    ds_read_b128 v[232:235], v253 offset:11968
    v_fmac_f32 v205, s23, v209
    v_mfma_f32_16x16x32_bf16 a[144:147], a[228:231], v[236:239], a[144:147]
    v_cvt_pk_bf16_f32 v205, v252, v205
    v_lshlrev_b32 v252, 16, v215
    v_mfma_f32_16x16x32_bf16 a[148:151], a[232:235], v[236:239], a[148:151]
    buffer_load_dwordx2 v[198:199], v203, s[4:7], s19 offen offset:1408
    v_mfma_f32_16x16x32_bf16 a[152:155], a[236:239], v[236:239], a[152:155]
    v_and_b32 v215, s22, v215
    v_add_f32 v252, v252, v248
    v_mfma_f32_16x16x32_bf16 a[132:135], a[240:243], v[236:239], a[132:135]
    v_add_f32 v215, v215, v207
    v_fmac_f32 v252, s23, v250
    v_mfma_f32_16x16x32_bf16 a[136:139], a[244:247], v[236:239], a[136:139]
    buffer_load_dwordx2 v[200:201], v203, s[4:7], s20 offen offset:1408
    v_mfma_f32_16x16x32_bf16 a[140:143], a[248:251], v[236:239], a[140:143]
    v_fmac_f32 v215, s23, v211
    v_cvt_pk_bf16_f32 v215, v252, v215
    v_mfma_f32_16x16x32_bf16 a[120:123], a[252:255], v[236:239], a[120:123]
    s_waitcnt lgkmcnt(1)
    v_fma_f32 v252, v249, s24, v251
    v_fmac_f32 v251, s25, v249
    v_mfma_f32_16x16x32_bf16 a[124:127], v[240:243], v[236:239], a[124:127]
    buffer_load_dwordx2 v[202:203], v203, s[4:7], s21 offen offset:1408
    v_mfma_f32_16x16x32_bf16 a[128:131], v[244:247], v[236:239], a[128:131]
    ds_read_b128 v[236:239], v253 offset:11712
    v_fma_f32 v249, v248, s24, v250
    v_mfma_f32_16x16x32_bf16 a[156:159], a[228:231], v[228:231], a[156:159]
    v_fmac_f32 v250, s25, v248
    v_fma_f32 v248, v250, s26, v251
    v_mfma_f32_16x16x32_bf16 a[160:163], a[232:235], v[228:231], a[160:163]
    v_fmac_f32 v251, s27, v250
    v_fma_f32 v250, v249, s28, v252
    v_mfma_f32_16x16x32_bf16 a[164:167], a[236:239], v[228:231], a[164:167]
    v_fmac_f32 v252, s29, v249
    v_fma_f32 v249, v209, s24, v213
    v_mfma_f32_16x16x32_bf16 a[144:147], a[240:243], v[228:231], a[144:147]
    v_fmac_f32 v213, s25, v209
    v_fma_f32 v209, v207, s24, v211
    v_mfma_f32_16x16x32_bf16 a[148:151], a[244:247], v[228:231], a[148:151]
    v_fmac_f32 v211, s25, v207
    v_fma_f32 v207, v211, s26, v213
    v_mfma_f32_16x16x32_bf16 a[152:155], a[248:251], v[228:231], a[152:155]
    v_fmac_f32 v213, s27, v211
    v_fma_f32 v211, v209, s28, v249
    v_mfma_f32_16x16x32_bf16 a[132:135], a[252:255], v[228:231], a[132:135]
    v_fmac_f32 v249, s29, v209
    v_cvt_pk_bf16_f32 v207, v248, v207
    v_mfma_f32_16x16x32_bf16 a[136:139], v[240:243], v[228:231], a[136:139]
    s_waitcnt lgkmcnt(1)
    v_cvt_pk_bf16_f32 v213, v251, v213
    v_cvt_pk_bf16_f32 v211, v250, v211
    v_mfma_f32_16x16x32_bf16 a[140:143], v[244:247], v[228:231], a[140:143]
    ds_read_b128 v[228:231], v253 offset:11456
    v_cvt_pk_bf16_f32 v209, v252, v249
    v_mfma_f32_16x16x32_bf16 a[168:171], a[228:231], v[232:235], a[168:171]
    v_lshrrev_b32 v252, 15, v255
    v_mfma_f32_16x16x32_bf16 a[172:175], a[232:235], v[232:235], a[172:175]
    ds_write_b64 v252, v[206:207] offset:512
    v_mfma_f32_16x16x32_bf16 a[176:179], a[236:239], v[232:235], a[176:179]
    s_waitcnt vmcnt(15)
    v_lshlrev_b32 v248, 16, v218
    v_lshlrev_b32 v249, 16, v220
    v_mfma_f32_16x16x32_bf16 a[156:159], a[240:243], v[232:235], a[156:159]
    ds_write_b64 v252, v[212:213] offset:2592
    v_mfma_f32_16x16x32_bf16 a[160:163], a[244:247], v[232:235], a[160:163]
    v_lshlrev_b32 v250, 16, v222
    v_lshlrev_b32 v251, 16, v224
    v_mfma_f32_16x16x32_bf16 a[164:167], a[248:251], v[232:235], a[164:167]
    ds_write_b64 v252, v[210:211] offset:4672
    v_mfma_f32_16x16x32_bf16 a[144:147], a[252:255], v[232:235], a[144:147]
    s_waitcnt lgkmcnt(4)
    v_and_b32 v218, s22, v218
    v_and_b32 v220, s22, v220
    v_mfma_f32_16x16x32_bf16 a[148:151], v[240:243], v[232:235], a[148:151]
    ds_write_b64 v252, v[204:205] offset:21312
    v_mfma_f32_16x16x32_bf16 a[152:155], v[244:247], v[232:235], a[152:155]
    ds_read_b128 v[232:235], v253 offset:11184
    v_and_b32 v222, s22, v222
    v_mfma_f32_16x16x32_bf16 a[180:183], a[228:231], v[236:239], a[180:183]
    v_and_b32 v224, s22, v224
    v_mfma_f32_16x16x32_bf16 a[184:187], a[232:235], v[236:239], a[184:187]
    ds_write_b64 v252, v[214:215] offset:29632
    v_mfma_f32_16x16x32_bf16 a[188:191], a[236:239], v[236:239], a[188:191]
    s_mov_b32 s42, 552960
    v_mfma_f32_16x16x32_bf16 a[168:171], a[240:243], v[236:239], a[168:171]
    buffer_load_dwordx4 a[228:231], v254, s[8:11], s42 offen offset:0
    v_mfma_f32_16x16x32_bf16 a[172:175], a[244:247], v[236:239], a[172:175]
    ds_write_b64 v252, v[208:209] offset:6752
    v_mfma_f32_16x16x32_bf16 a[176:179], a[248:251], v[236:239], a[176:179]
    v_mfma_f32_16x16x32_bf16 a[156:159], a[252:255], v[236:239], a[156:159]
    buffer_load_dwordx4 a[232:235], v254, s[8:11], s42 offen offset:1024
    v_mfma_f32_16x16x32_bf16 a[160:163], v[240:243], v[236:239], a[160:163]
    v_lshlrev_b32 v252, 16, v216
    v_and_b32 v216, s22, v216
    v_mfma_f32_16x16x32_bf16 a[164:167], v[244:247], v[236:239], a[164:167]
    s_waitcnt lgkmcnt(2)
    v_add_f32 v252, v252, v251
    v_add_f32 v216, v216, v224
    v_mfma_f32_16x16x32_bf16 a[180:183], a[240:243], v[228:231], a[180:183]
    ds_read_b128 v[236:239], v253 offset:13520
    v_fmac_f32 v252, s23, v249
    v_fmac_f32 v216, s23, v220
    v_mfma_f32_16x16x32_bf16 a[184:187], a[244:247], v[228:231], a[184:187]
    ds_read_b128 v[204:207], v253 offset:40288
    v_cvt_pk_bf16_f32 v216, v252, v216
    v_mfma_f32_16x16x32_bf16 a[188:191], a[248:251], v[228:231], a[188:191]
    buffer_load_dwordx4 a[236:239], v254, s[8:11], s42 offen offset:2048
    v_mfma_f32_16x16x32_bf16 a[168:171], a[252:255], v[228:231], a[168:171]
    s_mov_b32 s45, 472974346
    v_lshlrev_b32 v252, 16, v226
    v_and_b32 v226, s22, v226
    v_mfma_f32_16x16x32_bf16 a[172:175], v[240:243], v[228:231], a[172:175]
    s_mov_b32 s42, 556032
    v_add_f32 v252, v252, v248
    v_add_f32 v226, v226, v218
    v_mfma_f32_16x16x32_bf16 a[176:179], v[244:247], v[228:231], a[176:179]
    ds_read_b128 v[228:231], v253 offset:13248
    v_bfe_u32 v208, v254, 5, 3
    v_mfma_f32_16x16x32_bf16 a[180:183], a[252:255], v[232:235], a[180:183]
    buffer_load_dwordx4 a[240:243], v254, s[8:11], s42 offen offset:0
    v_mfma_f32_16x16x32_bf16 a[184:187], v[240:243], v[232:235], a[184:187]
    s_waitcnt vmcnt(16) lgkmcnt(2)
    v_fmac_f32 v252, s23, v250
    v_fmac_f32 v226, s23, v222
    v_cvt_pk_bf16_f32 v226, v252, v226
    v_mfma_f32_16x16x32_bf16 a[188:191], v[244:247], v[232:235], a[188:191]
    ds_read_b128 v[232:235], v253 offset:12992
    v_mul_u32_u24 v209, 5, v208
    v_mfma_f32_16x16x32_bf16 v[0:3], a[192:195], v[236:239], v[0:3]
    s_waitcnt lgkmcnt(1)
    v_fma_f32 v252, v249, s24, v251
    v_fmac_f32 v251, s25, v249
    v_mfma_f32_16x16x32_bf16 v[4:7], a[196:199], v[236:239], v[4:7]
    buffer_load_dwordx4 a[244:247], v254, s[8:11], s42 offen offset:1024
    v_mfma_f32_16x16x32_bf16 v[8:11], a[200:203], v[236:239], v[8:11]
    ds_read_b128 v[236:239], v253 offset:12736
    v_bfe_u32 v209, s45, v209, 5
    v_mfma_f32_16x16x32_bf16 v[12:15], a[192:195], v[228:231], v[12:15]
    v_fma_f32 v249, v248, s24, v250
    v_fmac_f32 v250, s25, v248
    v_mfma_f32_16x16x32_bf16 v[16:19], a[196:199], v[228:231], v[16:19]
    s_waitcnt vmcnt(14)
    v_mul_u32_u24 v209, 65, v209
    v_fma_f32 v248, v250, s26, v251
    v_mfma_f32_16x16x32_bf16 v[20:23], a[200:203], v[228:231], v[20:23]
    buffer_load_dwordx4 a[248:251], v254, s[8:11], s42 offen offset:2048
    v_fmac_f32 v251, s27, v250
    v_mfma_f32_16x16x32_bf16 v[0:3], a[204:207], v[228:231], v[0:3]
    s_waitcnt lgkmcnt(1)
    v_sub_u32 v209, v209, v208
    v_fma_f32 v250, v249, s28, v252
    v_mfma_f32_16x16x32_bf16 v[4:7], a[208:211], v[228:231], v[4:7]
    s_mov_b32 s42, 559104
    v_fmac_f32 v252, s29, v249
    v_fma_f32 v249, v220, s24, v224
    v_mfma_f32_16x16x32_bf16 v[8:11], a[212:215], v[228:231], v[8:11]
    ds_read_b128 v[228:231], v253 offset:12480
    v_lshl_add_u32 v208, v209, 5, v253
    v_mfma_f32_16x16x32_bf16 v[24:27], a[192:195], v[232:235], v[24:27]
    buffer_load_dwordx4 a[252:255], v254, s[8:11], s42 offen offset:0
    v_mfma_f32_16x16x32_bf16 v[28:31], a[196:199], v[232:235], v[28:31]
    v_fmac_f32 v224, s25, v220
    v_fma_f32 v220, v218, s24, v222
    v_mfma_f32_16x16x32_bf16 v[32:35], a[200:203], v[232:235], v[32:35]
    v_fmac_f32 v222, s25, v218
    v_fma_f32 v218, v222, s26, v224
    v_fmac_f32 v224, s27, v222
    v_mfma_f32_16x16x32_bf16 v[12:15], a[204:207], v[232:235], v[12:15]
    s_waitcnt vmcnt(13)
    v_fma_f32 v222, v220, s28, v249
    v_fmac_f32 v249, s29, v220
    v_mfma_f32_16x16x32_bf16 v[16:19], a[208:211], v[232:235], v[16:19]
    buffer_load_dwordx4 v[240:243], v254, s[8:11], s42 offen offset:1024
    v_mfma_f32_16x16x32_bf16 v[20:23], a[212:215], v[232:235], v[20:23]
    s_mov_b64 exec, s[46:47]
    ds_write_b128 v208, v[204:207] offset:1024
    s_mov_b64 exec, -1
    v_mfma_f32_16x16x32_bf16 v[0:3], a[216:219], v[232:235], v[0:3]
    s_waitcnt lgkmcnt(2)
    v_cvt_pk_bf16_f32 v218, v248, v218
    v_cvt_pk_bf16_f32 v224, v251, v224
    v_mfma_f32_16x16x32_bf16 v[4:7], a[220:223], v[232:235], v[4:7]
    buffer_load_dwordx4 v[244:247], v254, s[8:11], s42 offen offset:2048
    v_mfma_f32_16x16x32_bf16 v[8:11], a[224:227], v[232:235], v[8:11]
    ds_read_b128 v[232:235], v253 offset:14304
    v_and_b32 v215, 0x7fff, v255
    v_mfma_f32_16x16x32_bf16 v[36:39], a[192:195], v[236:239], v[36:39]
    v_cvt_pk_bf16_f32 v222, v250, v222
    v_cvt_pk_bf16_f32 v220, v252, v249
    v_lshlrev_b32 v248, 16, v219
    v_mfma_f32_16x16x32_bf16 v[40:43], a[196:199], v[236:239], v[40:43]
    buffer_load_dwordx2 v[204:205], v215, s[4:7], s16 offen offset:320
    v_mfma_f32_16x16x32_bf16 v[44:47], a[200:203], v[236:239], v[44:47]
    v_lshlrev_b32 v249, 16, v221
    v_lshlrev_b32 v250, 16, v223
    v_mfma_f32_16x16x32_bf16 v[24:27], a[204:207], v[236:239], v[24:27]
    v_lshlrev_b32 v251, 16, v225
    v_and_b32 v219, s22, v219
    v_mfma_f32_16x16x32_bf16 v[28:31], a[208:211], v[236:239], v[28:31]
    buffer_load_dwordx2 v[206:207], v215, s[4:7], s17 offen offset:320
    v_mfma_f32_16x16x32_bf16 v[32:35], a[212:215], v[236:239], v[32:35]
    v_and_b32 v221, s22, v221
    v_and_b32 v223, s22, v223
    v_mfma_f32_16x16x32_bf16 v[12:15], a[216:219], v[236:239], v[12:15]
    s_waitcnt lgkmcnt(2)
    v_and_b32 v225, s22, v225
    v_lshlrev_b32 v252, 16, v217
    v_mfma_f32_16x16x32_bf16 v[16:19], a[220:223], v[236:239], v[16:19]
    buffer_load_dwordx2 v[208:209], v215, s[4:7], s18 offen offset:320
    v_and_b32 v217, s22, v217
    v_mfma_f32_16x16x32_bf16 v[20:23], a[224:227], v[236:239], v[20:23]
    ds_read_b128 v[236:239], v253 offset:14048
    v_add_f32 v252, v252, v251
    v_mfma_f32_16x16x32_bf16 v[48:51], a[192:195], v[228:231], v[48:51]
    v_add_f32 v217, v217, v225
    v_fmac_f32 v252, s23, v249
    v_mfma_f32_16x16x32_bf16 v[52:55], a[196:199], v[228:231], v[52:55]
    buffer_load_dwordx2 v[210:211], v215, s[4:7], s19 offen offset:320
    v_mfma_f32_16x16x32_bf16 v[56:59], a[200:203], v[228:231], v[56:59]
    v_fmac_f32 v217, s23, v221
    v_cvt_pk_bf16_f32 v217, v252, v217
    v_mfma_f32_16x16x32_bf16 v[36:39], a[204:207], v[228:231], v[36:39]
    v_lshlrev_b32 v252, 16, v227
    v_and_b32 v227, s22, v227
    v_mfma_f32_16x16x32_bf16 v[40:43], a[208:211], v[228:231], v[40:43]
    buffer_load_dwordx2 v[212:213], v215, s[4:7], s20 offen offset:320
    v_add_f32 v252, v252, v248
    v_mfma_f32_16x16x32_bf16 v[44:47], a[212:215], v[228:231], v[44:47]
    v_add_f32 v227, v227, v219
    v_fmac_f32 v252, s23, v250
    v_mfma_f32_16x16x32_bf16 v[24:27], a[216:219], v[228:231], v[24:27]
    s_waitcnt lgkmcnt(1)
    v_fmac_f32 v227, s23, v223
    v_cvt_pk_bf16_f32 v227, v252, v227
    v_mfma_f32_16x16x32_bf16 v[28:31], a[220:223], v[228:231], v[28:31]
    buffer_load_dwordx2 v[214:215], v215, s[4:7], s21 offen offset:320
    v_mfma_f32_16x16x32_bf16 v[32:35], a[224:227], v[228:231], v[32:35]
    ds_read_b128 v[228:231], v253 offset:13792
    v_fma_f32 v252, v249, s24, v251
    v_mfma_f32_16x16x32_bf16 v[60:63], a[192:195], v[232:235], v[60:63]
    v_fmac_f32 v251, s25, v249
    v_fma_f32 v249, v248, s24, v250
    v_mfma_f32_16x16x32_bf16 v[64:67], a[196:199], v[232:235], v[64:67]
    v_fmac_f32 v250, s25, v248
    v_fma_f32 v248, v250, s26, v251
    v_mfma_f32_16x16x32_bf16 v[68:71], a[200:203], v[232:235], v[68:71]
    v_fmac_f32 v251, s27, v250
    v_fma_f32 v250, v249, s28, v252
    v_fmac_f32 v252, s29, v249
    v_mfma_f32_16x16x32_bf16 v[48:51], a[204:207], v[232:235], v[48:51]
    v_fma_f32 v249, v221, s24, v225
    v_fmac_f32 v225, s25, v221
    v_mfma_f32_16x16x32_bf16 v[52:55], a[208:211], v[232:235], v[52:55]
    v_fma_f32 v221, v219, s24, v223
    v_fmac_f32 v223, s25, v219
    v_mfma_f32_16x16x32_bf16 v[56:59], a[212:215], v[232:235], v[56:59]
    v_fma_f32 v219, v223, s26, v225
    v_fmac_f32 v225, s27, v223
    v_mfma_f32_16x16x32_bf16 v[36:39], a[216:219], v[232:235], v[36:39]
    v_fma_f32 v223, v221, s28, v249
    v_fmac_f32 v249, s29, v221
    v_mfma_f32_16x16x32_bf16 v[40:43], a[220:223], v[232:235], v[40:43]
    s_waitcnt lgkmcnt(1)
    v_cvt_pk_bf16_f32 v219, v248, v219
    v_cvt_pk_bf16_f32 v225, v251, v225
    v_mfma_f32_16x16x32_bf16 v[44:47], a[224:227], v[232:235], v[44:47]
    ds_read_b128 v[232:235], v253 offset:13536
    v_cvt_pk_bf16_f32 v223, v250, v223
    v_mfma_f32_16x16x32_bf16 v[72:75], a[192:195], v[236:239], v[72:75]
    v_cvt_pk_bf16_f32 v221, v252, v249
    v_lshrrev_b32 v252, 15, v255
    v_mfma_f32_16x16x32_bf16 v[76:79], a[196:199], v[236:239], v[76:79]
    ds_write_b64 v252, v[218:219] offset:256
    v_mfma_f32_16x16x32_bf16 v[80:83], a[200:203], v[236:239], v[80:83]
    s_waitcnt vmcnt(15)
    v_lshlrev_b32 v248, 16, v194
    v_lshlrev_b32 v249, 16, v196
    v_mfma_f32_16x16x32_bf16 v[60:63], a[204:207], v[236:239], v[60:63]
    ds_write_b64 v252, v[224:225] offset:2336
    v_mfma_f32_16x16x32_bf16 v[64:67], a[208:211], v[236:239], v[64:67]
    v_lshlrev_b32 v250, 16, v198
    v_lshlrev_b32 v251, 16, v200
    v_mfma_f32_16x16x32_bf16 v[68:71], a[212:215], v[236:239], v[68:71]
    ds_write_b64 v252, v[222:223] offset:4416
    v_mfma_f32_16x16x32_bf16 v[48:51], a[216:219], v[236:239], v[48:51]
    s_waitcnt lgkmcnt(4)
    v_and_b32 v194, s22, v194
    v_and_b32 v196, s22, v196
    v_mfma_f32_16x16x32_bf16 v[52:55], a[220:223], v[236:239], v[52:55]
    ds_write_b64 v252, v[216:217] offset:21056
    v_mfma_f32_16x16x32_bf16 v[56:59], a[224:227], v[236:239], v[56:59]
    ds_read_b128 v[236:239], v253 offset:13264
    v_and_b32 v198, s22, v198
    v_mfma_f32_16x16x32_bf16 v[84:87], a[192:195], v[228:231], v[84:87]
    v_and_b32 v200, s22, v200
    v_mfma_f32_16x16x32_bf16 v[88:91], a[196:199], v[228:231], v[88:91]
    ds_write_b64 v252, v[226:227] offset:29376
    v_mfma_f32_16x16x32_bf16 v[92:95], a[200:203], v[228:231], v[92:95]
    s_mov_b32 s42, 589824
    v_mfma_f32_16x16x32_bf16 v[72:75], a[204:207], v[228:231], v[72:75]
    buffer_load_dwordx4 a[192:195], v254, s[8:11], s42 offen offset:0
    v_mfma_f32_16x16x32_bf16 v[76:79], a[208:211], v[228:231], v[76:79]
    ds_write_b64 v252, v[220:221] offset:6496
    v_mfma_f32_16x16x32_bf16 v[80:83], a[212:215], v[228:231], v[80:83]
    v_mfma_f32_16x16x32_bf16 v[60:63], a[216:219], v[228:231], v[60:63]
    buffer_load_dwordx4 a[196:199], v254, s[8:11], s42 offen offset:1024
    v_mfma_f32_16x16x32_bf16 v[64:67], a[220:223], v[228:231], v[64:67]
    v_lshlrev_b32 v252, 16, v192
    v_and_b32 v192, s22, v192
    v_mfma_f32_16x16x32_bf16 v[68:71], a[224:227], v[228:231], v[68:71]
    s_waitcnt lgkmcnt(7)
    v_add_f32 v252, v252, v251
    v_add_f32 v192, v192, v200
    v_mfma_f32_16x16x32_bf16 v[84:87], a[204:207], v[232:235], v[84:87]
    ds_read_b128 v[228:231], v253 offset:32240
    v_fmac_f32 v252, s23, v249
    v_mfma_f32_16x16x32_bf16 v[88:91], a[208:211], v[232:235], v[88:91]
    v_fmac_f32 v192, s23, v196
    v_cvt_pk_bf16_f32 v192, v252, v192
    v_mfma_f32_16x16x32_bf16 v[92:95], a[212:215], v[232:235], v[92:95]
    buffer_load_dwordx4 a[200:203], v254, s[8:11], s42 offen offset:2048
    v_mfma_f32_16x16x32_bf16 v[72:75], a[216:219], v[232:235], v[72:75]
    s_waitcnt lgkmcnt(3)
    v_lshlrev_b32 v252, 16, v202
    v_and_b32 v202, s22, v202
    v_mfma_f32_16x16x32_bf16 v[76:79], a[220:223], v[232:235], v[76:79]
    s_mov_b32 s42, 592896
    v_add_f32 v252, v252, v248
    v_add_f32 v202, v202, v194
    v_mfma_f32_16x16x32_bf16 v[80:83], a[224:227], v[232:235], v[80:83]
    ds_read_b128 v[232:235], v253 offset:31968
    v_fmac_f32 v252, s23, v250
    v_mfma_f32_16x16x32_bf16 v[84:87], a[216:219], v[236:239], v[84:87]
    buffer_load_dwordx4 a[204:207], v254, s[8:11], s42 offen offset:0
    v_mfma_f32_16x16x32_bf16 v[88:91], a[220:223], v[236:239], v[88:91]
    s_waitcnt vmcnt(16) lgkmcnt(1)
    v_fmac_f32 v202, s23, v198
    v_cvt_pk_bf16_f32 v202, v252, v202
    v_mfma_f32_16x16x32_bf16 v[92:95], a[224:227], v[236:239], v[92:95]
    ds_read_b128 v[236:239], v253 offset:31712
    v_fma_f32 v252, v249, s24, v251
    v_mfma_f32_16x16x32_bf16 v[96:99], a[228:231], v[228:231], v[96:99]
    s_waitcnt lgkmcnt(1)
    v_fmac_f32 v251, s25, v249
    v_fma_f32 v249, v248, s24, v250
    v_mfma_f32_16x16x32_bf16 v[100:103], a[232:235], v[228:231], v[100:103]
    buffer_load_dwordx4 a[208:211], v254, s[8:11], s42 offen offset:1024
    v_mfma_f32_16x16x32_bf16 v[104:107], a[236:239], v[228:231], v[104:107]
    ds_read_b128 v[228:231], v253 offset:31456
    v_fmac_f32 v250, s25, v248
    v_mfma_f32_16x16x32_bf16 v[108:111], a[228:231], v[232:235], v[108:111]
    v_fma_f32 v248, v250, s26, v251
    v_fmac_f32 v251, s27, v250
    v_mfma_f32_16x16x32_bf16 v[112:115], a[232:235], v[232:235], v[112:115]
    s_waitcnt vmcnt(14)
    v_fma_f32 v250, v249, s28, v252
    v_fmac_f32 v252, s29, v249
    v_mfma_f32_16x16x32_bf16 v[116:119], a[236:239], v[232:235], v[116:119]
    buffer_load_dwordx4 a[212:215], v254, s[8:11], s42 offen offset:2048
    v_mfma_f32_16x16x32_bf16 v[96:99], a[240:243], v[232:235], v[96:99]
    s_waitcnt lgkmcnt(1)
    v_fma_f32 v249, v196, s24, v200
    v_fmac_f32 v200, s25, v196
    v_mfma_f32_16x16x32_bf16 v[100:103], a[244:247], v[232:235], v[100:103]
    s_mov_b32 s42, 595968
    v_fma_f32 v196, v194, s24, v198
    v_fmac_f32 v198, s25, v194
    v_mfma_f32_16x16x32_bf16 v[104:107], a[248:251], v[232:235], v[104:107]
    ds_read_b128 v[232:235], v253 offset:31200
    v_fma_f32 v194, v198, s26, v200
    v_mfma_f32_16x16x32_bf16 v[120:123], a[228:231], v[236:239], v[120:123]
    buffer_load_dwordx4 a[216:219], v254, s[8:11], s42 offen offset:0
    v_mfma_f32_16x16x32_bf16 v[124:127], a[232:235], v[236:239], v[124:127]
    v_fmac_f32 v200, s27, v198
    v_fma_f32 v198, v196, s28, v249
    v_mfma_f32_16x16x32_bf16 v[128:131], a[236:239], v[236:239], v[128:131]
    v_fmac_f32 v249, s29, v196
    v_cvt_pk_bf16_f32 v194, v248, v194
    v_mfma_f32_16x16x32_bf16 v[108:111], a[240:243], v[236:239], v[108:111]
    v_cvt_pk_bf16_f32 v200, v251, v200
    v_cvt_pk_bf16_f32 v198, v250, v198
    v_mfma_f32_16x16x32_bf16 v[112:115], a[244:247], v[236:239], v[112:115]
    buffer_load_dwordx4 a[220:223], v254, s[8:11], s42 offen offset:1024
    v_mfma_f32_16x16x32_bf16 v[116:119], a[248:251], v[236:239], v[116:119]
    s_waitcnt vmcnt(14)
    v_cvt_pk_bf16_f32 v196, v252, v249
    v_lshlrev_b32 v248, 16, v195
    v_mfma_f32_16x16x32_bf16 v[96:99], a[252:255], v[236:239], v[96:99]
    s_waitcnt lgkmcnt(1)
    v_lshlrev_b32 v249, 16, v197
    v_lshlrev_b32 v250, 16, v199
    v_mfma_f32_16x16x32_bf16 v[100:103], v[240:243], v[236:239], v[100:103]
    buffer_load_dwordx4 a[224:227], v254, s[8:11], s42 offen offset:2048
    v_mfma_f32_16x16x32_bf16 v[104:107], v[244:247], v[236:239], v[104:107]
    ds_read_b128 v[236:239], v253 offset:33024
    v_and_b32 v227, 0x7fff, v255
    v_mfma_f32_16x16x32_bf16 v[132:135], a[228:231], v[228:231], v[132:135]
    v_lshlrev_b32 v251, 16, v201
    v_and_b32 v195, s22, v195
    v_mfma_f32_16x16x32_bf16 v[136:139], a[232:235], v[228:231], v[136:139]
    buffer_load_dwordx2 v[216:217], v227, s[4:7], s16 offen offset:704
    v_mfma_f32_16x16x32_bf16 v[140:143], a[236:239], v[228:231], v[140:143]
    v_and_b32 v197, s22, v197
    v_and_b32 v199, s22, v199
    v_mfma_f32_16x16x32_bf16 v[120:123], a[240:243], v[228:231], v[120:123]
    v_and_b32 v201, s22, v201
    v_lshlrev_b32 v252, 16, v193
    v_mfma_f32_16x16x32_bf16 v[124:127], a[244:247], v[228:231], v[124:127]
    buffer_load_dwordx2 v[218:219], v227, s[4:7], s17 offen offset:704
    v_mfma_f32_16x16x32_bf16 v[128:131], a[248:251], v[228:231], v[128:131]
    v_and_b32 v193, s22, v193
    v_add_f32 v252, v252, v251
    v_mfma_f32_16x16x32_bf16 v[108:111], a[252:255], v[228:231], v[108:111]
    s_waitcnt lgkmcnt(1)
    v_add_f32 v193, v193, v201
    v_fmac_f32 v252, s23, v249
    v_mfma_f32_16x16x32_bf16 v[112:115], v[240:243], v[228:231], v[112:115]
    buffer_load_dwordx2 v[220:221], v227, s[4:7], s18 offen offset:704
    v_mfma_f32_16x16x32_bf16 v[116:119], v[244:247], v[228:231], v[116:119]
    ds_read_b128 v[228:231], v253 offset:32768
    v_fmac_f32 v193, s23, v197
    v_mfma_f32_16x16x32_bf16 v[144:147], a[228:231], v[232:235], v[144:147]
    v_cvt_pk_bf16_f32 v193, v252, v193
    v_lshlrev_b32 v252, 16, v203
    v_mfma_f32_16x16x32_bf16 v[148:151], a[232:235], v[232:235], v[148:151]
    buffer_load_dwordx2 v[222:223], v227, s[4:7], s19 offen offset:704
    v_mfma_f32_16x16x32_bf16 v[152:155], a[236:239], v[232:235], v[152:155]
    v_and_b32 v203, s22, v203
    v_add_f32 v252, v252, v248
    v_mfma_f32_16x16x32_bf16 v[132:135], a[240:243], v[232:235], v[132:135]
    v_add_f32 v203, v203, v195
    v_fmac_f32 v252, s23, v250
    v_mfma_f32_16x16x32_bf16 v[136:139], a[244:247], v[232:235], v[136:139]
    buffer_load_dwordx2 v[224:225], v227, s[4:7], s20 offen offset:704
    v_mfma_f32_16x16x32_bf16 v[140:143], a[248:251], v[232:235], v[140:143]
    v_fmac_f32 v203, s23, v199
    v_cvt_pk_bf16_f32 v203, v252, v203
    v_mfma_f32_16x16x32_bf16 v[120:123], a[252:255], v[232:235], v[120:123]
    s_waitcnt lgkmcnt(1)
    v_fma_f32 v252, v249, s24, v251
    v_fmac_f32 v251, s25, v249
    v_mfma_f32_16x16x32_bf16 v[124:127], v[240:243], v[232:235], v[124:127]
    buffer_load_dwordx2 v[226:227], v227, s[4:7], s21 offen offset:704
    v_mfma_f32_16x16x32_bf16 v[128:131], v[244:247], v[232:235], v[128:131]
    ds_read_b128 v[232:235], v253 offset:32512
    v_fma_f32 v249, v248, s24, v250
    v_mfma_f32_16x16x32_bf16 v[156:159], a[228:231], v[236:239], v[156:159]
    v_fmac_f32 v250, s25, v248
    v_fma_f32 v248, v250, s26, v251
    v_mfma_f32_16x16x32_bf16 v[160:163], a[232:235], v[236:239], v[160:163]
    v_fmac_f32 v251, s27, v250
    v_fma_f32 v250, v249, s28, v252
    v_mfma_f32_16x16x32_bf16 v[164:167], a[236:239], v[236:239], v[164:167]
    v_fmac_f32 v252, s29, v249
    v_fma_f32 v249, v197, s24, v201
    v_mfma_f32_16x16x32_bf16 v[144:147], a[240:243], v[236:239], v[144:147]
    v_fmac_f32 v201, s25, v197
    v_fma_f32 v197, v195, s24, v199
    v_mfma_f32_16x16x32_bf16 v[148:151], a[244:247], v[236:239], v[148:151]
    v_fmac_f32 v199, s25, v195
    v_fma_f32 v195, v199, s26, v201
    v_mfma_f32_16x16x32_bf16 v[152:155], a[248:251], v[236:239], v[152:155]
    v_fmac_f32 v201, s27, v199
    v_fma_f32 v199, v197, s28, v249
    v_mfma_f32_16x16x32_bf16 v[132:135], a[252:255], v[236:239], v[132:135]
    v_fmac_f32 v249, s29, v197
    v_cvt_pk_bf16_f32 v195, v248, v195
    v_mfma_f32_16x16x32_bf16 v[136:139], v[240:243], v[236:239], v[136:139]
    s_waitcnt lgkmcnt(1)
    v_cvt_pk_bf16_f32 v201, v251, v201
    v_cvt_pk_bf16_f32 v199, v250, v199
    v_mfma_f32_16x16x32_bf16 v[140:143], v[244:247], v[236:239], v[140:143]
    ds_read_b128 v[236:239], v253 offset:32256
    v_cvt_pk_bf16_f32 v197, v252, v249
    v_mfma_f32_16x16x32_bf16 v[168:171], a[228:231], v[228:231], v[168:171]
    v_lshrrev_b32 v252, 15, v255
    v_mfma_f32_16x16x32_bf16 v[172:175], a[232:235], v[228:231], v[172:175]
    ds_write_b64 v252, v[194:195] offset:0
    v_mfma_f32_16x16x32_bf16 v[176:179], a[236:239], v[228:231], v[176:179]
    s_waitcnt vmcnt(15)
    v_lshlrev_b32 v248, 16, v206
    v_lshlrev_b32 v249, 16, v208
    v_mfma_f32_16x16x32_bf16 v[156:159], a[240:243], v[228:231], v[156:159]
    ds_write_b64 v252, v[200:201] offset:2080
    v_mfma_f32_16x16x32_bf16 v[160:163], a[244:247], v[228:231], v[160:163]
    v_lshlrev_b32 v250, 16, v210
    v_lshlrev_b32 v251, 16, v212
    v_mfma_f32_16x16x32_bf16 v[164:167], a[248:251], v[228:231], v[164:167]
    ds_write_b64 v252, v[198:199] offset:4160
    v_mfma_f32_16x16x32_bf16 v[144:147], a[252:255], v[228:231], v[144:147]
    s_waitcnt lgkmcnt(4)
    v_and_b32 v206, s22, v206
    v_and_b32 v208, s22, v208
    v_mfma_f32_16x16x32_bf16 v[148:151], v[240:243], v[228:231], v[148:151]
    ds_write_b64 v252, v[192:193] offset:20800
    v_mfma_f32_16x16x32_bf16 v[152:155], v[244:247], v[228:231], v[152:155]
    ds_read_b128 v[228:231], v253 offset:31984
    v_and_b32 v210, s22, v210
    v_mfma_f32_16x16x32_bf16 v[180:183], a[228:231], v[232:235], v[180:183]
    v_and_b32 v212, s22, v212
    v_mfma_f32_16x16x32_bf16 v[184:187], a[232:235], v[232:235], v[184:187]
    ds_write_b64 v252, v[202:203] offset:29120
    v_mfma_f32_16x16x32_bf16 v[188:191], a[236:239], v[232:235], v[188:191]
    s_mov_b32 s42, 626688
    v_mfma_f32_16x16x32_bf16 v[168:171], a[240:243], v[232:235], v[168:171]
    buffer_load_dwordx4 a[228:231], v254, s[8:11], s42 offen offset:0
    v_mfma_f32_16x16x32_bf16 v[172:175], a[244:247], v[232:235], v[172:175]
    ds_write_b64 v252, v[196:197] offset:6240
    v_mfma_f32_16x16x32_bf16 v[176:179], a[248:251], v[232:235], v[176:179]
    s_waitcnt lgkmcnt(7)
    v_mfma_f32_16x16x32_bf16 v[156:159], a[252:255], v[232:235], v[156:159]
    buffer_load_dwordx4 a[232:235], v254, s[8:11], s42 offen offset:1024
    v_mfma_f32_16x16x32_bf16 v[160:163], v[240:243], v[232:235], v[160:163]
    s_waitcnt lgkmcnt(0)
    v_lshlrev_b32 v252, 16, v204
    v_and_b32 v204, s22, v204
    v_mfma_f32_16x16x32_bf16 v[164:167], v[244:247], v[232:235], v[164:167]
    s_barrier
    v_mfma_f32_16x16x32_bf16 v[180:183], a[240:243], v[236:239], v[180:183]
    ds_read_b128 v[232:235], v253 offset:1040
    v_add_f32 v252, v252, v251
    v_mfma_f32_16x16x32_bf16 v[184:187], a[244:247], v[236:239], v[184:187]
    v_add_f32 v204, v204, v212
    v_fmac_f32 v252, s23, v249
    v_mfma_f32_16x16x32_bf16 v[188:191], a[248:251], v[236:239], v[188:191]
    buffer_load_dwordx4 a[236:239], v254, s[8:11], s42 offen offset:2048
    v_mfma_f32_16x16x32_bf16 v[168:171], a[252:255], v[236:239], v[168:171]
    v_fmac_f32 v204, s23, v208
    v_cvt_pk_bf16_f32 v204, v252, v204
    v_mfma_f32_16x16x32_bf16 v[172:175], v[240:243], v[236:239], v[172:175]
    s_mov_b32 s42, 629760
    v_lshlrev_b32 v252, 16, v214
    v_and_b32 v214, s22, v214
    v_mfma_f32_16x16x32_bf16 v[176:179], v[244:247], v[236:239], v[176:179]
    ds_read_b128 v[236:239], v253 offset:768
    v_add_f32 v252, v252, v248
    v_mfma_f32_16x16x32_bf16 v[180:183], a[252:255], v[228:231], v[180:183]
    buffer_load_dwordx4 a[240:243], v254, s[8:11], s42 offen offset:0
    v_mfma_f32_16x16x32_bf16 v[184:187], v[240:243], v[228:231], v[184:187]
    s_waitcnt vmcnt(16) lgkmcnt(1)
    v_add_f32 v214, v214, v206
    v_fmac_f32 v252, s23, v250
    v_mfma_f32_16x16x32_bf16 v[188:191], v[244:247], v[228:231], v[188:191]
    ds_read_b128 v[228:231], v253 offset:512
    v_fmac_f32 v214, s23, v210
    v_mfma_f32_16x16x32_bf16 a[0:3], a[192:195], v[232:235], a[0:3]
    s_waitcnt lgkmcnt(1)
    v_cvt_pk_bf16_f32 v214, v252, v214
    v_fma_f32 v252, v249, s24, v251
    v_mfma_f32_16x16x32_bf16 a[4:7], a[196:199], v[232:235], a[4:7]
    buffer_load_dwordx4 a[244:247], v254, s[8:11], s42 offen offset:1024
    v_mfma_f32_16x16x32_bf16 a[8:11], a[200:203], v[232:235], a[8:11]
    ds_read_b128 v[232:235], v253 offset:256
    v_fmac_f32 v251, s25, v249
    v_mfma_f32_16x16x32_bf16 a[12:15], a[192:195], v[236:239], a[12:15]
    v_fma_f32 v249, v248, s24, v250
    v_fmac_f32 v250, s25, v248
    v_mfma_f32_16x16x32_bf16 a[16:19], a[196:199], v[236:239], a[16:19]
    s_waitcnt vmcnt(14)
    v_fma_f32 v248, v250, s26, v251
    v_fmac_f32 v251, s27, v250
    v_mfma_f32_16x16x32_bf16 a[20:23], a[200:203], v[236:239], a[20:23]
    buffer_load_dwordx4 a[248:251], v254, s[8:11], s42 offen offset:2048
    v_mfma_f32_16x16x32_bf16 a[0:3], a[204:207], v[236:239], a[0:3]
    s_waitcnt lgkmcnt(1)
    v_fma_f32 v250, v249, s28, v252
    v_fmac_f32 v252, s29, v249
    v_mfma_f32_16x16x32_bf16 a[4:7], a[208:211], v[236:239], a[4:7]
    s_mov_b32 s42, 632832
    v_fma_f32 v249, v208, s24, v212
    v_fmac_f32 v212, s25, v208
    v_mfma_f32_16x16x32_bf16 a[8:11], a[212:215], v[236:239], a[8:11]
    ds_read_b128 v[236:239], v253 offset:0
    v_fma_f32 v208, v206, s24, v210
    v_mfma_f32_16x16x32_bf16 a[24:27], a[192:195], v[228:231], a[24:27]
    buffer_load_dwordx4 a[252:255], v254, s[8:11], s42 offen offset:0
    v_mfma_f32_16x16x32_bf16 a[28:31], a[196:199], v[228:231], a[28:31]
    v_fmac_f32 v210, s25, v206
    v_fma_f32 v206, v210, s26, v212
    v_mfma_f32_16x16x32_bf16 a[32:35], a[200:203], v[228:231], a[32:35]
    v_fmac_f32 v212, s27, v210
    v_fma_f32 v210, v208, s28, v249
    v_mfma_f32_16x16x32_bf16 a[12:15], a[204:207], v[228:231], a[12:15]
    v_fmac_f32 v249, s29, v208
    v_cvt_pk_bf16_f32 v206, v248, v206
    v_mfma_f32_16x16x32_bf16 a[16:19], a[208:211], v[228:231], a[16:19]
    buffer_load_dwordx4 v[240:243], v254, s[8:11], s42 offen offset:1024
    v_mfma_f32_16x16x32_bf16 a[20:23], a[212:215], v[228:231], a[20:23]
    s_waitcnt vmcnt(14)
    v_cvt_pk_bf16_f32 v212, v251, v212
    v_cvt_pk_bf16_f32 v210, v250, v210
    v_mfma_f32_16x16x32_bf16 a[0:3], a[216:219], v[228:231], a[0:3]
    s_waitcnt lgkmcnt(1)
    v_cvt_pk_bf16_f32 v208, v252, v249
    v_lshlrev_b32 v248, 16, v207
    v_mfma_f32_16x16x32_bf16 a[4:7], a[220:223], v[228:231], a[4:7]
    buffer_load_dwordx4 v[244:247], v254, s[8:11], s42 offen offset:2048
    v_mfma_f32_16x16x32_bf16 a[8:11], a[224:227], v[228:231], a[8:11]
    ds_read_b128 v[228:231], v253 offset:1824
    v_and_b32 v203, 0x7fff, v255
    v_mfma_f32_16x16x32_bf16 a[36:39], a[192:195], v[232:235], a[36:39]
    v_lshlrev_b32 v249, 16, v209
    v_lshlrev_b32 v250, 16, v211
    v_mfma_f32_16x16x32_bf16 a[40:43], a[196:199], v[232:235], a[40:43]
    buffer_load_dwordx2 v[192:193], v203, s[4:7], s16 offen offset:1088
    v_mfma_f32_16x16x32_bf16 a[44:47], a[200:203], v[232:235], a[44:47]
    v_lshlrev_b32 v251, 16, v213
    v_and_b32 v207, s22, v207
    v_mfma_f32_16x16x32_bf16 a[24:27], a[204:207], v[232:235], a[24:27]
    v_and_b32 v209, s22, v209
    v_and_b32 v211, s22, v211
    v_mfma_f32_16x16x32_bf16 a[28:31], a[208:211], v[232:235], a[28:31]
    buffer_load_dwordx2 v[194:195], v203, s[4:7], s17 offen offset:1088
    v_mfma_f32_16x16x32_bf16 a[32:35], a[212:215], v[232:235], a[32:35]
    v_and_b32 v213, s22, v213
    v_lshlrev_b32 v252, 16, v205
    v_mfma_f32_16x16x32_bf16 a[12:15], a[216:219], v[232:235], a[12:15]
    s_waitcnt lgkmcnt(1)
    v_and_b32 v205, s22, v205
    v_add_f32 v252, v252, v251
    v_mfma_f32_16x16x32_bf16 a[16:19], a[220:223], v[232:235], a[16:19]
    buffer_load_dwordx2 v[196:197], v203, s[4:7], s18 offen offset:1088
    v_mfma_f32_16x16x32_bf16 a[20:23], a[224:227], v[232:235], a[20:23]
    ds_read_b128 v[232:235], v253 offset:1568
    v_add_f32 v205, v205, v213
    v_mfma_f32_16x16x32_bf16 a[48:51], a[192:195], v[236:239], a[48:51]
    v_fmac_f32 v252, s23, v249
    v_fmac_f32 v205, s23, v209
    v_mfma_f32_16x16x32_bf16 a[52:55], a[196:199], v[236:239], a[52:55]
    buffer_load_dwordx2 v[198:199], v203, s[4:7], s19 offen offset:1088
    v_mfma_f32_16x16x32_bf16 a[56:59], a[200:203], v[236:239], a[56:59]
    v_cvt_pk_bf16_f32 v205, v252, v205
    v_lshlrev_b32 v252, 16, v215
    v_mfma_f32_16x16x32_bf16 a[36:39], a[204:207], v[236:239], a[36:39]
    v_and_b32 v215, s22, v215
    v_add_f32 v252, v252, v248
    v_mfma_f32_16x16x32_bf16 a[40:43], a[208:211], v[236:239], a[40:43]
    buffer_load_dwordx2 v[200:201], v203, s[4:7], s20 offen offset:1088
    v_mfma_f32_16x16x32_bf16 a[44:47], a[212:215], v[236:239], a[44:47]
    v_add_f32 v215, v215, v207
    v_fmac_f32 v252, s23, v250
    v_mfma_f32_16x16x32_bf16 a[24:27], a[216:219], v[236:239], a[24:27]
    s_waitcnt lgkmcnt(1)
    v_fmac_f32 v215, s23, v211
    v_cvt_pk_bf16_f32 v215, v252, v215
    v_mfma_f32_16x16x32_bf16 a[28:31], a[220:223], v[236:239], a[28:31]
    buffer_load_dwordx2 v[202:203], v203, s[4:7], s21 offen offset:1088
    v_mfma_f32_16x16x32_bf16 a[32:35], a[224:227], v[236:239], a[32:35]
    ds_read_b128 v[236:239], v253 offset:1312
    v_fma_f32 v252, v249, s24, v251
    v_mfma_f32_16x16x32_bf16 a[60:63], a[192:195], v[228:231], a[60:63]
    v_fmac_f32 v251, s25, v249
    v_fma_f32 v249, v248, s24, v250
    v_mfma_f32_16x16x32_bf16 a[64:67], a[196:199], v[228:231], a[64:67]
    v_fmac_f32 v250, s25, v248
    v_fma_f32 v248, v250, s26, v251
    v_mfma_f32_16x16x32_bf16 a[68:71], a[200:203], v[228:231], a[68:71]
    v_fmac_f32 v251, s27, v250
    v_fma_f32 v250, v249, s28, v252
    v_mfma_f32_16x16x32_bf16 a[48:51], a[204:207], v[228:231], a[48:51]
    v_fmac_f32 v252, s29, v249
    v_fma_f32 v249, v209, s24, v213
    v_mfma_f32_16x16x32_bf16 a[52:55], a[208:211], v[228:231], a[52:55]
    v_fmac_f32 v213, s25, v209
    v_fma_f32 v209, v207, s24, v211
    v_mfma_f32_16x16x32_bf16 a[56:59], a[212:215], v[228:231], a[56:59]
    v_fmac_f32 v211, s25, v207
    v_fma_f32 v207, v211, s26, v213
    v_mfma_f32_16x16x32_bf16 a[36:39], a[216:219], v[228:231], a[36:39]
    v_fmac_f32 v213, s27, v211
    v_fma_f32 v211, v209, s28, v249
    v_mfma_f32_16x16x32_bf16 a[40:43], a[220:223], v[228:231], a[40:43]
    s_waitcnt lgkmcnt(1)
    v_fmac_f32 v249, s29, v209
    v_cvt_pk_bf16_f32 v207, v248, v207
    v_mfma_f32_16x16x32_bf16 a[44:47], a[224:227], v[228:231], a[44:47]
    ds_read_b128 v[228:231], v253 offset:1056
    v_cvt_pk_bf16_f32 v213, v251, v213
    v_mfma_f32_16x16x32_bf16 a[72:75], a[192:195], v[232:235], a[72:75]
    v_cvt_pk_bf16_f32 v211, v250, v211
    v_cvt_pk_bf16_f32 v209, v252, v249
    v_mfma_f32_16x16x32_bf16 a[76:79], a[196:199], v[232:235], a[76:79]
    v_lshrrev_b32 v252, 15, v255
    v_mfma_f32_16x16x32_bf16 a[80:83], a[200:203], v[232:235], a[80:83]
    ds_write_b64 v252, v[206:207] offset:9088
    v_mfma_f32_16x16x32_bf16 a[60:63], a[204:207], v[232:235], a[60:63]
    s_waitcnt vmcnt(15)
    v_lshlrev_b32 v248, 16, v218
    v_lshlrev_b32 v249, 16, v220
    v_mfma_f32_16x16x32_bf16 a[64:67], a[208:211], v[232:235], a[64:67]
    ds_write_b64 v252, v[212:213] offset:11168
    v_mfma_f32_16x16x32_bf16 a[68:71], a[212:215], v[232:235], a[68:71]
    v_lshlrev_b32 v250, 16, v222
    v_lshlrev_b32 v251, 16, v224
    v_mfma_f32_16x16x32_bf16 a[48:51], a[216:219], v[232:235], a[48:51]
    ds_write_b64 v252, v[210:211] offset:13248
    v_mfma_f32_16x16x32_bf16 a[52:55], a[220:223], v[232:235], a[52:55]
    s_waitcnt lgkmcnt(4)
    v_and_b32 v218, s22, v218
    v_and_b32 v220, s22, v220
    v_mfma_f32_16x16x32_bf16 a[56:59], a[224:227], v[232:235], a[56:59]
    ds_read_b128 v[232:235], v253 offset:784
    v_mfma_f32_16x16x32_bf16 a[84:87], a[192:195], v[236:239], a[84:87]
    ds_write_b64 v252, v[204:205] offset:23648
    v_mfma_f32_16x16x32_bf16 a[88:91], a[196:199], v[236:239], a[88:91]
    v_and_b32 v222, s22, v222
    v_and_b32 v224, s22, v224
    v_mfma_f32_16x16x32_bf16 a[92:95], a[200:203], v[236:239], a[92:95]
    s_mov_b32 s42, 663552
    v_mfma_f32_16x16x32_bf16 a[72:75], a[204:207], v[236:239], a[72:75]
    buffer_load_dwordx4 a[192:195], v254, s[8:11], s42 offen offset:0
    v_mfma_f32_16x16x32_bf16 a[76:79], a[208:211], v[236:239], a[76:79]
    ds_write_b64 v252, v[214:215] offset:31968
    v_mfma_f32_16x16x32_bf16 a[80:83], a[212:215], v[236:239], a[80:83]
    s_waitcnt lgkmcnt(6)
    v_mfma_f32_16x16x32_bf16 a[60:63], a[216:219], v[236:239], a[60:63]
    buffer_load_dwordx4 a[196:199], v254, s[8:11], s42 offen offset:1024
    v_mfma_f32_16x16x32_bf16 a[64:67], a[220:223], v[236:239], a[64:67]
    s_waitcnt lgkmcnt(0)
    v_mfma_f32_16x16x32_bf16 a[68:71], a[224:227], v[236:239], a[68:71]
    s_barrier
    v_mfma_f32_16x16x32_bf16 a[84:87], a[204:207], v[228:231], a[84:87]
    ds_read_b128 v[236:239], v253 offset:3120
    v_mfma_f32_16x16x32_bf16 a[88:91], a[208:211], v[228:231], a[88:91]
    ds_write_b64 v252, v[208:209] offset:768
    v_mfma_f32_16x16x32_bf16 a[92:95], a[212:215], v[228:231], a[92:95]
    buffer_load_dwordx4 a[200:203], v254, s[8:11], s42 offen offset:2048
    v_mfma_f32_16x16x32_bf16 a[72:75], a[216:219], v[228:231], a[72:75]
    v_lshlrev_b32 v252, 16, v216
    v_and_b32 v216, s22, v216
    v_mfma_f32_16x16x32_bf16 a[76:79], a[220:223], v[228:231], a[76:79]
    s_mov_b32 s42, 666624
    v_add_f32 v252, v252, v251
    v_add_f32 v216, v216, v224
    v_fmac_f32 v252, s23, v249
    v_mfma_f32_16x16x32_bf16 a[80:83], a[224:227], v[228:231], a[80:83]
    ds_read_b128 v[228:231], v253 offset:2848
    v_fmac_f32 v216, s23, v220
    v_mfma_f32_16x16x32_bf16 a[84:87], a[216:219], v[232:235], a[84:87]
    buffer_load_dwordx4 a[204:207], v254, s[8:11], s42 offen offset:0
    v_mfma_f32_16x16x32_bf16 a[88:91], a[220:223], v[232:235], a[88:91]
    s_waitcnt vmcnt(16) lgkmcnt(2)
    v_cvt_pk_bf16_f32 v216, v252, v216
    v_lshlrev_b32 v252, 16, v226
    v_mfma_f32_16x16x32_bf16 a[92:95], a[224:227], v[232:235], a[92:95]
    ds_read_b128 v[232:235], v253 offset:2592
    v_and_b32 v226, s22, v226
    v_mfma_f32_16x16x32_bf16 a[96:99], a[228:231], v[236:239], a[96:99]
    s_waitcnt lgkmcnt(1)
    v_add_f32 v252, v252, v248
    v_add_f32 v226, v226, v218
    v_mfma_f32_16x16x32_bf16 a[100:103], a[232:235], v[236:239], a[100:103]
    buffer_load_dwordx4 a[208:211], v254, s[8:11], s42 offen offset:1024
    v_mfma_f32_16x16x32_bf16 a[104:107], a[236:239], v[236:239], a[104:107]
    ds_read_b128 v[236:239], v253 offset:2336
    v_fmac_f32 v252, s23, v250
    v_mfma_f32_16x16x32_bf16 a[108:111], a[228:231], v[228:231], a[108:111]
    v_fmac_f32 v226, s23, v222
    v_cvt_pk_bf16_f32 v226, v252, v226
    v_mfma_f32_16x16x32_bf16 a[112:115], a[232:235], v[228:231], a[112:115]
    s_waitcnt vmcnt(14)
    v_fma_f32 v252, v249, s24, v251
    v_fmac_f32 v251, s25, v249
    v_mfma_f32_16x16x32_bf16 a[116:119], a[236:239], v[228:231], a[116:119]
    buffer_load_dwordx4 a[212:215], v254, s[8:11], s42 offen offset:2048
    v_fma_f32 v249, v248, s24, v250
    v_mfma_f32_16x16x32_bf16 a[96:99], a[240:243], v[228:231], a[96:99]
    s_waitcnt lgkmcnt(1)
    v_fmac_f32 v250, s25, v248
    v_fma_f32 v248, v250, s26, v251
    v_mfma_f32_16x16x32_bf16 a[100:103], a[244:247], v[228:231], a[100:103]
    s_mov_b32 s42, 669696
    v_fmac_f32 v251, s27, v250
    v_fma_f32 v250, v249, s28, v252
    v_mfma_f32_16x16x32_bf16 a[104:107], a[248:251], v[228:231], a[104:107]
    ds_read_b128 v[228:231], v253 offset:2080
    v_fmac_f32 v252, s29, v249
    v_mfma_f32_16x16x32_bf16 a[120:123], a[228:231], v[232:235], a[120:123]
    buffer_load_dwordx4 a[216:219], v254, s[8:11], s42 offen offset:0
    v_mfma_f32_16x16x32_bf16 a[124:127], a[232:235], v[232:235], a[124:127]
    v_fma_f32 v249, v220, s24, v224
    v_fmac_f32 v224, s25, v220
    v_mfma_f32_16x16x32_bf16 a[128:131], a[236:239], v[232:235], a[128:131]
    v_fma_f32 v220, v218, s24, v222
    v_fmac_f32 v222, s25, v218
    v_mfma_f32_16x16x32_bf16 a[108:111], a[240:243], v[232:235], a[108:111]
    v_fma_f32 v218, v222, s26, v224
    v_fmac_f32 v224, s27, v222
    v_mfma_f32_16x16x32_bf16 a[112:115], a[244:247], v[232:235], a[112:115]
    buffer_load_dwordx4 a[220:223], v254, s[8:11], s42 offen offset:1024
    v_mfma_f32_16x16x32_bf16 a[116:119], a[248:251], v[232:235], a[116:119]
    s_waitcnt vmcnt(14)
    v_fma_f32 v222, v220, s28, v249
    v_fmac_f32 v249, s29, v220
    v_mfma_f32_16x16x32_bf16 a[96:99], a[252:255], v[232:235], a[96:99]
    s_waitcnt lgkmcnt(1)
    v_cvt_pk_bf16_f32 v218, v248, v218
    v_cvt_pk_bf16_f32 v224, v251, v224
    v_cvt_pk_bf16_f32 v222, v250, v222
    v_mfma_f32_16x16x32_bf16 a[100:103], v[240:243], v[232:235], a[100:103]
    buffer_load_dwordx4 a[224:227], v254, s[8:11], s42 offen offset:2048
    v_mfma_f32_16x16x32_bf16 a[104:107], v[244:247], v[232:235], a[104:107]
    ds_read_b128 v[232:235], v253 offset:3904
    v_and_b32 v215, 0x7fff, v255
    v_mfma_f32_16x16x32_bf16 a[132:135], a[228:231], v[236:239], a[132:135]
    v_cvt_pk_bf16_f32 v220, v252, v249
    v_lshlrev_b32 v248, 16, v219
    v_mfma_f32_16x16x32_bf16 a[136:139], a[232:235], v[236:239], a[136:139]
    buffer_load_dwordx2 v[204:205], v215, s[4:7], s16 offen offset:1472
    v_mfma_f32_16x16x32_bf16 a[140:143], a[236:239], v[236:239], a[140:143]
    v_lshlrev_b32 v249, 16, v221
    v_lshlrev_b32 v250, 16, v223
    v_mfma_f32_16x16x32_bf16 a[120:123], a[240:243], v[236:239], a[120:123]
    v_lshlrev_b32 v251, 16, v225
    v_and_b32 v219, s22, v219
    v_mfma_f32_16x16x32_bf16 a[124:127], a[244:247], v[236:239], a[124:127]
    buffer_load_dwordx2 v[206:207], v215, s[4:7], s17 offen offset:1472
    v_mfma_f32_16x16x32_bf16 a[128:131], a[248:251], v[236:239], a[128:131]
    v_and_b32 v221, s22, v221
    v_and_b32 v223, s22, v223
    v_mfma_f32_16x16x32_bf16 a[108:111], a[252:255], v[236:239], a[108:111]
    s_waitcnt lgkmcnt(1)
    v_and_b32 v225, s22, v225
    v_lshlrev_b32 v252, 16, v217
    v_mfma_f32_16x16x32_bf16 a[112:115], v[240:243], v[236:239], a[112:115]
    buffer_load_dwordx2 v[208:209], v215, s[4:7], s18 offen offset:1472
    v_and_b32 v217, s22, v217
    v_mfma_f32_16x16x32_bf16 a[116:119], v[244:247], v[236:239], a[116:119]
    ds_read_b128 v[236:239], v253 offset:3648
    v_add_f32 v252, v252, v251
    v_mfma_f32_16x16x32_bf16 a[144:147], a[228:231], v[228:231], a[144:147]
    v_add_f32 v217, v217, v225
    v_fmac_f32 v252, s23, v249
    v_mfma_f32_16x16x32_bf16 a[148:151], a[232:235], v[228:231], a[148:151]
    buffer_load_dwordx2 v[210:211], v215, s[4:7], s19 offen offset:1472
    v_mfma_f32_16x16x32_bf16 a[152:155], a[236:239], v[228:231], a[152:155]
    v_fmac_f32 v217, s23, v221
    v_cvt_pk_bf16_f32 v217, v252, v217
    v_mfma_f32_16x16x32_bf16 a[132:135], a[240:243], v[228:231], a[132:135]
    v_lshlrev_b32 v252, 16, v227
    v_and_b32 v227, s22, v227
    v_mfma_f32_16x16x32_bf16 a[136:139], a[244:247], v[228:231], a[136:139]
    buffer_load_dwordx2 v[212:213], v215, s[4:7], s20 offen offset:1472
    v_mfma_f32_16x16x32_bf16 a[140:143], a[248:251], v[228:231], a[140:143]
    v_add_f32 v252, v252, v248
    v_add_f32 v227, v227, v219
    v_mfma_f32_16x16x32_bf16 a[120:123], a[252:255], v[228:231], a[120:123]
    s_waitcnt lgkmcnt(1)
    v_fmac_f32 v252, s23, v250
    v_fmac_f32 v227, s23, v223
    v_mfma_f32_16x16x32_bf16 a[124:127], v[240:243], v[228:231], a[124:127]
    buffer_load_dwordx2 v[214:215], v215, s[4:7], s21 offen offset:1472
    v_mfma_f32_16x16x32_bf16 a[128:131], v[244:247], v[228:231], a[128:131]
    ds_read_b128 v[228:231], v253 offset:3392
    v_cvt_pk_bf16_f32 v227, v252, v227
    v_fma_f32 v252, v249, s24, v251
    v_mfma_f32_16x16x32_bf16 a[156:159], a[228:231], v[232:235], a[156:159]
    v_fmac_f32 v251, s25, v249
    v_fma_f32 v249, v248, s24, v250
    v_mfma_f32_16x16x32_bf16 a[160:163], a[232:235], v[232:235], a[160:163]
    v_fmac_f32 v250, s25, v248
    v_fma_f32 v248, v250, s26, v251
    v_mfma_f32_16x16x32_bf16 a[164:167], a[236:239], v[232:235], a[164:167]
    v_fmac_f32 v251, s27, v250
    v_fma_f32 v250, v249, s28, v252
    v_mfma_f32_16x16x32_bf16 a[144:147], a[240:243], v[232:235], a[144:147]
    v_fmac_f32 v252, s29, v249
    v_fma_f32 v249, v221, s24, v225
    v_mfma_f32_16x16x32_bf16 a[148:151], a[244:247], v[232:235], a[148:151]
    v_fmac_f32 v225, s25, v221
    v_fma_f32 v221, v219, s24, v223
    v_mfma_f32_16x16x32_bf16 a[152:155], a[248:251], v[232:235], a[152:155]
    v_fmac_f32 v223, s25, v219
    v_fma_f32 v219, v223, s26, v225
    v_mfma_f32_16x16x32_bf16 a[132:135], a[252:255], v[232:235], a[132:135]
    v_fmac_f32 v225, s27, v223
    v_fma_f32 v223, v221, s28, v249
    v_mfma_f32_16x16x32_bf16 a[136:139], v[240:243], v[232:235], a[136:139]
    s_waitcnt lgkmcnt(1)
    v_fmac_f32 v249, s29, v221
    v_cvt_pk_bf16_f32 v219, v248, v219
    v_mfma_f32_16x16x32_bf16 a[140:143], v[244:247], v[232:235], a[140:143]
    ds_read_b128 v[232:235], v253 offset:3136
    v_cvt_pk_bf16_f32 v225, v251, v225
    v_mfma_f32_16x16x32_bf16 a[168:171], a[228:231], v[236:239], a[168:171]
    v_cvt_pk_bf16_f32 v223, v250, v223
    v_cvt_pk_bf16_f32 v221, v252, v249
    v_lshrrev_b32 v252, 15, v255
    v_mfma_f32_16x16x32_bf16 a[172:175], a[232:235], v[236:239], a[172:175]
    ds_write_b64 v252, v[218:219] offset:8832
    v_mfma_f32_16x16x32_bf16 a[176:179], a[236:239], v[236:239], a[176:179]
    s_waitcnt vmcnt(15)
    v_lshlrev_b32 v248, 16, v194
    v_lshlrev_b32 v249, 16, v196
    v_mfma_f32_16x16x32_bf16 a[156:159], a[240:243], v[236:239], a[156:159]
    ds_write_b64 v252, v[224:225] offset:10912
    v_mfma_f32_16x16x32_bf16 a[160:163], a[244:247], v[236:239], a[160:163]
    v_lshlrev_b32 v250, 16, v198
    v_lshlrev_b32 v251, 16, v200
    v_mfma_f32_16x16x32_bf16 a[164:167], a[248:251], v[236:239], a[164:167]
    ds_write_b64 v252, v[222:223] offset:12992
    v_mfma_f32_16x16x32_bf16 a[144:147], a[252:255], v[236:239], a[144:147]
    s_waitcnt lgkmcnt(4)
    v_and_b32 v194, s22, v194
    v_and_b32 v196, s22, v196
    v_mfma_f32_16x16x32_bf16 a[148:151], v[240:243], v[236:239], a[148:151]
    ds_write_b64 v252, v[216:217] offset:23392
    v_mfma_f32_16x16x32_bf16 a[152:155], v[244:247], v[236:239], a[152:155]
    ds_read_b128 v[236:239], v253 offset:2864
    v_and_b32 v198, s22, v198
    v_mfma_f32_16x16x32_bf16 a[180:183], a[228:231], v[228:231], a[180:183]
    v_and_b32 v200, s22, v200
    v_mfma_f32_16x16x32_bf16 a[184:187], a[232:235], v[228:231], a[184:187]
    ds_write_b64 v252, v[226:227] offset:31712
    v_mfma_f32_16x16x32_bf16 a[188:191], a[236:239], v[228:231], a[188:191]
    s_mov_b32 s42, 700416
    v_mfma_f32_16x16x32_bf16 a[168:171], a[240:243], v[228:231], a[168:171]
    buffer_load_dwordx4 a[228:231], v254, s[8:11], s42 offen offset:0
    v_mfma_f32_16x16x32_bf16 a[172:175], a[244:247], v[228:231], a[172:175]
    ds_write_b64 v252, v[220:221] offset:512
    v_mfma_f32_16x16x32_bf16 a[176:179], a[248:251], v[228:231], a[176:179]
    v_mfma_f32_16x16x32_bf16 a[156:159], a[252:255], v[228:231], a[156:159]
    buffer_load_dwordx4 a[232:235], v254, s[8:11], s42 offen offset:1024
    v_mfma_f32_16x16x32_bf16 a[160:163], v[240:243], v[228:231], a[160:163]
    v_lshlrev_b32 v252, 16, v192
    v_and_b32 v192, s22, v192
    v_mfma_f32_16x16x32_bf16 a[164:167], v[244:247], v[228:231], a[164:167]
    s_waitcnt lgkmcnt(2)
    v_add_f32 v252, v252, v251
    v_add_f32 v192, v192, v200
    v_fmac_f32 v252, s23, v249
    v_mfma_f32_16x16x32_bf16 a[180:183], a[240:243], v[232:235], a[180:183]
    ds_read_b128 v[228:231], v253 offset:5200
    v_fmac_f32 v192, s23, v196
    v_mfma_f32_16x16x32_bf16 a[184:187], a[244:247], v[232:235], a[184:187]
    ds_read_b128 v[216:219], v253 offset:40480
    v_cvt_pk_bf16_f32 v192, v252, v192
    v_mfma_f32_16x16x32_bf16 a[188:191], a[248:251], v[232:235], a[188:191]
    buffer_load_dwordx4 a[236:239], v254, s[8:11], s42 offen offset:2048
    v_mfma_f32_16x16x32_bf16 a[168:171], a[252:255], v[232:235], a[168:171]
    s_mov_b32 s45, 503518347
    v_lshlrev_b32 v252, 16, v202
    v_and_b32 v202, s22, v202
    v_mfma_f32_16x16x32_bf16 a[172:175], v[240:243], v[232:235], a[172:175]
    s_mov_b32 s42, 703488
    v_add_f32 v252, v252, v248
    v_add_f32 v202, v202, v194
    v_mfma_f32_16x16x32_bf16 a[176:179], v[244:247], v[232:235], a[176:179]
    ds_read_b128 v[232:235], v253 offset:4928
    v_bfe_u32 v220, v254, 5, 3
    v_mfma_f32_16x16x32_bf16 a[180:183], a[252:255], v[236:239], a[180:183]
    buffer_load_dwordx4 a[240:243], v254, s[8:11], s42 offen offset:0
    v_fmac_f32 v252, s23, v250
    v_mfma_f32_16x16x32_bf16 a[184:187], v[240:243], v[236:239], a[184:187]
    s_waitcnt vmcnt(16) lgkmcnt(2)
    v_fmac_f32 v202, s23, v198
    v_cvt_pk_bf16_f32 v202, v252, v202
    v_mfma_f32_16x16x32_bf16 a[188:191], v[244:247], v[236:239], a[188:191]
    ds_read_b128 v[236:239], v253 offset:4672
    v_mul_u32_u24 v221, 5, v220
    v_mfma_f32_16x16x32_bf16 v[0:3], a[192:195], v[228:231], v[0:3]
    s_waitcnt lgkmcnt(1)
    v_fma_f32 v252, v249, s24, v251
    v_fmac_f32 v251, s25, v249
    v_mfma_f32_16x16x32_bf16 v[4:7], a[196:199], v[228:231], v[4:7]
    buffer_load_dwordx4 a[244:247], v254, s[8:11], s42 offen offset:1024
    v_mfma_f32_16x16x32_bf16 v[8:11], a[200:203], v[228:231], v[8:11]
    ds_read_b128 v[228:231], v253 offset:4416
    v_bfe_u32 v221, s45, v221, 5
    v_mfma_f32_16x16x32_bf16 v[12:15], a[192:195], v[232:235], v[12:15]
    v_fma_f32 v249, v248, s24, v250
    v_fmac_f32 v250, s25, v248
    v_fma_f32 v248, v250, s26, v251
    v_mfma_f32_16x16x32_bf16 v[16:19], a[196:199], v[232:235], v[16:19]
    s_waitcnt vmcnt(14)
    v_mul_u32_u24 v221, 65, v221
    v_fmac_f32 v251, s27, v250
    v_mfma_f32_16x16x32_bf16 v[20:23], a[200:203], v[232:235], v[20:23]
    buffer_load_dwordx4 a[248:251], v254, s[8:11], s42 offen offset:2048
    v_mfma_f32_16x16x32_bf16 v[0:3], a[204:207], v[232:235], v[0:3]
    s_waitcnt lgkmcnt(1)
    v_sub_u32 v221, v221, v220
    v_fma_f32 v250, v249, s28, v252
    v_mfma_f32_16x16x32_bf16 v[4:7], a[208:211], v[232:235], v[4:7]
    s_mov_b32 s42, 706560
    v_fmac_f32 v252, s29, v249
    v_fma_f32 v249, v196, s24, v200
    v_mfma_f32_16x16x32_bf16 v[8:11], a[212:215], v[232:235], v[8:11]
    ds_read_b128 v[232:235], v253 offset:4160
    v_lshl_add_u32 v220, v221, 5, v253
    v_mfma_f32_16x16x32_bf16 v[24:27], a[192:195], v[236:239], v[24:27]
    buffer_load_dwordx4 a[252:255], v254, s[8:11], s42 offen offset:0
    v_mfma_f32_16x16x32_bf16 v[28:31], a[196:199], v[236:239], v[28:31]
    v_fmac_f32 v200, s25, v196
    v_fma_f32 v196, v194, s24, v198
    v_fmac_f32 v198, s25, v194
    v_mfma_f32_16x16x32_bf16 v[32:35], a[200:203], v[236:239], v[32:35]
    v_fma_f32 v194, v198, s26, v200
    v_fmac_f32 v200, s27, v198
    v_mfma_f32_16x16x32_bf16 v[12:15], a[204:207], v[236:239], v[12:15]
    s_waitcnt vmcnt(13)
    v_fma_f32 v198, v196, s28, v249
    v_fmac_f32 v249, s29, v196
    v_mfma_f32_16x16x32_bf16 v[16:19], a[208:211], v[236:239], v[16:19]
    buffer_load_dwordx4 v[240:243], v254, s[8:11], s42 offen offset:1024
    v_mfma_f32_16x16x32_bf16 v[20:23], a[212:215], v[236:239], v[20:23]
    s_mov_b64 exec, s[46:47]
    ds_write_b128 v220, v[216:219] offset:1024
    s_mov_b64 exec, -1
    v_mfma_f32_16x16x32_bf16 v[0:3], a[216:219], v[236:239], v[0:3]
    s_waitcnt lgkmcnt(2)
    v_cvt_pk_bf16_f32 v194, v248, v194
    v_cvt_pk_bf16_f32 v200, v251, v200
    v_mfma_f32_16x16x32_bf16 v[4:7], a[220:223], v[236:239], v[4:7]
    buffer_load_dwordx4 v[244:247], v254, s[8:11], s42 offen offset:2048
    v_mfma_f32_16x16x32_bf16 v[8:11], a[224:227], v[236:239], v[8:11]
    ds_read_b128 v[236:239], v253 offset:5984
    v_and_b32 v222, 0x1f0, v254
    v_cvt_pk_bf16_f32 v198, v250, v198
    v_mfma_f32_16x16x32_bf16 v[36:39], a[192:195], v[228:231], v[36:39]
    v_mul_u32_u24 v222, 96, v222
    v_cvt_pk_bf16_f32 v196, v252, v249
    v_mfma_f32_16x16x32_bf16 v[40:43], a[196:199], v[228:231], v[40:43]
    buffer_load_dword v222, v222, s[4:7], s33 offen offset:0
    v_mfma_f32_16x16x32_bf16 v[44:47], a[200:203], v[228:231], v[44:47]
    s_add_u32 s49, s49, 8
    v_lshlrev_b32 v248, 16, v195
    v_lshlrev_b32 v249, 16, v197
    v_mfma_f32_16x16x32_bf16 v[24:27], a[204:207], v[228:231], v[24:27]
    v_lshlrev_b32 v250, 16, v199
    v_lshlrev_b32 v251, 16, v201
    v_mfma_f32_16x16x32_bf16 v[28:31], a[208:211], v[228:231], v[28:31]
    s_cmp_eq_u32 s39, 1
    s_cselect_b32 s49, 128, s49
    v_and_b32 v195, s22, v195
    v_mfma_f32_16x16x32_bf16 v[32:35], a[212:215], v[228:231], v[32:35]
    v_and_b32 v197, s22, v197
    v_and_b32 v199, s22, v199
    v_and_b32 v201, s22, v201
    v_mfma_f32_16x16x32_bf16 v[12:15], a[216:219], v[228:231], v[12:15]
    s_waitcnt lgkmcnt(2)
    v_lshlrev_b32 v252, 16, v193
    v_and_b32 v193, s22, v193
    v_mfma_f32_16x16x32_bf16 v[16:19], a[220:223], v[228:231], v[16:19]
    s_mul_i32 s43, s49, 786432
    v_add_f32 v252, v252, v251
    v_add_f32 v193, v193, v201
    v_mfma_f32_16x16x32_bf16 v[20:23], a[224:227], v[228:231], v[20:23]
    ds_read_b128 v[228:231], v253 offset:5728
    v_fmac_f32 v252, s23, v249
    v_mfma_f32_16x16x32_bf16 v[48:51], a[192:195], v[232:235], v[48:51]
    v_fmac_f32 v193, s23, v197
    v_cvt_pk_bf16_f32 v193, v252, v193
    v_mfma_f32_16x16x32_bf16 v[52:55], a[196:199], v[232:235], v[52:55]
    s_add_u32 s43, s43, s53
    v_lshlrev_b32 v252, 16, v203
    v_and_b32 v203, s22, v203
    v_mfma_f32_16x16x32_bf16 v[56:59], a[200:203], v[232:235], v[56:59]
    v_add_f32 v252, v252, v248
    v_add_f32 v203, v203, v195
    v_mfma_f32_16x16x32_bf16 v[36:39], a[204:207], v[232:235], v[36:39]
    v_fmac_f32 v252, s23, v250
    v_fmac_f32 v203, s23, v199
    v_cvt_pk_bf16_f32 v203, v252, v203
    v_mfma_f32_16x16x32_bf16 v[40:43], a[208:211], v[232:235], v[40:43]
    s_cmp_ge_u32 s49, 128
    s_cselect_b32 s43, 2130706432, s43
    v_fma_f32 v252, v249, s24, v251
    v_mfma_f32_16x16x32_bf16 v[44:47], a[212:215], v[232:235], v[44:47]
    v_fmac_f32 v251, s25, v249
    v_fma_f32 v249, v248, s24, v250
    v_mfma_f32_16x16x32_bf16 v[24:27], a[216:219], v[232:235], v[24:27]
    s_sub_u32 s16, s43, 196608
    v_fmac_f32 v250, s25, v248
    v_fma_f32 v248, v250, s26, v251
    v_mfma_f32_16x16x32_bf16 v[28:31], a[220:223], v[232:235], v[28:31]
    s_waitcnt lgkmcnt(1)
    v_fmac_f32 v251, s27, v250
    v_fma_f32 v250, v249, s28, v252
    v_mfma_f32_16x16x32_bf16 v[32:35], a[224:227], v[232:235], v[32:35]
    ds_read_b128 v[232:235], v253 offset:5472
    v_fmac_f32 v252, s29, v249
    v_mfma_f32_16x16x32_bf16 v[60:63], a[192:195], v[236:239], v[60:63]
    s_cmp_eq_u32 s49, 0
    s_cselect_b32 s16, 2130706432, s16
    v_fma_f32 v249, v197, s24, v201
    v_mfma_f32_16x16x32_bf16 v[64:67], a[196:199], v[236:239], v[64:67]
    v_fmac_f32 v201, s25, v197
    v_fma_f32 v197, v195, s24, v199
    v_fmac_f32 v199, s25, v195
    v_mfma_f32_16x16x32_bf16 v[68:71], a[200:203], v[236:239], v[68:71]
    v_fma_f32 v195, v199, s26, v201
    v_fmac_f32 v201, s27, v199
    v_mfma_f32_16x16x32_bf16 v[48:51], a[204:207], v[236:239], v[48:51]
    s_mov_b32 s17, s43
    v_fma_f32 v199, v197, s28, v249
    v_fmac_f32 v249, s29, v197
    v_mfma_f32_16x16x32_bf16 v[52:55], a[208:211], v[236:239], v[52:55]
    v_cvt_pk_bf16_f32 v195, v248, v195
    v_cvt_pk_bf16_f32 v201, v251, v201
    v_mfma_f32_16x16x32_bf16 v[56:59], a[212:215], v[236:239], v[56:59]
    s_waitcnt lgkmcnt(1)
    v_cvt_pk_bf16_f32 v199, v250, v199
    v_cvt_pk_bf16_f32 v197, v252, v249
    v_mfma_f32_16x16x32_bf16 v[36:39], a[216:219], v[236:239], v[36:39]
    s_add_u32 s18, s43, 196608
    v_lshrrev_b32 v252, 15, v255
    v_mfma_f32_16x16x32_bf16 v[40:43], a[220:223], v[236:239], v[40:43]
    ds_write_b64 v252, v[194:195] offset:8576
    s_waitcnt vmcnt(10)
    v_mfma_f32_16x16x32_bf16 v[44:47], a[224:227], v[236:239], v[44:47]
    ds_read_b128 v[236:239], v253 offset:5216
    s_add_u32 s19, s43, 393216
    v_mfma_f32_16x16x32_bf16 v[72:75], a[192:195], v[228:231], v[72:75]
    v_lshlrev_b32 v248, 16, v206
    v_lshlrev_b32 v249, 16, v208
    v_mfma_f32_16x16x32_bf16 v[76:79], a[196:199], v[228:231], v[76:79]
    ds_write_b64 v252, v[200:201] offset:10656
    v_mfma_f32_16x16x32_bf16 v[80:83], a[200:203], v[228:231], v[80:83]
    s_add_u32 s20, s43, 589824
    v_lshlrev_b32 v250, 16, v210
    v_lshlrev_b32 v251, 16, v212
    v_mfma_f32_16x16x32_bf16 v[60:63], a[204:207], v[228:231], v[60:63]
    ds_write_b64 v252, v[198:199] offset:12736
    v_mfma_f32_16x16x32_bf16 v[64:67], a[208:211], v[228:231], v[64:67]
    v_and_b32 v206, s22, v206
    v_and_b32 v208, s22, v208
    v_mfma_f32_16x16x32_bf16 v[68:71], a[212:215], v[228:231], v[68:71]
    s_add_u32 s21, s43, 786432
    v_mfma_f32_16x16x32_bf16 v[48:51], a[216:219], v[228:231], v[48:51]
    ds_write_b64 v252, v[192:193] offset:23136
    v_mfma_f32_16x16x32_bf16 v[52:55], a[220:223], v[228:231], v[52:55]
    s_waitcnt lgkmcnt(5)
    v_and_b32 v210, s22, v210
    v_and_b32 v212, s22, v212
    v_mfma_f32_16x16x32_bf16 v[56:59], a[224:227], v[228:231], v[56:59]
    ds_read_b128 v[228:231], v253 offset:4944
    s_add_u32 s100, s43, s101
    v_mfma_f32_16x16x32_bf16 v[84:87], a[192:195], v[232:235], v[84:87]
    ds_write_b64 v252, v[202:203] offset:31456
    v_mfma_f32_16x16x32_bf16 v[88:91], a[196:199], v[232:235], v[88:91]
    v_mfma_f32_16x16x32_bf16 v[92:95], a[200:203], v[232:235], v[92:95]
    s_mov_b32 s42, 737280
    v_mfma_f32_16x16x32_bf16 v[72:75], a[204:207], v[232:235], v[72:75]
    buffer_load_dwordx4 a[192:195], v254, s[8:11], s42 offen offset:0
    v_mfma_f32_16x16x32_bf16 v[76:79], a[208:211], v[232:235], v[76:79]
    ds_write_b64 v252, v[196:197] offset:256
    v_mfma_f32_16x16x32_bf16 v[80:83], a[212:215], v[232:235], v[80:83]
    v_mfma_f32_16x16x32_bf16 v[60:63], a[216:219], v[232:235], v[60:63]
    buffer_load_dwordx4 a[196:199], v254, s[8:11], s42 offen offset:1024
    v_mfma_f32_16x16x32_bf16 v[64:67], a[220:223], v[232:235], v[64:67]
    v_lshlrev_b32 v252, 16, v204
    v_and_b32 v204, s22, v204
    v_mfma_f32_16x16x32_bf16 v[68:71], a[224:227], v[232:235], v[68:71]
    s_waitcnt lgkmcnt(6)
    v_add_f32 v252, v252, v251
    v_add_f32 v204, v204, v212
    v_mfma_f32_16x16x32_bf16 v[84:87], a[204:207], v[236:239], v[84:87]
    ds_read_b128 v[232:235], v253 offset:7280
    v_fmac_f32 v252, s23, v249
    v_fmac_f32 v204, s23, v208
    v_mfma_f32_16x16x32_bf16 v[88:91], a[208:211], v[236:239], v[88:91]
    v_cvt_pk_bf16_f32 v204, v252, v204
    v_lshlrev_b32 v252, 16, v214
    v_mfma_f32_16x16x32_bf16 v[92:95], a[212:215], v[236:239], v[92:95]
    buffer_load_dwordx4 a[200:203], v254, s[8:11], s42 offen offset:2048
    v_mfma_f32_16x16x32_bf16 v[72:75], a[216:219], v[236:239], v[72:75]
    s_waitcnt lgkmcnt(3)
    v_and_b32 v214, s22, v214
    v_add_f32 v252, v252, v248
    v_mfma_f32_16x16x32_bf16 v[76:79], a[220:223], v[236:239], v[76:79]
    s_mov_b32 s42, 740352
    v_add_f32 v214, v214, v206
    v_fmac_f32 v252, s23, v250
    v_mfma_f32_16x16x32_bf16 v[80:83], a[224:227], v[236:239], v[80:83]
    ds_read_b128 v[236:239], v253 offset:7008
    v_fmac_f32 v214, s23, v210
    v_mfma_f32_16x16x32_bf16 v[84:87], a[216:219], v[228:231], v[84:87]
    buffer_load_dwordx4 a[204:207], v254, s[8:11], s42 offen offset:0
    v_mfma_f32_16x16x32_bf16 v[88:91], a[220:223], v[228:231], v[88:91]
    s_waitcnt vmcnt(11) lgkmcnt(1)
    v_cvt_pk_bf16_f32 v214, v252, v214
    v_fma_f32 v252, v249, s24, v251
    v_mfma_f32_16x16x32_bf16 v[92:95], a[224:227], v[228:231], v[92:95]
    ds_read_b128 v[228:231], v253 offset:6752
    v_fmac_f32 v251, s25, v249
    v_mfma_f32_16x16x32_bf16 v[96:99], a[228:231], v[232:235], v[96:99]
    s_waitcnt lgkmcnt(1)
    v_fma_f32 v249, v248, s24, v250
    v_fmac_f32 v250, s25, v248
    v_mfma_f32_16x16x32_bf16 v[100:103], a[232:235], v[232:235], v[100:103]
    buffer_load_dwordx4 a[208:211], v254, s[8:11], s42 offen offset:1024
    v_fma_f32 v248, v250, s26, v251
    v_mfma_f32_16x16x32_bf16 v[104:107], a[236:239], v[232:235], v[104:107]
    ds_read_b128 v[232:235], v253 offset:6496
    v_fmac_f32 v251, s27, v250
    v_mfma_f32_16x16x32_bf16 v[108:111], a[228:231], v[236:239], v[108:111]
    v_fma_f32 v250, v249, s28, v252
    v_fmac_f32 v252, s29, v249
    v_mfma_f32_16x16x32_bf16 v[112:115], a[232:235], v[236:239], v[112:115]
    s_waitcnt vmcnt(9)
    v_fma_f32 v249, v208, s24, v212
    v_fmac_f32 v212, s25, v208
    v_mfma_f32_16x16x32_bf16 v[116:119], a[236:239], v[236:239], v[116:119]
    buffer_load_dwordx4 a[212:215], v254, s[8:11], s42 offen offset:2048
    v_mfma_f32_16x16x32_bf16 v[96:99], a[240:243], v[236:239], v[96:99]
    s_waitcnt lgkmcnt(1)
    v_fma_f32 v208, v206, s24, v210
    v_fmac_f32 v210, s25, v206
    v_mfma_f32_16x16x32_bf16 v[100:103], a[244:247], v[236:239], v[100:103]
    s_mov_b32 s42, 743424
    v_fma_f32 v206, v210, s26, v212
    v_fmac_f32 v212, s27, v210
    v_mfma_f32_16x16x32_bf16 v[104:107], a[248:251], v[236:239], v[104:107]
    ds_read_b128 v[236:239], v253 offset:6240
    v_and_b32 v203, 0xf0, v254
    v_mfma_f32_16x16x32_bf16 v[120:123], a[228:231], v[228:231], v[120:123]
    buffer_load_dwordx4 a[216:219], v254, s[8:11], s42 offen offset:0
    v_mfma_f32_16x16x32_bf16 v[124:127], a[232:235], v[228:231], v[124:127]
    v_lshrrev_b32 v203, 1, v203
    v_add_u32 v203, s52, v203
    v_mfma_f32_16x16x32_bf16 v[128:131], a[236:239], v[228:231], v[128:131]
    v_mov_b32 v202, s54
    v_mov_b32 v201, s55
    v_fma_f32 v210, v208, s28, v249
    v_mfma_f32_16x16x32_bf16 v[108:111], a[240:243], v[228:231], v[108:111]
    s_waitcnt vmcnt(8)
    v_cndmask_b32 v202, v202, v201, s[56:57]
    v_add_u32 v203, v203, v202
    v_mfma_f32_16x16x32_bf16 v[112:115], a[244:247], v[228:231], v[112:115]
    buffer_load_dwordx4 a[220:223], v254, s[8:11], s42 offen offset:1024
    v_mfma_f32_16x16x32_bf16 v[116:119], a[248:251], v[228:231], v[116:119]
    s_sub_u32 s45, s16, s50
    v_fmac_f32 v249, s29, v208
    v_cvt_pk_bf16_f32 v206, v248, v206
    v_mfma_f32_16x16x32_bf16 v[96:99], a[252:255], v[228:231], v[96:99]
    s_waitcnt lgkmcnt(1)
    v_cvt_pk_bf16_f32 v212, v251, v212
    v_cvt_pk_bf16_f32 v210, v250, v210
    v_mfma_f32_16x16x32_bf16 v[100:103], v[240:243], v[228:231], v[100:103]
    buffer_load_dwordx4 a[224:227], v254, s[8:11], s42 offen offset:2048
    v_mfma_f32_16x16x32_bf16 v[104:107], v[244:247], v[228:231], v[104:107]
    ds_read_b128 v[228:231], v253 offset:8064
    v_cvt_pk_bf16_f32 v208, v252, v249
    v_mfma_f32_16x16x32_bf16 v[132:135], a[228:231], v[232:235], v[132:135]
    v_lshlrev_b32 v248, 16, v207
    v_lshlrev_b32 v249, 16, v209
    v_mfma_f32_16x16x32_bf16 v[136:139], a[232:235], v[232:235], v[136:139]
    buffer_load_dwordx2 v[192:193], v203, s[4:7], s45 offen
    v_mfma_f32_16x16x32_bf16 v[140:143], a[236:239], v[232:235], v[140:143]
    s_sub_u32 s45, s17, s50
    v_lshlrev_b32 v250, 16, v211
    v_lshlrev_b32 v251, 16, v213
    v_mfma_f32_16x16x32_bf16 v[120:123], a[240:243], v[232:235], v[120:123]
    v_and_b32 v207, s22, v207
    v_and_b32 v209, s22, v209
    v_and_b32 v211, s22, v211
    v_mfma_f32_16x16x32_bf16 v[124:127], a[244:247], v[232:235], v[124:127]
    buffer_load_dwordx2 v[194:195], v203, s[4:7], s45 offen
    v_mfma_f32_16x16x32_bf16 v[128:131], a[248:251], v[232:235], v[128:131]
    s_sub_u32 s45, s18, s50
    v_and_b32 v213, s22, v213
    v_lshlrev_b32 v252, 16, v205
    v_mfma_f32_16x16x32_bf16 v[108:111], a[252:255], v[232:235], v[108:111]
    s_waitcnt lgkmcnt(1)
    v_and_b32 v205, s22, v205
    v_add_f32 v252, v252, v251
    v_mfma_f32_16x16x32_bf16 v[112:115], v[240:243], v[232:235], v[112:115]
    buffer_load_dwordx2 v[196:197], v203, s[4:7], s45 offen
    v_mfma_f32_16x16x32_bf16 v[116:119], v[244:247], v[232:235], v[116:119]
    ds_read_b128 v[232:235], v253 offset:7808
    s_sub_u32 s45, s19, s50
    v_mfma_f32_16x16x32_bf16 v[144:147], a[228:231], v[236:239], v[144:147]
    v_add_f32 v205, v205, v213
    v_fmac_f32 v252, s23, v249
    v_mfma_f32_16x16x32_bf16 v[148:151], a[232:235], v[236:239], v[148:151]
    buffer_load_dwordx2 v[198:199], v203, s[4:7], s45 offen
    v_mfma_f32_16x16x32_bf16 v[152:155], a[236:239], v[236:239], v[152:155]
    s_sub_u32 s45, s20, s50
    v_fmac_f32 v205, s23, v209
    v_cvt_pk_bf16_f32 v205, v252, v205
    v_mfma_f32_16x16x32_bf16 v[132:135], a[240:243], v[236:239], v[132:135]
    v_lshlrev_b32 v252, 16, v215
    v_and_b32 v215, s22, v215
    v_mfma_f32_16x16x32_bf16 v[136:139], a[244:247], v[236:239], v[136:139]
    buffer_load_dwordx2 v[200:201], v203, s[4:7], s45 offen
    v_add_f32 v252, v252, v248
    v_mfma_f32_16x16x32_bf16 v[140:143], a[248:251], v[236:239], v[140:143]
    s_sub_u32 s45, s21, s50
    v_add_f32 v215, v215, v207
    v_fmac_f32 v252, s23, v250
    v_mfma_f32_16x16x32_bf16 v[120:123], a[252:255], v[236:239], v[120:123]
    s_waitcnt lgkmcnt(1)
    v_fmac_f32 v215, s23, v211
    v_cvt_pk_bf16_f32 v215, v252, v215
    v_mfma_f32_16x16x32_bf16 v[124:127], v[240:243], v[236:239], v[124:127]
    buffer_load_dwordx2 v[202:203], v203, s[4:7], s45 offen
    v_mfma_f32_16x16x32_bf16 v[128:131], v[244:247], v[236:239], v[128:131]
    ds_read_b128 v[236:239], v253 offset:7552
    v_fma_f32 v252, v249, s24, v251
    v_mfma_f32_16x16x32_bf16 v[156:159], a[228:231], v[228:231], v[156:159]
    v_fmac_f32 v251, s25, v249
    v_fma_f32 v249, v248, s24, v250
    v_mfma_f32_16x16x32_bf16 v[160:163], a[232:235], v[228:231], v[160:163]
    v_fmac_f32 v250, s25, v248
    v_fma_f32 v248, v250, s26, v251
    v_mfma_f32_16x16x32_bf16 v[164:167], a[236:239], v[228:231], v[164:167]
    v_fmac_f32 v251, s27, v250
    v_fma_f32 v250, v249, s28, v252
    v_mfma_f32_16x16x32_bf16 v[144:147], a[240:243], v[228:231], v[144:147]
    v_fmac_f32 v252, s29, v249
    v_fma_f32 v249, v209, s24, v213
    v_mfma_f32_16x16x32_bf16 v[148:151], a[244:247], v[228:231], v[148:151]
    v_fmac_f32 v213, s25, v209
    v_fma_f32 v209, v207, s24, v211
    v_mfma_f32_16x16x32_bf16 v[152:155], a[248:251], v[228:231], v[152:155]
    v_fmac_f32 v211, s25, v207
    v_fma_f32 v207, v211, s26, v213
    v_fmac_f32 v213, s27, v211
    v_mfma_f32_16x16x32_bf16 v[132:135], a[252:255], v[228:231], v[132:135]
    v_fma_f32 v211, v209, s28, v249
    v_fmac_f32 v249, s29, v209
    v_mfma_f32_16x16x32_bf16 v[136:139], v[240:243], v[228:231], v[136:139]
    s_waitcnt lgkmcnt(1)
    v_cvt_pk_bf16_f32 v207, v248, v207
    v_cvt_pk_bf16_f32 v213, v251, v213
    v_mfma_f32_16x16x32_bf16 v[140:143], v[244:247], v[228:231], v[140:143]
    ds_read_b128 v[228:231], v253 offset:7296
    v_cvt_pk_bf16_f32 v211, v250, v211
    v_mfma_f32_16x16x32_bf16 v[168:171], a[228:231], v[232:235], v[168:171]
    v_cvt_pk_bf16_f32 v209, v252, v249
    v_lshrrev_b32 v252, 15, v255
    v_mfma_f32_16x16x32_bf16 v[172:175], a[232:235], v[232:235], v[172:175]
    ds_write_b64 v252, v[206:207] offset:8320
    v_mfma_f32_16x16x32_bf16 v[176:179], a[236:239], v[232:235], v[176:179]
    v_mfma_f32_16x16x32_bf16 v[156:159], a[240:243], v[232:235], v[156:159]
    ds_write_b64 v252, v[212:213] offset:10400
    v_mfma_f32_16x16x32_bf16 v[160:163], a[244:247], v[232:235], v[160:163]
    v_mfma_f32_16x16x32_bf16 v[164:167], a[248:251], v[232:235], v[164:167]
    ds_write_b64 v252, v[210:211] offset:12480
    v_mfma_f32_16x16x32_bf16 v[144:147], a[252:255], v[232:235], v[144:147]
    s_waitcnt lgkmcnt(4)
    v_mfma_f32_16x16x32_bf16 v[148:151], v[240:243], v[232:235], v[148:151]
    ds_write_b64 v252, v[204:205] offset:22880
    v_mfma_f32_16x16x32_bf16 v[152:155], v[244:247], v[232:235], v[152:155]
    ds_read_b128 v[232:235], v253 offset:7024
    v_mfma_f32_16x16x32_bf16 v[180:183], a[228:231], v[236:239], v[180:183]
    ds_write_b64 v252, v[214:215] offset:31200
    v_mfma_f32_16x16x32_bf16 v[184:187], a[232:235], v[236:239], v[184:187]
    v_mfma_f32_16x16x32_bf16 v[188:191], a[236:239], v[236:239], v[188:191]
    s_mov_b32 s42, 774144
    v_mfma_f32_16x16x32_bf16 v[168:171], a[240:243], v[236:239], v[168:171]
    buffer_load_dwordx4 a[228:231], v254, s[8:11], s42 offen offset:0
    v_mfma_f32_16x16x32_bf16 v[172:175], a[244:247], v[236:239], v[172:175]
    ds_write_b64 v252, v[208:209] offset:0
    v_mfma_f32_16x16x32_bf16 v[176:179], a[248:251], v[236:239], v[176:179]
    s_waitcnt lgkmcnt(7)
    v_mfma_f32_16x16x32_bf16 v[156:159], a[252:255], v[236:239], v[156:159]
    buffer_load_dwordx4 a[232:235], v254, s[8:11], s42 offen offset:1024
    v_mfma_f32_16x16x32_bf16 v[160:163], v[240:243], v[236:239], v[160:163]
    s_waitcnt lgkmcnt(0)
    v_mfma_f32_16x16x32_bf16 v[164:167], v[244:247], v[236:239], v[164:167]
    s_barrier
    v_mfma_f32_16x16x32_bf16 v[180:183], a[240:243], v[228:231], v[180:183]
    ds_read_b128 v[236:239], v253 offset:9360
    v_mfma_f32_16x16x32_bf16 v[184:187], a[244:247], v[228:231], v[184:187]
    v_mfma_f32_16x16x32_bf16 v[188:191], a[248:251], v[228:231], v[188:191]
    buffer_load_dwordx4 a[236:239], v254, s[8:11], s42 offen offset:2048
    v_mfma_f32_16x16x32_bf16 v[168:171], a[252:255], v[228:231], v[168:171]
    v_mfma_f32_16x16x32_bf16 v[172:175], v[240:243], v[228:231], v[172:175]
    s_mov_b32 s42, 777216
    v_mfma_f32_16x16x32_bf16 v[176:179], v[244:247], v[228:231], v[176:179]
    ds_read_b128 v[228:231], v253 offset:9088
    v_mfma_f32_16x16x32_bf16 v[180:183], a[252:255], v[232:235], v[180:183]
    buffer_load_dwordx4 a[240:243], v254, s[8:11], s42 offen offset:0
    v_mfma_f32_16x16x32_bf16 v[184:187], v[240:243], v[232:235], v[184:187]
    s_waitcnt vmcnt(16) lgkmcnt(1)
    v_mfma_f32_16x16x32_bf16 v[188:191], v[244:247], v[232:235], v[188:191]
    ds_read_b128 v[232:235], v253 offset:8832
    v_mfma_f32_16x16x32_bf16 a[0:3], a[192:195], v[236:239], a[0:3]
    s_waitcnt lgkmcnt(1)
    v_mfma_f32_16x16x32_bf16 a[4:7], a[196:199], v[236:239], a[4:7]
    buffer_load_dwordx4 a[244:247], v254, s[8:11], s42 offen offset:1024
    v_mfma_f32_16x16x32_bf16 a[8:11], a[200:203], v[236:239], a[8:11]
    ds_read_b128 v[236:239], v253 offset:8576
    v_mfma_f32_16x16x32_bf16 a[12:15], a[192:195], v[228:231], a[12:15]
    v_mfma_f32_16x16x32_bf16 a[16:19], a[196:199], v[228:231], a[16:19]
    s_waitcnt vmcnt(14)
    v_mfma_f32_16x16x32_bf16 a[20:23], a[200:203], v[228:231], a[20:23]
    buffer_load_dwordx4 a[248:251], v254, s[8:11], s42 offen offset:2048
    v_mfma_f32_16x16x32_bf16 a[0:3], a[204:207], v[228:231], a[0:3]
    s_waitcnt lgkmcnt(1)
    v_mfma_f32_16x16x32_bf16 a[4:7], a[208:211], v[228:231], a[4:7]
    s_mov_b32 s42, 780288
    v_mfma_f32_16x16x32_bf16 a[8:11], a[212:215], v[228:231], a[8:11]
    ds_read_b128 v[228:231], v253 offset:8320
    v_mfma_f32_16x16x32_bf16 a[24:27], a[192:195], v[232:235], a[24:27]
    buffer_load_dwordx4 a[252:255], v254, s[8:11], s42 offen offset:0
    v_mfma_f32_16x16x32_bf16 a[28:31], a[196:199], v[232:235], a[28:31]
    v_mfma_f32_16x16x32_bf16 a[32:35], a[200:203], v[232:235], a[32:35]
    v_mfma_f32_16x16x32_bf16 a[12:15], a[204:207], v[232:235], a[12:15]
    v_mfma_f32_16x16x32_bf16 a[16:19], a[208:211], v[232:235], a[16:19]
    buffer_load_dwordx4 v[240:243], v254, s[8:11], s42 offen offset:1024
    v_mfma_f32_16x16x32_bf16 a[20:23], a[212:215], v[232:235], a[20:23]
    s_waitcnt vmcnt(14)
    v_mfma_f32_16x16x32_bf16 a[0:3], a[216:219], v[232:235], a[0:3]
    s_waitcnt lgkmcnt(1)
    v_mfma_f32_16x16x32_bf16 a[4:7], a[220:223], v[232:235], a[4:7]
    buffer_load_dwordx4 v[244:247], v254, s[8:11], s42 offen offset:2048
    v_mfma_f32_16x16x32_bf16 a[8:11], a[224:227], v[232:235], a[8:11]
    ds_read_b128 v[232:235], v253 offset:10144
    v_and_b32 v226, 0x1f0, v254
    v_mfma_f32_16x16x32_bf16 a[36:39], a[192:195], v[236:239], a[36:39]
    v_mul_u32_u24 v226, 96, v226
    v_mfma_f32_16x16x32_bf16 a[40:43], a[196:199], v[236:239], a[40:43]
    buffer_load_dword v226, v226, s[4:7], s33 offen offset:384
    v_mfma_f32_16x16x32_bf16 a[44:47], a[200:203], v[236:239], a[44:47]
    v_mfma_f32_16x16x32_bf16 a[24:27], a[204:207], v[236:239], a[24:27]
    v_mfma_f32_16x16x32_bf16 a[28:31], a[208:211], v[236:239], a[28:31]
    v_mfma_f32_16x16x32_bf16 a[32:35], a[212:215], v[236:239], a[32:35]
    v_mfma_f32_16x16x32_bf16 a[12:15], a[216:219], v[236:239], a[12:15]
    v_mfma_f32_16x16x32_bf16 a[16:19], a[220:223], v[236:239], a[16:19]
    s_waitcnt lgkmcnt(1)
    v_mfma_f32_16x16x32_bf16 a[20:23], a[224:227], v[236:239], a[20:23]
    ds_read_b128 v[236:239], v253 offset:9888
    v_mfma_f32_16x16x32_bf16 a[48:51], a[192:195], v[228:231], a[48:51]
    v_mfma_f32_16x16x32_bf16 a[52:55], a[196:199], v[228:231], a[52:55]
    v_mfma_f32_16x16x32_bf16 a[56:59], a[200:203], v[228:231], a[56:59]
    v_mfma_f32_16x16x32_bf16 a[36:39], a[204:207], v[228:231], a[36:39]
    v_mfma_f32_16x16x32_bf16 a[40:43], a[208:211], v[228:231], a[40:43]
    v_mfma_f32_16x16x32_bf16 a[44:47], a[212:215], v[228:231], a[44:47]
    v_mfma_f32_16x16x32_bf16 a[24:27], a[216:219], v[228:231], a[24:27]
    v_mfma_f32_16x16x32_bf16 a[28:31], a[220:223], v[228:231], a[28:31]
    s_waitcnt lgkmcnt(1)
    v_mfma_f32_16x16x32_bf16 a[32:35], a[224:227], v[228:231], a[32:35]
    ds_read_b128 v[228:231], v253 offset:9632
    v_mfma_f32_16x16x32_bf16 a[60:63], a[192:195], v[232:235], a[60:63]
    v_mfma_f32_16x16x32_bf16 a[64:67], a[196:199], v[232:235], a[64:67]
    v_mfma_f32_16x16x32_bf16 a[68:71], a[200:203], v[232:235], a[68:71]
    v_mfma_f32_16x16x32_bf16 a[48:51], a[204:207], v[232:235], a[48:51]
    v_mfma_f32_16x16x32_bf16 a[52:55], a[208:211], v[232:235], a[52:55]
    v_mfma_f32_16x16x32_bf16 a[56:59], a[212:215], v[232:235], a[56:59]
    v_mfma_f32_16x16x32_bf16 a[36:39], a[216:219], v[232:235], a[36:39]
    v_mfma_f32_16x16x32_bf16 a[40:43], a[220:223], v[232:235], a[40:43]
    s_waitcnt lgkmcnt(1)
    v_mfma_f32_16x16x32_bf16 a[44:47], a[224:227], v[232:235], a[44:47]
    ds_read_b128 v[232:235], v253 offset:9376
    v_mfma_f32_16x16x32_bf16 a[72:75], a[192:195], v[236:239], a[72:75]
    v_mfma_f32_16x16x32_bf16 a[76:79], a[196:199], v[236:239], a[76:79]
    v_mfma_f32_16x16x32_bf16 a[80:83], a[200:203], v[236:239], a[80:83]
    v_mfma_f32_16x16x32_bf16 a[60:63], a[204:207], v[236:239], a[60:63]
    v_mfma_f32_16x16x32_bf16 a[64:67], a[208:211], v[236:239], a[64:67]
    v_mfma_f32_16x16x32_bf16 a[68:71], a[212:215], v[236:239], a[68:71]
    v_mfma_f32_16x16x32_bf16 a[48:51], a[216:219], v[236:239], a[48:51]
    v_mfma_f32_16x16x32_bf16 a[52:55], a[220:223], v[236:239], a[52:55]
    s_waitcnt lgkmcnt(1)
    v_mfma_f32_16x16x32_bf16 a[56:59], a[224:227], v[236:239], a[56:59]
    ds_read_b128 v[236:239], v253 offset:9104
    v_mfma_f32_16x16x32_bf16 a[84:87], a[192:195], v[228:231], a[84:87]
    v_mfma_f32_16x16x32_bf16 a[88:91], a[196:199], v[228:231], a[88:91]
    v_mfma_f32_16x16x32_bf16 a[92:95], a[200:203], v[228:231], a[92:95]
    s_mov_b32 s42, 811008
    v_mfma_f32_16x16x32_bf16 a[72:75], a[204:207], v[228:231], a[72:75]
    buffer_load_dwordx4 a[192:195], v254, s[8:11], s42 offen offset:0
    v_mfma_f32_16x16x32_bf16 a[76:79], a[208:211], v[228:231], a[76:79]
    v_mfma_f32_16x16x32_bf16 a[80:83], a[212:215], v[228:231], a[80:83]
    v_mfma_f32_16x16x32_bf16 a[60:63], a[216:219], v[228:231], a[60:63]
    buffer_load_dwordx4 a[196:199], v254, s[8:11], s42 offen offset:1024
    v_mfma_f32_16x16x32_bf16 a[64:67], a[220:223], v[228:231], a[64:67]
    v_mfma_f32_16x16x32_bf16 a[68:71], a[224:227], v[228:231], a[68:71]
    s_waitcnt lgkmcnt(1)
    v_mfma_f32_16x16x32_bf16 a[84:87], a[204:207], v[232:235], a[84:87]
    ds_read_b128 v[228:231], v253 offset:11440
    s_waitcnt vmcnt(12)
    v_mfma_f32_16x16x32_bf16 a[88:91], a[208:211], v[232:235], a[88:91]
    v_lshlrev_b32 v248, 16, v194
    v_lshlrev_b32 v249, 16, v196
    v_mfma_f32_16x16x32_bf16 a[92:95], a[212:215], v[232:235], a[92:95]
    buffer_load_dwordx4 a[200:203], v254, s[8:11], s42 offen offset:2048
    v_mfma_f32_16x16x32_bf16 a[72:75], a[216:219], v[232:235], a[72:75]
    s_waitcnt lgkmcnt(1)
    v_lshlrev_b32 v250, 16, v198
    v_lshlrev_b32 v251, 16, v200
    v_mfma_f32_16x16x32_bf16 a[76:79], a[220:223], v[232:235], a[76:79]
    s_mov_b32 s42, 814080
    v_and_b32 v194, s22, v194
    v_and_b32 v196, s22, v196
    v_mfma_f32_16x16x32_bf16 a[80:83], a[224:227], v[232:235], a[80:83]
    ds_read_b128 v[232:235], v253 offset:11168
    v_and_b32 v198, s22, v198
    v_mfma_f32_16x16x32_bf16 a[84:87], a[216:219], v[236:239], a[84:87]
    buffer_load_dwordx4 a[204:207], v254, s[8:11], s42 offen offset:0
    v_mfma_f32_16x16x32_bf16 a[88:91], a[220:223], v[236:239], a[88:91]
    s_waitcnt vmcnt(11) lgkmcnt(1)
    v_and_b32 v200, s22, v200
    v_lshlrev_b32 v252, 16, v192
    v_mfma_f32_16x16x32_bf16 a[92:95], a[224:227], v[236:239], a[92:95]
    ds_read_b128 v[236:239], v253 offset:10912
    v_and_b32 v192, s22, v192
    v_mfma_f32_16x16x32_bf16 a[96:99], a[228:231], v[228:231], a[96:99]
    s_waitcnt lgkmcnt(1)
    v_add_f32 v252, v252, v251
    v_add_f32 v192, v192, v200
    v_mfma_f32_16x16x32_bf16 a[100:103], a[232:235], v[228:231], a[100:103]
    buffer_load_dwordx4 a[208:211], v254, s[8:11], s42 offen offset:1024
    v_mfma_f32_16x16x32_bf16 a[104:107], a[236:239], v[228:231], a[104:107]
    ds_read_b128 v[228:231], v253 offset:10656
    v_fmac_f32 v252, s23, v249
    v_mfma_f32_16x16x32_bf16 a[108:111], a[228:231], v[232:235], a[108:111]
    v_fmac_f32 v192, s23, v196
    v_cvt_pk_bf16_f32 v192, v252, v192
    v_mfma_f32_16x16x32_bf16 a[112:115], a[232:235], v[232:235], a[112:115]
    s_waitcnt vmcnt(9)
    v_lshlrev_b32 v252, 16, v202
    v_and_b32 v202, s22, v202
    v_mfma_f32_16x16x32_bf16 a[116:119], a[236:239], v[232:235], a[116:119]
    buffer_load_dwordx4 a[212:215], v254, s[8:11], s42 offen offset:2048
    v_mfma_f32_16x16x32_bf16 a[96:99], a[240:243], v[232:235], a[96:99]
    s_waitcnt lgkmcnt(1)
    v_add_f32 v252, v252, v248
    v_add_f32 v202, v202, v194
    v_mfma_f32_16x16x32_bf16 a[100:103], a[244:247], v[232:235], a[100:103]
    s_mov_b32 s42, 817152
    v_fmac_f32 v252, s23, v250
    v_fmac_f32 v202, s23, v198
    v_mfma_f32_16x16x32_bf16 a[104:107], a[248:251], v[232:235], a[104:107]
    ds_read_b128 v[232:235], v253 offset:10400
    v_cvt_pk_bf16_f32 v202, v252, v202
    v_mfma_f32_16x16x32_bf16 a[120:123], a[228:231], v[236:239], a[120:123]
    buffer_load_dwordx4 a[216:219], v254, s[8:11], s42 offen offset:0
    v_mfma_f32_16x16x32_bf16 a[124:127], a[232:235], v[236:239], a[124:127]
    v_fma_f32 v252, v249, s24, v251
    v_fmac_f32 v251, s25, v249
    v_mfma_f32_16x16x32_bf16 a[128:131], a[236:239], v[236:239], a[128:131]
    v_fma_f32 v249, v248, s24, v250
    v_fmac_f32 v250, s25, v248
    v_mfma_f32_16x16x32_bf16 a[108:111], a[240:243], v[236:239], a[108:111]
    v_fma_f32 v248, v250, s26, v251
    v_fmac_f32 v251, s27, v250
    v_mfma_f32_16x16x32_bf16 a[112:115], a[244:247], v[236:239], a[112:115]
    buffer_load_dwordx4 a[220:223], v254, s[8:11], s42 offen offset:1024
    v_mfma_f32_16x16x32_bf16 a[116:119], a[248:251], v[236:239], a[116:119]
    s_waitcnt vmcnt(9)
    v_fma_f32 v250, v249, s28, v252
    v_fmac_f32 v252, s29, v249
    v_mfma_f32_16x16x32_bf16 a[96:99], a[252:255], v[236:239], a[96:99]
    s_waitcnt lgkmcnt(1)
    v_fma_f32 v249, v196, s24, v200
    v_fmac_f32 v200, s25, v196
    v_mfma_f32_16x16x32_bf16 a[100:103], v[240:243], v[236:239], a[100:103]
    buffer_load_dwordx4 a[224:227], v254, s[8:11], s42 offen offset:2048
    v_mfma_f32_16x16x32_bf16 a[104:107], v[244:247], v[236:239], a[104:107]
    ds_read_b128 v[236:239], v253 offset:12224
    v_and_b32 v222, 0x1f0, v254
    v_mfma_f32_16x16x32_bf16 a[132:135], a[228:231], v[228:231], a[132:135]
    v_mul_u32_u24 v222, 96, v222
    v_fma_f32 v196, v194, s24, v198
    v_mfma_f32_16x16x32_bf16 a[136:139], a[232:235], v[228:231], a[136:139]
    buffer_load_dword v222, v222, s[4:7], s33 offen offset:768
    v_mfma_f32_16x16x32_bf16 a[140:143], a[236:239], v[228:231], a[140:143]
    v_fmac_f32 v198, s25, v194
    v_fma_f32 v194, v198, s26, v200
    v_mfma_f32_16x16x32_bf16 a[120:123], a[240:243], v[228:231], a[120:123]
    v_fmac_f32 v200, s27, v198
    v_fma_f32 v198, v196, s28, v249
    v_mfma_f32_16x16x32_bf16 a[124:127], a[244:247], v[228:231], a[124:127]
    v_fmac_f32 v249, s29, v196
    v_cvt_pk_bf16_f32 v194, v248, v194
    v_mfma_f32_16x16x32_bf16 a[128:131], a[248:251], v[228:231], a[128:131]
    v_cvt_pk_bf16_f32 v200, v251, v200
    v_cvt_pk_bf16_f32 v198, v250, v198
    v_mfma_f32_16x16x32_bf16 a[108:111], a[252:255], v[228:231], a[108:111]
    v_cvt_pk_bf16_f32 v196, v252, v249
    v_lshlrev_b32 v248, 16, v195
    v_mfma_f32_16x16x32_bf16 a[112:115], v[240:243], v[228:231], a[112:115]
    s_waitcnt lgkmcnt(1)
    v_lshlrev_b32 v249, 16, v197
    v_lshlrev_b32 v250, 16, v199
    v_mfma_f32_16x16x32_bf16 a[116:119], v[244:247], v[228:231], a[116:119]
    ds_read_b128 v[228:231], v253 offset:11968
    v_lshlrev_b32 v251, 16, v201
    v_mfma_f32_16x16x32_bf16 a[144:147], a[228:231], v[232:235], a[144:147]
    v_and_b32 v195, s22, v195
    v_and_b32 v197, s22, v197
    v_mfma_f32_16x16x32_bf16 a[148:151], a[232:235], v[232:235], a[148:151]
    v_and_b32 v199, s22, v199
    v_and_b32 v201, s22, v201
    v_mfma_f32_16x16x32_bf16 a[152:155], a[236:239], v[232:235], a[152:155]
    v_lshlrev_b32 v252, 16, v193
    v_and_b32 v193, s22, v193
    v_mfma_f32_16x16x32_bf16 a[132:135], a[240:243], v[232:235], a[132:135]
    v_add_f32 v252, v252, v251
    v_add_f32 v193, v193, v201
    v_mfma_f32_16x16x32_bf16 a[136:139], a[244:247], v[232:235], a[136:139]
    v_fmac_f32 v252, s23, v249
    v_fmac_f32 v193, s23, v197
    v_mfma_f32_16x16x32_bf16 a[140:143], a[248:251], v[232:235], a[140:143]
    v_cvt_pk_bf16_f32 v193, v252, v193
    v_lshlrev_b32 v252, 16, v203
    v_mfma_f32_16x16x32_bf16 a[120:123], a[252:255], v[232:235], a[120:123]
    v_and_b32 v203, s22, v203
    v_add_f32 v252, v252, v248
    v_mfma_f32_16x16x32_bf16 a[124:127], v[240:243], v[232:235], a[124:127]
    s_waitcnt lgkmcnt(1)
    v_add_f32 v203, v203, v195
    v_fmac_f32 v252, s23, v250
    v_mfma_f32_16x16x32_bf16 a[128:131], v[244:247], v[232:235], a[128:131]
    ds_read_b128 v[232:235], v253 offset:11712
    v_fmac_f32 v203, s23, v199
    v_mfma_f32_16x16x32_bf16 a[156:159], a[228:231], v[236:239], a[156:159]
    v_cvt_pk_bf16_f32 v203, v252, v203
    v_fma_f32 v252, v249, s24, v251
    v_mfma_f32_16x16x32_bf16 a[160:163], a[232:235], v[236:239], a[160:163]
    v_fmac_f32 v251, s25, v249
    v_fma_f32 v249, v248, s24, v250
    v_mfma_f32_16x16x32_bf16 a[164:167], a[236:239], v[236:239], a[164:167]
    v_fmac_f32 v250, s25, v248
    v_fma_f32 v248, v250, s26, v251
    v_mfma_f32_16x16x32_bf16 a[144:147], a[240:243], v[236:239], a[144:147]
    v_fmac_f32 v251, s27, v250
    v_fma_f32 v250, v249, s28, v252
    v_mfma_f32_16x16x32_bf16 a[148:151], a[244:247], v[236:239], a[148:151]
    v_fmac_f32 v252, s29, v249
    v_fma_f32 v249, v197, s24, v201
    v_mfma_f32_16x16x32_bf16 a[152:155], a[248:251], v[236:239], a[152:155]
    v_fmac_f32 v201, s25, v197
    v_mfma_f32_16x16x32_bf16 a[132:135], a[252:255], v[236:239], a[132:135]
    v_fma_f32 v197, v195, s24, v199
    v_fmac_f32 v199, s25, v195
    v_mfma_f32_16x16x32_bf16 a[136:139], v[240:243], v[236:239], a[136:139]
    s_waitcnt lgkmcnt(1)
    v_fma_f32 v195, v199, s26, v201
    v_mfma_f32_16x16x32_bf16 a[140:143], v[244:247], v[236:239], a[140:143]
    ds_read_b128 v[236:239], v253 offset:11456
    v_fmac_f32 v201, s27, v199
    v_mfma_f32_16x16x32_bf16 a[168:171], a[228:231], v[228:231], a[168:171]
    v_fma_f32 v199, v197, s28, v249
    v_fmac_f32 v249, s29, v197
    v_mfma_f32_16x16x32_bf16 a[172:175], a[232:235], v[228:231], a[172:175]
    v_cvt_pk_bf16_f32 v195, v248, v195
    v_cvt_pk_bf16_f32 v201, v251, v201
    v_mfma_f32_16x16x32_bf16 a[176:179], a[236:239], v[228:231], a[176:179]
    v_cvt_pk_bf16_f32 v199, v250, v199
    v_mfma_f32_16x16x32_bf16 a[156:159], a[240:243], v[228:231], a[156:159]
    v_cvt_pk_bf16_f32 v197, v252, v249
    v_and_b32 v248, 0xf0, v254
    v_mfma_f32_16x16x32_bf16 a[160:163], a[244:247], v[228:231], a[160:163]
    v_lshrrev_b32 v248, 1, v248
    v_mfma_f32_16x16x32_bf16 a[164:167], a[248:251], v[228:231], a[164:167]
    v_add_u32 v248, s52, v248
    v_and_b32 v252, 8, v248
    v_mfma_f32_16x16x32_bf16 a[144:147], a[252:255], v[228:231], a[144:147]
    v_lshrrev_b32 v249, 6, v248
    v_mfma_f32_16x16x32_bf16 a[148:151], v[240:243], v[228:231], a[148:151]
    s_waitcnt lgkmcnt(1)
    v_mul_u32_u24 v249, 192, v249
    v_add_u32 v252, v252, v249
    v_mfma_f32_16x16x32_bf16 a[152:155], v[244:247], v[228:231], a[152:155]
    ds_read_b128 v[228:231], v253 offset:11184
    v_bfe_u32 v249, v248, 4, 2
    v_mfma_f32_16x16x32_bf16 a[180:183], a[228:231], v[232:235], a[180:183]
    v_mul_u32_u24 v249, 40704, v249
    v_add_u32 v252, v252, v249
    v_mfma_f32_16x16x32_bf16 a[184:187], a[232:235], v[232:235], a[184:187]
    v_and_b32 v249, 32, v248
    v_mfma_f32_16x16x32_bf16 a[188:191], a[236:239], v[232:235], a[188:191]
    s_mov_b32 s42, 847872
    v_lshl_add_u32 v252, v249, 1, v252
    v_bfe_u32 v249, v254, 8, 1
    v_mfma_f32_16x16x32_bf16 a[168:171], a[240:243], v[232:235], a[168:171]
    buffer_load_dwordx4 a[228:231], v254, s[8:11], s42 offen offset:0
    v_mfma_f32_16x16x32_bf16 a[172:175], a[244:247], v[232:235], a[172:175]
    v_lshl_add_u32 v252, v249, 4, v252
    v_mov_b32 v249, 123328
    v_mfma_f32_16x16x32_bf16 a[176:179], a[248:251], v[232:235], a[176:179]
    v_cndmask_b32 v252, v249, v252, s[58:59]
    v_mfma_f32_16x16x32_bf16 a[156:159], a[252:255], v[232:235], a[156:159]
    buffer_load_dwordx4 a[232:235], v254, s[8:11], s42 offen offset:1024
    v_mfma_f32_16x16x32_bf16 a[160:163], v[240:243], v[232:235], a[160:163]
    ds_write_b64 v252, v[192:193] offset:39520
    v_mfma_f32_16x16x32_bf16 a[164:167], v[244:247], v[232:235], a[164:167]
    s_waitcnt lgkmcnt(1)
    v_mfma_f32_16x16x32_bf16 a[180:183], a[240:243], v[236:239], a[180:183]
    ds_read_b128 v[232:235], v253 offset:13520
    v_mfma_f32_16x16x32_bf16 a[184:187], a[244:247], v[236:239], a[184:187]
    ds_write_b64 v252, v[194:195] offset:39552
    v_mfma_f32_16x16x32_bf16 a[188:191], a[248:251], v[236:239], a[188:191]
    buffer_load_dwordx4 a[236:239], v254, s[8:11], s42 offen offset:2048
    v_mfma_f32_16x16x32_bf16 a[168:171], a[252:255], v[236:239], a[168:171]
    ds_write_b64 v252, v[200:201] offset:39584
    v_mfma_f32_16x16x32_bf16 a[172:175], v[240:243], v[236:239], a[172:175]
    s_mov_b32 s42, 850944
    v_mfma_f32_16x16x32_bf16 a[176:179], v[244:247], v[236:239], a[176:179]
    ds_read_b128 v[236:239], v253 offset:13248
    v_mfma_f32_16x16x32_bf16 a[180:183], a[252:255], v[228:231], a[180:183]
    buffer_load_dwordx4 a[240:243], v254, s[8:11], s42 offen offset:0
    v_mfma_f32_16x16x32_bf16 a[184:187], v[240:243], v[228:231], a[184:187]
    ds_write_b64 v252, v[198:199] offset:39616
    v_mfma_f32_16x16x32_bf16 a[188:191], v[244:247], v[228:231], a[188:191]
    ds_read_b128 v[228:231], v253 offset:12992
    s_waitcnt vmcnt(11)
    s_waitcnt lgkmcnt(5)
    v_mfma_f32_16x16x32_bf16 v[0:3], a[192:195], v[232:235], v[0:3]
    ds_write_b64 v252, v[196:197] offset:39648
    v_mfma_f32_16x16x32_bf16 v[4:7], a[196:199], v[232:235], v[4:7]
    buffer_load_dwordx4 a[244:247], v254, s[8:11], s42 offen offset:1024
    v_mfma_f32_16x16x32_bf16 v[8:11], a[200:203], v[232:235], v[8:11]
    ds_read_b128 v[232:235], v253 offset:12736
    s_waitcnt lgkmcnt(4)
    v_mfma_f32_16x16x32_bf16 v[12:15], a[192:195], v[236:239], v[12:15]
    ds_write_b64 v252, v[202:203] offset:39680
    v_mfma_f32_16x16x32_bf16 v[16:19], a[196:199], v[236:239], v[16:19]
    s_waitcnt vmcnt(9)
    v_mfma_f32_16x16x32_bf16 v[20:23], a[200:203], v[236:239], v[20:23]
    buffer_load_dwordx4 a[248:251], v254, s[8:11], s42 offen offset:2048
    v_mfma_f32_16x16x32_bf16 v[0:3], a[204:207], v[236:239], v[0:3]
    s_waitcnt lgkmcnt(3)
    v_mfma_f32_16x16x32_bf16 v[4:7], a[208:211], v[236:239], v[4:7]
    s_mov_b32 s42, 854016
    v_mfma_f32_16x16x32_bf16 v[8:11], a[212:215], v[236:239], v[8:11]
    ds_read_b128 v[236:239], v253 offset:12480
    v_mfma_f32_16x16x32_bf16 v[24:27], a[192:195], v[228:231], v[24:27]
    buffer_load_dwordx4 a[252:255], v254, s[8:11], s42 offen offset:0
    v_mfma_f32_16x16x32_bf16 v[28:31], a[196:199], v[228:231], v[28:31]
    v_mfma_f32_16x16x32_bf16 v[32:35], a[200:203], v[228:231], v[32:35]
    v_mfma_f32_16x16x32_bf16 v[12:15], a[204:207], v[228:231], v[12:15]
    v_mfma_f32_16x16x32_bf16 v[16:19], a[208:211], v[228:231], v[16:19]
    buffer_load_dwordx4 v[240:243], v254, s[8:11], s42 offen offset:1024
    v_mfma_f32_16x16x32_bf16 v[20:23], a[212:215], v[228:231], v[20:23]
    s_waitcnt vmcnt(9)
    v_mfma_f32_16x16x32_bf16 v[0:3], a[216:219], v[228:231], v[0:3]
    s_waitcnt lgkmcnt(2)
    v_mfma_f32_16x16x32_bf16 v[4:7], a[220:223], v[228:231], v[4:7]
    buffer_load_dwordx4 v[244:247], v254, s[8:11], s42 offen offset:2048
    v_mfma_f32_16x16x32_bf16 v[8:11], a[224:227], v[228:231], v[8:11]
    ds_read_b128 v[228:231], v253 offset:14304
    v_mfma_f32_16x16x32_bf16 v[36:39], a[192:195], v[232:235], v[36:39]
    v_mfma_f32_16x16x32_bf16 v[40:43], a[196:199], v[232:235], v[40:43]
    v_mfma_f32_16x16x32_bf16 v[44:47], a[200:203], v[232:235], v[44:47]
    v_mfma_f32_16x16x32_bf16 v[24:27], a[204:207], v[232:235], v[24:27]
    v_mfma_f32_16x16x32_bf16 v[28:31], a[208:211], v[232:235], v[28:31]
    v_mfma_f32_16x16x32_bf16 v[32:35], a[212:215], v[232:235], v[32:35]
    v_mfma_f32_16x16x32_bf16 v[12:15], a[216:219], v[232:235], v[12:15]
    v_mfma_f32_16x16x32_bf16 v[16:19], a[220:223], v[232:235], v[16:19]
    s_waitcnt lgkmcnt(1)
    v_mfma_f32_16x16x32_bf16 v[20:23], a[224:227], v[232:235], v[20:23]
    ds_read_b128 v[232:235], v253 offset:14048
    v_mfma_f32_16x16x32_bf16 v[48:51], a[192:195], v[236:239], v[48:51]
    v_mfma_f32_16x16x32_bf16 v[52:55], a[196:199], v[236:239], v[52:55]
    v_mfma_f32_16x16x32_bf16 v[56:59], a[200:203], v[236:239], v[56:59]
    v_mfma_f32_16x16x32_bf16 v[36:39], a[204:207], v[236:239], v[36:39]
    v_mfma_f32_16x16x32_bf16 v[40:43], a[208:211], v[236:239], v[40:43]
    v_mfma_f32_16x16x32_bf16 v[44:47], a[212:215], v[236:239], v[44:47]
    v_mfma_f32_16x16x32_bf16 v[24:27], a[216:219], v[236:239], v[24:27]
    v_mfma_f32_16x16x32_bf16 v[28:31], a[220:223], v[236:239], v[28:31]
    s_waitcnt lgkmcnt(1)
    v_mfma_f32_16x16x32_bf16 v[32:35], a[224:227], v[236:239], v[32:35]
    ds_read_b128 v[236:239], v253 offset:13792
    v_mfma_f32_16x16x32_bf16 v[60:63], a[192:195], v[228:231], v[60:63]
    v_mfma_f32_16x16x32_bf16 v[64:67], a[196:199], v[228:231], v[64:67]
    v_mfma_f32_16x16x32_bf16 v[68:71], a[200:203], v[228:231], v[68:71]
    v_mfma_f32_16x16x32_bf16 v[48:51], a[204:207], v[228:231], v[48:51]
    v_mfma_f32_16x16x32_bf16 v[52:55], a[208:211], v[228:231], v[52:55]
    v_mfma_f32_16x16x32_bf16 v[56:59], a[212:215], v[228:231], v[56:59]
    v_mfma_f32_16x16x32_bf16 v[36:39], a[216:219], v[228:231], v[36:39]
    v_mfma_f32_16x16x32_bf16 v[40:43], a[220:223], v[228:231], v[40:43]
    s_waitcnt lgkmcnt(1)
    v_mfma_f32_16x16x32_bf16 v[44:47], a[224:227], v[228:231], v[44:47]
    ds_read_b128 v[228:231], v253 offset:13536
    v_mfma_f32_16x16x32_bf16 v[72:75], a[192:195], v[232:235], v[72:75]
    v_mfma_f32_16x16x32_bf16 v[76:79], a[196:199], v[232:235], v[76:79]
    v_mfma_f32_16x16x32_bf16 v[80:83], a[200:203], v[232:235], v[80:83]
    v_mfma_f32_16x16x32_bf16 v[60:63], a[204:207], v[232:235], v[60:63]
    v_mfma_f32_16x16x32_bf16 v[64:67], a[208:211], v[232:235], v[64:67]
    v_mfma_f32_16x16x32_bf16 v[68:71], a[212:215], v[232:235], v[68:71]
    v_mfma_f32_16x16x32_bf16 v[48:51], a[216:219], v[232:235], v[48:51]
    v_mfma_f32_16x16x32_bf16 v[52:55], a[220:223], v[232:235], v[52:55]
    s_waitcnt lgkmcnt(1)
    v_mfma_f32_16x16x32_bf16 v[56:59], a[224:227], v[232:235], v[56:59]
    ds_read_b128 v[232:235], v253 offset:13264
    v_mfma_f32_16x16x32_bf16 v[84:87], a[192:195], v[236:239], v[84:87]
    v_mfma_f32_16x16x32_bf16 v[88:91], a[196:199], v[236:239], v[88:91]
    v_mfma_f32_16x16x32_bf16 v[92:95], a[200:203], v[236:239], v[92:95]
    s_mov_b32 s42, 884736
    v_mfma_f32_16x16x32_bf16 v[72:75], a[204:207], v[236:239], v[72:75]
    buffer_load_dwordx4 a[192:195], v254, s[8:11], s42 offen offset:0
    v_mfma_f32_16x16x32_bf16 v[76:79], a[208:211], v[236:239], v[76:79]
    v_mfma_f32_16x16x32_bf16 v[80:83], a[212:215], v[236:239], v[80:83]
    v_mfma_f32_16x16x32_bf16 v[60:63], a[216:219], v[236:239], v[60:63]
    buffer_load_dwordx4 a[196:199], v254, s[8:11], s42 offen offset:1024
    v_mfma_f32_16x16x32_bf16 v[64:67], a[220:223], v[236:239], v[64:67]
    v_mfma_f32_16x16x32_bf16 v[68:71], a[224:227], v[236:239], v[68:71]
    s_waitcnt lgkmcnt(1)
    v_mfma_f32_16x16x32_bf16 v[84:87], a[204:207], v[228:231], v[84:87]
    ds_read_b128 v[236:239], v253 offset:1040
    v_mfma_f32_16x16x32_bf16 v[88:91], a[208:211], v[228:231], v[88:91]
    v_mfma_f32_16x16x32_bf16 v[92:95], a[212:215], v[228:231], v[92:95]
    buffer_load_dwordx4 a[200:203], v254, s[8:11], s42 offen offset:2048
    v_mfma_f32_16x16x32_bf16 v[72:75], a[216:219], v[228:231], v[72:75]
    s_waitcnt lgkmcnt(1)
    v_mfma_f32_16x16x32_bf16 v[76:79], a[220:223], v[228:231], v[76:79]
    s_mov_b32 s42, 887808
    v_mfma_f32_16x16x32_bf16 v[80:83], a[224:227], v[228:231], v[80:83]
    ds_read_b128 v[228:231], v253 offset:768
    v_mfma_f32_16x16x32_bf16 v[84:87], a[216:219], v[232:235], v[84:87]
    buffer_load_dwordx4 a[204:207], v254, s[8:11], s42 offen offset:0
    v_mfma_f32_16x16x32_bf16 v[88:91], a[220:223], v[232:235], v[88:91]
    s_waitcnt vmcnt(10) lgkmcnt(1)
    v_mfma_f32_16x16x32_bf16 v[92:95], a[224:227], v[232:235], v[92:95]
    ds_read_b128 v[232:235], v253 offset:512
    v_mfma_f32_16x16x32_bf16 v[96:99], a[228:231], v[236:239], v[96:99]
    s_waitcnt lgkmcnt(1)
    v_mfma_f32_16x16x32_bf16 v[100:103], a[232:235], v[236:239], v[100:103]
    buffer_load_dwordx4 a[208:211], v254, s[8:11], s42 offen offset:1024
    v_mfma_f32_16x16x32_bf16 v[104:107], a[236:239], v[236:239], v[104:107]
    ds_read_b128 v[236:239], v253 offset:256
    v_mfma_f32_16x16x32_bf16 v[108:111], a[228:231], v[228:231], v[108:111]
    v_mfma_f32_16x16x32_bf16 v[112:115], a[232:235], v[228:231], v[112:115]
    s_waitcnt vmcnt(8)
    v_mfma_f32_16x16x32_bf16 v[116:119], a[236:239], v[228:231], v[116:119]
    buffer_load_dwordx4 a[212:215], v254, s[8:11], s42 offen offset:2048
    v_mfma_f32_16x16x32_bf16 v[96:99], a[240:243], v[228:231], v[96:99]
    s_waitcnt lgkmcnt(1)
    v_mfma_f32_16x16x32_bf16 v[100:103], a[244:247], v[228:231], v[100:103]
    s_mov_b32 s42, 890880
    v_mfma_f32_16x16x32_bf16 v[104:107], a[248:251], v[228:231], v[104:107]
    ds_read_b128 v[228:231], v253 offset:0
    v_mfma_f32_16x16x32_bf16 v[120:123], a[228:231], v[232:235], v[120:123]
    buffer_load_dwordx4 a[216:219], v254, s[8:11], s42 offen offset:0
    v_mfma_f32_16x16x32_bf16 v[124:127], a[232:235], v[232:235], v[124:127]
    v_bfe_u32 v251, v254, 6, 2
    v_mfma_f32_16x16x32_bf16 v[128:131], a[236:239], v[232:235], v[128:131]
    v_mfma_f32_16x16x32_bf16 v[108:111], a[240:243], v[232:235], v[108:111]
    v_mfma_f32_16x16x32_bf16 v[112:115], a[244:247], v[232:235], v[112:115]
    buffer_load_dwordx4 a[220:223], v254, s[8:11], s42 offen offset:1024
    v_mfma_f32_16x16x32_bf16 v[116:119], a[248:251], v[232:235], v[116:119]
    s_waitcnt vmcnt(8)
    v_mul_u32_u24 v248, 40704, v251
    v_mfma_f32_16x16x32_bf16 v[96:99], a[252:255], v[232:235], v[96:99]
    s_waitcnt lgkmcnt(1)
    v_mfma_f32_16x16x32_bf16 v[100:103], v[240:243], v[232:235], v[100:103]
    buffer_load_dwordx4 a[224:227], v254, s[8:11], s42 offen offset:2048
    v_mfma_f32_16x16x32_bf16 v[104:107], v[244:247], v[232:235], v[104:107]
    ds_read_b128 v[232:235], v253 offset:1824
    v_and_b32 v252, 0x1f0, v254
    v_mfma_f32_16x16x32_bf16 v[132:135], a[228:231], v[236:239], v[132:135]
    v_mul_u32_u24 v252, 96, v252
    v_and_b32 v251, 0x80, v254
    v_mfma_f32_16x16x32_bf16 v[136:139], a[232:235], v[236:239], v[136:139]
    buffer_load_dword v252, v252, s[4:7], s33 offen offset:1152
    v_mfma_f32_16x16x32_bf16 v[140:143], a[236:239], v[236:239], v[140:143]
    v_lshrrev_b32 v251, 1, v251
    v_mfma_f32_16x16x32_bf16 v[120:123], a[240:243], v[236:239], v[120:123]
    v_mfma_f32_16x16x32_bf16 v[124:127], a[244:247], v[236:239], v[124:127]
    v_mfma_f32_16x16x32_bf16 v[128:131], a[248:251], v[236:239], v[128:131]
    v_add_u32 v248, v248, v251
    v_mfma_f32_16x16x32_bf16 v[108:111], a[252:255], v[236:239], v[108:111]
    v_mfma_f32_16x16x32_bf16 v[112:115], v[240:243], v[236:239], v[112:115]
    s_waitcnt lgkmcnt(1)
    v_mfma_f32_16x16x32_bf16 v[116:119], v[244:247], v[236:239], v[116:119]
    ds_read_b128 v[236:239], v253 offset:1568
    v_and_b32 v251, 0x40, v254
    v_mfma_f32_16x16x32_bf16 v[144:147], a[228:231], v[228:231], v[144:147]
    v_mfma_f32_16x16x32_bf16 v[148:151], a[232:235], v[228:231], v[148:151]
    v_mfma_f32_16x16x32_bf16 v[152:155], a[236:239], v[228:231], v[152:155]
    v_mfma_f32_16x16x32_bf16 v[132:135], a[240:243], v[228:231], v[132:135]
    v_lshrrev_b32 v251, 2, v251
    v_mfma_f32_16x16x32_bf16 v[136:139], a[244:247], v[228:231], v[136:139]
    v_mfma_f32_16x16x32_bf16 v[140:143], a[248:251], v[228:231], v[140:143]
    v_mfma_f32_16x16x32_bf16 v[120:123], a[252:255], v[228:231], v[120:123]
    v_add_u32 v248, v248, v251
    v_mfma_f32_16x16x32_bf16 v[124:127], v[240:243], v[228:231], v[124:127]
    s_waitcnt lgkmcnt(1)
    v_mfma_f32_16x16x32_bf16 v[128:131], v[244:247], v[228:231], v[128:131]
    ds_read_b128 v[228:231], v253 offset:1312
    v_mfma_f32_16x16x32_bf16 v[156:159], a[228:231], v[232:235], v[156:159]
    v_bfe_u32 v251, v254, 4, 2
    v_mfma_f32_16x16x32_bf16 v[160:163], a[232:235], v[232:235], v[160:163]
    v_mfma_f32_16x16x32_bf16 v[164:167], a[236:239], v[232:235], v[164:167]
    v_mfma_f32_16x16x32_bf16 v[144:147], a[240:243], v[232:235], v[144:147]
    v_mfma_f32_16x16x32_bf16 v[148:151], a[244:247], v[232:235], v[148:151]
    v_mul_u32_u24 v251, 3104, v251
    v_mfma_f32_16x16x32_bf16 v[152:155], a[248:251], v[232:235], v[152:155]
    v_mfma_f32_16x16x32_bf16 v[132:135], a[252:255], v[232:235], v[132:135]
    v_mfma_f32_16x16x32_bf16 v[136:139], v[240:243], v[232:235], v[136:139]
    s_waitcnt lgkmcnt(1)
    v_add_u32 v248, v248, v251
    v_mfma_f32_16x16x32_bf16 v[140:143], v[244:247], v[232:235], v[140:143]
    ds_read_b128 v[232:235], v253 offset:1056
    v_mfma_f32_16x16x32_bf16 v[168:171], a[228:231], v[236:239], v[168:171]
    v_mfma_f32_16x16x32_bf16 v[172:175], a[232:235], v[236:239], v[172:175]
    v_add_u32 v248, s52, v248
    v_mfma_f32_16x16x32_bf16 v[176:179], a[236:239], v[236:239], v[176:179]
    v_mfma_f32_16x16x32_bf16 v[156:159], a[240:243], v[236:239], v[156:159]
    v_mfma_f32_16x16x32_bf16 v[160:163], a[244:247], v[236:239], v[160:163]
    v_mfma_f32_16x16x32_bf16 v[164:167], a[248:251], v[236:239], v[164:167]
    v_lshrrev_b32 v251, 8, v254
    v_mfma_f32_16x16x32_bf16 v[144:147], a[252:255], v[236:239], v[144:147]
    v_mfma_f32_16x16x32_bf16 v[148:151], v[240:243], v[236:239], v[148:151]
    s_waitcnt lgkmcnt(1)
    v_mfma_f32_16x16x32_bf16 v[152:155], v[244:247], v[236:239], v[152:155]
    ds_read_b128 v[236:239], v253 offset:784
    v_lshl_add_u32 v249, v251, 3, v248
    v_mfma_f32_16x16x32_bf16 v[180:183], a[228:231], v[228:231], v[180:183]
    v_mfma_f32_16x16x32_bf16 v[184:187], a[232:235], v[228:231], v[184:187]
    v_mfma_f32_16x16x32_bf16 v[188:191], a[236:239], v[228:231], v[188:191]
    s_mov_b32 s42, 921600
    v_lshl_add_u32 v248, v251, 4, v248
    v_mfma_f32_16x16x32_bf16 v[168:171], a[240:243], v[228:231], v[168:171]
    buffer_load_dwordx4 a[228:231], v254, s[8:11], s42 offen offset:0
    v_mfma_f32_16x16x32_bf16 v[172:175], a[244:247], v[228:231], v[172:175]
    v_mfma_f32_16x16x32_bf16 v[176:179], a[248:251], v[228:231], v[176:179]
    s_waitcnt lgkmcnt(1)
    v_mfma_f32_16x16x32_bf16 v[156:159], a[252:255], v[228:231], v[156:159]
    buffer_load_dwordx4 a[232:235], v254, s[8:11], s42 offen offset:1024
    v_mfma_f32_16x16x32_bf16 v[160:163], v[240:243], v[228:231], v[160:163]
    s_waitcnt lgkmcnt(0)
    v_mfma_f32_16x16x32_bf16 v[164:167], v[244:247], v[228:231], v[164:167]
    s_barrier
    v_mfma_f32_16x16x32_bf16 v[180:183], a[240:243], v[232:235], v[180:183]
    ds_read_b128 v[228:231], v253 offset:34320
    v_mfma_f32_16x16x32_bf16 v[184:187], a[244:247], v[232:235], v[184:187]
    v_mfma_f32_16x16x32_bf16 v[188:191], a[248:251], v[232:235], v[188:191]
    buffer_load_dwordx4 a[236:239], v254, s[8:11], s42 offen offset:2048
    v_mfma_f32_16x16x32_bf16 v[168:171], a[252:255], v[232:235], v[168:171]
    v_mfma_f32_16x16x32_bf16 v[172:175], v[240:243], v[232:235], v[172:175]
    s_mov_b32 s42, 924672
    v_mfma_f32_16x16x32_bf16 v[176:179], v[244:247], v[232:235], v[176:179]
    ds_read_b128 v[232:235], v253 offset:34048
    v_mfma_f32_16x16x32_bf16 v[180:183], a[252:255], v[236:239], v[180:183]
    buffer_load_dwordx4 a[240:243], v254, s[8:11], s42 offen offset:0
    v_mfma_f32_16x16x32_bf16 v[184:187], v[240:243], v[236:239], v[184:187]
    s_waitcnt vmcnt(11) lgkmcnt(1)
    v_mfma_f32_16x16x32_bf16 v[188:191], v[244:247], v[236:239], v[188:191]
    ds_read_b128 v[236:239], v253 offset:33792
    s_nop 7
    v_accvgpr_read_b32 v192, a0
    v_accvgpr_read_b32 v193, a1
    v_accvgpr_read_b32 v194, a2
    v_accvgpr_read_b32 v195, a3
    v_accvgpr_read_b32 v196, a96
    v_accvgpr_read_b32 v197, a97
    v_accvgpr_read_b32 v198, a98
    v_accvgpr_read_b32 v199, a99
    v_pk_add_f32 v[192:193], v[192:193], v[196:197]
    v_pk_add_f32 v[194:195], v[194:195], v[198:199]
    v_pk_add_f32 v[196:197], v[0:1], v[96:97]
    v_pk_add_f32 v[198:199], v[2:3], v[98:99]
    v_pk_add_f32 v[96:97], v[0:1], v[96:97] neg_lo:[0,1] neg_hi:[0,1]
    v_pk_add_f32 v[98:99], v[2:3], v[98:99] neg_lo:[0,1] neg_hi:[0,1]
    v_pk_fma_f32 v[0:1], v[196:197], s[30:31], v[192:193]
    v_pk_fma_f32 v[2:3], v[198:199], s[30:31], v[194:195]
    v_pk_fma_f32 v[192:193], v[192:193], s[30:31], v[196:197]
    v_pk_fma_f32 v[194:195], v[194:195], s[30:31], v[198:199]
    v_cvt_pk_bf16_f32 v208, v192, v193
    v_cvt_pk_bf16_f32 v209, v194, v195
    v_accvgpr_read_b32 v200, a4
    v_accvgpr_read_b32 v201, a5
    v_accvgpr_read_b32 v202, a6
    v_accvgpr_read_b32 v203, a7
    v_accvgpr_read_b32 v204, a100
    v_accvgpr_read_b32 v205, a101
    v_accvgpr_read_b32 v206, a102
    v_accvgpr_read_b32 v207, a103
    v_pk_add_f32 v[200:201], v[200:201], v[204:205]
    v_pk_add_f32 v[202:203], v[202:203], v[206:207]
    v_pk_add_f32 v[204:205], v[4:5], v[100:101]
    v_pk_add_f32 v[206:207], v[6:7], v[102:103]
    v_pk_add_f32 v[100:101], v[4:5], v[100:101] neg_lo:[0,1] neg_hi:[0,1]
    v_pk_add_f32 v[102:103], v[6:7], v[102:103] neg_lo:[0,1] neg_hi:[0,1]
    v_pk_fma_f32 v[4:5], v[204:205], s[30:31], v[200:201]
    v_pk_fma_f32 v[6:7], v[206:207], s[30:31], v[202:203]
    v_pk_fma_f32 v[200:201], v[200:201], s[30:31], v[204:205]
    v_pk_fma_f32 v[202:203], v[202:203], s[30:31], v[206:207]
    v_cvt_pk_bf16_f32 v210, v200, v201
    v_cvt_pk_bf16_f32 v211, v202, v203
    ds_write_b128 v248, v[208:211] offset:0
    v_accvgpr_read_b32 v192, a8
    v_accvgpr_read_b32 v193, a9
    v_accvgpr_read_b32 v194, a10
    v_accvgpr_read_b32 v195, a11
    v_accvgpr_read_b32 v196, a104
    v_accvgpr_read_b32 v197, a105
    v_accvgpr_read_b32 v198, a106
    v_accvgpr_read_b32 v199, a107
    v_pk_add_f32 v[192:193], v[192:193], v[196:197]
    v_pk_add_f32 v[194:195], v[194:195], v[198:199]
    v_pk_add_f32 v[196:197], v[8:9], v[104:105]
    v_pk_add_f32 v[198:199], v[10:11], v[106:107]
    v_pk_add_f32 v[104:105], v[8:9], v[104:105] neg_lo:[0,1] neg_hi:[0,1]
    v_pk_add_f32 v[106:107], v[10:11], v[106:107] neg_lo:[0,1] neg_hi:[0,1]
    v_pk_fma_f32 v[8:9], v[196:197], s[30:31], v[192:193]
    v_pk_fma_f32 v[10:11], v[198:199], s[30:31], v[194:195]
    v_pk_fma_f32 v[192:193], v[192:193], s[30:31], v[196:197]
    v_pk_fma_f32 v[194:195], v[194:195], s[30:31], v[198:199]
    v_cvt_pk_bf16_f32 v212, v192, v193
    v_cvt_pk_bf16_f32 v213, v194, v195
    v_accvgpr_read_b32 v192, a12
    v_accvgpr_read_b32 v193, a13
    v_accvgpr_read_b32 v194, a14
    v_accvgpr_read_b32 v195, a15
    v_accvgpr_read_b32 v196, a108
    v_accvgpr_read_b32 v197, a109
    v_accvgpr_read_b32 v198, a110
    v_accvgpr_read_b32 v199, a111
    v_pk_add_f32 v[192:193], v[192:193], v[196:197]
    v_pk_add_f32 v[194:195], v[194:195], v[198:199]
    v_pk_add_f32 v[196:197], v[12:13], v[108:109]
    v_pk_add_f32 v[198:199], v[14:15], v[110:111]
    v_pk_add_f32 v[108:109], v[12:13], v[108:109] neg_lo:[0,1] neg_hi:[0,1]
    v_pk_add_f32 v[110:111], v[14:15], v[110:111] neg_lo:[0,1] neg_hi:[0,1]
    v_pk_fma_f32 v[12:13], v[196:197], s[30:31], v[192:193]
    v_pk_fma_f32 v[14:15], v[198:199], s[30:31], v[194:195]
    v_pk_fma_f32 v[192:193], v[192:193], s[30:31], v[196:197]
    v_pk_fma_f32 v[194:195], v[194:195], s[30:31], v[198:199]
    v_cvt_pk_bf16_f32 v214, v192, v193
    v_cvt_pk_bf16_f32 v215, v194, v195
    ds_write_b64 v249, v[212:213] offset:64
    v_accvgpr_read_b32 v200, a16
    v_accvgpr_read_b32 v201, a17
    v_accvgpr_read_b32 v202, a18
    v_accvgpr_read_b32 v203, a19
    v_accvgpr_read_b32 v204, a112
    v_accvgpr_read_b32 v205, a113
    v_accvgpr_read_b32 v206, a114
    v_accvgpr_read_b32 v207, a115
    v_pk_add_f32 v[200:201], v[200:201], v[204:205]
    v_pk_add_f32 v[202:203], v[202:203], v[206:207]
    v_pk_add_f32 v[204:205], v[16:17], v[112:113]
    v_pk_add_f32 v[206:207], v[18:19], v[114:115]
    v_pk_add_f32 v[112:113], v[16:17], v[112:113] neg_lo:[0,1] neg_hi:[0,1]
    v_pk_add_f32 v[114:115], v[18:19], v[114:115] neg_lo:[0,1] neg_hi:[0,1]
    v_pk_fma_f32 v[16:17], v[204:205], s[30:31], v[200:201]
    v_pk_fma_f32 v[18:19], v[206:207], s[30:31], v[202:203]
    v_pk_fma_f32 v[200:201], v[200:201], s[30:31], v[204:205]
    v_pk_fma_f32 v[202:203], v[202:203], s[30:31], v[206:207]
    v_cvt_pk_bf16_f32 v216, v200, v201
    v_cvt_pk_bf16_f32 v217, v202, v203
    ds_write_b128 v248, v[214:217] offset:384
    v_accvgpr_read_b32 v192, a20
    v_accvgpr_read_b32 v193, a21
    v_accvgpr_read_b32 v194, a22
    v_accvgpr_read_b32 v195, a23
    v_accvgpr_read_b32 v196, a116
    v_accvgpr_read_b32 v197, a117
    v_accvgpr_read_b32 v198, a118
    v_accvgpr_read_b32 v199, a119
    v_pk_add_f32 v[192:193], v[192:193], v[196:197]
    v_pk_add_f32 v[194:195], v[194:195], v[198:199]
    v_pk_add_f32 v[196:197], v[20:21], v[116:117]
    v_pk_add_f32 v[198:199], v[22:23], v[118:119]
    v_pk_add_f32 v[116:117], v[20:21], v[116:117] neg_lo:[0,1] neg_hi:[0,1]
    v_pk_add_f32 v[118:119], v[22:23], v[118:119] neg_lo:[0,1] neg_hi:[0,1]
    v_pk_fma_f32 v[20:21], v[196:197], s[30:31], v[192:193]
    v_pk_fma_f32 v[22:23], v[198:199], s[30:31], v[194:195]
    v_pk_fma_f32 v[192:193], v[192:193], s[30:31], v[196:197]
    v_pk_fma_f32 v[194:195], v[194:195], s[30:31], v[198:199]
    v_cvt_pk_bf16_f32 v218, v192, v193
    v_cvt_pk_bf16_f32 v219, v194, v195
    v_accvgpr_read_b32 v192, a24
    v_accvgpr_read_b32 v193, a25
    v_accvgpr_read_b32 v194, a26
    v_accvgpr_read_b32 v195, a27
    v_accvgpr_read_b32 v196, a120
    v_accvgpr_read_b32 v197, a121
    v_accvgpr_read_b32 v198, a122
    v_accvgpr_read_b32 v199, a123
    v_pk_add_f32 v[192:193], v[192:193], v[196:197]
    v_pk_add_f32 v[194:195], v[194:195], v[198:199]
    v_pk_add_f32 v[196:197], v[24:25], v[120:121]
    v_pk_add_f32 v[198:199], v[26:27], v[122:123]
    v_pk_add_f32 v[120:121], v[24:25], v[120:121] neg_lo:[0,1] neg_hi:[0,1]
    v_pk_add_f32 v[122:123], v[26:27], v[122:123] neg_lo:[0,1] neg_hi:[0,1]
    v_pk_fma_f32 v[24:25], v[196:197], s[30:31], v[192:193]
    v_pk_fma_f32 v[26:27], v[198:199], s[30:31], v[194:195]
    v_pk_fma_f32 v[192:193], v[192:193], s[30:31], v[196:197]
    v_pk_fma_f32 v[194:195], v[194:195], s[30:31], v[198:199]
    v_cvt_pk_bf16_f32 v208, v192, v193
    v_cvt_pk_bf16_f32 v209, v194, v195
    ds_write_b64 v249, v[218:219] offset:448
    v_accvgpr_read_b32 v200, a28
    v_accvgpr_read_b32 v201, a29
    v_accvgpr_read_b32 v202, a30
    v_accvgpr_read_b32 v203, a31
    v_accvgpr_read_b32 v204, a124
    v_accvgpr_read_b32 v205, a125
    v_accvgpr_read_b32 v206, a126
    v_accvgpr_read_b32 v207, a127
    v_pk_add_f32 v[200:201], v[200:201], v[204:205]
    v_pk_add_f32 v[202:203], v[202:203], v[206:207]
    v_pk_add_f32 v[204:205], v[28:29], v[124:125]
    v_pk_add_f32 v[206:207], v[30:31], v[126:127]
    v_pk_add_f32 v[124:125], v[28:29], v[124:125] neg_lo:[0,1] neg_hi:[0,1]
    v_pk_add_f32 v[126:127], v[30:31], v[126:127] neg_lo:[0,1] neg_hi:[0,1]
    v_pk_fma_f32 v[28:29], v[204:205], s[30:31], v[200:201]
    v_pk_fma_f32 v[30:31], v[206:207], s[30:31], v[202:203]
    v_pk_fma_f32 v[200:201], v[200:201], s[30:31], v[204:205]
    v_pk_fma_f32 v[202:203], v[202:203], s[30:31], v[206:207]
    v_cvt_pk_bf16_f32 v210, v200, v201
    v_cvt_pk_bf16_f32 v211, v202, v203
    ds_write_b128 v248, v[208:211] offset:768
    v_accvgpr_read_b32 v192, a32
    v_accvgpr_read_b32 v193, a33
    v_accvgpr_read_b32 v194, a34
    v_accvgpr_read_b32 v195, a35
    v_accvgpr_read_b32 v196, a128
    v_accvgpr_read_b32 v197, a129
    v_accvgpr_read_b32 v198, a130
    v_accvgpr_read_b32 v199, a131
    v_pk_add_f32 v[192:193], v[192:193], v[196:197]
    v_pk_add_f32 v[194:195], v[194:195], v[198:199]
    v_pk_add_f32 v[196:197], v[32:33], v[128:129]
    v_pk_add_f32 v[198:199], v[34:35], v[130:131]
    v_pk_add_f32 v[128:129], v[32:33], v[128:129] neg_lo:[0,1] neg_hi:[0,1]
    v_pk_add_f32 v[130:131], v[34:35], v[130:131] neg_lo:[0,1] neg_hi:[0,1]
    v_pk_fma_f32 v[32:33], v[196:197], s[30:31], v[192:193]
    v_pk_fma_f32 v[34:35], v[198:199], s[30:31], v[194:195]
    v_pk_fma_f32 v[192:193], v[192:193], s[30:31], v[196:197]
    v_pk_fma_f32 v[194:195], v[194:195], s[30:31], v[198:199]
    v_cvt_pk_bf16_f32 v212, v192, v193
    v_cvt_pk_bf16_f32 v213, v194, v195
    v_accvgpr_read_b32 v192, a36
    v_accvgpr_read_b32 v193, a37
    v_accvgpr_read_b32 v194, a38
    v_accvgpr_read_b32 v195, a39
    v_accvgpr_read_b32 v196, a132
    v_accvgpr_read_b32 v197, a133
    v_accvgpr_read_b32 v198, a134
    v_accvgpr_read_b32 v199, a135
    v_pk_add_f32 v[192:193], v[192:193], v[196:197]
    v_pk_add_f32 v[194:195], v[194:195], v[198:199]
    v_pk_add_f32 v[196:197], v[36:37], v[132:133]
    v_pk_add_f32 v[198:199], v[38:39], v[134:135]
    v_pk_add_f32 v[132:133], v[36:37], v[132:133] neg_lo:[0,1] neg_hi:[0,1]
    v_pk_add_f32 v[134:135], v[38:39], v[134:135] neg_lo:[0,1] neg_hi:[0,1]
    v_pk_fma_f32 v[36:37], v[196:197], s[30:31], v[192:193]
    v_pk_fma_f32 v[38:39], v[198:199], s[30:31], v[194:195]
    v_pk_fma_f32 v[192:193], v[192:193], s[30:31], v[196:197]
    v_pk_fma_f32 v[194:195], v[194:195], s[30:31], v[198:199]
    v_cvt_pk_bf16_f32 v214, v192, v193
    v_cvt_pk_bf16_f32 v215, v194, v195
    ds_write_b64 v249, v[212:213] offset:832
    v_accvgpr_read_b32 v200, a40
    v_accvgpr_read_b32 v201, a41
    v_accvgpr_read_b32 v202, a42
    v_accvgpr_read_b32 v203, a43
    v_accvgpr_read_b32 v204, a136
    v_accvgpr_read_b32 v205, a137
    v_accvgpr_read_b32 v206, a138
    v_accvgpr_read_b32 v207, a139
    v_pk_add_f32 v[200:201], v[200:201], v[204:205]
    v_pk_add_f32 v[202:203], v[202:203], v[206:207]
    v_pk_add_f32 v[204:205], v[40:41], v[136:137]
    v_pk_add_f32 v[206:207], v[42:43], v[138:139]
    v_pk_add_f32 v[136:137], v[40:41], v[136:137] neg_lo:[0,1] neg_hi:[0,1]
    v_pk_add_f32 v[138:139], v[42:43], v[138:139] neg_lo:[0,1] neg_hi:[0,1]
    v_pk_fma_f32 v[40:41], v[204:205], s[30:31], v[200:201]
    v_pk_fma_f32 v[42:43], v[206:207], s[30:31], v[202:203]
    v_pk_fma_f32 v[200:201], v[200:201], s[30:31], v[204:205]
    v_pk_fma_f32 v[202:203], v[202:203], s[30:31], v[206:207]
    v_cvt_pk_bf16_f32 v216, v200, v201
    v_cvt_pk_bf16_f32 v217, v202, v203
    ds_write_b128 v248, v[214:217] offset:1152
    v_accvgpr_read_b32 v192, a44
    v_accvgpr_read_b32 v193, a45
    v_accvgpr_read_b32 v194, a46
    v_accvgpr_read_b32 v195, a47
    v_accvgpr_read_b32 v196, a140
    v_accvgpr_read_b32 v197, a141
    v_accvgpr_read_b32 v198, a142
    v_accvgpr_read_b32 v199, a143
    v_pk_add_f32 v[192:193], v[192:193], v[196:197]
    v_pk_add_f32 v[194:195], v[194:195], v[198:199]
    v_pk_add_f32 v[196:197], v[44:45], v[140:141]
    v_pk_add_f32 v[198:199], v[46:47], v[142:143]
    v_pk_add_f32 v[140:141], v[44:45], v[140:141] neg_lo:[0,1] neg_hi:[0,1]
    v_pk_add_f32 v[142:143], v[46:47], v[142:143] neg_lo:[0,1] neg_hi:[0,1]
    v_pk_fma_f32 v[44:45], v[196:197], s[30:31], v[192:193]
    v_pk_fma_f32 v[46:47], v[198:199], s[30:31], v[194:195]
    v_pk_fma_f32 v[192:193], v[192:193], s[30:31], v[196:197]
    v_pk_fma_f32 v[194:195], v[194:195], s[30:31], v[198:199]
    v_cvt_pk_bf16_f32 v218, v192, v193
    v_cvt_pk_bf16_f32 v219, v194, v195
    v_accvgpr_read_b32 v192, a48
    v_accvgpr_read_b32 v193, a49
    v_accvgpr_read_b32 v194, a50
    v_accvgpr_read_b32 v195, a51
    v_accvgpr_read_b32 v196, a144
    v_accvgpr_read_b32 v197, a145
    v_accvgpr_read_b32 v198, a146
    v_accvgpr_read_b32 v199, a147
    v_pk_add_f32 v[192:193], v[192:193], v[196:197]
    v_pk_add_f32 v[194:195], v[194:195], v[198:199]
    v_pk_add_f32 v[196:197], v[48:49], v[144:145]
    v_pk_add_f32 v[198:199], v[50:51], v[146:147]
    v_pk_add_f32 v[144:145], v[48:49], v[144:145] neg_lo:[0,1] neg_hi:[0,1]
    v_pk_add_f32 v[146:147], v[50:51], v[146:147] neg_lo:[0,1] neg_hi:[0,1]
    v_pk_fma_f32 v[48:49], v[196:197], s[30:31], v[192:193]
    v_pk_fma_f32 v[50:51], v[198:199], s[30:31], v[194:195]
    v_pk_fma_f32 v[192:193], v[192:193], s[30:31], v[196:197]
    v_pk_fma_f32 v[194:195], v[194:195], s[30:31], v[198:199]
    v_cvt_pk_bf16_f32 v208, v192, v193
    v_cvt_pk_bf16_f32 v209, v194, v195
    ds_write_b64 v249, v[218:219] offset:1216
    v_accvgpr_read_b32 v200, a52
    v_accvgpr_read_b32 v201, a53
    v_accvgpr_read_b32 v202, a54
    v_accvgpr_read_b32 v203, a55
    v_accvgpr_read_b32 v204, a148
    v_accvgpr_read_b32 v205, a149
    v_accvgpr_read_b32 v206, a150
    v_accvgpr_read_b32 v207, a151
    v_pk_add_f32 v[200:201], v[200:201], v[204:205]
    v_pk_add_f32 v[202:203], v[202:203], v[206:207]
    v_pk_add_f32 v[204:205], v[52:53], v[148:149]
    v_pk_add_f32 v[206:207], v[54:55], v[150:151]
    v_pk_add_f32 v[148:149], v[52:53], v[148:149] neg_lo:[0,1] neg_hi:[0,1]
    v_pk_add_f32 v[150:151], v[54:55], v[150:151] neg_lo:[0,1] neg_hi:[0,1]
    v_pk_fma_f32 v[52:53], v[204:205], s[30:31], v[200:201]
    v_pk_fma_f32 v[54:55], v[206:207], s[30:31], v[202:203]
    v_pk_fma_f32 v[200:201], v[200:201], s[30:31], v[204:205]
    v_pk_fma_f32 v[202:203], v[202:203], s[30:31], v[206:207]
    v_cvt_pk_bf16_f32 v210, v200, v201
    v_cvt_pk_bf16_f32 v211, v202, v203
    ds_write_b128 v248, v[208:211] offset:1536
    v_accvgpr_read_b32 v192, a56
    v_accvgpr_read_b32 v193, a57
    v_accvgpr_read_b32 v194, a58
    v_accvgpr_read_b32 v195, a59
    v_accvgpr_read_b32 v196, a152
    v_accvgpr_read_b32 v197, a153
    v_accvgpr_read_b32 v198, a154
    v_accvgpr_read_b32 v199, a155
    v_pk_add_f32 v[192:193], v[192:193], v[196:197]
    v_pk_add_f32 v[194:195], v[194:195], v[198:199]
    v_pk_add_f32 v[196:197], v[56:57], v[152:153]
    v_pk_add_f32 v[198:199], v[58:59], v[154:155]
    v_pk_add_f32 v[152:153], v[56:57], v[152:153] neg_lo:[0,1] neg_hi:[0,1]
    v_pk_add_f32 v[154:155], v[58:59], v[154:155] neg_lo:[0,1] neg_hi:[0,1]
    v_pk_fma_f32 v[56:57], v[196:197], s[30:31], v[192:193]
    v_pk_fma_f32 v[58:59], v[198:199], s[30:31], v[194:195]
    v_pk_fma_f32 v[192:193], v[192:193], s[30:31], v[196:197]
    v_pk_fma_f32 v[194:195], v[194:195], s[30:31], v[198:199]
    v_cvt_pk_bf16_f32 v212, v192, v193
    v_cvt_pk_bf16_f32 v213, v194, v195
    v_accvgpr_read_b32 v192, a60
    v_accvgpr_read_b32 v193, a61
    v_accvgpr_read_b32 v194, a62
    v_accvgpr_read_b32 v195, a63
    v_accvgpr_read_b32 v196, a156
    v_accvgpr_read_b32 v197, a157
    v_accvgpr_read_b32 v198, a158
    v_accvgpr_read_b32 v199, a159
    v_pk_add_f32 v[192:193], v[192:193], v[196:197]
    v_pk_add_f32 v[194:195], v[194:195], v[198:199]
    v_pk_add_f32 v[196:197], v[60:61], v[156:157]
    v_pk_add_f32 v[198:199], v[62:63], v[158:159]
    v_pk_add_f32 v[156:157], v[60:61], v[156:157] neg_lo:[0,1] neg_hi:[0,1]
    v_pk_add_f32 v[158:159], v[62:63], v[158:159] neg_lo:[0,1] neg_hi:[0,1]
    v_pk_fma_f32 v[60:61], v[196:197], s[30:31], v[192:193]
    v_pk_fma_f32 v[62:63], v[198:199], s[30:31], v[194:195]
    v_pk_fma_f32 v[192:193], v[192:193], s[30:31], v[196:197]
    v_pk_fma_f32 v[194:195], v[194:195], s[30:31], v[198:199]
    v_cvt_pk_bf16_f32 v214, v192, v193
    v_cvt_pk_bf16_f32 v215, v194, v195
    ds_write_b64 v249, v[212:213] offset:1600
    v_accvgpr_read_b32 v200, a64
    v_accvgpr_read_b32 v201, a65
    v_accvgpr_read_b32 v202, a66
    v_accvgpr_read_b32 v203, a67
    v_accvgpr_read_b32 v204, a160
    v_accvgpr_read_b32 v205, a161
    v_accvgpr_read_b32 v206, a162
    v_accvgpr_read_b32 v207, a163
    v_pk_add_f32 v[200:201], v[200:201], v[204:205]
    v_pk_add_f32 v[202:203], v[202:203], v[206:207]
    v_pk_add_f32 v[204:205], v[64:65], v[160:161]
    v_pk_add_f32 v[206:207], v[66:67], v[162:163]
    v_pk_add_f32 v[160:161], v[64:65], v[160:161] neg_lo:[0,1] neg_hi:[0,1]
    v_pk_add_f32 v[162:163], v[66:67], v[162:163] neg_lo:[0,1] neg_hi:[0,1]
    v_pk_fma_f32 v[64:65], v[204:205], s[30:31], v[200:201]
    v_pk_fma_f32 v[66:67], v[206:207], s[30:31], v[202:203]
    v_pk_fma_f32 v[200:201], v[200:201], s[30:31], v[204:205]
    v_pk_fma_f32 v[202:203], v[202:203], s[30:31], v[206:207]
    v_cvt_pk_bf16_f32 v216, v200, v201
    v_cvt_pk_bf16_f32 v217, v202, v203
    ds_write_b128 v248, v[214:217] offset:1920
    v_accvgpr_read_b32 v192, a68
    v_accvgpr_read_b32 v193, a69
    v_accvgpr_read_b32 v194, a70
    v_accvgpr_read_b32 v195, a71
    v_accvgpr_read_b32 v196, a164
    v_accvgpr_read_b32 v197, a165
    v_accvgpr_read_b32 v198, a166
    v_accvgpr_read_b32 v199, a167
    v_pk_add_f32 v[192:193], v[192:193], v[196:197]
    v_pk_add_f32 v[194:195], v[194:195], v[198:199]
    v_pk_add_f32 v[196:197], v[68:69], v[164:165]
    v_pk_add_f32 v[198:199], v[70:71], v[166:167]
    v_pk_add_f32 v[164:165], v[68:69], v[164:165] neg_lo:[0,1] neg_hi:[0,1]
    v_pk_add_f32 v[166:167], v[70:71], v[166:167] neg_lo:[0,1] neg_hi:[0,1]
    v_pk_fma_f32 v[68:69], v[196:197], s[30:31], v[192:193]
    v_pk_fma_f32 v[70:71], v[198:199], s[30:31], v[194:195]
    v_pk_fma_f32 v[192:193], v[192:193], s[30:31], v[196:197]
    v_pk_fma_f32 v[194:195], v[194:195], s[30:31], v[198:199]
    v_cvt_pk_bf16_f32 v218, v192, v193
    v_cvt_pk_bf16_f32 v219, v194, v195
    v_accvgpr_read_b32 v192, a72
    v_accvgpr_read_b32 v193, a73
    v_accvgpr_read_b32 v194, a74
    v_accvgpr_read_b32 v195, a75
    v_accvgpr_read_b32 v196, a168
    v_accvgpr_read_b32 v197, a169
    v_accvgpr_read_b32 v198, a170
    v_accvgpr_read_b32 v199, a171
    v_pk_add_f32 v[192:193], v[192:193], v[196:197]
    v_pk_add_f32 v[194:195], v[194:195], v[198:199]
    v_pk_add_f32 v[196:197], v[72:73], v[168:169]
    v_pk_add_f32 v[198:199], v[74:75], v[170:171]
    v_pk_add_f32 v[168:169], v[72:73], v[168:169] neg_lo:[0,1] neg_hi:[0,1]
    v_pk_add_f32 v[170:171], v[74:75], v[170:171] neg_lo:[0,1] neg_hi:[0,1]
    v_pk_fma_f32 v[72:73], v[196:197], s[30:31], v[192:193]
    v_pk_fma_f32 v[74:75], v[198:199], s[30:31], v[194:195]
    v_pk_fma_f32 v[192:193], v[192:193], s[30:31], v[196:197]
    v_pk_fma_f32 v[194:195], v[194:195], s[30:31], v[198:199]
    v_cvt_pk_bf16_f32 v208, v192, v193
    v_cvt_pk_bf16_f32 v209, v194, v195
    ds_write_b64 v249, v[218:219] offset:1984
    v_accvgpr_read_b32 v200, a76
    v_accvgpr_read_b32 v201, a77
    v_accvgpr_read_b32 v202, a78
    v_accvgpr_read_b32 v203, a79
    v_accvgpr_read_b32 v204, a172
    v_accvgpr_read_b32 v205, a173
    v_accvgpr_read_b32 v206, a174
    v_accvgpr_read_b32 v207, a175
    v_pk_add_f32 v[200:201], v[200:201], v[204:205]
    v_pk_add_f32 v[202:203], v[202:203], v[206:207]
    v_pk_add_f32 v[204:205], v[76:77], v[172:173]
    v_pk_add_f32 v[206:207], v[78:79], v[174:175]
    v_pk_add_f32 v[172:173], v[76:77], v[172:173] neg_lo:[0,1] neg_hi:[0,1]
    v_pk_add_f32 v[174:175], v[78:79], v[174:175] neg_lo:[0,1] neg_hi:[0,1]
    v_pk_fma_f32 v[76:77], v[204:205], s[30:31], v[200:201]
    v_pk_fma_f32 v[78:79], v[206:207], s[30:31], v[202:203]
    v_pk_fma_f32 v[200:201], v[200:201], s[30:31], v[204:205]
    v_pk_fma_f32 v[202:203], v[202:203], s[30:31], v[206:207]
    v_cvt_pk_bf16_f32 v210, v200, v201
    v_cvt_pk_bf16_f32 v211, v202, v203
    ds_write_b128 v248, v[208:211] offset:2304
    v_accvgpr_read_b32 v192, a80
    v_accvgpr_read_b32 v193, a81
    v_accvgpr_read_b32 v194, a82
    v_accvgpr_read_b32 v195, a83
    v_accvgpr_read_b32 v196, a176
    v_accvgpr_read_b32 v197, a177
    v_accvgpr_read_b32 v198, a178
    v_accvgpr_read_b32 v199, a179
    v_pk_add_f32 v[192:193], v[192:193], v[196:197]
    v_pk_add_f32 v[194:195], v[194:195], v[198:199]
    v_pk_add_f32 v[196:197], v[80:81], v[176:177]
    v_pk_add_f32 v[198:199], v[82:83], v[178:179]
    v_pk_add_f32 v[176:177], v[80:81], v[176:177] neg_lo:[0,1] neg_hi:[0,1]
    v_pk_add_f32 v[178:179], v[82:83], v[178:179] neg_lo:[0,1] neg_hi:[0,1]
    v_pk_fma_f32 v[80:81], v[196:197], s[30:31], v[192:193]
    v_pk_fma_f32 v[82:83], v[198:199], s[30:31], v[194:195]
    v_pk_fma_f32 v[192:193], v[192:193], s[30:31], v[196:197]
    v_pk_fma_f32 v[194:195], v[194:195], s[30:31], v[198:199]
    v_cvt_pk_bf16_f32 v212, v192, v193
    v_cvt_pk_bf16_f32 v213, v194, v195
    v_accvgpr_read_b32 v192, a84
    v_accvgpr_read_b32 v193, a85
    v_accvgpr_read_b32 v194, a86
    v_accvgpr_read_b32 v195, a87
    v_accvgpr_read_b32 v196, a180
    v_accvgpr_read_b32 v197, a181
    v_accvgpr_read_b32 v198, a182
    v_accvgpr_read_b32 v199, a183
    v_pk_add_f32 v[192:193], v[192:193], v[196:197]
    v_pk_add_f32 v[194:195], v[194:195], v[198:199]
    v_pk_add_f32 v[196:197], v[84:85], v[180:181]
    v_pk_add_f32 v[198:199], v[86:87], v[182:183]
    v_pk_add_f32 v[180:181], v[84:85], v[180:181] neg_lo:[0,1] neg_hi:[0,1]
    v_pk_add_f32 v[182:183], v[86:87], v[182:183] neg_lo:[0,1] neg_hi:[0,1]
    v_pk_fma_f32 v[84:85], v[196:197], s[30:31], v[192:193]
    v_pk_fma_f32 v[86:87], v[198:199], s[30:31], v[194:195]
    v_pk_fma_f32 v[192:193], v[192:193], s[30:31], v[196:197]
    v_pk_fma_f32 v[194:195], v[194:195], s[30:31], v[198:199]
    v_cvt_pk_bf16_f32 v214, v192, v193
    v_cvt_pk_bf16_f32 v215, v194, v195
    ds_write_b64 v249, v[212:213] offset:2368
    v_accvgpr_read_b32 v200, a88
    v_accvgpr_read_b32 v201, a89
    v_accvgpr_read_b32 v202, a90
    v_accvgpr_read_b32 v203, a91
    v_accvgpr_read_b32 v204, a184
    v_accvgpr_read_b32 v205, a185
    v_accvgpr_read_b32 v206, a186
    v_accvgpr_read_b32 v207, a187
    v_pk_add_f32 v[200:201], v[200:201], v[204:205]
    v_pk_add_f32 v[202:203], v[202:203], v[206:207]
    v_pk_add_f32 v[204:205], v[88:89], v[184:185]
    v_pk_add_f32 v[206:207], v[90:91], v[186:187]
    v_pk_add_f32 v[184:185], v[88:89], v[184:185] neg_lo:[0,1] neg_hi:[0,1]
    v_pk_add_f32 v[186:187], v[90:91], v[186:187] neg_lo:[0,1] neg_hi:[0,1]
    v_pk_fma_f32 v[88:89], v[204:205], s[30:31], v[200:201]
    v_pk_fma_f32 v[90:91], v[206:207], s[30:31], v[202:203]
    v_pk_fma_f32 v[200:201], v[200:201], s[30:31], v[204:205]
    v_pk_fma_f32 v[202:203], v[202:203], s[30:31], v[206:207]
    v_cvt_pk_bf16_f32 v216, v200, v201
    v_cvt_pk_bf16_f32 v217, v202, v203
    ds_write_b128 v248, v[214:217] offset:2688
    v_accvgpr_read_b32 v192, a92
    v_accvgpr_read_b32 v193, a93
    v_accvgpr_read_b32 v194, a94
    v_accvgpr_read_b32 v195, a95
    v_accvgpr_read_b32 v196, a188
    v_accvgpr_read_b32 v197, a189
    v_accvgpr_read_b32 v198, a190
    v_accvgpr_read_b32 v199, a191
    v_pk_add_f32 v[192:193], v[192:193], v[196:197]
    v_pk_add_f32 v[194:195], v[194:195], v[198:199]
    v_pk_add_f32 v[196:197], v[92:93], v[188:189]
    v_pk_add_f32 v[198:199], v[94:95], v[190:191]
    v_pk_add_f32 v[188:189], v[92:93], v[188:189] neg_lo:[0,1] neg_hi:[0,1]
    v_pk_add_f32 v[190:191], v[94:95], v[190:191] neg_lo:[0,1] neg_hi:[0,1]
    v_pk_fma_f32 v[92:93], v[196:197], s[30:31], v[192:193]
    v_pk_fma_f32 v[94:95], v[198:199], s[30:31], v[194:195]
    v_pk_fma_f32 v[192:193], v[192:193], s[30:31], v[196:197]
    v_pk_fma_f32 v[194:195], v[194:195], s[30:31], v[198:199]
    v_cvt_pk_bf16_f32 v218, v192, v193
    v_cvt_pk_bf16_f32 v219, v194, v195
    ds_write_b64 v249, v[218:219] offset:2752
    s_waitcnt lgkmcnt(0)
    s_barrier
    v_mfma_f32_16x16x32_bf16 v[0:3], a[192:195], v[228:231], v[0:3]
    v_add_u32 v250, s51, v254
    v_accvgpr_read_b32 v220, a0
    v_mfma_f32_16x16x32_bf16 v[4:7], a[196:199], v[228:231], v[4:7]
    buffer_load_dwordx4 a[244:247], v254, s[8:11], s42 offen offset:1024
    v_accvgpr_read_b32 v221, a1
    v_mfma_f32_16x16x32_bf16 v[8:11], a[200:203], v[228:231], v[8:11]
    ds_read_b128 v[228:231], v253 offset:33536
    v_accvgpr_read_b32 v222, a2
    v_mfma_f32_16x16x32_bf16 v[12:15], a[192:195], v[232:235], v[12:15]
    ds_read_b128 v[204:207], v250 offset:0
    v_accvgpr_read_b32 v223, a3
    v_mfma_f32_16x16x32_bf16 v[16:19], a[196:199], v[232:235], v[16:19]
    ds_read_b128 v[208:211], v250 offset:1024
    v_accvgpr_read_b32 v224, a96
    v_accvgpr_read_b32 v225, a97
    v_mfma_f32_16x16x32_bf16 v[20:23], a[200:203], v[232:235], v[20:23]
    buffer_load_dwordx4 a[248:251], v254, s[8:11], s42 offen offset:2048
    s_waitcnt vmcnt(10)
    v_mfma_f32_16x16x32_bf16 v[0:3], a[204:207], v[232:235], v[0:3]
    ds_read_b128 v[212:215], v250 offset:2048
    v_accvgpr_read_b32 v226, a98
    v_accvgpr_read_b32 v227, a99
    v_mfma_f32_16x16x32_bf16 v[4:7], a[208:211], v[232:235], v[4:7]
    s_mov_b32 s42, 927744
    s_add_u32 s44, s40, 393216
    v_sub_f32 v220, v220, v224
    v_mfma_f32_16x16x32_bf16 v[8:11], a[212:215], v[232:235], v[8:11]
    ds_read_b128 v[232:235], v253 offset:33280
    v_sub_f32 v221, v221, v225
    v_mfma_f32_16x16x32_bf16 v[24:27], a[192:195], v[236:239], v[24:27]
    buffer_load_dwordx4 a[252:255], v254, s[8:11], s42 offen offset:0
    v_sub_f32 v222, v222, v226
    v_mfma_f32_16x16x32_bf16 v[28:31], a[196:199], v[236:239], v[28:31]
    ds_read_b128 v[216:219], v250 offset:3104
    v_sub_f32 v223, v223, v227
    v_mfma_f32_16x16x32_bf16 v[32:35], a[200:203], v[236:239], v[32:35]
    s_waitcnt lgkmcnt(4)
    v_add_f32 v224, v220, v96
    v_add_f32 v225, v221, v97
    v_add_f32 v226, v222, v98
    v_mfma_f32_16x16x32_bf16 v[12:15], a[204:207], v[236:239], v[12:15]
    v_add_f32 v227, v223, v99
    v_mul_f32 v96, s28, v96
    v_mfma_f32_16x16x32_bf16 v[16:19], a[208:211], v[236:239], v[16:19]
    buffer_load_dwordx4 v[240:243], v254, s[8:11], s42 offen offset:1024
    v_mfma_f32_16x16x32_bf16 v[20:23], a[212:215], v[236:239], v[20:23]
    s_waitcnt vmcnt(9)
    v_mul_f32 v97, s28, v97
    v_mul_f32 v98, s28, v98
    v_mul_f32 v99, s28, v99
    v_mfma_f32_16x16x32_bf16 v[0:3], a[216:219], v[236:239], v[0:3]
    v_mul_f32 v224, s26, v224
    v_mul_f32 v225, s26, v225
    v_mfma_f32_16x16x32_bf16 v[4:7], a[220:223], v[236:239], v[4:7]
    buffer_load_dwordx4 v[244:247], v254, s[8:11], s42 offen offset:2048
    v_mul_f32 v226, s26, v226
    v_mfma_f32_16x16x32_bf16 v[8:11], a[224:227], v[236:239], v[8:11]
    ds_read_b128 v[236:239], v253 offset:35104
    v_mul_f32 v227, s26, v227
    v_mfma_f32_16x16x32_bf16 v[36:39], a[192:195], v[228:231], v[36:39]
    v_fmac_f32 v96, s34, v220
    v_fmac_f32 v97, s34, v221
    v_mfma_f32_16x16x32_bf16 v[40:43], a[196:199], v[228:231], v[40:43]
    buffer_store_dwordx4 v[204:207], v254, s[12:15], s44 offen sc1
    s_add_u32 s44, s40, 394240
    v_fmac_f32 v98, s34, v222
    v_fmac_f32 v99, s34, v223
    v_mfma_f32_16x16x32_bf16 v[44:47], a[200:203], v[228:231], v[44:47]
    v_cvt_pk_bf16_f32 v192, v224, v225
    v_cvt_pk_bf16_f32 v193, v226, v227
    v_mfma_f32_16x16x32_bf16 v[24:27], a[204:207], v[228:231], v[24:27]
    v_accvgpr_write_b32 a0, v192
    v_accvgpr_write_b32 a1, v193
    v_accvgpr_read_b32 v220, a4
    v_mfma_f32_16x16x32_bf16 v[28:31], a[208:211], v[228:231], v[28:31]
    v_accvgpr_read_b32 v221, a5
    v_accvgpr_read_b32 v222, a6
    v_mfma_f32_16x16x32_bf16 v[32:35], a[212:215], v[228:231], v[32:35]
    s_waitcnt lgkmcnt(4)
    v_accvgpr_read_b32 v223, a7
    v_accvgpr_read_b32 v224, a100
    v_mfma_f32_16x16x32_bf16 v[12:15], a[216:219], v[228:231], v[12:15]
    v_accvgpr_read_b32 v225, a101
    v_accvgpr_read_b32 v226, a102
    v_accvgpr_read_b32 v227, a103
    v_mfma_f32_16x16x32_bf16 v[16:19], a[220:223], v[228:231], v[16:19]
    s_waitcnt lgkmcnt(2)
    v_sub_f32 v220, v220, v224
    v_sub_f32 v221, v221, v225
    v_mfma_f32_16x16x32_bf16 v[20:23], a[224:227], v[228:231], v[20:23]
    ds_read_b128 v[228:231], v253 offset:34848
    v_sub_f32 v222, v222, v226
    v_sub_f32 v223, v223, v227
    v_mfma_f32_16x16x32_bf16 v[48:51], a[192:195], v[232:235], v[48:51]
    buffer_store_dwordx4 v[208:211], v254, s[12:15], s44 offen sc1
    v_add_f32 v224, v220, v100
    v_add_f32 v225, v221, v101
    v_mfma_f32_16x16x32_bf16 v[52:55], a[196:199], v[232:235], v[52:55]
    v_add_f32 v226, v222, v102
    v_add_f32 v227, v223, v103
    v_mfma_f32_16x16x32_bf16 v[56:59], a[200:203], v[232:235], v[56:59]
    ds_read_b128 v[204:207], v250 offset:4128
    v_mul_f32 v100, s28, v100
    v_mul_f32 v101, s28, v101
    v_mfma_f32_16x16x32_bf16 v[36:39], a[204:207], v[232:235], v[36:39]
    ds_read_b128 v[208:211], v250 offset:5152
    v_mul_f32 v102, s28, v102
    v_mfma_f32_16x16x32_bf16 v[40:43], a[208:211], v[232:235], v[40:43]
    s_add_u32 s44, s40, 395264
    v_mul_f32 v103, s28, v103
    v_mul_f32 v224, s26, v224
    v_mul_f32 v225, s26, v225
    v_mfma_f32_16x16x32_bf16 v[44:47], a[212:215], v[232:235], v[44:47]
    v_mul_f32 v226, s26, v226
    v_mul_f32 v227, s26, v227
    v_mfma_f32_16x16x32_bf16 v[24:27], a[216:219], v[232:235], v[24:27]
    v_fmac_f32 v100, s34, v220
    v_fmac_f32 v101, s34, v221
    v_mfma_f32_16x16x32_bf16 v[28:31], a[220:223], v[232:235], v[28:31]
    s_waitcnt lgkmcnt(3)
    v_fmac_f32 v102, s34, v222
    v_fmac_f32 v103, s34, v223
    v_cvt_pk_bf16_f32 v194, v224, v225
    v_mfma_f32_16x16x32_bf16 v[32:35], a[224:227], v[232:235], v[32:35]
    ds_read_b128 v[232:235], v253 offset:34592
    v_mfma_f32_16x16x32_bf16 v[60:63], a[192:195], v[236:239], v[60:63]
    v_cvt_pk_bf16_f32 v195, v226, v227
    v_accvgpr_write_b32 a2, v194
    v_accvgpr_write_b32 a3, v195
    v_mfma_f32_16x16x32_bf16 v[64:67], a[196:199], v[236:239], v[64:67]
    v_accvgpr_read_b32 v220, a8
    v_accvgpr_read_b32 v221, a9
    v_mfma_f32_16x16x32_bf16 v[68:71], a[200:203], v[236:239], v[68:71]
    v_accvgpr_read_b32 v222, a10
    v_accvgpr_read_b32 v223, a11
    v_mfma_f32_16x16x32_bf16 v[48:51], a[204:207], v[236:239], v[48:51]
    buffer_store_dwordx4 v[212:215], v254, s[12:15], s44 offen sc1
    v_accvgpr_read_b32 v224, a104
    v_accvgpr_read_b32 v225, a105
    v_accvgpr_read_b32 v226, a106
    v_mfma_f32_16x16x32_bf16 v[52:55], a[208:211], v[236:239], v[52:55]
    v_accvgpr_read_b32 v227, a107
    v_sub_f32 v220, v220, v224
    v_mfma_f32_16x16x32_bf16 v[56:59], a[212:215], v[236:239], v[56:59]
    v_sub_f32 v221, v221, v225
    v_sub_f32 v222, v222, v226
    v_sub_f32 v223, v223, v227
    v_mfma_f32_16x16x32_bf16 v[36:39], a[216:219], v[236:239], v[36:39]
    s_waitcnt lgkmcnt(3)
    v_add_f32 v224, v220, v104
    v_add_f32 v225, v221, v105
    v_mfma_f32_16x16x32_bf16 v[40:43], a[220:223], v[236:239], v[40:43]
    s_add_u32 s44, s40, 396288
    v_add_f32 v226, v222, v106
    v_add_f32 v227, v223, v107
    v_mfma_f32_16x16x32_bf16 v[44:47], a[224:227], v[236:239], v[44:47]
    ds_read_b128 v[236:239], v253 offset:34336
    v_mul_f32 v104, s28, v104
    v_mul_f32 v105, s28, v105
    v_mfma_f32_16x16x32_bf16 v[72:75], a[192:195], v[228:231], v[72:75]
    v_mul_f32 v106, s28, v106
    v_mul_f32 v107, s28, v107
    v_mfma_f32_16x16x32_bf16 v[76:79], a[196:199], v[228:231], v[76:79]
    v_mul_f32 v224, s26, v224
    v_mul_f32 v225, s26, v225
    v_mul_f32 v226, s26, v226
    v_mfma_f32_16x16x32_bf16 v[80:83], a[200:203], v[228:231], v[80:83]
    v_mul_f32 v227, s26, v227
    v_fmac_f32 v104, s34, v220
    v_mfma_f32_16x16x32_bf16 v[60:63], a[204:207], v[228:231], v[60:63]
    v_fmac_f32 v105, s34, v221
    v_fmac_f32 v106, s34, v222
    v_mfma_f32_16x16x32_bf16 v[64:67], a[208:211], v[228:231], v[64:67]
    v_fmac_f32 v107, s34, v223
    v_cvt_pk_bf16_f32 v196, v224, v225
    v_cvt_pk_bf16_f32 v197, v226, v227
    v_mfma_f32_16x16x32_bf16 v[68:71], a[212:215], v[228:231], v[68:71]
    v_accvgpr_write_b32 a4, v196
    v_accvgpr_write_b32 a5, v197
    v_mfma_f32_16x16x32_bf16 v[48:51], a[216:219], v[228:231], v[48:51]
    s_waitcnt lgkmcnt(1)
    v_accvgpr_read_b32 v220, a12
    v_accvgpr_read_b32 v221, a13
    v_accvgpr_read_b32 v222, a14
    v_mfma_f32_16x16x32_bf16 v[52:55], a[220:223], v[228:231], v[52:55]
    buffer_store_dwordx4 v[216:219], v254, s[12:15], s44 offen sc1
    v_accvgpr_read_b32 v223, a15
    v_accvgpr_read_b32 v224, a108
    v_mfma_f32_16x16x32_bf16 v[56:59], a[224:227], v[228:231], v[56:59]
    ds_read_b128 v[228:231], v253 offset:34064
    v_accvgpr_read_b32 v225, a109
    v_mfma_f32_16x16x32_bf16 v[84:87], a[192:195], v[232:235], v[84:87]
    v_accvgpr_read_b32 v226, a110
    v_accvgpr_read_b32 v227, a111
    v_sub_f32 v220, v220, v224
    v_mfma_f32_16x16x32_bf16 v[88:91], a[196:199], v[232:235], v[88:91]
    v_sub_f32 v221, v221, v225
    v_sub_f32 v222, v222, v226
    v_mfma_f32_16x16x32_bf16 v[92:95], a[200:203], v[232:235], v[92:95]
    s_mov_b32 s42, 958464
    v_sub_f32 v223, v223, v227
    v_add_f32 v224, v220, v108
    v_add_f32 v225, v221, v109
    v_mfma_f32_16x16x32_bf16 v[72:75], a[204:207], v[232:235], v[72:75]
    buffer_load_dwordx4 a[192:195], v254, s[8:11], s42 offen offset:0
    v_mfma_f32_16x16x32_bf16 v[76:79], a[208:211], v[232:235], v[76:79]
    v_add_f32 v226, v222, v110
    v_add_f32 v227, v223, v111
    v_mfma_f32_16x16x32_bf16 v[80:83], a[212:215], v[232:235], v[80:83]
    v_mul_f32 v108, s28, v108
    v_mul_f32 v109, s28, v109
    v_mul_f32 v110, s28, v110
    v_mfma_f32_16x16x32_bf16 v[60:63], a[216:219], v[232:235], v[60:63]
    buffer_load_dwordx4 a[196:199], v254, s[8:11], s42 offen offset:1024
    v_mfma_f32_16x16x32_bf16 v[64:67], a[220:223], v[232:235], v[64:67]
    v_mul_f32 v111, s28, v111
    v_mul_f32 v224, s26, v224
    v_mul_f32 v225, s26, v225
    v_mfma_f32_16x16x32_bf16 v[68:71], a[224:227], v[232:235], v[68:71]
    s_waitcnt lgkmcnt(1)
    v_mul_f32 v226, s26, v226
    v_mul_f32 v227, s26, v227
    v_mfma_f32_16x16x32_bf16 v[84:87], a[204:207], v[236:239], v[84:87]
    ds_read_b128 v[232:235], v253 offset:15600
    v_fmac_f32 v108, s34, v220
    v_mfma_f32_16x16x32_bf16 v[88:91], a[208:211], v[236:239], v[88:91]
    v_fmac_f32 v109, s34, v221
    v_fmac_f32 v110, s34, v222
    v_fmac_f32 v111, s34, v223
    v_mfma_f32_16x16x32_bf16 v[92:95], a[212:215], v[236:239], v[92:95]
    buffer_load_dwordx4 a[200:203], v254, s[8:11], s42 offen offset:2048
    v_mfma_f32_16x16x32_bf16 v[72:75], a[216:219], v[236:239], v[72:75]
    s_waitcnt lgkmcnt(1)
    v_cvt_pk_bf16_f32 v198, v224, v225
    v_cvt_pk_bf16_f32 v199, v226, v227
    v_accvgpr_write_b32 a12, v198
    v_mfma_f32_16x16x32_bf16 v[76:79], a[220:223], v[236:239], v[76:79]
    s_mov_b32 s42, 961536
    v_accvgpr_write_b32 a13, v199
    v_accvgpr_read_b32 v220, a16
    v_mfma_f32_16x16x32_bf16 v[80:83], a[224:227], v[236:239], v[80:83]
    ds_read_b128 v[236:239], v253 offset:15328
    v_accvgpr_read_b32 v221, a17
    v_mfma_f32_16x16x32_bf16 v[84:87], a[216:219], v[228:231], v[84:87]
    buffer_load_dwordx4 a[204:207], v254, s[8:11], s42 offen offset:0
    v_accvgpr_read_b32 v222, a18
    v_mfma_f32_16x16x32_bf16 v[88:91], a[220:223], v[228:231], v[88:91]
    s_waitcnt vmcnt(14) lgkmcnt(1)
    v_accvgpr_read_b32 v223, a19
    v_accvgpr_read_b32 v224, a112
    v_mfma_f32_16x16x32_bf16 v[92:95], a[224:227], v[228:231], v[92:95]
    ds_read_b128 v[228:231], v253 offset:15072
    v_accvgpr_read_b32 v225, a113
    v_accvgpr_read_b32 v226, a114
    v_mfma_f32_16x16x32_bf16 v[0:3], a[228:231], v[232:235], v[0:3]
    s_waitcnt lgkmcnt(1)
    v_accvgpr_read_b32 v227, a115
    v_sub_f32 v220, v220, v224
    v_mfma_f32_16x16x32_bf16 v[4:7], a[232:235], v[232:235], v[4:7]
    buffer_load_dwordx4 a[208:211], v254, s[8:11], s42 offen offset:1024
    v_mfma_f32_16x16x32_bf16 v[8:11], a[236:239], v[232:235], v[8:11]
    ds_read_b128 v[232:235], v253 offset:14816
    v_sub_f32 v221, v221, v225
    v_sub_f32 v222, v222, v226
    v_mfma_f32_16x16x32_bf16 v[12:15], a[228:231], v[236:239], v[12:15]
    v_sub_f32 v223, v223, v227
    v_add_f32 v224, v220, v112
    v_mfma_f32_16x16x32_bf16 v[16:19], a[232:235], v[236:239], v[16:19]
    s_waitcnt vmcnt(12)
    v_add_f32 v225, v221, v113
    v_add_f32 v226, v222, v114
    v_add_f32 v227, v223, v115
    v_mfma_f32_16x16x32_bf16 v[20:23], a[236:239], v[236:239], v[20:23]
    buffer_load_dwordx4 a[212:215], v254, s[8:11], s42 offen offset:2048
    v_mfma_f32_16x16x32_bf16 v[0:3], a[240:243], v[236:239], v[0:3]
    s_waitcnt lgkmcnt(1)
    v_mul_f32 v112, s28, v112
    v_mul_f32 v113, s28, v113
    v_mfma_f32_16x16x32_bf16 v[4:7], a[244:247], v[236:239], v[4:7]
    s_mov_b32 s42, 964608
    v_mul_f32 v114, s28, v114
    v_mul_f32 v115, s28, v115
    v_mul_f32 v224, s26, v224
    v_mfma_f32_16x16x32_bf16 v[8:11], a[248:251], v[236:239], v[8:11]
    ds_read_b128 v[236:239], v253 offset:14560
    v_mul_f32 v225, s26, v225
    v_mfma_f32_16x16x32_bf16 v[24:27], a[228:231], v[228:231], v[24:27]
    buffer_load_dwordx4 a[216:219], v254, s[8:11], s42 offen offset:0
    v_mul_f32 v226, s26, v226
    v_mfma_f32_16x16x32_bf16 v[28:31], a[232:235], v[228:231], v[28:31]
    v_mul_f32 v227, s26, v227
    v_fmac_f32 v112, s34, v220
    v_mfma_f32_16x16x32_bf16 v[32:35], a[236:239], v[228:231], v[32:35]
    v_fmac_f32 v113, s34, v221
    v_fmac_f32 v114, s34, v222
    v_mfma_f32_16x16x32_bf16 v[12:15], a[240:243], v[228:231], v[12:15]
    v_fmac_f32 v115, s34, v223
    v_cvt_pk_bf16_f32 v200, v224, v225
    v_cvt_pk_bf16_f32 v201, v226, v227
    v_mfma_f32_16x16x32_bf16 v[16:19], a[244:247], v[228:231], v[16:19]
    buffer_load_dwordx4 a[220:223], v254, s[8:11], s42 offen offset:1024
    v_mfma_f32_16x16x32_bf16 v[20:23], a[248:251], v[228:231], v[20:23]
    s_waitcnt vmcnt(12)
    v_accvgpr_write_b32 a14, v200
    v_accvgpr_write_b32 a15, v201
    v_accvgpr_read_b32 v220, a20
    v_mfma_f32_16x16x32_bf16 v[0:3], a[252:255], v[228:231], v[0:3]
    s_waitcnt lgkmcnt(1)
    v_accvgpr_read_b32 v221, a21
    v_accvgpr_read_b32 v222, a22
    v_mfma_f32_16x16x32_bf16 v[4:7], v[240:243], v[228:231], v[4:7]
    buffer_load_dwordx4 a[224:227], v254, s[8:11], s42 offen offset:2048
    v_mfma_f32_16x16x32_bf16 v[8:11], v[244:247], v[228:231], v[8:11]
    ds_read_b128 v[228:231], v253 offset:16384
    v_accvgpr_read_b32 v223, a23
    v_accvgpr_read_b32 v224, a116
    v_mfma_f32_16x16x32_bf16 v[36:39], a[228:231], v[232:235], v[36:39]
    s_add_u32 s44, s40, 397312
    v_accvgpr_read_b32 v225, a117
    v_accvgpr_read_b32 v226, a118
    v_mfma_f32_16x16x32_bf16 v[40:43], a[232:235], v[232:235], v[40:43]
    v_accvgpr_read_b32 v227, a119
    v_sub_f32 v220, v220, v224
    v_sub_f32 v221, v221, v225
    v_mfma_f32_16x16x32_bf16 v[44:47], a[236:239], v[232:235], v[44:47]
    v_sub_f32 v222, v222, v226
    v_sub_f32 v223, v223, v227
    v_mfma_f32_16x16x32_bf16 v[24:27], a[240:243], v[232:235], v[24:27]
    v_add_f32 v224, v220, v116
    v_add_f32 v225, v221, v117
    v_mfma_f32_16x16x32_bf16 v[28:31], a[244:247], v[232:235], v[28:31]
    v_add_f32 v226, v222, v118
    v_add_f32 v227, v223, v119
    v_mul_f32 v116, s28, v116
    v_mfma_f32_16x16x32_bf16 v[32:35], a[248:251], v[232:235], v[32:35]
    v_mul_f32 v117, s28, v117
    v_mul_f32 v118, s28, v118
    v_mfma_f32_16x16x32_bf16 v[12:15], a[252:255], v[232:235], v[12:15]
    v_mul_f32 v119, s28, v119
    v_mul_f32 v224, s26, v224
    v_mul_f32 v225, s26, v225
    v_mfma_f32_16x16x32_bf16 v[16:19], v[240:243], v[232:235], v[16:19]
    s_waitcnt lgkmcnt(1)
    v_mul_f32 v226, s26, v226
    v_mul_f32 v227, s26, v227
    v_mfma_f32_16x16x32_bf16 v[20:23], v[244:247], v[232:235], v[20:23]
    ds_read_b128 v[232:235], v253 offset:16128
    v_fmac_f32 v116, s34, v220
    v_mfma_f32_16x16x32_bf16 v[48:51], a[228:231], v[236:239], v[48:51]
    v_fmac_f32 v117, s34, v221
    v_fmac_f32 v118, s34, v222
    v_fmac_f32 v119, s34, v223
    v_mfma_f32_16x16x32_bf16 v[52:55], a[232:235], v[236:239], v[52:55]
    v_cvt_pk_bf16_f32 v202, v224, v225
    v_cvt_pk_bf16_f32 v203, v226, v227
    v_mfma_f32_16x16x32_bf16 v[56:59], a[236:239], v[236:239], v[56:59]
    v_accvgpr_write_b32 a16, v202
    v_accvgpr_write_b32 a17, v203
    v_accvgpr_read_b32 v220, a24
    v_mfma_f32_16x16x32_bf16 v[36:39], a[240:243], v[236:239], v[36:39]
    v_accvgpr_read_b32 v221, a25
    v_accvgpr_read_b32 v222, a26
    v_mfma_f32_16x16x32_bf16 v[40:43], a[244:247], v[236:239], v[40:43]
    buffer_store_dwordx4 v[204:207], v254, s[12:15], s44 offen sc1
    v_accvgpr_read_b32 v223, a27
    v_accvgpr_read_b32 v224, a120
    v_mfma_f32_16x16x32_bf16 v[44:47], a[248:251], v[236:239], v[44:47]
    v_accvgpr_read_b32 v225, a121
    v_accvgpr_read_b32 v226, a122
    v_accvgpr_read_b32 v227, a123
    v_mfma_f32_16x16x32_bf16 v[24:27], a[252:255], v[236:239], v[24:27]
    v_sub_f32 v220, v220, v224
    v_sub_f32 v221, v221, v225
    v_mfma_f32_16x16x32_bf16 v[28:31], v[240:243], v[236:239], v[28:31]
    s_waitcnt lgkmcnt(1)
    v_sub_f32 v222, v222, v226
    v_sub_f32 v223, v223, v227
    v_add_f32 v224, v220, v120
    v_mfma_f32_16x16x32_bf16 v[32:35], v[244:247], v[236:239], v[32:35]
    ds_read_b128 v[236:239], v253 offset:15872
    v_add_f32 v225, v221, v121
    v_mfma_f32_16x16x32_bf16 v[60:63], a[228:231], v[228:231], v[60:63]
    v_add_f32 v226, v222, v122
    v_add_f32 v227, v223, v123
    v_mfma_f32_16x16x32_bf16 v[64:67], a[232:235], v[228:231], v[64:67]
    v_mul_f32 v120, s28, v120
    v_mul_f32 v121, s28, v121
    v_mul_f32 v122, s28, v122
    v_mfma_f32_16x16x32_bf16 v[68:71], a[236:239], v[228:231], v[68:71]
    ds_read_b128 a[96:99], v250 offset:6208
    s_add_u32 s44, s40, 398336
    v_mfma_f32_16x16x32_bf16 v[48:51], a[240:243], v[228:231], v[48:51]
    v_mul_f32 v123, s28, v123
    v_mul_f32 v224, s26, v224
    v_mul_f32 v225, s26, v225
    v_mfma_f32_16x16x32_bf16 v[52:55], a[244:247], v[228:231], v[52:55]
    v_mul_f32 v226, s26, v226
    v_mul_f32 v227, s26, v227
    v_mfma_f32_16x16x32_bf16 v[56:59], a[248:251], v[228:231], v[56:59]
    ds_read_b128 a[100:103], v250 offset:7232
    v_fmac_f32 v120, s34, v220
    v_mfma_f32_16x16x32_bf16 v[36:39], a[252:255], v[228:231], v[36:39]
    v_fmac_f32 v121, s34, v221
    v_fmac_f32 v122, s34, v222
    v_fmac_f32 v123, s34, v223
    v_mfma_f32_16x16x32_bf16 v[40:43], v[240:243], v[228:231], v[40:43]
    s_waitcnt lgkmcnt(3)
    v_cvt_pk_bf16_f32 v192, v224, v225
    v_cvt_pk_bf16_f32 v193, v226, v227
    v_mfma_f32_16x16x32_bf16 v[44:47], v[244:247], v[228:231], v[44:47]
    ds_read_b128 v[228:231], v253 offset:15616
    v_accvgpr_write_b32 a24, v192
    v_accvgpr_write_b32 a25, v193
    v_mfma_f32_16x16x32_bf16 v[72:75], a[228:231], v[232:235], v[72:75]
    ds_read_b128 a[104:107], v250 offset:8256
    v_mfma_f32_16x16x32_bf16 v[76:79], a[232:235], v[232:235], v[76:79]
    v_accvgpr_read_b32 v220, a28
    v_accvgpr_read_b32 v221, a29
    v_mfma_f32_16x16x32_bf16 v[80:83], a[236:239], v[232:235], v[80:83]
    v_accvgpr_read_b32 v222, a30
    v_accvgpr_read_b32 v223, a31
    v_accvgpr_read_b32 v224, a124
    v_mfma_f32_16x16x32_bf16 v[60:63], a[240:243], v[232:235], v[60:63]
    ds_read_b128 a[108:111], v250 offset:9312
    v_accvgpr_read_b32 v225, a125
    v_mfma_f32_16x16x32_bf16 v[64:67], a[244:247], v[232:235], v[64:67]
    v_accvgpr_read_b32 v226, a126
    v_accvgpr_read_b32 v227, a127
    v_sub_f32 v220, v220, v224
    v_mfma_f32_16x16x32_bf16 v[68:71], a[248:251], v[232:235], v[68:71]
    s_waitcnt lgkmcnt(5)
    v_sub_f32 v221, v221, v225
    v_sub_f32 v222, v222, v226
    v_mfma_f32_16x16x32_bf16 v[48:51], a[252:255], v[232:235], v[48:51]
    buffer_store_dwordx4 v[208:211], v254, s[12:15], s44 offen sc1
    v_sub_f32 v223, v223, v227
    v_add_f32 v224, v220, v124
    v_mfma_f32_16x16x32_bf16 v[52:55], v[240:243], v[232:235], v[52:55]
    ds_read_b128 a[112:115], v250 offset:10336
    v_add_f32 v225, v221, v125
    v_add_f32 v226, v222, v126
    v_mfma_f32_16x16x32_bf16 v[56:59], v[244:247], v[232:235], v[56:59]
    ds_read_b128 v[232:235], v253 offset:15344
    v_add_f32 v227, v223, v127
    v_mfma_f32_16x16x32_bf16 v[84:87], a[228:231], v[236:239], v[84:87]
    v_mul_f32 v124, s28, v124
    v_mul_f32 v125, s28, v125
    v_mul_f32 v126, s28, v126
    v_mfma_f32_16x16x32_bf16 v[88:91], a[232:235], v[236:239], v[88:91]
    ds_read_b128 a[116:119], v250 offset:11360
    v_mul_f32 v127, s28, v127
    v_mfma_f32_16x16x32_bf16 v[92:95], a[236:239], v[236:239], v[92:95]
    s_mov_b32 s42, 995328
    v_mul_f32 v224, s26, v224
    v_mul_f32 v225, s26, v225
    v_mfma_f32_16x16x32_bf16 v[72:75], a[240:243], v[236:239], v[72:75]
    buffer_load_dwordx4 a[228:231], v254, s[8:11], s42 offen offset:0
    v_mul_f32 v226, s26, v226
    v_mfma_f32_16x16x32_bf16 v[76:79], a[244:247], v[236:239], v[76:79]
    s_add_u32 s44, s40, 399360
    v_mul_f32 v227, s26, v227
    v_fmac_f32 v124, s34, v220
    v_mfma_f32_16x16x32_bf16 v[80:83], a[248:251], v[236:239], v[80:83]
    s_waitcnt lgkmcnt(5)
    v_fmac_f32 v125, s34, v221
    v_fmac_f32 v126, s34, v222
    v_fmac_f32 v127, s34, v223
    v_mfma_f32_16x16x32_bf16 v[60:63], a[252:255], v[236:239], v[60:63]
    buffer_load_dwordx4 a[232:235], v254, s[8:11], s42 offen offset:1024
    v_mfma_f32_16x16x32_bf16 v[64:67], v[240:243], v[236:239], v[64:67]
    s_waitcnt lgkmcnt(0)
    v_cvt_pk_bf16_f32 v194, v224, v225
    v_cvt_pk_bf16_f32 v195, v226, v227
    v_mfma_f32_16x16x32_bf16 v[68:71], v[244:247], v[236:239], v[68:71]
    s_barrier
    v_accvgpr_write_b32 a26, v194
    v_mfma_f32_16x16x32_bf16 v[84:87], a[240:243], v[228:231], v[84:87]
    ds_read_b128 v[236:239], v253 offset:17680
    v_accvgpr_write_b32 a27, v195
    v_mfma_f32_16x16x32_bf16 v[88:91], a[244:247], v[228:231], v[88:91]
    ds_write_b128 v248, a[0:3] offset:0
    v_accvgpr_read_b32 v220, a32
    v_mfma_f32_16x16x32_bf16 v[92:95], a[248:251], v[228:231], v[92:95]
    buffer_load_dwordx4 a[236:239], v254, s[8:11], s42 offen offset:2048
    v_mfma_f32_16x16x32_bf16 v[72:75], a[252:255], v[228:231], v[72:75]
    v_accvgpr_read_b32 v221, a33
    v_accvgpr_read_b32 v222, a34
    v_mfma_f32_16x16x32_bf16 v[76:79], v[240:243], v[228:231], v[76:79]
    s_mov_b32 s42, 998400
    v_accvgpr_read_b32 v223, a35
    v_accvgpr_read_b32 v224, a128
    v_accvgpr_read_b32 v225, a129
    v_mfma_f32_16x16x32_bf16 v[80:83], v[244:247], v[228:231], v[80:83]
    ds_read_b128 v[228:231], v253 offset:17408
    v_accvgpr_read_b32 v226, a130
    v_mfma_f32_16x16x32_bf16 v[84:87], a[252:255], v[232:235], v[84:87]
    buffer_load_dwordx4 a[240:243], v254, s[8:11], s42 offen offset:0
    v_accvgpr_read_b32 v227, a131
    v_mfma_f32_16x16x32_bf16 v[88:91], v[240:243], v[232:235], v[88:91]
    s_waitcnt vmcnt(12) lgkmcnt(2)
    v_sub_f32 v220, v220, v224
    v_sub_f32 v221, v221, v225
    v_mfma_f32_16x16x32_bf16 v[92:95], v[244:247], v[232:235], v[92:95]
    ds_read_b128 v[232:235], v253 offset:17152
    v_sub_f32 v222, v222, v226
    v_mfma_f32_16x16x32_bf16 v[0:3], a[192:195], v[236:239], v[0:3]
    s_waitcnt lgkmcnt(1)
    v_sub_f32 v223, v223, v227
    v_add_f32 v224, v220, v128
    v_add_f32 v225, v221, v129
    v_mfma_f32_16x16x32_bf16 v[4:7], a[196:199], v[236:239], v[4:7]
    buffer_load_dwordx4 a[244:247], v254, s[8:11], s42 offen offset:1024
    v_mfma_f32_16x16x32_bf16 v[8:11], a[200:203], v[236:239], v[8:11]
    ds_read_b128 v[236:239], v253 offset:16896
    v_add_f32 v226, v222, v130
    v_add_f32 v227, v223, v131
    v_mfma_f32_16x16x32_bf16 v[12:15], a[192:195], v[228:231], v[12:15]
    ds_write_b64 v249, a[4:5] offset:64
    v_mfma_f32_16x16x32_bf16 v[16:19], a[196:199], v[228:231], v[16:19]
    s_waitcnt vmcnt(10)
    v_mul_f32 v128, s28, v128
    v_mul_f32 v129, s28, v129
    v_mfma_f32_16x16x32_bf16 v[20:23], a[200:203], v[228:231], v[20:23]
    buffer_load_dwordx4 a[248:251], v254, s[8:11], s42 offen offset:2048
    v_mul_f32 v130, s28, v130
    v_mfma_f32_16x16x32_bf16 v[0:3], a[204:207], v[228:231], v[0:3]
    s_waitcnt lgkmcnt(2)
    v_mul_f32 v131, s28, v131
    v_mul_f32 v224, s26, v224
    v_mfma_f32_16x16x32_bf16 v[4:7], a[208:211], v[228:231], v[4:7]
    s_mov_b32 s42, 1001472
    v_mul_f32 v225, s26, v225
    v_mul_f32 v226, s26, v226
    v_mul_f32 v227, s26, v227
    v_mfma_f32_16x16x32_bf16 v[8:11], a[212:215], v[228:231], v[8:11]
    ds_read_b128 v[228:231], v253 offset:16640
    v_fmac_f32 v128, s34, v220
    v_mfma_f32_16x16x32_bf16 v[24:27], a[192:195], v[232:235], v[24:27]
    buffer_load_dwordx4 a[252:255], v254, s[8:11], s42 offen offset:0
    v_mfma_f32_16x16x32_bf16 v[28:31], a[196:199], v[232:235], v[28:31]
    v_fmac_f32 v129, s34, v221
    v_fmac_f32 v130, s34, v222
    v_fmac_f32 v131, s34, v223
    v_mfma_f32_16x16x32_bf16 v[32:35], a[200:203], v[232:235], v[32:35]
    ds_write_b128 v248, a[12:15] offset:384
    v_mfma_f32_16x16x32_bf16 v[12:15], a[204:207], v[232:235], v[12:15]
    v_cvt_pk_bf16_f32 v196, v224, v225
    v_cvt_pk_bf16_f32 v197, v226, v227
    v_accvgpr_write_b32 a28, v196
    v_mfma_f32_16x16x32_bf16 v[16:19], a[208:211], v[232:235], v[16:19]
    buffer_load_dwordx4 v[240:243], v254, s[8:11], s42 offen offset:1024
    v_mfma_f32_16x16x32_bf16 v[20:23], a[212:215], v[232:235], v[20:23]
    s_waitcnt vmcnt(10)
    v_accvgpr_write_b32 a29, v197
    v_accvgpr_read_b32 v220, a36
    v_mfma_f32_16x16x32_bf16 v[0:3], a[216:219], v[232:235], v[0:3]
    s_waitcnt lgkmcnt(3)
    v_accvgpr_read_b32 v221, a37
    v_accvgpr_read_b32 v222, a38
    v_accvgpr_read_b32 v223, a39
    v_mfma_f32_16x16x32_bf16 v[4:7], a[220:223], v[232:235], v[4:7]
    buffer_load_dwordx4 v[244:247], v254, s[8:11], s42 offen offset:2048
    v_mfma_f32_16x16x32_bf16 v[8:11], a[224:227], v[232:235], v[8:11]
    ds_read_b128 v[232:235], v253 offset:18464
    v_accvgpr_read_b32 v224, a132
    v_accvgpr_read_b32 v225, a133
    v_mfma_f32_16x16x32_bf16 v[36:39], a[192:195], v[236:239], v[36:39]
    v_accvgpr_read_b32 v226, a134
    v_accvgpr_read_b32 v227, a135
    v_mfma_f32_16x16x32_bf16 v[40:43], a[196:199], v[236:239], v[40:43]
    buffer_store_dwordx4 a[96:99], v254, s[12:15], s44 offen sc1
    s_add_u32 s44, s40, 400384
    v_mfma_f32_16x16x32_bf16 v[44:47], a[200:203], v[236:239], v[44:47]
    ds_write_b64 v249, a[16:17] offset:448
    v_sub_f32 v220, v220, v224
    v_mfma_f32_16x16x32_bf16 v[24:27], a[204:207], v[236:239], v[24:27]
    v_sub_f32 v221, v221, v225
    v_sub_f32 v222, v222, v226
    v_mfma_f32_16x16x32_bf16 v[28:31], a[208:211], v[236:239], v[28:31]
    buffer_store_dwordx4 a[100:103], v254, s[12:15], s44 offen sc1
    v_sub_f32 v223, v223, v227
    v_add_f32 v224, v220, v132
    v_add_f32 v225, v221, v133
    v_mfma_f32_16x16x32_bf16 v[32:35], a[212:215], v[236:239], v[32:35]
    v_add_f32 v226, v222, v134
    v_add_f32 v227, v223, v135
    v_mfma_f32_16x16x32_bf16 v[12:15], a[216:219], v[236:239], v[12:15]
    v_mul_f32 v132, s28, v132
    v_mul_f32 v133, s28, v133
    v_mfma_f32_16x16x32_bf16 v[16:19], a[220:223], v[236:239], v[16:19]
    s_waitcnt lgkmcnt(3)
    v_mul_f32 v134, s28, v134
    v_mul_f32 v135, s28, v135
    v_mul_f32 v224, s26, v224
    v_mfma_f32_16x16x32_bf16 v[20:23], a[224:227], v[236:239], v[20:23]
    ds_read_b128 v[236:239], v253 offset:18208
    v_mul_f32 v225, s26, v225
    v_mfma_f32_16x16x32_bf16 v[48:51], a[192:195], v[228:231], v[48:51]
    s_add_u32 s44, s40, 401408
    v_mul_f32 v226, s26, v226
    v_mul_f32 v227, s26, v227
    v_fmac_f32 v132, s34, v220
    v_mfma_f32_16x16x32_bf16 v[52:55], a[196:199], v[228:231], v[52:55]
    v_fmac_f32 v133, s34, v221
    v_fmac_f32 v134, s34, v222
    v_mfma_f32_16x16x32_bf16 v[56:59], a[200:203], v[228:231], v[56:59]
    v_fmac_f32 v135, s34, v223
    v_cvt_pk_bf16_f32 v198, v224, v225
    v_mfma_f32_16x16x32_bf16 v[36:39], a[204:207], v[228:231], v[36:39]
    v_cvt_pk_bf16_f32 v199, v226, v227
    v_accvgpr_read_b32 v220, a40
    v_accvgpr_read_b32 v221, a41
    v_mfma_f32_16x16x32_bf16 v[40:43], a[208:211], v[228:231], v[40:43]
    v_accvgpr_read_b32 v222, a42
    v_accvgpr_read_b32 v223, a43
    v_mfma_f32_16x16x32_bf16 v[44:47], a[212:215], v[228:231], v[44:47]
    v_accvgpr_read_b32 v224, a136
    v_accvgpr_read_b32 v225, a137
    v_accvgpr_read_b32 v226, a138
    v_mfma_f32_16x16x32_bf16 v[24:27], a[216:219], v[228:231], v[24:27]
    v_accvgpr_read_b32 v227, a139
    v_sub_f32 v220, v220, v224
    v_mfma_f32_16x16x32_bf16 v[28:31], a[220:223], v[228:231], v[28:31]
    s_waitcnt lgkmcnt(2)
    v_sub_f32 v221, v221, v225
    v_sub_f32 v222, v222, v226
    v_mfma_f32_16x16x32_bf16 v[32:35], a[224:227], v[228:231], v[32:35]
    ds_read_b128 v[228:231], v253 offset:17952
    v_sub_f32 v223, v223, v227
    v_add_f32 v224, v220, v136
    v_mfma_f32_16x16x32_bf16 v[60:63], a[192:195], v[232:235], v[60:63]
    v_add_f32 v225, v221, v137
    v_add_f32 v226, v222, v138
    v_mfma_f32_16x16x32_bf16 v[64:67], a[196:199], v[232:235], v[64:67]
    v_add_f32 v227, v223, v139
    v_mul_f32 v136, s28, v136
    v_mul_f32 v137, s28, v137
    v_mfma_f32_16x16x32_bf16 v[68:71], a[200:203], v[232:235], v[68:71]
    v_mul_f32 v138, s28, v138
    v_mul_f32 v139, s28, v139
    v_mfma_f32_16x16x32_bf16 v[48:51], a[204:207], v[232:235], v[48:51]
    v_mul_f32 v224, s26, v224
    v_mul_f32 v225, s26, v225
    v_mfma_f32_16x16x32_bf16 v[52:55], a[208:211], v[232:235], v[52:55]
    buffer_store_dwordx4 a[104:107], v254, s[12:15], s44 offen sc1
    v_mul_f32 v226, s26, v226
    v_mul_f32 v227, s26, v227
    v_fmac_f32 v136, s34, v220
    v_mfma_f32_16x16x32_bf16 v[56:59], a[212:215], v[232:235], v[56:59]
    ds_write_b128 v248, a[24:27] offset:768
    v_mfma_f32_16x16x32_bf16 v[36:39], a[216:219], v[232:235], v[36:39]
    v_fmac_f32 v137, s34, v221
    v_fmac_f32 v138, s34, v222
    v_fmac_f32 v139, s34, v223
    v_mfma_f32_16x16x32_bf16 v[40:43], a[220:223], v[232:235], v[40:43]
    s_waitcnt lgkmcnt(2)
    v_cvt_pk_bf16_f32 v200, v224, v225
    v_cvt_pk_bf16_f32 v201, v226, v227
    v_mfma_f32_16x16x32_bf16 v[44:47], a[224:227], v[232:235], v[44:47]
    ds_read_b128 v[232:235], v253 offset:17696
    v_mfma_f32_16x16x32_bf16 v[72:75], a[192:195], v[236:239], v[72:75]
    ds_write_b128 v248, v[198:201] offset:1152
    v_accvgpr_read_b32 v220, a44
    v_mfma_f32_16x16x32_bf16 v[76:79], a[196:199], v[236:239], v[76:79]
    v_accvgpr_read_b32 v221, a45
    v_accvgpr_read_b32 v222, a46
    v_mfma_f32_16x16x32_bf16 v[80:83], a[200:203], v[236:239], v[80:83]
    s_add_u32 s44, s40, 402432
    v_accvgpr_read_b32 v223, a47
    v_accvgpr_read_b32 v224, a140
    v_accvgpr_read_b32 v225, a141
    v_mfma_f32_16x16x32_bf16 v[60:63], a[204:207], v[236:239], v[60:63]
    v_accvgpr_read_b32 v226, a142
    v_accvgpr_read_b32 v227, a143
    v_mfma_f32_16x16x32_bf16 v[64:67], a[208:211], v[236:239], v[64:67]
    ds_write_b64 v249, a[28:29] offset:832
    v_mfma_f32_16x16x32_bf16 v[68:71], a[212:215], v[236:239], v[68:71]
    v_sub_f32 v220, v220, v224
    v_sub_f32 v221, v221, v225
    v_sub_f32 v222, v222, v226
    v_mfma_f32_16x16x32_bf16 v[48:51], a[216:219], v[236:239], v[48:51]
    v_sub_f32 v223, v223, v227
    v_add_f32 v224, v220, v140
    v_mfma_f32_16x16x32_bf16 v[52:55], a[220:223], v[236:239], v[52:55]
    s_waitcnt lgkmcnt(4)
    v_add_f32 v225, v221, v141
    v_add_f32 v226, v222, v142
    v_add_f32 v227, v223, v143
    v_mfma_f32_16x16x32_bf16 v[56:59], a[224:227], v[236:239], v[56:59]
    ds_read_b128 v[236:239], v253 offset:17424
    v_mul_f32 v140, s28, v140
    v_mfma_f32_16x16x32_bf16 v[84:87], a[192:195], v[228:231], v[84:87]
    v_mul_f32 v141, s28, v141
    v_mul_f32 v142, s28, v142
    v_mfma_f32_16x16x32_bf16 v[88:91], a[196:199], v[228:231], v[88:91]
    v_mul_f32 v143, s28, v143
    v_mul_f32 v224, s26, v224
    v_mul_f32 v225, s26, v225
    v_mfma_f32_16x16x32_bf16 v[92:95], a[200:203], v[228:231], v[92:95]
    s_mov_b32 s42, 1032192
    v_mul_f32 v226, s26, v226
    v_mul_f32 v227, s26, v227
    v_mfma_f32_16x16x32_bf16 v[72:75], a[204:207], v[228:231], v[72:75]
    buffer_load_dwordx4 a[192:195], v254, s[8:11], s42 offen offset:0
    v_fmac_f32 v140, s34, v220
    v_mfma_f32_16x16x32_bf16 v[76:79], a[208:211], v[228:231], v[76:79]
    v_fmac_f32 v141, s34, v221
    v_fmac_f32 v142, s34, v222
    v_mfma_f32_16x16x32_bf16 v[80:83], a[212:215], v[228:231], v[80:83]
    s_waitcnt lgkmcnt(3)
    v_fmac_f32 v143, s34, v223
    v_cvt_pk_bf16_f32 v202, v224, v225
    v_mfma_f32_16x16x32_bf16 v[60:63], a[216:219], v[228:231], v[60:63]
    buffer_load_dwordx4 a[196:199], v254, s[8:11], s42 offen offset:1024
    v_cvt_pk_bf16_f32 v203, v226, v227
    v_mfma_f32_16x16x32_bf16 v[64:67], a[220:223], v[228:231], v[64:67]
    s_waitcnt lgkmcnt(0)
    v_mfma_f32_16x16x32_bf16 v[68:71], a[224:227], v[228:231], v[68:71]
    s_barrier
    v_mfma_f32_16x16x32_bf16 v[84:87], a[204:207], v[232:235], v[84:87]
    ds_read_b128 v[228:231], v253 offset:19760
    v_mfma_f32_16x16x32_bf16 v[88:91], a[208:211], v[232:235], v[88:91]
    ds_read_b128 a[120:123], v250 offset:0
    v_mfma_f32_16x16x32_bf16 v[92:95], a[212:215], v[232:235], v[92:95]
    buffer_load_dwordx4 a[200:203], v254, s[8:11], s42 offen offset:2048
    v_mfma_f32_16x16x32_bf16 v[72:75], a[216:219], v[232:235], v[72:75]
    ds_write_b64 v249, v[202:203] offset:1216
    v_mfma_f32_16x16x32_bf16 v[76:79], a[220:223], v[232:235], v[76:79]
    s_mov_b32 s42, 1035264
    v_accvgpr_read_b32 v220, a48
    v_accvgpr_read_b32 v221, a49
    v_accvgpr_read_b32 v222, a50
    v_mfma_f32_16x16x32_bf16 v[80:83], a[224:227], v[232:235], v[80:83]
    ds_read_b128 v[232:235], v253 offset:19488
    v_accvgpr_read_b32 v223, a51
    v_mfma_f32_16x16x32_bf16 v[84:87], a[216:219], v[236:239], v[84:87]
    buffer_load_dwordx4 a[204:207], v254, s[8:11], s42 offen offset:0
    v_mfma_f32_16x16x32_bf16 v[88:91], a[220:223], v[236:239], v[88:91]
    s_waitcnt vmcnt(13) lgkmcnt(3)
    v_accvgpr_read_b32 v224, a144
    v_accvgpr_read_b32 v225, a145
    v_accvgpr_read_b32 v226, a146
    v_mfma_f32_16x16x32_bf16 v[92:95], a[224:227], v[236:239], v[92:95]
    ds_read_b128 v[236:239], v253 offset:19232
    v_accvgpr_read_b32 v227, a147
    v_mfma_f32_16x16x32_bf16 v[0:3], a[228:231], v[228:231], v[0:3]
    s_waitcnt lgkmcnt(1)
    v_sub_f32 v220, v220, v224
    v_sub_f32 v221, v221, v225
    v_sub_f32 v222, v222, v226
    v_mfma_f32_16x16x32_bf16 v[4:7], a[232:235], v[228:231], v[4:7]
    buffer_load_dwordx4 a[208:211], v254, s[8:11], s42 offen offset:1024
    v_mfma_f32_16x16x32_bf16 v[8:11], a[236:239], v[228:231], v[8:11]
    ds_read_b128 v[228:231], v253 offset:18976
    v_sub_f32 v223, v223, v227
    v_mfma_f32_16x16x32_bf16 v[12:15], a[228:231], v[232:235], v[12:15]
    ds_read_b128 a[124:127], v250 offset:3104
    v_add_f32 v224, v220, v144
    v_add_f32 v225, v221, v145
    v_mfma_f32_16x16x32_bf16 v[16:19], a[232:235], v[232:235], v[16:19]
    s_waitcnt vmcnt(11)
    v_add_f32 v226, v222, v146
    v_add_f32 v227, v223, v147
    v_mfma_f32_16x16x32_bf16 v[20:23], a[236:239], v[232:235], v[20:23]
    buffer_load_dwordx4 a[212:215], v254, s[8:11], s42 offen offset:2048
    v_mul_f32 v144, s28, v144
    v_mfma_f32_16x16x32_bf16 v[0:3], a[240:243], v[232:235], v[0:3]
    s_waitcnt lgkmcnt(2)
    v_mul_f32 v145, s28, v145
    v_mul_f32 v146, s28, v146
    v_mfma_f32_16x16x32_bf16 v[4:7], a[244:247], v[232:235], v[4:7]
    s_mov_b32 s42, 1038336
    v_mul_f32 v147, s28, v147
    v_mul_f32 v224, s26, v224
    v_mfma_f32_16x16x32_bf16 v[8:11], a[248:251], v[232:235], v[8:11]
    ds_read_b128 v[232:235], v253 offset:18720
    v_mul_f32 v225, s26, v225
    v_mul_f32 v226, s26, v226
    v_mfma_f32_16x16x32_bf16 v[24:27], a[228:231], v[236:239], v[24:27]
    buffer_load_dwordx4 a[216:219], v254, s[8:11], s42 offen offset:0
    v_mfma_f32_16x16x32_bf16 v[28:31], a[232:235], v[236:239], v[28:31]
    v_mul_f32 v227, s26, v227
    v_fmac_f32 v144, s34, v220
    v_fmac_f32 v145, s34, v221
    v_mfma_f32_16x16x32_bf16 v[32:35], a[236:239], v[236:239], v[32:35]
    ds_read_b128 a[128:131], v250 offset:6208
    v_fmac_f32 v146, s34, v222
    v_mfma_f32_16x16x32_bf16 v[12:15], a[240:243], v[236:239], v[12:15]
    v_fmac_f32 v147, s34, v223
    v_cvt_pk_bf16_f32 v192, v224, v225
    v_mfma_f32_16x16x32_bf16 v[16:19], a[244:247], v[236:239], v[16:19]
    buffer_load_dwordx4 a[220:223], v254, s[8:11], s42 offen offset:1024
    v_cvt_pk_bf16_f32 v193, v226, v227
    v_mfma_f32_16x16x32_bf16 v[20:23], a[248:251], v[236:239], v[20:23]
    s_waitcnt vmcnt(11)
    v_accvgpr_read_b32 v220, a52
    v_accvgpr_read_b32 v221, a53
    v_mfma_f32_16x16x32_bf16 v[0:3], a[252:255], v[236:239], v[0:3]
    s_waitcnt lgkmcnt(3)
    v_accvgpr_read_b32 v222, a54
    v_accvgpr_read_b32 v223, a55
    v_accvgpr_read_b32 v224, a148
    v_mfma_f32_16x16x32_bf16 v[4:7], v[240:243], v[236:239], v[4:7]
    buffer_load_dwordx4 a[224:227], v254, s[8:11], s42 offen offset:2048
    v_mfma_f32_16x16x32_bf16 v[8:11], v[244:247], v[236:239], v[8:11]
    ds_read_b128 v[236:239], v253 offset:20544
    v_accvgpr_read_b32 v225, a149
    v_mfma_f32_16x16x32_bf16 v[36:39], a[228:231], v[228:231], v[36:39]
    v_accvgpr_read_b32 v226, a150
    v_accvgpr_read_b32 v227, a151
    v_sub_f32 v220, v220, v224
    v_mfma_f32_16x16x32_bf16 v[40:43], a[232:235], v[228:231], v[40:43]
    buffer_store_dwordx4 a[108:111], v254, s[12:15], s44 offen sc1
    s_add_u32 s44, s40, 403456
    v_mfma_f32_16x16x32_bf16 v[44:47], a[236:239], v[228:231], v[44:47]
    ds_read_b128 a[132:135], v250 offset:9312
    v_sub_f32 v221, v221, v225
    v_sub_f32 v222, v222, v226
    v_mfma_f32_16x16x32_bf16 v[24:27], a[240:243], v[228:231], v[24:27]
    v_sub_f32 v223, v223, v227
    v_add_f32 v224, v220, v148
    v_mfma_f32_16x16x32_bf16 v[28:31], a[244:247], v[228:231], v[28:31]
    buffer_store_dwordx4 a[112:115], v254, s[12:15], s44 offen sc1
    s_add_u32 s44, s40, 404480
    v_mfma_f32_16x16x32_bf16 v[32:35], a[248:251], v[228:231], v[32:35]
    v_add_f32 v225, v221, v149
    v_add_f32 v226, v222, v150
    v_add_f32 v227, v223, v151
    v_mfma_f32_16x16x32_bf16 v[12:15], a[252:255], v[228:231], v[12:15]
    v_mul_f32 v148, s28, v148
    v_mul_f32 v149, s28, v149
    v_mfma_f32_16x16x32_bf16 v[16:19], v[240:243], v[228:231], v[16:19]
    s_waitcnt lgkmcnt(3)
    v_mul_f32 v150, s28, v150
    v_mul_f32 v151, s28, v151
    v_mul_f32 v224, s26, v224
    v_mfma_f32_16x16x32_bf16 v[20:23], v[244:247], v[228:231], v[20:23]
    ds_read_b128 v[228:231], v253 offset:20288
    v_mul_f32 v225, s26, v225
    v_mfma_f32_16x16x32_bf16 v[48:51], a[228:231], v[232:235], v[48:51]
    v_mul_f32 v226, s26, v226
    v_mul_f32 v227, s26, v227
    v_mfma_f32_16x16x32_bf16 v[52:55], a[232:235], v[232:235], v[52:55]
    v_fmac_f32 v148, s34, v220
    v_fmac_f32 v149, s34, v221
    v_fmac_f32 v150, s34, v222
    v_mfma_f32_16x16x32_bf16 v[56:59], a[236:239], v[232:235], v[56:59]
    buffer_store_dwordx4 a[116:119], v254, s[12:15], s44 offen sc1
    v_fmac_f32 v151, s34, v223
    v_cvt_pk_bf16_f32 v194, v224, v225
    v_mfma_f32_16x16x32_bf16 v[36:39], a[240:243], v[232:235], v[36:39]
    v_cvt_pk_bf16_f32 v195, v226, v227
    v_mfma_f32_16x16x32_bf16 v[40:43], a[244:247], v[232:235], v[40:43]
    ds_write_b128 v248, v[192:195] offset:1536
    v_mfma_f32_16x16x32_bf16 v[44:47], a[248:251], v[232:235], v[44:47]
    v_accvgpr_read_b32 v220, a56
    v_accvgpr_read_b32 v221, a57
    v_mfma_f32_16x16x32_bf16 v[24:27], a[252:255], v[232:235], v[24:27]
    v_accvgpr_read_b32 v222, a58
    v_accvgpr_read_b32 v223, a59
    v_accvgpr_read_b32 v224, a152
    v_mfma_f32_16x16x32_bf16 v[28:31], v[240:243], v[232:235], v[28:31]
    s_waitcnt lgkmcnt(3)
    v_accvgpr_read_b32 v225, a153
    v_accvgpr_read_b32 v226, a154
    v_mfma_f32_16x16x32_bf16 v[32:35], v[244:247], v[232:235], v[32:35]
    ds_read_b128 v[232:235], v253 offset:20032
    v_accvgpr_read_b32 v227, a155
    v_sub_f32 v220, v220, v224
    v_mfma_f32_16x16x32_bf16 v[60:63], a[228:231], v[236:239], v[60:63]
    v_sub_f32 v221, v221, v225
    v_sub_f32 v222, v222, v226
    v_mfma_f32_16x16x32_bf16 v[64:67], a[232:235], v[236:239], v[64:67]
    s_add_u32 s44, s40, 196608
    v_sub_f32 v223, v223, v227
    v_add_f32 v224, v220, v152
    v_mfma_f32_16x16x32_bf16 v[68:71], a[236:239], v[236:239], v[68:71]
    v_add_f32 v225, v221, v153
    v_add_f32 v226, v222, v154
    v_add_f32 v227, v223, v155
    v_mfma_f32_16x16x32_bf16 v[48:51], a[240:243], v[236:239], v[48:51]
    v_mul_f32 v152, s28, v152
    v_mul_f32 v153, s28, v153
    v_mfma_f32_16x16x32_bf16 v[52:55], a[244:247], v[236:239], v[52:55]
    v_mul_f32 v154, s28, v154
    v_mul_f32 v155, s28, v155
    v_mul_f32 v224, s26, v224
    v_mfma_f32_16x16x32_bf16 v[56:59], a[248:251], v[236:239], v[56:59]
    v_mul_f32 v225, s26, v225
    v_mul_f32 v226, s26, v226
    v_mfma_f32_16x16x32_bf16 v[36:39], a[252:255], v[236:239], v[36:39]
    v_mul_f32 v227, s26, v227
    v_fmac_f32 v152, s34, v220
    v_mfma_f32_16x16x32_bf16 v[40:43], v[240:243], v[236:239], v[40:43]
    s_waitcnt lgkmcnt(2)
    v_fmac_f32 v153, s34, v221
    v_fmac_f32 v154, s34, v222
    v_fmac_f32 v155, s34, v223
    v_mfma_f32_16x16x32_bf16 v[44:47], v[244:247], v[236:239], v[44:47]
    ds_read_b128 v[236:239], v253 offset:19776
    v_cvt_pk_bf16_f32 v196, v224, v225
    v_mfma_f32_16x16x32_bf16 v[72:75], a[228:231], v[228:231], v[72:75]
    v_cvt_pk_bf16_f32 v197, v226, v227
    v_mfma_f32_16x16x32_bf16 v[76:79], a[232:235], v[228:231], v[76:79]
    ds_write_b64 v249, v[196:197] offset:1600
    v_mfma_f32_16x16x32_bf16 v[80:83], a[236:239], v[228:231], v[80:83]
    v_accvgpr_read_b32 v220, a60
    v_accvgpr_read_b32 v221, a61
    v_mfma_f32_16x16x32_bf16 v[60:63], a[240:243], v[228:231], v[60:63]
    v_accvgpr_read_b32 v222, a62
    v_accvgpr_read_b32 v223, a63
    v_accvgpr_read_b32 v224, a156
    v_mfma_f32_16x16x32_bf16 v[64:67], a[244:247], v[228:231], v[64:67]
    v_accvgpr_read_b32 v225, a157
    v_accvgpr_read_b32 v226, a158
    v_mfma_f32_16x16x32_bf16 v[68:71], a[248:251], v[228:231], v[68:71]
    v_accvgpr_read_b32 v227, a159
    v_sub_f32 v220, v220, v224
    v_sub_f32 v221, v221, v225
    v_mfma_f32_16x16x32_bf16 v[48:51], a[252:255], v[228:231], v[48:51]
    v_sub_f32 v222, v222, v226
    v_sub_f32 v223, v223, v227
    v_mfma_f32_16x16x32_bf16 v[52:55], v[240:243], v[228:231], v[52:55]
    s_waitcnt lgkmcnt(2)
    v_add_f32 v224, v220, v156
    v_add_f32 v225, v221, v157
    v_mfma_f32_16x16x32_bf16 v[56:59], v[244:247], v[228:231], v[56:59]
    ds_read_b128 v[228:231], v253 offset:19504
    v_add_f32 v226, v222, v158
    v_add_f32 v227, v223, v159
    v_mfma_f32_16x16x32_bf16 v[84:87], a[228:231], v[232:235], v[84:87]
    buffer_store_dwordx4 a[120:123], v254, s[12:15], s44 offen sc1
    v_mul_f32 v156, s28, v156
    v_mul_f32 v157, s28, v157
    v_mfma_f32_16x16x32_bf16 v[88:91], a[232:235], v[232:235], v[88:91]
    v_mul_f32 v158, s28, v158
    v_mul_f32 v159, s28, v159
    v_mul_f32 v224, s26, v224
    v_mfma_f32_16x16x32_bf16 v[92:95], a[236:239], v[232:235], v[92:95]
    s_mov_b32 s42, 1069056
    v_mul_f32 v225, s26, v225
    v_mul_f32 v226, s26, v226
    v_mfma_f32_16x16x32_bf16 v[72:75], a[240:243], v[232:235], v[72:75]
    buffer_load_dwordx4 a[228:231], v254, s[8:11], s42 offen offset:0
    v_mfma_f32_16x16x32_bf16 v[76:79], a[244:247], v[232:235], v[76:79]
    v_mul_f32 v227, s26, v227
    v_fmac_f32 v156, s34, v220
    v_fmac_f32 v157, s34, v221
    v_mfma_f32_16x16x32_bf16 v[80:83], a[248:251], v[232:235], v[80:83]
    v_fmac_f32 v158, s34, v222
    v_fmac_f32 v159, s34, v223
    v_mfma_f32_16x16x32_bf16 v[60:63], a[252:255], v[232:235], v[60:63]
    buffer_load_dwordx4 a[232:235], v254, s[8:11], s42 offen offset:1024
    v_cvt_pk_bf16_f32 v198, v224, v225
    v_mfma_f32_16x16x32_bf16 v[64:67], v[240:243], v[232:235], v[64:67]
    s_waitcnt lgkmcnt(2)
    v_cvt_pk_bf16_f32 v199, v226, v227
    v_accvgpr_read_b32 v220, a64
    v_mfma_f32_16x16x32_bf16 v[68:71], v[244:247], v[232:235], v[68:71]
    s_add_u32 s44, s40, 199680
    v_accvgpr_read_b32 v221, a65
    v_accvgpr_read_b32 v222, a66
    v_mfma_f32_16x16x32_bf16 v[84:87], a[240:243], v[236:239], v[84:87]
    ds_read_b128 v[232:235], v253 offset:21840
    v_accvgpr_read_b32 v223, a67
    v_accvgpr_read_b32 v224, a160
    v_mfma_f32_16x16x32_bf16 v[88:91], a[244:247], v[236:239], v[88:91]
    v_accvgpr_read_b32 v225, a161
    v_accvgpr_read_b32 v226, a162
    v_mfma_f32_16x16x32_bf16 v[92:95], a[248:251], v[236:239], v[92:95]
    buffer_load_dwordx4 a[236:239], v254, s[8:11], s42 offen offset:2048
    v_accvgpr_read_b32 v227, a163
    v_mfma_f32_16x16x32_bf16 v[72:75], a[252:255], v[236:239], v[72:75]
    s_waitcnt lgkmcnt(1)
    v_sub_f32 v220, v220, v224
    v_sub_f32 v221, v221, v225
    v_mfma_f32_16x16x32_bf16 v[76:79], v[240:243], v[236:239], v[76:79]
    s_mov_b32 s42, 1072128
    v_sub_f32 v222, v222, v226
    v_sub_f32 v223, v223, v227
    v_mfma_f32_16x16x32_bf16 v[80:83], v[244:247], v[236:239], v[80:83]
    ds_read_b128 v[236:239], v253 offset:21568
    v_add_f32 v224, v220, v160
    v_add_f32 v225, v221, v161
    v_mfma_f32_16x16x32_bf16 v[84:87], a[252:255], v[228:231], v[84:87]
    buffer_load_dwordx4 a[240:243], v254, s[8:11], s42 offen offset:0
    v_mfma_f32_16x16x32_bf16 v[88:91], v[240:243], v[228:231], v[88:91]
    s_waitcnt vmcnt(14) lgkmcnt(1)
    v_add_f32 v226, v222, v162
    v_add_f32 v227, v223, v163
    v_mul_f32 v160, s28, v160
    v_mfma_f32_16x16x32_bf16 v[92:95], v[244:247], v[228:231], v[92:95]
    ds_read_b128 v[228:231], v253 offset:21312
    v_mul_f32 v161, s28, v161
    v_mfma_f32_16x16x32_bf16 v[0:3], a[192:195], v[232:235], v[0:3]
    s_waitcnt lgkmcnt(1)
    v_mul_f32 v162, s28, v162
    v_mul_f32 v163, s28, v163
    v_mfma_f32_16x16x32_bf16 v[4:7], a[196:199], v[232:235], v[4:7]
    buffer_load_dwordx4 a[244:247], v254, s[8:11], s42 offen offset:1024
    v_mul_f32 v224, s26, v224
    v_mfma_f32_16x16x32_bf16 v[8:11], a[200:203], v[232:235], v[8:11]
    ds_read_b128 v[232:235], v253 offset:21056
    v_mul_f32 v225, s26, v225
    v_mfma_f32_16x16x32_bf16 v[12:15], a[192:195], v[236:239], v[12:15]
    v_mul_f32 v226, s26, v226
    v_mul_f32 v227, s26, v227
    v_fmac_f32 v160, s34, v220
    v_mfma_f32_16x16x32_bf16 v[16:19], a[196:199], v[236:239], v[16:19]
    s_waitcnt vmcnt(12)
    v_fmac_f32 v161, s34, v221
    v_fmac_f32 v162, s34, v222
    v_mfma_f32_16x16x32_bf16 v[20:23], a[200:203], v[236:239], v[20:23]
    buffer_load_dwordx4 a[248:251], v254, s[8:11], s42 offen offset:2048
    v_mfma_f32_16x16x32_bf16 v[0:3], a[204:207], v[236:239], v[0:3]
    s_waitcnt lgkmcnt(1)
    v_fmac_f32 v163, s34, v223
    v_cvt_pk_bf16_f32 v200, v224, v225
    v_cvt_pk_bf16_f32 v201, v226, v227
    v_mfma_f32_16x16x32_bf16 v[4:7], a[208:211], v[236:239], v[4:7]
    s_mov_b32 s42, 1075200
    v_mfma_f32_16x16x32_bf16 v[8:11], a[212:215], v[236:239], v[8:11]
    ds_read_b128 v[236:239], v253 offset:20800
    v_mfma_f32_16x16x32_bf16 v[24:27], a[192:195], v[228:231], v[24:27]
    buffer_load_dwordx4 a[252:255], v254, s[8:11], s42 offen offset:0
    v_mfma_f32_16x16x32_bf16 v[28:31], a[196:199], v[228:231], v[28:31]
    ds_write_b128 v248, v[198:201] offset:1920
    v_mfma_f32_16x16x32_bf16 v[32:35], a[200:203], v[228:231], v[32:35]
    v_accvgpr_read_b32 v220, a68
    v_accvgpr_read_b32 v221, a69
    v_accvgpr_read_b32 v222, a70
    v_mfma_f32_16x16x32_bf16 v[12:15], a[204:207], v[228:231], v[12:15]
    v_accvgpr_read_b32 v223, a71
    v_accvgpr_read_b32 v224, a164
    v_mfma_f32_16x16x32_bf16 v[16:19], a[208:211], v[228:231], v[16:19]
    buffer_load_dwordx4 v[240:243], v254, s[8:11], s42 offen offset:1024
    v_accvgpr_read_b32 v225, a165
    v_mfma_f32_16x16x32_bf16 v[20:23], a[212:215], v[228:231], v[20:23]
    s_waitcnt vmcnt(12)
    v_accvgpr_read_b32 v226, a166
    v_accvgpr_read_b32 v227, a167
    v_mfma_f32_16x16x32_bf16 v[0:3], a[216:219], v[228:231], v[0:3]
    s_waitcnt lgkmcnt(2)
    v_sub_f32 v220, v220, v224
    v_sub_f32 v221, v221, v225
    v_mfma_f32_16x16x32_bf16 v[4:7], a[220:223], v[228:231], v[4:7]
    buffer_load_dwordx4 v[244:247], v254, s[8:11], s42 offen offset:2048
    v_sub_f32 v222, v222, v226
    v_mfma_f32_16x16x32_bf16 v[8:11], a[224:227], v[228:231], v[8:11]
    ds_read_b128 v[228:231], v253 offset:22624
    v_sub_f32 v223, v223, v227
    v_mfma_f32_16x16x32_bf16 v[36:39], a[192:195], v[232:235], v[36:39]
    v_add_f32 v224, v220, v164
    v_add_f32 v225, v221, v165
    v_add_f32 v226, v222, v166
    v_mfma_f32_16x16x32_bf16 v[40:43], a[196:199], v[232:235], v[40:43]
    buffer_store_dwordx4 a[124:127], v254, s[12:15], s44 offen sc1
    s_add_u32 s44, s40, 202752
    v_add_f32 v227, v223, v167
    v_mfma_f32_16x16x32_bf16 v[44:47], a[200:203], v[232:235], v[44:47]
    v_mul_f32 v164, s28, v164
    v_mul_f32 v165, s28, v165
    v_mfma_f32_16x16x32_bf16 v[24:27], a[204:207], v[232:235], v[24:27]
    v_mul_f32 v166, s28, v166
    v_mul_f32 v167, s28, v167
    v_mul_f32 v224, s26, v224
    v_mfma_f32_16x16x32_bf16 v[28:31], a[208:211], v[232:235], v[28:31]
    v_mul_f32 v225, s26, v225
    v_mul_f32 v226, s26, v226
    v_mfma_f32_16x16x32_bf16 v[32:35], a[212:215], v[232:235], v[32:35]
    v_mul_f32 v227, s26, v227
    v_fmac_f32 v164, s34, v220
    v_fmac_f32 v165, s34, v221
    v_mfma_f32_16x16x32_bf16 v[12:15], a[216:219], v[232:235], v[12:15]
    v_fmac_f32 v166, s34, v222
    v_fmac_f32 v167, s34, v223
    v_mfma_f32_16x16x32_bf16 v[16:19], a[220:223], v[232:235], v[16:19]
    s_waitcnt lgkmcnt(2)
    v_cvt_pk_bf16_f32 v202, v224, v225
    v_cvt_pk_bf16_f32 v203, v226, v227
    v_mfma_f32_16x16x32_bf16 v[20:23], a[224:227], v[232:235], v[20:23]
    ds_read_b128 v[232:235], v253 offset:22368
    v_mfma_f32_16x16x32_bf16 v[48:51], a[192:195], v[236:239], v[48:51]
    ds_write_b64 v249, v[202:203] offset:1984
    v_mfma_f32_16x16x32_bf16 v[52:55], a[196:199], v[236:239], v[52:55]
    v_accvgpr_read_b32 v220, a72
    v_accvgpr_read_b32 v221, a73
    v_accvgpr_read_b32 v222, a74
    v_mfma_f32_16x16x32_bf16 v[56:59], a[200:203], v[236:239], v[56:59]
    v_accvgpr_read_b32 v223, a75
    v_accvgpr_read_b32 v224, a168
    v_mfma_f32_16x16x32_bf16 v[36:39], a[204:207], v[236:239], v[36:39]
    v_accvgpr_read_b32 v225, a169
    v_accvgpr_read_b32 v226, a170
    v_mfma_f32_16x16x32_bf16 v[40:43], a[208:211], v[236:239], v[40:43]
    buffer_store_dwordx4 a[128:131], v254, s[12:15], s44 offen sc1
    v_accvgpr_read_b32 v227, a171
    v_sub_f32 v220, v220, v224
    v_sub_f32 v221, v221, v225
    v_mfma_f32_16x16x32_bf16 v[44:47], a[212:215], v[236:239], v[44:47]
    v_sub_f32 v222, v222, v226
    v_sub_f32 v223, v223, v227
    v_mfma_f32_16x16x32_bf16 v[24:27], a[216:219], v[236:239], v[24:27]
    v_add_f32 v224, v220, v168
    v_add_f32 v225, v221, v169
    v_add_f32 v226, v222, v170
    v_mfma_f32_16x16x32_bf16 v[28:31], a[220:223], v[236:239], v[28:31]
    s_waitcnt lgkmcnt(2)
    v_add_f32 v227, v223, v171
    v_mul_f32 v168, s28, v168
    v_mfma_f32_16x16x32_bf16 v[32:35], a[224:227], v[236:239], v[32:35]
    ds_read_b128 v[236:239], v253 offset:22112
    v_mul_f32 v169, s28, v169
    v_mfma_f32_16x16x32_bf16 v[60:63], a[192:195], v[228:231], v[60:63]
    v_mul_f32 v170, s28, v170
    v_mul_f32 v171, s28, v171
    v_mul_f32 v224, s26, v224
    v_mfma_f32_16x16x32_bf16 v[64:67], a[196:199], v[228:231], v[64:67]
    v_mul_f32 v225, s26, v225
    v_mul_f32 v226, s26, v226
    v_mfma_f32_16x16x32_bf16 v[68:71], a[200:203], v[228:231], v[68:71]
    v_mul_f32 v227, s26, v227
    v_fmac_f32 v168, s34, v220
    v_fmac_f32 v169, s34, v221
    v_mfma_f32_16x16x32_bf16 v[48:51], a[204:207], v[228:231], v[48:51]
    v_fmac_f32 v170, s34, v222
    v_fmac_f32 v171, s34, v223
    v_mfma_f32_16x16x32_bf16 v[52:55], a[208:211], v[228:231], v[52:55]
    s_add_u32 s44, s40, 205824
    v_cvt_pk_bf16_f32 v192, v224, v225
    v_cvt_pk_bf16_f32 v193, v226, v227
    v_mfma_f32_16x16x32_bf16 v[56:59], a[212:215], v[228:231], v[56:59]
    v_accvgpr_read_b32 v220, a76
    v_accvgpr_read_b32 v221, a77
    v_accvgpr_read_b32 v222, a78
    v_mfma_f32_16x16x32_bf16 v[36:39], a[216:219], v[228:231], v[36:39]
    v_accvgpr_read_b32 v223, a79
    v_accvgpr_read_b32 v224, a172
    v_mfma_f32_16x16x32_bf16 v[40:43], a[220:223], v[228:231], v[40:43]
    s_waitcnt lgkmcnt(2)
    v_accvgpr_read_b32 v225, a173
    v_accvgpr_read_b32 v226, a174
    v_accvgpr_read_b32 v227, a175
    v_mfma_f32_16x16x32_bf16 v[44:47], a[224:227], v[228:231], v[44:47]
    ds_read_b128 v[228:231], v253 offset:21856
    v_sub_f32 v220, v220, v224
    v_mfma_f32_16x16x32_bf16 v[72:75], a[192:195], v[232:235], v[72:75]
    v_sub_f32 v221, v221, v225
    v_sub_f32 v222, v222, v226
    v_mfma_f32_16x16x32_bf16 v[76:79], a[196:199], v[232:235], v[76:79]
    v_sub_f32 v223, v223, v227
    v_add_f32 v224, v220, v172
    v_add_f32 v225, v221, v173
    v_mfma_f32_16x16x32_bf16 v[80:83], a[200:203], v[232:235], v[80:83]
    v_add_f32 v226, v222, v174
    v_add_f32 v227, v223, v175
    v_mfma_f32_16x16x32_bf16 v[60:63], a[204:207], v[232:235], v[60:63]
    v_mul_f32 v172, s28, v172
    v_mul_f32 v173, s28, v173
    v_mul_f32 v174, s28, v174
    v_mfma_f32_16x16x32_bf16 v[64:67], a[208:211], v[232:235], v[64:67]
    v_mul_f32 v175, s28, v175
    v_mul_f32 v224, s26, v224
    v_mfma_f32_16x16x32_bf16 v[68:71], a[212:215], v[232:235], v[68:71]
    v_mul_f32 v225, s26, v225
    v_mul_f32 v226, s26, v226
    v_mfma_f32_16x16x32_bf16 v[48:51], a[216:219], v[232:235], v[48:51]
    v_mul_f32 v227, s26, v227
    v_fmac_f32 v172, s34, v220
    v_fmac_f32 v173, s34, v221
    v_mfma_f32_16x16x32_bf16 v[52:55], a[220:223], v[232:235], v[52:55]
    s_waitcnt lgkmcnt(1)
    v_fmac_f32 v174, s34, v222
    v_fmac_f32 v175, s34, v223
    v_mfma_f32_16x16x32_bf16 v[56:59], a[224:227], v[232:235], v[56:59]
    ds_read_b128 v[232:235], v253 offset:21584
    v_cvt_pk_bf16_f32 v194, v224, v225
    v_cvt_pk_bf16_f32 v195, v226, v227
    v_mfma_f32_16x16x32_bf16 v[84:87], a[192:195], v[236:239], v[84:87]
    ds_write_b128 v248, v[192:195] offset:2304
    v_mfma_f32_16x16x32_bf16 v[88:91], a[196:199], v[236:239], v[88:91]
    v_accvgpr_read_b32 v220, a80
    v_accvgpr_read_b32 v221, a81
    v_mfma_f32_16x16x32_bf16 v[92:95], a[200:203], v[236:239], v[92:95]
    s_mov_b32 s42, 1105920
    v_accvgpr_read_b32 v222, a82
    v_accvgpr_read_b32 v223, a83
    v_accvgpr_read_b32 v224, a176
    v_mfma_f32_16x16x32_bf16 v[72:75], a[204:207], v[236:239], v[72:75]
    buffer_load_dwordx4 a[192:195], v254, s[8:11], s42 offen offset:0
    v_mfma_f32_16x16x32_bf16 v[76:79], a[208:211], v[236:239], v[76:79]
    v_accvgpr_read_b32 v225, a177
    v_accvgpr_read_b32 v226, a178
    v_accvgpr_read_b32 v227, a179
    v_mfma_f32_16x16x32_bf16 v[80:83], a[212:215], v[236:239], v[80:83]
    s_waitcnt lgkmcnt(2)
    v_sub_f32 v220, v220, v224
    v_sub_f32 v221, v221, v225
    v_mfma_f32_16x16x32_bf16 v[60:63], a[216:219], v[236:239], v[60:63]
    buffer_load_dwordx4 a[196:199], v254, s[8:11], s42 offen offset:1024
    v_mfma_f32_16x16x32_bf16 v[64:67], a[220:223], v[236:239], v[64:67]
    s_waitcnt lgkmcnt(0)
    v_sub_f32 v222, v222, v226
    v_sub_f32 v223, v223, v227
    v_add_f32 v224, v220, v176
    v_mfma_f32_16x16x32_bf16 v[68:71], a[224:227], v[236:239], v[68:71]
    s_barrier
    v_mfma_f32_16x16x32_bf16 v[84:87], a[204:207], v[228:231], v[84:87]
    ds_read_b128 v[236:239], v253 offset:23920
    v_add_f32 v225, v221, v177
    v_add_f32 v226, v222, v178
    v_mfma_f32_16x16x32_bf16 v[88:91], a[208:211], v[228:231], v[88:91]
    ds_read_b128 a[136:139], v250 offset:1024
    v_add_f32 v227, v223, v179
    v_mfma_f32_16x16x32_bf16 v[92:95], a[212:215], v[228:231], v[92:95]
    buffer_load_dwordx4 a[200:203], v254, s[8:11], s42 offen offset:2048
    v_mfma_f32_16x16x32_bf16 v[72:75], a[216:219], v[228:231], v[72:75]
    v_mul_f32 v176, s28, v176
    v_mul_f32 v177, s28, v177
    v_mul_f32 v178, s28, v178
    v_mfma_f32_16x16x32_bf16 v[76:79], a[220:223], v[228:231], v[76:79]
    s_mov_b32 s42, 1108992
    v_mul_f32 v179, s28, v179
    v_mul_f32 v224, s26, v224
    v_mfma_f32_16x16x32_bf16 v[80:83], a[224:227], v[228:231], v[80:83]
    ds_read_b128 v[228:231], v253 offset:23648
    v_mul_f32 v225, s26, v225
    v_mul_f32 v226, s26, v226
    v_mfma_f32_16x16x32_bf16 v[84:87], a[216:219], v[232:235], v[84:87]
    buffer_load_dwordx4 a[204:207], v254, s[8:11], s42 offen offset:0
    v_mfma_f32_16x16x32_bf16 v[88:91], a[220:223], v[232:235], v[88:91]
    s_waitcnt vmcnt(12) lgkmcnt(2)
    v_mul_f32 v227, s26, v227
    v_fmac_f32 v176, s34, v220
    v_mfma_f32_16x16x32_bf16 v[92:95], a[224:227], v[232:235], v[92:95]
    ds_read_b128 v[232:235], v253 offset:23392
    v_fmac_f32 v177, s34, v221
    v_fmac_f32 v178, s34, v222
    v_mfma_f32_16x16x32_bf16 v[0:3], a[228:231], v[236:239], v[0:3]
    ds_read_b128 a[140:143], v250 offset:4128
    v_fmac_f32 v179, s34, v223
    v_mfma_f32_16x16x32_bf16 v[4:7], a[232:235], v[236:239], v[4:7]
    buffer_load_dwordx4 a[208:211], v254, s[8:11], s42 offen offset:1024
    v_cvt_pk_bf16_f32 v196, v224, v225
    v_mfma_f32_16x16x32_bf16 v[8:11], a[236:239], v[236:239], v[8:11]
    ds_read_b128 v[236:239], v253 offset:23136
    v_cvt_pk_bf16_f32 v197, v226, v227
    s_waitcnt lgkmcnt(3)
    v_mfma_f32_16x16x32_bf16 v[12:15], a[228:231], v[228:231], v[12:15]
    ds_write_b64 v249, v[196:197] offset:2368
    v_mfma_f32_16x16x32_bf16 v[16:19], a[232:235], v[228:231], v[16:19]
    s_waitcnt vmcnt(10) lgkmcnt(3)
    v_accvgpr_read_b32 v220, a84
    v_accvgpr_read_b32 v221, a85
    v_accvgpr_read_b32 v222, a86
    v_mfma_f32_16x16x32_bf16 v[20:23], a[236:239], v[228:231], v[20:23]
    buffer_load_dwordx4 a[212:215], v254, s[8:11], s42 offen offset:2048
    v_mfma_f32_16x16x32_bf16 v[0:3], a[240:243], v[228:231], v[0:3]
    ds_read_b128 a[144:147], v250 offset:7232
    v_accvgpr_read_b32 v223, a87
    v_accvgpr_read_b32 v224, a180
    v_mfma_f32_16x16x32_bf16 v[4:7], a[244:247], v[228:231], v[4:7]
    s_mov_b32 s42, 1112064
    v_accvgpr_read_b32 v225, a181
    v_accvgpr_read_b32 v226, a182
    v_mfma_f32_16x16x32_bf16 v[8:11], a[248:251], v[228:231], v[8:11]
    ds_read_b128 v[228:231], v253 offset:22880
    v_accvgpr_read_b32 v227, a183
    v_mfma_f32_16x16x32_bf16 v[24:27], a[228:231], v[232:235], v[24:27]
    buffer_load_dwordx4 a[216:219], v254, s[8:11], s42 offen offset:0
    v_sub_f32 v220, v220, v224
    v_mfma_f32_16x16x32_bf16 v[28:31], a[232:235], v[232:235], v[28:31]
    v_sub_f32 v221, v221, v225
    v_sub_f32 v222, v222, v226
    v_mfma_f32_16x16x32_bf16 v[32:35], a[236:239], v[232:235], v[32:35]
    v_sub_f32 v223, v223, v227
    v_add_f32 v224, v220, v180
    v_add_f32 v225, v221, v181
    v_mfma_f32_16x16x32_bf16 v[12:15], a[240:243], v[232:235], v[12:15]
    s_waitcnt vmcnt(9)
    v_add_f32 v226, v222, v182
    v_add_f32 v227, v223, v183
    v_mfma_f32_16x16x32_bf16 v[16:19], a[244:247], v[232:235], v[16:19]
    buffer_load_dwordx4 a[220:223], v254, s[8:11], s42 offen offset:1024
    v_mfma_f32_16x16x32_bf16 v[20:23], a[248:251], v[232:235], v[20:23]
    ds_read_b128 a[148:151], v250 offset:10336
    v_mul_f32 v180, s28, v180
    v_mul_f32 v181, s28, v181
    v_mfma_f32_16x16x32_bf16 v[0:3], a[252:255], v[232:235], v[0:3]
    s_waitcnt lgkmcnt(4)
    v_mul_f32 v182, s28, v182
    v_mul_f32 v183, s28, v183
    v_mfma_f32_16x16x32_bf16 v[4:7], v[240:243], v[232:235], v[4:7]
    buffer_load_dwordx4 a[224:227], v254, s[8:11], s42 offen offset:2048
    v_mul_f32 v224, s26, v224
    v_mfma_f32_16x16x32_bf16 v[8:11], v[244:247], v[232:235], v[8:11]
    ds_read_b128 v[232:235], v253 offset:24704
    v_and_b32 v215, 0x7fff, v255
    v_mfma_f32_16x16x32_bf16 v[36:39], a[228:231], v[236:239], v[36:39]
    v_mul_f32 v225, s26, v225
    v_mul_f32 v226, s26, v226
    v_mfma_f32_16x16x32_bf16 v[40:43], a[232:235], v[236:239], v[40:43]
    buffer_load_dwordx2 v[204:205], v215, s[4:7], s16 offen offset:0
    v_mul_f32 v227, s26, v227
    v_mfma_f32_16x16x32_bf16 v[44:47], a[236:239], v[236:239], v[44:47]
    v_fmac_f32 v180, s34, v220
    v_fmac_f32 v181, s34, v221
    v_mfma_f32_16x16x32_bf16 v[24:27], a[240:243], v[236:239], v[24:27]
    v_fmac_f32 v182, s34, v222
    v_fmac_f32 v183, s34, v223
    v_cvt_pk_bf16_f32 v198, v224, v225
    v_mfma_f32_16x16x32_bf16 v[28:31], a[244:247], v[236:239], v[28:31]
    buffer_load_dwordx2 v[206:207], v215, s[4:7], s17 offen offset:0
    v_mfma_f32_16x16x32_bf16 v[32:35], a[248:251], v[236:239], v[32:35]
    v_cvt_pk_bf16_f32 v199, v226, v227
    v_accvgpr_read_b32 v220, a88
    v_mfma_f32_16x16x32_bf16 v[12:15], a[252:255], v[236:239], v[12:15]
    s_waitcnt lgkmcnt(2)
    v_accvgpr_read_b32 v221, a89
    v_accvgpr_read_b32 v222, a90
    v_accvgpr_read_b32 v223, a91
    v_mfma_f32_16x16x32_bf16 v[16:19], v[240:243], v[236:239], v[16:19]
    buffer_load_dwordx2 v[208:209], v215, s[4:7], s18 offen offset:0
    v_mfma_f32_16x16x32_bf16 v[20:23], v[244:247], v[236:239], v[20:23]
    ds_read_b128 v[236:239], v253 offset:24448
    v_accvgpr_read_b32 v224, a184
    v_accvgpr_read_b32 v225, a185
    v_mfma_f32_16x16x32_bf16 v[48:51], a[228:231], v[228:231], v[48:51]
    v_accvgpr_read_b32 v226, a186
    v_accvgpr_read_b32 v227, a187
    v_mfma_f32_16x16x32_bf16 v[52:55], a[232:235], v[228:231], v[52:55]
    buffer_load_dwordx2 v[210:211], v215, s[4:7], s19 offen offset:0
    v_mfma_f32_16x16x32_bf16 v[56:59], a[236:239], v[228:231], v[56:59]
    v_sub_f32 v220, v220, v224
    v_sub_f32 v221, v221, v225
    v_sub_f32 v222, v222, v226
    v_mfma_f32_16x16x32_bf16 v[36:39], a[240:243], v[228:231], v[36:39]
    v_sub_f32 v223, v223, v227
    v_add_f32 v224, v220, v184
    v_mfma_f32_16x16x32_bf16 v[40:43], a[244:247], v[228:231], v[40:43]
    buffer_load_dwordx2 v[212:213], v215, s[4:7], s20 offen offset:0
    v_add_f32 v225, v221, v185
    v_mfma_f32_16x16x32_bf16 v[44:47], a[248:251], v[228:231], v[44:47]
    v_add_f32 v226, v222, v186
    v_add_f32 v227, v223, v187
    v_mfma_f32_16x16x32_bf16 v[24:27], a[252:255], v[228:231], v[24:27]
    s_waitcnt lgkmcnt(1)
    v_mul_f32 v184, s28, v184
    v_mul_f32 v185, s28, v185
    v_mfma_f32_16x16x32_bf16 v[28:31], v[240:243], v[228:231], v[28:31]
    buffer_load_dwordx2 v[214:215], v215, s[4:7], s21 offen offset:0
    v_mul_f32 v186, s28, v186
    v_mfma_f32_16x16x32_bf16 v[32:35], v[244:247], v[228:231], v[32:35]
    ds_read_b128 v[228:231], v253 offset:24192
    v_mul_f32 v187, s28, v187
    v_mfma_f32_16x16x32_bf16 v[60:63], a[228:231], v[232:235], v[60:63]
    v_mul_f32 v224, s26, v224
    v_mul_f32 v225, s26, v225
    v_mul_f32 v226, s26, v226
    v_mfma_f32_16x16x32_bf16 v[64:67], a[232:235], v[232:235], v[64:67]
    buffer_store_dwordx4 a[132:135], v254, s[12:15], s44 offen sc1
    s_add_u32 s44, s40, 197632
    v_mfma_f32_16x16x32_bf16 v[68:71], a[236:239], v[232:235], v[68:71]
    v_mul_f32 v227, s26, v227
    v_fmac_f32 v184, s34, v220
    v_mfma_f32_16x16x32_bf16 v[48:51], a[240:243], v[232:235], v[48:51]
    v_fmac_f32 v185, s34, v221
    v_fmac_f32 v186, s34, v222
    v_fmac_f32 v187, s34, v223
    v_mfma_f32_16x16x32_bf16 v[52:55], a[244:247], v[232:235], v[52:55]
    buffer_store_dwordx4 a[136:139], v254, s[12:15], s44 offen sc1
    s_add_u32 s44, s40, 200704
    v_mfma_f32_16x16x32_bf16 v[56:59], a[248:251], v[232:235], v[56:59]
    s_waitcnt lgkmcnt(1)
    v_cvt_pk_bf16_f32 v200, v224, v225
    v_cvt_pk_bf16_f32 v201, v226, v227
    v_mfma_f32_16x16x32_bf16 v[36:39], a[252:255], v[232:235], v[36:39]
    ds_write_b128 v248, v[198:201] offset:2688
    v_mfma_f32_16x16x32_bf16 v[40:43], v[240:243], v[232:235], v[40:43]
    buffer_store_dwordx4 a[140:143], v254, s[12:15], s44 offen sc1
    s_add_u32 s44, s40, 203776
    v_accvgpr_read_b32 v220, a92
    v_mfma_f32_16x16x32_bf16 v[44:47], v[244:247], v[232:235], v[44:47]
    ds_read_b128 v[232:235], v253 offset:23936
    v_accvgpr_read_b32 v221, a93
    v_accvgpr_read_b32 v222, a94
    v_mfma_f32_16x16x32_bf16 v[72:75], a[228:231], v[236:239], v[72:75]
    v_accvgpr_read_b32 v223, a95
    v_accvgpr_read_b32 v224, a188
    v_mfma_f32_16x16x32_bf16 v[76:79], a[232:235], v[236:239], v[76:79]
    v_accvgpr_read_b32 v225, a189
    v_accvgpr_read_b32 v226, a190
    v_accvgpr_read_b32 v227, a191
    v_mfma_f32_16x16x32_bf16 v[80:83], a[236:239], v[236:239], v[80:83]
    v_sub_f32 v220, v220, v224
    v_sub_f32 v221, v221, v225
    v_mfma_f32_16x16x32_bf16 v[60:63], a[240:243], v[236:239], v[60:63]
    v_sub_f32 v222, v222, v226
    v_sub_f32 v223, v223, v227
    v_mfma_f32_16x16x32_bf16 v[64:67], a[244:247], v[236:239], v[64:67]
    v_add_f32 v224, v220, v188
    v_add_f32 v225, v221, v189
    v_add_f32 v226, v222, v190
    v_mfma_f32_16x16x32_bf16 v[68:71], a[248:251], v[236:239], v[68:71]
    v_add_f32 v227, v223, v191
    v_mul_f32 v188, s28, v188
    v_mfma_f32_16x16x32_bf16 v[48:51], a[252:255], v[236:239], v[48:51]
    v_mul_f32 v189, s28, v189
    v_mul_f32 v190, s28, v190
    v_mul_f32 v191, s28, v191
    v_mfma_f32_16x16x32_bf16 v[52:55], v[240:243], v[236:239], v[52:55]
    s_waitcnt lgkmcnt(2)
    v_mul_f32 v224, s26, v224
    v_mul_f32 v225, s26, v225
    v_mfma_f32_16x16x32_bf16 v[56:59], v[244:247], v[236:239], v[56:59]
    ds_read_b128 v[236:239], v253 offset:23664
    v_mul_f32 v226, s26, v226
    v_mfma_f32_16x16x32_bf16 v[84:87], a[228:231], v[228:231], v[84:87]
    v_mul_f32 v227, s26, v227
    v_fmac_f32 v188, s34, v220
    v_fmac_f32 v189, s34, v221
    v_mfma_f32_16x16x32_bf16 v[88:91], a[232:235], v[228:231], v[88:91]
    v_fmac_f32 v190, s34, v222
    v_fmac_f32 v191, s34, v223
    v_mfma_f32_16x16x32_bf16 v[92:95], a[236:239], v[228:231], v[92:95]
    s_mov_b32 s42, 1142784
    v_cvt_pk_bf16_f32 v202, v224, v225
    v_cvt_pk_bf16_f32 v203, v226, v227
    v_mfma_f32_16x16x32_bf16 v[72:75], a[240:243], v[228:231], v[72:75]
    buffer_load_dwordx4 a[228:231], v254, s[8:11], s42 offen offset:0
    v_mfma_f32_16x16x32_bf16 v[76:79], a[244:247], v[228:231], v[76:79]
    ds_write_b64 v249, v[202:203] offset:2752
    v_mfma_f32_16x16x32_bf16 v[80:83], a[248:251], v[228:231], v[80:83]
    s_waitcnt lgkmcnt(2)
    v_mfma_f32_16x16x32_bf16 v[60:63], a[252:255], v[228:231], v[60:63]
    buffer_load_dwordx4 a[232:235], v254, s[8:11], s42 offen offset:1024
    v_mfma_f32_16x16x32_bf16 v[64:67], v[240:243], v[228:231], v[64:67]
    s_waitcnt lgkmcnt(0)
    v_mfma_f32_16x16x32_bf16 v[68:71], v[244:247], v[228:231], v[68:71]
    s_barrier
    v_mfma_f32_16x16x32_bf16 v[84:87], a[240:243], v[232:235], v[84:87]
    ds_read_b128 v[228:231], v253 offset:36400
    v_mfma_f32_16x16x32_bf16 v[88:91], a[244:247], v[232:235], v[88:91]
    ds_read_b128 a[152:155], v250 offset:2048
    v_cvt_pk_bf16_f32 v8, v8, v9
    v_cvt_pk_bf16_f32 v9, v10, v11
    v_mfma_f32_16x16x32_bf16 v[92:95], a[248:251], v[232:235], v[92:95]
    buffer_load_dwordx4 a[236:239], v254, s[8:11], s42 offen offset:2048
    v_mfma_f32_16x16x32_bf16 v[72:75], a[252:255], v[232:235], v[72:75]
    ds_write_b64 v249, v[8:9] offset:12544
    v_cvt_pk_bf16_f32 v0, v0, v1
    v_cvt_pk_bf16_f32 v1, v2, v3
    v_mfma_f32_16x16x32_bf16 v[76:79], v[240:243], v[232:235], v[76:79]
    s_mov_b32 s42, 1145856
    v_cvt_pk_bf16_f32 v2, v4, v5
    v_cvt_pk_bf16_f32 v3, v6, v7
    v_mfma_f32_16x16x32_bf16 v[80:83], v[244:247], v[232:235], v[80:83]
    ds_read_b128 v[232:235], v253 offset:36128
    v_mfma_f32_16x16x32_bf16 v[84:87], a[252:255], v[236:239], v[84:87]
    buffer_load_dwordx4 a[240:243], v254, s[8:11], s42 offen offset:0
    v_mfma_f32_16x16x32_bf16 v[88:91], v[240:243], v[236:239], v[88:91]
    ds_write_b128 v248, v[0:3] offset:12480
    v_mov_b32 v4, v248
    v_mov_b32 v5, v249
    v_mfma_f32_16x16x32_bf16 v[92:95], v[244:247], v[236:239], v[92:95]
    ds_read_b128 v[236:239], v253 offset:35872
    v_mov_b32 v6, v250
    v_cvt_pk_bf16_f32 v20, v20, v21
    v_cvt_pk_bf16_f32 v21, v22, v23
    s_waitcnt vmcnt(19)
    s_waitcnt lgkmcnt(5)
    v_mfma_f32_16x16x32_bf16 v[96:99], a[192:195], v[228:231], v[96:99]
    s_waitcnt lgkmcnt(2)
    v_mfma_f32_16x16x32_bf16 v[100:103], a[196:199], v[228:231], v[100:103]
    buffer_load_dwordx4 a[244:247], v254, s[8:11], s42 offen offset:1024
    v_mfma_f32_16x16x32_bf16 v[104:107], a[200:203], v[228:231], v[104:107]
    ds_read_b128 v[228:231], v253 offset:35616
    v_mfma_f32_16x16x32_bf16 v[108:111], a[192:195], v[232:235], v[108:111]
    ds_read_b128 a[156:159], v250 offset:5152
    v_mfma_f32_16x16x32_bf16 v[112:115], a[196:199], v[232:235], v[112:115]
    ds_write_b64 v249, v[20:21] offset:12928
    v_cvt_pk_bf16_f32 v12, v12, v13
    v_cvt_pk_bf16_f32 v13, v14, v15
    v_mfma_f32_16x16x32_bf16 v[116:119], a[200:203], v[232:235], v[116:119]
    buffer_load_dwordx4 a[248:251], v254, s[8:11], s42 offen offset:2048
    v_cvt_pk_bf16_f32 v14, v16, v17
    v_cvt_pk_bf16_f32 v15, v18, v19
    s_waitcnt vmcnt(18)
    v_mfma_f32_16x16x32_bf16 v[96:99], a[204:207], v[232:235], v[96:99]
    ds_write_b128 v248, v[12:15] offset:12864
    v_cvt_pk_bf16_f32 v32, v32, v33
    v_mfma_f32_16x16x32_bf16 v[100:103], a[208:211], v[232:235], v[100:103]
    s_mov_b32 s42, 1148928
    v_cvt_pk_bf16_f32 v33, v34, v35
    v_mfma_f32_16x16x32_bf16 v[104:107], a[212:215], v[232:235], v[104:107]
    ds_read_b128 v[232:235], v253 offset:35360
    s_waitcnt lgkmcnt(5)
    v_mfma_f32_16x16x32_bf16 v[120:123], a[192:195], v[236:239], v[120:123]
    buffer_load_dwordx4 a[252:255], v254, s[8:11], s42 offen offset:0
    v_mfma_f32_16x16x32_bf16 v[124:127], a[196:199], v[236:239], v[124:127]
    ds_write_b64 v249, v[32:33] offset:13312
    v_cvt_pk_bf16_f32 v24, v24, v25
    v_mfma_f32_16x16x32_bf16 v[128:131], a[200:203], v[236:239], v[128:131]
    ds_read_b128 a[160:163], v250 offset:8256
    v_cvt_pk_bf16_f32 v25, v26, v27
    v_cvt_pk_bf16_f32 v26, v28, v29
    v_cvt_pk_bf16_f32 v27, v30, v31
    v_mfma_f32_16x16x32_bf16 v[108:111], a[204:207], v[236:239], v[108:111]
    ds_write_b128 v248, v[24:27] offset:13248
    v_cvt_pk_bf16_f32 v44, v44, v45
    v_cvt_pk_bf16_f32 v45, v46, v47
    v_mfma_f32_16x16x32_bf16 v[112:115], a[208:211], v[236:239], v[112:115]
    buffer_load_dwordx4 v[240:243], v254, s[8:11], s42 offen offset:1024
    v_mfma_f32_16x16x32_bf16 v[116:119], a[212:215], v[236:239], v[116:119]
    s_waitcnt vmcnt(17)
    v_mfma_f32_16x16x32_bf16 v[96:99], a[216:219], v[236:239], v[96:99]
    s_waitcnt lgkmcnt(7)
    v_mfma_f32_16x16x32_bf16 v[100:103], a[220:223], v[236:239], v[100:103]
    buffer_load_dwordx4 v[244:247], v254, s[8:11], s42 offen offset:2048
    v_mfma_f32_16x16x32_bf16 v[104:107], a[224:227], v[236:239], v[104:107]
    ds_read_b128 v[236:239], v253 offset:37184
    v_and_b32 v227, 0x7fff, v255
    v_mfma_f32_16x16x32_bf16 v[132:135], a[192:195], v[228:231], v[132:135]
    ds_write_b64 v249, v[44:45] offset:13696
    v_cvt_pk_bf16_f32 v36, v36, v37
    v_cvt_pk_bf16_f32 v37, v38, v39
    v_mfma_f32_16x16x32_bf16 v[136:139], a[196:199], v[228:231], v[136:139]
    buffer_load_dwordx2 v[216:217], v227, s[4:7], s16 offen offset:384
    v_cvt_pk_bf16_f32 v38, v40, v41
    v_cvt_pk_bf16_f32 v39, v42, v43
    v_mfma_f32_16x16x32_bf16 v[140:143], a[200:203], v[228:231], v[140:143]
    ds_read_b128 a[164:167], v250 offset:11360
    v_mfma_f32_16x16x32_bf16 v[120:123], a[204:207], v[228:231], v[120:123]
    ds_write_b128 v248, v[36:39] offset:13632
    v_cvt_pk_bf16_f32 v56, v56, v57
    v_cvt_pk_bf16_f32 v57, v58, v59
    v_mfma_f32_16x16x32_bf16 v[124:127], a[208:211], v[228:231], v[124:127]
    buffer_load_dwordx2 v[218:219], v227, s[4:7], s17 offen offset:384
    v_mfma_f32_16x16x32_bf16 v[128:131], a[212:215], v[228:231], v[128:131]
    v_mfma_f32_16x16x32_bf16 v[108:111], a[216:219], v[228:231], v[108:111]
    s_waitcnt lgkmcnt(7)
    v_mfma_f32_16x16x32_bf16 v[112:115], a[220:223], v[228:231], v[112:115]
    buffer_load_dwordx2 v[220:221], v227, s[4:7], s18 offen offset:384
    v_mfma_f32_16x16x32_bf16 v[116:119], a[224:227], v[228:231], v[116:119]
    ds_read_b128 v[228:231], v253 offset:36928
    v_mfma_f32_16x16x32_bf16 v[144:147], a[192:195], v[232:235], v[144:147]
    ds_write_b64 v249, v[56:57] offset:14080
    v_cvt_pk_bf16_f32 v48, v48, v49
    v_cvt_pk_bf16_f32 v49, v50, v51
    v_mfma_f32_16x16x32_bf16 v[148:151], a[196:199], v[232:235], v[148:151]
    buffer_load_dwordx2 v[222:223], v227, s[4:7], s19 offen offset:384
    v_cvt_pk_bf16_f32 v50, v52, v53
    v_cvt_pk_bf16_f32 v51, v54, v55
    v_mfma_f32_16x16x32_bf16 v[152:155], a[200:203], v[232:235], v[152:155]
    ds_write_b128 v248, v[48:51] offset:14016
    v_cvt_pk_bf16_f32 v68, v68, v69
    v_cvt_pk_bf16_f32 v69, v70, v71
    v_mfma_f32_16x16x32_bf16 v[132:135], a[204:207], v[232:235], v[132:135]
    v_mfma_f32_16x16x32_bf16 v[136:139], a[208:211], v[232:235], v[136:139]
    buffer_load_dwordx2 v[224:225], v227, s[4:7], s20 offen offset:384
    v_mfma_f32_16x16x32_bf16 v[140:143], a[212:215], v[232:235], v[140:143]
    s_waitcnt lgkmcnt(6)
    v_mfma_f32_16x16x32_bf16 v[120:123], a[216:219], v[232:235], v[120:123]
    ds_write_b64 v249, v[68:69] offset:14464
    v_cvt_pk_bf16_f32 v60, v60, v61
    v_mfma_f32_16x16x32_bf16 v[124:127], a[220:223], v[232:235], v[124:127]
    buffer_load_dwordx2 v[226:227], v227, s[4:7], s21 offen offset:384
    v_cvt_pk_bf16_f32 v61, v62, v63
    v_cvt_pk_bf16_f32 v62, v64, v65
    v_mfma_f32_16x16x32_bf16 v[128:131], a[224:227], v[232:235], v[128:131]
    ds_read_b128 v[232:235], v253 offset:36672
    v_cvt_pk_bf16_f32 v63, v66, v67
    v_mfma_f32_16x16x32_bf16 v[156:159], a[192:195], v[236:239], v[156:159]
    ds_write_b128 v248, v[60:63] offset:14400
    v_cvt_pk_bf16_f32 v80, v80, v81
    v_mfma_f32_16x16x32_bf16 v[160:163], a[196:199], v[236:239], v[160:163]
    buffer_store_dwordx4 a[144:147], v254, s[12:15], s44 offen sc1
    s_add_u32 s44, s40, 206848
    v_cvt_pk_bf16_f32 v81, v82, v83
    v_mfma_f32_16x16x32_bf16 v[164:167], a[200:203], v[236:239], v[164:167]
    v_mfma_f32_16x16x32_bf16 v[144:147], a[204:207], v[236:239], v[144:147]
    v_mfma_f32_16x16x32_bf16 v[148:151], a[208:211], v[236:239], v[148:151]
    buffer_store_dwordx4 a[148:151], v254, s[12:15], s44 offen sc1
    s_add_u32 s44, s40, 198656
    v_mfma_f32_16x16x32_bf16 v[152:155], a[212:215], v[236:239], v[152:155]
    ds_write_b64 v249, v[80:81] offset:14848
    v_cvt_pk_bf16_f32 v72, v72, v73
    v_cvt_pk_bf16_f32 v73, v74, v75
    v_mfma_f32_16x16x32_bf16 v[132:135], a[216:219], v[236:239], v[132:135]
    s_waitcnt lgkmcnt(6)
    v_cvt_pk_bf16_f32 v74, v76, v77
    v_cvt_pk_bf16_f32 v75, v78, v79
    v_mfma_f32_16x16x32_bf16 v[136:139], a[220:223], v[236:239], v[136:139]
    buffer_store_dwordx4 a[152:155], v254, s[12:15], s44 offen sc1
    v_mfma_f32_16x16x32_bf16 v[140:143], a[224:227], v[236:239], v[140:143]
    ds_read_b128 v[236:239], v253 offset:36416
    v_mfma_f32_16x16x32_bf16 v[168:171], a[192:195], v[228:231], v[168:171]
    ds_write_b128 v248, v[72:75] offset:14784
    v_cvt_pk_bf16_f32 v92, v92, v93
    v_cvt_pk_bf16_f32 v93, v94, v95
    v_mfma_f32_16x16x32_bf16 v[172:175], a[196:199], v[228:231], v[172:175]
    s_add_u32 s44, s40, 201728
    v_mfma_f32_16x16x32_bf16 v[176:179], a[200:203], v[228:231], v[176:179]
    v_mfma_f32_16x16x32_bf16 v[156:159], a[204:207], v[228:231], v[156:159]
    v_mfma_f32_16x16x32_bf16 v[160:163], a[208:211], v[228:231], v[160:163]
    ds_write_b64 v249, v[92:93] offset:15232
    v_cvt_pk_bf16_f32 v84, v84, v85
    v_cvt_pk_bf16_f32 v85, v86, v87
    v_mfma_f32_16x16x32_bf16 v[164:167], a[212:215], v[228:231], v[164:167]
    v_cvt_pk_bf16_f32 v86, v88, v89
    v_cvt_pk_bf16_f32 v87, v90, v91
    v_mfma_f32_16x16x32_bf16 v[144:147], a[216:219], v[228:231], v[144:147]
    ds_write_b128 v248, v[84:87] offset:15168
    v_mfma_f32_16x16x32_bf16 v[148:151], a[220:223], v[228:231], v[148:151]
    s_waitcnt lgkmcnt(6)
    v_mfma_f32_16x16x32_bf16 v[152:155], a[224:227], v[228:231], v[152:155]
    ds_read_b128 v[228:231], v253 offset:36144
    v_mfma_f32_16x16x32_bf16 v[180:183], a[192:195], v[232:235], v[180:183]
    v_mfma_f32_16x16x32_bf16 v[184:187], a[196:199], v[232:235], v[184:187]
    v_mfma_f32_16x16x32_bf16 v[188:191], a[200:203], v[232:235], v[188:191]
    s_mov_b32 s42, 1179648
    v_mfma_f32_16x16x32_bf16 v[168:171], a[204:207], v[232:235], v[168:171]
    buffer_load_dwordx4 a[192:195], v254, s[8:11], s42 offen offset:0
    v_mfma_f32_16x16x32_bf16 v[172:175], a[208:211], v[232:235], v[172:175]
    v_mfma_f32_16x16x32_bf16 v[176:179], a[212:215], v[232:235], v[176:179]
    s_waitcnt lgkmcnt(4)
    v_mfma_f32_16x16x32_bf16 v[156:159], a[216:219], v[232:235], v[156:159]
    buffer_load_dwordx4 a[196:199], v254, s[8:11], s42 offen offset:1024
    v_mfma_f32_16x16x32_bf16 v[160:163], a[220:223], v[232:235], v[160:163]
    s_waitcnt lgkmcnt(0)
    s_waitcnt vmcnt(23)
    v_lshlrev_b32 v248, 16, v206
    v_mfma_f32_16x16x32_bf16 v[164:167], a[224:227], v[232:235], v[164:167]
    s_barrier
    v_mfma_f32_16x16x32_bf16 v[180:183], a[204:207], v[236:239], v[180:183]
    ds_read_b128 v[232:235], v253 offset:38480
    v_lshlrev_b32 v249, 16, v208
    v_lshlrev_b32 v250, 16, v210
    v_mfma_f32_16x16x32_bf16 v[184:187], a[208:211], v[236:239], v[184:187]
    ds_read_b128 a[0:3], v6 offset:12480
    v_lshlrev_b32 v251, 16, v212
    v_mfma_f32_16x16x32_bf16 v[188:191], a[212:215], v[236:239], v[188:191]
    buffer_load_dwordx4 a[200:203], v254, s[8:11], s42 offen offset:2048
    v_mfma_f32_16x16x32_bf16 v[168:171], a[216:219], v[236:239], v[168:171]
    v_and_b32 v206, s22, v206
    v_and_b32 v208, s22, v208
    v_and_b32 v210, s22, v210
    v_mfma_f32_16x16x32_bf16 v[172:175], a[220:223], v[236:239], v[172:175]
    s_mov_b32 s42, 1182720
    v_and_b32 v212, s22, v212
    v_lshlrev_b32 v252, 16, v204
    v_mfma_f32_16x16x32_bf16 v[176:179], a[224:227], v[236:239], v[176:179]
    ds_read_b128 v[236:239], v253 offset:38208
    v_and_b32 v204, s22, v204
    v_mfma_f32_16x16x32_bf16 v[180:183], a[216:219], v[228:231], v[180:183]
    buffer_load_dwordx4 a[204:207], v254, s[8:11], s42 offen offset:0
    v_add_f32 v252, v252, v251
    v_mfma_f32_16x16x32_bf16 v[184:187], a[220:223], v[228:231], v[184:187]
    s_waitcnt vmcnt(19) lgkmcnt(2)
    v_add_f32 v204, v204, v212
    v_fmac_f32 v252, s23, v249
    v_mfma_f32_16x16x32_bf16 v[188:191], a[224:227], v[228:231], v[188:191]
    ds_read_b128 v[228:231], v253 offset:37952
    v_fmac_f32 v204, s23, v208
    v_mfma_f32_16x16x32_bf16 v[96:99], a[228:231], v[232:235], v[96:99]
    s_waitcnt lgkmcnt(1)
    v_cvt_pk_bf16_f32 v204, v252, v204
    v_lshlrev_b32 v252, 16, v214
    v_mfma_f32_16x16x32_bf16 v[100:103], a[232:235], v[232:235], v[100:103]
    buffer_load_dwordx4 a[208:211], v254, s[8:11], s42 offen offset:1024
    v_and_b32 v214, s22, v214
    v_mfma_f32_16x16x32_bf16 v[104:107], a[236:239], v[232:235], v[104:107]
    ds_read_b128 v[232:235], v253 offset:37696
    v_add_f32 v252, v252, v248
    v_mfma_f32_16x16x32_bf16 v[108:111], a[228:231], v[236:239], v[108:111]
    v_add_f32 v214, v214, v206
    v_fmac_f32 v252, s23, v250
    v_mfma_f32_16x16x32_bf16 v[112:115], a[232:235], v[236:239], v[112:115]
    s_waitcnt vmcnt(17)
    v_fmac_f32 v214, s23, v210
    v_cvt_pk_bf16_f32 v214, v252, v214
    v_fma_f32 v252, v249, s24, v251
    v_mfma_f32_16x16x32_bf16 v[116:119], a[236:239], v[236:239], v[116:119]
    buffer_load_dwordx4 a[212:215], v254, s[8:11], s42 offen offset:2048
    v_mfma_f32_16x16x32_bf16 v[96:99], a[240:243], v[236:239], v[96:99]
    s_waitcnt lgkmcnt(1)
    v_fmac_f32 v251, s25, v249
    v_fma_f32 v249, v248, s24, v250
    v_mfma_f32_16x16x32_bf16 v[100:103], a[244:247], v[236:239], v[100:103]
    s_mov_b32 s42, 1185792
    v_fmac_f32 v250, s25, v248
    v_fma_f32 v248, v250, s26, v251
    v_fmac_f32 v251, s27, v250
    v_mfma_f32_16x16x32_bf16 v[104:107], a[248:251], v[236:239], v[104:107]
    ds_read_b128 v[236:239], v253 offset:37440
    v_fma_f32 v250, v249, s28, v252
    v_mfma_f32_16x16x32_bf16 v[120:123], a[228:231], v[228:231], v[120:123]
    buffer_load_dwordx4 a[216:219], v254, s[8:11], s42 offen offset:0
    v_mfma_f32_16x16x32_bf16 v[124:127], a[232:235], v[228:231], v[124:127]
    v_fmac_f32 v252, s29, v249
    v_fma_f32 v249, v208, s24, v212
    v_mfma_f32_16x16x32_bf16 v[128:131], a[236:239], v[228:231], v[128:131]
    v_fmac_f32 v212, s25, v208
    v_fma_f32 v208, v206, s24, v210
    v_fmac_f32 v210, s25, v206
    v_mfma_f32_16x16x32_bf16 v[108:111], a[240:243], v[228:231], v[108:111]
    ds_read_b128 a[4:7], v6 offset:13504
    v_fma_f32 v206, v210, s26, v212
    v_mfma_f32_16x16x32_bf16 v[112:115], a[244:247], v[228:231], v[112:115]
    buffer_load_dwordx4 a[220:223], v254, s[8:11], s42 offen offset:1024
    v_mfma_f32_16x16x32_bf16 v[116:119], a[248:251], v[228:231], v[116:119]
    s_waitcnt vmcnt(17)
    v_fmac_f32 v212, s27, v210
    v_fma_f32 v210, v208, s28, v249
    v_fmac_f32 v249, s29, v208
    v_mfma_f32_16x16x32_bf16 v[96:99], a[252:255], v[228:231], v[96:99]
    s_waitcnt lgkmcnt(2)
    v_cvt_pk_bf16_f32 v206, v248, v206
    v_cvt_pk_bf16_f32 v212, v251, v212
    v_mfma_f32_16x16x32_bf16 v[100:103], v[240:243], v[228:231], v[100:103]
    buffer_load_dwordx4 a[224:227], v254, s[8:11], s42 offen offset:2048
    v_mfma_f32_16x16x32_bf16 v[104:107], v[244:247], v[228:231], v[104:107]
    ds_read_b128 v[228:231], v253 offset:39264
    v_and_b32 v203, 0x7fff, v255
    v_cvt_pk_bf16_f32 v210, v250, v210
    v_mfma_f32_16x16x32_bf16 v[132:135], a[228:231], v[232:235], v[132:135]
    v_cvt_pk_bf16_f32 v208, v252, v249
    v_lshlrev_b32 v248, 16, v207
    v_mfma_f32_16x16x32_bf16 v[136:139], a[232:235], v[232:235], v[136:139]
    buffer_load_dwordx2 v[192:193], v203, s[4:7], s16 offen offset:768
    v_mfma_f32_16x16x32_bf16 v[140:143], a[236:239], v[232:235], v[140:143]
    v_lshlrev_b32 v249, 16, v209
    v_lshlrev_b32 v250, 16, v211
    v_mfma_f32_16x16x32_bf16 v[120:123], a[240:243], v[232:235], v[120:123]
    v_lshlrev_b32 v251, 16, v213
    v_and_b32 v207, s22, v207
    v_and_b32 v209, s22, v209
    v_mfma_f32_16x16x32_bf16 v[124:127], a[244:247], v[232:235], v[124:127]
    buffer_load_dwordx2 v[194:195], v203, s[4:7], s17 offen offset:768
    v_mfma_f32_16x16x32_bf16 v[128:131], a[248:251], v[232:235], v[128:131]
    v_and_b32 v211, s22, v211
    v_and_b32 v213, s22, v213
    v_mfma_f32_16x16x32_bf16 v[108:111], a[252:255], v[232:235], v[108:111]
    s_waitcnt lgkmcnt(2)
    v_lshlrev_b32 v252, 16, v205
    v_and_b32 v205, s22, v205
    v_add_f32 v252, v252, v251
    v_mfma_f32_16x16x32_bf16 v[112:115], v[240:243], v[232:235], v[112:115]
    buffer_load_dwordx2 v[196:197], v203, s[4:7], s18 offen offset:768
    v_mfma_f32_16x16x32_bf16 v[116:119], v[244:247], v[232:235], v[116:119]
    ds_read_b128 v[232:235], v253 offset:39008
    v_add_f32 v205, v205, v213
    v_mfma_f32_16x16x32_bf16 v[144:147], a[228:231], v[236:239], v[144:147]
    v_fmac_f32 v252, s23, v249
    v_fmac_f32 v205, s23, v209
    v_cvt_pk_bf16_f32 v205, v252, v205
    v_mfma_f32_16x16x32_bf16 v[148:151], a[232:235], v[236:239], v[148:151]
    buffer_load_dwordx2 v[198:199], v203, s[4:7], s19 offen offset:768
    v_mfma_f32_16x16x32_bf16 v[152:155], a[236:239], v[236:239], v[152:155]
    v_lshlrev_b32 v252, 16, v215
    v_and_b32 v215, s22, v215
    v_mfma_f32_16x16x32_bf16 v[132:135], a[240:243], v[236:239], v[132:135]
    v_add_f32 v252, v252, v248
    v_add_f32 v215, v215, v207
    v_mfma_f32_16x16x32_bf16 v[136:139], a[244:247], v[236:239], v[136:139]
    buffer_load_dwordx2 v[200:201], v203, s[4:7], s20 offen offset:768
    v_fmac_f32 v252, s23, v250
    v_mfma_f32_16x16x32_bf16 v[140:143], a[248:251], v[236:239], v[140:143]
    ds_read_b128 a[8:11], v6 offset:14528
    v_fmac_f32 v215, s23, v211
    v_mfma_f32_16x16x32_bf16 v[120:123], a[252:255], v[236:239], v[120:123]
    s_waitcnt lgkmcnt(2)
    v_cvt_pk_bf16_f32 v215, v252, v215
    v_fma_f32 v252, v249, s24, v251
    v_mfma_f32_16x16x32_bf16 v[124:127], v[240:243], v[236:239], v[124:127]
    buffer_load_dwordx2 v[202:203], v203, s[4:7], s21 offen offset:768
    v_fmac_f32 v251, s25, v249
    v_mfma_f32_16x16x32_bf16 v[128:131], v[244:247], v[236:239], v[128:131]
    ds_read_b128 v[236:239], v253 offset:38752
    v_fma_f32 v249, v248, s24, v250
    v_mfma_f32_16x16x32_bf16 v[156:159], a[228:231], v[228:231], v[156:159]
    v_fmac_f32 v250, s25, v248
    v_fma_f32 v248, v250, s26, v251
    v_mfma_f32_16x16x32_bf16 v[160:163], a[232:235], v[228:231], v[160:163]
    buffer_store_dwordx4 a[156:159], v254, s[12:15], s44 offen sc1
    s_add_u32 s44, s40, 204800
    v_fmac_f32 v251, s27, v250
    v_mfma_f32_16x16x32_bf16 v[164:167], a[236:239], v[228:231], v[164:167]
    v_fma_f32 v250, v249, s28, v252
    v_fmac_f32 v252, s29, v249
    v_mfma_f32_16x16x32_bf16 v[144:147], a[240:243], v[228:231], v[144:147]
    v_fma_f32 v249, v209, s24, v213
    v_fmac_f32 v213, s25, v209
    v_mfma_f32_16x16x32_bf16 v[148:151], a[244:247], v[228:231], v[148:151]
    buffer_store_dwordx4 a[160:163], v254, s[12:15], s44 offen sc1
    s_add_u32 s44, s40, 207872
    v_mfma_f32_16x16x32_bf16 v[152:155], a[248:251], v[228:231], v[152:155]
    v_fma_f32 v209, v207, s24, v211
    v_fmac_f32 v211, s25, v207
    v_fma_f32 v207, v211, s26, v213
    v_mfma_f32_16x16x32_bf16 v[132:135], a[252:255], v[228:231], v[132:135]
    s_waitcnt lgkmcnt(2)
    v_fmac_f32 v213, s27, v211
    v_fma_f32 v211, v209, s28, v249
    v_mfma_f32_16x16x32_bf16 v[136:139], v[240:243], v[228:231], v[136:139]
    buffer_store_dwordx4 a[164:167], v254, s[12:15], s44 offen sc1
    v_fmac_f32 v249, s29, v209
    v_cvt_pk_bf16_f32 v207, v248, v207
    v_mfma_f32_16x16x32_bf16 v[140:143], v[244:247], v[228:231], v[140:143]
    ds_read_b128 v[228:231], v253 offset:38496
    v_cvt_pk_bf16_f32 v213, v251, v213
    v_cvt_pk_bf16_f32 v211, v250, v211
    v_mfma_f32_16x16x32_bf16 v[168:171], a[228:231], v[232:235], v[168:171]
    v_cvt_pk_bf16_f32 v209, v252, v249
    v_lshrrev_b32 v252, 15, v255
    v_mfma_f32_16x16x32_bf16 v[172:175], a[232:235], v[232:235], v[172:175]
    ds_write_b64 v252, v[206:207] offset:768
    v_mfma_f32_16x16x32_bf16 v[176:179], a[236:239], v[232:235], v[176:179]
    s_waitcnt vmcnt(21)
    v_lshlrev_b32 v248, 16, v218
    v_lshlrev_b32 v249, 16, v220
    v_mfma_f32_16x16x32_bf16 v[156:159], a[240:243], v[232:235], v[156:159]
    ds_write_b64 v252, v[212:213] offset:2848
    v_mfma_f32_16x16x32_bf16 v[160:163], a[244:247], v[232:235], v[160:163]
    s_waitcnt lgkmcnt(3)
    v_lshlrev_b32 v250, 16, v222
    v_lshlrev_b32 v251, 16, v224
    v_mfma_f32_16x16x32_bf16 v[164:167], a[248:251], v[232:235], v[164:167]
    ds_write_b64 v252, v[210:211] offset:4928
    v_mfma_f32_16x16x32_bf16 v[144:147], a[252:255], v[232:235], v[144:147]
    s_add_u32 s44, s40, 0
    v_and_b32 v218, s22, v218
    v_and_b32 v220, s22, v220
    v_mfma_f32_16x16x32_bf16 v[148:151], v[240:243], v[232:235], v[148:151]
    ds_write_b64 v252, v[204:205] offset:34048
    v_mfma_f32_16x16x32_bf16 v[152:155], v[244:247], v[232:235], v[152:155]
    ds_read_b128 v[232:235], v253 offset:38224
    v_and_b32 v222, s22, v222
    v_mfma_f32_16x16x32_bf16 v[180:183], a[228:231], v[236:239], v[180:183]
    ds_read_b128 a[12:15], v6 offset:15584
    v_and_b32 v224, s22, v224
    v_mfma_f32_16x16x32_bf16 v[184:187], a[232:235], v[236:239], v[184:187]
    ds_write_b64 v252, v[214:215] offset:36128
    v_mfma_f32_16x16x32_bf16 v[188:191], a[236:239], v[236:239], v[188:191]
    s_mov_b32 s42, 1216512
    v_mfma_f32_16x16x32_bf16 v[168:171], a[240:243], v[236:239], v[168:171]
    buffer_load_dwordx4 a[228:231], v254, s[8:11], s42 offen offset:0
    v_mfma_f32_16x16x32_bf16 v[172:175], a[244:247], v[236:239], v[172:175]
    v_mfma_f32_16x16x32_bf16 v[176:179], a[248:251], v[236:239], v[176:179]
    ds_write_b64 v252, v[208:209] offset:7008
    v_mfma_f32_16x16x32_bf16 v[156:159], a[252:255], v[236:239], v[156:159]
    buffer_load_dwordx4 a[232:235], v254, s[8:11], s42 offen offset:1024
    v_mfma_f32_16x16x32_bf16 v[160:163], v[240:243], v[236:239], v[160:163]
    v_lshlrev_b32 v252, 16, v216
    v_and_b32 v216, s22, v216
    v_add_f32 v252, v252, v251
    v_mfma_f32_16x16x32_bf16 v[164:167], v[244:247], v[236:239], v[164:167]
    s_waitcnt lgkmcnt(8)
    v_add_f32 v216, v216, v224
    v_fmac_f32 v252, s23, v249
    v_mfma_f32_16x16x32_bf16 v[180:183], a[240:243], v[228:231], v[180:183]
    ds_read_b128 v[236:239], v253 offset:26000
    v_fmac_f32 v216, s23, v220
    v_mfma_f32_16x16x32_bf16 v[184:187], a[244:247], v[228:231], v[184:187]
    v_cvt_pk_bf16_f32 v216, v252, v216
    v_lshlrev_b32 v252, 16, v226
    v_and_b32 v226, s22, v226
    v_mfma_f32_16x16x32_bf16 v[188:191], a[248:251], v[228:231], v[188:191]
    buffer_load_dwordx4 a[236:239], v254, s[8:11], s42 offen offset:2048
    v_mfma_f32_16x16x32_bf16 v[168:171], a[252:255], v[228:231], v[168:171]
    s_waitcnt lgkmcnt(4)
    v_add_f32 v252, v252, v248
    v_add_f32 v226, v226, v218
    v_mfma_f32_16x16x32_bf16 v[172:175], v[240:243], v[228:231], v[172:175]
    s_mov_b32 s42, 1219584
    v_fmac_f32 v252, s23, v250
    v_fmac_f32 v226, s23, v222
    v_cvt_pk_bf16_f32 v226, v252, v226
    v_mfma_f32_16x16x32_bf16 v[176:179], v[244:247], v[228:231], v[176:179]
    ds_read_b128 v[228:231], v253 offset:25728
    v_fma_f32 v252, v249, s24, v251
    v_mfma_f32_16x16x32_bf16 v[180:183], a[252:255], v[232:235], v[180:183]
    buffer_load_dwordx4 a[240:243], v254, s[8:11], s42 offen offset:0
    v_mfma_f32_16x16x32_bf16 v[184:187], v[240:243], v[232:235], v[184:187]
    s_waitcnt vmcnt(19) lgkmcnt(1)
    v_fmac_f32 v251, s25, v249
    v_fma_f32 v249, v248, s24, v250
    v_mfma_f32_16x16x32_bf16 v[188:191], v[244:247], v[232:235], v[188:191]
    ds_read_b128 v[232:235], v253 offset:25472
    v_fmac_f32 v250, s25, v248
    v_fma_f32 v248, v250, s26, v251
    v_mfma_f32_16x16x32_bf16 v[96:99], a[192:195], v[236:239], v[96:99]
    s_waitcnt lgkmcnt(1)
    v_fmac_f32 v251, s27, v250
    v_fma_f32 v250, v249, s28, v252
    v_mfma_f32_16x16x32_bf16 v[100:103], a[196:199], v[236:239], v[100:103]
    buffer_load_dwordx4 a[244:247], v254, s[8:11], s42 offen offset:1024
    v_mfma_f32_16x16x32_bf16 v[104:107], a[200:203], v[236:239], v[104:107]
    ds_read_b128 v[236:239], v253 offset:25216
    v_fmac_f32 v252, s29, v249
    v_fma_f32 v249, v220, s24, v224
    v_mfma_f32_16x16x32_bf16 v[108:111], a[192:195], v[228:231], v[108:111]
    ds_read_b128 a[16:19], v6 offset:16608
    v_fmac_f32 v224, s25, v220
    v_mfma_f32_16x16x32_bf16 v[112:115], a[196:199], v[228:231], v[112:115]
    s_waitcnt vmcnt(17)
    v_fma_f32 v220, v218, s24, v222
    v_fmac_f32 v222, s25, v218
    v_mfma_f32_16x16x32_bf16 v[116:119], a[200:203], v[228:231], v[116:119]
    buffer_load_dwordx4 a[248:251], v254, s[8:11], s42 offen offset:2048
    v_fma_f32 v218, v222, s26, v224
    v_mfma_f32_16x16x32_bf16 v[96:99], a[204:207], v[228:231], v[96:99]
    s_waitcnt lgkmcnt(2)
    v_fmac_f32 v224, s27, v222
    v_fma_f32 v222, v220, s28, v249
    v_mfma_f32_16x16x32_bf16 v[100:103], a[208:211], v[228:231], v[100:103]
    s_mov_b32 s42, 1222656
    v_fmac_f32 v249, s29, v220
    v_cvt_pk_bf16_f32 v218, v248, v218
    v_mfma_f32_16x16x32_bf16 v[104:107], a[212:215], v[228:231], v[104:107]
    ds_read_b128 v[228:231], v253 offset:24960
    v_cvt_pk_bf16_f32 v224, v251, v224
    v_mfma_f32_16x16x32_bf16 v[120:123], a[192:195], v[232:235], v[120:123]
    buffer_load_dwordx4 a[252:255], v254, s[8:11], s42 offen offset:0
    v_cvt_pk_bf16_f32 v222, v250, v222
    v_mfma_f32_16x16x32_bf16 v[124:127], a[196:199], v[232:235], v[124:127]
    v_cvt_pk_bf16_f32 v220, v252, v249
    v_lshlrev_b32 v248, 16, v219
    v_mfma_f32_16x16x32_bf16 v[128:131], a[200:203], v[232:235], v[128:131]
    v_lshlrev_b32 v249, 16, v221
    v_lshlrev_b32 v250, 16, v223
    v_mfma_f32_16x16x32_bf16 v[108:111], a[204:207], v[232:235], v[108:111]
    v_lshlrev_b32 v251, 16, v225
    v_and_b32 v219, s22, v219
    v_and_b32 v221, s22, v221
    v_mfma_f32_16x16x32_bf16 v[112:115], a[208:211], v[232:235], v[112:115]
    buffer_load_dwordx4 v[240:243], v254, s[8:11], s42 offen offset:1024
    v_mfma_f32_16x16x32_bf16 v[116:119], a[212:215], v[232:235], v[116:119]
    s_waitcnt vmcnt(17)
    v_and_b32 v223, s22, v223
    v_and_b32 v225, s22, v225
    v_mfma_f32_16x16x32_bf16 v[96:99], a[216:219], v[232:235], v[96:99]
    s_waitcnt lgkmcnt(2)
    v_lshlrev_b32 v252, 16, v217
    v_and_b32 v217, s22, v217
    v_add_f32 v252, v252, v251
    v_mfma_f32_16x16x32_bf16 v[100:103], a[220:223], v[232:235], v[100:103]
    buffer_load_dwordx4 v[244:247], v254, s[8:11], s42 offen offset:2048
    v_mfma_f32_16x16x32_bf16 v[104:107], a[224:227], v[232:235], v[104:107]
    ds_read_b128 v[232:235], v253 offset:26784
    v_and_b32 v215, 0x7fff, v255
    v_mfma_f32_16x16x32_bf16 v[132:135], a[192:195], v[236:239], v[132:135]
    v_add_f32 v217, v217, v225
    v_fmac_f32 v252, s23, v249
    v_mfma_f32_16x16x32_bf16 v[136:139], a[196:199], v[236:239], v[136:139]
    buffer_load_dwordx2 v[204:205], v215, s[4:7], s16 offen offset:1152
    v_fmac_f32 v217, s23, v221
    v_mfma_f32_16x16x32_bf16 v[140:143], a[200:203], v[236:239], v[140:143]
    v_cvt_pk_bf16_f32 v217, v252, v217
    v_lshlrev_b32 v252, 16, v227
    v_mfma_f32_16x16x32_bf16 v[120:123], a[204:207], v[236:239], v[120:123]
    ds_read_b128 a[20:23], v6 offset:17632
    v_and_b32 v227, s22, v227
    v_mfma_f32_16x16x32_bf16 v[124:127], a[208:211], v[236:239], v[124:127]
    buffer_load_dwordx2 v[206:207], v215, s[4:7], s17 offen offset:1152
    v_add_f32 v252, v252, v248
    v_mfma_f32_16x16x32_bf16 v[128:131], a[212:215], v[236:239], v[128:131]
    v_add_f32 v227, v227, v219
    v_fmac_f32 v252, s23, v250
    v_mfma_f32_16x16x32_bf16 v[108:111], a[216:219], v[236:239], v[108:111]
    s_waitcnt lgkmcnt(2)
    v_fmac_f32 v227, s23, v223
    v_cvt_pk_bf16_f32 v227, v252, v227
    v_mfma_f32_16x16x32_bf16 v[112:115], a[220:223], v[236:239], v[112:115]
    buffer_load_dwordx2 v[208:209], v215, s[4:7], s18 offen offset:1152
    v_fma_f32 v252, v249, s24, v251
    v_mfma_f32_16x16x32_bf16 v[116:119], a[224:227], v[236:239], v[116:119]
    ds_read_b128 v[236:239], v253 offset:26528
    v_fmac_f32 v251, s25, v249
    v_mfma_f32_16x16x32_bf16 v[144:147], a[192:195], v[228:231], v[144:147]
    v_fma_f32 v249, v248, s24, v250
    v_fmac_f32 v250, s25, v248
    v_mfma_f32_16x16x32_bf16 v[148:151], a[196:199], v[228:231], v[148:151]
    buffer_load_dwordx2 v[210:211], v215, s[4:7], s19 offen offset:1152
    v_mfma_f32_16x16x32_bf16 v[152:155], a[200:203], v[228:231], v[152:155]
    v_fma_f32 v248, v250, s26, v251
    v_fmac_f32 v251, s27, v250
    v_fma_f32 v250, v249, s28, v252
    v_mfma_f32_16x16x32_bf16 v[132:135], a[204:207], v[228:231], v[132:135]
    v_fmac_f32 v252, s29, v249
    v_fma_f32 v249, v221, s24, v225
    v_mfma_f32_16x16x32_bf16 v[136:139], a[208:211], v[228:231], v[136:139]
    buffer_load_dwordx2 v[212:213], v215, s[4:7], s20 offen offset:1152
    v_mfma_f32_16x16x32_bf16 v[140:143], a[212:215], v[228:231], v[140:143]
    v_fmac_f32 v225, s25, v221
    v_fma_f32 v221, v219, s24, v223
    v_fmac_f32 v223, s25, v219
    v_mfma_f32_16x16x32_bf16 v[120:123], a[216:219], v[228:231], v[120:123]
    s_waitcnt lgkmcnt(2)
    v_fma_f32 v219, v223, s26, v225
    v_fmac_f32 v225, s27, v223
    v_mfma_f32_16x16x32_bf16 v[124:127], a[220:223], v[228:231], v[124:127]
    buffer_load_dwordx2 v[214:215], v215, s[4:7], s21 offen offset:1152
    v_mfma_f32_16x16x32_bf16 v[128:131], a[224:227], v[228:231], v[128:131]
    ds_read_b128 v[228:231], v253 offset:26272
    v_fma_f32 v223, v221, s28, v249
    v_fmac_f32 v249, s29, v221
    v_mfma_f32_16x16x32_bf16 v[156:159], a[192:195], v[232:235], v[156:159]
    v_cvt_pk_bf16_f32 v219, v248, v219
    v_cvt_pk_bf16_f32 v225, v251, v225
    v_mfma_f32_16x16x32_bf16 v[160:163], a[196:199], v[232:235], v[160:163]
    buffer_store_dwordx4 a[0:3], v254, s[12:15], s44 offen sc1
    s_add_u32 s44, s40, 1024
    v_mfma_f32_16x16x32_bf16 v[164:167], a[200:203], v[232:235], v[164:167]
    v_cvt_pk_bf16_f32 v223, v250, v223
    v_cvt_pk_bf16_f32 v221, v252, v249
    v_mfma_f32_16x16x32_bf16 v[144:147], a[204:207], v[232:235], v[144:147]
    s_waitcnt lgkmcnt(1)
    v_lshrrev_b32 v252, 15, v255
    v_mfma_f32_16x16x32_bf16 v[148:151], a[208:211], v[232:235], v[148:151]
    buffer_store_dwordx4 a[4:7], v254, s[12:15], s44 offen sc1
    s_add_u32 s44, s40, 2048
    v_mfma_f32_16x16x32_bf16 v[152:155], a[212:215], v[232:235], v[152:155]
    ds_write_b64 v252, v[218:219] offset:512
    v_mfma_f32_16x16x32_bf16 v[132:135], a[216:219], v[232:235], v[132:135]
    ds_read_b128 a[24:27], v6 offset:18688
    s_waitcnt vmcnt(20)
    v_lshlrev_b32 v248, 16, v194
    v_mfma_f32_16x16x32_bf16 v[136:139], a[220:223], v[232:235], v[136:139]
    buffer_store_dwordx4 a[8:11], v254, s[12:15], s44 offen sc1
    v_lshlrev_b32 v249, 16, v196
    v_mfma_f32_16x16x32_bf16 v[140:143], a[224:227], v[232:235], v[140:143]
    ds_read_b128 v[232:235], v253 offset:26016
    v_mfma_f32_16x16x32_bf16 v[168:171], a[192:195], v[236:239], v[168:171]
    ds_write_b64 v252, v[224:225] offset:2592
    v_lshlrev_b32 v250, 16, v198
    v_mfma_f32_16x16x32_bf16 v[172:175], a[196:199], v[236:239], v[172:175]
    v_lshlrev_b32 v251, 16, v200
    v_mfma_f32_16x16x32_bf16 v[176:179], a[200:203], v[236:239], v[176:179]
    s_add_u32 s44, s40, 3072
    v_mfma_f32_16x16x32_bf16 v[156:159], a[204:207], v[236:239], v[156:159]
    ds_write_b64 v252, v[222:223] offset:4672
    v_mfma_f32_16x16x32_bf16 v[160:163], a[208:211], v[236:239], v[160:163]
    v_and_b32 v194, s22, v194
    v_and_b32 v196, s22, v196
    v_mfma_f32_16x16x32_bf16 v[164:167], a[212:215], v[236:239], v[164:167]
    ds_write_b64 v252, v[216:217] offset:33792
    v_mfma_f32_16x16x32_bf16 v[144:147], a[216:219], v[236:239], v[144:147]
    s_waitcnt lgkmcnt(6)
    v_and_b32 v198, s22, v198
    v_and_b32 v200, s22, v200
    v_mfma_f32_16x16x32_bf16 v[148:151], a[220:223], v[236:239], v[148:151]
    ds_write_b64 v252, v[226:227] offset:35872
    v_mfma_f32_16x16x32_bf16 v[152:155], a[224:227], v[236:239], v[152:155]
    ds_read_b128 v[236:239], v253 offset:25744
    v_mfma_f32_16x16x32_bf16 v[180:183], a[192:195], v[228:231], v[180:183]
    ds_write_b64 v252, v[220:221] offset:6752
    v_mfma_f32_16x16x32_bf16 v[184:187], a[196:199], v[228:231], v[184:187]
    v_mfma_f32_16x16x32_bf16 v[188:191], a[200:203], v[228:231], v[188:191]
    s_mov_b32 s42, 1253376
    v_mfma_f32_16x16x32_bf16 v[168:171], a[204:207], v[228:231], v[168:171]
    buffer_load_dwordx4 a[192:195], v254, s[8:11], s42 offen offset:0
    v_mfma_f32_16x16x32_bf16 v[172:175], a[208:211], v[228:231], v[172:175]
    v_mfma_f32_16x16x32_bf16 v[176:179], a[212:215], v[228:231], v[176:179]
    v_mfma_f32_16x16x32_bf16 v[156:159], a[216:219], v[228:231], v[156:159]
    buffer_load_dwordx4 a[196:199], v254, s[8:11], s42 offen offset:1024
    v_mfma_f32_16x16x32_bf16 v[160:163], a[220:223], v[228:231], v[160:163]
    s_waitcnt lgkmcnt(6)
    v_lshlrev_b32 v252, 16, v192
    v_and_b32 v192, s22, v192
    v_mfma_f32_16x16x32_bf16 v[164:167], a[224:227], v[228:231], v[164:167]
    ds_read_b128 a[28:31], v6 offset:19712
    v_add_f32 v252, v252, v251
    v_mfma_f32_16x16x32_bf16 v[180:183], a[204:207], v[232:235], v[180:183]
    ds_read_b128 v[228:231], v253 offset:28080
    v_add_f32 v192, v192, v200
    v_mfma_f32_16x16x32_bf16 v[184:187], a[208:211], v[232:235], v[184:187]
    ds_read_b128 v[216:219], v253 offset:39520
    v_fmac_f32 v252, s23, v249
    v_mfma_f32_16x16x32_bf16 v[188:191], a[212:215], v[232:235], v[188:191]
    buffer_load_dwordx4 a[200:203], v254, s[8:11], s42 offen offset:2048
    v_fmac_f32 v192, s23, v196
    v_mfma_f32_16x16x32_bf16 v[168:171], a[216:219], v[232:235], v[168:171]
    s_mov_b32 s45, 573637648
    v_cvt_pk_bf16_f32 v192, v252, v192
    v_lshlrev_b32 v252, 16, v202
    v_mfma_f32_16x16x32_bf16 v[172:175], a[220:223], v[232:235], v[172:175]
    s_mov_b32 s42, 1256448
    v_and_b32 v202, s22, v202
    v_add_f32 v252, v252, v248
    v_mfma_f32_16x16x32_bf16 v[176:179], a[224:227], v[232:235], v[176:179]
    ds_read_b128 v[232:235], v253 offset:27808
    v_bfe_u32 v220, v254, 5, 3
    s_waitcnt lgkmcnt(5)
    v_mfma_f32_16x16x32_bf16 v[180:183], a[216:219], v[236:239], v[180:183]
    buffer_load_dwordx4 a[204:207], v254, s[8:11], s42 offen offset:0
    v_mfma_f32_16x16x32_bf16 v[184:187], a[220:223], v[236:239], v[184:187]
    s_waitcnt vmcnt(19) lgkmcnt(2)
    v_add_f32 v202, v202, v194
    v_fmac_f32 v252, s23, v250
    v_mfma_f32_16x16x32_bf16 v[188:191], a[224:227], v[236:239], v[188:191]
    ds_read_b128 v[236:239], v253 offset:27552
    v_mul_u32_u24 v221, 5, v220
    v_mfma_f32_16x16x32_bf16 v[96:99], a[228:231], v[228:231], v[96:99]
    s_waitcnt lgkmcnt(1)
    v_fmac_f32 v202, s23, v198
    v_cvt_pk_bf16_f32 v202, v252, v202
    v_mfma_f32_16x16x32_bf16 v[100:103], a[232:235], v[228:231], v[100:103]
    buffer_load_dwordx4 a[208:211], v254, s[8:11], s42 offen offset:1024
    v_mfma_f32_16x16x32_bf16 v[104:107], a[236:239], v[228:231], v[104:107]
    ds_read_b128 v[228:231], v253 offset:27296
    v_bfe_u32 v221, s45, v221, 5
    v_mfma_f32_16x16x32_bf16 v[108:111], a[228:231], v[232:235], v[108:111]
    v_fma_f32 v252, v249, s24, v251
    v_fmac_f32 v251, s25, v249
    v_fma_f32 v249, v248, s24, v250
    v_mfma_f32_16x16x32_bf16 v[112:115], a[232:235], v[232:235], v[112:115]
    s_waitcnt vmcnt(17)
    v_mul_u32_u24 v221, 65, v221
    v_fmac_f32 v250, s25, v248
    v_mfma_f32_16x16x32_bf16 v[116:119], a[236:239], v[232:235], v[116:119]
    buffer_load_dwordx4 a[212:215], v254, s[8:11], s42 offen offset:2048
    v_mfma_f32_16x16x32_bf16 v[96:99], a[240:243], v[232:235], v[96:99]
    s_waitcnt lgkmcnt(1)
    v_sub_u32 v221, v221, v220
    v_fma_f32 v248, v250, s26, v251
    v_mfma_f32_16x16x32_bf16 v[100:103], a[244:247], v[232:235], v[100:103]
    s_mov_b32 s42, 1259520
    v_fmac_f32 v251, s27, v250
    v_fma_f32 v250, v249, s28, v252
    v_mfma_f32_16x16x32_bf16 v[104:107], a[248:251], v[232:235], v[104:107]
    ds_read_b128 v[232:235], v253 offset:27040
    v_lshl_add_u32 v220, v221, 5, v253
    v_mfma_f32_16x16x32_bf16 v[120:123], a[228:231], v[236:239], v[120:123]
    buffer_load_dwordx4 a[216:219], v254, s[8:11], s42 offen offset:0
    v_mfma_f32_16x16x32_bf16 v[124:127], a[232:235], v[236:239], v[124:127]
    ds_read_b128 a[32:35], v6 offset:20736
    v_fmac_f32 v252, s29, v249
    v_mfma_f32_16x16x32_bf16 v[128:131], a[236:239], v[236:239], v[128:131]
    v_fma_f32 v249, v196, s24, v200
    v_fmac_f32 v200, s25, v196
    v_mfma_f32_16x16x32_bf16 v[108:111], a[240:243], v[236:239], v[108:111]
    s_waitcnt vmcnt(16)
    v_fma_f32 v196, v194, s24, v198
    v_fmac_f32 v198, s25, v194
    v_mfma_f32_16x16x32_bf16 v[112:115], a[244:247], v[236:239], v[112:115]
    buffer_load_dwordx4 a[220:223], v254, s[8:11], s42 offen offset:1024
    v_fma_f32 v194, v198, s26, v200
    v_mfma_f32_16x16x32_bf16 v[116:119], a[248:251], v[236:239], v[116:119]
    s_mov_b64 exec, s[46:47]
    ds_write_b128 v220, v[216:219] offset:1024
    s_mov_b64 exec, -1
    v_mfma_f32_16x16x32_bf16 v[96:99], a[252:255], v[236:239], v[96:99]
    s_waitcnt lgkmcnt(3)
    v_fmac_f32 v200, s27, v198
    v_fma_f32 v198, v196, s28, v249
    v_mfma_f32_16x16x32_bf16 v[100:103], v[240:243], v[236:239], v[100:103]
    buffer_load_dwordx4 a[224:227], v254, s[8:11], s42 offen offset:2048
    v_mfma_f32_16x16x32_bf16 v[104:107], v[244:247], v[236:239], v[104:107]
    ds_read_b128 v[236:239], v253 offset:28864
    v_fmac_f32 v249, s29, v196
    v_mfma_f32_16x16x32_bf16 v[132:135], a[228:231], v[228:231], v[132:135]
    v_cvt_pk_bf16_f32 v194, v248, v194
    v_cvt_pk_bf16_f32 v200, v251, v200
    v_mfma_f32_16x16x32_bf16 v[136:139], a[232:235], v[228:231], v[136:139]
    buffer_store_dwordx4 a[12:15], v254, s[12:15], s44 offen sc1
    s_add_u32 s44, s40, 4096
    v_mfma_f32_16x16x32_bf16 v[140:143], a[236:239], v[228:231], v[140:143]
    v_cvt_pk_bf16_f32 v198, v250, v198
    v_cvt_pk_bf16_f32 v196, v252, v249
    v_mfma_f32_16x16x32_bf16 v[120:123], a[240:243], v[228:231], v[120:123]
    v_lshlrev_b32 v248, 16, v195
    v_lshlrev_b32 v249, 16, v197
    v_mfma_f32_16x16x32_bf16 v[124:127], a[244:247], v[228:231], v[124:127]
    buffer_store_dwordx4 a[16:19], v254, s[12:15], s44 offen sc1
    s_add_u32 s44, s40, 5120
    v_lshlrev_b32 v250, 16, v199
    v_mfma_f32_16x16x32_bf16 v[128:131], a[248:251], v[228:231], v[128:131]
    v_lshlrev_b32 v251, 16, v201
    v_and_b32 v195, s22, v195
    v_and_b32 v197, s22, v197
    v_mfma_f32_16x16x32_bf16 v[108:111], a[252:255], v[228:231], v[108:111]
    v_and_b32 v199, s22, v199
    v_and_b32 v201, s22, v201
    v_mfma_f32_16x16x32_bf16 v[112:115], v[240:243], v[228:231], v[112:115]
    s_waitcnt lgkmcnt(3)
    v_lshlrev_b32 v252, 16, v193
    v_and_b32 v193, s22, v193
    v_mfma_f32_16x16x32_bf16 v[116:119], v[244:247], v[228:231], v[116:119]
    ds_read_b128 v[228:231], v253 offset:28608
    v_add_f32 v252, v252, v251
    v_mfma_f32_16x16x32_bf16 v[144:147], a[228:231], v[232:235], v[144:147]
    v_add_f32 v193, v193, v201
    v_fmac_f32 v252, s23, v249
    v_mfma_f32_16x16x32_bf16 v[148:151], a[232:235], v[232:235], v[148:151]
    v_fmac_f32 v193, s23, v197
    v_cvt_pk_bf16_f32 v193, v252, v193
    v_mfma_f32_16x16x32_bf16 v[152:155], a[236:239], v[232:235], v[152:155]
    v_lshlrev_b32 v252, 16, v203
    v_and_b32 v203, s22, v203
    v_mfma_f32_16x16x32_bf16 v[132:135], a[240:243], v[232:235], v[132:135]
    v_add_f32 v252, v252, v248
    v_add_f32 v203, v203, v195
    v_mfma_f32_16x16x32_bf16 v[136:139], a[244:247], v[232:235], v[136:139]
    ds_read_b128 a[36:39], v6 offset:21792
    v_fmac_f32 v252, s23, v250
    v_mfma_f32_16x16x32_bf16 v[140:143], a[248:251], v[232:235], v[140:143]
    v_fmac_f32 v203, s23, v199
    v_cvt_pk_bf16_f32 v203, v252, v203
    v_mfma_f32_16x16x32_bf16 v[120:123], a[252:255], v[232:235], v[120:123]
    v_fma_f32 v252, v249, s24, v251
    v_fmac_f32 v251, s25, v249
    v_fma_f32 v249, v248, s24, v250
    v_mfma_f32_16x16x32_bf16 v[124:127], v[240:243], v[232:235], v[124:127]
    s_waitcnt lgkmcnt(2)
    v_fmac_f32 v250, s25, v248
    v_fma_f32 v248, v250, s26, v251
    v_mfma_f32_16x16x32_bf16 v[128:131], v[244:247], v[232:235], v[128:131]
    ds_read_b128 v[232:235], v253 offset:28352
    v_fmac_f32 v251, s27, v250
    v_mfma_f32_16x16x32_bf16 v[156:159], a[228:231], v[236:239], v[156:159]
    buffer_store_dwordx4 a[20:23], v254, s[12:15], s44 offen sc1
    v_fma_f32 v250, v249, s28, v252
    v_fmac_f32 v252, s29, v249
    v_mfma_f32_16x16x32_bf16 v[160:163], a[232:235], v[236:239], v[160:163]
    v_fma_f32 v249, v197, s24, v201
    v_fmac_f32 v201, s25, v197
    v_mfma_f32_16x16x32_bf16 v[164:167], a[236:239], v[236:239], v[164:167]
    v_fma_f32 v197, v195, s24, v199
    v_fmac_f32 v199, s25, v195
    v_mfma_f32_16x16x32_bf16 v[144:147], a[240:243], v[236:239], v[144:147]
    v_fma_f32 v195, v199, s26, v201
    v_fmac_f32 v201, s27, v199
    v_mfma_f32_16x16x32_bf16 v[148:151], a[244:247], v[236:239], v[148:151]
    v_fma_f32 v199, v197, s28, v249
    v_fmac_f32 v249, s29, v197
    v_mfma_f32_16x16x32_bf16 v[152:155], a[248:251], v[236:239], v[152:155]
    v_cvt_pk_bf16_f32 v195, v248, v195
    v_cvt_pk_bf16_f32 v201, v251, v201
    v_mfma_f32_16x16x32_bf16 v[132:135], a[252:255], v[236:239], v[132:135]
    v_cvt_pk_bf16_f32 v199, v250, v199
    v_cvt_pk_bf16_f32 v197, v252, v249
    v_mfma_f32_16x16x32_bf16 v[136:139], v[240:243], v[236:239], v[136:139]
    s_waitcnt lgkmcnt(2)
    v_lshrrev_b32 v252, 15, v255
    v_mfma_f32_16x16x32_bf16 v[140:143], v[244:247], v[236:239], v[140:143]
    ds_read_b128 v[236:239], v253 offset:28096
    s_add_u32 s44, s40, 6144
    v_mfma_f32_16x16x32_bf16 v[168:171], a[228:231], v[228:231], v[168:171]
    ds_write_b64 v252, v[194:195] offset:256
    v_mfma_f32_16x16x32_bf16 v[172:175], a[232:235], v[228:231], v[172:175]
    s_waitcnt vmcnt(15)
    v_lshlrev_b32 v248, 16, v206
    v_lshlrev_b32 v249, 16, v208
    v_mfma_f32_16x16x32_bf16 v[176:179], a[236:239], v[228:231], v[176:179]
    ds_write_b64 v252, v[200:201] offset:2336
    v_mfma_f32_16x16x32_bf16 v[156:159], a[240:243], v[228:231], v[156:159]
    v_lshlrev_b32 v250, 16, v210
    v_lshlrev_b32 v251, 16, v212
    v_mfma_f32_16x16x32_bf16 v[160:163], a[244:247], v[228:231], v[160:163]
    ds_write_b64 v252, v[198:199] offset:4416
    v_mfma_f32_16x16x32_bf16 v[164:167], a[248:251], v[228:231], v[164:167]
    s_waitcnt lgkmcnt(4)
    v_and_b32 v206, s22, v206
    v_and_b32 v208, s22, v208
    v_mfma_f32_16x16x32_bf16 v[144:147], a[252:255], v[228:231], v[144:147]
    ds_read_b128 a[40:43], v6 offset:22816
    v_mfma_f32_16x16x32_bf16 v[148:151], v[240:243], v[228:231], v[148:151]
    ds_write_b64 v252, v[192:193] offset:33536
    v_mfma_f32_16x16x32_bf16 v[152:155], v[244:247], v[228:231], v[152:155]
    ds_read_b128 v[228:231], v253 offset:27824
    v_and_b32 v210, s22, v210
    v_and_b32 v212, s22, v212
    v_mfma_f32_16x16x32_bf16 v[180:183], a[228:231], v[232:235], v[180:183]
    ds_write_b64 v252, v[202:203] offset:35616
    v_mfma_f32_16x16x32_bf16 v[184:187], a[232:235], v[232:235], v[184:187]
    v_mfma_f32_16x16x32_bf16 v[188:191], a[236:239], v[232:235], v[188:191]
    s_mov_b32 s42, 1290240
    v_mfma_f32_16x16x32_bf16 v[168:171], a[240:243], v[232:235], v[168:171]
    buffer_load_dwordx4 a[228:231], v254, s[8:11], s42 offen offset:0
    v_mfma_f32_16x16x32_bf16 v[172:175], a[244:247], v[232:235], v[172:175]
    ds_write_b64 v252, v[196:197] offset:6496
    v_mfma_f32_16x16x32_bf16 v[176:179], a[248:251], v[232:235], v[176:179]
    v_mfma_f32_16x16x32_bf16 v[156:159], a[252:255], v[232:235], v[156:159]
    buffer_load_dwordx4 a[232:235], v254, s[8:11], s42 offen offset:1024
    v_mfma_f32_16x16x32_bf16 v[160:163], v[240:243], v[232:235], v[160:163]
    v_lshlrev_b32 v252, 16, v204
    v_and_b32 v204, s22, v204
    v_mfma_f32_16x16x32_bf16 v[164:167], v[244:247], v[232:235], v[164:167]
    s_waitcnt lgkmcnt(8)
    v_add_f32 v252, v252, v251
    v_add_f32 v204, v204, v212
    v_mfma_f32_16x16x32_bf16 v[180:183], a[240:243], v[236:239], v[180:183]
    ds_read_b128 v[232:235], v253 offset:30160
    v_fmac_f32 v252, s23, v249
    v_fmac_f32 v204, s23, v208
    v_mfma_f32_16x16x32_bf16 v[184:187], a[244:247], v[236:239], v[184:187]
    v_cvt_pk_bf16_f32 v204, v252, v204
    v_lshlrev_b32 v252, 16, v214
    v_mfma_f32_16x16x32_bf16 v[188:191], a[248:251], v[236:239], v[188:191]
    buffer_load_dwordx4 a[236:239], v254, s[8:11], s42 offen offset:2048
    v_mfma_f32_16x16x32_bf16 v[168:171], a[252:255], v[236:239], v[168:171]
    s_waitcnt lgkmcnt(3)
    v_and_b32 v214, s22, v214
    v_add_f32 v252, v252, v248
    v_mfma_f32_16x16x32_bf16 v[172:175], v[240:243], v[236:239], v[172:175]
    s_mov_b32 s42, 1293312
    v_add_f32 v214, v214, v206
    v_fmac_f32 v252, s23, v250
    v_mfma_f32_16x16x32_bf16 v[176:179], v[244:247], v[236:239], v[176:179]
    ds_read_b128 v[236:239], v253 offset:29888
    v_fmac_f32 v214, s23, v210
    v_mfma_f32_16x16x32_bf16 v[180:183], a[252:255], v[228:231], v[180:183]
    buffer_load_dwordx4 a[240:243], v254, s[8:11], s42 offen offset:0
    v_mfma_f32_16x16x32_bf16 v[184:187], v[240:243], v[228:231], v[184:187]
    s_waitcnt vmcnt(13) lgkmcnt(1)
    v_cvt_pk_bf16_f32 v214, v252, v214
    v_fma_f32 v252, v249, s24, v251
    v_fmac_f32 v251, s25, v249
    v_mfma_f32_16x16x32_bf16 v[188:191], v[244:247], v[228:231], v[188:191]
    ds_read_b128 v[228:231], v253 offset:29632
    v_fma_f32 v249, v248, s24, v250
    v_mfma_f32_16x16x32_bf16 v[96:99], a[192:195], v[232:235], v[96:99]
    ds_read_b128 a[44:47], v6 offset:23840
    v_fmac_f32 v250, s25, v248
    v_mfma_f32_16x16x32_bf16 v[100:103], a[196:199], v[232:235], v[100:103]
    buffer_load_dwordx4 a[244:247], v254, s[8:11], s42 offen offset:1024
    v_mfma_f32_16x16x32_bf16 v[104:107], a[200:203], v[232:235], v[104:107]
    ds_read_b128 v[232:235], v253 offset:29376
    v_fma_f32 v248, v250, s26, v251
    s_waitcnt lgkmcnt(3)
    v_mfma_f32_16x16x32_bf16 v[108:111], a[192:195], v[236:239], v[108:111]
    v_fmac_f32 v251, s27, v250
    v_fma_f32 v250, v249, s28, v252
    v_mfma_f32_16x16x32_bf16 v[112:115], a[196:199], v[236:239], v[112:115]
    s_waitcnt vmcnt(11)
    v_fmac_f32 v252, s29, v249
    v_fma_f32 v249, v208, s24, v212
    v_mfma_f32_16x16x32_bf16 v[116:119], a[200:203], v[236:239], v[116:119]
    buffer_load_dwordx4 a[248:251], v254, s[8:11], s42 offen offset:2048
    v_fmac_f32 v212, s25, v208
    v_mfma_f32_16x16x32_bf16 v[96:99], a[204:207], v[236:239], v[96:99]
    s_waitcnt lgkmcnt(2)
    v_fma_f32 v208, v206, s24, v210
    v_fmac_f32 v210, s25, v206
    v_mfma_f32_16x16x32_bf16 v[100:103], a[208:211], v[236:239], v[100:103]
    s_mov_b32 s42, 1296384
    v_fma_f32 v206, v210, s26, v212
    v_fmac_f32 v212, s27, v210
    v_mfma_f32_16x16x32_bf16 v[104:107], a[212:215], v[236:239], v[104:107]
    ds_read_b128 v[236:239], v253 offset:29120
    v_fma_f32 v210, v208, s28, v249
    v_mfma_f32_16x16x32_bf16 v[120:123], a[192:195], v[228:231], v[120:123]
    buffer_load_dwordx4 a[252:255], v254, s[8:11], s42 offen offset:0
    v_mfma_f32_16x16x32_bf16 v[124:127], a[196:199], v[228:231], v[124:127]
    v_fmac_f32 v249, s29, v208
    v_cvt_pk_bf16_f32 v206, v248, v206
    v_mfma_f32_16x16x32_bf16 v[128:131], a[200:203], v[228:231], v[128:131]
    v_cvt_pk_bf16_f32 v212, v251, v212
    v_cvt_pk_bf16_f32 v210, v250, v210
    v_cvt_pk_bf16_f32 v208, v252, v249
    v_mfma_f32_16x16x32_bf16 v[108:111], a[204:207], v[228:231], v[108:111]
    v_lshlrev_b32 v248, 16, v207
    v_lshlrev_b32 v249, 16, v209
    v_mfma_f32_16x16x32_bf16 v[112:115], a[208:211], v[228:231], v[112:115]
    buffer_load_dwordx4 v[240:243], v254, s[8:11], s42 offen offset:1024
    v_mfma_f32_16x16x32_bf16 v[116:119], a[212:215], v[228:231], v[116:119]
    s_waitcnt vmcnt(11)
    v_lshlrev_b32 v250, 16, v211
    v_lshlrev_b32 v251, 16, v213
    v_mfma_f32_16x16x32_bf16 v[96:99], a[216:219], v[228:231], v[96:99]
    s_waitcnt lgkmcnt(1)
    v_and_b32 v207, s22, v207
    v_and_b32 v209, s22, v209
    v_mfma_f32_16x16x32_bf16 v[100:103], a[220:223], v[228:231], v[100:103]
    buffer_load_dwordx4 v[244:247], v254, s[8:11], s42 offen offset:2048
    v_mfma_f32_16x16x32_bf16 v[104:107], a[224:227], v[228:231], v[104:107]
    ds_read_b128 v[228:231], v253 offset:30944
    v_and_b32 v203, 0x7fff, v255
    v_mfma_f32_16x16x32_bf16 v[132:135], a[192:195], v[232:235], v[132:135]
    v_and_b32 v211, s22, v211
    v_and_b32 v213, s22, v213
    v_lshlrev_b32 v252, 16, v205
    v_mfma_f32_16x16x32_bf16 v[136:139], a[196:199], v[232:235], v[136:139]
    buffer_load_dwordx2 v[192:193], v203, s[4:7], s16 offen offset:64
    v_mfma_f32_16x16x32_bf16 v[140:143], a[200:203], v[232:235], v[140:143]
    v_and_b32 v205, s22, v205
    v_add_f32 v252, v252, v251
    v_mfma_f32_16x16x32_bf16 v[120:123], a[204:207], v[232:235], v[120:123]
    v_add_f32 v205, v205, v213
    v_fmac_f32 v252, s23, v249
    v_mfma_f32_16x16x32_bf16 v[124:127], a[208:211], v[232:235], v[124:127]
    buffer_load_dwordx2 v[194:195], v203, s[4:7], s17 offen offset:64
    v_mfma_f32_16x16x32_bf16 v[128:131], a[212:215], v[232:235], v[128:131]
    v_fmac_f32 v205, s23, v209
    v_cvt_pk_bf16_f32 v205, v252, v205
    v_mfma_f32_16x16x32_bf16 v[108:111], a[216:219], v[232:235], v[108:111]
    s_waitcnt lgkmcnt(1)
    v_lshlrev_b32 v252, 16, v215
    v_and_b32 v215, s22, v215
    v_mfma_f32_16x16x32_bf16 v[112:115], a[220:223], v[232:235], v[112:115]
    buffer_load_dwordx2 v[196:197], v203, s[4:7], s18 offen offset:64
    v_add_f32 v252, v252, v248
    v_mfma_f32_16x16x32_bf16 v[116:119], a[224:227], v[232:235], v[116:119]
    ds_read_b128 v[232:235], v253 offset:30688
    v_add_f32 v215, v215, v207
    v_mfma_f32_16x16x32_bf16 v[144:147], a[192:195], v[236:239], v[144:147]
    v_fmac_f32 v252, s23, v250
    v_fmac_f32 v215, s23, v211
    v_mfma_f32_16x16x32_bf16 v[148:151], a[196:199], v[236:239], v[148:151]
    buffer_load_dwordx2 v[198:199], v203, s[4:7], s19 offen offset:64
    v_mfma_f32_16x16x32_bf16 v[152:155], a[200:203], v[236:239], v[152:155]
    v_cvt_pk_bf16_f32 v215, v252, v215
    v_fma_f32 v252, v249, s24, v251
    v_mfma_f32_16x16x32_bf16 v[132:135], a[204:207], v[236:239], v[132:135]
    v_fmac_f32 v251, s25, v249
    v_fma_f32 v249, v248, s24, v250
    v_mfma_f32_16x16x32_bf16 v[136:139], a[208:211], v[236:239], v[136:139]
    buffer_load_dwordx2 v[200:201], v203, s[4:7], s20 offen offset:64
    v_fmac_f32 v250, s25, v248
    v_mfma_f32_16x16x32_bf16 v[140:143], a[212:215], v[236:239], v[140:143]
    v_fma_f32 v248, v250, s26, v251
    v_fmac_f32 v251, s27, v250
    v_mfma_f32_16x16x32_bf16 v[120:123], a[216:219], v[236:239], v[120:123]
    s_waitcnt lgkmcnt(1)
    v_fma_f32 v250, v249, s28, v252
    v_fmac_f32 v252, s29, v249
    v_mfma_f32_16x16x32_bf16 v[124:127], a[220:223], v[236:239], v[124:127]
    buffer_load_dwordx2 v[202:203], v203, s[4:7], s21 offen offset:64
    v_mfma_f32_16x16x32_bf16 v[128:131], a[224:227], v[236:239], v[128:131]
    ds_read_b128 v[236:239], v253 offset:30432
    v_fma_f32 v249, v209, s24, v213
    v_mfma_f32_16x16x32_bf16 v[156:159], a[192:195], v[228:231], v[156:159]
    v_fmac_f32 v213, s25, v209
    v_fma_f32 v209, v207, s24, v211
    v_mfma_f32_16x16x32_bf16 v[160:163], a[196:199], v[228:231], v[160:163]
    buffer_store_dwordx4 a[24:27], v254, s[12:15], s44 offen sc1
    s_add_u32 s44, s40, 7168
    v_mfma_f32_16x16x32_bf16 v[164:167], a[200:203], v[228:231], v[164:167]
    v_fmac_f32 v211, s25, v207
    v_fma_f32 v207, v211, s26, v213
    v_fmac_f32 v213, s27, v211
    v_mfma_f32_16x16x32_bf16 v[144:147], a[204:207], v[228:231], v[144:147]
    v_fma_f32 v211, v209, s28, v249
    v_fmac_f32 v249, s29, v209
    v_mfma_f32_16x16x32_bf16 v[148:151], a[208:211], v[228:231], v[148:151]
    buffer_store_dwordx4 a[28:31], v254, s[12:15], s44 offen sc1
    s_add_u32 s44, s40, 8192
    v_mfma_f32_16x16x32_bf16 v[152:155], a[212:215], v[228:231], v[152:155]
    v_cvt_pk_bf16_f32 v207, v248, v207
    v_cvt_pk_bf16_f32 v213, v251, v213
    v_mfma_f32_16x16x32_bf16 v[132:135], a[216:219], v[228:231], v[132:135]
    s_waitcnt lgkmcnt(1)
    v_cvt_pk_bf16_f32 v211, v250, v211
    v_cvt_pk_bf16_f32 v209, v252, v249
    v_mfma_f32_16x16x32_bf16 v[136:139], a[220:223], v[228:231], v[136:139]
    buffer_store_dwordx4 a[32:35], v254, s[12:15], s44 offen sc1
    s_add_u32 s44, s40, 9216
    v_lshrrev_b32 v252, 15, v255
    v_mfma_f32_16x16x32_bf16 v[140:143], a[224:227], v[228:231], v[140:143]
    ds_read_b128 v[228:231], v253 offset:30176
    v_mfma_f32_16x16x32_bf16 v[168:171], a[192:195], v[232:235], v[168:171]
    ds_write_b64 v252, v[206:207] offset:0
    v_mfma_f32_16x16x32_bf16 v[172:175], a[196:199], v[232:235], v[172:175]
    v_mfma_f32_16x16x32_bf16 v[176:179], a[200:203], v[232:235], v[176:179]
    ds_write_b64 v252, v[212:213] offset:2080
    v_mfma_f32_16x16x32_bf16 v[156:159], a[204:207], v[232:235], v[156:159]
    v_mfma_f32_16x16x32_bf16 v[160:163], a[208:211], v[232:235], v[160:163]
    ds_write_b64 v252, v[210:211] offset:4160
    v_mfma_f32_16x16x32_bf16 v[164:167], a[212:215], v[232:235], v[164:167]
    v_mfma_f32_16x16x32_bf16 v[144:147], a[216:219], v[232:235], v[144:147]
    ds_write_b64 v252, v[204:205] offset:33280
    v_mfma_f32_16x16x32_bf16 v[148:151], a[220:223], v[232:235], v[148:151]
    s_waitcnt lgkmcnt(5)
    v_mfma_f32_16x16x32_bf16 v[152:155], a[224:227], v[232:235], v[152:155]
    ds_read_b128 v[232:235], v253 offset:29904
    v_mfma_f32_16x16x32_bf16 v[180:183], a[192:195], v[236:239], v[180:183]
    ds_write_b64 v252, v[214:215] offset:35360
    v_mfma_f32_16x16x32_bf16 v[184:187], a[196:199], v[236:239], v[184:187]
    v_mfma_f32_16x16x32_bf16 v[188:191], a[200:203], v[236:239], v[188:191]
    s_mov_b32 s42, 0
    v_mfma_f32_16x16x32_bf16 v[168:171], a[204:207], v[236:239], v[168:171]
    buffer_load_dwordx4 a[192:195], v254, s[8:11], s42 offen offset:0
    v_mfma_f32_16x16x32_bf16 v[172:175], a[208:211], v[236:239], v[172:175]
    ds_write_b64 v252, v[208:209] offset:6240
    v_mfma_f32_16x16x32_bf16 v[176:179], a[212:215], v[236:239], v[176:179]
    s_waitcnt lgkmcnt(7)
    v_mfma_f32_16x16x32_bf16 v[156:159], a[216:219], v[236:239], v[156:159]
    buffer_load_dwordx4 a[196:199], v254, s[8:11], s42 offen offset:1024
    v_mfma_f32_16x16x32_bf16 v[160:163], a[220:223], v[236:239], v[160:163]
    s_waitcnt lgkmcnt(0)
    v_mfma_f32_16x16x32_bf16 v[164:167], a[224:227], v[236:239], v[164:167]
    s_barrier
    v_mfma_f32_16x16x32_bf16 v[180:183], a[204:207], v[228:231], v[180:183]
    ds_read_b128 v[236:239], v253 offset:32240
    v_mfma_f32_16x16x32_bf16 v[184:187], a[208:211], v[228:231], v[184:187]
    v_mfma_f32_16x16x32_bf16 v[188:191], a[212:215], v[228:231], v[188:191]
    buffer_load_dwordx4 a[200:203], v254, s[8:11], s42 offen offset:2048
    v_mfma_f32_16x16x32_bf16 v[168:171], a[216:219], v[228:231], v[168:171]
    v_mfma_f32_16x16x32_bf16 v[172:175], a[220:223], v[228:231], v[172:175]
    s_mov_b32 s42, 3072
    v_mfma_f32_16x16x32_bf16 v[176:179], a[224:227], v[228:231], v[176:179]
    ds_read_b128 v[228:231], v253 offset:31968
    v_mfma_f32_16x16x32_bf16 v[180:183], a[216:219], v[232:235], v[180:183]
    buffer_load_dwordx4 a[204:207], v254, s[8:11], s42 offen offset:0
    v_mfma_f32_16x16x32_bf16 v[184:187], a[220:223], v[232:235], v[184:187]
    s_waitcnt vmcnt(19) lgkmcnt(1)
    v_mfma_f32_16x16x32_bf16 v[188:191], a[224:227], v[232:235], v[188:191]
    ds_read_b128 v[232:235], v253 offset:31712
    v_mfma_f32_16x16x32_bf16 v[96:99], a[228:231], v[236:239], v[96:99]
    s_waitcnt lgkmcnt(1)
    v_mfma_f32_16x16x32_bf16 v[100:103], a[232:235], v[236:239], v[100:103]
    buffer_load_dwordx4 a[208:211], v254, s[8:11], s42 offen offset:1024
    v_mfma_f32_16x16x32_bf16 v[104:107], a[236:239], v[236:239], v[104:107]
    ds_read_b128 v[236:239], v253 offset:31456
    v_mfma_f32_16x16x32_bf16 v[108:111], a[228:231], v[228:231], v[108:111]
    v_mfma_f32_16x16x32_bf16 v[112:115], a[232:235], v[228:231], v[112:115]
    s_waitcnt vmcnt(17)
    v_mfma_f32_16x16x32_bf16 v[116:119], a[236:239], v[228:231], v[116:119]
    buffer_load_dwordx4 a[212:215], v254, s[8:11], s42 offen offset:2048
    v_mfma_f32_16x16x32_bf16 v[96:99], a[240:243], v[228:231], v[96:99]
    s_waitcnt lgkmcnt(1)
    v_mfma_f32_16x16x32_bf16 v[100:103], a[244:247], v[228:231], v[100:103]
    s_mov_b32 s42, 6144
    v_mfma_f32_16x16x32_bf16 v[104:107], a[248:251], v[228:231], v[104:107]
    ds_read_b128 v[228:231], v253 offset:31200
    v_mfma_f32_16x16x32_bf16 v[120:123], a[228:231], v[232:235], v[120:123]
    buffer_load_dwordx4 a[216:219], v254, s[8:11], s42 offen offset:0
    v_mfma_f32_16x16x32_bf16 v[124:127], a[232:235], v[232:235], v[124:127]
    v_mfma_f32_16x16x32_bf16 v[128:131], a[236:239], v[232:235], v[128:131]
    v_mfma_f32_16x16x32_bf16 v[108:111], a[240:243], v[232:235], v[108:111]
    v_mfma_f32_16x16x32_bf16 v[112:115], a[244:247], v[232:235], v[112:115]
    buffer_load_dwordx4 a[220:223], v254, s[8:11], s42 offen offset:1024
    v_mfma_f32_16x16x32_bf16 v[116:119], a[248:251], v[232:235], v[116:119]
    s_waitcnt vmcnt(17)
    v_mfma_f32_16x16x32_bf16 v[96:99], a[252:255], v[232:235], v[96:99]
    s_waitcnt lgkmcnt(1)
    v_mfma_f32_16x16x32_bf16 v[100:103], v[240:243], v[232:235], v[100:103]
    buffer_load_dwordx4 a[224:227], v254, s[8:11], s42 offen offset:2048
    v_mfma_f32_16x16x32_bf16 v[104:107], v[244:247], v[232:235], v[104:107]
    ds_read_b128 v[232:235], v253 offset:33024
    v_and_b32 v215, 0x7fff, v255
    v_mfma_f32_16x16x32_bf16 v[132:135], a[228:231], v[236:239], v[132:135]
    v_mfma_f32_16x16x32_bf16 v[136:139], a[232:235], v[236:239], v[136:139]
    buffer_load_dwordx2 v[204:205], v215, s[4:7], s16 offen offset:448
    v_mfma_f32_16x16x32_bf16 v[140:143], a[236:239], v[236:239], v[140:143]
    v_mfma_f32_16x16x32_bf16 v[120:123], a[240:243], v[236:239], v[120:123]
    v_mfma_f32_16x16x32_bf16 v[124:127], a[244:247], v[236:239], v[124:127]
    buffer_load_dwordx2 v[206:207], v215, s[4:7], s17 offen offset:448
    v_mfma_f32_16x16x32_bf16 v[128:131], a[248:251], v[236:239], v[128:131]
    s_waitcnt lgkmcnt(1)
    v_cvt_pk_bf16_f32 v104, v104, v105
    v_cvt_pk_bf16_f32 v105, v106, v107
    v_mfma_f32_16x16x32_bf16 v[108:111], a[252:255], v[236:239], v[108:111]
    ds_write_b64 v5, v[104:105] offset:16704
    v_mfma_f32_16x16x32_bf16 v[112:115], v[240:243], v[236:239], v[112:115]
    buffer_load_dwordx2 v[208:209], v215, s[4:7], s18 offen offset:448
    v_mfma_f32_16x16x32_bf16 v[116:119], v[244:247], v[236:239], v[116:119]
    ds_read_b128 v[236:239], v253 offset:32768
    v_cvt_pk_bf16_f32 v96, v96, v97
    v_mfma_f32_16x16x32_bf16 v[144:147], a[228:231], v[228:231], v[144:147]
    v_cvt_pk_bf16_f32 v97, v98, v99
    v_cvt_pk_bf16_f32 v98, v100, v101
    v_mfma_f32_16x16x32_bf16 v[148:151], a[232:235], v[228:231], v[148:151]
    buffer_load_dwordx2 v[210:211], v215, s[4:7], s19 offen offset:448
    v_mfma_f32_16x16x32_bf16 v[152:155], a[236:239], v[228:231], v[152:155]
    v_cvt_pk_bf16_f32 v99, v102, v103
    v_mfma_f32_16x16x32_bf16 v[132:135], a[240:243], v[228:231], v[132:135]
    ds_write_b128 v4, v[96:99] offset:16640
    v_mfma_f32_16x16x32_bf16 v[136:139], a[244:247], v[228:231], v[136:139]
    buffer_load_dwordx2 v[212:213], v215, s[4:7], s20 offen offset:448
    v_mfma_f32_16x16x32_bf16 v[140:143], a[248:251], v[228:231], v[140:143]
    v_cvt_pk_bf16_f32 v116, v116, v117
    v_cvt_pk_bf16_f32 v117, v118, v119
    v_mfma_f32_16x16x32_bf16 v[120:123], a[252:255], v[228:231], v[120:123]
    s_waitcnt lgkmcnt(3)
    v_mfma_f32_16x16x32_bf16 v[124:127], v[240:243], v[228:231], v[124:127]
    buffer_load_dwordx2 v[214:215], v215, s[4:7], s21 offen offset:448
    v_mfma_f32_16x16x32_bf16 v[128:131], v[244:247], v[228:231], v[128:131]
    ds_read_b128 v[228:231], v253 offset:32512
    v_mfma_f32_16x16x32_bf16 v[156:159], a[228:231], v[232:235], v[156:159]
    ds_write_b64 v5, v[116:117] offset:17088
    v_mfma_f32_16x16x32_bf16 v[160:163], a[232:235], v[232:235], v[160:163]
    buffer_store_dwordx4 a[36:39], v254, s[12:15], s44 offen sc1
    s_add_u32 s44, s40, 10240
    v_mfma_f32_16x16x32_bf16 v[164:167], a[236:239], v[232:235], v[164:167]
    v_cvt_pk_bf16_f32 v108, v108, v109
    v_cvt_pk_bf16_f32 v109, v110, v111
    v_mfma_f32_16x16x32_bf16 v[144:147], a[240:243], v[232:235], v[144:147]
    v_cvt_pk_bf16_f32 v110, v112, v113
    v_cvt_pk_bf16_f32 v111, v114, v115
    v_mfma_f32_16x16x32_bf16 v[148:151], a[244:247], v[232:235], v[148:151]
    buffer_store_dwordx4 a[40:43], v254, s[12:15], s44 offen sc1
    s_add_u32 s44, s40, 11264
    v_mfma_f32_16x16x32_bf16 v[152:155], a[248:251], v[232:235], v[152:155]
    ds_write_b128 v4, v[108:111] offset:17024
    v_mfma_f32_16x16x32_bf16 v[132:135], a[252:255], v[232:235], v[132:135]
    s_waitcnt lgkmcnt(4)
    v_cvt_pk_bf16_f32 v128, v128, v129
    v_cvt_pk_bf16_f32 v129, v130, v131
    v_mfma_f32_16x16x32_bf16 v[136:139], v[240:243], v[232:235], v[136:139]
    buffer_store_dwordx4 a[44:47], v254, s[12:15], s44 offen sc1
    v_mfma_f32_16x16x32_bf16 v[140:143], v[244:247], v[232:235], v[140:143]
    ds_read_b128 v[232:235], v253 offset:32256
    v_mfma_f32_16x16x32_bf16 v[168:171], a[228:231], v[236:239], v[168:171]
    ds_write_b64 v5, v[128:129] offset:17472
    v_mfma_f32_16x16x32_bf16 v[172:175], a[232:235], v[236:239], v[172:175]
    v_cvt_pk_bf16_f32 v120, v120, v121
    v_cvt_pk_bf16_f32 v121, v122, v123
    v_mfma_f32_16x16x32_bf16 v[176:179], a[236:239], v[236:239], v[176:179]
    v_cvt_pk_bf16_f32 v122, v124, v125
    v_cvt_pk_bf16_f32 v123, v126, v127
    v_mfma_f32_16x16x32_bf16 v[156:159], a[240:243], v[236:239], v[156:159]
    ds_write_b128 v4, v[120:123] offset:17408
    v_mfma_f32_16x16x32_bf16 v[160:163], a[244:247], v[236:239], v[160:163]
    v_mfma_f32_16x16x32_bf16 v[164:167], a[248:251], v[236:239], v[164:167]
    v_cvt_pk_bf16_f32 v140, v140, v141
    v_cvt_pk_bf16_f32 v141, v142, v143
    v_mfma_f32_16x16x32_bf16 v[144:147], a[252:255], v[236:239], v[144:147]
    s_waitcnt lgkmcnt(5)
    v_mfma_f32_16x16x32_bf16 v[148:151], v[240:243], v[236:239], v[148:151]
    ds_write_b64 v5, v[140:141] offset:17856
    v_mfma_f32_16x16x32_bf16 v[152:155], v[244:247], v[236:239], v[152:155]
    ds_read_b128 v[236:239], v253 offset:31984
    v_cvt_pk_bf16_f32 v132, v132, v133
    v_mfma_f32_16x16x32_bf16 v[180:183], a[228:231], v[228:231], v[180:183]
    v_cvt_pk_bf16_f32 v133, v134, v135
    v_cvt_pk_bf16_f32 v134, v136, v137
    v_mfma_f32_16x16x32_bf16 v[184:187], a[232:235], v[228:231], v[184:187]
    v_cvt_pk_bf16_f32 v135, v138, v139
    v_mfma_f32_16x16x32_bf16 v[188:191], a[236:239], v[228:231], v[188:191]
    s_mov_b32 s42, 36864
    v_mfma_f32_16x16x32_bf16 v[168:171], a[240:243], v[228:231], v[168:171]
    buffer_load_dwordx4 a[228:231], v254, s[8:11], s42 offen offset:0
    v_mfma_f32_16x16x32_bf16 v[172:175], a[244:247], v[228:231], v[172:175]
    ds_write_b128 v4, v[132:135] offset:17792
    v_mfma_f32_16x16x32_bf16 v[176:179], a[248:251], v[228:231], v[176:179]
    v_cvt_pk_bf16_f32 v152, v152, v153
    v_cvt_pk_bf16_f32 v153, v154, v155
    v_mfma_f32_16x16x32_bf16 v[156:159], a[252:255], v[228:231], v[156:159]
    buffer_load_dwordx4 a[232:235], v254, s[8:11], s42 offen offset:1024
    v_mfma_f32_16x16x32_bf16 v[160:163], v[240:243], v[228:231], v[160:163]
    s_waitcnt lgkmcnt(5)
    v_mfma_f32_16x16x32_bf16 v[164:167], v[244:247], v[228:231], v[164:167]
    ds_write_b64 v5, v[152:153] offset:18240
    v_mfma_f32_16x16x32_bf16 v[180:183], a[240:243], v[232:235], v[180:183]
    ds_read_b128 v[228:231], v253 offset:1040
    v_cvt_pk_bf16_f32 v144, v144, v145
    v_mfma_f32_16x16x32_bf16 v[184:187], a[244:247], v[232:235], v[184:187]
    v_cvt_pk_bf16_f32 v145, v146, v147
    v_cvt_pk_bf16_f32 v146, v148, v149
    v_mfma_f32_16x16x32_bf16 v[188:191], a[248:251], v[232:235], v[188:191]
    buffer_load_dwordx4 a[236:239], v254, s[8:11], s42 offen offset:2048
    v_mfma_f32_16x16x32_bf16 v[168:171], a[252:255], v[232:235], v[168:171]
    s_waitcnt lgkmcnt(3)
    v_cvt_pk_bf16_f32 v147, v150, v151
    v_mfma_f32_16x16x32_bf16 v[172:175], v[240:243], v[232:235], v[172:175]
    s_mov_b32 s42, 39936
    v_mfma_f32_16x16x32_bf16 v[176:179], v[244:247], v[232:235], v[176:179]
    ds_read_b128 v[232:235], v253 offset:768
    v_mfma_f32_16x16x32_bf16 v[180:183], a[252:255], v[236:239], v[180:183]
    buffer_load_dwordx4 a[240:243], v254, s[8:11], s42 offen offset:0
    v_mfma_f32_16x16x32_bf16 v[184:187], v[240:243], v[236:239], v[184:187]
    ds_write_b128 v4, v[144:147] offset:18176
    v_mfma_f32_16x16x32_bf16 v[188:191], v[244:247], v[236:239], v[188:191]
    ds_read_b128 v[236:239], v253 offset:512
    s_waitcnt vmcnt(19)
    s_waitcnt lgkmcnt(3)
    s_add_u32 s41, s40, 589824
    s_add_u32 s40, s40, 6291456
    s_mov_b32 s33, 2130706432
    s_mov_b32 s32, 2130706432
    s_add_u32 s39, s39, 1
    s_cmp_lt_u32 s39, 2
    s_cbranch_scc1 blk_loop
    v_cvt_pk_bf16_f32 v164, v164, v165
    v_cvt_pk_bf16_f32 v165, v166, v167
    ds_write_b64 v5, v[164:165] offset:18624
    v_cvt_pk_bf16_f32 v156, v156, v157
    v_cvt_pk_bf16_f32 v157, v158, v159
    v_cvt_pk_bf16_f32 v158, v160, v161
    v_cvt_pk_bf16_f32 v159, v162, v163
    ds_write_b128 v4, v[156:159] offset:18560
    v_cvt_pk_bf16_f32 v176, v176, v177
    v_cvt_pk_bf16_f32 v177, v178, v179
    ds_write_b64 v5, v[176:177] offset:19008
    v_cvt_pk_bf16_f32 v168, v168, v169
    v_cvt_pk_bf16_f32 v169, v170, v171
    v_cvt_pk_bf16_f32 v170, v172, v173
    v_cvt_pk_bf16_f32 v171, v174, v175
    ds_write_b128 v4, v[168:171] offset:18944
    v_cvt_pk_bf16_f32 v188, v188, v189
    v_cvt_pk_bf16_f32 v189, v190, v191
    ds_write_b64 v5, v[188:189] offset:19392
    v_cvt_pk_bf16_f32 v180, v180, v181
    v_cvt_pk_bf16_f32 v181, v182, v183
    v_cvt_pk_bf16_f32 v182, v184, v185
    v_cvt_pk_bf16_f32 v183, v186, v187
    ds_write_b128 v4, v[180:183] offset:19328
    s_waitcnt lgkmcnt(0)
    s_barrier
    ds_read_b128 v[144:147], v6 offset:16640
    ds_read_b128 v[148:151], v6 offset:17664
    ds_read_b128 v[152:155], v6 offset:18688
    ds_read_b128 v[156:159], v6 offset:19744
    ds_read_b128 v[160:163], v6 offset:20768
    ds_read_b128 v[164:167], v6 offset:21792
    ds_read_b128 v[168:171], v6 offset:22848
    ds_read_b128 v[172:175], v6 offset:23872
    ds_read_b128 v[176:179], v6 offset:24896
    ds_read_b128 v[180:183], v6 offset:25952
    ds_read_b128 v[184:187], v6 offset:26976
    ds_read_b128 v[188:191], v6 offset:28000
    s_add_u32 s44, s41, 0
    s_waitcnt lgkmcnt(11)
    buffer_store_dwordx4 v[144:147], v254, s[12:15], s44 offen sc1
    s_add_u32 s44, s41, 1024
    s_waitcnt lgkmcnt(10)
    buffer_store_dwordx4 v[148:151], v254, s[12:15], s44 offen sc1
    s_add_u32 s44, s41, 2048
    s_waitcnt lgkmcnt(9)
    buffer_store_dwordx4 v[152:155], v254, s[12:15], s44 offen sc1
    s_add_u32 s44, s41, 3072
    s_waitcnt lgkmcnt(8)
    buffer_store_dwordx4 v[156:159], v254, s[12:15], s44 offen sc1
    s_add_u32 s44, s41, 4096
    s_waitcnt lgkmcnt(7)
    buffer_store_dwordx4 v[160:163], v254, s[12:15], s44 offen sc1
    s_add_u32 s44, s41, 5120
    s_waitcnt lgkmcnt(6)
    buffer_store_dwordx4 v[164:167], v254, s[12:15], s44 offen sc1
    s_add_u32 s44, s41, 6144
    s_waitcnt lgkmcnt(5)
    buffer_store_dwordx4 v[168:171], v254, s[12:15], s44 offen sc1
    s_add_u32 s44, s41, 7168
    s_waitcnt lgkmcnt(4)
    buffer_store_dwordx4 v[172:175], v254, s[12:15], s44 offen sc1
    s_add_u32 s44, s41, 8192
    s_waitcnt lgkmcnt(3)
    buffer_store_dwordx4 v[176:179], v254, s[12:15], s44 offen sc1
    s_add_u32 s44, s41, 9216
    s_waitcnt lgkmcnt(2)
    buffer_store_dwordx4 v[180:183], v254, s[12:15], s44 offen sc1
    s_add_u32 s44, s41, 10240
    s_waitcnt lgkmcnt(1)
    buffer_store_dwordx4 v[184:187], v254, s[12:15], s44 offen sc1
    s_add_u32 s44, s41, 11264
    s_waitcnt lgkmcnt(0)
    buffer_store_dwordx4 v[188:191], v254, s[12:15], s44 offen sc1
main_done:
    s_endpgm
code_end:
.section .rodata,"a"
.p2align 6
.amdhsa_kernel wt_kernel
  .amdhsa_next_free_vgpr 72
  .amdhsa_next_free_sgpr 40
  .amdhsa_accum_offset 72
  .amdhsa_group_segment_fixed_size 0
  .amdhsa_kernarg_size 40
  .amdhsa_user_sgpr_count 2
  .amdhsa_user_sgpr_kernarg_segment_ptr 1
  .amdhsa_system_sgpr_workgroup_id_x 1
  .amdhsa_float_denorm_mode_32 3
.end_amdhsa_kernel
.p2align 6
.amdhsa_kernel wino_kernel
  .amdhsa_next_free_vgpr 512
  .amdhsa_next_free_sgpr 102
  .amdhsa_accum_offset 256
  .amdhsa_group_segment_fixed_size 0
  .amdhsa_kernarg_size 40
  .amdhsa_user_sgpr_count 2
  .amdhsa_user_sgpr_kernarg_segment_ptr 1
  .amdhsa_system_sgpr_workgroup_id_x 1
  .amdhsa_float_denorm_mode_32 3
.end_amdhsa_kernel
```

```asm
; @launch grid=(256,1,1) block=(256,1,1) lds=163840
.amdgcn_target "amdgcn-amd-amdhsa--gfx950"
.text
.globl standalone__winograd__vision_kernel
.p2align 8
.type standalone__winograd__vision_kernel,@function
standalone__winograd__vision_kernel:
    s_cmp_ge_u32 s2, 256
    s_cbranch_scc1 main_done
    s_load_dwordx4 s[4:7], s[0:1], 0
    s_load_dwordx4 s[12:15], s[0:1], 16
    s_load_dwordx2 s[8:9], s[0:1], 32
    s_getpc_b64 s[92:93]
pcref:
    v_and_b32 v70, 3, v0
    v_lshrrev_b32 v71, 6, v0
    v_lshl_add_u32 v70, v70, 7, v71
    s_lshr_b32 s94, s2, 3
    s_lshl_b32 s94, s94, 2
    v_add_lshl_u32 v70, v70, s94, 7
    v_min_u32 v70, code_end-pcref-4, v70
    v_add_co_u32 v72, vcc, s92, v70
    v_mov_b32 v73, s93
    s_nop 0
    v_addc_co_u32 v73, vcc, 0, v73, vcc
    global_load_dword v76, v[72:73], off
    v_lshrrev_b32 v1, 6, v0
    v_and_b32 v2, 63, v0
    v_readfirstlane_b32 s38, v1
    v_lshlrev_b32 v254, 4, v2
    v_mov_b32 v98, 0
    v_lshrrev_b32 v3, 3, v2
    v_and_b32 v4, 7, v2
    v_mul_u32_u24 v5, 3072, v3
    v_lshl_add_u32 v255, v4, 3, v5
    s_lshr_b32 s44, s2, 3
    s_and_b32 s48, s44, 3
    s_lshr_b32 s44, s44, 2
    s_and_b32 s49, s2, 7
    s_lshl_b32 s49, s49, 4
    s_add_u32 s49, s49, s44
    s_and_b32 s90, s38, 1
    s_lshr_b32 s91, s38, 1
    s_and_b32 s89, s48, 1
    s_mul_i32 s50, s90, 24576
    s_mul_i32 s45, s91, 1536
    s_add_u32 s50, s50, s45
    s_lshl_b32 s45, s89, 6
    s_add_u32 s50, s50, s45
    s_mul_i32 s101, s38, 196608
    s_sub_u32 s101, s101, s50
    s_mul_i32 s53, s48, 49152
    s_add_u32 s53, s53, s50
    s_mul_i32 s43, s49, 786432
    s_add_u32 s43, s43, s53
    s_cmp_ge_u32 s49, 128
    s_cselect_b32 s43, 2130706432, s43
    s_sub_u32 s16, s43, 196608
    s_cmp_eq_u32 s49, 0
    s_cselect_b32 s16, 2130706432, s16
    s_mov_b32 s17, s43
    s_add_u32 s18, s43, 196608
    s_add_u32 s19, s43, 393216
    s_add_u32 s20, s43, 589824
    s_add_u32 s21, s43, 786432
    s_add_u32 s100, s43, s101
    s_mul_i32 s52, s38, 96
    s_mul_i32 s44, s38, 9216
    s_mov_b32 s70, s2
    v_mov_b32 v80, v255
    s_mul_i32 s73, s70, 43691
    s_lshr_b32 s73, s73, 17
    s_mul_i32 s74, s73, 3
    s_sub_u32 s74, s70, s74
    s_mul_i32 s75, s73, 43691
    s_lshr_b32 s75, s75, 17
    s_mul_i32 s76, s75, 3
    s_sub_u32 s76, s73, s76
    v_and_b32 v101, 15, v2
    v_lshrrev_b32 v102, 4, v2
    v_and_b32 v103, 12, v101
    s_lshl_b32 s78, s74, 2
    s_cmp_lt_u32 s74, 2
    s_cselect_b32 s77, 1, 0
    s_cselect_b32 s78, s78, 32
    v_mul_u32_u24 v103, s77, v103
    v_add_u32 v103, v103, v101
    v_add_u32 v103, s78, v103
    v_lshl_add_u32 v103, v103, 1, s52
    v_mul_u32_u24 v104, 3072, v102
    v_add_u32 v103, v103, v104
    s_mul_i32 s79, s76, 73728
    s_mul_i32 s80, s75, 12288
    s_add_u32 s79, s79, s80
    s_add_u32 s80, s79, 221184
    s_add_u32 s81, s79, 442368
    s_waitcnt lgkmcnt(0)
    s_mov_b32 s60, s6
    s_and_b32 s61, s7, 0xffff
    s_mov_b32 s62, 663552
    s_mov_b32 s63, 0x20000
    s_and_b32 s5, s5, 0xffff
    s_mov_b32 s6, 100663296
    s_mov_b32 s7, 0x20000
    s_add_u32 s8, s8, s44
    s_addc_u32 s9, s9, 0
    s_and_b32 s9, s9, 0xffff
    s_mov_b32 s10, 1299456
    s_mov_b32 s11, 0x20000
    s_mov_b32 s64, s14
    s_and_b32 s65, s15, 0xffff
    s_mov_b32 s66, 256
    s_mov_b32 s67, 0x20000
    s_mov_b64 s[68:69], s[14:15]
    s_cmp_lt_u32 s2, 54
    s_cbranch_scc1 wt_path
    buffer_load_dwordx2 v[8:9], v80, s[4:7], s16 offen offset:0
    buffer_load_dwordx2 v[10:11], v80, s[4:7], s17 offen offset:0
    buffer_load_dwordx2 v[12:13], v80, s[4:7], s18 offen offset:0
    buffer_load_dwordx2 v[14:15], v80, s[4:7], s19 offen offset:0
    buffer_load_dwordx2 v[16:17], v80, s[4:7], s20 offen offset:0
    buffer_load_dwordx2 v[18:19], v80, s[4:7], s21 offen offset:0
    buffer_load_dwordx2 v[20:21], v80, s[4:7], s16 offen offset:384
    buffer_load_dwordx2 v[22:23], v80, s[4:7], s17 offen offset:384
    buffer_load_dwordx2 v[24:25], v80, s[4:7], s18 offen offset:384
    buffer_load_dwordx2 v[26:27], v80, s[4:7], s19 offen offset:384
    buffer_load_dwordx2 v[28:29], v80, s[4:7], s20 offen offset:384
    buffer_load_dwordx2 v[30:31], v80, s[4:7], s21 offen offset:384
    s_branch wt_join
wt_path:
    buffer_load_ushort v110, v103, s[60:63], s79 offen offset:0
    buffer_load_ushort v111, v103, s[60:63], s79 offen offset:384
    buffer_load_ushort v112, v103, s[60:63], s79 offen offset:768
    buffer_load_ushort v113, v103, s[60:63], s79 offen offset:1152
    buffer_load_ushort v114, v103, s[60:63], s79 offen offset:1536
    buffer_load_ushort v115, v103, s[60:63], s79 offen offset:1920
    buffer_load_ushort v116, v103, s[60:63], s79 offen offset:2304
    buffer_load_ushort v117, v103, s[60:63], s79 offen offset:2688
    buffer_load_ushort v118, v103, s[60:63], s80 offen offset:0
    buffer_load_ushort v119, v103, s[60:63], s80 offen offset:384
    buffer_load_ushort v120, v103, s[60:63], s80 offen offset:768
    buffer_load_ushort v121, v103, s[60:63], s80 offen offset:1152
    buffer_load_ushort v122, v103, s[60:63], s80 offen offset:1536
    buffer_load_ushort v123, v103, s[60:63], s80 offen offset:1920
    buffer_load_ushort v124, v103, s[60:63], s80 offen offset:2304
    buffer_load_ushort v125, v103, s[60:63], s80 offen offset:2688
    buffer_load_ushort v126, v103, s[60:63], s81 offen offset:0
    buffer_load_ushort v127, v103, s[60:63], s81 offen offset:384
    buffer_load_ushort v128, v103, s[60:63], s81 offen offset:768
    buffer_load_ushort v129, v103, s[60:63], s81 offen offset:1152
    buffer_load_ushort v130, v103, s[60:63], s81 offen offset:1536
    buffer_load_ushort v131, v103, s[60:63], s81 offen offset:1920
    buffer_load_ushort v132, v103, s[60:63], s81 offen offset:2304
    buffer_load_ushort v133, v103, s[60:63], s81 offen offset:2688
    s_mul_i32 s82, s76, 3072
    s_lshl_b32 s83, s74, 10
    s_add_u32 s82, s82, s83
    s_mul_i32 s83, s75, 36864
    s_lshl_b32 s84, s83, 2
    s_add_u32 s83, s83, s82
    s_add_u32 s84, s84, s82
    s_waitcnt vmcnt(0)
    v_lshlrev_b32 v110, 16, v110
    v_lshlrev_b32 v111, 16, v111
    v_lshlrev_b32 v112, 16, v112
    v_lshlrev_b32 v113, 16, v113
    v_lshlrev_b32 v114, 16, v114
    v_lshlrev_b32 v115, 16, v115
    v_lshlrev_b32 v116, 16, v116
    v_lshlrev_b32 v117, 16, v117
    v_lshlrev_b32 v118, 16, v118
    v_lshlrev_b32 v119, 16, v119
    v_lshlrev_b32 v120, 16, v120
    v_lshlrev_b32 v121, 16, v121
    v_lshlrev_b32 v122, 16, v122
    v_lshlrev_b32 v123, 16, v123
    v_lshlrev_b32 v124, 16, v124
    v_lshlrev_b32 v125, 16, v125
    v_lshlrev_b32 v126, 16, v126
    v_lshlrev_b32 v127, 16, v127
    v_lshlrev_b32 v128, 16, v128
    v_lshlrev_b32 v129, 16, v129
    v_lshlrev_b32 v130, 16, v130
    v_lshlrev_b32 v131, 16, v131
    v_lshlrev_b32 v132, 16, v132
    v_lshlrev_b32 v133, 16, v133
    v_mul_f32 v136, 0xbf170c51, v110
    v_fmac_f32 v136, 0xbe6c033f, v126
    v_fmamk_f32 v144, v118, 0xbebccf65, v136
    v_fmac_f32 v136, 0x3ebccf65, v118
    v_mul_f32 v137, 0xbf170c51, v111
    v_fmac_f32 v137, 0xbe6c033f, v127
    v_fmamk_f32 v145, v119, 0xbebccf65, v137
    v_fmac_f32 v137, 0x3ebccf65, v119
    v_mul_f32 v138, 0xbf170c51, v112
    v_fmac_f32 v138, 0xbe6c033f, v128
    v_fmamk_f32 v146, v120, 0xbebccf65, v138
    v_fmac_f32 v138, 0x3ebccf65, v120
    v_mul_f32 v139, 0xbf170c51, v113
    v_fmac_f32 v139, 0xbe6c033f, v129
    v_fmamk_f32 v147, v121, 0xbebccf65, v139
    v_fmac_f32 v139, 0x3ebccf65, v121
    v_mul_f32 v140, 0xbf170c51, v114
    v_fmac_f32 v140, 0xbe6c033f, v130
    v_fmamk_f32 v148, v122, 0xbebccf65, v140
    v_fmac_f32 v140, 0x3ebccf65, v122
    v_mul_f32 v141, 0xbf170c51, v115
    v_fmac_f32 v141, 0xbe6c033f, v131
    v_fmamk_f32 v149, v123, 0xbebccf65, v141
    v_fmac_f32 v141, 0x3ebccf65, v123
    v_mul_f32 v142, 0xbf170c51, v116
    v_fmac_f32 v142, 0xbe6c033f, v132
    v_fmamk_f32 v150, v124, 0xbebccf65, v142
    v_fmac_f32 v142, 0x3ebccf65, v124
    v_mul_f32 v143, 0xbf170c51, v117
    v_fmac_f32 v143, 0xbe6c033f, v133
    v_fmamk_f32 v151, v125, 0xbebccf65, v143
    v_fmac_f32 v143, 0x3ebccf65, v125
    v_cvt_pk_bf16_f32 v156, v144, v145
    v_cvt_pk_bf16_f32 v157, v146, v147
    v_cvt_pk_bf16_f32 v158, v148, v149
    v_cvt_pk_bf16_f32 v159, v150, v151
    s_add_u32 s85, s84, 0
    buffer_store_dwordx4 v[156:159], v254, s[8:11], s85 offen sc1
    v_cvt_pk_bf16_f32 v160, v136, v137
    v_cvt_pk_bf16_f32 v161, v138, v139
    v_cvt_pk_bf16_f32 v162, v140, v141
    v_cvt_pk_bf16_f32 v163, v142, v143
    s_add_u32 s85, s84, 36864
    buffer_store_dwordx4 v[160:163], v254, s[8:11], s85 offen sc1
    v_mul_f32 v136, 0x3e6c033f, v110
    v_fmac_f32 v136, 0x3f170c51, v126
    v_fmamk_f32 v144, v118, 0x3ebccf65, v136
    v_fmac_f32 v136, 0xbebccf65, v118
    v_mul_f32 v137, 0x3e6c033f, v111
    v_fmac_f32 v137, 0x3f170c51, v127
    v_fmamk_f32 v145, v119, 0x3ebccf65, v137
    v_fmac_f32 v137, 0xbebccf65, v119
    v_mul_f32 v138, 0x3e6c033f, v112
    v_fmac_f32 v138, 0x3f170c51, v128
    v_fmamk_f32 v146, v120, 0x3ebccf65, v138
    v_fmac_f32 v138, 0xbebccf65, v120
    v_mul_f32 v139, 0x3e6c033f, v113
    v_fmac_f32 v139, 0x3f170c51, v129
    v_fmamk_f32 v147, v121, 0x3ebccf65, v139
    v_fmac_f32 v139, 0xbebccf65, v121
    v_mul_f32 v140, 0x3e6c033f, v114
    v_fmac_f32 v140, 0x3f170c51, v130
    v_fmamk_f32 v148, v122, 0x3ebccf65, v140
    v_fmac_f32 v140, 0xbebccf65, v122
    v_mul_f32 v141, 0x3e6c033f, v115
    v_fmac_f32 v141, 0x3f170c51, v131
    v_fmamk_f32 v149, v123, 0x3ebccf65, v141
    v_fmac_f32 v141, 0xbebccf65, v123
    v_mul_f32 v142, 0x3e6c033f, v116
    v_fmac_f32 v142, 0x3f170c51, v132
    v_fmamk_f32 v150, v124, 0x3ebccf65, v142
    v_fmac_f32 v142, 0xbebccf65, v124
    v_mul_f32 v143, 0x3e6c033f, v117
    v_fmac_f32 v143, 0x3f170c51, v133
    v_fmamk_f32 v151, v125, 0x3ebccf65, v143
    v_fmac_f32 v143, 0xbebccf65, v125
    v_cvt_pk_bf16_f32 v164, v144, v145
    v_cvt_pk_bf16_f32 v165, v146, v147
    v_cvt_pk_bf16_f32 v166, v148, v149
    v_cvt_pk_bf16_f32 v167, v150, v151
    s_add_u32 s85, s84, 73728
    buffer_store_dwordx4 v[164:167], v254, s[8:11], s85 offen sc1
    v_cvt_pk_bf16_f32 v168, v136, v137
    v_cvt_pk_bf16_f32 v169, v138, v139
    v_cvt_pk_bf16_f32 v170, v140, v141
    v_cvt_pk_bf16_f32 v171, v142, v143
    s_add_u32 s85, s84, 110592
    buffer_store_dwordx4 v[168:171], v254, s[8:11], s85 offen sc1
    v_cvt_pk_bf16_f32 v152, v110, v111
    v_cvt_pk_bf16_f32 v153, v112, v113
    v_cvt_pk_bf16_f32 v154, v114, v115
    v_cvt_pk_bf16_f32 v155, v116, v117
    s_add_u32 s85, s83, 884736
    buffer_store_dwordx4 v[152:155], v254, s[8:11], s85 offen sc1
    v_cvt_pk_bf16_f32 v172, v126, v127
    v_cvt_pk_bf16_f32 v173, v128, v129
    v_cvt_pk_bf16_f32 v174, v130, v131
    v_cvt_pk_bf16_f32 v175, v132, v133
    s_add_u32 s85, s83, 1105920
    buffer_store_dwordx4 v[172:175], v254, s[8:11], s85 offen sc1
    buffer_load_dwordx2 v[8:9], v80, s[4:7], s16 offen offset:0
    buffer_load_dwordx2 v[10:11], v80, s[4:7], s17 offen offset:0
    buffer_load_dwordx2 v[12:13], v80, s[4:7], s18 offen offset:0
    buffer_load_dwordx2 v[14:15], v80, s[4:7], s19 offen offset:0
    buffer_load_dwordx2 v[16:17], v80, s[4:7], s20 offen offset:0
    buffer_load_dwordx2 v[18:19], v80, s[4:7], s21 offen offset:0
    s_mov_b32 s87, 1
    s_cmp_lg_u32 s38, 0
    s_waitcnt vmcnt(6)
    s_barrier
    s_cbranch_scc1 wt_pub
    s_atomic_add s87, s[68:69], 0 glc
    s_waitcnt lgkmcnt(0)
    s_cmp_lg_u32 s87, 53
    s_cbranch_scc1 wt_pub
    s_atomic_add s87, s[68:69], 128
wt_pub:
    buffer_load_dwordx2 v[20:21], v80, s[4:7], s16 offen offset:384
    buffer_load_dwordx2 v[22:23], v80, s[4:7], s17 offen offset:384
    buffer_load_dwordx2 v[24:25], v80, s[4:7], s18 offen offset:384
    buffer_load_dwordx2 v[26:27], v80, s[4:7], s19 offen offset:384
    buffer_load_dwordx2 v[28:29], v80, s[4:7], s20 offen offset:384
    buffer_load_dwordx2 v[30:31], v80, s[4:7], s21 offen offset:384
wt_join:
    s_and_b32 s13, s13, 0xffff
    s_mov_b32 s14, 100663296
    s_mov_b32 s15, 0x20000
    v_lshrrev_b32 v5, 4, v2
    v_mul_u32_u24 v6, 40704, v5
    v_lshrrev_b32 v5, 1, v5
    v_lshl_add_u32 v6, v5, 6, v6
    v_and_b32 v5, 0xf0, v254
    v_add_u32 v253, v6, v5
    v_lshrrev_b32 v6, 1, v4
    v_mul_u32_u24 v7, 40704, v6
    v_lshrrev_b32 v6, 1, v6
    v_lshl_add_u32 v7, v6, 6, v7
    v_and_b32 v6, 1, v2
    v_lshl_add_u32 v7, v6, 3, v7
    v_lshl_add_u32 v7, v3, 4, v7
    s_lshl_b32 s44, s90, 7
    s_mul_i32 s45, s91, 1056
    s_add_u32 s44, s44, s45
    v_add_u32 v7, s44, v7
    v_lshl_or_b32 v255, v7, 15, v255
    s_mul_i32 s51, s38, 40704
    s_lshl_b32 s45, s91, 6
    s_add_u32 s51, s51, s45
    s_lshl_b32 s45, s90, 4
    s_add_u32 s51, s51, s45
    s_mul_i32 s40, s49, 786432
    s_mul_i32 s45, s48, 49152
    s_add_u32 s40, s40, s45
    s_mul_i32 s45, s38, 12288
    s_add_u32 s40, s40, s45
    s_mov_b32 s41, 2130706432
    s_mov_b32 s39, 0
    s_lshl_b32 s45, s38, 4
    s_mov_b32 s46, 0xfff
    s_mov_b32 s47, 0
    s_lshl_b64 s[46:47], s[46:47], s45
    s_mov_b32 s58, 0x0fff0fff
    s_mov_b32 s59, 0
    s_mov_b32 s23, 0xc03cd70a
    s_mov_b32 s24, 0xbec80000
    s_mov_b32 s25, 0xc023d70a
    s_mov_b32 s26, 0x3f200000
    s_mov_b32 s27, 0xbf200000
    s_mov_b32 s28, 0x3fcccccd
    s_mov_b32 s29, 0xbfcccccd
    s_mov_b32 s30, 0x3ec80000
    s_mov_b32 s31, 0x3ec80000
    s_mov_b32 s34, 0x3e7a0000
    s_mov_b32 s22, 0xffff0000
    s_mul_i32 s32, s89, 147456
    s_mul_i32 s35, s89, -737280
    s_mul_i32 s36, s89, 36864
    s_mul_i32 s37, s89, -184320
    s_mul_i32 s3, s89, 384
    s_add_u32 s33, s100, 6291456
    v_bfe_u32 v6, v254, 6, 2
    v_mul_u32_u24 v4, 40704, v6
    v_and_b32 v6, 0x80, v254
    v_lshrrev_b32 v6, 1, v6
    v_add_u32 v4, v4, v6
    v_and_b32 v6, 0x40, v254
    v_lshrrev_b32 v6, 2, v6
    v_add_u32 v4, v4, v6
    v_bfe_u32 v6, v254, 4, 2
    v_mul_u32_u24 v6, 3104, v6
    v_add_u32 v4, v4, v6
    v_add_u32 v4, s52, v4
    v_lshrrev_b32 v6, 8, v254
    v_lshl_add_u32 v5, v6, 3, v4
    v_lshl_add_u32 v4, v6, 4, v4
    v_add_u32 v6, s51, v254
    s_cmp_gt_u32 s48, 0
    s_cselect_b32 s45, 384, 0
    s_cselect_b32 s55, 0, 2130706432
    s_add_u32 s50, s50, s45
    s_add_u32 s54, s45, 49152
    s_cmp_eq_u32 s48, 3
    s_cselect_b32 s54, 2130706432, s54
    s_mov_b32 s56, 0xffff0000
    s_mov_b32 s57, 0
    v_and_b32 v67, 0xf0, v254
    v_lshrrev_b32 v67, 1, v67
    v_add_u32 v67, s52, v67
    v_mov_b32 v66, s54
    v_mov_b32 v65, s55
    v_cndmask_b32 v66, v66, v65, s[56:57]
    v_add_u32 v67, v67, v66
    s_sub_u32 s45, s16, s50
    buffer_load_dwordx2 v[56:57], v67, s[4:7], s45 offen
    s_sub_u32 s45, s17, s50
    buffer_load_dwordx2 v[58:59], v67, s[4:7], s45 offen
    s_sub_u32 s45, s18, s50
    buffer_load_dwordx2 v[60:61], v67, s[4:7], s45 offen
    s_sub_u32 s45, s19, s50
    buffer_load_dwordx2 v[62:63], v67, s[4:7], s45 offen
    s_sub_u32 s45, s20, s50
    buffer_load_dwordx2 v[64:65], v67, s[4:7], s45 offen
    s_sub_u32 s45, s21, s50
    buffer_load_dwordx2 v[66:67], v67, s[4:7], s45 offen
    buffer_load_dwordx2 v[32:33], v80, s[4:7], s16 offen offset:768
    buffer_load_dwordx2 v[34:35], v80, s[4:7], s17 offen offset:768
    buffer_load_dwordx2 v[36:37], v80, s[4:7], s18 offen offset:768
    buffer_load_dwordx2 v[38:39], v80, s[4:7], s19 offen offset:768
    buffer_load_dwordx2 v[40:41], v80, s[4:7], s20 offen offset:768
    buffer_load_dwordx2 v[42:43], v80, s[4:7], s21 offen offset:768
    buffer_load_dwordx2 v[44:45], v80, s[4:7], s16 offen offset:1152
    buffer_load_dwordx2 v[46:47], v80, s[4:7], s17 offen offset:1152
    buffer_load_dwordx2 v[48:49], v80, s[4:7], s18 offen offset:1152
    buffer_load_dwordx2 v[50:51], v80, s[4:7], s19 offen offset:1152
    buffer_load_dwordx2 v[52:53], v80, s[4:7], s20 offen offset:1152
    buffer_load_dwordx2 v[54:55], v80, s[4:7], s21 offen offset:1152
    s_waitcnt vmcnt(24)
    v_lshlrev_b32 v176, 16, v8
    v_and_b32 v177, s22, v8
    v_lshlrev_b32 v178, 16, v10
    v_and_b32 v179, s22, v10
    v_lshlrev_b32 v180, 16, v12
    v_and_b32 v181, s22, v12
    v_lshlrev_b32 v182, 16, v14
    v_and_b32 v183, s22, v14
    v_lshlrev_b32 v184, 16, v16
    v_and_b32 v185, s22, v16
    v_lshlrev_b32 v186, 16, v18
    v_and_b32 v187, s22, v18
    v_pk_add_f32 v[176:177], v[176:177], v[184:185]
    v_pk_add_f32 v[186:187], v[186:187], v[178:179]
    v_pk_fma_f32 v[176:177], v[180:181], s[22:23], v[176:177] op_sel:[0,1,0]
    v_pk_fma_f32 v[186:187], v[182:183], s[22:23], v[186:187] op_sel:[0,1,0]
    v_pk_fma_f32 v[188:189], v[180:181], s[24:25], v[184:185] op_sel_hi:[1,0,1]
    v_pk_fma_f32 v[184:185], v[180:181], s[24:25], v[184:185] op_sel:[0,1,0]
    v_pk_fma_f32 v[180:181], v[178:179], s[24:25], v[182:183] op_sel_hi:[1,0,1]
    v_pk_fma_f32 v[182:183], v[178:179], s[24:25], v[182:183] op_sel:[0,1,0]
    v_pk_fma_f32 v[178:179], v[182:183], s[26:27], v[184:185] op_sel_hi:[1,0,1]
    v_pk_fma_f32 v[184:185], v[182:183], s[26:27], v[184:185] op_sel:[0,1,0]
    v_pk_fma_f32 v[182:183], v[180:181], s[28:29], v[188:189] op_sel_hi:[1,0,1]
    v_pk_fma_f32 v[180:181], v[180:181], s[28:29], v[188:189] op_sel:[0,1,0]
    v_cvt_pk_bf16_f32 v8, v176, v177
    v_cvt_pk_bf16_f32 v10, v178, v179
    v_cvt_pk_bf16_f32 v12, v180, v181
    v_cvt_pk_bf16_f32 v14, v182, v183
    v_cvt_pk_bf16_f32 v16, v184, v185
    v_cvt_pk_bf16_f32 v18, v186, v187
    v_lshlrev_b32 v176, 16, v9
    v_and_b32 v177, s22, v9
    v_lshlrev_b32 v178, 16, v11
    v_and_b32 v179, s22, v11
    v_lshlrev_b32 v180, 16, v13
    v_and_b32 v181, s22, v13
    v_lshlrev_b32 v182, 16, v15
    v_and_b32 v183, s22, v15
    v_lshlrev_b32 v184, 16, v17
    v_and_b32 v185, s22, v17
    v_lshlrev_b32 v186, 16, v19
    v_and_b32 v187, s22, v19
    v_pk_add_f32 v[176:177], v[176:177], v[184:185]
    v_pk_add_f32 v[186:187], v[186:187], v[178:179]
    v_pk_fma_f32 v[176:177], v[180:181], s[22:23], v[176:177] op_sel:[0,1,0]
    v_pk_fma_f32 v[186:187], v[182:183], s[22:23], v[186:187] op_sel:[0,1,0]
    v_pk_fma_f32 v[188:189], v[180:181], s[24:25], v[184:185] op_sel_hi:[1,0,1]
    v_pk_fma_f32 v[184:185], v[180:181], s[24:25], v[184:185] op_sel:[0,1,0]
    v_pk_fma_f32 v[180:181], v[178:179], s[24:25], v[182:183] op_sel_hi:[1,0,1]
    v_pk_fma_f32 v[182:183], v[178:179], s[24:25], v[182:183] op_sel:[0,1,0]
    v_pk_fma_f32 v[178:179], v[182:183], s[26:27], v[184:185] op_sel_hi:[1,0,1]
    v_pk_fma_f32 v[184:185], v[182:183], s[26:27], v[184:185] op_sel:[0,1,0]
    v_pk_fma_f32 v[182:183], v[180:181], s[28:29], v[188:189] op_sel_hi:[1,0,1]
    v_pk_fma_f32 v[180:181], v[180:181], s[28:29], v[188:189] op_sel:[0,1,0]
    v_cvt_pk_bf16_f32 v9, v176, v177
    v_cvt_pk_bf16_f32 v11, v178, v179
    v_cvt_pk_bf16_f32 v13, v180, v181
    v_cvt_pk_bf16_f32 v15, v182, v183
    v_cvt_pk_bf16_f32 v17, v184, v185
    v_cvt_pk_bf16_f32 v19, v186, v187
    v_lshrrev_b32 v252, 15, v255
    ds_write_b64 v252, v[8:9] offset:34048
    ds_write_b64 v252, v[10:11] offset:768
    ds_write_b64 v252, v[16:17] offset:2848
    ds_write_b64 v252, v[14:15] offset:4928
    ds_write_b64 v252, v[12:13] offset:7008
    ds_write_b64 v252, v[18:19] offset:36128
    s_waitcnt vmcnt(18)
    v_lshlrev_b32 v176, 16, v20
    v_and_b32 v177, s22, v20
    v_lshlrev_b32 v178, 16, v22
    v_and_b32 v179, s22, v22
    v_lshlrev_b32 v180, 16, v24
    v_and_b32 v181, s22, v24
    v_lshlrev_b32 v182, 16, v26
    v_and_b32 v183, s22, v26
    v_lshlrev_b32 v184, 16, v28
    v_and_b32 v185, s22, v28
    v_lshlrev_b32 v186, 16, v30
    v_and_b32 v187, s22, v30
    v_pk_add_f32 v[176:177], v[176:177], v[184:185]
    v_pk_add_f32 v[186:187], v[186:187], v[178:179]
    v_pk_fma_f32 v[176:177], v[180:181], s[22:23], v[176:177] op_sel:[0,1,0]
    v_pk_fma_f32 v[186:187], v[182:183], s[22:23], v[186:187] op_sel:[0,1,0]
    v_pk_fma_f32 v[188:189], v[180:181], s[24:25], v[184:185] op_sel_hi:[1,0,1]
    v_pk_fma_f32 v[184:185], v[180:181], s[24:25], v[184:185] op_sel:[0,1,0]
    v_pk_fma_f32 v[180:181], v[178:179], s[24:25], v[182:183] op_sel_hi:[1,0,1]
    v_pk_fma_f32 v[182:183], v[178:179], s[24:25], v[182:183] op_sel:[0,1,0]
    v_pk_fma_f32 v[178:179], v[182:183], s[26:27], v[184:185] op_sel_hi:[1,0,1]
    v_pk_fma_f32 v[184:185], v[182:183], s[26:27], v[184:185] op_sel:[0,1,0]
    v_pk_fma_f32 v[182:183], v[180:181], s[28:29], v[188:189] op_sel_hi:[1,0,1]
    v_pk_fma_f32 v[180:181], v[180:181], s[28:29], v[188:189] op_sel:[0,1,0]
    v_cvt_pk_bf16_f32 v20, v176, v177
    v_cvt_pk_bf16_f32 v22, v178, v179
    v_cvt_pk_bf16_f32 v24, v180, v181
    v_cvt_pk_bf16_f32 v26, v182, v183
    v_cvt_pk_bf16_f32 v28, v184, v185
    v_cvt_pk_bf16_f32 v30, v186, v187
    v_lshlrev_b32 v176, 16, v21
    v_and_b32 v177, s22, v21
    v_lshlrev_b32 v178, 16, v23
    v_and_b32 v179, s22, v23
    v_lshlrev_b32 v180, 16, v25
    v_and_b32 v181, s22, v25
    v_lshlrev_b32 v182, 16, v27
    v_and_b32 v183, s22, v27
    v_lshlrev_b32 v184, 16, v29
    v_and_b32 v185, s22, v29
    v_lshlrev_b32 v186, 16, v31
    v_and_b32 v187, s22, v31
    v_pk_add_f32 v[176:177], v[176:177], v[184:185]
    v_pk_add_f32 v[186:187], v[186:187], v[178:179]
    v_pk_fma_f32 v[176:177], v[180:181], s[22:23], v[176:177] op_sel:[0,1,0]
    v_pk_fma_f32 v[186:187], v[182:183], s[22:23], v[186:187] op_sel:[0,1,0]
    v_pk_fma_f32 v[188:189], v[180:181], s[24:25], v[184:185] op_sel_hi:[1,0,1]
    v_pk_fma_f32 v[184:185], v[180:181], s[24:25], v[184:185] op_sel:[0,1,0]
    v_pk_fma_f32 v[180:181], v[178:179], s[24:25], v[182:183] op_sel_hi:[1,0,1]
    v_pk_fma_f32 v[182:183], v[178:179], s[24:25], v[182:183] op_sel:[0,1,0]
    v_pk_fma_f32 v[178:179], v[182:183], s[26:27], v[184:185] op_sel_hi:[1,0,1]
    v_pk_fma_f32 v[184:185], v[182:183], s[26:27], v[184:185] op_sel:[0,1,0]
    v_pk_fma_f32 v[182:183], v[180:181], s[28:29], v[188:189] op_sel_hi:[1,0,1]
    v_pk_fma_f32 v[180:181], v[180:181], s[28:29], v[188:189] op_sel:[0,1,0]
    v_cvt_pk_bf16_f32 v21, v176, v177
    v_cvt_pk_bf16_f32 v23, v178, v179
    v_cvt_pk_bf16_f32 v25, v180, v181
    v_cvt_pk_bf16_f32 v27, v182, v183
    v_cvt_pk_bf16_f32 v29, v184, v185
    v_cvt_pk_bf16_f32 v31, v186, v187
    v_lshrrev_b32 v252, 15, v255
    ds_write_b64 v252, v[20:21] offset:33792
    ds_write_b64 v252, v[22:23] offset:512
    ds_write_b64 v252, v[28:29] offset:2592
    ds_write_b64 v252, v[26:27] offset:4672
    ds_write_b64 v252, v[24:25] offset:6752
    ds_write_b64 v252, v[30:31] offset:35872
    s_waitcnt vmcnt(12)
    v_lshlrev_b32 v176, 16, v56
    v_and_b32 v177, s22, v56
    v_lshlrev_b32 v178, 16, v58
    v_and_b32 v179, s22, v58
    v_lshlrev_b32 v180, 16, v60
    v_and_b32 v181, s22, v60
    v_lshlrev_b32 v182, 16, v62
    v_and_b32 v183, s22, v62
    v_lshlrev_b32 v184, 16, v64
    v_and_b32 v185, s22, v64
    v_lshlrev_b32 v186, 16, v66
    v_and_b32 v187, s22, v66
    v_pk_add_f32 v[176:177], v[176:177], v[184:185]
    v_pk_add_f32 v[186:187], v[186:187], v[178:179]
    v_pk_fma_f32 v[176:177], v[180:181], s[22:23], v[176:177] op_sel:[0,1,0]
    v_pk_fma_f32 v[186:187], v[182:183], s[22:23], v[186:187] op_sel:[0,1,0]
    v_pk_fma_f32 v[188:189], v[180:181], s[24:25], v[184:185] op_sel_hi:[1,0,1]
    v_pk_fma_f32 v[184:185], v[180:181], s[24:25], v[184:185] op_sel:[0,1,0]
    v_pk_fma_f32 v[180:181], v[178:179], s[24:25], v[182:183] op_sel_hi:[1,0,1]
    v_pk_fma_f32 v[182:183], v[178:179], s[24:25], v[182:183] op_sel:[0,1,0]
    v_pk_fma_f32 v[178:179], v[182:183], s[26:27], v[184:185] op_sel_hi:[1,0,1]
    v_pk_fma_f32 v[184:185], v[182:183], s[26:27], v[184:185] op_sel:[0,1,0]
    v_pk_fma_f32 v[182:183], v[180:181], s[28:29], v[188:189] op_sel_hi:[1,0,1]
    v_pk_fma_f32 v[180:181], v[180:181], s[28:29], v[188:189] op_sel:[0,1,0]
    v_cvt_pk_bf16_f32 v56, v176, v177
    v_cvt_pk_bf16_f32 v58, v178, v179
    v_cvt_pk_bf16_f32 v60, v180, v181
    v_cvt_pk_bf16_f32 v62, v182, v183
    v_cvt_pk_bf16_f32 v64, v184, v185
    v_cvt_pk_bf16_f32 v66, v186, v187
    v_lshlrev_b32 v176, 16, v57
    v_and_b32 v177, s22, v57
    v_lshlrev_b32 v178, 16, v59
    v_and_b32 v179, s22, v59
    v_lshlrev_b32 v180, 16, v61
    v_and_b32 v181, s22, v61
    v_lshlrev_b32 v182, 16, v63
    v_and_b32 v183, s22, v63
    v_lshlrev_b32 v184, 16, v65
    v_and_b32 v185, s22, v65
    v_lshlrev_b32 v186, 16, v67
    v_and_b32 v187, s22, v67
    v_pk_add_f32 v[176:177], v[176:177], v[184:185]
    v_pk_add_f32 v[186:187], v[186:187], v[178:179]
    v_pk_fma_f32 v[176:177], v[180:181], s[22:23], v[176:177] op_sel:[0,1,0]
    v_pk_fma_f32 v[186:187], v[182:183], s[22:23], v[186:187] op_sel:[0,1,0]
    v_pk_fma_f32 v[188:189], v[180:181], s[24:25], v[184:185] op_sel_hi:[1,0,1]
    v_pk_fma_f32 v[184:185], v[180:181], s[24:25], v[184:185] op_sel:[0,1,0]
    v_pk_fma_f32 v[180:181], v[178:179], s[24:25], v[182:183] op_sel_hi:[1,0,1]
    v_pk_fma_f32 v[182:183], v[178:179], s[24:25], v[182:183] op_sel:[0,1,0]
    v_pk_fma_f32 v[178:179], v[182:183], s[26:27], v[184:185] op_sel_hi:[1,0,1]
    v_pk_fma_f32 v[184:185], v[182:183], s[26:27], v[184:185] op_sel:[0,1,0]
    v_pk_fma_f32 v[182:183], v[180:181], s[28:29], v[188:189] op_sel_hi:[1,0,1]
    v_pk_fma_f32 v[180:181], v[180:181], s[28:29], v[188:189] op_sel:[0,1,0]
    v_cvt_pk_bf16_f32 v57, v176, v177
    v_cvt_pk_bf16_f32 v59, v178, v179
    v_cvt_pk_bf16_f32 v61, v180, v181
    v_cvt_pk_bf16_f32 v63, v182, v183
    v_cvt_pk_bf16_f32 v65, v184, v185
    v_cvt_pk_bf16_f32 v67, v186, v187
    v_and_b32 v248, 0xf0, v254
    v_lshrrev_b32 v248, 1, v248
    v_add_u32 v248, s52, v248
    v_and_b32 v252, 8, v248
    v_lshrrev_b32 v249, 6, v248
    v_mul_u32_u24 v249, 384, v249
    v_subrev_u32 v249, s3, v249
    v_min_u32 v249, 1920, v249
    v_lshrrev_b32 v249, 1, v249
    v_cmp_eq_u32 s[92:93], 0, v249
    v_add_u32 v252, v252, v249
    v_bfe_u32 v249, v248, 4, 2
    v_mul_u32_u24 v249, 40704, v249
    v_add_u32 v252, v252, v249
    v_and_b32 v249, 32, v248
    v_lshl_add_u32 v252, v249, 1, v252
    v_bfe_u32 v249, v254, 8, 1
    v_lshl_add_u32 v252, v249, 4, v252
    v_mov_b32 v249, 123328
    v_cndmask_b32 v252, v249, v252, s[58:59]
    ds_write_b64 v252, v[56:57] offset:39520
    ds_write_b64 v252, v[58:59] offset:39552
    ds_write_b64 v252, v[64:65] offset:39584
    ds_write_b64 v252, v[62:63] offset:39616
    ds_write_b64 v252, v[60:61] offset:39648
    ds_write_b64 v252, v[66:67] offset:39680
    s_and_b64 exec, s[92:93], s[58:59]
    ds_write_b64 v252, v[56:57] offset:34304
    ds_write_b64 v252, v[58:59] offset:1024
    ds_write_b64 v252, v[64:65] offset:3104
    ds_write_b64 v252, v[62:63] offset:5184
    ds_write_b64 v252, v[60:61] offset:7264
    ds_write_b64 v252, v[66:67] offset:36384
    s_mov_b64 exec, -1
    v_and_b32 v203, 0x7fff, v255
    buffer_load_dwordx2 v[192:193], v203, s[4:7], s16 offen offset:64
    buffer_load_dwordx2 v[194:195], v203, s[4:7], s17 offen offset:64
    buffer_load_dwordx2 v[196:197], v203, s[4:7], s18 offen offset:64
    buffer_load_dwordx2 v[198:199], v203, s[4:7], s19 offen offset:64
    buffer_load_dwordx2 v[200:201], v203, s[4:7], s20 offen offset:64
    buffer_load_dwordx2 v[202:203], v203, s[4:7], s21 offen offset:64
    v_and_b32 v215, 0x7fff, v255
    buffer_load_dwordx2 v[204:205], v215, s[4:7], s16 offen offset:448
    buffer_load_dwordx2 v[206:207], v215, s[4:7], s17 offen offset:448
    buffer_load_dwordx2 v[208:209], v215, s[4:7], s18 offen offset:448
    buffer_load_dwordx2 v[210:211], v215, s[4:7], s19 offen offset:448
    buffer_load_dwordx2 v[212:213], v215, s[4:7], s20 offen offset:448
    buffer_load_dwordx2 v[214:215], v215, s[4:7], s21 offen offset:448
    s_waitcnt vmcnt(18)
    v_lshlrev_b32 v176, 16, v32
    v_and_b32 v177, s22, v32
    v_lshlrev_b32 v178, 16, v34
    v_and_b32 v179, s22, v34
    v_lshlrev_b32 v180, 16, v36
    v_and_b32 v181, s22, v36
    v_lshlrev_b32 v182, 16, v38
    v_and_b32 v183, s22, v38
    v_lshlrev_b32 v184, 16, v40
    v_and_b32 v185, s22, v40
    v_lshlrev_b32 v186, 16, v42
    v_and_b32 v187, s22, v42
    v_pk_add_f32 v[176:177], v[176:177], v[184:185]
    v_pk_add_f32 v[186:187], v[186:187], v[178:179]
    v_pk_fma_f32 v[176:177], v[180:181], s[22:23], v[176:177] op_sel:[0,1,0]
    v_pk_fma_f32 v[186:187], v[182:183], s[22:23], v[186:187] op_sel:[0,1,0]
    v_pk_fma_f32 v[188:189], v[180:181], s[24:25], v[184:185] op_sel_hi:[1,0,1]
    v_pk_fma_f32 v[184:185], v[180:181], s[24:25], v[184:185] op_sel:[0,1,0]
    v_pk_fma_f32 v[180:181], v[178:179], s[24:25], v[182:183] op_sel_hi:[1,0,1]
    v_pk_fma_f32 v[182:183], v[178:179], s[24:25], v[182:183] op_sel:[0,1,0]
    v_pk_fma_f32 v[178:179], v[182:183], s[26:27], v[184:185] op_sel_hi:[1,0,1]
    v_pk_fma_f32 v[184:185], v[182:183], s[26:27], v[184:185] op_sel:[0,1,0]
    v_pk_fma_f32 v[182:183], v[180:181], s[28:29], v[188:189] op_sel_hi:[1,0,1]
    v_pk_fma_f32 v[180:181], v[180:181], s[28:29], v[188:189] op_sel:[0,1,0]
    v_cvt_pk_bf16_f32 v32, v176, v177
    v_cvt_pk_bf16_f32 v34, v178, v179
    v_cvt_pk_bf16_f32 v36, v180, v181
    v_cvt_pk_bf16_f32 v38, v182, v183
    v_cvt_pk_bf16_f32 v40, v184, v185
    v_cvt_pk_bf16_f32 v42, v186, v187
    v_lshlrev_b32 v176, 16, v33
    v_and_b32 v177, s22, v33
    v_lshlrev_b32 v178, 16, v35
    v_and_b32 v179, s22, v35
    v_lshlrev_b32 v180, 16, v37
    v_and_b32 v181, s22, v37
    v_lshlrev_b32 v182, 16, v39
    v_and_b32 v183, s22, v39
    v_lshlrev_b32 v184, 16, v41
    v_and_b32 v185, s22, v41
    v_lshlrev_b32 v186, 16, v43
    v_and_b32 v187, s22, v43
    v_pk_add_f32 v[176:177], v[176:177], v[184:185]
    v_pk_add_f32 v[186:187], v[186:187], v[178:179]
    v_pk_fma_f32 v[176:177], v[180:181], s[22:23], v[176:177] op_sel:[0,1,0]
    v_pk_fma_f32 v[186:187], v[182:183], s[22:23], v[186:187] op_sel:[0,1,0]
    v_pk_fma_f32 v[188:189], v[180:181], s[24:25], v[184:185] op_sel_hi:[1,0,1]
    v_pk_fma_f32 v[184:185], v[180:181], s[24:25], v[184:185] op_sel:[0,1,0]
    v_pk_fma_f32 v[180:181], v[178:179], s[24:25], v[182:183] op_sel_hi:[1,0,1]
    v_pk_fma_f32 v[182:183], v[178:179], s[24:25], v[182:183] op_sel:[0,1,0]
    v_pk_fma_f32 v[178:179], v[182:183], s[26:27], v[184:185] op_sel_hi:[1,0,1]
    v_pk_fma_f32 v[184:185], v[182:183], s[26:27], v[184:185] op_sel:[0,1,0]
    v_pk_fma_f32 v[182:183], v[180:181], s[28:29], v[188:189] op_sel_hi:[1,0,1]
    v_pk_fma_f32 v[180:181], v[180:181], s[28:29], v[188:189] op_sel:[0,1,0]
    v_cvt_pk_bf16_f32 v33, v176, v177
    v_cvt_pk_bf16_f32 v35, v178, v179
    v_cvt_pk_bf16_f32 v37, v180, v181
    v_cvt_pk_bf16_f32 v39, v182, v183
    v_cvt_pk_bf16_f32 v41, v184, v185
    v_cvt_pk_bf16_f32 v43, v186, v187
    v_lshrrev_b32 v252, 15, v255
    ds_write_b64 v252, v[32:33] offset:33536
    ds_write_b64 v252, v[34:35] offset:256
    ds_write_b64 v252, v[40:41] offset:2336
    ds_write_b64 v252, v[38:39] offset:4416
    ds_write_b64 v252, v[36:37] offset:6496
    ds_write_b64 v252, v[42:43] offset:35616
    s_waitcnt vmcnt(12)
    v_lshlrev_b32 v176, 16, v44
    v_and_b32 v177, s22, v44
    v_lshlrev_b32 v178, 16, v46
    v_and_b32 v179, s22, v46
    v_lshlrev_b32 v180, 16, v48
    v_and_b32 v181, s22, v48
    v_lshlrev_b32 v182, 16, v50
    v_and_b32 v183, s22, v50
    v_lshlrev_b32 v184, 16, v52
    v_and_b32 v185, s22, v52
    v_lshlrev_b32 v186, 16, v54
    v_and_b32 v187, s22, v54
    v_pk_add_f32 v[176:177], v[176:177], v[184:185]
    v_pk_add_f32 v[186:187], v[186:187], v[178:179]
    v_pk_fma_f32 v[176:177], v[180:181], s[22:23], v[176:177] op_sel:[0,1,0]
    v_pk_fma_f32 v[186:187], v[182:183], s[22:23], v[186:187] op_sel:[0,1,0]
    v_pk_fma_f32 v[188:189], v[180:181], s[24:25], v[184:185] op_sel_hi:[1,0,1]
    v_pk_fma_f32 v[184:185], v[180:181], s[24:25], v[184:185] op_sel:[0,1,0]
    v_pk_fma_f32 v[180:181], v[178:179], s[24:25], v[182:183] op_sel_hi:[1,0,1]
    v_pk_fma_f32 v[182:183], v[178:179], s[24:25], v[182:183] op_sel:[0,1,0]
    v_pk_fma_f32 v[178:179], v[182:183], s[26:27], v[184:185] op_sel_hi:[1,0,1]
    v_pk_fma_f32 v[184:185], v[182:183], s[26:27], v[184:185] op_sel:[0,1,0]
    v_pk_fma_f32 v[182:183], v[180:181], s[28:29], v[188:189] op_sel_hi:[1,0,1]
    v_pk_fma_f32 v[180:181], v[180:181], s[28:29], v[188:189] op_sel:[0,1,0]
    v_cvt_pk_bf16_f32 v44, v176, v177
    v_cvt_pk_bf16_f32 v46, v178, v179
    v_cvt_pk_bf16_f32 v48, v180, v181
    v_cvt_pk_bf16_f32 v50, v182, v183
    v_cvt_pk_bf16_f32 v52, v184, v185
    v_cvt_pk_bf16_f32 v54, v186, v187
    v_lshlrev_b32 v176, 16, v45
    v_and_b32 v177, s22, v45
    v_lshlrev_b32 v178, 16, v47
    v_and_b32 v179, s22, v47
    v_lshlrev_b32 v180, 16, v49
    v_and_b32 v181, s22, v49
    v_lshlrev_b32 v182, 16, v51
    v_and_b32 v183, s22, v51
    v_lshlrev_b32 v184, 16, v53
    v_and_b32 v185, s22, v53
    v_lshlrev_b32 v186, 16, v55
    v_and_b32 v187, s22, v55
    v_pk_add_f32 v[176:177], v[176:177], v[184:185]
    v_pk_add_f32 v[186:187], v[186:187], v[178:179]
    v_pk_fma_f32 v[176:177], v[180:181], s[22:23], v[176:177] op_sel:[0,1,0]
    v_pk_fma_f32 v[186:187], v[182:183], s[22:23], v[186:187] op_sel:[0,1,0]
    v_pk_fma_f32 v[188:189], v[180:181], s[24:25], v[184:185] op_sel_hi:[1,0,1]
    v_pk_fma_f32 v[184:185], v[180:181], s[24:25], v[184:185] op_sel:[0,1,0]
    v_pk_fma_f32 v[180:181], v[178:179], s[24:25], v[182:183] op_sel_hi:[1,0,1]
    v_pk_fma_f32 v[182:183], v[178:179], s[24:25], v[182:183] op_sel:[0,1,0]
    v_pk_fma_f32 v[178:179], v[182:183], s[26:27], v[184:185] op_sel_hi:[1,0,1]
    v_pk_fma_f32 v[184:185], v[182:183], s[26:27], v[184:185] op_sel:[0,1,0]
    v_pk_fma_f32 v[182:183], v[180:181], s[28:29], v[188:189] op_sel_hi:[1,0,1]
    v_pk_fma_f32 v[180:181], v[180:181], s[28:29], v[188:189] op_sel:[0,1,0]
    v_cvt_pk_bf16_f32 v45, v176, v177
    v_cvt_pk_bf16_f32 v47, v178, v179
    v_cvt_pk_bf16_f32 v49, v180, v181
    v_cvt_pk_bf16_f32 v51, v182, v183
    v_cvt_pk_bf16_f32 v53, v184, v185
    v_cvt_pk_bf16_f32 v55, v186, v187
    v_lshrrev_b32 v252, 15, v255
    ds_write_b64 v252, v[44:45] offset:33280
    ds_write_b64 v252, v[46:47] offset:0
    ds_write_b64 v252, v[52:53] offset:2080
    ds_write_b64 v252, v[50:51] offset:4160
    ds_write_b64 v252, v[48:49] offset:6240
    ds_write_b64 v252, v[54:55] offset:35360
    buffer_load_dword v97, v98, s[64:67], 0 offen offset:128 sc1
    s_waitcnt vmcnt(0)
    s_mov_b32 s86, 0
poll_loop:
    v_readfirstlane_b32 s87, v97
    s_add_u32 s86, s86, 1
    s_cmp_lg_u32 s87, 0
    s_cbranch_scc1 u_ready
    buffer_load_dword v97, v98, s[64:67], 0 offen offset:128 sc1
    s_cmp_lt_u32 s86, 512
    s_waitcnt vmcnt(0)
    s_cbranch_scc1 poll_loop
    s_mov_b32 s70, 0
    s_branch wt_loop
u_ready:
    s_add_u32 s42, s32, 0
    buffer_load_dwordx4 a[192:195], v254, s[8:11], s42 offen offset:0 sc1
    buffer_load_dwordx4 a[196:199], v254, s[8:11], s42 offen offset:1024 sc1
    buffer_load_dwordx4 a[200:203], v254, s[8:11], s42 offen offset:2048 sc1
    s_add_u32 s42, s32, 3072
    buffer_load_dwordx4 a[204:207], v254, s[8:11], s42 offen offset:0 sc1
    buffer_load_dwordx4 a[208:211], v254, s[8:11], s42 offen offset:1024 sc1
    buffer_load_dwordx4 a[212:215], v254, s[8:11], s42 offen offset:2048 sc1
    s_add_u32 s42, s32, 6144
    buffer_load_dwordx4 a[216:219], v254, s[8:11], s42 offen offset:0 sc1
    buffer_load_dwordx4 a[220:223], v254, s[8:11], s42 offen offset:1024 sc1
    buffer_load_dwordx4 a[224:227], v254, s[8:11], s42 offen offset:2048 sc1
    s_add_u32 s42, s32, 36864
    buffer_load_dwordx4 a[228:231], v254, s[8:11], s42 offen offset:0 sc1
    buffer_load_dwordx4 a[232:235], v254, s[8:11], s42 offen offset:1024 sc1
    buffer_load_dwordx4 a[236:239], v254, s[8:11], s42 offen offset:2048 sc1
    s_add_u32 s42, s32, 39936
    buffer_load_dwordx4 a[240:243], v254, s[8:11], s42 offen offset:0 sc1
    s_waitcnt lgkmcnt(0)
    s_barrier
    ds_read_b128 v[228:231], v253 offset:1040
    ds_read_b128 v[232:235], v253 offset:768
    ds_read_b128 v[236:239], v253 offset:512
    s_waitcnt vmcnt(4) lgkmcnt(0)
.p2align 6
blk_loop:
    v_mfma_f32_16x16x32_bf16 a[0:3], a[192:195], v[228:231], 0
    s_waitcnt lgkmcnt(2)
    v_cvt_pk_bf16_f32 v164, v164, v165
    v_cvt_pk_bf16_f32 v165, v166, v167
    v_lshlrev_b32 v248, 16, v194
    v_mfma_f32_16x16x32_bf16 a[4:7], a[196:199], v[228:231], 0
    buffer_load_dwordx4 a[244:247], v254, s[8:11], s42 offen offset:1024 sc1
    v_lshlrev_b32 v249, 16, v196
    v_mfma_f32_16x16x32_bf16 a[8:11], a[200:203], v[228:231], 0
    ds_read_b128 v[228:231], v253 offset:256
    v_lshlrev_b32 v250, 16, v198
    v_lshlrev_b32 v251, 16, v200
    v_and_b32 v194, s22, v194
    v_mfma_f32_16x16x32_bf16 a[12:15], a[192:195], v[232:235], 0
    ds_write_b64 v5, v[164:165] offset:18624
    v_and_b32 v196, s22, v196
    v_mfma_f32_16x16x32_bf16 a[16:19], a[196:199], v[232:235], 0
    s_waitcnt vmcnt(17)
    v_cvt_pk_bf16_f32 v156, v156, v157
    v_cvt_pk_bf16_f32 v157, v158, v159
    v_and_b32 v198, s22, v198
    v_mfma_f32_16x16x32_bf16 a[20:23], a[200:203], v[232:235], 0
    buffer_load_dwordx4 a[248:251], v254, s[8:11], s42 offen offset:2048 sc1
    v_cvt_pk_bf16_f32 v158, v160, v161
    v_and_b32 v200, s22, v200
    v_mfma_f32_16x16x32_bf16 a[0:3], a[204:207], v[232:235], a[0:3]
    s_waitcnt lgkmcnt(2)
    v_cvt_pk_bf16_f32 v159, v162, v163
    v_lshlrev_b32 v252, 16, v192
    v_and_b32 v192, s22, v192
    v_mfma_f32_16x16x32_bf16 a[4:7], a[208:211], v[232:235], a[4:7]
    s_add_u32 s42, s32, 43008
    v_add_f32 v252, v252, v251
    v_add_f32 v192, v192, v200
    v_fmac_f32 v252, s23, v249
    v_mfma_f32_16x16x32_bf16 a[8:11], a[212:215], v[232:235], a[8:11]
    ds_read_b128 v[232:235], v253 offset:0
    v_fmac_f32 v192, s23, v196
    v_cvt_pk_bf16_f32 v192, v252, v192
    v_lshlrev_b32 v252, 16, v202
    v_mfma_f32_16x16x32_bf16 a[24:27], a[192:195], v[236:239], 0
    buffer_load_dwordx4 a[252:255], v254, s[8:11], s42 offen offset:0 sc1
    v_and_b32 v202, s22, v202
    v_mfma_f32_16x16x32_bf16 a[28:31], a[196:199], v[236:239], 0
    ds_write_b128 v4, v[156:159] offset:18560
    v_add_f32 v252, v252, v248
    v_mfma_f32_16x16x32_bf16 a[32:35], a[200:203], v[236:239], 0
    v_cvt_pk_bf16_f32 v176, v176, v177
    v_cvt_pk_bf16_f32 v177, v178, v179
    v_add_f32 v202, v202, v194
    v_fmac_f32 v252, s23, v250
    v_mfma_f32_16x16x32_bf16 a[12:15], a[204:207], v[236:239], a[12:15]
    s_waitcnt vmcnt(16)
    v_fmac_f32 v202, s23, v198
    v_cvt_pk_bf16_f32 v202, v252, v202
    v_fma_f32 v252, v249, s24, v251
    v_mfma_f32_16x16x32_bf16 a[16:19], a[208:211], v[236:239], a[16:19]
    buffer_load_dwordx4 v[240:243], v254, s[8:11], s42 offen offset:1024 sc1
    v_fmac_f32 v251, s25, v249
    v_mfma_f32_16x16x32_bf16 a[20:23], a[212:215], v[236:239], a[20:23]
    ds_write_b64 v5, v[176:177] offset:19008
    v_cvt_pk_bf16_f32 v168, v168, v169
    v_fma_f32 v249, v248, s24, v250
    v_mfma_f32_16x16x32_bf16 a[0:3], a[216:219], v[236:239], a[0:3]
    s_waitcnt lgkmcnt(4)
    v_cvt_pk_bf16_f32 v169, v170, v171
    v_cvt_pk_bf16_f32 v170, v172, v173
    v_fmac_f32 v250, s25, v248
    v_mfma_f32_16x16x32_bf16 a[4:7], a[220:223], v[236:239], a[4:7]
    buffer_load_dwordx4 v[244:247], v254, s[8:11], s42 offen offset:2048 sc1
    v_fma_f32 v248, v250, s26, v251
    v_mfma_f32_16x16x32_bf16 a[8:11], a[224:227], v[236:239], a[8:11]
    ds_read_b128 v[236:239], v253 offset:1824
    v_and_b32 v227, 0x7fff, v255
    v_cvt_pk_bf16_f32 v171, v174, v175
    v_fmac_f32 v251, s27, v250
    v_mfma_f32_16x16x32_bf16 a[36:39], a[192:195], v[228:231], 0
    ds_write_b128 v4, v[168:171] offset:18944
    v_fma_f32 v250, v249, s28, v252
    v_mfma_f32_16x16x32_bf16 a[40:43], a[196:199], v[228:231], 0
    buffer_load_dwordx2 v[216:217], v227, s[4:7], s16 offen offset:832
    v_cvt_pk_bf16_f32 v188, v188, v189
    v_fmac_f32 v252, s29, v249
    v_mfma_f32_16x16x32_bf16 a[44:47], a[200:203], v[228:231], 0
    v_cvt_pk_bf16_f32 v189, v190, v191
    v_fma_f32 v249, v196, s24, v200
    v_fmac_f32 v200, s25, v196
    v_mfma_f32_16x16x32_bf16 a[24:27], a[204:207], v[228:231], a[24:27]
    v_fma_f32 v196, v194, s24, v198
    v_fmac_f32 v198, s25, v194
    v_fma_f32 v194, v198, s26, v200
    v_mfma_f32_16x16x32_bf16 a[28:31], a[208:211], v[228:231], a[28:31]
    buffer_load_dwordx2 v[218:219], v227, s[4:7], s17 offen offset:832
    v_fmac_f32 v200, s27, v198
    v_fma_f32 v198, v196, s28, v249
    v_mfma_f32_16x16x32_bf16 a[32:35], a[212:215], v[228:231], a[32:35]
    ds_write_b64 v5, v[188:189] offset:19392
    v_fmac_f32 v249, s29, v196
    v_mfma_f32_16x16x32_bf16 a[12:15], a[216:219], v[228:231], a[12:15]
    s_waitcnt lgkmcnt(5)
    v_cvt_pk_bf16_f32 v180, v180, v181
    v_cvt_pk_bf16_f32 v181, v182, v183
    v_cvt_pk_bf16_f32 v194, v248, v194
    v_mfma_f32_16x16x32_bf16 a[16:19], a[220:223], v[228:231], a[16:19]
    buffer_load_dwordx2 v[220:221], v227, s[4:7], s18 offen offset:832
    v_cvt_pk_bf16_f32 v182, v184, v185
    v_cvt_pk_bf16_f32 v200, v251, v200
    v_mfma_f32_16x16x32_bf16 a[20:23], a[224:227], v[228:231], a[20:23]
    ds_read_b128 v[228:231], v253 offset:1568
    v_cvt_pk_bf16_f32 v183, v186, v187
    v_cvt_pk_bf16_f32 v198, v250, v198
    v_mfma_f32_16x16x32_bf16 a[48:51], a[192:195], v[232:235], 0
    ds_write_b128 v4, v[180:183] offset:19328
    v_cvt_pk_bf16_f32 v196, v252, v249
    v_mfma_f32_16x16x32_bf16 a[52:55], a[196:199], v[232:235], 0
    s_waitcnt lgkmcnt(0)
    v_lshlrev_b32 v248, 16, v195
    v_lshlrev_b32 v249, 16, v197
    v_lshlrev_b32 v250, 16, v199
    v_lshlrev_b32 v251, 16, v201
    v_mfma_f32_16x16x32_bf16 a[56:59], a[200:203], v[232:235], 0
    s_barrier
    v_and_b32 v195, s22, v195
    v_mfma_f32_16x16x32_bf16 a[36:39], a[204:207], v[232:235], a[36:39]
    buffer_load_dwordx2 v[222:223], v227, s[4:7], s19 offen offset:832
    v_and_b32 v197, s22, v197
    v_mfma_f32_16x16x32_bf16 a[40:43], a[208:211], v[232:235], a[40:43]
    ds_read_b128 v[144:147], v6 offset:16640
    v_and_b32 v199, s22, v199
    v_and_b32 v201, s22, v201
    v_lshlrev_b32 v252, 16, v193
    v_mfma_f32_16x16x32_bf16 a[44:47], a[212:215], v[232:235], a[44:47]
    v_and_b32 v193, s22, v193
    v_add_f32 v252, v252, v251
    v_add_f32 v193, v193, v201
    v_mfma_f32_16x16x32_bf16 a[24:27], a[216:219], v[232:235], a[24:27]
    buffer_load_dwordx2 v[224:225], v227, s[4:7], s20 offen offset:832
    v_fmac_f32 v252, s23, v249
    v_mfma_f32_16x16x32_bf16 a[28:31], a[220:223], v[232:235], a[28:31]
    v_fmac_f32 v193, s23, v197
    v_cvt_pk_bf16_f32 v193, v252, v193
    v_lshlrev_b32 v252, 16, v203
    v_and_b32 v203, s22, v203
    v_mfma_f32_16x16x32_bf16 a[32:35], a[224:227], v[232:235], a[32:35]
    ds_read_b128 v[232:235], v253 offset:1312
    s_add_u32 s44, s41, 0
    v_add_f32 v252, v252, v248
    v_mfma_f32_16x16x32_bf16 a[60:63], a[192:195], v[236:239], 0
    buffer_load_dwordx2 v[226:227], v227, s[4:7], s21 offen offset:832
    v_add_f32 v203, v203, v195
    v_mfma_f32_16x16x32_bf16 a[64:67], a[196:199], v[236:239], 0
    v_fmac_f32 v252, s23, v250
    v_fmac_f32 v203, s23, v199
    v_cvt_pk_bf16_f32 v203, v252, v203
    v_fma_f32 v252, v249, s24, v251
    v_mfma_f32_16x16x32_bf16 a[68:71], a[200:203], v[236:239], 0
    v_fmac_f32 v251, s25, v249
    v_fma_f32 v249, v248, s24, v250
    v_fmac_f32 v250, s25, v248
    v_mfma_f32_16x16x32_bf16 a[48:51], a[204:207], v[236:239], a[48:51]
    ds_read_b128 v[148:151], v6 offset:17664
    v_fma_f32 v248, v250, s26, v251
    v_fmac_f32 v251, s27, v250
    v_fma_f32 v250, v249, s28, v252
    v_mfma_f32_16x16x32_bf16 a[52:55], a[208:211], v[236:239], a[52:55]
    s_waitcnt lgkmcnt(2)
    v_fmac_f32 v252, s29, v249
    v_fma_f32 v249, v197, s24, v201
    v_fmac_f32 v201, s25, v197
    v_mfma_f32_16x16x32_bf16 a[56:59], a[212:215], v[236:239], a[56:59]
    v_fma_f32 v197, v195, s24, v199
    v_fmac_f32 v199, s25, v195
    v_fma_f32 v195, v199, s26, v201
    v_mfma_f32_16x16x32_bf16 a[36:39], a[216:219], v[236:239], a[36:39]
    v_fmac_f32 v201, s27, v199
    v_fma_f32 v199, v197, s28, v249
    v_fmac_f32 v249, s29, v197
    v_cvt_pk_bf16_f32 v195, v248, v195
    v_mfma_f32_16x16x32_bf16 a[40:43], a[220:223], v[236:239], a[40:43]
    v_cvt_pk_bf16_f32 v201, v251, v201
    v_cvt_pk_bf16_f32 v199, v250, v199
    v_cvt_pk_bf16_f32 v197, v252, v249
    v_mfma_f32_16x16x32_bf16 a[44:47], a[224:227], v[236:239], a[44:47]
    ds_read_b128 v[236:239], v253 offset:1056
    v_lshrrev_b32 v252, 15, v255
    v_mfma_f32_16x16x32_bf16 a[72:75], a[192:195], v[228:231], 0
    ds_write_b64 v252, v[194:195] offset:9088
    s_waitcnt vmcnt(18)
    v_lshlrev_b32 v248, 16, v206
    v_mfma_f32_16x16x32_bf16 a[76:79], a[196:199], v[228:231], 0
    buffer_store_dwordx4 v[144:147], v254, s[12:15], s44 offen sc1
    v_lshlrev_b32 v249, 16, v208
    v_mfma_f32_16x16x32_bf16 a[80:83], a[200:203], v[228:231], 0
    ds_write_b64 v252, v[200:201] offset:11168
    v_lshlrev_b32 v250, 16, v210
    v_mfma_f32_16x16x32_bf16 a[60:63], a[204:207], v[228:231], a[60:63]
    ds_read_b128 v[152:155], v6 offset:18688
    v_lshlrev_b32 v251, 16, v212
    v_mfma_f32_16x16x32_bf16 a[64:67], a[208:211], v[228:231], a[64:67]
    ds_write_b64 v252, v[198:199] offset:13248
    v_and_b32 v206, s22, v206
    v_mfma_f32_16x16x32_bf16 a[68:71], a[212:215], v[228:231], a[68:71]
    s_waitcnt lgkmcnt(6)
    v_and_b32 v208, s22, v208
    v_mfma_f32_16x16x32_bf16 a[48:51], a[216:219], v[228:231], a[48:51]
    s_add_u32 s44, s41, 1024
    v_mfma_f32_16x16x32_bf16 a[52:55], a[220:223], v[228:231], a[52:55]
    ds_write_b64 v252, v[192:193] offset:15328
    v_and_b32 v210, s22, v210
    v_mfma_f32_16x16x32_bf16 a[56:59], a[224:227], v[228:231], a[56:59]
    ds_read_b128 v[228:231], v253 offset:784
    v_and_b32 v212, s22, v212
    v_mfma_f32_16x16x32_bf16 a[84:87], a[192:195], v[232:235], 0
    ds_write_b64 v252, v[202:203] offset:38208
    v_mfma_f32_16x16x32_bf16 a[88:91], a[196:199], v[232:235], 0
    v_mfma_f32_16x16x32_bf16 a[92:95], a[200:203], v[232:235], 0
    s_add_u32 s42, s32, 73728
    v_mfma_f32_16x16x32_bf16 a[72:75], a[204:207], v[232:235], a[72:75]
    buffer_load_dwordx4 a[192:195], v254, s[8:11], s42 offen offset:0 sc1
    v_mfma_f32_16x16x32_bf16 a[76:79], a[208:211], v[232:235], a[76:79]
    ds_read_b128 v[156:159], v6 offset:19744
    s_waitcnt lgkmcnt(9)
    v_mfma_f32_16x16x32_bf16 a[80:83], a[212:215], v[232:235], a[80:83]
    ds_write_b64 v252, v[196:197] offset:31968
    v_mfma_f32_16x16x32_bf16 a[60:63], a[216:219], v[232:235], a[60:63]
    buffer_load_dwordx4 a[196:199], v254, s[8:11], s42 offen offset:1024 sc1
    v_mfma_f32_16x16x32_bf16 a[64:67], a[220:223], v[232:235], a[64:67]
    v_lshlrev_b32 v252, 16, v204
    v_and_b32 v204, s22, v204
    v_mfma_f32_16x16x32_bf16 a[68:71], a[224:227], v[232:235], a[68:71]
    s_waitcnt lgkmcnt(9)
    v_add_f32 v252, v252, v251
    v_add_f32 v204, v204, v212
    v_mfma_f32_16x16x32_bf16 a[84:87], a[204:207], v[236:239], a[84:87]
    ds_read_b128 v[232:235], v253 offset:3120
    v_fmac_f32 v252, s23, v249
    v_fmac_f32 v204, s23, v208
    v_mfma_f32_16x16x32_bf16 a[88:91], a[208:211], v[236:239], a[88:91]
    s_waitcnt lgkmcnt(4)
    v_cvt_pk_bf16_f32 v204, v252, v204
    v_lshlrev_b32 v252, 16, v214
    v_mfma_f32_16x16x32_bf16 a[92:95], a[212:215], v[236:239], a[92:95]
    buffer_load_dwordx4 a[200:203], v254, s[8:11], s42 offen offset:2048 sc1
    v_mfma_f32_16x16x32_bf16 a[72:75], a[216:219], v[236:239], a[72:75]
    ds_read_b128 v[160:163], v6 offset:20768
    v_and_b32 v214, s22, v214
    v_add_f32 v252, v252, v248
    v_mfma_f32_16x16x32_bf16 a[76:79], a[220:223], v[236:239], a[76:79]
    s_add_u32 s42, s32, 76800
    v_add_f32 v214, v214, v206
    v_fmac_f32 v252, s23, v250
    v_mfma_f32_16x16x32_bf16 a[80:83], a[224:227], v[236:239], a[80:83]
    ds_read_b128 v[236:239], v253 offset:2848
    v_fmac_f32 v214, s23, v210
    v_mfma_f32_16x16x32_bf16 a[84:87], a[216:219], v[228:231], a[84:87]
    buffer_load_dwordx4 a[204:207], v254, s[8:11], s42 offen offset:0 sc1
    v_cvt_pk_bf16_f32 v214, v252, v214
    v_mfma_f32_16x16x32_bf16 a[88:91], a[220:223], v[228:231], a[88:91]
    s_waitcnt vmcnt(17) lgkmcnt(2)
    v_fma_f32 v252, v249, s24, v251
    v_fmac_f32 v251, s25, v249
    v_mfma_f32_16x16x32_bf16 a[92:95], a[224:227], v[228:231], a[92:95]
    ds_read_b128 v[228:231], v253 offset:2592
    v_fma_f32 v249, v248, s24, v250
    v_mfma_f32_16x16x32_bf16 a[96:99], a[228:231], v[232:235], 0
    s_waitcnt lgkmcnt(1)
    v_fmac_f32 v250, s25, v248
    v_fma_f32 v248, v250, s26, v251
    v_mfma_f32_16x16x32_bf16 a[100:103], a[232:235], v[232:235], 0
    buffer_load_dwordx4 a[208:211], v254, s[8:11], s42 offen offset:1024 sc1
    v_fmac_f32 v251, s27, v250
    v_mfma_f32_16x16x32_bf16 a[104:107], a[236:239], v[232:235], 0
    ds_read_b128 v[232:235], v253 offset:2336
    v_fma_f32 v250, v249, s28, v252
    v_mfma_f32_16x16x32_bf16 a[108:111], a[228:231], v[236:239], 0
    ds_read_b128 v[164:167], v6 offset:21792
    v_fmac_f32 v252, s29, v249
    v_mfma_f32_16x16x32_bf16 a[112:115], a[232:235], v[236:239], 0
    s_waitcnt vmcnt(15)
    v_fma_f32 v249, v208, s24, v212
    v_fmac_f32 v212, s25, v208
    v_fma_f32 v208, v206, s24, v210
    v_mfma_f32_16x16x32_bf16 a[116:119], a[236:239], v[236:239], 0
    buffer_load_dwordx4 a[212:215], v254, s[8:11], s42 offen offset:2048 sc1
    v_mfma_f32_16x16x32_bf16 a[96:99], a[240:243], v[236:239], a[96:99]
    s_waitcnt lgkmcnt(2)
    v_fmac_f32 v210, s25, v206
    v_fma_f32 v206, v210, s26, v212
    v_mfma_f32_16x16x32_bf16 a[100:103], a[244:247], v[236:239], a[100:103]
    s_add_u32 s42, s32, 79872
    v_fmac_f32 v212, s27, v210
    v_fma_f32 v210, v208, s28, v249
    v_fmac_f32 v249, s29, v208
    v_mfma_f32_16x16x32_bf16 a[104:107], a[248:251], v[236:239], a[104:107]
    ds_read_b128 v[236:239], v253 offset:2080
    v_cvt_pk_bf16_f32 v206, v248, v206
    v_mfma_f32_16x16x32_bf16 a[120:123], a[228:231], v[228:231], 0
    buffer_load_dwordx4 a[216:219], v254, s[8:11], s42 offen offset:0 sc1
    v_mfma_f32_16x16x32_bf16 a[124:127], a[232:235], v[228:231], 0
    v_cvt_pk_bf16_f32 v212, v251, v212
    v_cvt_pk_bf16_f32 v210, v250, v210
    v_mfma_f32_16x16x32_bf16 a[128:131], a[236:239], v[228:231], 0
    v_cvt_pk_bf16_f32 v208, v252, v249
    v_lshlrev_b32 v248, 16, v207
    v_lshlrev_b32 v249, 16, v209
    v_mfma_f32_16x16x32_bf16 a[108:111], a[240:243], v[228:231], a[108:111]
    s_waitcnt vmcnt(14)
    v_lshlrev_b32 v250, 16, v211
    v_lshlrev_b32 v251, 16, v213
    v_mfma_f32_16x16x32_bf16 a[112:115], a[244:247], v[228:231], a[112:115]
    buffer_load_dwordx4 a[220:223], v254, s[8:11], s42 offen offset:1024 sc1
    v_mfma_f32_16x16x32_bf16 a[116:119], a[248:251], v[228:231], a[116:119]
    ds_read_b128 v[168:171], v6 offset:22848
    v_and_b32 v207, s22, v207
    v_and_b32 v209, s22, v209
    v_mfma_f32_16x16x32_bf16 a[96:99], a[252:255], v[228:231], a[96:99]
    s_waitcnt lgkmcnt(3)
    v_and_b32 v211, s22, v211
    v_and_b32 v213, s22, v213
    v_mfma_f32_16x16x32_bf16 a[100:103], v[240:243], v[228:231], a[100:103]
    buffer_load_dwordx4 a[224:227], v254, s[8:11], s42 offen offset:2048 sc1
    v_mfma_f32_16x16x32_bf16 a[104:107], v[244:247], v[228:231], a[104:107]
    ds_read_b128 v[228:231], v253 offset:3904
    v_and_b32 v203, 0x7fff, v255
    v_lshlrev_b32 v252, 16, v205
    v_mfma_f32_16x16x32_bf16 a[132:135], a[228:231], v[232:235], 0
    v_and_b32 v205, s22, v205
    v_add_f32 v252, v252, v251
    v_mfma_f32_16x16x32_bf16 a[136:139], a[232:235], v[232:235], 0
    buffer_load_dwordx2 v[192:193], v203, s[4:7], s16 offen offset:1216
    v_mfma_f32_16x16x32_bf16 a[140:143], a[236:239], v[232:235], 0
    v_add_f32 v205, v205, v213
    v_fmac_f32 v252, s23, v249
    v_mfma_f32_16x16x32_bf16 a[120:123], a[240:243], v[232:235], a[120:123]
    v_fmac_f32 v205, s23, v209
    v_cvt_pk_bf16_f32 v205, v252, v205
    v_lshlrev_b32 v252, 16, v215
    v_mfma_f32_16x16x32_bf16 a[124:127], a[244:247], v[232:235], a[124:127]
    buffer_load_dwordx2 v[194:195], v203, s[4:7], s17 offen offset:1216
    v_mfma_f32_16x16x32_bf16 a[128:131], a[248:251], v[232:235], a[128:131]
    ds_read_b128 v[172:175], v6 offset:23872
    v_and_b32 v215, s22, v215
    v_mfma_f32_16x16x32_bf16 a[108:111], a[252:255], v[232:235], a[108:111]
    s_waitcnt lgkmcnt(3)
    v_add_f32 v252, v252, v248
    v_add_f32 v215, v215, v207
    v_fmac_f32 v252, s23, v250
    v_mfma_f32_16x16x32_bf16 a[112:115], v[240:243], v[232:235], a[112:115]
    buffer_load_dwordx2 v[196:197], v203, s[4:7], s18 offen offset:1216
    v_mfma_f32_16x16x32_bf16 a[116:119], v[244:247], v[232:235], a[116:119]
    ds_read_b128 v[232:235], v253 offset:3648
    v_fmac_f32 v215, s23, v211
    v_mfma_f32_16x16x32_bf16 a[144:147], a[228:231], v[236:239], 0
    v_cvt_pk_bf16_f32 v215, v252, v215
    v_fma_f32 v252, v249, s24, v251
    v_fmac_f32 v251, s25, v249
    v_mfma_f32_16x16x32_bf16 a[148:151], a[232:235], v[236:239], 0
    buffer_load_dwordx2 v[198:199], v203, s[4:7], s19 offen offset:1216
    v_mfma_f32_16x16x32_bf16 a[152:155], a[236:239], v[236:239], 0
    v_fma_f32 v249, v248, s24, v250
    v_fmac_f32 v250, s25, v248
    v_mfma_f32_16x16x32_bf16 a[132:135], a[240:243], v[236:239], a[132:135]
    v_fma_f32 v248, v250, s26, v251
    v_fmac_f32 v251, s27, v250
    v_mfma_f32_16x16x32_bf16 a[136:139], a[244:247], v[236:239], a[136:139]
    buffer_load_dwordx2 v[200:201], v203, s[4:7], s20 offen offset:1216
    v_fma_f32 v250, v249, s28, v252
    v_mfma_f32_16x16x32_bf16 a[140:143], a[248:251], v[236:239], a[140:143]
    ds_read_b128 v[176:179], v6 offset:24896
    v_fmac_f32 v252, s29, v249
    v_mfma_f32_16x16x32_bf16 a[120:123], a[252:255], v[236:239], a[120:123]
    s_waitcnt lgkmcnt(3)
    v_fma_f32 v249, v209, s24, v213
    v_fmac_f32 v213, s25, v209
    v_mfma_f32_16x16x32_bf16 a[124:127], v[240:243], v[236:239], a[124:127]
    buffer_load_dwordx2 v[202:203], v203, s[4:7], s21 offen offset:1216
    v_fma_f32 v209, v207, s24, v211
    v_mfma_f32_16x16x32_bf16 a[128:131], v[244:247], v[236:239], a[128:131]
    ds_read_b128 v[236:239], v253 offset:3392
    v_fmac_f32 v211, s25, v207
    v_mfma_f32_16x16x32_bf16 a[156:159], a[228:231], v[228:231], 0
    v_fma_f32 v207, v211, s26, v213
    v_fmac_f32 v213, s27, v211
    v_mfma_f32_16x16x32_bf16 a[160:163], a[232:235], v[228:231], 0
    buffer_store_dwordx4 v[148:151], v254, s[12:15], s44 offen sc1
    s_add_u32 s44, s41, 2048
    v_fma_f32 v211, v209, s28, v249
    v_mfma_f32_16x16x32_bf16 a[164:167], a[236:239], v[228:231], 0
    v_fmac_f32 v249, s29, v209
    v_cvt_pk_bf16_f32 v207, v248, v207
    v_mfma_f32_16x16x32_bf16 a[144:147], a[240:243], v[228:231], a[144:147]
    v_cvt_pk_bf16_f32 v213, v251, v213
    v_cvt_pk_bf16_f32 v211, v250, v211
    v_mfma_f32_16x16x32_bf16 a[148:151], a[244:247], v[228:231], a[148:151]
    ds_read_b128 v[180:183], v6 offset:25952
    v_cvt_pk_bf16_f32 v209, v252, v249
    v_mfma_f32_16x16x32_bf16 a[152:155], a[248:251], v[228:231], a[152:155]
    buffer_store_dwordx4 v[152:155], v254, s[12:15], s44 offen sc1
    s_add_u32 s44, s41, 3072
    v_lshrrev_b32 v252, 15, v255
    v_mfma_f32_16x16x32_bf16 a[132:135], a[252:255], v[228:231], a[132:135]
    ds_write_b64 v252, v[206:207] offset:8832
    v_mfma_f32_16x16x32_bf16 a[136:139], v[240:243], v[228:231], a[136:139]
    s_waitcnt vmcnt(18) lgkmcnt(4)
    v_lshlrev_b32 v248, 16, v218
    v_lshlrev_b32 v249, 16, v220
    v_mfma_f32_16x16x32_bf16 a[140:143], v[244:247], v[228:231], a[140:143]
    ds_read_b128 v[228:231], v253 offset:3136
    v_mfma_f32_16x16x32_bf16 a[168:171], a[228:231], v[232:235], 0
    buffer_store_dwordx4 v[156:159], v254, s[12:15], s44 offen sc1
    s_add_u32 s44, s41, 4096
    v_mfma_f32_16x16x32_bf16 a[172:175], a[232:235], v[232:235], 0
    ds_write_b64 v252, v[212:213] offset:10912
    v_mfma_f32_16x16x32_bf16 a[176:179], a[236:239], v[232:235], 0
    v_lshlrev_b32 v250, 16, v222
    v_lshlrev_b32 v251, 16, v224
    v_mfma_f32_16x16x32_bf16 a[156:159], a[240:243], v[232:235], a[156:159]
    buffer_store_dwordx4 v[160:163], v254, s[12:15], s44 offen sc1
    s_add_u32 s44, s41, 5120
    v_mfma_f32_16x16x32_bf16 a[160:163], a[244:247], v[232:235], a[160:163]
    ds_read_b128 v[184:187], v6 offset:26976
    v_mfma_f32_16x16x32_bf16 a[164:167], a[248:251], v[232:235], a[164:167]
    ds_write_b64 v252, v[210:211] offset:12992
    v_mfma_f32_16x16x32_bf16 a[144:147], a[252:255], v[232:235], a[144:147]
    s_waitcnt lgkmcnt(6)
    v_and_b32 v218, s22, v218
    v_and_b32 v220, s22, v220
    v_mfma_f32_16x16x32_bf16 a[148:151], v[240:243], v[232:235], a[148:151]
    ds_write_b64 v252, v[204:205] offset:15072
    v_mfma_f32_16x16x32_bf16 a[152:155], v[244:247], v[232:235], a[152:155]
    ds_read_b128 v[232:235], v253 offset:2864
    v_and_b32 v222, s22, v222
    v_mfma_f32_16x16x32_bf16 a[180:183], a[228:231], v[236:239], 0
    v_and_b32 v224, s22, v224
    v_mfma_f32_16x16x32_bf16 a[184:187], a[232:235], v[236:239], 0
    ds_write_b64 v252, v[214:215] offset:37952
    v_mfma_f32_16x16x32_bf16 a[188:191], a[236:239], v[236:239], 0
    s_add_u32 s42, s32, 110592
    v_mfma_f32_16x16x32_bf16 a[168:171], a[240:243], v[236:239], a[168:171]
    buffer_load_dwordx4 a[228:231], v254, s[8:11], s42 offen offset:0 sc1
    v_mfma_f32_16x16x32_bf16 a[172:175], a[244:247], v[236:239], a[172:175]
    ds_read_b128 v[188:191], v6 offset:28000
    v_mfma_f32_16x16x32_bf16 a[176:179], a[248:251], v[236:239], a[176:179]
    ds_write_b64 v252, v[208:209] offset:31712
    v_mfma_f32_16x16x32_bf16 a[156:159], a[252:255], v[236:239], a[156:159]
    buffer_load_dwordx4 a[232:235], v254, s[8:11], s42 offen offset:1024 sc1
    v_mfma_f32_16x16x32_bf16 a[160:163], v[240:243], v[236:239], a[160:163]
    v_lshlrev_b32 v252, 16, v216
    v_and_b32 v216, s22, v216
    v_add_f32 v252, v252, v251
    v_mfma_f32_16x16x32_bf16 a[164:167], v[244:247], v[236:239], a[164:167]
    s_waitcnt lgkmcnt(3)
    v_add_f32 v216, v216, v224
    v_fmac_f32 v252, s23, v249
    v_mfma_f32_16x16x32_bf16 a[180:183], a[240:243], v[228:231], a[180:183]
    ds_read_b128 v[236:239], v253 offset:5200
    v_fmac_f32 v216, s23, v220
    v_mfma_f32_16x16x32_bf16 a[184:187], a[244:247], v[228:231], a[184:187]
    ds_read_b128 v[204:207], v253 offset:39712
    v_cvt_pk_bf16_f32 v216, v252, v216
    v_lshlrev_b32 v252, 16, v226
    v_mfma_f32_16x16x32_bf16 a[188:191], a[248:251], v[228:231], a[188:191]
    buffer_load_dwordx4 a[236:239], v254, s[8:11], s42 offen offset:2048 sc1
    v_mfma_f32_16x16x32_bf16 a[168:171], a[252:255], v[228:231], a[168:171]
    s_mov_b32 s45, 619910279
    v_and_b32 v226, s22, v226
    v_add_f32 v252, v252, v248
    v_mfma_f32_16x16x32_bf16 a[172:175], v[240:243], v[228:231], a[172:175]
    s_add_u32 s42, s32, 113664
    v_add_f32 v226, v226, v218
    v_fmac_f32 v252, s23, v250
    v_fmac_f32 v226, s23, v222
    v_mfma_f32_16x16x32_bf16 a[176:179], v[244:247], v[228:231], a[176:179]
    ds_read_b128 v[228:231], v253 offset:4928
    v_bfe_u32 v208, v254, 5, 3
    v_mfma_f32_16x16x32_bf16 a[180:183], a[252:255], v[232:235], a[180:183]
    buffer_load_dwordx4 a[240:243], v254, s[8:11], s42 offen offset:0 sc1
    v_mfma_f32_16x16x32_bf16 a[184:187], v[240:243], v[232:235], a[184:187]
    s_waitcnt vmcnt(20) lgkmcnt(2)
    v_cvt_pk_bf16_f32 v226, v252, v226
    v_fma_f32 v252, v249, s24, v251
    v_mfma_f32_16x16x32_bf16 a[188:191], v[244:247], v[232:235], a[188:191]
    ds_read_b128 v[232:235], v253 offset:4672
    v_mul_u32_u24 v209, 5, v208
    v_fmac_f32 v251, s25, v249
    v_mfma_f32_16x16x32_bf16 v[0:3], a[192:195], v[236:239], 0
    s_waitcnt lgkmcnt(1)
    v_fma_f32 v249, v248, s24, v250
    v_fmac_f32 v250, s25, v248
    v_mfma_f32_16x16x32_bf16 v[4:7], a[196:199], v[236:239], 0
    buffer_load_dwordx4 a[244:247], v254, s[8:11], s42 offen offset:1024 sc1
    v_mfma_f32_16x16x32_bf16 v[8:11], a[200:203], v[236:239], 0
    ds_read_b128 v[236:239], v253 offset:4416
    v_bfe_u32 v209, s45, v209, 5
    v_fma_f32 v248, v250, s26, v251
    v_mfma_f32_16x16x32_bf16 v[12:15], a[192:195], v[228:231], 0
    v_fmac_f32 v251, s27, v250
    v_fma_f32 v250, v249, s28, v252
    v_mfma_f32_16x16x32_bf16 v[16:19], a[196:199], v[228:231], 0
    s_waitcnt vmcnt(18)
    v_mul_u32_u24 v209, 65, v209
    v_fmac_f32 v252, s29, v249
    v_mfma_f32_16x16x32_bf16 v[20:23], a[200:203], v[228:231], 0
    buffer_load_dwordx4 a[248:251], v254, s[8:11], s42 offen offset:2048 sc1
    v_fma_f32 v249, v220, s24, v224
    v_mfma_f32_16x16x32_bf16 v[0:3], a[204:207], v[228:231], v[0:3]
    s_waitcnt lgkmcnt(1)
    v_sub_u32 v209, v209, v208
    v_fmac_f32 v224, s25, v220
    v_mfma_f32_16x16x32_bf16 v[4:7], a[208:211], v[228:231], v[4:7]
    s_add_u32 s42, s32, 116736
    v_fma_f32 v220, v218, s24, v222
    v_fmac_f32 v222, s25, v218
    v_mfma_f32_16x16x32_bf16 v[8:11], a[212:215], v[228:231], v[8:11]
    ds_read_b128 v[228:231], v253 offset:4160
    v_lshl_add_u32 v208, v209, 5, v253
    v_mfma_f32_16x16x32_bf16 v[24:27], a[192:195], v[232:235], 0
    buffer_load_dwordx4 a[252:255], v254, s[8:11], s42 offen offset:0 sc1
    v_fma_f32 v218, v222, s26, v224
    v_mfma_f32_16x16x32_bf16 v[28:31], a[196:199], v[232:235], 0
    v_fmac_f32 v224, s27, v222
    v_fma_f32 v222, v220, s28, v249
    v_mfma_f32_16x16x32_bf16 v[32:35], a[200:203], v[232:235], 0
    v_fmac_f32 v249, s29, v220
    v_cvt_pk_bf16_f32 v218, v248, v218
    v_mfma_f32_16x16x32_bf16 v[12:15], a[204:207], v[232:235], v[12:15]
    s_waitcnt vmcnt(17)
    v_cvt_pk_bf16_f32 v224, v251, v224
    v_cvt_pk_bf16_f32 v222, v250, v222
    v_cvt_pk_bf16_f32 v220, v252, v249
    v_mfma_f32_16x16x32_bf16 v[16:19], a[208:211], v[232:235], v[16:19]
    buffer_load_dwordx4 v[240:243], v254, s[8:11], s42 offen offset:1024 sc1
    v_mfma_f32_16x16x32_bf16 v[20:23], a[212:215], v[232:235], v[20:23]
    s_mov_b64 exec, s[46:47]
    ds_write_b128 v208, v[204:207] offset:1024
    s_mov_b64 exec, -1
    v_mfma_f32_16x16x32_bf16 v[0:3], a[216:219], v[232:235], v[0:3]
    s_waitcnt lgkmcnt(2)
    v_lshlrev_b32 v248, 16, v219
    v_lshlrev_b32 v249, 16, v221
    v_lshlrev_b32 v250, 16, v223
    v_mfma_f32_16x16x32_bf16 v[4:7], a[220:223], v[232:235], v[4:7]
    buffer_load_dwordx4 v[244:247], v254, s[8:11], s42 offen offset:2048 sc1
    v_mfma_f32_16x16x32_bf16 v[8:11], a[224:227], v[232:235], v[8:11]
    ds_read_b128 v[232:235], v253 offset:5984
    v_and_b32 v215, 0x7fff, v255
    v_mfma_f32_16x16x32_bf16 v[36:39], a[192:195], v[236:239], 0
    v_lshlrev_b32 v251, 16, v225
    v_and_b32 v219, s22, v219
    v_mfma_f32_16x16x32_bf16 v[40:43], a[196:199], v[236:239], 0
    buffer_load_dwordx2 v[204:205], v215, s[4:7], s16 offen offset:128
    v_and_b32 v221, s22, v221
    v_mfma_f32_16x16x32_bf16 v[44:47], a[200:203], v[236:239], 0
    v_and_b32 v223, s22, v223
    v_and_b32 v225, s22, v225
    v_mfma_f32_16x16x32_bf16 v[24:27], a[204:207], v[236:239], v[24:27]
    v_lshlrev_b32 v252, 16, v217
    v_and_b32 v217, s22, v217
    v_mfma_f32_16x16x32_bf16 v[28:31], a[208:211], v[236:239], v[28:31]
    buffer_load_dwordx2 v[206:207], v215, s[4:7], s17 offen offset:128
    v_add_f32 v252, v252, v251
    v_mfma_f32_16x16x32_bf16 v[32:35], a[212:215], v[236:239], v[32:35]
    v_add_f32 v217, v217, v225
    v_fmac_f32 v252, s23, v249
    v_mfma_f32_16x16x32_bf16 v[12:15], a[216:219], v[236:239], v[12:15]
    s_waitcnt lgkmcnt(2)
    v_fmac_f32 v217, s23, v221
    v_cvt_pk_bf16_f32 v217, v252, v217
    v_mfma_f32_16x16x32_bf16 v[16:19], a[220:223], v[236:239], v[16:19]
    buffer_load_dwordx2 v[208:209], v215, s[4:7], s18 offen offset:128
    v_lshlrev_b32 v252, 16, v227
    v_mfma_f32_16x16x32_bf16 v[20:23], a[224:227], v[236:239], v[20:23]
    ds_read_b128 v[236:239], v253 offset:5728
    v_and_b32 v227, s22, v227
    v_mfma_f32_16x16x32_bf16 v[48:51], a[192:195], v[228:231], 0
    v_add_f32 v252, v252, v248
    v_add_f32 v227, v227, v219
    v_mfma_f32_16x16x32_bf16 v[52:55], a[196:199], v[228:231], 0
    buffer_load_dwordx2 v[210:211], v215, s[4:7], s19 offen offset:128
    v_mfma_f32_16x16x32_bf16 v[56:59], a[200:203], v[228:231], 0
    v_fmac_f32 v252, s23, v250
    v_fmac_f32 v227, s23, v223
    v_cvt_pk_bf16_f32 v227, v252, v227
    v_mfma_f32_16x16x32_bf16 v[36:39], a[204:207], v[228:231], v[36:39]
    v_fma_f32 v252, v249, s24, v251
    v_fmac_f32 v251, s25, v249
    v_mfma_f32_16x16x32_bf16 v[40:43], a[208:211], v[228:231], v[40:43]
    buffer_load_dwordx2 v[212:213], v215, s[4:7], s20 offen offset:128
    v_mfma_f32_16x16x32_bf16 v[44:47], a[212:215], v[228:231], v[44:47]
    v_fma_f32 v249, v248, s24, v250
    v_fmac_f32 v250, s25, v248
    v_fma_f32 v248, v250, s26, v251
    v_mfma_f32_16x16x32_bf16 v[24:27], a[216:219], v[228:231], v[24:27]
    s_waitcnt lgkmcnt(1)
    v_fmac_f32 v251, s27, v250
    v_fma_f32 v250, v249, s28, v252
    v_mfma_f32_16x16x32_bf16 v[28:31], a[220:223], v[228:231], v[28:31]
    buffer_load_dwordx2 v[214:215], v215, s[4:7], s21 offen offset:128
    v_mfma_f32_16x16x32_bf16 v[32:35], a[224:227], v[228:231], v[32:35]
    ds_read_b128 v[228:231], v253 offset:5472
    v_fmac_f32 v252, s29, v249
    v_fma_f32 v249, v221, s24, v225
    v_mfma_f32_16x16x32_bf16 v[60:63], a[192:195], v[232:235], 0
    v_fmac_f32 v225, s25, v221
    v_fma_f32 v221, v219, s24, v223
    v_mfma_f32_16x16x32_bf16 v[64:67], a[196:199], v[232:235], 0
    buffer_store_dwordx4 v[164:167], v254, s[12:15], s44 offen sc1
    s_add_u32 s44, s41, 6144
    v_mfma_f32_16x16x32_bf16 v[68:71], a[200:203], v[232:235], 0
    v_fmac_f32 v223, s25, v219
    v_fma_f32 v219, v223, s26, v225
    v_mfma_f32_16x16x32_bf16 v[48:51], a[204:207], v[232:235], v[48:51]
    v_fmac_f32 v225, s27, v223
    v_fma_f32 v223, v221, s28, v249
    v_fmac_f32 v249, s29, v221
    v_mfma_f32_16x16x32_bf16 v[52:55], a[208:211], v[232:235], v[52:55]
    buffer_store_dwordx4 v[168:171], v254, s[12:15], s44 offen sc1
    s_add_u32 s44, s41, 7168
    v_mfma_f32_16x16x32_bf16 v[56:59], a[212:215], v[232:235], v[56:59]
    v_cvt_pk_bf16_f32 v219, v248, v219
    v_cvt_pk_bf16_f32 v225, v251, v225
    v_mfma_f32_16x16x32_bf16 v[36:39], a[216:219], v[232:235], v[36:39]
    s_waitcnt lgkmcnt(1)
    v_cvt_pk_bf16_f32 v223, v250, v223
    v_cvt_pk_bf16_f32 v221, v252, v249
    v_lshrrev_b32 v252, 15, v255
    v_mfma_f32_16x16x32_bf16 v[40:43], a[220:223], v[232:235], v[40:43]
    buffer_store_dwordx4 v[172:175], v254, s[12:15], s44 offen sc1
    s_add_u32 s44, s41, 8192
    v_mfma_f32_16x16x32_bf16 v[44:47], a[224:227], v[232:235], v[44:47]
    ds_read_b128 v[232:235], v253 offset:5216
    v_mfma_f32_16x16x32_bf16 v[72:75], a[192:195], v[236:239], 0
    ds_write_b64 v252, v[218:219] offset:8576
    s_waitcnt vmcnt(22)
    v_mfma_f32_16x16x32_bf16 v[76:79], a[196:199], v[236:239], 0
    buffer_store_dwordx4 v[176:179], v254, s[12:15], s44 offen sc1
    s_add_u32 s44, s41, 9216
    v_mfma_f32_16x16x32_bf16 v[80:83], a[200:203], v[236:239], 0
    v_lshlrev_b32 v248, 16, v194
    v_lshlrev_b32 v249, 16, v196
    v_mfma_f32_16x16x32_bf16 v[60:63], a[204:207], v[236:239], v[60:63]
    ds_write_b64 v252, v[224:225] offset:10656
    v_mfma_f32_16x16x32_bf16 v[64:67], a[208:211], v[236:239], v[64:67]
    s_waitcnt lgkmcnt(3)
    v_lshlrev_b32 v250, 16, v198
    v_lshlrev_b32 v251, 16, v200
    v_mfma_f32_16x16x32_bf16 v[68:71], a[212:215], v[236:239], v[68:71]
    ds_write_b64 v252, v[222:223] offset:12736
    v_mfma_f32_16x16x32_bf16 v[48:51], a[216:219], v[236:239], v[48:51]
    buffer_store_dwordx4 v[180:183], v254, s[12:15], s44 offen sc1
    v_and_b32 v194, s22, v194
    v_and_b32 v196, s22, v196
    v_mfma_f32_16x16x32_bf16 v[52:55], a[220:223], v[236:239], v[52:55]
    ds_write_b64 v252, v[216:217] offset:14816
    v_and_b32 v198, s22, v198
    v_mfma_f32_16x16x32_bf16 v[56:59], a[224:227], v[236:239], v[56:59]
    ds_read_b128 v[236:239], v253 offset:4944
    v_and_b32 v200, s22, v200
    v_mfma_f32_16x16x32_bf16 v[84:87], a[192:195], v[228:231], 0
    ds_write_b64 v252, v[226:227] offset:37696
    v_mfma_f32_16x16x32_bf16 v[88:91], a[196:199], v[228:231], 0
    v_mfma_f32_16x16x32_bf16 v[92:95], a[200:203], v[228:231], 0
    s_add_u32 s42, s32, 147456
    s_add_u32 s44, s41, 10240
    v_mfma_f32_16x16x32_bf16 v[72:75], a[204:207], v[228:231], v[72:75]
    buffer_load_dwordx4 a[192:195], v254, s[8:11], s42 offen offset:0 sc1
    v_mfma_f32_16x16x32_bf16 v[76:79], a[208:211], v[228:231], v[76:79]
    ds_write_b64 v252, v[220:221] offset:31456
    v_mfma_f32_16x16x32_bf16 v[80:83], a[212:215], v[228:231], v[80:83]
    v_mfma_f32_16x16x32_bf16 v[60:63], a[216:219], v[228:231], v[60:63]
    buffer_load_dwordx4 a[196:199], v254, s[8:11], s42 offen offset:1024 sc1
    v_mfma_f32_16x16x32_bf16 v[64:67], a[220:223], v[228:231], v[64:67]
    v_lshlrev_b32 v252, 16, v192
    v_and_b32 v192, s22, v192
    v_mfma_f32_16x16x32_bf16 v[68:71], a[224:227], v[228:231], v[68:71]
    s_waitcnt lgkmcnt(7)
    v_add_f32 v252, v252, v251
    v_add_f32 v192, v192, v200
    v_mfma_f32_16x16x32_bf16 v[84:87], a[204:207], v[232:235], v[84:87]
    ds_read_b128 v[228:231], v253 offset:7280
    v_fmac_f32 v252, s23, v249
    v_mfma_f32_16x16x32_bf16 v[88:91], a[208:211], v[232:235], v[88:91]
    v_fmac_f32 v192, s23, v196
    v_cvt_pk_bf16_f32 v192, v252, v192
    v_mfma_f32_16x16x32_bf16 v[92:95], a[212:215], v[232:235], v[92:95]
    buffer_load_dwordx4 a[200:203], v254, s[8:11], s42 offen offset:2048 sc1
    v_mfma_f32_16x16x32_bf16 v[72:75], a[216:219], v[232:235], v[72:75]
    s_waitcnt lgkmcnt(3)
    v_lshlrev_b32 v252, 16, v202
    v_and_b32 v202, s22, v202
    v_mfma_f32_16x16x32_bf16 v[76:79], a[220:223], v[232:235], v[76:79]
    s_add_u32 s42, s32, 150528
    v_add_f32 v252, v252, v248
    v_add_f32 v202, v202, v194
    v_mfma_f32_16x16x32_bf16 v[80:83], a[224:227], v[232:235], v[80:83]
    ds_read_b128 v[232:235], v253 offset:7008
    v_fmac_f32 v252, s23, v250
    v_mfma_f32_16x16x32_bf16 v[84:87], a[216:219], v[236:239], v[84:87]
    buffer_load_dwordx4 a[204:207], v254, s[8:11], s42 offen offset:0 sc1
    v_mfma_f32_16x16x32_bf16 v[88:91], a[220:223], v[236:239], v[88:91]
    s_waitcnt vmcnt(21) lgkmcnt(1)
    v_fmac_f32 v202, s23, v198
    v_cvt_pk_bf16_f32 v202, v252, v202
    v_mfma_f32_16x16x32_bf16 v[92:95], a[224:227], v[236:239], v[92:95]
    ds_read_b128 v[236:239], v253 offset:6752
    v_fma_f32 v252, v249, s24, v251
    v_mfma_f32_16x16x32_bf16 v[96:99], a[228:231], v[228:231], 0
    s_waitcnt lgkmcnt(1)
    v_fmac_f32 v251, s25, v249
    v_fma_f32 v249, v248, s24, v250
    v_mfma_f32_16x16x32_bf16 v[100:103], a[232:235], v[228:231], 0
    buffer_load_dwordx4 a[208:211], v254, s[8:11], s42 offen offset:1024 sc1
    v_mfma_f32_16x16x32_bf16 v[104:107], a[236:239], v[228:231], 0
    ds_read_b128 v[228:231], v253 offset:6496
    v_fmac_f32 v250, s25, v248
    v_mfma_f32_16x16x32_bf16 v[108:111], a[228:231], v[232:235], 0
    v_fma_f32 v248, v250, s26, v251
    v_fmac_f32 v251, s27, v250
    v_fma_f32 v250, v249, s28, v252
    v_mfma_f32_16x16x32_bf16 v[112:115], a[232:235], v[232:235], 0
    s_waitcnt vmcnt(19)
    v_fmac_f32 v252, s29, v249
    v_fma_f32 v249, v196, s24, v200
    v_mfma_f32_16x16x32_bf16 v[116:119], a[236:239], v[232:235], 0
    buffer_load_dwordx4 a[212:215], v254, s[8:11], s42 offen offset:2048 sc1
    v_mfma_f32_16x16x32_bf16 v[96:99], a[240:243], v[232:235], v[96:99]
    s_waitcnt lgkmcnt(1)
    v_fmac_f32 v200, s25, v196
    v_fma_f32 v196, v194, s24, v198
    v_mfma_f32_16x16x32_bf16 v[100:103], a[244:247], v[232:235], v[100:103]
    s_add_u32 s42, s32, 153600
    v_fmac_f32 v198, s25, v194
    v_fma_f32 v194, v198, s26, v200
    v_mfma_f32_16x16x32_bf16 v[104:107], a[248:251], v[232:235], v[104:107]
    ds_read_b128 v[232:235], v253 offset:6240
    v_fmac_f32 v200, s27, v198
    v_mfma_f32_16x16x32_bf16 v[120:123], a[228:231], v[236:239], 0
    buffer_load_dwordx4 a[216:219], v254, s[8:11], s42 offen offset:0 sc1
    v_mfma_f32_16x16x32_bf16 v[124:127], a[232:235], v[236:239], 0
    v_fma_f32 v198, v196, s28, v249
    v_fmac_f32 v249, s29, v196
    v_mfma_f32_16x16x32_bf16 v[128:131], a[236:239], v[236:239], 0
    v_cvt_pk_bf16_f32 v194, v248, v194
    v_cvt_pk_bf16_f32 v200, v251, v200
    v_mfma_f32_16x16x32_bf16 v[108:111], a[240:243], v[236:239], v[108:111]
    v_cvt_pk_bf16_f32 v198, v250, v198
    v_cvt_pk_bf16_f32 v196, v252, v249
    v_mfma_f32_16x16x32_bf16 v[112:115], a[244:247], v[236:239], v[112:115]
    buffer_load_dwordx4 a[220:223], v254, s[8:11], s42 offen offset:1024 sc1
    v_mfma_f32_16x16x32_bf16 v[116:119], a[248:251], v[236:239], v[116:119]
    s_waitcnt vmcnt(19)
    v_lshlrev_b32 v248, 16, v195
    v_lshlrev_b32 v249, 16, v197
    v_mfma_f32_16x16x32_bf16 v[96:99], a[252:255], v[236:239], v[96:99]
    s_waitcnt lgkmcnt(1)
    v_lshlrev_b32 v250, 16, v199
    v_lshlrev_b32 v251, 16, v201
    v_mfma_f32_16x16x32_bf16 v[100:103], v[240:243], v[236:239], v[100:103]
    buffer_load_dwordx4 a[224:227], v254, s[8:11], s42 offen offset:2048 sc1
    v_mfma_f32_16x16x32_bf16 v[104:107], v[244:247], v[236:239], v[104:107]
    ds_read_b128 v[236:239], v253 offset:8064
    v_and_b32 v227, 0x7fff, v255
    v_mfma_f32_16x16x32_bf16 v[132:135], a[228:231], v[228:231], 0
    v_and_b32 v195, s22, v195
    v_and_b32 v197, s22, v197
    v_mfma_f32_16x16x32_bf16 v[136:139], a[232:235], v[228:231], 0
    buffer_load_dwordx2 v[216:217], v227, s[4:7], s16 offen offset:512
    v_mfma_f32_16x16x32_bf16 v[140:143], a[236:239], v[228:231], 0
    v_and_b32 v199, s22, v199
    v_and_b32 v201, s22, v201
    v_mfma_f32_16x16x32_bf16 v[120:123], a[240:243], v[228:231], v[120:123]
    v_lshlrev_b32 v252, 16, v193
    v_and_b32 v193, s22, v193
    v_mfma_f32_16x16x32_bf16 v[124:127], a[244:247], v[228:231], v[124:127]
    buffer_load_dwordx2 v[218:219], v227, s[4:7], s17 offen offset:512
    v_mfma_f32_16x16x32_bf16 v[128:131], a[248:251], v[228:231], v[128:131]
    v_add_f32 v252, v252, v251
    v_add_f32 v193, v193, v201
    v_fmac_f32 v252, s23, v249
    v_mfma_f32_16x16x32_bf16 v[108:111], a[252:255], v[228:231], v[108:111]
    s_waitcnt lgkmcnt(1)
    v_fmac_f32 v193, s23, v197
    v_cvt_pk_bf16_f32 v193, v252, v193
    v_mfma_f32_16x16x32_bf16 v[112:115], v[240:243], v[228:231], v[112:115]
    buffer_load_dwordx2 v[220:221], v227, s[4:7], s18 offen offset:512
    v_mfma_f32_16x16x32_bf16 v[116:119], v[244:247], v[228:231], v[116:119]
    ds_read_b128 v[228:231], v253 offset:7808
    v_lshlrev_b32 v252, 16, v203
    v_mfma_f32_16x16x32_bf16 v[144:147], a[228:231], v[232:235], 0
    v_and_b32 v203, s22, v203
    v_add_f32 v252, v252, v248
    v_mfma_f32_16x16x32_bf16 v[148:151], a[232:235], v[232:235], 0
    buffer_load_dwordx2 v[222:223], v227, s[4:7], s19 offen offset:512
    v_mfma_f32_16x16x32_bf16 v[152:155], a[236:239], v[232:235], 0
    v_add_f32 v203, v203, v195
    v_fmac_f32 v252, s23, v250
    v_mfma_f32_16x16x32_bf16 v[132:135], a[240:243], v[232:235], v[132:135]
    v_fmac_f32 v203, s23, v199
    v_cvt_pk_bf16_f32 v203, v252, v203
    v_mfma_f32_16x16x32_bf16 v[136:139], a[244:247], v[232:235], v[136:139]
    buffer_load_dwordx2 v[224:225], v227, s[4:7], s20 offen offset:512
    v_mfma_f32_16x16x32_bf16 v[140:143], a[248:251], v[232:235], v[140:143]
    v_fma_f32 v252, v249, s24, v251
    v_fmac_f32 v251, s25, v249
    v_mfma_f32_16x16x32_bf16 v[120:123], a[252:255], v[232:235], v[120:123]
    s_waitcnt lgkmcnt(1)
    v_fma_f32 v249, v248, s24, v250
    v_fmac_f32 v250, s25, v248
    v_mfma_f32_16x16x32_bf16 v[124:127], v[240:243], v[232:235], v[124:127]
    buffer_load_dwordx2 v[226:227], v227, s[4:7], s21 offen offset:512
    v_mfma_f32_16x16x32_bf16 v[128:131], v[244:247], v[232:235], v[128:131]
    ds_read_b128 v[232:235], v253 offset:7552
    v_fma_f32 v248, v250, s26, v251
    v_mfma_f32_16x16x32_bf16 v[156:159], a[228:231], v[236:239], 0
    v_fmac_f32 v251, s27, v250
    v_fma_f32 v250, v249, s28, v252
    v_mfma_f32_16x16x32_bf16 v[160:163], a[232:235], v[236:239], 0
    buffer_store_dwordx4 v[184:187], v254, s[12:15], s44 offen sc1
    s_add_u32 s44, s41, 11264
    v_mfma_f32_16x16x32_bf16 v[164:167], a[236:239], v[236:239], 0
    v_fmac_f32 v252, s29, v249
    v_fma_f32 v249, v197, s24, v201
    v_mfma_f32_16x16x32_bf16 v[144:147], a[240:243], v[236:239], v[144:147]
    v_fmac_f32 v201, s25, v197
    v_fma_f32 v197, v195, s24, v199
    v_mfma_f32_16x16x32_bf16 v[148:151], a[244:247], v[236:239], v[148:151]
    buffer_store_dwordx4 v[188:191], v254, s[12:15], s44 offen sc1
    v_fmac_f32 v199, s25, v195
    v_fma_f32 v195, v199, s26, v201
    v_mfma_f32_16x16x32_bf16 v[152:155], a[248:251], v[236:239], v[152:155]
    v_fmac_f32 v201, s27, v199
    v_fma_f32 v199, v197, s28, v249
    v_mfma_f32_16x16x32_bf16 v[132:135], a[252:255], v[236:239], v[132:135]
    v_fmac_f32 v249, s29, v197
    v_cvt_pk_bf16_f32 v195, v248, v195
    v_mfma_f32_16x16x32_bf16 v[136:139], v[240:243], v[236:239], v[136:139]
    s_waitcnt lgkmcnt(1)
    v_cvt_pk_bf16_f32 v201, v251, v201
    v_cvt_pk_bf16_f32 v199, v250, v199
    v_cvt_pk_bf16_f32 v197, v252, v249
    v_mfma_f32_16x16x32_bf16 v[140:143], v[244:247], v[236:239], v[140:143]
    ds_read_b128 v[236:239], v253 offset:7296
    v_lshrrev_b32 v252, 15, v255
    v_mfma_f32_16x16x32_bf16 v[168:171], a[228:231], v[228:231], 0
    ds_write_b64 v252, v[194:195] offset:8320
    v_mfma_f32_16x16x32_bf16 v[172:175], a[232:235], v[228:231], 0
    s_waitcnt vmcnt(22)
    v_lshlrev_b32 v248, 16, v206
    v_lshlrev_b32 v249, 16, v208
    v_mfma_f32_16x16x32_bf16 v[176:179], a[236:239], v[228:231], 0
    ds_write_b64 v252, v[200:201] offset:10400
    v_mfma_f32_16x16x32_bf16 v[156:159], a[240:243], v[228:231], v[156:159]
    v_lshlrev_b32 v250, 16, v210
    v_lshlrev_b32 v251, 16, v212
    v_mfma_f32_16x16x32_bf16 v[160:163], a[244:247], v[228:231], v[160:163]
    ds_write_b64 v252, v[198:199] offset:12480
    v_mfma_f32_16x16x32_bf16 v[164:167], a[248:251], v[228:231], v[164:167]
    v_and_b32 v206, s22, v206
    v_and_b32 v208, s22, v208
    v_mfma_f32_16x16x32_bf16 v[144:147], a[252:255], v[228:231], v[144:147]
    ds_write_b64 v252, v[192:193] offset:14560
    v_mfma_f32_16x16x32_bf16 v[148:151], v[240:243], v[228:231], v[148:151]
    s_waitcnt lgkmcnt(5)
    v_and_b32 v210, s22, v210
    v_and_b32 v212, s22, v212
    v_mfma_f32_16x16x32_bf16 v[152:155], v[244:247], v[228:231], v[152:155]
    ds_read_b128 v[228:231], v253 offset:7024
    v_mfma_f32_16x16x32_bf16 v[180:183], a[228:231], v[232:235], 0
    ds_write_b64 v252, v[202:203] offset:37440
    v_mfma_f32_16x16x32_bf16 v[184:187], a[232:235], v[232:235], 0
    v_mfma_f32_16x16x32_bf16 v[188:191], a[236:239], v[232:235], 0
    s_add_u32 s42, s32, 184320
    v_mfma_f32_16x16x32_bf16 v[168:171], a[240:243], v[232:235], v[168:171]
    buffer_load_dwordx4 a[228:231], v254, s[8:11], s42 offen offset:0 sc1
    v_mfma_f32_16x16x32_bf16 v[172:175], a[244:247], v[232:235], v[172:175]
    ds_write_b64 v252, v[196:197] offset:31200
    v_mfma_f32_16x16x32_bf16 v[176:179], a[248:251], v[232:235], v[176:179]
    s_waitcnt lgkmcnt(7)
    v_mfma_f32_16x16x32_bf16 v[156:159], a[252:255], v[232:235], v[156:159]
    buffer_load_dwordx4 a[232:235], v254, s[8:11], s42 offen offset:1024 sc1
    v_mfma_f32_16x16x32_bf16 v[160:163], v[240:243], v[232:235], v[160:163]
    s_waitcnt lgkmcnt(0)
    v_lshlrev_b32 v252, 16, v204
    v_and_b32 v204, s22, v204
    v_mfma_f32_16x16x32_bf16 v[164:167], v[244:247], v[232:235], v[164:167]
    s_barrier
    v_mfma_f32_16x16x32_bf16 v[180:183], a[240:243], v[236:239], v[180:183]
    ds_read_b128 v[232:235], v253 offset:9360
    v_add_f32 v252, v252, v251
    v_add_f32 v204, v204, v212
    v_mfma_f32_16x16x32_bf16 v[184:187], a[244:247], v[236:239], v[184:187]
    v_fmac_f32 v252, s23, v249
    v_fmac_f32 v204, s23, v208
    v_mfma_f32_16x16x32_bf16 v[188:191], a[248:251], v[236:239], v[188:191]
    buffer_load_dwordx4 a[236:239], v254, s[8:11], s42 offen offset:2048 sc1
    v_mfma_f32_16x16x32_bf16 v[168:171], a[252:255], v[236:239], v[168:171]
    v_cvt_pk_bf16_f32 v204, v252, v204
    v_lshlrev_b32 v252, 16, v214
    v_mfma_f32_16x16x32_bf16 v[172:175], v[240:243], v[236:239], v[172:175]
    s_add_u32 s42, s32, 187392
    v_and_b32 v214, s22, v214
    v_add_f32 v252, v252, v248
    v_mfma_f32_16x16x32_bf16 v[176:179], v[244:247], v[236:239], v[176:179]
    ds_read_b128 v[236:239], v253 offset:9088
    v_add_f32 v214, v214, v206
    v_mfma_f32_16x16x32_bf16 v[180:183], a[252:255], v[228:231], v[180:183]
    buffer_load_dwordx4 a[240:243], v254, s[8:11], s42 offen offset:0 sc1
    v_mfma_f32_16x16x32_bf16 v[184:187], v[240:243], v[228:231], v[184:187]
    s_waitcnt vmcnt(18) lgkmcnt(1)
    v_fmac_f32 v252, s23, v250
    v_fmac_f32 v214, s23, v210
    v_mfma_f32_16x16x32_bf16 v[188:191], v[244:247], v[228:231], v[188:191]
    ds_read_b128 v[228:231], v253 offset:8832
    v_cvt_pk_bf16_f32 v214, v252, v214
    v_mfma_f32_16x16x32_bf16 a[0:3], a[192:195], v[232:235], a[0:3]
    s_waitcnt lgkmcnt(1)
    v_fma_f32 v252, v249, s24, v251
    v_fmac_f32 v251, s25, v249
    v_mfma_f32_16x16x32_bf16 a[4:7], a[196:199], v[232:235], a[4:7]
    buffer_load_dwordx4 a[244:247], v254, s[8:11], s42 offen offset:1024 sc1
    v_mfma_f32_16x16x32_bf16 a[8:11], a[200:203], v[232:235], a[8:11]
    ds_read_b128 v[232:235], v253 offset:8576
    v_fma_f32 v249, v248, s24, v250
    v_mfma_f32_16x16x32_bf16 a[12:15], a[192:195], v[236:239], a[12:15]
    v_fmac_f32 v250, s25, v248
    v_fma_f32 v248, v250, s26, v251
    v_mfma_f32_16x16x32_bf16 a[16:19], a[196:199], v[236:239], a[16:19]
    s_waitcnt vmcnt(16)
    v_fmac_f32 v251, s27, v250
    v_fma_f32 v250, v249, s28, v252
    v_mfma_f32_16x16x32_bf16 a[20:23], a[200:203], v[236:239], a[20:23]
    buffer_load_dwordx4 a[248:251], v254, s[8:11], s42 offen offset:2048 sc1
    v_mfma_f32_16x16x32_bf16 a[0:3], a[204:207], v[236:239], a[0:3]
    s_waitcnt lgkmcnt(1)
    v_fmac_f32 v252, s29, v249
    v_fma_f32 v249, v208, s24, v212
    v_mfma_f32_16x16x32_bf16 a[4:7], a[208:211], v[236:239], a[4:7]
    s_add_u32 s42, s32, 190464
    v_fmac_f32 v212, s25, v208
    v_fma_f32 v208, v206, s24, v210
    v_mfma_f32_16x16x32_bf16 a[8:11], a[212:215], v[236:239], a[8:11]
    ds_read_b128 v[236:239], v253 offset:8320
    v_fmac_f32 v210, s25, v206
    v_mfma_f32_16x16x32_bf16 a[24:27], a[192:195], v[228:231], a[24:27]
    buffer_load_dwordx4 a[252:255], v254, s[8:11], s42 offen offset:0 sc1
    v_mfma_f32_16x16x32_bf16 a[28:31], a[196:199], v[228:231], a[28:31]
    v_fma_f32 v206, v210, s26, v212
    v_fmac_f32 v212, s27, v210
    v_mfma_f32_16x16x32_bf16 a[32:35], a[200:203], v[228:231], a[32:35]
    v_fma_f32 v210, v208, s28, v249
    v_fmac_f32 v249, s29, v208
    v_cvt_pk_bf16_f32 v206, v248, v206
    v_mfma_f32_16x16x32_bf16 a[12:15], a[204:207], v[228:231], a[12:15]
    v_cvt_pk_bf16_f32 v212, v251, v212
    v_cvt_pk_bf16_f32 v210, v250, v210
    v_mfma_f32_16x16x32_bf16 a[16:19], a[208:211], v[228:231], a[16:19]
    buffer_load_dwordx4 v[240:243], v254, s[8:11], s42 offen offset:1024 sc1
    v_mfma_f32_16x16x32_bf16 a[20:23], a[212:215], v[228:231], a[20:23]
    s_waitcnt vmcnt(16)
    v_cvt_pk_bf16_f32 v208, v252, v249
    v_lshlrev_b32 v248, 16, v207
    v_mfma_f32_16x16x32_bf16 a[0:3], a[216:219], v[228:231], a[0:3]
    s_waitcnt lgkmcnt(1)
    v_lshlrev_b32 v249, 16, v209
    v_lshlrev_b32 v250, 16, v211
    v_mfma_f32_16x16x32_bf16 a[4:7], a[220:223], v[228:231], a[4:7]
    buffer_load_dwordx4 v[244:247], v254, s[8:11], s42 offen offset:2048 sc1
    v_mfma_f32_16x16x32_bf16 a[8:11], a[224:227], v[228:231], a[8:11]
    ds_read_b128 v[228:231], v253 offset:10144
    v_and_b32 v203, 0x7fff, v255
    v_mfma_f32_16x16x32_bf16 a[36:39], a[192:195], v[232:235], a[36:39]
    v_lshlrev_b32 v251, 16, v213
    v_and_b32 v207, s22, v207
    v_mfma_f32_16x16x32_bf16 a[40:43], a[196:199], v[232:235], a[40:43]
    buffer_load_dwordx2 v[192:193], v203, s[4:7], s16 offen offset:896
    v_mfma_f32_16x16x32_bf16 a[44:47], a[200:203], v[232:235], a[44:47]
    v_and_b32 v209, s22, v209
    v_and_b32 v211, s22, v211
    v_mfma_f32_16x16x32_bf16 a[24:27], a[204:207], v[232:235], a[24:27]
    v_and_b32 v213, s22, v213
    v_lshlrev_b32 v252, 16, v205
    v_mfma_f32_16x16x32_bf16 a[28:31], a[208:211], v[232:235], a[28:31]
    buffer_load_dwordx2 v[194:195], v203, s[4:7], s17 offen offset:896
    v_mfma_f32_16x16x32_bf16 a[32:35], a[212:215], v[232:235], a[32:35]
    v_and_b32 v205, s22, v205
    v_add_f32 v252, v252, v251
    v_mfma_f32_16x16x32_bf16 a[12:15], a[216:219], v[232:235], a[12:15]
    s_waitcnt lgkmcnt(1)
    v_add_f32 v205, v205, v213
    v_fmac_f32 v252, s23, v249
    v_mfma_f32_16x16x32_bf16 a[16:19], a[220:223], v[232:235], a[16:19]
    buffer_load_dwordx2 v[196:197], v203, s[4:7], s18 offen offset:896
    v_mfma_f32_16x16x32_bf16 a[20:23], a[224:227], v[232:235], a[20:23]
    ds_read_b128 v[232:235], v253 offset:9888
    v_fmac_f32 v205, s23, v209
    v_mfma_f32_16x16x32_bf16 a[48:51], a[192:195], v[236:239], a[48:51]
    v_cvt_pk_bf16_f32 v205, v252, v205
    v_lshlrev_b32 v252, 16, v215
    v_mfma_f32_16x16x32_bf16 a[52:55], a[196:199], v[236:239], a[52:55]
    buffer_load_dwordx2 v[198:199], v203, s[4:7], s19 offen offset:896
    v_mfma_f32_16x16x32_bf16 a[56:59], a[200:203], v[236:239], a[56:59]
    v_and_b32 v215, s22, v215
    v_add_f32 v252, v252, v248
    v_mfma_f32_16x16x32_bf16 a[36:39], a[204:207], v[236:239], a[36:39]
    v_add_f32 v215, v215, v207
    v_fmac_f32 v252, s23, v250
    v_mfma_f32_16x16x32_bf16 a[40:43], a[208:211], v[236:239], a[40:43]
    buffer_load_dwordx2 v[200:201], v203, s[4:7], s20 offen offset:896
    v_fmac_f32 v215, s23, v211
    v_mfma_f32_16x16x32_bf16 a[44:47], a[212:215], v[236:239], a[44:47]
    v_cvt_pk_bf16_f32 v215, v252, v215
    v_fma_f32 v252, v249, s24, v251
    v_mfma_f32_16x16x32_bf16 a[24:27], a[216:219], v[236:239], a[24:27]
    s_waitcnt lgkmcnt(1)
    v_fmac_f32 v251, s25, v249
    v_fma_f32 v249, v248, s24, v250
    v_mfma_f32_16x16x32_bf16 a[28:31], a[220:223], v[236:239], a[28:31]
    buffer_load_dwordx2 v[202:203], v203, s[4:7], s21 offen offset:896
    v_mfma_f32_16x16x32_bf16 a[32:35], a[224:227], v[236:239], a[32:35]
    ds_read_b128 v[236:239], v253 offset:9632
    v_fmac_f32 v250, s25, v248
    v_mfma_f32_16x16x32_bf16 a[60:63], a[192:195], v[228:231], a[60:63]
    v_fma_f32 v248, v250, s26, v251
    v_fmac_f32 v251, s27, v250
    v_mfma_f32_16x16x32_bf16 a[64:67], a[196:199], v[228:231], a[64:67]
    v_fma_f32 v250, v249, s28, v252
    v_fmac_f32 v252, s29, v249
    v_mfma_f32_16x16x32_bf16 a[68:71], a[200:203], v[228:231], a[68:71]
    v_fma_f32 v249, v209, s24, v213
    v_fmac_f32 v213, s25, v209
    v_mfma_f32_16x16x32_bf16 a[48:51], a[204:207], v[228:231], a[48:51]
    v_fma_f32 v209, v207, s24, v211
    v_fmac_f32 v211, s25, v207
    v_mfma_f32_16x16x32_bf16 a[52:55], a[208:211], v[228:231], a[52:55]
    v_fma_f32 v207, v211, s26, v213
    v_fmac_f32 v213, s27, v211
    v_mfma_f32_16x16x32_bf16 a[56:59], a[212:215], v[228:231], a[56:59]
    v_fma_f32 v211, v209, s28, v249
    v_fmac_f32 v249, s29, v209
    v_mfma_f32_16x16x32_bf16 a[36:39], a[216:219], v[228:231], a[36:39]
    v_cvt_pk_bf16_f32 v207, v248, v207
    v_cvt_pk_bf16_f32 v213, v251, v213
    v_mfma_f32_16x16x32_bf16 a[40:43], a[220:223], v[228:231], a[40:43]
    s_waitcnt lgkmcnt(1)
    v_cvt_pk_bf16_f32 v211, v250, v211
    v_cvt_pk_bf16_f32 v209, v252, v249
    v_mfma_f32_16x16x32_bf16 a[44:47], a[224:227], v[228:231], a[44:47]
    ds_read_b128 v[228:231], v253 offset:9376
    v_lshrrev_b32 v252, 15, v255
    v_mfma_f32_16x16x32_bf16 a[72:75], a[192:195], v[232:235], a[72:75]
    ds_write_b64 v252, v[206:207] offset:768
    v_mfma_f32_16x16x32_bf16 a[76:79], a[196:199], v[232:235], a[76:79]
    s_waitcnt vmcnt(17)
    v_lshlrev_b32 v248, 16, v218
    v_lshlrev_b32 v249, 16, v220
    v_mfma_f32_16x16x32_bf16 a[80:83], a[200:203], v[232:235], a[80:83]
    ds_write_b64 v252, v[212:213] offset:2848
    v_mfma_f32_16x16x32_bf16 a[60:63], a[204:207], v[232:235], a[60:63]
    v_lshlrev_b32 v250, 16, v222
    v_lshlrev_b32 v251, 16, v224
    v_mfma_f32_16x16x32_bf16 a[64:67], a[208:211], v[232:235], a[64:67]
    ds_write_b64 v252, v[210:211] offset:4928
    v_mfma_f32_16x16x32_bf16 a[68:71], a[212:215], v[232:235], a[68:71]
    v_and_b32 v218, s22, v218
    v_and_b32 v220, s22, v220
    v_mfma_f32_16x16x32_bf16 a[48:51], a[216:219], v[232:235], a[48:51]
    ds_write_b64 v252, v[204:205] offset:17408
    v_and_b32 v222, s22, v222
    v_mfma_f32_16x16x32_bf16 a[52:55], a[220:223], v[232:235], a[52:55]
    s_waitcnt lgkmcnt(5)
    v_and_b32 v224, s22, v224
    v_mfma_f32_16x16x32_bf16 a[56:59], a[224:227], v[232:235], a[56:59]
    ds_read_b128 v[232:235], v253 offset:9104
    v_mfma_f32_16x16x32_bf16 a[84:87], a[192:195], v[236:239], a[84:87]
    ds_write_b64 v252, v[214:215] offset:25728
    v_mfma_f32_16x16x32_bf16 a[88:91], a[196:199], v[236:239], a[88:91]
    v_mfma_f32_16x16x32_bf16 a[92:95], a[200:203], v[236:239], a[92:95]
    s_add_u32 s42, s32, 221184
    v_mfma_f32_16x16x32_bf16 a[72:75], a[204:207], v[236:239], a[72:75]
    buffer_load_dwordx4 a[192:195], v254, s[8:11], s42 offen offset:0 sc1
    v_mfma_f32_16x16x32_bf16 a[76:79], a[208:211], v[236:239], a[76:79]
    ds_write_b64 v252, v[208:209] offset:7008
    v_mfma_f32_16x16x32_bf16 a[80:83], a[212:215], v[236:239], a[80:83]
    v_mfma_f32_16x16x32_bf16 a[60:63], a[216:219], v[236:239], a[60:63]
    buffer_load_dwordx4 a[196:199], v254, s[8:11], s42 offen offset:1024 sc1
    v_mfma_f32_16x16x32_bf16 a[64:67], a[220:223], v[236:239], a[64:67]
    v_lshlrev_b32 v252, 16, v216
    v_and_b32 v216, s22, v216
    v_mfma_f32_16x16x32_bf16 a[68:71], a[224:227], v[236:239], a[68:71]
    s_waitcnt lgkmcnt(7)
    v_add_f32 v252, v252, v251
    v_add_f32 v216, v216, v224
    v_mfma_f32_16x16x32_bf16 a[84:87], a[204:207], v[228:231], a[84:87]
    ds_read_b128 v[236:239], v253 offset:11440
    v_fmac_f32 v252, s23, v249
    v_mfma_f32_16x16x32_bf16 a[88:91], a[208:211], v[228:231], a[88:91]
    v_fmac_f32 v216, s23, v220
    v_cvt_pk_bf16_f32 v216, v252, v216
    v_mfma_f32_16x16x32_bf16 a[92:95], a[212:215], v[228:231], a[92:95]
    buffer_load_dwordx4 a[200:203], v254, s[8:11], s42 offen offset:2048 sc1
    v_mfma_f32_16x16x32_bf16 a[72:75], a[216:219], v[228:231], a[72:75]
    s_waitcnt lgkmcnt(3)
    v_lshlrev_b32 v252, 16, v226
    v_and_b32 v226, s22, v226
    v_mfma_f32_16x16x32_bf16 a[76:79], a[220:223], v[228:231], a[76:79]
    s_add_u32 s42, s32, 224256
    v_add_f32 v252, v252, v248
    v_add_f32 v226, v226, v218
    v_mfma_f32_16x16x32_bf16 a[80:83], a[224:227], v[228:231], a[80:83]
    ds_read_b128 v[228:231], v253 offset:11168
    v_fmac_f32 v252, s23, v250
    v_mfma_f32_16x16x32_bf16 a[84:87], a[216:219], v[232:235], a[84:87]
    buffer_load_dwordx4 a[204:207], v254, s[8:11], s42 offen offset:0 sc1
    v_mfma_f32_16x16x32_bf16 a[88:91], a[220:223], v[232:235], a[88:91]
    s_waitcnt vmcnt(16) lgkmcnt(1)
    v_fmac_f32 v226, s23, v222
    v_cvt_pk_bf16_f32 v226, v252, v226
    v_mfma_f32_16x16x32_bf16 a[92:95], a[224:227], v[232:235], a[92:95]
    ds_read_b128 v[232:235], v253 offset:10912
    v_fma_f32 v252, v249, s24, v251
    v_mfma_f32_16x16x32_bf16 a[96:99], a[228:231], v[236:239], a[96:99]
    s_waitcnt lgkmcnt(1)
    v_fmac_f32 v251, s25, v249
    v_fma_f32 v249, v248, s24, v250
    v_mfma_f32_16x16x32_bf16 a[100:103], a[232:235], v[236:239], a[100:103]
    buffer_load_dwordx4 a[208:211], v254, s[8:11], s42 offen offset:1024 sc1
    v_mfma_f32_16x16x32_bf16 a[104:107], a[236:239], v[236:239], a[104:107]
    ds_read_b128 v[236:239], v253 offset:10656
    v_fmac_f32 v250, s25, v248
    v_mfma_f32_16x16x32_bf16 a[108:111], a[228:231], v[228:231], a[108:111]
    v_fma_f32 v248, v250, s26, v251
    v_fmac_f32 v251, s27, v250
    v_mfma_f32_16x16x32_bf16 a[112:115], a[232:235], v[228:231], a[112:115]
    s_waitcnt vmcnt(14)
    v_fma_f32 v250, v249, s28, v252
    v_fmac_f32 v252, s29, v249
    v_mfma_f32_16x16x32_bf16 a[116:119], a[236:239], v[228:231], a[116:119]
    buffer_load_dwordx4 a[212:215], v254, s[8:11], s42 offen offset:2048 sc1
    v_mfma_f32_16x16x32_bf16 a[96:99], a[240:243], v[228:231], a[96:99]
    s_waitcnt lgkmcnt(1)
    v_fma_f32 v249, v220, s24, v224
    v_fmac_f32 v224, s25, v220
    v_mfma_f32_16x16x32_bf16 a[100:103], a[244:247], v[228:231], a[100:103]
    s_add_u32 s42, s32, 227328
    v_fma_f32 v220, v218, s24, v222
    v_fmac_f32 v222, s25, v218
    v_mfma_f32_16x16x32_bf16 a[104:107], a[248:251], v[228:231], a[104:107]
    ds_read_b128 v[228:231], v253 offset:10400
    v_fma_f32 v218, v222, s26, v224
    v_mfma_f32_16x16x32_bf16 a[120:123], a[228:231], v[232:235], a[120:123]
    buffer_load_dwordx4 a[216:219], v254, s[8:11], s42 offen offset:0 sc1
    v_mfma_f32_16x16x32_bf16 a[124:127], a[232:235], v[232:235], a[124:127]
    v_fmac_f32 v224, s27, v222
    v_fma_f32 v222, v220, s28, v249
    v_mfma_f32_16x16x32_bf16 a[128:131], a[236:239], v[232:235], a[128:131]
    v_fmac_f32 v249, s29, v220
    v_cvt_pk_bf16_f32 v218, v248, v218
    v_mfma_f32_16x16x32_bf16 a[108:111], a[240:243], v[232:235], a[108:111]
    v_cvt_pk_bf16_f32 v224, v251, v224
    v_cvt_pk_bf16_f32 v222, v250, v222
    v_mfma_f32_16x16x32_bf16 a[112:115], a[244:247], v[232:235], a[112:115]
    buffer_load_dwordx4 a[220:223], v254, s[8:11], s42 offen offset:1024 sc1
    v_mfma_f32_16x16x32_bf16 a[116:119], a[248:251], v[232:235], a[116:119]
    s_waitcnt vmcnt(14)
    v_cvt_pk_bf16_f32 v220, v252, v249
    v_lshlrev_b32 v248, 16, v219
    v_mfma_f32_16x16x32_bf16 a[96:99], a[252:255], v[232:235], a[96:99]
    s_waitcnt lgkmcnt(1)
    v_lshlrev_b32 v249, 16, v221
    v_lshlrev_b32 v250, 16, v223
    v_mfma_f32_16x16x32_bf16 a[100:103], v[240:243], v[232:235], a[100:103]
    buffer_load_dwordx4 a[224:227], v254, s[8:11], s42 offen offset:2048 sc1
    v_mfma_f32_16x16x32_bf16 a[104:107], v[244:247], v[232:235], a[104:107]
    ds_read_b128 v[232:235], v253 offset:12224
    v_and_b32 v215, 0x7fff, v255
    v_mfma_f32_16x16x32_bf16 a[132:135], a[228:231], v[236:239], a[132:135]
    v_lshlrev_b32 v251, 16, v225
    v_and_b32 v219, s22, v219
    v_mfma_f32_16x16x32_bf16 a[136:139], a[232:235], v[236:239], a[136:139]
    buffer_load_dwordx2 v[204:205], v215, s[4:7], s16 offen offset:1280
    v_mfma_f32_16x16x32_bf16 a[140:143], a[236:239], v[236:239], a[140:143]
    v_and_b32 v221, s22, v221
    v_and_b32 v223, s22, v223
    v_mfma_f32_16x16x32_bf16 a[120:123], a[240:243], v[236:239], a[120:123]
    v_and_b32 v225, s22, v225
    v_lshlrev_b32 v252, 16, v217
    v_mfma_f32_16x16x32_bf16 a[124:127], a[244:247], v[236:239], a[124:127]
    buffer_load_dwordx2 v[206:207], v215, s[4:7], s17 offen offset:1280
    v_mfma_f32_16x16x32_bf16 a[128:131], a[248:251], v[236:239], a[128:131]
    v_and_b32 v217, s22, v217
    v_add_f32 v252, v252, v251
    v_mfma_f32_16x16x32_bf16 a[108:111], a[252:255], v[236:239], a[108:111]
    s_waitcnt lgkmcnt(1)
    v_add_f32 v217, v217, v225
    v_fmac_f32 v252, s23, v249
    v_mfma_f32_16x16x32_bf16 a[112:115], v[240:243], v[236:239], a[112:115]
    buffer_load_dwordx2 v[208:209], v215, s[4:7], s18 offen offset:1280
    v_mfma_f32_16x16x32_bf16 a[116:119], v[244:247], v[236:239], a[116:119]
    ds_read_b128 v[236:239], v253 offset:11968
    v_fmac_f32 v217, s23, v221
    v_mfma_f32_16x16x32_bf16 a[144:147], a[228:231], v[228:231], a[144:147]
    v_cvt_pk_bf16_f32 v217, v252, v217
    v_lshlrev_b32 v252, 16, v227
    v_mfma_f32_16x16x32_bf16 a[148:151], a[232:235], v[228:231], a[148:151]
    buffer_load_dwordx2 v[210:211], v215, s[4:7], s19 offen offset:1280
    v_mfma_f32_16x16x32_bf16 a[152:155], a[236:239], v[228:231], a[152:155]
    v_and_b32 v227, s22, v227
    v_add_f32 v252, v252, v248
    v_mfma_f32_16x16x32_bf16 a[132:135], a[240:243], v[228:231], a[132:135]
    v_add_f32 v227, v227, v219
    v_fmac_f32 v252, s23, v250
    v_mfma_f32_16x16x32_bf16 a[136:139], a[244:247], v[228:231], a[136:139]
    buffer_load_dwordx2 v[212:213], v215, s[4:7], s20 offen offset:1280
    v_mfma_f32_16x16x32_bf16 a[140:143], a[248:251], v[228:231], a[140:143]
    v_fmac_f32 v227, s23, v223
    v_cvt_pk_bf16_f32 v227, v252, v227
    v_mfma_f32_16x16x32_bf16 a[120:123], a[252:255], v[228:231], a[120:123]
    s_waitcnt lgkmcnt(1)
    v_fma_f32 v252, v249, s24, v251
    v_fmac_f32 v251, s25, v249
    v_mfma_f32_16x16x32_bf16 a[124:127], v[240:243], v[228:231], a[124:127]
    buffer_load_dwordx2 v[214:215], v215, s[4:7], s21 offen offset:1280
    v_mfma_f32_16x16x32_bf16 a[128:131], v[244:247], v[228:231], a[128:131]
    ds_read_b128 v[228:231], v253 offset:11712
    v_fma_f32 v249, v248, s24, v250
    v_mfma_f32_16x16x32_bf16 a[156:159], a[228:231], v[232:235], a[156:159]
    v_fmac_f32 v250, s25, v248
    v_fma_f32 v248, v250, s26, v251
    v_mfma_f32_16x16x32_bf16 a[160:163], a[232:235], v[232:235], a[160:163]
    v_fmac_f32 v251, s27, v250
    v_fma_f32 v250, v249, s28, v252
    v_mfma_f32_16x16x32_bf16 a[164:167], a[236:239], v[232:235], a[164:167]
    v_fmac_f32 v252, s29, v249
    v_fma_f32 v249, v221, s24, v225
    v_mfma_f32_16x16x32_bf16 a[144:147], a[240:243], v[232:235], a[144:147]
    v_fmac_f32 v225, s25, v221
    v_fma_f32 v221, v219, s24, v223
    v_mfma_f32_16x16x32_bf16 a[148:151], a[244:247], v[232:235], a[148:151]
    v_fmac_f32 v223, s25, v219
    v_fma_f32 v219, v223, s26, v225
    v_mfma_f32_16x16x32_bf16 a[152:155], a[248:251], v[232:235], a[152:155]
    v_fmac_f32 v225, s27, v223
    v_fma_f32 v223, v221, s28, v249
    v_mfma_f32_16x16x32_bf16 a[132:135], a[252:255], v[232:235], a[132:135]
    v_fmac_f32 v249, s29, v221
    v_cvt_pk_bf16_f32 v219, v248, v219
    v_mfma_f32_16x16x32_bf16 a[136:139], v[240:243], v[232:235], a[136:139]
    s_waitcnt lgkmcnt(1)
    v_cvt_pk_bf16_f32 v225, v251, v225
    v_cvt_pk_bf16_f32 v223, v250, v223
    v_mfma_f32_16x16x32_bf16 a[140:143], v[244:247], v[232:235], a[140:143]
    ds_read_b128 v[232:235], v253 offset:11456
    v_cvt_pk_bf16_f32 v221, v252, v249
    v_mfma_f32_16x16x32_bf16 a[168:171], a[228:231], v[236:239], a[168:171]
    v_lshrrev_b32 v252, 15, v255
    v_mfma_f32_16x16x32_bf16 a[172:175], a[232:235], v[236:239], a[172:175]
    ds_write_b64 v252, v[218:219] offset:512
    v_mfma_f32_16x16x32_bf16 a[176:179], a[236:239], v[236:239], a[176:179]
    s_waitcnt vmcnt(15)
    v_lshlrev_b32 v248, 16, v194
    v_lshlrev_b32 v249, 16, v196
    v_mfma_f32_16x16x32_bf16 a[156:159], a[240:243], v[236:239], a[156:159]
    ds_write_b64 v252, v[224:225] offset:2592
    v_mfma_f32_16x16x32_bf16 a[160:163], a[244:247], v[236:239], a[160:163]
    v_lshlrev_b32 v250, 16, v198
    v_lshlrev_b32 v251, 16, v200
    v_mfma_f32_16x16x32_bf16 a[164:167], a[248:251], v[236:239], a[164:167]
    ds_write_b64 v252, v[222:223] offset:4672
    v_mfma_f32_16x16x32_bf16 a[144:147], a[252:255], v[236:239], a[144:147]
    s_waitcnt lgkmcnt(4)
    v_and_b32 v194, s22, v194
    v_and_b32 v196, s22, v196
    v_mfma_f32_16x16x32_bf16 a[148:151], v[240:243], v[236:239], a[148:151]
    ds_write_b64 v252, v[216:217] offset:17152
    v_mfma_f32_16x16x32_bf16 a[152:155], v[244:247], v[236:239], a[152:155]
    ds_read_b128 v[236:239], v253 offset:11184
    v_and_b32 v198, s22, v198
    v_mfma_f32_16x16x32_bf16 a[180:183], a[228:231], v[228:231], a[180:183]
    v_and_b32 v200, s22, v200
    v_mfma_f32_16x16x32_bf16 a[184:187], a[232:235], v[228:231], a[184:187]
    ds_write_b64 v252, v[226:227] offset:25472
    v_mfma_f32_16x16x32_bf16 a[188:191], a[236:239], v[228:231], a[188:191]
    s_add_u32 s42, s32, 258048
    v_mfma_f32_16x16x32_bf16 a[168:171], a[240:243], v[228:231], a[168:171]
    buffer_load_dwordx4 a[228:231], v254, s[8:11], s42 offen offset:0 sc1
    v_mfma_f32_16x16x32_bf16 a[172:175], a[244:247], v[228:231], a[172:175]
    ds_write_b64 v252, v[220:221] offset:6752
    v_mfma_f32_16x16x32_bf16 a[176:179], a[248:251], v[228:231], a[176:179]
    v_mfma_f32_16x16x32_bf16 a[156:159], a[252:255], v[228:231], a[156:159]
    buffer_load_dwordx4 a[232:235], v254, s[8:11], s42 offen offset:1024 sc1
    v_mfma_f32_16x16x32_bf16 a[160:163], v[240:243], v[228:231], a[160:163]
    v_lshlrev_b32 v252, 16, v192
    v_and_b32 v192, s22, v192
    v_mfma_f32_16x16x32_bf16 a[164:167], v[244:247], v[228:231], a[164:167]
    s_waitcnt lgkmcnt(2)
    v_add_f32 v252, v252, v251
    v_add_f32 v192, v192, v200
    v_mfma_f32_16x16x32_bf16 a[180:183], a[240:243], v[232:235], a[180:183]
    ds_read_b128 v[228:231], v253 offset:13520
    v_fmac_f32 v252, s23, v249
    v_mfma_f32_16x16x32_bf16 a[184:187], a[244:247], v[232:235], a[184:187]
    ds_read_b128 v[216:219], v253 offset:39904
    v_fmac_f32 v192, s23, v196
    v_mfma_f32_16x16x32_bf16 a[188:191], a[248:251], v[232:235], a[188:191]
    buffer_load_dwordx4 a[236:239], v254, s[8:11], s42 offen offset:2048 sc1
    v_mfma_f32_16x16x32_bf16 a[168:171], a[252:255], v[232:235], a[168:171]
    s_mov_b32 s45, 405865480
    v_cvt_pk_bf16_f32 v192, v252, v192
    v_lshlrev_b32 v252, 16, v202
    v_and_b32 v202, s22, v202
    v_mfma_f32_16x16x32_bf16 a[172:175], v[240:243], v[232:235], a[172:175]
    s_add_u32 s42, s32, 261120
    v_add_f32 v252, v252, v248
    v_add_f32 v202, v202, v194
    v_mfma_f32_16x16x32_bf16 a[176:179], v[244:247], v[232:235], a[176:179]
    ds_read_b128 v[232:235], v253 offset:13248
    v_bfe_u32 v220, v254, 5, 3
    v_mfma_f32_16x16x32_bf16 a[180:183], a[252:255], v[236:239], a[180:183]
    buffer_load_dwordx4 a[240:243], v254, s[8:11], s42 offen offset:0 sc1
    v_mfma_f32_16x16x32_bf16 a[184:187], v[240:243], v[236:239], a[184:187]
    s_waitcnt vmcnt(16) lgkmcnt(2)
    v_fmac_f32 v252, s23, v250
    v_fmac_f32 v202, s23, v198
    v_mfma_f32_16x16x32_bf16 a[188:191], v[244:247], v[236:239], a[188:191]
    ds_read_b128 v[236:239], v253 offset:12992
    v_mul_u32_u24 v221, 5, v220
    v_mfma_f32_16x16x32_bf16 v[0:3], a[192:195], v[228:231], v[0:3]
    s_waitcnt lgkmcnt(1)
    v_cvt_pk_bf16_f32 v202, v252, v202
    v_fma_f32 v252, v249, s24, v251
    v_mfma_f32_16x16x32_bf16 v[4:7], a[196:199], v[228:231], v[4:7]
    buffer_load_dwordx4 a[244:247], v254, s[8:11], s42 offen offset:1024 sc1
    v_fmac_f32 v251, s25, v249
    v_mfma_f32_16x16x32_bf16 v[8:11], a[200:203], v[228:231], v[8:11]
    ds_read_b128 v[228:231], v253 offset:12736
    v_bfe_u32 v221, s45, v221, 5
    v_mfma_f32_16x16x32_bf16 v[12:15], a[192:195], v[232:235], v[12:15]
    v_fma_f32 v249, v248, s24, v250
    v_fmac_f32 v250, s25, v248
    v_mfma_f32_16x16x32_bf16 v[16:19], a[196:199], v[232:235], v[16:19]
    s_waitcnt vmcnt(14)
    v_mul_u32_u24 v221, 65, v221
    v_fma_f32 v248, v250, s26, v251
    v_mfma_f32_16x16x32_bf16 v[20:23], a[200:203], v[232:235], v[20:23]
    buffer_load_dwordx4 a[248:251], v254, s[8:11], s42 offen offset:2048 sc1
    v_mfma_f32_16x16x32_bf16 v[0:3], a[204:207], v[232:235], v[0:3]
    s_waitcnt lgkmcnt(1)
    v_sub_u32 v221, v221, v220
    v_fmac_f32 v251, s27, v250
    v_mfma_f32_16x16x32_bf16 v[4:7], a[208:211], v[232:235], v[4:7]
    s_add_u32 s42, s32, 264192
    v_fma_f32 v250, v249, s28, v252
    v_fmac_f32 v252, s29, v249
    v_fma_f32 v249, v196, s24, v200
    v_mfma_f32_16x16x32_bf16 v[8:11], a[212:215], v[232:235], v[8:11]
    ds_read_b128 v[232:235], v253 offset:12480
    v_lshl_add_u32 v220, v221, 5, v253
    v_mfma_f32_16x16x32_bf16 v[24:27], a[192:195], v[236:239], v[24:27]
    buffer_load_dwordx4 a[252:255], v254, s[8:11], s42 offen offset:0 sc1
    v_mfma_f32_16x16x32_bf16 v[28:31], a[196:199], v[236:239], v[28:31]
    v_fmac_f32 v200, s25, v196
    v_fma_f32 v196, v194, s24, v198
    v_mfma_f32_16x16x32_bf16 v[32:35], a[200:203], v[236:239], v[32:35]
    v_fmac_f32 v198, s25, v194
    v_fma_f32 v194, v198, s26, v200
    v_mfma_f32_16x16x32_bf16 v[12:15], a[204:207], v[236:239], v[12:15]
    s_waitcnt vmcnt(13)
    v_fmac_f32 v200, s27, v198
    v_fma_f32 v198, v196, s28, v249
    v_mfma_f32_16x16x32_bf16 v[16:19], a[208:211], v[236:239], v[16:19]
    buffer_load_dwordx4 v[240:243], v254, s[8:11], s42 offen offset:1024 sc1
    v_mfma_f32_16x16x32_bf16 v[20:23], a[212:215], v[236:239], v[20:23]
    s_mov_b64 exec, s[46:47]
    ds_write_b128 v220, v[216:219] offset:1024
    s_mov_b64 exec, -1
    v_fmac_f32 v249, s29, v196
    v_mfma_f32_16x16x32_bf16 v[0:3], a[216:219], v[236:239], v[0:3]
    s_waitcnt lgkmcnt(2)
    v_cvt_pk_bf16_f32 v194, v248, v194
    v_cvt_pk_bf16_f32 v200, v251, v200
    v_mfma_f32_16x16x32_bf16 v[4:7], a[220:223], v[236:239], v[4:7]
    buffer_load_dwordx4 v[244:247], v254, s[8:11], s42 offen offset:2048 sc1
    v_mfma_f32_16x16x32_bf16 v[8:11], a[224:227], v[236:239], v[8:11]
    ds_read_b128 v[236:239], v253 offset:14304
    v_and_b32 v227, 0x7fff, v255
    v_mfma_f32_16x16x32_bf16 v[36:39], a[192:195], v[228:231], v[36:39]
    v_cvt_pk_bf16_f32 v198, v250, v198
    v_cvt_pk_bf16_f32 v196, v252, v249
    v_mfma_f32_16x16x32_bf16 v[40:43], a[196:199], v[228:231], v[40:43]
    buffer_load_dwordx2 v[216:217], v227, s[4:7], s16 offen offset:192
    v_mfma_f32_16x16x32_bf16 v[44:47], a[200:203], v[228:231], v[44:47]
    v_lshlrev_b32 v248, 16, v195
    v_lshlrev_b32 v249, 16, v197
    v_mfma_f32_16x16x32_bf16 v[24:27], a[204:207], v[228:231], v[24:27]
    v_lshlrev_b32 v250, 16, v199
    v_lshlrev_b32 v251, 16, v201
    v_and_b32 v195, s22, v195
    v_mfma_f32_16x16x32_bf16 v[28:31], a[208:211], v[228:231], v[28:31]
    buffer_load_dwordx2 v[218:219], v227, s[4:7], s17 offen offset:192
    v_mfma_f32_16x16x32_bf16 v[32:35], a[212:215], v[228:231], v[32:35]
    v_and_b32 v197, s22, v197
    v_and_b32 v199, s22, v199
    v_mfma_f32_16x16x32_bf16 v[12:15], a[216:219], v[228:231], v[12:15]
    s_waitcnt lgkmcnt(2)
    v_and_b32 v201, s22, v201
    v_lshlrev_b32 v252, 16, v193
    v_mfma_f32_16x16x32_bf16 v[16:19], a[220:223], v[228:231], v[16:19]
    buffer_load_dwordx2 v[220:221], v227, s[4:7], s18 offen offset:192
    v_mfma_f32_16x16x32_bf16 v[20:23], a[224:227], v[228:231], v[20:23]
    ds_read_b128 v[228:231], v253 offset:14048
    v_and_b32 v193, s22, v193
    v_mfma_f32_16x16x32_bf16 v[48:51], a[192:195], v[232:235], v[48:51]
    v_add_f32 v252, v252, v251
    v_add_f32 v193, v193, v201
    v_fmac_f32 v252, s23, v249
    v_mfma_f32_16x16x32_bf16 v[52:55], a[196:199], v[232:235], v[52:55]
    buffer_load_dwordx2 v[222:223], v227, s[4:7], s19 offen offset:192
    v_mfma_f32_16x16x32_bf16 v[56:59], a[200:203], v[232:235], v[56:59]
    v_fmac_f32 v193, s23, v197
    v_cvt_pk_bf16_f32 v193, v252, v193
    v_mfma_f32_16x16x32_bf16 v[36:39], a[204:207], v[232:235], v[36:39]
    v_lshlrev_b32 v252, 16, v203
    v_and_b32 v203, s22, v203
    v_mfma_f32_16x16x32_bf16 v[40:43], a[208:211], v[232:235], v[40:43]
    buffer_load_dwordx2 v[224:225], v227, s[4:7], s20 offen offset:192
    v_mfma_f32_16x16x32_bf16 v[44:47], a[212:215], v[232:235], v[44:47]
    v_add_f32 v252, v252, v248
    v_add_f32 v203, v203, v195
    v_mfma_f32_16x16x32_bf16 v[24:27], a[216:219], v[232:235], v[24:27]
    s_waitcnt lgkmcnt(1)
    v_fmac_f32 v252, s23, v250
    v_fmac_f32 v203, s23, v199
    v_mfma_f32_16x16x32_bf16 v[28:31], a[220:223], v[232:235], v[28:31]
    buffer_load_dwordx2 v[226:227], v227, s[4:7], s21 offen offset:192
    v_cvt_pk_bf16_f32 v203, v252, v203
    v_mfma_f32_16x16x32_bf16 v[32:35], a[224:227], v[232:235], v[32:35]
    ds_read_b128 v[232:235], v253 offset:13792
    v_fma_f32 v252, v249, s24, v251
    v_mfma_f32_16x16x32_bf16 v[60:63], a[192:195], v[236:239], v[60:63]
    v_fmac_f32 v251, s25, v249
    v_fma_f32 v249, v248, s24, v250
    v_mfma_f32_16x16x32_bf16 v[64:67], a[196:199], v[236:239], v[64:67]
    v_fmac_f32 v250, s25, v248
    v_fma_f32 v248, v250, s26, v251
    v_mfma_f32_16x16x32_bf16 v[68:71], a[200:203], v[236:239], v[68:71]
    v_fmac_f32 v251, s27, v250
    v_fma_f32 v250, v249, s28, v252
    v_mfma_f32_16x16x32_bf16 v[48:51], a[204:207], v[236:239], v[48:51]
    v_fmac_f32 v252, s29, v249
    v_fma_f32 v249, v197, s24, v201
    v_mfma_f32_16x16x32_bf16 v[52:55], a[208:211], v[236:239], v[52:55]
    v_fmac_f32 v201, s25, v197
    v_fma_f32 v197, v195, s24, v199
    v_mfma_f32_16x16x32_bf16 v[56:59], a[212:215], v[236:239], v[56:59]
    v_fmac_f32 v199, s25, v195
    v_fma_f32 v195, v199, s26, v201
    v_fmac_f32 v201, s27, v199
    v_mfma_f32_16x16x32_bf16 v[36:39], a[216:219], v[236:239], v[36:39]
    v_fma_f32 v199, v197, s28, v249
    v_fmac_f32 v249, s29, v197
    v_mfma_f32_16x16x32_bf16 v[40:43], a[220:223], v[236:239], v[40:43]
    s_waitcnt lgkmcnt(1)
    v_cvt_pk_bf16_f32 v195, v248, v195
    v_cvt_pk_bf16_f32 v201, v251, v201
    v_mfma_f32_16x16x32_bf16 v[44:47], a[224:227], v[236:239], v[44:47]
    ds_read_b128 v[236:239], v253 offset:13536
    v_cvt_pk_bf16_f32 v199, v250, v199
    v_mfma_f32_16x16x32_bf16 v[72:75], a[192:195], v[228:231], v[72:75]
    v_cvt_pk_bf16_f32 v197, v252, v249
    v_lshrrev_b32 v252, 15, v255
    v_mfma_f32_16x16x32_bf16 v[76:79], a[196:199], v[228:231], v[76:79]
    ds_write_b64 v252, v[194:195] offset:256
    v_mfma_f32_16x16x32_bf16 v[80:83], a[200:203], v[228:231], v[80:83]
    s_waitcnt vmcnt(15)
    v_lshlrev_b32 v248, 16, v206
    v_lshlrev_b32 v249, 16, v208
    v_mfma_f32_16x16x32_bf16 v[60:63], a[204:207], v[228:231], v[60:63]
    ds_write_b64 v252, v[200:201] offset:2336
    v_mfma_f32_16x16x32_bf16 v[64:67], a[208:211], v[228:231], v[64:67]
    v_lshlrev_b32 v250, 16, v210
    v_lshlrev_b32 v251, 16, v212
    v_mfma_f32_16x16x32_bf16 v[68:71], a[212:215], v[228:231], v[68:71]
    ds_write_b64 v252, v[198:199] offset:4416
    v_mfma_f32_16x16x32_bf16 v[48:51], a[216:219], v[228:231], v[48:51]
    s_waitcnt lgkmcnt(4)
    v_and_b32 v206, s22, v206
    v_and_b32 v208, s22, v208
    v_mfma_f32_16x16x32_bf16 v[52:55], a[220:223], v[228:231], v[52:55]
    ds_write_b64 v252, v[192:193] offset:16896
    v_mfma_f32_16x16x32_bf16 v[56:59], a[224:227], v[228:231], v[56:59]
    ds_read_b128 v[228:231], v253 offset:13264
    v_and_b32 v210, s22, v210
    v_mfma_f32_16x16x32_bf16 v[84:87], a[192:195], v[232:235], v[84:87]
    v_and_b32 v212, s22, v212
    v_mfma_f32_16x16x32_bf16 v[88:91], a[196:199], v[232:235], v[88:91]
    ds_write_b64 v252, v[202:203] offset:25216
    v_mfma_f32_16x16x32_bf16 v[92:95], a[200:203], v[232:235], v[92:95]
    s_add_u32 s42, s32, 294912
    v_mfma_f32_16x16x32_bf16 v[72:75], a[204:207], v[232:235], v[72:75]
    buffer_load_dwordx4 a[192:195], v254, s[8:11], s42 offen offset:0 sc1
    v_mfma_f32_16x16x32_bf16 v[76:79], a[208:211], v[232:235], v[76:79]
    ds_write_b64 v252, v[196:197] offset:6496
    v_mfma_f32_16x16x32_bf16 v[80:83], a[212:215], v[232:235], v[80:83]
    v_mfma_f32_16x16x32_bf16 v[60:63], a[216:219], v[232:235], v[60:63]
    buffer_load_dwordx4 a[196:199], v254, s[8:11], s42 offen offset:1024 sc1
    v_mfma_f32_16x16x32_bf16 v[64:67], a[220:223], v[232:235], v[64:67]
    v_lshlrev_b32 v252, 16, v204
    v_and_b32 v204, s22, v204
    v_mfma_f32_16x16x32_bf16 v[68:71], a[224:227], v[232:235], v[68:71]
    s_waitcnt lgkmcnt(7)
    v_add_f32 v252, v252, v251
    v_add_f32 v204, v204, v212
    v_mfma_f32_16x16x32_bf16 v[84:87], a[204:207], v[236:239], v[84:87]
    ds_read_b128 v[232:235], v253 offset:32240
    v_fmac_f32 v252, s23, v249
    v_mfma_f32_16x16x32_bf16 v[88:91], a[208:211], v[236:239], v[88:91]
    v_fmac_f32 v204, s23, v208
    v_cvt_pk_bf16_f32 v204, v252, v204
    v_mfma_f32_16x16x32_bf16 v[92:95], a[212:215], v[236:239], v[92:95]
    buffer_load_dwordx4 a[200:203], v254, s[8:11], s42 offen offset:2048 sc1
    v_mfma_f32_16x16x32_bf16 v[72:75], a[216:219], v[236:239], v[72:75]
    s_waitcnt lgkmcnt(3)
    v_lshlrev_b32 v252, 16, v214
    v_and_b32 v214, s22, v214
    v_mfma_f32_16x16x32_bf16 v[76:79], a[220:223], v[236:239], v[76:79]
    s_add_u32 s42, s32, 297984
    v_add_f32 v252, v252, v248
    v_add_f32 v214, v214, v206
    v_mfma_f32_16x16x32_bf16 v[80:83], a[224:227], v[236:239], v[80:83]
    ds_read_b128 v[236:239], v253 offset:31968
    v_fmac_f32 v252, s23, v250
    v_mfma_f32_16x16x32_bf16 v[84:87], a[216:219], v[228:231], v[84:87]
    buffer_load_dwordx4 a[204:207], v254, s[8:11], s42 offen offset:0 sc1
    v_mfma_f32_16x16x32_bf16 v[88:91], a[220:223], v[228:231], v[88:91]
    s_waitcnt vmcnt(16) lgkmcnt(1)
    v_fmac_f32 v214, s23, v210
    v_cvt_pk_bf16_f32 v214, v252, v214
    v_mfma_f32_16x16x32_bf16 v[92:95], a[224:227], v[228:231], v[92:95]
    ds_read_b128 v[228:231], v253 offset:31712
    v_fma_f32 v252, v249, s24, v251
    v_mfma_f32_16x16x32_bf16 v[96:99], a[228:231], v[232:235], v[96:99]
    s_waitcnt lgkmcnt(1)
    v_fmac_f32 v251, s25, v249
    v_fma_f32 v249, v248, s24, v250
    v_mfma_f32_16x16x32_bf16 v[100:103], a[232:235], v[232:235], v[100:103]
    buffer_load_dwordx4 a[208:211], v254, s[8:11], s42 offen offset:1024 sc1
    v_mfma_f32_16x16x32_bf16 v[104:107], a[236:239], v[232:235], v[104:107]
    ds_read_b128 v[232:235], v253 offset:31456
    v_fmac_f32 v250, s25, v248
    v_mfma_f32_16x16x32_bf16 v[108:111], a[228:231], v[236:239], v[108:111]
    v_fma_f32 v248, v250, s26, v251
    v_fmac_f32 v251, s27, v250
    v_mfma_f32_16x16x32_bf16 v[112:115], a[232:235], v[236:239], v[112:115]
    s_waitcnt vmcnt(14)
    v_fma_f32 v250, v249, s28, v252
    v_fmac_f32 v252, s29, v249
    v_mfma_f32_16x16x32_bf16 v[116:119], a[236:239], v[236:239], v[116:119]
    buffer_load_dwordx4 a[212:215], v254, s[8:11], s42 offen offset:2048 sc1
    v_mfma_f32_16x16x32_bf16 v[96:99], a[240:243], v[236:239], v[96:99]
    s_waitcnt lgkmcnt(1)
    v_fma_f32 v249, v208, s24, v212
    v_fmac_f32 v212, s25, v208
    v_mfma_f32_16x16x32_bf16 v[100:103], a[244:247], v[236:239], v[100:103]
    s_add_u32 s42, s32, 301056
    v_fma_f32 v208, v206, s24, v210
    v_fmac_f32 v210, s25, v206
    v_mfma_f32_16x16x32_bf16 v[104:107], a[248:251], v[236:239], v[104:107]
    ds_read_b128 v[236:239], v253 offset:31200
    v_fma_f32 v206, v210, s26, v212
    v_mfma_f32_16x16x32_bf16 v[120:123], a[228:231], v[228:231], v[120:123]
    buffer_load_dwordx4 a[216:219], v254, s[8:11], s42 offen offset:0 sc1
    v_mfma_f32_16x16x32_bf16 v[124:127], a[232:235], v[228:231], v[124:127]
    v_fmac_f32 v212, s27, v210
    v_fma_f32 v210, v208, s28, v249
    v_mfma_f32_16x16x32_bf16 v[128:131], a[236:239], v[228:231], v[128:131]
    v_fmac_f32 v249, s29, v208
    v_cvt_pk_bf16_f32 v206, v248, v206
    v_mfma_f32_16x16x32_bf16 v[108:111], a[240:243], v[228:231], v[108:111]
    v_cvt_pk_bf16_f32 v212, v251, v212
    v_cvt_pk_bf16_f32 v210, v250, v210
    v_mfma_f32_16x16x32_bf16 v[112:115], a[244:247], v[228:231], v[112:115]
    buffer_load_dwordx4 a[220:223], v254, s[8:11], s42 offen offset:1024 sc1
    v_mfma_f32_16x16x32_bf16 v[116:119], a[248:251], v[228:231], v[116:119]
    s_waitcnt vmcnt(14)
    v_cvt_pk_bf16_f32 v208, v252, v249
    v_lshlrev_b32 v248, 16, v207
    v_mfma_f32_16x16x32_bf16 v[96:99], a[252:255], v[228:231], v[96:99]
    s_waitcnt lgkmcnt(1)
    v_lshlrev_b32 v249, 16, v209
    v_lshlrev_b32 v250, 16, v211
    v_mfma_f32_16x16x32_bf16 v[100:103], v[240:243], v[228:231], v[100:103]
    buffer_load_dwordx4 a[224:227], v254, s[8:11], s42 offen offset:2048 sc1
    v_mfma_f32_16x16x32_bf16 v[104:107], v[244:247], v[228:231], v[104:107]
    ds_read_b128 v[228:231], v253 offset:33024
    v_and_b32 v203, 0x7fff, v255
    v_mfma_f32_16x16x32_bf16 v[132:135], a[228:231], v[232:235], v[132:135]
    v_lshlrev_b32 v251, 16, v213
    v_and_b32 v207, s22, v207
    v_mfma_f32_16x16x32_bf16 v[136:139], a[232:235], v[232:235], v[136:139]
    buffer_load_dwordx2 v[192:193], v203, s[4:7], s16 offen offset:576
    v_mfma_f32_16x16x32_bf16 v[140:143], a[236:239], v[232:235], v[140:143]
    v_and_b32 v209, s22, v209
    v_and_b32 v211, s22, v211
    v_mfma_f32_16x16x32_bf16 v[120:123], a[240:243], v[232:235], v[120:123]
    v_and_b32 v213, s22, v213
    v_lshlrev_b32 v252, 16, v205
    v_mfma_f32_16x16x32_bf16 v[124:127], a[244:247], v[232:235], v[124:127]
    buffer_load_dwordx2 v[194:195], v203, s[4:7], s17 offen offset:576
    v_mfma_f32_16x16x32_bf16 v[128:131], a[248:251], v[232:235], v[128:131]
    v_and_b32 v205, s22, v205
    v_add_f32 v252, v252, v251
    v_mfma_f32_16x16x32_bf16 v[108:111], a[252:255], v[232:235], v[108:111]
    s_waitcnt lgkmcnt(1)
    v_add_f32 v205, v205, v213
    v_fmac_f32 v252, s23, v249
    v_mfma_f32_16x16x32_bf16 v[112:115], v[240:243], v[232:235], v[112:115]
    buffer_load_dwordx2 v[196:197], v203, s[4:7], s18 offen offset:576
    v_mfma_f32_16x16x32_bf16 v[116:119], v[244:247], v[232:235], v[116:119]
    ds_read_b128 v[232:235], v253 offset:32768
    v_fmac_f32 v205, s23, v209
    v_mfma_f32_16x16x32_bf16 v[144:147], a[228:231], v[236:239], v[144:147]
    v_cvt_pk_bf16_f32 v205, v252, v205
    v_lshlrev_b32 v252, 16, v215
    v_mfma_f32_16x16x32_bf16 v[148:151], a[232:235], v[236:239], v[148:151]
    buffer_load_dwordx2 v[198:199], v203, s[4:7], s19 offen offset:576
    v_mfma_f32_16x16x32_bf16 v[152:155], a[236:239], v[236:239], v[152:155]
    v_and_b32 v215, s22, v215
    v_add_f32 v252, v252, v248
    v_mfma_f32_16x16x32_bf16 v[132:135], a[240:243], v[236:239], v[132:135]
    v_add_f32 v215, v215, v207
    v_fmac_f32 v252, s23, v250
    v_mfma_f32_16x16x32_bf16 v[136:139], a[244:247], v[236:239], v[136:139]
    buffer_load_dwordx2 v[200:201], v203, s[4:7], s20 offen offset:576
    v_mfma_f32_16x16x32_bf16 v[140:143], a[248:251], v[236:239], v[140:143]
    v_fmac_f32 v215, s23, v211
    v_cvt_pk_bf16_f32 v215, v252, v215
    v_mfma_f32_16x16x32_bf16 v[120:123], a[252:255], v[236:239], v[120:123]
    s_waitcnt lgkmcnt(1)
    v_fma_f32 v252, v249, s24, v251
    v_fmac_f32 v251, s25, v249
    v_mfma_f32_16x16x32_bf16 v[124:127], v[240:243], v[236:239], v[124:127]
    buffer_load_dwordx2 v[202:203], v203, s[4:7], s21 offen offset:576
    v_mfma_f32_16x16x32_bf16 v[128:131], v[244:247], v[236:239], v[128:131]
    ds_read_b128 v[236:239], v253 offset:32512
    v_fma_f32 v249, v248, s24, v250
    v_mfma_f32_16x16x32_bf16 v[156:159], a[228:231], v[228:231], v[156:159]
    v_fmac_f32 v250, s25, v248
    v_fma_f32 v248, v250, s26, v251
    v_mfma_f32_16x16x32_bf16 v[160:163], a[232:235], v[228:231], v[160:163]
    v_fmac_f32 v251, s27, v250
    v_fma_f32 v250, v249, s28, v252
    v_mfma_f32_16x16x32_bf16 v[164:167], a[236:239], v[228:231], v[164:167]
    v_fmac_f32 v252, s29, v249
    v_fma_f32 v249, v209, s24, v213
    v_mfma_f32_16x16x32_bf16 v[144:147], a[240:243], v[228:231], v[144:147]
    v_fmac_f32 v213, s25, v209
    v_fma_f32 v209, v207, s24, v211
    v_mfma_f32_16x16x32_bf16 v[148:151], a[244:247], v[228:231], v[148:151]
    v_fmac_f32 v211, s25, v207
    v_fma_f32 v207, v211, s26, v213
    v_mfma_f32_16x16x32_bf16 v[152:155], a[248:251], v[228:231], v[152:155]
    v_fmac_f32 v213, s27, v211
    v_fma_f32 v211, v209, s28, v249
    v_mfma_f32_16x16x32_bf16 v[132:135], a[252:255], v[228:231], v[132:135]
    v_fmac_f32 v249, s29, v209
    v_cvt_pk_bf16_f32 v207, v248, v207
    v_mfma_f32_16x16x32_bf16 v[136:139], v[240:243], v[228:231], v[136:139]
    s_waitcnt lgkmcnt(1)
    v_cvt_pk_bf16_f32 v213, v251, v213
    v_cvt_pk_bf16_f32 v211, v250, v211
    v_mfma_f32_16x16x32_bf16 v[140:143], v[244:247], v[228:231], v[140:143]
    ds_read_b128 v[228:231], v253 offset:32256
    v_cvt_pk_bf16_f32 v209, v252, v249
    v_mfma_f32_16x16x32_bf16 v[168:171], a[228:231], v[232:235], v[168:171]
    v_lshrrev_b32 v252, 15, v255
    v_mfma_f32_16x16x32_bf16 v[172:175], a[232:235], v[232:235], v[172:175]
    ds_write_b64 v252, v[206:207] offset:0
    v_mfma_f32_16x16x32_bf16 v[176:179], a[236:239], v[232:235], v[176:179]
    s_waitcnt vmcnt(15)
    v_lshlrev_b32 v248, 16, v218
    v_lshlrev_b32 v249, 16, v220
    v_mfma_f32_16x16x32_bf16 v[156:159], a[240:243], v[232:235], v[156:159]
    ds_write_b64 v252, v[212:213] offset:2080
    v_mfma_f32_16x16x32_bf16 v[160:163], a[244:247], v[232:235], v[160:163]
    v_lshlrev_b32 v250, 16, v222
    v_lshlrev_b32 v251, 16, v224
    v_mfma_f32_16x16x32_bf16 v[164:167], a[248:251], v[232:235], v[164:167]
    ds_write_b64 v252, v[210:211] offset:4160
    v_mfma_f32_16x16x32_bf16 v[144:147], a[252:255], v[232:235], v[144:147]
    s_waitcnt lgkmcnt(4)
    v_and_b32 v218, s22, v218
    v_and_b32 v220, s22, v220
    v_mfma_f32_16x16x32_bf16 v[148:151], v[240:243], v[232:235], v[148:151]
    ds_write_b64 v252, v[204:205] offset:16640
    v_mfma_f32_16x16x32_bf16 v[152:155], v[244:247], v[232:235], v[152:155]
    ds_read_b128 v[232:235], v253 offset:31984
    v_and_b32 v222, s22, v222
    v_mfma_f32_16x16x32_bf16 v[180:183], a[228:231], v[236:239], v[180:183]
    v_and_b32 v224, s22, v224
    v_mfma_f32_16x16x32_bf16 v[184:187], a[232:235], v[236:239], v[184:187]
    ds_write_b64 v252, v[214:215] offset:24960
    v_mfma_f32_16x16x32_bf16 v[188:191], a[236:239], v[236:239], v[188:191]
    s_add_u32 s42, s32, 331776
    v_mfma_f32_16x16x32_bf16 v[168:171], a[240:243], v[236:239], v[168:171]
    buffer_load_dwordx4 a[228:231], v254, s[8:11], s42 offen offset:0 sc1
    v_mfma_f32_16x16x32_bf16 v[172:175], a[244:247], v[236:239], v[172:175]
    ds_write_b64 v252, v[208:209] offset:6240
    v_mfma_f32_16x16x32_bf16 v[176:179], a[248:251], v[236:239], v[176:179]
    s_waitcnt lgkmcnt(7)
    v_mfma_f32_16x16x32_bf16 v[156:159], a[252:255], v[236:239], v[156:159]
    buffer_load_dwordx4 a[232:235], v254, s[8:11], s42 offen offset:1024 sc1
    v_mfma_f32_16x16x32_bf16 v[160:163], v[240:243], v[236:239], v[160:163]
    s_waitcnt lgkmcnt(0)
    v_lshlrev_b32 v252, 16, v216
    v_and_b32 v216, s22, v216
    v_mfma_f32_16x16x32_bf16 v[164:167], v[244:247], v[236:239], v[164:167]
    s_barrier
    v_mfma_f32_16x16x32_bf16 v[180:183], a[240:243], v[228:231], v[180:183]
    ds_read_b128 v[236:239], v253 offset:1040
    v_add_f32 v252, v252, v251
    v_mfma_f32_16x16x32_bf16 v[184:187], a[244:247], v[228:231], v[184:187]
    v_add_f32 v216, v216, v224
    v_fmac_f32 v252, s23, v249
    v_mfma_f32_16x16x32_bf16 v[188:191], a[248:251], v[228:231], v[188:191]
    buffer_load_dwordx4 a[236:239], v254, s[8:11], s42 offen offset:2048 sc1
    v_mfma_f32_16x16x32_bf16 v[168:171], a[252:255], v[228:231], v[168:171]
    v_fmac_f32 v216, s23, v220
    v_cvt_pk_bf16_f32 v216, v252, v216
    v_mfma_f32_16x16x32_bf16 v[172:175], v[240:243], v[228:231], v[172:175]
    s_add_u32 s42, s32, 334848
    v_lshlrev_b32 v252, 16, v226
    v_and_b32 v226, s22, v226
    v_mfma_f32_16x16x32_bf16 v[176:179], v[244:247], v[228:231], v[176:179]
    ds_read_b128 v[228:231], v253 offset:768
    v_add_f32 v252, v252, v248
    v_mfma_f32_16x16x32_bf16 v[180:183], a[252:255], v[232:235], v[180:183]
    buffer_load_dwordx4 a[240:243], v254, s[8:11], s42 offen offset:0 sc1
    v_mfma_f32_16x16x32_bf16 v[184:187], v[240:243], v[232:235], v[184:187]
    s_waitcnt vmcnt(16) lgkmcnt(1)
    v_add_f32 v226, v226, v218
    v_fmac_f32 v252, s23, v250
    v_mfma_f32_16x16x32_bf16 v[188:191], v[244:247], v[232:235], v[188:191]
    ds_read_b128 v[232:235], v253 offset:512
    v_fmac_f32 v226, s23, v222
    v_mfma_f32_16x16x32_bf16 a[0:3], a[192:195], v[236:239], a[0:3]
    s_waitcnt lgkmcnt(1)
    v_cvt_pk_bf16_f32 v226, v252, v226
    v_fma_f32 v252, v249, s24, v251
    v_mfma_f32_16x16x32_bf16 a[4:7], a[196:199], v[236:239], a[4:7]
    buffer_load_dwordx4 a[244:247], v254, s[8:11], s42 offen offset:1024 sc1
    v_mfma_f32_16x16x32_bf16 a[8:11], a[200:203], v[236:239], a[8:11]
    ds_read_b128 v[236:239], v253 offset:256
    v_fmac_f32 v251, s25, v249
    v_mfma_f32_16x16x32_bf16 a[12:15], a[192:195], v[228:231], a[12:15]
    v_fma_f32 v249, v248, s24, v250
    v_fmac_f32 v250, s25, v248
    v_fma_f32 v248, v250, s26, v251
    v_mfma_f32_16x16x32_bf16 a[16:19], a[196:199], v[228:231], a[16:19]
    s_waitcnt vmcnt(14)
    v_fmac_f32 v251, s27, v250
    v_fma_f32 v250, v249, s28, v252
    v_mfma_f32_16x16x32_bf16 a[20:23], a[200:203], v[228:231], a[20:23]
    buffer_load_dwordx4 a[248:251], v254, s[8:11], s42 offen offset:2048 sc1
    v_mfma_f32_16x16x32_bf16 a[0:3], a[204:207], v[228:231], a[0:3]
    s_waitcnt lgkmcnt(1)
    v_fmac_f32 v252, s29, v249
    v_fma_f32 v249, v220, s24, v224
    v_mfma_f32_16x16x32_bf16 a[4:7], a[208:211], v[228:231], a[4:7]
    s_add_u32 s42, s32, 337920
    v_fmac_f32 v224, s25, v220
    v_fma_f32 v220, v218, s24, v222
    v_mfma_f32_16x16x32_bf16 a[8:11], a[212:215], v[228:231], a[8:11]
    ds_read_b128 v[228:231], v253 offset:0
    v_fmac_f32 v222, s25, v218
    v_mfma_f32_16x16x32_bf16 a[24:27], a[192:195], v[232:235], a[24:27]
    buffer_load_dwordx4 a[252:255], v254, s[8:11], s42 offen offset:0 sc1
    v_mfma_f32_16x16x32_bf16 a[28:31], a[196:199], v[232:235], a[28:31]
    v_fma_f32 v218, v222, s26, v224
    v_fmac_f32 v224, s27, v222
    v_mfma_f32_16x16x32_bf16 a[32:35], a[200:203], v[232:235], a[32:35]
    v_fma_f32 v222, v220, s28, v249
    v_fmac_f32 v249, s29, v220
    v_mfma_f32_16x16x32_bf16 a[12:15], a[204:207], v[232:235], a[12:15]
    v_cvt_pk_bf16_f32 v218, v248, v218
    v_cvt_pk_bf16_f32 v224, v251, v224
    v_mfma_f32_16x16x32_bf16 a[16:19], a[208:211], v[232:235], a[16:19]
    buffer_load_dwordx4 v[240:243], v254, s[8:11], s42 offen offset:1024 sc1
    v_mfma_f32_16x16x32_bf16 a[20:23], a[212:215], v[232:235], a[20:23]
    s_waitcnt vmcnt(14)
    v_cvt_pk_bf16_f32 v222, v250, v222
    v_cvt_pk_bf16_f32 v220, v252, v249
    v_mfma_f32_16x16x32_bf16 a[0:3], a[216:219], v[232:235], a[0:3]
    s_waitcnt lgkmcnt(1)
    v_lshlrev_b32 v248, 16, v219
    v_lshlrev_b32 v249, 16, v221
    v_mfma_f32_16x16x32_bf16 a[4:7], a[220:223], v[232:235], a[4:7]
    buffer_load_dwordx4 v[244:247], v254, s[8:11], s42 offen offset:2048 sc1
    v_mfma_f32_16x16x32_bf16 a[8:11], a[224:227], v[232:235], a[8:11]
    ds_read_b128 v[232:235], v253 offset:1824
    v_and_b32 v215, 0x7fff, v255
    v_mfma_f32_16x16x32_bf16 a[36:39], a[192:195], v[236:239], a[36:39]
    v_lshlrev_b32 v250, 16, v223
    v_lshlrev_b32 v251, 16, v225
    v_mfma_f32_16x16x32_bf16 a[40:43], a[196:199], v[236:239], a[40:43]
    buffer_load_dwordx2 v[204:205], v215, s[4:7], s16 offen offset:960
    v_mfma_f32_16x16x32_bf16 a[44:47], a[200:203], v[236:239], a[44:47]
    v_and_b32 v219, s22, v219
    v_and_b32 v221, s22, v221
    v_mfma_f32_16x16x32_bf16 a[24:27], a[204:207], v[236:239], a[24:27]
    v_and_b32 v223, s22, v223
    v_and_b32 v225, s22, v225
    v_mfma_f32_16x16x32_bf16 a[28:31], a[208:211], v[236:239], a[28:31]
    buffer_load_dwordx2 v[206:207], v215, s[4:7], s17 offen offset:960
    v_mfma_f32_16x16x32_bf16 a[32:35], a[212:215], v[236:239], a[32:35]
    v_lshlrev_b32 v252, 16, v217
    v_and_b32 v217, s22, v217
    v_add_f32 v252, v252, v251
    v_mfma_f32_16x16x32_bf16 a[12:15], a[216:219], v[236:239], a[12:15]
    s_waitcnt lgkmcnt(1)
    v_add_f32 v217, v217, v225
    v_fmac_f32 v252, s23, v249
    v_mfma_f32_16x16x32_bf16 a[16:19], a[220:223], v[236:239], a[16:19]
    buffer_load_dwordx2 v[208:209], v215, s[4:7], s18 offen offset:960
    v_mfma_f32_16x16x32_bf16 a[20:23], a[224:227], v[236:239], a[20:23]
    ds_read_b128 v[236:239], v253 offset:1568
    v_fmac_f32 v217, s23, v221
    v_mfma_f32_16x16x32_bf16 a[48:51], a[192:195], v[228:231], a[48:51]
    v_cvt_pk_bf16_f32 v217, v252, v217
    v_lshlrev_b32 v252, 16, v227
    v_mfma_f32_16x16x32_bf16 a[52:55], a[196:199], v[228:231], a[52:55]
    buffer_load_dwordx2 v[210:211], v215, s[4:7], s19 offen offset:960
    v_mfma_f32_16x16x32_bf16 a[56:59], a[200:203], v[228:231], a[56:59]
    v_and_b32 v227, s22, v227
    v_add_f32 v252, v252, v248
    v_mfma_f32_16x16x32_bf16 a[36:39], a[204:207], v[228:231], a[36:39]
    v_add_f32 v227, v227, v219
    v_fmac_f32 v252, s23, v250
    v_mfma_f32_16x16x32_bf16 a[40:43], a[208:211], v[228:231], a[40:43]
    buffer_load_dwordx2 v[212:213], v215, s[4:7], s20 offen offset:960
    v_mfma_f32_16x16x32_bf16 a[44:47], a[212:215], v[228:231], a[44:47]
    v_fmac_f32 v227, s23, v223
    v_cvt_pk_bf16_f32 v227, v252, v227
    v_mfma_f32_16x16x32_bf16 a[24:27], a[216:219], v[228:231], a[24:27]
    s_waitcnt lgkmcnt(1)
    v_fma_f32 v252, v249, s24, v251
    v_fmac_f32 v251, s25, v249
    v_mfma_f32_16x16x32_bf16 a[28:31], a[220:223], v[228:231], a[28:31]
    buffer_load_dwordx2 v[214:215], v215, s[4:7], s21 offen offset:960
    v_mfma_f32_16x16x32_bf16 a[32:35], a[224:227], v[228:231], a[32:35]
    ds_read_b128 v[228:231], v253 offset:1312
    v_fma_f32 v249, v248, s24, v250
    v_mfma_f32_16x16x32_bf16 a[60:63], a[192:195], v[232:235], a[60:63]
    v_fmac_f32 v250, s25, v248
    v_fma_f32 v248, v250, s26, v251
    v_mfma_f32_16x16x32_bf16 a[64:67], a[196:199], v[232:235], a[64:67]
    v_fmac_f32 v251, s27, v250
    v_fma_f32 v250, v249, s28, v252
    v_mfma_f32_16x16x32_bf16 a[68:71], a[200:203], v[232:235], a[68:71]
    v_fmac_f32 v252, s29, v249
    v_fma_f32 v249, v221, s24, v225
    v_mfma_f32_16x16x32_bf16 a[48:51], a[204:207], v[232:235], a[48:51]
    v_fmac_f32 v225, s25, v221
    v_fma_f32 v221, v219, s24, v223
    v_mfma_f32_16x16x32_bf16 a[52:55], a[208:211], v[232:235], a[52:55]
    v_fmac_f32 v223, s25, v219
    v_fma_f32 v219, v223, s26, v225
    v_mfma_f32_16x16x32_bf16 a[56:59], a[212:215], v[232:235], a[56:59]
    v_fmac_f32 v225, s27, v223
    v_fma_f32 v223, v221, s28, v249
    v_mfma_f32_16x16x32_bf16 a[36:39], a[216:219], v[232:235], a[36:39]
    v_fmac_f32 v249, s29, v221
    v_cvt_pk_bf16_f32 v219, v248, v219
    v_mfma_f32_16x16x32_bf16 a[40:43], a[220:223], v[232:235], a[40:43]
    s_waitcnt lgkmcnt(1)
    v_cvt_pk_bf16_f32 v225, v251, v225
    v_cvt_pk_bf16_f32 v223, v250, v223
    v_cvt_pk_bf16_f32 v221, v252, v249
    v_mfma_f32_16x16x32_bf16 a[44:47], a[224:227], v[232:235], a[44:47]
    ds_read_b128 v[232:235], v253 offset:1056
    v_lshrrev_b32 v252, 15, v255
    v_mfma_f32_16x16x32_bf16 a[72:75], a[192:195], v[236:239], a[72:75]
    ds_write_b64 v252, v[218:219] offset:9088
    v_mfma_f32_16x16x32_bf16 a[76:79], a[196:199], v[236:239], a[76:79]
    s_waitcnt vmcnt(15)
    v_lshlrev_b32 v248, 16, v194
    v_lshlrev_b32 v249, 16, v196
    v_mfma_f32_16x16x32_bf16 a[80:83], a[200:203], v[236:239], a[80:83]
    ds_write_b64 v252, v[224:225] offset:11168
    v_mfma_f32_16x16x32_bf16 a[60:63], a[204:207], v[236:239], a[60:63]
    v_lshlrev_b32 v250, 16, v198
    v_lshlrev_b32 v251, 16, v200
    v_mfma_f32_16x16x32_bf16 a[64:67], a[208:211], v[236:239], a[64:67]
    ds_write_b64 v252, v[222:223] offset:13248
    v_mfma_f32_16x16x32_bf16 a[68:71], a[212:215], v[236:239], a[68:71]
    v_and_b32 v194, s22, v194
    v_and_b32 v196, s22, v196
    v_mfma_f32_16x16x32_bf16 a[48:51], a[216:219], v[236:239], a[48:51]
    ds_write_b64 v252, v[216:217] offset:19488
    v_mfma_f32_16x16x32_bf16 a[52:55], a[220:223], v[236:239], a[52:55]
    s_waitcnt lgkmcnt(5)
    v_and_b32 v198, s22, v198
    v_and_b32 v200, s22, v200
    v_mfma_f32_16x16x32_bf16 a[56:59], a[224:227], v[236:239], a[56:59]
    ds_read_b128 v[236:239], v253 offset:784
    v_mfma_f32_16x16x32_bf16 a[84:87], a[192:195], v[228:231], a[84:87]
    ds_write_b64 v252, v[226:227] offset:27808
    v_mfma_f32_16x16x32_bf16 a[88:91], a[196:199], v[228:231], a[88:91]
    v_mfma_f32_16x16x32_bf16 a[92:95], a[200:203], v[228:231], a[92:95]
    s_add_u32 s42, s32, 368640
    v_mfma_f32_16x16x32_bf16 a[72:75], a[204:207], v[228:231], a[72:75]
    buffer_load_dwordx4 a[192:195], v254, s[8:11], s42 offen offset:0 sc1
    v_mfma_f32_16x16x32_bf16 a[76:79], a[208:211], v[228:231], a[76:79]
    ds_write_b64 v252, v[220:221] offset:31968
    v_mfma_f32_16x16x32_bf16 a[80:83], a[212:215], v[228:231], a[80:83]
    v_mfma_f32_16x16x32_bf16 a[60:63], a[216:219], v[228:231], a[60:63]
    buffer_load_dwordx4 a[196:199], v254, s[8:11], s42 offen offset:1024 sc1
    v_mfma_f32_16x16x32_bf16 a[64:67], a[220:223], v[228:231], a[64:67]
    v_lshlrev_b32 v252, 16, v192
    v_and_b32 v192, s22, v192
    v_mfma_f32_16x16x32_bf16 a[68:71], a[224:227], v[228:231], a[68:71]
    s_waitcnt lgkmcnt(7)
    v_add_f32 v252, v252, v251
    v_add_f32 v192, v192, v200
    v_mfma_f32_16x16x32_bf16 a[84:87], a[204:207], v[232:235], a[84:87]
    ds_read_b128 v[228:231], v253 offset:3120
    v_fmac_f32 v252, s23, v249
    v_mfma_f32_16x16x32_bf16 a[88:91], a[208:211], v[232:235], a[88:91]
    v_fmac_f32 v192, s23, v196
    v_cvt_pk_bf16_f32 v192, v252, v192
    v_mfma_f32_16x16x32_bf16 a[92:95], a[212:215], v[232:235], a[92:95]
    buffer_load_dwordx4 a[200:203], v254, s[8:11], s42 offen offset:2048 sc1
    v_mfma_f32_16x16x32_bf16 a[72:75], a[216:219], v[232:235], a[72:75]
    s_waitcnt lgkmcnt(3)
    v_lshlrev_b32 v252, 16, v202
    v_and_b32 v202, s22, v202
    v_mfma_f32_16x16x32_bf16 a[76:79], a[220:223], v[232:235], a[76:79]
    s_add_u32 s42, s32, 371712
    v_add_f32 v252, v252, v248
    v_add_f32 v202, v202, v194
    v_mfma_f32_16x16x32_bf16 a[80:83], a[224:227], v[232:235], a[80:83]
    ds_read_b128 v[232:235], v253 offset:2848
    v_fmac_f32 v252, s23, v250
    v_mfma_f32_16x16x32_bf16 a[84:87], a[216:219], v[236:239], a[84:87]
    buffer_load_dwordx4 a[204:207], v254, s[8:11], s42 offen offset:0 sc1
    v_mfma_f32_16x16x32_bf16 a[88:91], a[220:223], v[236:239], a[88:91]
    s_waitcnt vmcnt(16) lgkmcnt(1)
    v_fmac_f32 v202, s23, v198
    v_cvt_pk_bf16_f32 v202, v252, v202
    v_mfma_f32_16x16x32_bf16 a[92:95], a[224:227], v[236:239], a[92:95]
    ds_read_b128 v[236:239], v253 offset:2592
    v_fma_f32 v252, v249, s24, v251
    v_mfma_f32_16x16x32_bf16 a[96:99], a[228:231], v[228:231], a[96:99]
    s_waitcnt lgkmcnt(1)
    v_fmac_f32 v251, s25, v249
    v_fma_f32 v249, v248, s24, v250
    v_mfma_f32_16x16x32_bf16 a[100:103], a[232:235], v[228:231], a[100:103]
    buffer_load_dwordx4 a[208:211], v254, s[8:11], s42 offen offset:1024 sc1
    v_mfma_f32_16x16x32_bf16 a[104:107], a[236:239], v[228:231], a[104:107]
    ds_read_b128 v[228:231], v253 offset:2336
    v_fmac_f32 v250, s25, v248
    v_mfma_f32_16x16x32_bf16 a[108:111], a[228:231], v[232:235], a[108:111]
    v_fma_f32 v248, v250, s26, v251
    v_fmac_f32 v251, s27, v250
    v_mfma_f32_16x16x32_bf16 a[112:115], a[232:235], v[232:235], a[112:115]
    s_waitcnt vmcnt(14)
    v_fma_f32 v250, v249, s28, v252
    v_fmac_f32 v252, s29, v249
    v_mfma_f32_16x16x32_bf16 a[116:119], a[236:239], v[232:235], a[116:119]
    buffer_load_dwordx4 a[212:215], v254, s[8:11], s42 offen offset:2048 sc1
    v_mfma_f32_16x16x32_bf16 a[96:99], a[240:243], v[232:235], a[96:99]
    s_waitcnt lgkmcnt(1)
    v_fma_f32 v249, v196, s24, v200
    v_fmac_f32 v200, s25, v196
    v_mfma_f32_16x16x32_bf16 a[100:103], a[244:247], v[232:235], a[100:103]
    s_add_u32 s42, s32, 374784
    v_fma_f32 v196, v194, s24, v198
    v_fmac_f32 v198, s25, v194
    v_mfma_f32_16x16x32_bf16 a[104:107], a[248:251], v[232:235], a[104:107]
    ds_read_b128 v[232:235], v253 offset:2080
    v_fma_f32 v194, v198, s26, v200
    v_mfma_f32_16x16x32_bf16 a[120:123], a[228:231], v[236:239], a[120:123]
    buffer_load_dwordx4 a[216:219], v254, s[8:11], s42 offen offset:0 sc1
    v_mfma_f32_16x16x32_bf16 a[124:127], a[232:235], v[236:239], a[124:127]
    v_fmac_f32 v200, s27, v198
    v_fma_f32 v198, v196, s28, v249
    v_mfma_f32_16x16x32_bf16 a[128:131], a[236:239], v[236:239], a[128:131]
    v_fmac_f32 v249, s29, v196
    v_cvt_pk_bf16_f32 v194, v248, v194
    v_mfma_f32_16x16x32_bf16 a[108:111], a[240:243], v[236:239], a[108:111]
    v_cvt_pk_bf16_f32 v200, v251, v200
    v_cvt_pk_bf16_f32 v198, v250, v198
    v_mfma_f32_16x16x32_bf16 a[112:115], a[244:247], v[236:239], a[112:115]
    buffer_load_dwordx4 a[220:223], v254, s[8:11], s42 offen offset:1024 sc1
    v_mfma_f32_16x16x32_bf16 a[116:119], a[248:251], v[236:239], a[116:119]
    s_waitcnt vmcnt(14)
    v_cvt_pk_bf16_f32 v196, v252, v249
    v_lshlrev_b32 v248, 16, v195
    v_mfma_f32_16x16x32_bf16 a[96:99], a[252:255], v[236:239], a[96:99]
    s_waitcnt lgkmcnt(1)
    v_lshlrev_b32 v249, 16, v197
    v_lshlrev_b32 v250, 16, v199
    v_mfma_f32_16x16x32_bf16 a[100:103], v[240:243], v[236:239], a[100:103]
    buffer_load_dwordx4 a[224:227], v254, s[8:11], s42 offen offset:2048 sc1
    v_mfma_f32_16x16x32_bf16 a[104:107], v[244:247], v[236:239], a[104:107]
    ds_read_b128 v[236:239], v253 offset:3904
    v_and_b32 v227, 0x7fff, v255
    v_mfma_f32_16x16x32_bf16 a[132:135], a[228:231], v[228:231], a[132:135]
    v_lshlrev_b32 v251, 16, v201
    v_and_b32 v195, s22, v195
    v_mfma_f32_16x16x32_bf16 a[136:139], a[232:235], v[228:231], a[136:139]
    buffer_load_dwordx2 v[216:217], v227, s[4:7], s16 offen offset:1344
    v_mfma_f32_16x16x32_bf16 a[140:143], a[236:239], v[228:231], a[140:143]
    v_and_b32 v197, s22, v197
    v_and_b32 v199, s22, v199
    v_mfma_f32_16x16x32_bf16 a[120:123], a[240:243], v[228:231], a[120:123]
    v_and_b32 v201, s22, v201
    v_lshlrev_b32 v252, 16, v193
    v_mfma_f32_16x16x32_bf16 a[124:127], a[244:247], v[228:231], a[124:127]
    buffer_load_dwordx2 v[218:219], v227, s[4:7], s17 offen offset:1344
    v_mfma_f32_16x16x32_bf16 a[128:131], a[248:251], v[228:231], a[128:131]
    v_and_b32 v193, s22, v193
    v_add_f32 v252, v252, v251
    v_mfma_f32_16x16x32_bf16 a[108:111], a[252:255], v[228:231], a[108:111]
    s_waitcnt lgkmcnt(1)
    v_add_f32 v193, v193, v201
    v_fmac_f32 v252, s23, v249
    v_mfma_f32_16x16x32_bf16 a[112:115], v[240:243], v[228:231], a[112:115]
    buffer_load_dwordx2 v[220:221], v227, s[4:7], s18 offen offset:1344
    v_mfma_f32_16x16x32_bf16 a[116:119], v[244:247], v[228:231], a[116:119]
    ds_read_b128 v[228:231], v253 offset:3648
    v_fmac_f32 v193, s23, v197
    v_mfma_f32_16x16x32_bf16 a[144:147], a[228:231], v[232:235], a[144:147]
    v_cvt_pk_bf16_f32 v193, v252, v193
    v_lshlrev_b32 v252, 16, v203
    v_mfma_f32_16x16x32_bf16 a[148:151], a[232:235], v[232:235], a[148:151]
    buffer_load_dwordx2 v[222:223], v227, s[4:7], s19 offen offset:1344
    v_mfma_f32_16x16x32_bf16 a[152:155], a[236:239], v[232:235], a[152:155]
    v_and_b32 v203, s22, v203
    v_add_f32 v252, v252, v248
    v_mfma_f32_16x16x32_bf16 a[132:135], a[240:243], v[232:235], a[132:135]
    v_add_f32 v203, v203, v195
    v_fmac_f32 v252, s23, v250
    v_mfma_f32_16x16x32_bf16 a[136:139], a[244:247], v[232:235], a[136:139]
    buffer_load_dwordx2 v[224:225], v227, s[4:7], s20 offen offset:1344
    v_mfma_f32_16x16x32_bf16 a[140:143], a[248:251], v[232:235], a[140:143]
    v_fmac_f32 v203, s23, v199
    v_cvt_pk_bf16_f32 v203, v252, v203
    v_mfma_f32_16x16x32_bf16 a[120:123], a[252:255], v[232:235], a[120:123]
    s_waitcnt lgkmcnt(1)
    v_fma_f32 v252, v249, s24, v251
    v_fmac_f32 v251, s25, v249
    v_mfma_f32_16x16x32_bf16 a[124:127], v[240:243], v[232:235], a[124:127]
    buffer_load_dwordx2 v[226:227], v227, s[4:7], s21 offen offset:1344
    v_mfma_f32_16x16x32_bf16 a[128:131], v[244:247], v[232:235], a[128:131]
    ds_read_b128 v[232:235], v253 offset:3392
    v_fma_f32 v249, v248, s24, v250
    v_mfma_f32_16x16x32_bf16 a[156:159], a[228:231], v[236:239], a[156:159]
    v_fmac_f32 v250, s25, v248
    v_fma_f32 v248, v250, s26, v251
    v_mfma_f32_16x16x32_bf16 a[160:163], a[232:235], v[236:239], a[160:163]
    v_fmac_f32 v251, s27, v250
    v_fma_f32 v250, v249, s28, v252
    v_mfma_f32_16x16x32_bf16 a[164:167], a[236:239], v[236:239], a[164:167]
    v_fmac_f32 v252, s29, v249
    v_fma_f32 v249, v197, s24, v201
    v_mfma_f32_16x16x32_bf16 a[144:147], a[240:243], v[236:239], a[144:147]
    v_fmac_f32 v201, s25, v197
    v_fma_f32 v197, v195, s24, v199
    v_mfma_f32_16x16x32_bf16 a[148:151], a[244:247], v[236:239], a[148:151]
    v_fmac_f32 v199, s25, v195
    v_fma_f32 v195, v199, s26, v201
    v_mfma_f32_16x16x32_bf16 a[152:155], a[248:251], v[236:239], a[152:155]
    v_fmac_f32 v201, s27, v199
    v_fma_f32 v199, v197, s28, v249
    v_mfma_f32_16x16x32_bf16 a[132:135], a[252:255], v[236:239], a[132:135]
    v_fmac_f32 v249, s29, v197
    v_cvt_pk_bf16_f32 v195, v248, v195
    v_mfma_f32_16x16x32_bf16 a[136:139], v[240:243], v[236:239], a[136:139]
    s_waitcnt lgkmcnt(1)
    v_cvt_pk_bf16_f32 v201, v251, v201
    v_cvt_pk_bf16_f32 v199, v250, v199
    v_mfma_f32_16x16x32_bf16 a[140:143], v[244:247], v[236:239], a[140:143]
    ds_read_b128 v[236:239], v253 offset:3136
    v_cvt_pk_bf16_f32 v197, v252, v249
    v_mfma_f32_16x16x32_bf16 a[168:171], a[228:231], v[228:231], a[168:171]
    v_lshrrev_b32 v252, 15, v255
    v_mfma_f32_16x16x32_bf16 a[172:175], a[232:235], v[228:231], a[172:175]
    ds_write_b64 v252, v[194:195] offset:8832
    v_mfma_f32_16x16x32_bf16 a[176:179], a[236:239], v[228:231], a[176:179]
    s_waitcnt vmcnt(15)
    v_lshlrev_b32 v248, 16, v206
    v_lshlrev_b32 v249, 16, v208
    v_mfma_f32_16x16x32_bf16 a[156:159], a[240:243], v[228:231], a[156:159]
    ds_write_b64 v252, v[200:201] offset:10912
    v_mfma_f32_16x16x32_bf16 a[160:163], a[244:247], v[228:231], a[160:163]
    v_lshlrev_b32 v250, 16, v210
    v_lshlrev_b32 v251, 16, v212
    v_mfma_f32_16x16x32_bf16 a[164:167], a[248:251], v[228:231], a[164:167]
    ds_write_b64 v252, v[198:199] offset:12992
    v_mfma_f32_16x16x32_bf16 a[144:147], a[252:255], v[228:231], a[144:147]
    s_waitcnt lgkmcnt(4)
    v_and_b32 v206, s22, v206
    v_and_b32 v208, s22, v208
    v_mfma_f32_16x16x32_bf16 a[148:151], v[240:243], v[228:231], a[148:151]
    ds_write_b64 v252, v[192:193] offset:19232
    v_mfma_f32_16x16x32_bf16 a[152:155], v[244:247], v[228:231], a[152:155]
    ds_read_b128 v[228:231], v253 offset:2864
    v_and_b32 v210, s22, v210
    v_mfma_f32_16x16x32_bf16 a[180:183], a[228:231], v[232:235], a[180:183]
    v_and_b32 v212, s22, v212
    v_mfma_f32_16x16x32_bf16 a[184:187], a[232:235], v[232:235], a[184:187]
    ds_write_b64 v252, v[202:203] offset:27552
    v_mfma_f32_16x16x32_bf16 a[188:191], a[236:239], v[232:235], a[188:191]
    s_add_u32 s42, s32, 405504
    v_mfma_f32_16x16x32_bf16 a[168:171], a[240:243], v[232:235], a[168:171]
    buffer_load_dwordx4 a[228:231], v254, s[8:11], s42 offen offset:0 sc1
    v_mfma_f32_16x16x32_bf16 a[172:175], a[244:247], v[232:235], a[172:175]
    ds_write_b64 v252, v[196:197] offset:31712
    v_mfma_f32_16x16x32_bf16 a[176:179], a[248:251], v[232:235], a[176:179]
    v_mfma_f32_16x16x32_bf16 a[156:159], a[252:255], v[232:235], a[156:159]
    buffer_load_dwordx4 a[232:235], v254, s[8:11], s42 offen offset:1024 sc1
    v_mfma_f32_16x16x32_bf16 a[160:163], v[240:243], v[232:235], a[160:163]
    v_lshlrev_b32 v252, 16, v204
    v_and_b32 v204, s22, v204
    v_mfma_f32_16x16x32_bf16 a[164:167], v[244:247], v[232:235], a[164:167]
    s_waitcnt lgkmcnt(2)
    v_add_f32 v252, v252, v251
    v_add_f32 v204, v204, v212
    v_mfma_f32_16x16x32_bf16 a[180:183], a[240:243], v[236:239], a[180:183]
    ds_read_b128 v[232:235], v253 offset:5200
    v_fmac_f32 v252, s23, v249
    v_mfma_f32_16x16x32_bf16 a[184:187], a[244:247], v[236:239], a[184:187]
    ds_read_b128 v[192:195], v253 offset:40096
    v_fmac_f32 v204, s23, v208
    v_mfma_f32_16x16x32_bf16 a[188:191], a[248:251], v[236:239], a[188:191]
    buffer_load_dwordx4 a[236:239], v254, s[8:11], s42 offen offset:2048 sc1
    v_cvt_pk_bf16_f32 v204, v252, v204
    v_mfma_f32_16x16x32_bf16 a[168:171], a[252:255], v[236:239], a[168:171]
    s_mov_b32 s45, 452138121
    v_lshlrev_b32 v252, 16, v214
    v_and_b32 v214, s22, v214
    v_mfma_f32_16x16x32_bf16 a[172:175], v[240:243], v[236:239], a[172:175]
    s_add_u32 s42, s32, 408576
    v_add_f32 v252, v252, v248
    v_add_f32 v214, v214, v206
    v_mfma_f32_16x16x32_bf16 a[176:179], v[244:247], v[236:239], a[176:179]
    ds_read_b128 v[236:239], v253 offset:4928
    v_bfe_u32 v196, v254, 5, 3
    v_mfma_f32_16x16x32_bf16 a[180:183], a[252:255], v[228:231], a[180:183]
    buffer_load_dwordx4 a[240:243], v254, s[8:11], s42 offen offset:0 sc1
    v_mfma_f32_16x16x32_bf16 a[184:187], v[240:243], v[228:231], a[184:187]
    s_waitcnt vmcnt(16) lgkmcnt(2)
    v_fmac_f32 v252, s23, v250
    v_fmac_f32 v214, s23, v210
    v_mfma_f32_16x16x32_bf16 a[188:191], v[244:247], v[228:231], a[188:191]
    ds_read_b128 v[228:231], v253 offset:4672
    v_mul_u32_u24 v197, 5, v196
    v_cvt_pk_bf16_f32 v214, v252, v214
    v_mfma_f32_16x16x32_bf16 v[0:3], a[192:195], v[232:235], v[0:3]
    s_waitcnt lgkmcnt(1)
    v_fma_f32 v252, v249, s24, v251
    v_fmac_f32 v251, s25, v249
    v_mfma_f32_16x16x32_bf16 v[4:7], a[196:199], v[232:235], v[4:7]
    buffer_load_dwordx4 a[244:247], v254, s[8:11], s42 offen offset:1024 sc1
    v_mfma_f32_16x16x32_bf16 v[8:11], a[200:203], v[232:235], v[8:11]
    ds_read_b128 v[232:235], v253 offset:4416
    v_bfe_u32 v197, s45, v197, 5
    v_mfma_f32_16x16x32_bf16 v[12:15], a[192:195], v[236:239], v[12:15]
    v_fma_f32 v249, v248, s24, v250
    v_fmac_f32 v250, s25, v248
    v_mfma_f32_16x16x32_bf16 v[16:19], a[196:199], v[236:239], v[16:19]
    s_waitcnt vmcnt(14)
    v_mul_u32_u24 v197, 65, v197
    v_fma_f32 v248, v250, s26, v251
    v_mfma_f32_16x16x32_bf16 v[20:23], a[200:203], v[236:239], v[20:23]
    buffer_load_dwordx4 a[248:251], v254, s[8:11], s42 offen offset:2048 sc1
    v_mfma_f32_16x16x32_bf16 v[0:3], a[204:207], v[236:239], v[0:3]
    s_waitcnt lgkmcnt(1)
    v_sub_u32 v197, v197, v196
    v_fmac_f32 v251, s27, v250
    v_fma_f32 v250, v249, s28, v252
    v_mfma_f32_16x16x32_bf16 v[4:7], a[208:211], v[236:239], v[4:7]
    s_add_u32 s42, s32, 411648
    v_fmac_f32 v252, s29, v249
    v_fma_f32 v249, v208, s24, v212
    v_mfma_f32_16x16x32_bf16 v[8:11], a[212:215], v[236:239], v[8:11]
    ds_read_b128 v[236:239], v253 offset:4160
    v_lshl_add_u32 v196, v197, 5, v253
    v_mfma_f32_16x16x32_bf16 v[24:27], a[192:195], v[228:231], v[24:27]
    buffer_load_dwordx4 a[252:255], v254, s[8:11], s42 offen offset:0 sc1
    v_mfma_f32_16x16x32_bf16 v[28:31], a[196:199], v[228:231], v[28:31]
    v_fmac_f32 v212, s25, v208
    v_fma_f32 v208, v206, s24, v210
    v_mfma_f32_16x16x32_bf16 v[32:35], a[200:203], v[228:231], v[32:35]
    v_fmac_f32 v210, s25, v206
    v_fma_f32 v206, v210, s26, v212
    v_mfma_f32_16x16x32_bf16 v[12:15], a[204:207], v[228:231], v[12:15]
    s_waitcnt vmcnt(13)
    v_fmac_f32 v212, s27, v210
    v_fma_f32 v210, v208, s28, v249
    v_mfma_f32_16x16x32_bf16 v[16:19], a[208:211], v[228:231], v[16:19]
    buffer_load_dwordx4 v[240:243], v254, s[8:11], s42 offen offset:1024 sc1
    v_fmac_f32 v249, s29, v208
    v_mfma_f32_16x16x32_bf16 v[20:23], a[212:215], v[228:231], v[20:23]
    s_mov_b64 exec, s[46:47]
    ds_write_b128 v196, v[192:195] offset:1024
    s_mov_b64 exec, -1
    v_mfma_f32_16x16x32_bf16 v[0:3], a[216:219], v[228:231], v[0:3]
    s_waitcnt lgkmcnt(2)
    v_cvt_pk_bf16_f32 v206, v248, v206
    v_cvt_pk_bf16_f32 v212, v251, v212
    v_mfma_f32_16x16x32_bf16 v[4:7], a[220:223], v[228:231], v[4:7]
    buffer_load_dwordx4 v[244:247], v254, s[8:11], s42 offen offset:2048 sc1
    v_mfma_f32_16x16x32_bf16 v[8:11], a[224:227], v[228:231], v[8:11]
    ds_read_b128 v[228:231], v253 offset:5984
    v_and_b32 v203, 0x7fff, v255
    v_mfma_f32_16x16x32_bf16 v[36:39], a[192:195], v[232:235], v[36:39]
    v_cvt_pk_bf16_f32 v210, v250, v210
    v_cvt_pk_bf16_f32 v208, v252, v249
    v_mfma_f32_16x16x32_bf16 v[40:43], a[196:199], v[232:235], v[40:43]
    buffer_load_dwordx2 v[192:193], v203, s[4:7], s16 offen offset:256
    v_lshlrev_b32 v248, 16, v207
    v_mfma_f32_16x16x32_bf16 v[44:47], a[200:203], v[232:235], v[44:47]
    v_lshlrev_b32 v249, 16, v209
    v_lshlrev_b32 v250, 16, v211
    v_mfma_f32_16x16x32_bf16 v[24:27], a[204:207], v[232:235], v[24:27]
    v_lshlrev_b32 v251, 16, v213
    v_and_b32 v207, s22, v207
    v_mfma_f32_16x16x32_bf16 v[28:31], a[208:211], v[232:235], v[28:31]
    buffer_load_dwordx2 v[194:195], v203, s[4:7], s17 offen offset:256
    v_mfma_f32_16x16x32_bf16 v[32:35], a[212:215], v[232:235], v[32:35]
    v_and_b32 v209, s22, v209
    v_and_b32 v211, s22, v211
    v_mfma_f32_16x16x32_bf16 v[12:15], a[216:219], v[232:235], v[12:15]
    s_waitcnt lgkmcnt(2)
    v_and_b32 v213, s22, v213
    v_lshlrev_b32 v252, 16, v205
    v_mfma_f32_16x16x32_bf16 v[16:19], a[220:223], v[232:235], v[16:19]
    buffer_load_dwordx2 v[196:197], v203, s[4:7], s18 offen offset:256
    v_mfma_f32_16x16x32_bf16 v[20:23], a[224:227], v[232:235], v[20:23]
    ds_read_b128 v[232:235], v253 offset:5728
    v_and_b32 v205, s22, v205
    v_add_f32 v252, v252, v251
    v_mfma_f32_16x16x32_bf16 v[48:51], a[192:195], v[236:239], v[48:51]
    v_add_f32 v205, v205, v213
    v_fmac_f32 v252, s23, v249
    v_mfma_f32_16x16x32_bf16 v[52:55], a[196:199], v[236:239], v[52:55]
    buffer_load_dwordx2 v[198:199], v203, s[4:7], s19 offen offset:256
    v_mfma_f32_16x16x32_bf16 v[56:59], a[200:203], v[236:239], v[56:59]
    v_fmac_f32 v205, s23, v209
    v_cvt_pk_bf16_f32 v205, v252, v205
    v_mfma_f32_16x16x32_bf16 v[36:39], a[204:207], v[236:239], v[36:39]
    v_lshlrev_b32 v252, 16, v215
    v_and_b32 v215, s22, v215
    v_mfma_f32_16x16x32_bf16 v[40:43], a[208:211], v[236:239], v[40:43]
    buffer_load_dwordx2 v[200:201], v203, s[4:7], s20 offen offset:256
    v_mfma_f32_16x16x32_bf16 v[44:47], a[212:215], v[236:239], v[44:47]
    v_add_f32 v252, v252, v248
    v_add_f32 v215, v215, v207
    v_mfma_f32_16x16x32_bf16 v[24:27], a[216:219], v[236:239], v[24:27]
    s_waitcnt lgkmcnt(1)
    v_fmac_f32 v252, s23, v250
    v_fmac_f32 v215, s23, v211
    v_cvt_pk_bf16_f32 v215, v252, v215
    v_mfma_f32_16x16x32_bf16 v[28:31], a[220:223], v[236:239], v[28:31]
    buffer_load_dwordx2 v[202:203], v203, s[4:7], s21 offen offset:256
    v_mfma_f32_16x16x32_bf16 v[32:35], a[224:227], v[236:239], v[32:35]
    ds_read_b128 v[236:239], v253 offset:5472
    v_fma_f32 v252, v249, s24, v251
    v_mfma_f32_16x16x32_bf16 v[60:63], a[192:195], v[228:231], v[60:63]
    v_fmac_f32 v251, s25, v249
    v_fma_f32 v249, v248, s24, v250
    v_mfma_f32_16x16x32_bf16 v[64:67], a[196:199], v[228:231], v[64:67]
    v_fmac_f32 v250, s25, v248
    v_fma_f32 v248, v250, s26, v251
    v_mfma_f32_16x16x32_bf16 v[68:71], a[200:203], v[228:231], v[68:71]
    v_fmac_f32 v251, s27, v250
    v_fma_f32 v250, v249, s28, v252
    v_mfma_f32_16x16x32_bf16 v[48:51], a[204:207], v[228:231], v[48:51]
    v_fmac_f32 v252, s29, v249
    v_fma_f32 v249, v209, s24, v213
    v_fmac_f32 v213, s25, v209
    v_mfma_f32_16x16x32_bf16 v[52:55], a[208:211], v[228:231], v[52:55]
    v_fma_f32 v209, v207, s24, v211
    v_fmac_f32 v211, s25, v207
    v_mfma_f32_16x16x32_bf16 v[56:59], a[212:215], v[228:231], v[56:59]
    v_fma_f32 v207, v211, s26, v213
    v_fmac_f32 v213, s27, v211
    v_mfma_f32_16x16x32_bf16 v[36:39], a[216:219], v[228:231], v[36:39]
    v_fma_f32 v211, v209, s28, v249
    v_fmac_f32 v249, s29, v209
    v_mfma_f32_16x16x32_bf16 v[40:43], a[220:223], v[228:231], v[40:43]
    s_waitcnt lgkmcnt(1)
    v_cvt_pk_bf16_f32 v207, v248, v207
    v_cvt_pk_bf16_f32 v213, v251, v213
    v_mfma_f32_16x16x32_bf16 v[44:47], a[224:227], v[228:231], v[44:47]
    ds_read_b128 v[228:231], v253 offset:5216
    v_cvt_pk_bf16_f32 v211, v250, v211
    v_mfma_f32_16x16x32_bf16 v[72:75], a[192:195], v[232:235], v[72:75]
    v_cvt_pk_bf16_f32 v209, v252, v249
    v_lshrrev_b32 v252, 15, v255
    v_mfma_f32_16x16x32_bf16 v[76:79], a[196:199], v[232:235], v[76:79]
    ds_write_b64 v252, v[206:207] offset:8576
    s_waitcnt vmcnt(15)
    v_mfma_f32_16x16x32_bf16 v[80:83], a[200:203], v[232:235], v[80:83]
    v_lshlrev_b32 v248, 16, v218
    v_lshlrev_b32 v249, 16, v220
    v_mfma_f32_16x16x32_bf16 v[60:63], a[204:207], v[232:235], v[60:63]
    ds_write_b64 v252, v[212:213] offset:10656
    v_mfma_f32_16x16x32_bf16 v[64:67], a[208:211], v[232:235], v[64:67]
    v_lshlrev_b32 v250, 16, v222
    v_lshlrev_b32 v251, 16, v224
    v_mfma_f32_16x16x32_bf16 v[68:71], a[212:215], v[232:235], v[68:71]
    ds_write_b64 v252, v[210:211] offset:12736
    v_mfma_f32_16x16x32_bf16 v[48:51], a[216:219], v[232:235], v[48:51]
    s_waitcnt lgkmcnt(4)
    v_and_b32 v218, s22, v218
    v_and_b32 v220, s22, v220
    v_mfma_f32_16x16x32_bf16 v[52:55], a[220:223], v[232:235], v[52:55]
    ds_write_b64 v252, v[204:205] offset:18976
    v_mfma_f32_16x16x32_bf16 v[56:59], a[224:227], v[232:235], v[56:59]
    ds_read_b128 v[232:235], v253 offset:4944
    v_and_b32 v222, s22, v222
    v_and_b32 v224, s22, v224
    v_mfma_f32_16x16x32_bf16 v[84:87], a[192:195], v[236:239], v[84:87]
    ds_write_b64 v252, v[214:215] offset:27296
    v_mfma_f32_16x16x32_bf16 v[88:91], a[196:199], v[236:239], v[88:91]
    v_mfma_f32_16x16x32_bf16 v[92:95], a[200:203], v[236:239], v[92:95]
    s_add_u32 s42, s32, 442368
    v_mfma_f32_16x16x32_bf16 v[72:75], a[204:207], v[236:239], v[72:75]
    buffer_load_dwordx4 a[192:195], v254, s[8:11], s42 offen offset:0 sc1
    v_mfma_f32_16x16x32_bf16 v[76:79], a[208:211], v[236:239], v[76:79]
    ds_write_b64 v252, v[208:209] offset:31456
    v_mfma_f32_16x16x32_bf16 v[80:83], a[212:215], v[236:239], v[80:83]
    v_mfma_f32_16x16x32_bf16 v[60:63], a[216:219], v[236:239], v[60:63]
    buffer_load_dwordx4 a[196:199], v254, s[8:11], s42 offen offset:1024 sc1
    v_mfma_f32_16x16x32_bf16 v[64:67], a[220:223], v[236:239], v[64:67]
    v_lshlrev_b32 v252, 16, v216
    v_and_b32 v216, s22, v216
    v_mfma_f32_16x16x32_bf16 v[68:71], a[224:227], v[236:239], v[68:71]
    s_waitcnt lgkmcnt(7)
    v_add_f32 v252, v252, v251
    v_add_f32 v216, v216, v224
    v_mfma_f32_16x16x32_bf16 v[84:87], a[204:207], v[228:231], v[84:87]
    ds_read_b128 v[236:239], v253 offset:7280
    v_fmac_f32 v252, s23, v249
    v_mfma_f32_16x16x32_bf16 v[88:91], a[208:211], v[228:231], v[88:91]
    v_fmac_f32 v216, s23, v220
    v_cvt_pk_bf16_f32 v216, v252, v216
    v_mfma_f32_16x16x32_bf16 v[92:95], a[212:215], v[228:231], v[92:95]
    buffer_load_dwordx4 a[200:203], v254, s[8:11], s42 offen offset:2048 sc1
    v_mfma_f32_16x16x32_bf16 v[72:75], a[216:219], v[228:231], v[72:75]
    s_waitcnt lgkmcnt(3)
    v_lshlrev_b32 v252, 16, v226
    v_and_b32 v226, s22, v226
    v_mfma_f32_16x16x32_bf16 v[76:79], a[220:223], v[228:231], v[76:79]
    s_add_u32 s42, s32, 445440
    v_add_f32 v252, v252, v248
    v_add_f32 v226, v226, v218
    v_mfma_f32_16x16x32_bf16 v[80:83], a[224:227], v[228:231], v[80:83]
    ds_read_b128 v[228:231], v253 offset:7008
    v_fmac_f32 v252, s23, v250
    v_mfma_f32_16x16x32_bf16 v[84:87], a[216:219], v[232:235], v[84:87]
    buffer_load_dwordx4 a[204:207], v254, s[8:11], s42 offen offset:0 sc1
    v_mfma_f32_16x16x32_bf16 v[88:91], a[220:223], v[232:235], v[88:91]
    s_waitcnt vmcnt(16) lgkmcnt(1)
    v_fmac_f32 v226, s23, v222
    v_cvt_pk_bf16_f32 v226, v252, v226
    v_mfma_f32_16x16x32_bf16 v[92:95], a[224:227], v[232:235], v[92:95]
    ds_read_b128 v[232:235], v253 offset:6752
    v_fma_f32 v252, v249, s24, v251
    v_mfma_f32_16x16x32_bf16 v[96:99], a[228:231], v[236:239], v[96:99]
    s_waitcnt lgkmcnt(1)
    v_fmac_f32 v251, s25, v249
    v_fma_f32 v249, v248, s24, v250
    v_mfma_f32_16x16x32_bf16 v[100:103], a[232:235], v[236:239], v[100:103]
    buffer_load_dwordx4 a[208:211], v254, s[8:11], s42 offen offset:1024 sc1
    v_mfma_f32_16x16x32_bf16 v[104:107], a[236:239], v[236:239], v[104:107]
    ds_read_b128 v[236:239], v253 offset:6496
    v_fmac_f32 v250, s25, v248
    v_mfma_f32_16x16x32_bf16 v[108:111], a[228:231], v[228:231], v[108:111]
    v_fma_f32 v248, v250, s26, v251
    v_fmac_f32 v251, s27, v250
    v_mfma_f32_16x16x32_bf16 v[112:115], a[232:235], v[228:231], v[112:115]
    s_waitcnt vmcnt(14)
    v_fma_f32 v250, v249, s28, v252
    v_fmac_f32 v252, s29, v249
    v_mfma_f32_16x16x32_bf16 v[116:119], a[236:239], v[228:231], v[116:119]
    buffer_load_dwordx4 a[212:215], v254, s[8:11], s42 offen offset:2048 sc1
    v_mfma_f32_16x16x32_bf16 v[96:99], a[240:243], v[228:231], v[96:99]
    s_waitcnt lgkmcnt(1)
    v_fma_f32 v249, v220, s24, v224
    v_fmac_f32 v224, s25, v220
    v_mfma_f32_16x16x32_bf16 v[100:103], a[244:247], v[228:231], v[100:103]
    s_add_u32 s42, s32, 448512
    v_fma_f32 v220, v218, s24, v222
    v_fmac_f32 v222, s25, v218
    v_mfma_f32_16x16x32_bf16 v[104:107], a[248:251], v[228:231], v[104:107]
    ds_read_b128 v[228:231], v253 offset:6240
    v_fma_f32 v218, v222, s26, v224
    v_mfma_f32_16x16x32_bf16 v[120:123], a[228:231], v[232:235], v[120:123]
    buffer_load_dwordx4 a[216:219], v254, s[8:11], s42 offen offset:0 sc1
    v_mfma_f32_16x16x32_bf16 v[124:127], a[232:235], v[232:235], v[124:127]
    v_fmac_f32 v224, s27, v222
    v_fma_f32 v222, v220, s28, v249
    v_mfma_f32_16x16x32_bf16 v[128:131], a[236:239], v[232:235], v[128:131]
    v_fmac_f32 v249, s29, v220
    v_cvt_pk_bf16_f32 v218, v248, v218
    v_mfma_f32_16x16x32_bf16 v[108:111], a[240:243], v[232:235], v[108:111]
    v_cvt_pk_bf16_f32 v224, v251, v224
    v_cvt_pk_bf16_f32 v222, v250, v222
    v_mfma_f32_16x16x32_bf16 v[112:115], a[244:247], v[232:235], v[112:115]
    buffer_load_dwordx4 a[220:223], v254, s[8:11], s42 offen offset:1024 sc1
    v_mfma_f32_16x16x32_bf16 v[116:119], a[248:251], v[232:235], v[116:119]
    s_waitcnt vmcnt(14)
    v_cvt_pk_bf16_f32 v220, v252, v249
    v_lshlrev_b32 v248, 16, v219
    v_mfma_f32_16x16x32_bf16 v[96:99], a[252:255], v[232:235], v[96:99]
    s_waitcnt lgkmcnt(1)
    v_lshlrev_b32 v249, 16, v221
    v_lshlrev_b32 v250, 16, v223
    v_mfma_f32_16x16x32_bf16 v[100:103], v[240:243], v[232:235], v[100:103]
    buffer_load_dwordx4 a[224:227], v254, s[8:11], s42 offen offset:2048 sc1
    v_mfma_f32_16x16x32_bf16 v[104:107], v[244:247], v[232:235], v[104:107]
    ds_read_b128 v[232:235], v253 offset:8064
    v_and_b32 v215, 0x7fff, v255
    v_mfma_f32_16x16x32_bf16 v[132:135], a[228:231], v[236:239], v[132:135]
    v_lshlrev_b32 v251, 16, v225
    v_and_b32 v219, s22, v219
    v_mfma_f32_16x16x32_bf16 v[136:139], a[232:235], v[236:239], v[136:139]
    buffer_load_dwordx2 v[204:205], v215, s[4:7], s16 offen offset:640
    v_mfma_f32_16x16x32_bf16 v[140:143], a[236:239], v[236:239], v[140:143]
    v_and_b32 v221, s22, v221
    v_and_b32 v223, s22, v223
    v_mfma_f32_16x16x32_bf16 v[120:123], a[240:243], v[236:239], v[120:123]
    v_and_b32 v225, s22, v225
    v_lshlrev_b32 v252, 16, v217
    v_mfma_f32_16x16x32_bf16 v[124:127], a[244:247], v[236:239], v[124:127]
    buffer_load_dwordx2 v[206:207], v215, s[4:7], s17 offen offset:640
    v_mfma_f32_16x16x32_bf16 v[128:131], a[248:251], v[236:239], v[128:131]
    v_and_b32 v217, s22, v217
    v_add_f32 v252, v252, v251
    v_mfma_f32_16x16x32_bf16 v[108:111], a[252:255], v[236:239], v[108:111]
    s_waitcnt lgkmcnt(1)
    v_add_f32 v217, v217, v225
    v_fmac_f32 v252, s23, v249
    v_mfma_f32_16x16x32_bf16 v[112:115], v[240:243], v[236:239], v[112:115]
    buffer_load_dwordx2 v[208:209], v215, s[4:7], s18 offen offset:640
    v_mfma_f32_16x16x32_bf16 v[116:119], v[244:247], v[236:239], v[116:119]
    ds_read_b128 v[236:239], v253 offset:7808
    v_fmac_f32 v217, s23, v221
    v_mfma_f32_16x16x32_bf16 v[144:147], a[228:231], v[228:231], v[144:147]
    v_cvt_pk_bf16_f32 v217, v252, v217
    v_lshlrev_b32 v252, 16, v227
    v_mfma_f32_16x16x32_bf16 v[148:151], a[232:235], v[228:231], v[148:151]
    buffer_load_dwordx2 v[210:211], v215, s[4:7], s19 offen offset:640
    v_mfma_f32_16x16x32_bf16 v[152:155], a[236:239], v[228:231], v[152:155]
    v_and_b32 v227, s22, v227
    v_add_f32 v252, v252, v248
    v_mfma_f32_16x16x32_bf16 v[132:135], a[240:243], v[228:231], v[132:135]
    v_add_f32 v227, v227, v219
    v_fmac_f32 v252, s23, v250
    v_mfma_f32_16x16x32_bf16 v[136:139], a[244:247], v[228:231], v[136:139]
    buffer_load_dwordx2 v[212:213], v215, s[4:7], s20 offen offset:640
    v_mfma_f32_16x16x32_bf16 v[140:143], a[248:251], v[228:231], v[140:143]
    v_fmac_f32 v227, s23, v223
    v_cvt_pk_bf16_f32 v227, v252, v227
    v_mfma_f32_16x16x32_bf16 v[120:123], a[252:255], v[228:231], v[120:123]
    s_waitcnt lgkmcnt(1)
    v_fma_f32 v252, v249, s24, v251
    v_fmac_f32 v251, s25, v249
    v_mfma_f32_16x16x32_bf16 v[124:127], v[240:243], v[228:231], v[124:127]
    buffer_load_dwordx2 v[214:215], v215, s[4:7], s21 offen offset:640
    v_mfma_f32_16x16x32_bf16 v[128:131], v[244:247], v[228:231], v[128:131]
    ds_read_b128 v[228:231], v253 offset:7552
    v_fma_f32 v249, v248, s24, v250
    v_mfma_f32_16x16x32_bf16 v[156:159], a[228:231], v[232:235], v[156:159]
    v_fmac_f32 v250, s25, v248
    v_fma_f32 v248, v250, s26, v251
    v_mfma_f32_16x16x32_bf16 v[160:163], a[232:235], v[232:235], v[160:163]
    v_fmac_f32 v251, s27, v250
    v_fma_f32 v250, v249, s28, v252
    v_mfma_f32_16x16x32_bf16 v[164:167], a[236:239], v[232:235], v[164:167]
    v_fmac_f32 v252, s29, v249
    v_fma_f32 v249, v221, s24, v225
    v_mfma_f32_16x16x32_bf16 v[144:147], a[240:243], v[232:235], v[144:147]
    v_fmac_f32 v225, s25, v221
    v_fma_f32 v221, v219, s24, v223
    v_mfma_f32_16x16x32_bf16 v[148:151], a[244:247], v[232:235], v[148:151]
    v_fmac_f32 v223, s25, v219
    v_fma_f32 v219, v223, s26, v225
    v_mfma_f32_16x16x32_bf16 v[152:155], a[248:251], v[232:235], v[152:155]
    v_fmac_f32 v225, s27, v223
    v_fma_f32 v223, v221, s28, v249
    v_mfma_f32_16x16x32_bf16 v[132:135], a[252:255], v[232:235], v[132:135]
    v_fmac_f32 v249, s29, v221
    v_cvt_pk_bf16_f32 v219, v248, v219
    v_mfma_f32_16x16x32_bf16 v[136:139], v[240:243], v[232:235], v[136:139]
    s_waitcnt lgkmcnt(1)
    v_cvt_pk_bf16_f32 v225, v251, v225
    v_cvt_pk_bf16_f32 v223, v250, v223
    v_mfma_f32_16x16x32_bf16 v[140:143], v[244:247], v[232:235], v[140:143]
    ds_read_b128 v[232:235], v253 offset:7296
    v_cvt_pk_bf16_f32 v221, v252, v249
    v_mfma_f32_16x16x32_bf16 v[168:171], a[228:231], v[236:239], v[168:171]
    v_lshrrev_b32 v252, 15, v255
    v_mfma_f32_16x16x32_bf16 v[172:175], a[232:235], v[236:239], v[172:175]
    ds_write_b64 v252, v[218:219] offset:8320
    v_mfma_f32_16x16x32_bf16 v[176:179], a[236:239], v[236:239], v[176:179]
    s_waitcnt vmcnt(15)
    v_lshlrev_b32 v248, 16, v194
    v_lshlrev_b32 v249, 16, v196
    v_mfma_f32_16x16x32_bf16 v[156:159], a[240:243], v[236:239], v[156:159]
    ds_write_b64 v252, v[224:225] offset:10400
    v_mfma_f32_16x16x32_bf16 v[160:163], a[244:247], v[236:239], v[160:163]
    v_lshlrev_b32 v250, 16, v198
    v_lshlrev_b32 v251, 16, v200
    v_mfma_f32_16x16x32_bf16 v[164:167], a[248:251], v[236:239], v[164:167]
    ds_write_b64 v252, v[222:223] offset:12480
    v_mfma_f32_16x16x32_bf16 v[144:147], a[252:255], v[236:239], v[144:147]
    s_waitcnt lgkmcnt(4)
    v_and_b32 v194, s22, v194
    v_and_b32 v196, s22, v196
    v_mfma_f32_16x16x32_bf16 v[148:151], v[240:243], v[236:239], v[148:151]
    ds_write_b64 v252, v[216:217] offset:18720
    v_mfma_f32_16x16x32_bf16 v[152:155], v[244:247], v[236:239], v[152:155]
    ds_read_b128 v[236:239], v253 offset:7024
    v_and_b32 v198, s22, v198
    v_mfma_f32_16x16x32_bf16 v[180:183], a[228:231], v[228:231], v[180:183]
    v_and_b32 v200, s22, v200
    v_mfma_f32_16x16x32_bf16 v[184:187], a[232:235], v[228:231], v[184:187]
    ds_write_b64 v252, v[226:227] offset:27040
    v_mfma_f32_16x16x32_bf16 v[188:191], a[236:239], v[228:231], v[188:191]
    s_add_u32 s42, s32, 479232
    v_mfma_f32_16x16x32_bf16 v[168:171], a[240:243], v[228:231], v[168:171]
    buffer_load_dwordx4 a[228:231], v254, s[8:11], s42 offen offset:0 sc1
    v_mfma_f32_16x16x32_bf16 v[172:175], a[244:247], v[228:231], v[172:175]
    ds_write_b64 v252, v[220:221] offset:31200
    v_mfma_f32_16x16x32_bf16 v[176:179], a[248:251], v[228:231], v[176:179]
    s_waitcnt lgkmcnt(7)
    v_mfma_f32_16x16x32_bf16 v[156:159], a[252:255], v[228:231], v[156:159]
    buffer_load_dwordx4 a[232:235], v254, s[8:11], s42 offen offset:1024 sc1
    v_mfma_f32_16x16x32_bf16 v[160:163], v[240:243], v[228:231], v[160:163]
    s_waitcnt lgkmcnt(0)
    v_lshlrev_b32 v252, 16, v192
    v_and_b32 v192, s22, v192
    v_mfma_f32_16x16x32_bf16 v[164:167], v[244:247], v[228:231], v[164:167]
    s_barrier
    v_mfma_f32_16x16x32_bf16 v[180:183], a[240:243], v[232:235], v[180:183]
    ds_read_b128 v[228:231], v253 offset:9360
    v_add_f32 v252, v252, v251
    v_mfma_f32_16x16x32_bf16 v[184:187], a[244:247], v[232:235], v[184:187]
    v_add_f32 v192, v192, v200
    v_fmac_f32 v252, s23, v249
    v_mfma_f32_16x16x32_bf16 v[188:191], a[248:251], v[232:235], v[188:191]
    buffer_load_dwordx4 a[236:239], v254, s[8:11], s42 offen offset:2048 sc1
    v_mfma_f32_16x16x32_bf16 v[168:171], a[252:255], v[232:235], v[168:171]
    v_fmac_f32 v192, s23, v196
    v_cvt_pk_bf16_f32 v192, v252, v192
    v_mfma_f32_16x16x32_bf16 v[172:175], v[240:243], v[232:235], v[172:175]
    s_add_u32 s42, s32, 482304
    v_lshlrev_b32 v252, 16, v202
    v_and_b32 v202, s22, v202
    v_add_f32 v252, v252, v248
    v_mfma_f32_16x16x32_bf16 v[176:179], v[244:247], v[232:235], v[176:179]
    ds_read_b128 v[232:235], v253 offset:9088
    v_add_f32 v202, v202, v194
    v_mfma_f32_16x16x32_bf16 v[180:183], a[252:255], v[236:239], v[180:183]
    buffer_load_dwordx4 a[240:243], v254, s[8:11], s42 offen offset:0 sc1
    v_mfma_f32_16x16x32_bf16 v[184:187], v[240:243], v[236:239], v[184:187]
    s_waitcnt vmcnt(16) lgkmcnt(1)
    v_fmac_f32 v252, s23, v250
    v_fmac_f32 v202, s23, v198
    v_mfma_f32_16x16x32_bf16 v[188:191], v[244:247], v[236:239], v[188:191]
    ds_read_b128 v[236:239], v253 offset:8832
    v_cvt_pk_bf16_f32 v202, v252, v202
    v_mfma_f32_16x16x32_bf16 a[0:3], a[192:195], v[228:231], a[0:3]
    s_waitcnt lgkmcnt(1)
    v_fma_f32 v252, v249, s24, v251
    v_fmac_f32 v251, s25, v249
    v_mfma_f32_16x16x32_bf16 a[4:7], a[196:199], v[228:231], a[4:7]
    buffer_load_dwordx4 a[244:247], v254, s[8:11], s42 offen offset:1024 sc1
    v_mfma_f32_16x16x32_bf16 a[8:11], a[200:203], v[228:231], a[8:11]
    ds_read_b128 v[228:231], v253 offset:8576
    v_fma_f32 v249, v248, s24, v250
    v_mfma_f32_16x16x32_bf16 a[12:15], a[192:195], v[232:235], a[12:15]
    v_fmac_f32 v250, s25, v248
    v_fma_f32 v248, v250, s26, v251
    v_mfma_f32_16x16x32_bf16 a[16:19], a[196:199], v[232:235], a[16:19]
    s_waitcnt vmcnt(14)
    v_fmac_f32 v251, s27, v250
    v_fma_f32 v250, v249, s28, v252
    v_mfma_f32_16x16x32_bf16 a[20:23], a[200:203], v[232:235], a[20:23]
    buffer_load_dwordx4 a[248:251], v254, s[8:11], s42 offen offset:2048 sc1
    v_mfma_f32_16x16x32_bf16 a[0:3], a[204:207], v[232:235], a[0:3]
    s_waitcnt lgkmcnt(1)
    v_fmac_f32 v252, s29, v249
    v_fma_f32 v249, v196, s24, v200
    v_mfma_f32_16x16x32_bf16 a[4:7], a[208:211], v[232:235], a[4:7]
    s_add_u32 s42, s32, 485376
    v_fmac_f32 v200, s25, v196
    v_fma_f32 v196, v194, s24, v198
    v_mfma_f32_16x16x32_bf16 a[8:11], a[212:215], v[232:235], a[8:11]
    ds_read_b128 v[232:235], v253 offset:8320
    v_fmac_f32 v198, s25, v194
    v_mfma_f32_16x16x32_bf16 a[24:27], a[192:195], v[236:239], a[24:27]
    buffer_load_dwordx4 a[252:255], v254, s[8:11], s42 offen offset:0 sc1
    v_mfma_f32_16x16x32_bf16 a[28:31], a[196:199], v[236:239], a[28:31]
    v_fma_f32 v194, v198, s26, v200
    v_fmac_f32 v200, s27, v198
    v_mfma_f32_16x16x32_bf16 a[32:35], a[200:203], v[236:239], a[32:35]
    v_fma_f32 v198, v196, s28, v249
    v_fmac_f32 v249, s29, v196
    v_mfma_f32_16x16x32_bf16 a[12:15], a[204:207], v[236:239], a[12:15]
    v_cvt_pk_bf16_f32 v194, v248, v194
    v_cvt_pk_bf16_f32 v200, v251, v200
    v_mfma_f32_16x16x32_bf16 a[16:19], a[208:211], v[236:239], a[16:19]
    buffer_load_dwordx4 v[240:243], v254, s[8:11], s42 offen offset:1024 sc1
    v_mfma_f32_16x16x32_bf16 a[20:23], a[212:215], v[236:239], a[20:23]
    s_waitcnt vmcnt(14)
    v_cvt_pk_bf16_f32 v198, v250, v198
    v_cvt_pk_bf16_f32 v196, v252, v249
    v_mfma_f32_16x16x32_bf16 a[0:3], a[216:219], v[236:239], a[0:3]
    s_waitcnt lgkmcnt(1)
    v_lshlrev_b32 v248, 16, v195
    v_lshlrev_b32 v249, 16, v197
    v_lshlrev_b32 v250, 16, v199
    v_mfma_f32_16x16x32_bf16 a[4:7], a[220:223], v[236:239], a[4:7]
    buffer_load_dwordx4 v[244:247], v254, s[8:11], s42 offen offset:2048 sc1
    v_mfma_f32_16x16x32_bf16 a[8:11], a[224:227], v[236:239], a[8:11]
    ds_read_b128 v[236:239], v253 offset:10144
    v_and_b32 v227, 0x7fff, v255
    v_mfma_f32_16x16x32_bf16 a[36:39], a[192:195], v[228:231], a[36:39]
    v_lshlrev_b32 v251, 16, v201
    v_and_b32 v195, s22, v195
    v_mfma_f32_16x16x32_bf16 a[40:43], a[196:199], v[228:231], a[40:43]
    buffer_load_dwordx2 v[216:217], v227, s[4:7], s16 offen offset:1024
    v_mfma_f32_16x16x32_bf16 a[44:47], a[200:203], v[228:231], a[44:47]
    v_and_b32 v197, s22, v197
    v_and_b32 v199, s22, v199
    v_mfma_f32_16x16x32_bf16 a[24:27], a[204:207], v[228:231], a[24:27]
    v_and_b32 v201, s22, v201
    v_lshlrev_b32 v252, 16, v193
    v_mfma_f32_16x16x32_bf16 a[28:31], a[208:211], v[228:231], a[28:31]
    buffer_load_dwordx2 v[218:219], v227, s[4:7], s17 offen offset:1024
    v_mfma_f32_16x16x32_bf16 a[32:35], a[212:215], v[228:231], a[32:35]
    v_and_b32 v193, s22, v193
    v_add_f32 v252, v252, v251
    v_mfma_f32_16x16x32_bf16 a[12:15], a[216:219], v[228:231], a[12:15]
    s_waitcnt lgkmcnt(1)
    v_add_f32 v193, v193, v201
    v_fmac_f32 v252, s23, v249
    v_mfma_f32_16x16x32_bf16 a[16:19], a[220:223], v[228:231], a[16:19]
    buffer_load_dwordx2 v[220:221], v227, s[4:7], s18 offen offset:1024
    v_mfma_f32_16x16x32_bf16 a[20:23], a[224:227], v[228:231], a[20:23]
    ds_read_b128 v[228:231], v253 offset:9888
    v_fmac_f32 v193, s23, v197
    v_mfma_f32_16x16x32_bf16 a[48:51], a[192:195], v[232:235], a[48:51]
    v_cvt_pk_bf16_f32 v193, v252, v193
    v_lshlrev_b32 v252, 16, v203
    v_mfma_f32_16x16x32_bf16 a[52:55], a[196:199], v[232:235], a[52:55]
    buffer_load_dwordx2 v[222:223], v227, s[4:7], s19 offen offset:1024
    v_mfma_f32_16x16x32_bf16 a[56:59], a[200:203], v[232:235], a[56:59]
    v_and_b32 v203, s22, v203
    v_add_f32 v252, v252, v248
    v_mfma_f32_16x16x32_bf16 a[36:39], a[204:207], v[232:235], a[36:39]
    v_add_f32 v203, v203, v195
    v_fmac_f32 v252, s23, v250
    v_mfma_f32_16x16x32_bf16 a[40:43], a[208:211], v[232:235], a[40:43]
    buffer_load_dwordx2 v[224:225], v227, s[4:7], s20 offen offset:1024
    v_mfma_f32_16x16x32_bf16 a[44:47], a[212:215], v[232:235], a[44:47]
    v_fmac_f32 v203, s23, v199
    v_cvt_pk_bf16_f32 v203, v252, v203
    v_mfma_f32_16x16x32_bf16 a[24:27], a[216:219], v[232:235], a[24:27]
    s_waitcnt lgkmcnt(1)
    v_fma_f32 v252, v249, s24, v251
    v_fmac_f32 v251, s25, v249
    v_mfma_f32_16x16x32_bf16 a[28:31], a[220:223], v[232:235], a[28:31]
    buffer_load_dwordx2 v[226:227], v227, s[4:7], s21 offen offset:1024
    v_mfma_f32_16x16x32_bf16 a[32:35], a[224:227], v[232:235], a[32:35]
    ds_read_b128 v[232:235], v253 offset:9632
    v_fma_f32 v249, v248, s24, v250
    v_fmac_f32 v250, s25, v248
    v_mfma_f32_16x16x32_bf16 a[60:63], a[192:195], v[236:239], a[60:63]
    v_fma_f32 v248, v250, s26, v251
    v_fmac_f32 v251, s27, v250
    v_mfma_f32_16x16x32_bf16 a[64:67], a[196:199], v[236:239], a[64:67]
    v_fma_f32 v250, v249, s28, v252
    v_fmac_f32 v252, s29, v249
    v_mfma_f32_16x16x32_bf16 a[68:71], a[200:203], v[236:239], a[68:71]
    v_fma_f32 v249, v197, s24, v201
    v_fmac_f32 v201, s25, v197
    v_mfma_f32_16x16x32_bf16 a[48:51], a[204:207], v[236:239], a[48:51]
    v_fma_f32 v197, v195, s24, v199
    v_fmac_f32 v199, s25, v195
    v_mfma_f32_16x16x32_bf16 a[52:55], a[208:211], v[236:239], a[52:55]
    v_fma_f32 v195, v199, s26, v201
    v_fmac_f32 v201, s27, v199
    v_mfma_f32_16x16x32_bf16 a[56:59], a[212:215], v[236:239], a[56:59]
    v_fma_f32 v199, v197, s28, v249
    v_fmac_f32 v249, s29, v197
    v_mfma_f32_16x16x32_bf16 a[36:39], a[216:219], v[236:239], a[36:39]
    v_cvt_pk_bf16_f32 v195, v248, v195
    v_cvt_pk_bf16_f32 v201, v251, v201
    v_mfma_f32_16x16x32_bf16 a[40:43], a[220:223], v[236:239], a[40:43]
    s_waitcnt lgkmcnt(1)
    v_cvt_pk_bf16_f32 v199, v250, v199
    v_cvt_pk_bf16_f32 v197, v252, v249
    v_mfma_f32_16x16x32_bf16 a[44:47], a[224:227], v[236:239], a[44:47]
    ds_read_b128 v[236:239], v253 offset:9376
    v_lshrrev_b32 v252, 15, v255
    v_mfma_f32_16x16x32_bf16 a[72:75], a[192:195], v[228:231], a[72:75]
    ds_write_b64 v252, v[194:195] offset:768
    v_mfma_f32_16x16x32_bf16 a[76:79], a[196:199], v[228:231], a[76:79]
    s_waitcnt vmcnt(15)
    v_lshlrev_b32 v248, 16, v206
    v_lshlrev_b32 v249, 16, v208
    v_mfma_f32_16x16x32_bf16 a[80:83], a[200:203], v[228:231], a[80:83]
    ds_write_b64 v252, v[200:201] offset:2848
    v_mfma_f32_16x16x32_bf16 a[60:63], a[204:207], v[228:231], a[60:63]
    v_lshlrev_b32 v250, 16, v210
    v_lshlrev_b32 v251, 16, v212
    v_mfma_f32_16x16x32_bf16 a[64:67], a[208:211], v[228:231], a[64:67]
    ds_write_b64 v252, v[198:199] offset:4928
    v_mfma_f32_16x16x32_bf16 a[68:71], a[212:215], v[228:231], a[68:71]
    v_and_b32 v206, s22, v206
    v_and_b32 v208, s22, v208
    v_mfma_f32_16x16x32_bf16 a[48:51], a[216:219], v[228:231], a[48:51]
    ds_write_b64 v252, v[192:193] offset:21568
    v_mfma_f32_16x16x32_bf16 a[52:55], a[220:223], v[228:231], a[52:55]
    s_waitcnt lgkmcnt(5)
    v_and_b32 v210, s22, v210
    v_and_b32 v212, s22, v212
    v_mfma_f32_16x16x32_bf16 a[56:59], a[224:227], v[228:231], a[56:59]
    ds_read_b128 v[228:231], v253 offset:9104
    v_mfma_f32_16x16x32_bf16 a[84:87], a[192:195], v[232:235], a[84:87]
    ds_write_b64 v252, v[202:203] offset:29888
    v_mfma_f32_16x16x32_bf16 a[88:91], a[196:199], v[232:235], a[88:91]
    v_mfma_f32_16x16x32_bf16 a[92:95], a[200:203], v[232:235], a[92:95]
    s_add_u32 s42, s32, 516096
    v_mfma_f32_16x16x32_bf16 a[72:75], a[204:207], v[232:235], a[72:75]
    buffer_load_dwordx4 a[192:195], v254, s[8:11], s42 offen offset:0 sc1
    v_mfma_f32_16x16x32_bf16 a[76:79], a[208:211], v[232:235], a[76:79]
    ds_write_b64 v252, v[196:197] offset:7008
    v_mfma_f32_16x16x32_bf16 a[80:83], a[212:215], v[232:235], a[80:83]
    v_mfma_f32_16x16x32_bf16 a[60:63], a[216:219], v[232:235], a[60:63]
    buffer_load_dwordx4 a[196:199], v254, s[8:11], s42 offen offset:1024 sc1
    v_mfma_f32_16x16x32_bf16 a[64:67], a[220:223], v[232:235], a[64:67]
    v_lshlrev_b32 v252, 16, v204
    v_and_b32 v204, s22, v204
    v_mfma_f32_16x16x32_bf16 a[68:71], a[224:227], v[232:235], a[68:71]
    s_waitcnt lgkmcnt(7)
    v_add_f32 v252, v252, v251
    v_add_f32 v204, v204, v212
    v_mfma_f32_16x16x32_bf16 a[84:87], a[204:207], v[236:239], a[84:87]
    ds_read_b128 v[232:235], v253 offset:11440
    v_fmac_f32 v252, s23, v249
    v_mfma_f32_16x16x32_bf16 a[88:91], a[208:211], v[236:239], a[88:91]
    v_fmac_f32 v204, s23, v208
    v_cvt_pk_bf16_f32 v204, v252, v204
    v_mfma_f32_16x16x32_bf16 a[92:95], a[212:215], v[236:239], a[92:95]
    buffer_load_dwordx4 a[200:203], v254, s[8:11], s42 offen offset:2048 sc1
    v_mfma_f32_16x16x32_bf16 a[72:75], a[216:219], v[236:239], a[72:75]
    s_waitcnt lgkmcnt(3)
    v_lshlrev_b32 v252, 16, v214
    v_and_b32 v214, s22, v214
    v_mfma_f32_16x16x32_bf16 a[76:79], a[220:223], v[236:239], a[76:79]
    s_add_u32 s42, s32, 519168
    v_add_f32 v252, v252, v248
    v_add_f32 v214, v214, v206
    v_mfma_f32_16x16x32_bf16 a[80:83], a[224:227], v[236:239], a[80:83]
    ds_read_b128 v[236:239], v253 offset:11168
    v_fmac_f32 v252, s23, v250
    v_mfma_f32_16x16x32_bf16 a[84:87], a[216:219], v[228:231], a[84:87]
    buffer_load_dwordx4 a[204:207], v254, s[8:11], s42 offen offset:0 sc1
    v_mfma_f32_16x16x32_bf16 a[88:91], a[220:223], v[228:231], a[88:91]
    s_waitcnt vmcnt(16) lgkmcnt(1)
    v_fmac_f32 v214, s23, v210
    v_cvt_pk_bf16_f32 v214, v252, v214
    v_mfma_f32_16x16x32_bf16 a[92:95], a[224:227], v[228:231], a[92:95]
    ds_read_b128 v[228:231], v253 offset:10912
    v_fma_f32 v252, v249, s24, v251
    v_mfma_f32_16x16x32_bf16 a[96:99], a[228:231], v[232:235], a[96:99]
    s_waitcnt lgkmcnt(1)
    v_fmac_f32 v251, s25, v249
    v_fma_f32 v249, v248, s24, v250
    v_mfma_f32_16x16x32_bf16 a[100:103], a[232:235], v[232:235], a[100:103]
    buffer_load_dwordx4 a[208:211], v254, s[8:11], s42 offen offset:1024 sc1
    v_mfma_f32_16x16x32_bf16 a[104:107], a[236:239], v[232:235], a[104:107]
    ds_read_b128 v[232:235], v253 offset:10656
    v_fmac_f32 v250, s25, v248
    v_mfma_f32_16x16x32_bf16 a[108:111], a[228:231], v[236:239], a[108:111]
    v_fma_f32 v248, v250, s26, v251
    v_fmac_f32 v251, s27, v250
    v_mfma_f32_16x16x32_bf16 a[112:115], a[232:235], v[236:239], a[112:115]
    s_waitcnt vmcnt(14)
    v_fma_f32 v250, v249, s28, v252
    v_fmac_f32 v252, s29, v249
    v_mfma_f32_16x16x32_bf16 a[116:119], a[236:239], v[236:239], a[116:119]
    buffer_load_dwordx4 a[212:215], v254, s[8:11], s42 offen offset:2048 sc1
    v_mfma_f32_16x16x32_bf16 a[96:99], a[240:243], v[236:239], a[96:99]
    s_waitcnt lgkmcnt(1)
    v_fma_f32 v249, v208, s24, v212
    v_fmac_f32 v212, s25, v208
    v_mfma_f32_16x16x32_bf16 a[100:103], a[244:247], v[236:239], a[100:103]
    s_add_u32 s42, s32, 522240
    v_fma_f32 v208, v206, s24, v210
    v_fmac_f32 v210, s25, v206
    v_mfma_f32_16x16x32_bf16 a[104:107], a[248:251], v[236:239], a[104:107]
    ds_read_b128 v[236:239], v253 offset:10400
    v_fma_f32 v206, v210, s26, v212
    v_mfma_f32_16x16x32_bf16 a[120:123], a[228:231], v[228:231], a[120:123]
    buffer_load_dwordx4 a[216:219], v254, s[8:11], s42 offen offset:0 sc1
    v_mfma_f32_16x16x32_bf16 a[124:127], a[232:235], v[228:231], a[124:127]
    v_fmac_f32 v212, s27, v210
    v_fma_f32 v210, v208, s28, v249
    v_mfma_f32_16x16x32_bf16 a[128:131], a[236:239], v[228:231], a[128:131]
    v_fmac_f32 v249, s29, v208
    v_cvt_pk_bf16_f32 v206, v248, v206
    v_mfma_f32_16x16x32_bf16 a[108:111], a[240:243], v[228:231], a[108:111]
    v_cvt_pk_bf16_f32 v212, v251, v212
    v_cvt_pk_bf16_f32 v210, v250, v210
    v_mfma_f32_16x16x32_bf16 a[112:115], a[244:247], v[228:231], a[112:115]
    buffer_load_dwordx4 a[220:223], v254, s[8:11], s42 offen offset:1024 sc1
    v_mfma_f32_16x16x32_bf16 a[116:119], a[248:251], v[228:231], a[116:119]
    s_waitcnt vmcnt(14)
    v_cvt_pk_bf16_f32 v208, v252, v249
    v_lshlrev_b32 v248, 16, v207
    v_mfma_f32_16x16x32_bf16 a[96:99], a[252:255], v[228:231], a[96:99]
    s_waitcnt lgkmcnt(1)
    v_lshlrev_b32 v249, 16, v209
    v_lshlrev_b32 v250, 16, v211
    v_mfma_f32_16x16x32_bf16 a[100:103], v[240:243], v[228:231], a[100:103]
    buffer_load_dwordx4 a[224:227], v254, s[8:11], s42 offen offset:2048 sc1
    v_mfma_f32_16x16x32_bf16 a[104:107], v[244:247], v[228:231], a[104:107]
    ds_read_b128 v[228:231], v253 offset:12224
    v_and_b32 v203, 0x7fff, v255
    v_mfma_f32_16x16x32_bf16 a[132:135], a[228:231], v[232:235], a[132:135]
    v_lshlrev_b32 v251, 16, v213
    v_and_b32 v207, s22, v207
    v_mfma_f32_16x16x32_bf16 a[136:139], a[232:235], v[232:235], a[136:139]
    buffer_load_dwordx2 v[192:193], v203, s[4:7], s16 offen offset:1408
    v_mfma_f32_16x16x32_bf16 a[140:143], a[236:239], v[232:235], a[140:143]
    v_and_b32 v209, s22, v209
    v_and_b32 v211, s22, v211
    v_mfma_f32_16x16x32_bf16 a[120:123], a[240:243], v[232:235], a[120:123]
    v_and_b32 v213, s22, v213
    v_lshlrev_b32 v252, 16, v205
    v_mfma_f32_16x16x32_bf16 a[124:127], a[244:247], v[232:235], a[124:127]
    buffer_load_dwordx2 v[194:195], v203, s[4:7], s17 offen offset:1408
    v_mfma_f32_16x16x32_bf16 a[128:131], a[248:251], v[232:235], a[128:131]
    v_and_b32 v205, s22, v205
    v_add_f32 v252, v252, v251
    v_mfma_f32_16x16x32_bf16 a[108:111], a[252:255], v[232:235], a[108:111]
    s_waitcnt lgkmcnt(1)
    v_add_f32 v205, v205, v213
    v_fmac_f32 v252, s23, v249
    v_mfma_f32_16x16x32_bf16 a[112:115], v[240:243], v[232:235], a[112:115]
    buffer_load_dwordx2 v[196:197], v203, s[4:7], s18 offen offset:1408
    v_mfma_f32_16x16x32_bf16 a[116:119], v[244:247], v[232:235], a[116:119]
    ds_read_b128 v[232:235], v253 offset:11968
    v_fmac_f32 v205, s23, v209
    v_mfma_f32_16x16x32_bf16 a[144:147], a[228:231], v[236:239], a[144:147]
    v_cvt_pk_bf16_f32 v205, v252, v205
    v_lshlrev_b32 v252, 16, v215
    v_mfma_f32_16x16x32_bf16 a[148:151], a[232:235], v[236:239], a[148:151]
    buffer_load_dwordx2 v[198:199], v203, s[4:7], s19 offen offset:1408
    v_mfma_f32_16x16x32_bf16 a[152:155], a[236:239], v[236:239], a[152:155]
    v_and_b32 v215, s22, v215
    v_add_f32 v252, v252, v248
    v_mfma_f32_16x16x32_bf16 a[132:135], a[240:243], v[236:239], a[132:135]
    v_add_f32 v215, v215, v207
    v_fmac_f32 v252, s23, v250
    v_mfma_f32_16x16x32_bf16 a[136:139], a[244:247], v[236:239], a[136:139]
    buffer_load_dwordx2 v[200:201], v203, s[4:7], s20 offen offset:1408
    v_mfma_f32_16x16x32_bf16 a[140:143], a[248:251], v[236:239], a[140:143]
    v_fmac_f32 v215, s23, v211
    v_cvt_pk_bf16_f32 v215, v252, v215
    v_mfma_f32_16x16x32_bf16 a[120:123], a[252:255], v[236:239], a[120:123]
    s_waitcnt lgkmcnt(1)
    v_fma_f32 v252, v249, s24, v251
    v_fmac_f32 v251, s25, v249
    v_mfma_f32_16x16x32_bf16 a[124:127], v[240:243], v[236:239], a[124:127]
    buffer_load_dwordx2 v[202:203], v203, s[4:7], s21 offen offset:1408
    v_mfma_f32_16x16x32_bf16 a[128:131], v[244:247], v[236:239], a[128:131]
    ds_read_b128 v[236:239], v253 offset:11712
    v_fma_f32 v249, v248, s24, v250
    v_mfma_f32_16x16x32_bf16 a[156:159], a[228:231], v[228:231], a[156:159]
    v_fmac_f32 v250, s25, v248
    v_fma_f32 v248, v250, s26, v251
    v_mfma_f32_16x16x32_bf16 a[160:163], a[232:235], v[228:231], a[160:163]
    v_fmac_f32 v251, s27, v250
    v_fma_f32 v250, v249, s28, v252
    v_mfma_f32_16x16x32_bf16 a[164:167], a[236:239], v[228:231], a[164:167]
    v_fmac_f32 v252, s29, v249
    v_fma_f32 v249, v209, s24, v213
    v_mfma_f32_16x16x32_bf16 a[144:147], a[240:243], v[228:231], a[144:147]
    v_fmac_f32 v213, s25, v209
    v_fma_f32 v209, v207, s24, v211
    v_mfma_f32_16x16x32_bf16 a[148:151], a[244:247], v[228:231], a[148:151]
    v_fmac_f32 v211, s25, v207
    v_fma_f32 v207, v211, s26, v213
    v_mfma_f32_16x16x32_bf16 a[152:155], a[248:251], v[228:231], a[152:155]
    v_fmac_f32 v213, s27, v211
    v_fma_f32 v211, v209, s28, v249
    v_mfma_f32_16x16x32_bf16 a[132:135], a[252:255], v[228:231], a[132:135]
    v_fmac_f32 v249, s29, v209
    v_cvt_pk_bf16_f32 v207, v248, v207
    v_mfma_f32_16x16x32_bf16 a[136:139], v[240:243], v[228:231], a[136:139]
    s_waitcnt lgkmcnt(1)
    v_cvt_pk_bf16_f32 v213, v251, v213
    v_cvt_pk_bf16_f32 v211, v250, v211
    v_mfma_f32_16x16x32_bf16 a[140:143], v[244:247], v[228:231], a[140:143]
    ds_read_b128 v[228:231], v253 offset:11456
    v_cvt_pk_bf16_f32 v209, v252, v249
    v_mfma_f32_16x16x32_bf16 a[168:171], a[228:231], v[232:235], a[168:171]
    v_lshrrev_b32 v252, 15, v255
    v_mfma_f32_16x16x32_bf16 a[172:175], a[232:235], v[232:235], a[172:175]
    ds_write_b64 v252, v[206:207] offset:512
    v_mfma_f32_16x16x32_bf16 a[176:179], a[236:239], v[232:235], a[176:179]
    s_waitcnt vmcnt(15)
    v_lshlrev_b32 v248, 16, v218
    v_lshlrev_b32 v249, 16, v220
    v_mfma_f32_16x16x32_bf16 a[156:159], a[240:243], v[232:235], a[156:159]
    ds_write_b64 v252, v[212:213] offset:2592
    v_mfma_f32_16x16x32_bf16 a[160:163], a[244:247], v[232:235], a[160:163]
    v_lshlrev_b32 v250, 16, v222
    v_lshlrev_b32 v251, 16, v224
    v_mfma_f32_16x16x32_bf16 a[164:167], a[248:251], v[232:235], a[164:167]
    ds_write_b64 v252, v[210:211] offset:4672
    v_mfma_f32_16x16x32_bf16 a[144:147], a[252:255], v[232:235], a[144:147]
    s_waitcnt lgkmcnt(4)
    v_and_b32 v218, s22, v218
    v_and_b32 v220, s22, v220
    v_mfma_f32_16x16x32_bf16 a[148:151], v[240:243], v[232:235], a[148:151]
    ds_write_b64 v252, v[204:205] offset:21312
    v_mfma_f32_16x16x32_bf16 a[152:155], v[244:247], v[232:235], a[152:155]
    ds_read_b128 v[232:235], v253 offset:11184
    v_and_b32 v222, s22, v222
    v_mfma_f32_16x16x32_bf16 a[180:183], a[228:231], v[236:239], a[180:183]
    v_and_b32 v224, s22, v224
    v_mfma_f32_16x16x32_bf16 a[184:187], a[232:235], v[236:239], a[184:187]
    ds_write_b64 v252, v[214:215] offset:29632
    v_mfma_f32_16x16x32_bf16 a[188:191], a[236:239], v[236:239], a[188:191]
    s_add_u32 s42, s32, 552960
    v_mfma_f32_16x16x32_bf16 a[168:171], a[240:243], v[236:239], a[168:171]
    buffer_load_dwordx4 a[228:231], v254, s[8:11], s42 offen offset:0 sc1
    v_mfma_f32_16x16x32_bf16 a[172:175], a[244:247], v[236:239], a[172:175]
    s_sub_u32 s16, s16, s3
    v_mfma_f32_16x16x32_bf16 a[176:179], a[248:251], v[236:239], a[176:179]
    ds_write_b64 v252, v[208:209] offset:6752
    v_mfma_f32_16x16x32_bf16 a[156:159], a[252:255], v[236:239], a[156:159]
    buffer_load_dwordx4 a[232:235], v254, s[8:11], s42 offen offset:1024 sc1
    v_mfma_f32_16x16x32_bf16 a[160:163], v[240:243], v[236:239], a[160:163]
    s_waitcnt lgkmcnt(7)
    v_lshlrev_b32 v252, 16, v216
    v_and_b32 v216, s22, v216
    v_mfma_f32_16x16x32_bf16 a[164:167], v[244:247], v[236:239], a[164:167]
    s_sub_u32 s17, s17, s3
    v_add_f32 v252, v252, v251
    v_add_f32 v216, v216, v224
    v_mfma_f32_16x16x32_bf16 a[180:183], a[240:243], v[228:231], a[180:183]
    ds_read_b128 v[236:239], v253 offset:13520
    v_fmac_f32 v252, s23, v249
    v_fmac_f32 v216, s23, v220
    v_mfma_f32_16x16x32_bf16 a[184:187], a[244:247], v[228:231], a[184:187]
    ds_read_b128 v[204:207], v253 offset:40288
    v_cvt_pk_bf16_f32 v216, v252, v216
    v_mfma_f32_16x16x32_bf16 a[188:191], a[248:251], v[228:231], a[188:191]
    buffer_load_dwordx4 a[236:239], v254, s[8:11], s42 offen offset:2048 sc1
    v_mfma_f32_16x16x32_bf16 a[168:171], a[252:255], v[228:231], a[168:171]
    s_mov_b32 s45, 472974346
    v_lshlrev_b32 v252, 16, v226
    v_and_b32 v226, s22, v226
    v_mfma_f32_16x16x32_bf16 a[172:175], v[240:243], v[228:231], a[172:175]
    s_add_u32 s42, s32, 556032
    s_sub_u32 s18, s18, s3
    v_add_f32 v252, v252, v248
    v_mfma_f32_16x16x32_bf16 a[176:179], v[244:247], v[228:231], a[176:179]
    ds_read_b128 v[228:231], v253 offset:13248
    v_bfe_u32 v208, v254, 5, 3
    s_waitcnt lgkmcnt(5)
    v_mfma_f32_16x16x32_bf16 a[180:183], a[252:255], v[232:235], a[180:183]
    buffer_load_dwordx4 a[240:243], v254, s[8:11], s42 offen offset:0 sc1
    v_mfma_f32_16x16x32_bf16 a[184:187], v[240:243], v[232:235], a[184:187]
    s_waitcnt vmcnt(16) lgkmcnt(2)
    v_add_f32 v226, v226, v218
    v_fmac_f32 v252, s23, v250
    v_fmac_f32 v226, s23, v222
    v_mfma_f32_16x16x32_bf16 a[188:191], v[244:247], v[232:235], a[188:191]
    ds_read_b128 v[232:235], v253 offset:12992
    v_mul_u32_u24 v209, 5, v208
    v_mfma_f32_16x16x32_bf16 v[0:3], a[192:195], v[236:239], v[0:3]
    s_sub_u32 s19, s19, s3
    v_cvt_pk_bf16_f32 v226, v252, v226
    v_fma_f32 v252, v249, s24, v251
    v_mfma_f32_16x16x32_bf16 v[4:7], a[196:199], v[236:239], v[4:7]
    buffer_load_dwordx4 a[244:247], v254, s[8:11], s42 offen offset:1024 sc1
    v_mfma_f32_16x16x32_bf16 v[8:11], a[200:203], v[236:239], v[8:11]
    ds_read_b128 v[236:239], v253 offset:12736
    v_bfe_u32 v209, s45, v209, 5
    s_waitcnt lgkmcnt(2)
    v_mfma_f32_16x16x32_bf16 v[12:15], a[192:195], v[228:231], v[12:15]
    v_fmac_f32 v251, s25, v249
    v_fma_f32 v249, v248, s24, v250
    v_mfma_f32_16x16x32_bf16 v[16:19], a[196:199], v[228:231], v[16:19]
    s_waitcnt vmcnt(14) lgkmcnt(1)
    v_mul_u32_u24 v209, 65, v209
    v_fmac_f32 v250, s25, v248
    v_mfma_f32_16x16x32_bf16 v[20:23], a[200:203], v[228:231], v[20:23]
    buffer_load_dwordx4 a[248:251], v254, s[8:11], s42 offen offset:2048 sc1
    v_fma_f32 v248, v250, s26, v251
    v_mfma_f32_16x16x32_bf16 v[0:3], a[204:207], v[228:231], v[0:3]
    s_sub_u32 s20, s20, s3
    v_sub_u32 v209, v209, v208
    v_fmac_f32 v251, s27, v250
    v_mfma_f32_16x16x32_bf16 v[4:7], a[208:211], v[228:231], v[4:7]
    s_add_u32 s42, s32, 559104
    v_fma_f32 v250, v249, s28, v252
    v_fmac_f32 v252, s29, v249
    v_mfma_f32_16x16x32_bf16 v[8:11], a[212:215], v[228:231], v[8:11]
    ds_read_b128 v[228:231], v253 offset:12480
    v_lshl_add_u32 v208, v209, 5, v253
    v_mfma_f32_16x16x32_bf16 v[24:27], a[192:195], v[232:235], v[24:27]
    buffer_load_dwordx4 a[252:255], v254, s[8:11], s42 offen offset:0 sc1
    v_mfma_f32_16x16x32_bf16 v[28:31], a[196:199], v[232:235], v[28:31]
    s_sub_u32 s21, s21, s3
    v_fma_f32 v249, v220, s24, v224
    v_fmac_f32 v224, s25, v220
    v_mfma_f32_16x16x32_bf16 v[32:35], a[200:203], v[232:235], v[32:35]
    v_fma_f32 v220, v218, s24, v222
    v_fmac_f32 v222, s25, v218
    v_fma_f32 v218, v222, s26, v224
    v_mfma_f32_16x16x32_bf16 v[12:15], a[204:207], v[232:235], v[12:15]
    s_waitcnt vmcnt(13)
    v_fmac_f32 v224, s27, v222
    v_fma_f32 v222, v220, s28, v249
    v_mfma_f32_16x16x32_bf16 v[16:19], a[208:211], v[232:235], v[16:19]
    buffer_load_dwordx4 v[240:243], v254, s[8:11], s42 offen offset:1024 sc1
    v_mfma_f32_16x16x32_bf16 v[20:23], a[212:215], v[232:235], v[20:23]
    s_mov_b64 exec, s[46:47]
    ds_write_b128 v208, v[204:207] offset:1024
    s_mov_b64 exec, -1
    v_mfma_f32_16x16x32_bf16 v[0:3], a[216:219], v[232:235], v[0:3]
    s_waitcnt lgkmcnt(2)
    v_fmac_f32 v249, s29, v220
    v_cvt_pk_bf16_f32 v218, v248, v218
    v_mfma_f32_16x16x32_bf16 v[4:7], a[220:223], v[232:235], v[4:7]
    buffer_load_dwordx4 v[244:247], v254, s[8:11], s42 offen offset:2048 sc1
    v_mfma_f32_16x16x32_bf16 v[8:11], a[224:227], v[232:235], v[8:11]
    ds_read_b128 v[232:235], v253 offset:14304
    v_and_b32 v215, 0x7fff, v255
    v_mfma_f32_16x16x32_bf16 v[36:39], a[192:195], v[236:239], v[36:39]
    v_cvt_pk_bf16_f32 v224, v251, v224
    v_cvt_pk_bf16_f32 v222, v250, v222
    v_cvt_pk_bf16_f32 v220, v252, v249
    v_mfma_f32_16x16x32_bf16 v[40:43], a[196:199], v[236:239], v[40:43]
    buffer_load_dwordx2 v[204:205], v215, s[4:7], s16 offen offset:320
    v_mfma_f32_16x16x32_bf16 v[44:47], a[200:203], v[236:239], v[44:47]
    v_lshlrev_b32 v248, 16, v219
    v_lshlrev_b32 v249, 16, v221
    v_mfma_f32_16x16x32_bf16 v[24:27], a[204:207], v[236:239], v[24:27]
    v_lshlrev_b32 v250, 16, v223
    v_lshlrev_b32 v251, 16, v225
    v_mfma_f32_16x16x32_bf16 v[28:31], a[208:211], v[236:239], v[28:31]
    buffer_load_dwordx2 v[206:207], v215, s[4:7], s17 offen offset:320
    v_mfma_f32_16x16x32_bf16 v[32:35], a[212:215], v[236:239], v[32:35]
    v_and_b32 v219, s22, v219
    v_and_b32 v221, s22, v221
    v_mfma_f32_16x16x32_bf16 v[12:15], a[216:219], v[236:239], v[12:15]
    s_waitcnt lgkmcnt(2)
    v_and_b32 v223, s22, v223
    v_and_b32 v225, s22, v225
    v_mfma_f32_16x16x32_bf16 v[16:19], a[220:223], v[236:239], v[16:19]
    buffer_load_dwordx2 v[208:209], v215, s[4:7], s18 offen offset:320
    v_lshlrev_b32 v252, 16, v217
    v_mfma_f32_16x16x32_bf16 v[20:23], a[224:227], v[236:239], v[20:23]
    ds_read_b128 v[236:239], v253 offset:14048
    v_and_b32 v217, s22, v217
    v_mfma_f32_16x16x32_bf16 v[48:51], a[192:195], v[228:231], v[48:51]
    v_add_f32 v252, v252, v251
    v_add_f32 v217, v217, v225
    v_mfma_f32_16x16x32_bf16 v[52:55], a[196:199], v[228:231], v[52:55]
    buffer_load_dwordx2 v[210:211], v215, s[4:7], s19 offen offset:320
    v_mfma_f32_16x16x32_bf16 v[56:59], a[200:203], v[228:231], v[56:59]
    v_fmac_f32 v252, s23, v249
    v_fmac_f32 v217, s23, v221
    v_mfma_f32_16x16x32_bf16 v[36:39], a[204:207], v[228:231], v[36:39]
    v_cvt_pk_bf16_f32 v217, v252, v217
    v_lshlrev_b32 v252, 16, v227
    v_mfma_f32_16x16x32_bf16 v[40:43], a[208:211], v[228:231], v[40:43]
    buffer_load_dwordx2 v[212:213], v215, s[4:7], s20 offen offset:320
    v_and_b32 v227, s22, v227
    v_mfma_f32_16x16x32_bf16 v[44:47], a[212:215], v[228:231], v[44:47]
    v_add_f32 v252, v252, v248
    v_add_f32 v227, v227, v219
    v_mfma_f32_16x16x32_bf16 v[24:27], a[216:219], v[228:231], v[24:27]
    s_waitcnt lgkmcnt(1)
    v_fmac_f32 v252, s23, v250
    v_fmac_f32 v227, s23, v223
    v_mfma_f32_16x16x32_bf16 v[28:31], a[220:223], v[228:231], v[28:31]
    buffer_load_dwordx2 v[214:215], v215, s[4:7], s21 offen offset:320
    v_mfma_f32_16x16x32_bf16 v[32:35], a[224:227], v[228:231], v[32:35]
    ds_read_b128 v[228:231], v253 offset:13792
    v_cvt_pk_bf16_f32 v227, v252, v227
    v_mfma_f32_16x16x32_bf16 v[60:63], a[192:195], v[232:235], v[60:63]
    v_fma_f32 v252, v249, s24, v251
    v_fmac_f32 v251, s25, v249
    v_mfma_f32_16x16x32_bf16 v[64:67], a[196:199], v[232:235], v[64:67]
    v_fma_f32 v249, v248, s24, v250
    v_fmac_f32 v250, s25, v248
    v_mfma_f32_16x16x32_bf16 v[68:71], a[200:203], v[232:235], v[68:71]
    v_fma_f32 v248, v250, s26, v251
    v_fmac_f32 v251, s27, v250
    v_fma_f32 v250, v249, s28, v252
    v_mfma_f32_16x16x32_bf16 v[48:51], a[204:207], v[232:235], v[48:51]
    v_fmac_f32 v252, s29, v249
    v_fma_f32 v249, v221, s24, v225
    v_mfma_f32_16x16x32_bf16 v[52:55], a[208:211], v[232:235], v[52:55]
    v_fmac_f32 v225, s25, v221
    v_fma_f32 v221, v219, s24, v223
    v_mfma_f32_16x16x32_bf16 v[56:59], a[212:215], v[232:235], v[56:59]
    v_fmac_f32 v223, s25, v219
    v_fma_f32 v219, v223, s26, v225
    v_mfma_f32_16x16x32_bf16 v[36:39], a[216:219], v[232:235], v[36:39]
    v_fmac_f32 v225, s27, v223
    v_fma_f32 v223, v221, s28, v249
    v_mfma_f32_16x16x32_bf16 v[40:43], a[220:223], v[232:235], v[40:43]
    s_waitcnt lgkmcnt(1)
    v_fmac_f32 v249, s29, v221
    v_cvt_pk_bf16_f32 v219, v248, v219
    v_mfma_f32_16x16x32_bf16 v[44:47], a[224:227], v[232:235], v[44:47]
    ds_read_b128 v[232:235], v253 offset:13536
    v_cvt_pk_bf16_f32 v225, v251, v225
    v_mfma_f32_16x16x32_bf16 v[72:75], a[192:195], v[236:239], v[72:75]
    v_cvt_pk_bf16_f32 v223, v250, v223
    v_cvt_pk_bf16_f32 v221, v252, v249
    v_lshrrev_b32 v252, 15, v255
    v_mfma_f32_16x16x32_bf16 v[76:79], a[196:199], v[236:239], v[76:79]
    ds_write_b64 v252, v[218:219] offset:256
    v_mfma_f32_16x16x32_bf16 v[80:83], a[200:203], v[236:239], v[80:83]
    s_waitcnt vmcnt(15)
    v_lshlrev_b32 v248, 16, v194
    v_lshlrev_b32 v249, 16, v196
    v_mfma_f32_16x16x32_bf16 v[60:63], a[204:207], v[236:239], v[60:63]
    ds_write_b64 v252, v[224:225] offset:2336
    v_mfma_f32_16x16x32_bf16 v[64:67], a[208:211], v[236:239], v[64:67]
    v_lshlrev_b32 v250, 16, v198
    v_lshlrev_b32 v251, 16, v200
    v_mfma_f32_16x16x32_bf16 v[68:71], a[212:215], v[236:239], v[68:71]
    ds_write_b64 v252, v[222:223] offset:4416
    v_mfma_f32_16x16x32_bf16 v[48:51], a[216:219], v[236:239], v[48:51]
    s_waitcnt lgkmcnt(4)
    v_and_b32 v194, s22, v194
    v_and_b32 v196, s22, v196
    v_mfma_f32_16x16x32_bf16 v[52:55], a[220:223], v[236:239], v[52:55]
    ds_write_b64 v252, v[216:217] offset:21056
    v_mfma_f32_16x16x32_bf16 v[56:59], a[224:227], v[236:239], v[56:59]
    ds_read_b128 v[236:239], v253 offset:13264
    v_and_b32 v198, s22, v198
    v_mfma_f32_16x16x32_bf16 v[84:87], a[192:195], v[228:231], v[84:87]
    v_and_b32 v200, s22, v200
    v_mfma_f32_16x16x32_bf16 v[88:91], a[196:199], v[228:231], v[88:91]
    ds_write_b64 v252, v[226:227] offset:29376
    v_mfma_f32_16x16x32_bf16 v[92:95], a[200:203], v[228:231], v[92:95]
    s_add_u32 s42, s32, 589824
    v_mfma_f32_16x16x32_bf16 v[72:75], a[204:207], v[228:231], v[72:75]
    buffer_load_dwordx4 a[192:195], v254, s[8:11], s42 offen offset:0 sc1
    v_mfma_f32_16x16x32_bf16 v[76:79], a[208:211], v[228:231], v[76:79]
    ds_write_b64 v252, v[220:221] offset:6496
    v_mfma_f32_16x16x32_bf16 v[80:83], a[212:215], v[228:231], v[80:83]
    v_mfma_f32_16x16x32_bf16 v[60:63], a[216:219], v[228:231], v[60:63]
    buffer_load_dwordx4 a[196:199], v254, s[8:11], s42 offen offset:1024 sc1
    v_mfma_f32_16x16x32_bf16 v[64:67], a[220:223], v[228:231], v[64:67]
    v_lshlrev_b32 v252, 16, v192
    v_and_b32 v192, s22, v192
    v_mfma_f32_16x16x32_bf16 v[68:71], a[224:227], v[228:231], v[68:71]
    s_waitcnt lgkmcnt(7)
    v_add_f32 v252, v252, v251
    v_add_f32 v192, v192, v200
    v_mfma_f32_16x16x32_bf16 v[84:87], a[204:207], v[232:235], v[84:87]
    ds_read_b128 v[228:231], v253 offset:32240
    v_fmac_f32 v252, s23, v249
    v_mfma_f32_16x16x32_bf16 v[88:91], a[208:211], v[232:235], v[88:91]
    v_fmac_f32 v192, s23, v196
    v_cvt_pk_bf16_f32 v192, v252, v192
    v_mfma_f32_16x16x32_bf16 v[92:95], a[212:215], v[232:235], v[92:95]
    buffer_load_dwordx4 a[200:203], v254, s[8:11], s42 offen offset:2048 sc1
    v_mfma_f32_16x16x32_bf16 v[72:75], a[216:219], v[232:235], v[72:75]
    s_waitcnt lgkmcnt(3)
    v_lshlrev_b32 v252, 16, v202
    v_and_b32 v202, s22, v202
    v_mfma_f32_16x16x32_bf16 v[76:79], a[220:223], v[232:235], v[76:79]
    s_add_u32 s42, s32, 592896
    v_add_f32 v252, v252, v248
    v_add_f32 v202, v202, v194
    v_mfma_f32_16x16x32_bf16 v[80:83], a[224:227], v[232:235], v[80:83]
    ds_read_b128 v[232:235], v253 offset:31968
    v_fmac_f32 v252, s23, v250
    v_mfma_f32_16x16x32_bf16 v[84:87], a[216:219], v[236:239], v[84:87]
    buffer_load_dwordx4 a[204:207], v254, s[8:11], s42 offen offset:0 sc1
    v_mfma_f32_16x16x32_bf16 v[88:91], a[220:223], v[236:239], v[88:91]
    s_waitcnt vmcnt(16) lgkmcnt(1)
    v_fmac_f32 v202, s23, v198
    v_cvt_pk_bf16_f32 v202, v252, v202
    v_mfma_f32_16x16x32_bf16 v[92:95], a[224:227], v[236:239], v[92:95]
    ds_read_b128 v[236:239], v253 offset:31712
    v_fma_f32 v252, v249, s24, v251
    v_mfma_f32_16x16x32_bf16 v[96:99], a[228:231], v[228:231], v[96:99]
    s_waitcnt lgkmcnt(1)
    v_fmac_f32 v251, s25, v249
    v_fma_f32 v249, v248, s24, v250
    v_mfma_f32_16x16x32_bf16 v[100:103], a[232:235], v[228:231], v[100:103]
    buffer_load_dwordx4 a[208:211], v254, s[8:11], s42 offen offset:1024 sc1
    v_mfma_f32_16x16x32_bf16 v[104:107], a[236:239], v[228:231], v[104:107]
    ds_read_b128 v[228:231], v253 offset:31456
    v_fmac_f32 v250, s25, v248
    v_mfma_f32_16x16x32_bf16 v[108:111], a[228:231], v[232:235], v[108:111]
    v_fma_f32 v248, v250, s26, v251
    v_fmac_f32 v251, s27, v250
    v_mfma_f32_16x16x32_bf16 v[112:115], a[232:235], v[232:235], v[112:115]
    s_waitcnt vmcnt(14)
    v_fma_f32 v250, v249, s28, v252
    v_fmac_f32 v252, s29, v249
    v_mfma_f32_16x16x32_bf16 v[116:119], a[236:239], v[232:235], v[116:119]
    buffer_load_dwordx4 a[212:215], v254, s[8:11], s42 offen offset:2048 sc1
    v_mfma_f32_16x16x32_bf16 v[96:99], a[240:243], v[232:235], v[96:99]
    s_waitcnt lgkmcnt(1)
    v_fma_f32 v249, v196, s24, v200
    v_fmac_f32 v200, s25, v196
    v_mfma_f32_16x16x32_bf16 v[100:103], a[244:247], v[232:235], v[100:103]
    s_add_u32 s42, s32, 595968
    v_fma_f32 v196, v194, s24, v198
    v_fmac_f32 v198, s25, v194
    v_mfma_f32_16x16x32_bf16 v[104:107], a[248:251], v[232:235], v[104:107]
    ds_read_b128 v[232:235], v253 offset:31200
    v_fma_f32 v194, v198, s26, v200
    v_mfma_f32_16x16x32_bf16 v[120:123], a[228:231], v[236:239], v[120:123]
    buffer_load_dwordx4 a[216:219], v254, s[8:11], s42 offen offset:0 sc1
    v_mfma_f32_16x16x32_bf16 v[124:127], a[232:235], v[236:239], v[124:127]
    v_fmac_f32 v200, s27, v198
    v_fma_f32 v198, v196, s28, v249
    v_mfma_f32_16x16x32_bf16 v[128:131], a[236:239], v[236:239], v[128:131]
    v_fmac_f32 v249, s29, v196
    v_cvt_pk_bf16_f32 v194, v248, v194
    v_mfma_f32_16x16x32_bf16 v[108:111], a[240:243], v[236:239], v[108:111]
    v_cvt_pk_bf16_f32 v200, v251, v200
    v_cvt_pk_bf16_f32 v198, v250, v198
    v_mfma_f32_16x16x32_bf16 v[112:115], a[244:247], v[236:239], v[112:115]
    buffer_load_dwordx4 a[220:223], v254, s[8:11], s42 offen offset:1024 sc1
    v_mfma_f32_16x16x32_bf16 v[116:119], a[248:251], v[236:239], v[116:119]
    s_waitcnt vmcnt(14)
    v_cvt_pk_bf16_f32 v196, v252, v249
    v_lshlrev_b32 v248, 16, v195
    v_mfma_f32_16x16x32_bf16 v[96:99], a[252:255], v[236:239], v[96:99]
    s_waitcnt lgkmcnt(1)
    v_lshlrev_b32 v249, 16, v197
    v_lshlrev_b32 v250, 16, v199
    v_mfma_f32_16x16x32_bf16 v[100:103], v[240:243], v[236:239], v[100:103]
    buffer_load_dwordx4 a[224:227], v254, s[8:11], s42 offen offset:2048 sc1
    v_mfma_f32_16x16x32_bf16 v[104:107], v[244:247], v[236:239], v[104:107]
    ds_read_b128 v[236:239], v253 offset:33024
    v_and_b32 v227, 0x7fff, v255
    v_mfma_f32_16x16x32_bf16 v[132:135], a[228:231], v[228:231], v[132:135]
    v_lshlrev_b32 v251, 16, v201
    v_and_b32 v195, s22, v195
    v_mfma_f32_16x16x32_bf16 v[136:139], a[232:235], v[228:231], v[136:139]
    buffer_load_dwordx2 v[216:217], v227, s[4:7], s16 offen offset:704
    v_mfma_f32_16x16x32_bf16 v[140:143], a[236:239], v[228:231], v[140:143]
    v_and_b32 v197, s22, v197
    v_and_b32 v199, s22, v199
    v_mfma_f32_16x16x32_bf16 v[120:123], a[240:243], v[228:231], v[120:123]
    v_and_b32 v201, s22, v201
    v_lshlrev_b32 v252, 16, v193
    v_mfma_f32_16x16x32_bf16 v[124:127], a[244:247], v[228:231], v[124:127]
    buffer_load_dwordx2 v[218:219], v227, s[4:7], s17 offen offset:704
    v_mfma_f32_16x16x32_bf16 v[128:131], a[248:251], v[228:231], v[128:131]
    v_and_b32 v193, s22, v193
    v_add_f32 v252, v252, v251
    v_mfma_f32_16x16x32_bf16 v[108:111], a[252:255], v[228:231], v[108:111]
    s_waitcnt lgkmcnt(1)
    v_add_f32 v193, v193, v201
    v_fmac_f32 v252, s23, v249
    v_mfma_f32_16x16x32_bf16 v[112:115], v[240:243], v[228:231], v[112:115]
    buffer_load_dwordx2 v[220:221], v227, s[4:7], s18 offen offset:704
    v_mfma_f32_16x16x32_bf16 v[116:119], v[244:247], v[228:231], v[116:119]
    ds_read_b128 v[228:231], v253 offset:32768
    v_fmac_f32 v193, s23, v197
    v_mfma_f32_16x16x32_bf16 v[144:147], a[228:231], v[232:235], v[144:147]
    v_cvt_pk_bf16_f32 v193, v252, v193
    v_lshlrev_b32 v252, 16, v203
    v_mfma_f32_16x16x32_bf16 v[148:151], a[232:235], v[232:235], v[148:151]
    buffer_load_dwordx2 v[222:223], v227, s[4:7], s19 offen offset:704
    v_mfma_f32_16x16x32_bf16 v[152:155], a[236:239], v[232:235], v[152:155]
    v_and_b32 v203, s22, v203
    v_add_f32 v252, v252, v248
    v_mfma_f32_16x16x32_bf16 v[132:135], a[240:243], v[232:235], v[132:135]
    v_add_f32 v203, v203, v195
    v_fmac_f32 v252, s23, v250
    v_mfma_f32_16x16x32_bf16 v[136:139], a[244:247], v[232:235], v[136:139]
    buffer_load_dwordx2 v[224:225], v227, s[4:7], s20 offen offset:704
    v_mfma_f32_16x16x32_bf16 v[140:143], a[248:251], v[232:235], v[140:143]
    v_fmac_f32 v203, s23, v199
    v_cvt_pk_bf16_f32 v203, v252, v203
    v_mfma_f32_16x16x32_bf16 v[120:123], a[252:255], v[232:235], v[120:123]
    s_waitcnt lgkmcnt(1)
    v_fma_f32 v252, v249, s24, v251
    v_fmac_f32 v251, s25, v249
    v_mfma_f32_16x16x32_bf16 v[124:127], v[240:243], v[232:235], v[124:127]
    buffer_load_dwordx2 v[226:227], v227, s[4:7], s21 offen offset:704
    v_mfma_f32_16x16x32_bf16 v[128:131], v[244:247], v[232:235], v[128:131]
    ds_read_b128 v[232:235], v253 offset:32512
    v_fma_f32 v249, v248, s24, v250
    v_mfma_f32_16x16x32_bf16 v[156:159], a[228:231], v[236:239], v[156:159]
    v_fmac_f32 v250, s25, v248
    v_fma_f32 v248, v250, s26, v251
    v_mfma_f32_16x16x32_bf16 v[160:163], a[232:235], v[236:239], v[160:163]
    v_fmac_f32 v251, s27, v250
    v_fma_f32 v250, v249, s28, v252
    v_mfma_f32_16x16x32_bf16 v[164:167], a[236:239], v[236:239], v[164:167]
    v_fmac_f32 v252, s29, v249
    v_fma_f32 v249, v197, s24, v201
    v_mfma_f32_16x16x32_bf16 v[144:147], a[240:243], v[236:239], v[144:147]
    v_fmac_f32 v201, s25, v197
    v_fma_f32 v197, v195, s24, v199
    v_mfma_f32_16x16x32_bf16 v[148:151], a[244:247], v[236:239], v[148:151]
    v_fmac_f32 v199, s25, v195
    v_fma_f32 v195, v199, s26, v201
    v_mfma_f32_16x16x32_bf16 v[152:155], a[248:251], v[236:239], v[152:155]
    v_fmac_f32 v201, s27, v199
    v_fma_f32 v199, v197, s28, v249
    v_mfma_f32_16x16x32_bf16 v[132:135], a[252:255], v[236:239], v[132:135]
    v_fmac_f32 v249, s29, v197
    v_cvt_pk_bf16_f32 v195, v248, v195
    v_mfma_f32_16x16x32_bf16 v[136:139], v[240:243], v[236:239], v[136:139]
    s_waitcnt lgkmcnt(1)
    v_cvt_pk_bf16_f32 v201, v251, v201
    v_cvt_pk_bf16_f32 v199, v250, v199
    v_mfma_f32_16x16x32_bf16 v[140:143], v[244:247], v[236:239], v[140:143]
    ds_read_b128 v[236:239], v253 offset:32256
    v_cvt_pk_bf16_f32 v197, v252, v249
    v_mfma_f32_16x16x32_bf16 v[168:171], a[228:231], v[228:231], v[168:171]
    v_lshrrev_b32 v252, 15, v255
    v_mfma_f32_16x16x32_bf16 v[172:175], a[232:235], v[228:231], v[172:175]
    ds_write_b64 v252, v[194:195] offset:0
    v_mfma_f32_16x16x32_bf16 v[176:179], a[236:239], v[228:231], v[176:179]
    s_waitcnt vmcnt(15)
    v_lshlrev_b32 v248, 16, v206
    v_lshlrev_b32 v249, 16, v208
    v_mfma_f32_16x16x32_bf16 v[156:159], a[240:243], v[228:231], v[156:159]
    ds_write_b64 v252, v[200:201] offset:2080
    v_mfma_f32_16x16x32_bf16 v[160:163], a[244:247], v[228:231], v[160:163]
    v_lshlrev_b32 v250, 16, v210
    v_lshlrev_b32 v251, 16, v212
    v_mfma_f32_16x16x32_bf16 v[164:167], a[248:251], v[228:231], v[164:167]
    ds_write_b64 v252, v[198:199] offset:4160
    v_mfma_f32_16x16x32_bf16 v[144:147], a[252:255], v[228:231], v[144:147]
    s_waitcnt lgkmcnt(4)
    v_and_b32 v206, s22, v206
    v_and_b32 v208, s22, v208
    v_mfma_f32_16x16x32_bf16 v[148:151], v[240:243], v[228:231], v[148:151]
    ds_write_b64 v252, v[192:193] offset:20800
    v_mfma_f32_16x16x32_bf16 v[152:155], v[244:247], v[228:231], v[152:155]
    ds_read_b128 v[228:231], v253 offset:31984
    v_and_b32 v210, s22, v210
    v_mfma_f32_16x16x32_bf16 v[180:183], a[228:231], v[232:235], v[180:183]
    v_and_b32 v212, s22, v212
    v_mfma_f32_16x16x32_bf16 v[184:187], a[232:235], v[232:235], v[184:187]
    ds_write_b64 v252, v[202:203] offset:29120
    v_mfma_f32_16x16x32_bf16 v[188:191], a[236:239], v[232:235], v[188:191]
    s_add_u32 s42, s32, 626688
    v_mfma_f32_16x16x32_bf16 v[168:171], a[240:243], v[232:235], v[168:171]
    buffer_load_dwordx4 a[228:231], v254, s[8:11], s42 offen offset:0 sc1
    v_mfma_f32_16x16x32_bf16 v[172:175], a[244:247], v[232:235], v[172:175]
    ds_write_b64 v252, v[196:197] offset:6240
    v_mfma_f32_16x16x32_bf16 v[176:179], a[248:251], v[232:235], v[176:179]
    s_waitcnt lgkmcnt(7)
    v_mfma_f32_16x16x32_bf16 v[156:159], a[252:255], v[232:235], v[156:159]
    buffer_load_dwordx4 a[232:235], v254, s[8:11], s42 offen offset:1024 sc1
    v_mfma_f32_16x16x32_bf16 v[160:163], v[240:243], v[232:235], v[160:163]
    s_waitcnt lgkmcnt(0)
    v_lshlrev_b32 v252, 16, v204
    v_and_b32 v204, s22, v204
    v_mfma_f32_16x16x32_bf16 v[164:167], v[244:247], v[232:235], v[164:167]
    s_barrier
    v_mfma_f32_16x16x32_bf16 v[180:183], a[240:243], v[236:239], v[180:183]
    ds_read_b128 v[232:235], v253 offset:1040
    v_add_f32 v252, v252, v251
    v_mfma_f32_16x16x32_bf16 v[184:187], a[244:247], v[236:239], v[184:187]
    v_add_f32 v204, v204, v212
    v_fmac_f32 v252, s23, v249
    v_mfma_f32_16x16x32_bf16 v[188:191], a[248:251], v[236:239], v[188:191]
    buffer_load_dwordx4 a[236:239], v254, s[8:11], s42 offen offset:2048 sc1
    v_mfma_f32_16x16x32_bf16 v[168:171], a[252:255], v[236:239], v[168:171]
    v_fmac_f32 v204, s23, v208
    v_cvt_pk_bf16_f32 v204, v252, v204
    v_mfma_f32_16x16x32_bf16 v[172:175], v[240:243], v[236:239], v[172:175]
    s_add_u32 s42, s32, 629760
    v_lshlrev_b32 v252, 16, v214
    v_and_b32 v214, s22, v214
    v_mfma_f32_16x16x32_bf16 v[176:179], v[244:247], v[236:239], v[176:179]
    ds_read_b128 v[236:239], v253 offset:768
    v_add_f32 v252, v252, v248
    v_mfma_f32_16x16x32_bf16 v[180:183], a[252:255], v[228:231], v[180:183]
    buffer_load_dwordx4 a[240:243], v254, s[8:11], s42 offen offset:0 sc1
    v_mfma_f32_16x16x32_bf16 v[184:187], v[240:243], v[228:231], v[184:187]
    s_waitcnt vmcnt(16) lgkmcnt(1)
    v_add_f32 v214, v214, v206
    v_fmac_f32 v252, s23, v250
    v_mfma_f32_16x16x32_bf16 v[188:191], v[244:247], v[228:231], v[188:191]
    ds_read_b128 v[228:231], v253 offset:512
    v_fmac_f32 v214, s23, v210
    v_mfma_f32_16x16x32_bf16 a[0:3], a[192:195], v[232:235], a[0:3]
    s_waitcnt lgkmcnt(1)
    v_cvt_pk_bf16_f32 v214, v252, v214
    v_fma_f32 v252, v249, s24, v251
    v_mfma_f32_16x16x32_bf16 a[4:7], a[196:199], v[232:235], a[4:7]
    buffer_load_dwordx4 a[244:247], v254, s[8:11], s42 offen offset:1024 sc1
    v_mfma_f32_16x16x32_bf16 a[8:11], a[200:203], v[232:235], a[8:11]
    ds_read_b128 v[232:235], v253 offset:256
    v_fmac_f32 v251, s25, v249
    v_mfma_f32_16x16x32_bf16 a[12:15], a[192:195], v[236:239], a[12:15]
    v_fma_f32 v249, v248, s24, v250
    v_fmac_f32 v250, s25, v248
    v_mfma_f32_16x16x32_bf16 a[16:19], a[196:199], v[236:239], a[16:19]
    s_waitcnt vmcnt(14)
    v_fma_f32 v248, v250, s26, v251
    v_fmac_f32 v251, s27, v250
    v_mfma_f32_16x16x32_bf16 a[20:23], a[200:203], v[236:239], a[20:23]
    buffer_load_dwordx4 a[248:251], v254, s[8:11], s42 offen offset:2048 sc1
    v_mfma_f32_16x16x32_bf16 a[0:3], a[204:207], v[236:239], a[0:3]
    s_waitcnt lgkmcnt(1)
    v_fma_f32 v250, v249, s28, v252
    v_fmac_f32 v252, s29, v249
    v_mfma_f32_16x16x32_bf16 a[4:7], a[208:211], v[236:239], a[4:7]
    s_add_u32 s42, s32, 632832
    v_fma_f32 v249, v208, s24, v212
    v_fmac_f32 v212, s25, v208
    v_mfma_f32_16x16x32_bf16 a[8:11], a[212:215], v[236:239], a[8:11]
    ds_read_b128 v[236:239], v253 offset:0
    v_fma_f32 v208, v206, s24, v210
    v_mfma_f32_16x16x32_bf16 a[24:27], a[192:195], v[228:231], a[24:27]
    buffer_load_dwordx4 a[252:255], v254, s[8:11], s42 offen offset:0 sc1
    v_mfma_f32_16x16x32_bf16 a[28:31], a[196:199], v[228:231], a[28:31]
    v_fmac_f32 v210, s25, v206
    v_fma_f32 v206, v210, s26, v212
    v_mfma_f32_16x16x32_bf16 a[32:35], a[200:203], v[228:231], a[32:35]
    v_fmac_f32 v212, s27, v210
    v_fma_f32 v210, v208, s28, v249
    v_mfma_f32_16x16x32_bf16 a[12:15], a[204:207], v[228:231], a[12:15]
    v_fmac_f32 v249, s29, v208
    v_cvt_pk_bf16_f32 v206, v248, v206
    v_mfma_f32_16x16x32_bf16 a[16:19], a[208:211], v[228:231], a[16:19]
    buffer_load_dwordx4 v[240:243], v254, s[8:11], s42 offen offset:1024 sc1
    v_mfma_f32_16x16x32_bf16 a[20:23], a[212:215], v[228:231], a[20:23]
    s_waitcnt vmcnt(14)
    v_cvt_pk_bf16_f32 v212, v251, v212
    v_cvt_pk_bf16_f32 v210, v250, v210
    v_mfma_f32_16x16x32_bf16 a[0:3], a[216:219], v[228:231], a[0:3]
    s_waitcnt lgkmcnt(1)
    v_cvt_pk_bf16_f32 v208, v252, v249
    v_lshlrev_b32 v248, 16, v207
    v_mfma_f32_16x16x32_bf16 a[4:7], a[220:223], v[228:231], a[4:7]
    buffer_load_dwordx4 v[244:247], v254, s[8:11], s42 offen offset:2048 sc1
    v_mfma_f32_16x16x32_bf16 a[8:11], a[224:227], v[228:231], a[8:11]
    ds_read_b128 v[228:231], v253 offset:1824
    v_and_b32 v203, 0x7fff, v255
    v_mfma_f32_16x16x32_bf16 a[36:39], a[192:195], v[232:235], a[36:39]
    v_lshlrev_b32 v249, 16, v209
    v_lshlrev_b32 v250, 16, v211
    v_mfma_f32_16x16x32_bf16 a[40:43], a[196:199], v[232:235], a[40:43]
    buffer_load_dwordx2 v[192:193], v203, s[4:7], s16 offen offset:1088
    v_mfma_f32_16x16x32_bf16 a[44:47], a[200:203], v[232:235], a[44:47]
    v_lshlrev_b32 v251, 16, v213
    v_and_b32 v207, s22, v207
    v_mfma_f32_16x16x32_bf16 a[24:27], a[204:207], v[232:235], a[24:27]
    v_and_b32 v209, s22, v209
    v_and_b32 v211, s22, v211
    v_mfma_f32_16x16x32_bf16 a[28:31], a[208:211], v[232:235], a[28:31]
    buffer_load_dwordx2 v[194:195], v203, s[4:7], s17 offen offset:1088
    v_mfma_f32_16x16x32_bf16 a[32:35], a[212:215], v[232:235], a[32:35]
    v_and_b32 v213, s22, v213
    v_lshlrev_b32 v252, 16, v205
    v_mfma_f32_16x16x32_bf16 a[12:15], a[216:219], v[232:235], a[12:15]
    s_waitcnt lgkmcnt(1)
    v_and_b32 v205, s22, v205
    v_add_f32 v252, v252, v251
    v_mfma_f32_16x16x32_bf16 a[16:19], a[220:223], v[232:235], a[16:19]
    buffer_load_dwordx2 v[196:197], v203, s[4:7], s18 offen offset:1088
    v_mfma_f32_16x16x32_bf16 a[20:23], a[224:227], v[232:235], a[20:23]
    ds_read_b128 v[232:235], v253 offset:1568
    v_add_f32 v205, v205, v213
    v_mfma_f32_16x16x32_bf16 a[48:51], a[192:195], v[236:239], a[48:51]
    v_fmac_f32 v252, s23, v249
    v_fmac_f32 v205, s23, v209
    v_mfma_f32_16x16x32_bf16 a[52:55], a[196:199], v[236:239], a[52:55]
    buffer_load_dwordx2 v[198:199], v203, s[4:7], s19 offen offset:1088
    v_mfma_f32_16x16x32_bf16 a[56:59], a[200:203], v[236:239], a[56:59]
    v_cvt_pk_bf16_f32 v205, v252, v205
    v_lshlrev_b32 v252, 16, v215
    v_mfma_f32_16x16x32_bf16 a[36:39], a[204:207], v[236:239], a[36:39]
    v_and_b32 v215, s22, v215
    v_add_f32 v252, v252, v248
    v_mfma_f32_16x16x32_bf16 a[40:43], a[208:211], v[236:239], a[40:43]
    buffer_load_dwordx2 v[200:201], v203, s[4:7], s20 offen offset:1088
    v_mfma_f32_16x16x32_bf16 a[44:47], a[212:215], v[236:239], a[44:47]
    v_add_f32 v215, v215, v207
    v_fmac_f32 v252, s23, v250
    v_mfma_f32_16x16x32_bf16 a[24:27], a[216:219], v[236:239], a[24:27]
    s_waitcnt lgkmcnt(1)
    v_fmac_f32 v215, s23, v211
    v_cvt_pk_bf16_f32 v215, v252, v215
    v_mfma_f32_16x16x32_bf16 a[28:31], a[220:223], v[236:239], a[28:31]
    buffer_load_dwordx2 v[202:203], v203, s[4:7], s21 offen offset:1088
    v_mfma_f32_16x16x32_bf16 a[32:35], a[224:227], v[236:239], a[32:35]
    ds_read_b128 v[236:239], v253 offset:1312
    v_fma_f32 v252, v249, s24, v251
    v_mfma_f32_16x16x32_bf16 a[60:63], a[192:195], v[228:231], a[60:63]
    v_fmac_f32 v251, s25, v249
    v_fma_f32 v249, v248, s24, v250
    v_mfma_f32_16x16x32_bf16 a[64:67], a[196:199], v[228:231], a[64:67]
    v_fmac_f32 v250, s25, v248
    v_fma_f32 v248, v250, s26, v251
    v_mfma_f32_16x16x32_bf16 a[68:71], a[200:203], v[228:231], a[68:71]
    v_fmac_f32 v251, s27, v250
    v_fma_f32 v250, v249, s28, v252
    v_mfma_f32_16x16x32_bf16 a[48:51], a[204:207], v[228:231], a[48:51]
    v_fmac_f32 v252, s29, v249
    v_fma_f32 v249, v209, s24, v213
    v_mfma_f32_16x16x32_bf16 a[52:55], a[208:211], v[228:231], a[52:55]
    v_fmac_f32 v213, s25, v209
    v_fma_f32 v209, v207, s24, v211
    v_mfma_f32_16x16x32_bf16 a[56:59], a[212:215], v[228:231], a[56:59]
    v_fmac_f32 v211, s25, v207
    v_fma_f32 v207, v211, s26, v213
    v_mfma_f32_16x16x32_bf16 a[36:39], a[216:219], v[228:231], a[36:39]
    v_fmac_f32 v213, s27, v211
    v_fma_f32 v211, v209, s28, v249
    v_mfma_f32_16x16x32_bf16 a[40:43], a[220:223], v[228:231], a[40:43]
    s_waitcnt lgkmcnt(1)
    v_fmac_f32 v249, s29, v209
    v_cvt_pk_bf16_f32 v207, v248, v207
    v_mfma_f32_16x16x32_bf16 a[44:47], a[224:227], v[228:231], a[44:47]
    ds_read_b128 v[228:231], v253 offset:1056
    v_cvt_pk_bf16_f32 v213, v251, v213
    v_mfma_f32_16x16x32_bf16 a[72:75], a[192:195], v[232:235], a[72:75]
    v_cvt_pk_bf16_f32 v211, v250, v211
    v_cvt_pk_bf16_f32 v209, v252, v249
    v_mfma_f32_16x16x32_bf16 a[76:79], a[196:199], v[232:235], a[76:79]
    v_lshrrev_b32 v252, 15, v255
    v_mfma_f32_16x16x32_bf16 a[80:83], a[200:203], v[232:235], a[80:83]
    ds_write_b64 v252, v[206:207] offset:9088
    v_mfma_f32_16x16x32_bf16 a[60:63], a[204:207], v[232:235], a[60:63]
    s_waitcnt vmcnt(15)
    v_lshlrev_b32 v248, 16, v218
    v_lshlrev_b32 v249, 16, v220
    v_mfma_f32_16x16x32_bf16 a[64:67], a[208:211], v[232:235], a[64:67]
    ds_write_b64 v252, v[212:213] offset:11168
    v_mfma_f32_16x16x32_bf16 a[68:71], a[212:215], v[232:235], a[68:71]
    v_lshlrev_b32 v250, 16, v222
    v_lshlrev_b32 v251, 16, v224
    v_mfma_f32_16x16x32_bf16 a[48:51], a[216:219], v[232:235], a[48:51]
    ds_write_b64 v252, v[210:211] offset:13248
    v_mfma_f32_16x16x32_bf16 a[52:55], a[220:223], v[232:235], a[52:55]
    s_waitcnt lgkmcnt(4)
    v_and_b32 v218, s22, v218
    v_and_b32 v220, s22, v220
    v_mfma_f32_16x16x32_bf16 a[56:59], a[224:227], v[232:235], a[56:59]
    ds_read_b128 v[232:235], v253 offset:784
    v_mfma_f32_16x16x32_bf16 a[84:87], a[192:195], v[236:239], a[84:87]
    ds_write_b64 v252, v[204:205] offset:23648
    v_mfma_f32_16x16x32_bf16 a[88:91], a[196:199], v[236:239], a[88:91]
    v_and_b32 v222, s22, v222
    v_and_b32 v224, s22, v224
    v_mfma_f32_16x16x32_bf16 a[92:95], a[200:203], v[236:239], a[92:95]
    s_add_u32 s42, s32, 663552
    v_mfma_f32_16x16x32_bf16 a[72:75], a[204:207], v[236:239], a[72:75]
    buffer_load_dwordx4 a[192:195], v254, s[8:11], s42 offen offset:0 sc1
    v_mfma_f32_16x16x32_bf16 a[76:79], a[208:211], v[236:239], a[76:79]
    ds_write_b64 v252, v[214:215] offset:31968
    v_mfma_f32_16x16x32_bf16 a[80:83], a[212:215], v[236:239], a[80:83]
    s_waitcnt lgkmcnt(6)
    v_mfma_f32_16x16x32_bf16 a[60:63], a[216:219], v[236:239], a[60:63]
    buffer_load_dwordx4 a[196:199], v254, s[8:11], s42 offen offset:1024 sc1
    v_mfma_f32_16x16x32_bf16 a[64:67], a[220:223], v[236:239], a[64:67]
    s_waitcnt lgkmcnt(0)
    v_mfma_f32_16x16x32_bf16 a[68:71], a[224:227], v[236:239], a[68:71]
    s_barrier
    v_mfma_f32_16x16x32_bf16 a[84:87], a[204:207], v[228:231], a[84:87]
    ds_read_b128 v[236:239], v253 offset:3120
    v_mfma_f32_16x16x32_bf16 a[88:91], a[208:211], v[228:231], a[88:91]
    ds_write_b64 v252, v[208:209] offset:768
    v_mfma_f32_16x16x32_bf16 a[92:95], a[212:215], v[228:231], a[92:95]
    buffer_load_dwordx4 a[200:203], v254, s[8:11], s42 offen offset:2048 sc1
    v_mfma_f32_16x16x32_bf16 a[72:75], a[216:219], v[228:231], a[72:75]
    v_lshlrev_b32 v252, 16, v216
    v_and_b32 v216, s22, v216
    v_mfma_f32_16x16x32_bf16 a[76:79], a[220:223], v[228:231], a[76:79]
    s_add_u32 s42, s32, 666624
    v_add_f32 v252, v252, v251
    v_add_f32 v216, v216, v224
    v_fmac_f32 v252, s23, v249
    v_mfma_f32_16x16x32_bf16 a[80:83], a[224:227], v[228:231], a[80:83]
    ds_read_b128 v[228:231], v253 offset:2848
    v_fmac_f32 v216, s23, v220
    v_mfma_f32_16x16x32_bf16 a[84:87], a[216:219], v[232:235], a[84:87]
    buffer_load_dwordx4 a[204:207], v254, s[8:11], s42 offen offset:0 sc1
    v_mfma_f32_16x16x32_bf16 a[88:91], a[220:223], v[232:235], a[88:91]
    s_waitcnt vmcnt(16) lgkmcnt(2)
    v_cvt_pk_bf16_f32 v216, v252, v216
    v_lshlrev_b32 v252, 16, v226
    v_mfma_f32_16x16x32_bf16 a[92:95], a[224:227], v[232:235], a[92:95]
    ds_read_b128 v[232:235], v253 offset:2592
    v_and_b32 v226, s22, v226
    v_mfma_f32_16x16x32_bf16 a[96:99], a[228:231], v[236:239], a[96:99]
    s_waitcnt lgkmcnt(1)
    v_add_f32 v252, v252, v248
    v_add_f32 v226, v226, v218
    v_mfma_f32_16x16x32_bf16 a[100:103], a[232:235], v[236:239], a[100:103]
    buffer_load_dwordx4 a[208:211], v254, s[8:11], s42 offen offset:1024 sc1
    v_mfma_f32_16x16x32_bf16 a[104:107], a[236:239], v[236:239], a[104:107]
    ds_read_b128 v[236:239], v253 offset:2336
    v_fmac_f32 v252, s23, v250
    v_mfma_f32_16x16x32_bf16 a[108:111], a[228:231], v[228:231], a[108:111]
    v_fmac_f32 v226, s23, v222
    v_cvt_pk_bf16_f32 v226, v252, v226
    v_mfma_f32_16x16x32_bf16 a[112:115], a[232:235], v[228:231], a[112:115]
    s_waitcnt vmcnt(14)
    v_fma_f32 v252, v249, s24, v251
    v_fmac_f32 v251, s25, v249
    v_mfma_f32_16x16x32_bf16 a[116:119], a[236:239], v[228:231], a[116:119]
    buffer_load_dwordx4 a[212:215], v254, s[8:11], s42 offen offset:2048 sc1
    v_fma_f32 v249, v248, s24, v250
    v_mfma_f32_16x16x32_bf16 a[96:99], a[240:243], v[228:231], a[96:99]
    s_waitcnt lgkmcnt(1)
    v_fmac_f32 v250, s25, v248
    v_fma_f32 v248, v250, s26, v251
    v_mfma_f32_16x16x32_bf16 a[100:103], a[244:247], v[228:231], a[100:103]
    s_add_u32 s42, s32, 669696
    v_fmac_f32 v251, s27, v250
    v_fma_f32 v250, v249, s28, v252
    v_mfma_f32_16x16x32_bf16 a[104:107], a[248:251], v[228:231], a[104:107]
    ds_read_b128 v[228:231], v253 offset:2080
    v_fmac_f32 v252, s29, v249
    v_mfma_f32_16x16x32_bf16 a[120:123], a[228:231], v[232:235], a[120:123]
    buffer_load_dwordx4 a[216:219], v254, s[8:11], s42 offen offset:0 sc1
    v_mfma_f32_16x16x32_bf16 a[124:127], a[232:235], v[232:235], a[124:127]
    v_fma_f32 v249, v220, s24, v224
    v_fmac_f32 v224, s25, v220
    v_mfma_f32_16x16x32_bf16 a[128:131], a[236:239], v[232:235], a[128:131]
    v_fma_f32 v220, v218, s24, v222
    v_fmac_f32 v222, s25, v218
    v_mfma_f32_16x16x32_bf16 a[108:111], a[240:243], v[232:235], a[108:111]
    v_fma_f32 v218, v222, s26, v224
    v_fmac_f32 v224, s27, v222
    v_mfma_f32_16x16x32_bf16 a[112:115], a[244:247], v[232:235], a[112:115]
    buffer_load_dwordx4 a[220:223], v254, s[8:11], s42 offen offset:1024 sc1
    v_mfma_f32_16x16x32_bf16 a[116:119], a[248:251], v[232:235], a[116:119]
    s_waitcnt vmcnt(14)
    v_fma_f32 v222, v220, s28, v249
    v_fmac_f32 v249, s29, v220
    v_mfma_f32_16x16x32_bf16 a[96:99], a[252:255], v[232:235], a[96:99]
    s_waitcnt lgkmcnt(1)
    v_cvt_pk_bf16_f32 v218, v248, v218
    v_cvt_pk_bf16_f32 v224, v251, v224
    v_cvt_pk_bf16_f32 v222, v250, v222
    v_mfma_f32_16x16x32_bf16 a[100:103], v[240:243], v[232:235], a[100:103]
    buffer_load_dwordx4 a[224:227], v254, s[8:11], s42 offen offset:2048 sc1
    v_mfma_f32_16x16x32_bf16 a[104:107], v[244:247], v[232:235], a[104:107]
    ds_read_b128 v[232:235], v253 offset:3904
    v_and_b32 v215, 0x7fff, v255
    v_mfma_f32_16x16x32_bf16 a[132:135], a[228:231], v[236:239], a[132:135]
    v_cvt_pk_bf16_f32 v220, v252, v249
    v_lshlrev_b32 v248, 16, v219
    v_mfma_f32_16x16x32_bf16 a[136:139], a[232:235], v[236:239], a[136:139]
    buffer_load_dwordx2 v[204:205], v215, s[4:7], s16 offen offset:1472
    v_mfma_f32_16x16x32_bf16 a[140:143], a[236:239], v[236:239], a[140:143]
    v_lshlrev_b32 v249, 16, v221
    v_lshlrev_b32 v250, 16, v223
    v_mfma_f32_16x16x32_bf16 a[120:123], a[240:243], v[236:239], a[120:123]
    v_lshlrev_b32 v251, 16, v225
    v_and_b32 v219, s22, v219
    v_mfma_f32_16x16x32_bf16 a[124:127], a[244:247], v[236:239], a[124:127]
    buffer_load_dwordx2 v[206:207], v215, s[4:7], s17 offen offset:1472
    v_mfma_f32_16x16x32_bf16 a[128:131], a[248:251], v[236:239], a[128:131]
    v_and_b32 v221, s22, v221
    v_and_b32 v223, s22, v223
    v_mfma_f32_16x16x32_bf16 a[108:111], a[252:255], v[236:239], a[108:111]
    s_waitcnt lgkmcnt(1)
    v_and_b32 v225, s22, v225
    v_lshlrev_b32 v252, 16, v217
    v_mfma_f32_16x16x32_bf16 a[112:115], v[240:243], v[236:239], a[112:115]
    buffer_load_dwordx2 v[208:209], v215, s[4:7], s18 offen offset:1472
    v_and_b32 v217, s22, v217
    v_mfma_f32_16x16x32_bf16 a[116:119], v[244:247], v[236:239], a[116:119]
    ds_read_b128 v[236:239], v253 offset:3648
    v_add_f32 v252, v252, v251
    v_mfma_f32_16x16x32_bf16 a[144:147], a[228:231], v[228:231], a[144:147]
    v_add_f32 v217, v217, v225
    v_fmac_f32 v252, s23, v249
    v_mfma_f32_16x16x32_bf16 a[148:151], a[232:235], v[228:231], a[148:151]
    buffer_load_dwordx2 v[210:211], v215, s[4:7], s19 offen offset:1472
    v_mfma_f32_16x16x32_bf16 a[152:155], a[236:239], v[228:231], a[152:155]
    v_fmac_f32 v217, s23, v221
    v_cvt_pk_bf16_f32 v217, v252, v217
    v_mfma_f32_16x16x32_bf16 a[132:135], a[240:243], v[228:231], a[132:135]
    v_lshlrev_b32 v252, 16, v227
    v_and_b32 v227, s22, v227
    v_mfma_f32_16x16x32_bf16 a[136:139], a[244:247], v[228:231], a[136:139]
    buffer_load_dwordx2 v[212:213], v215, s[4:7], s20 offen offset:1472
    v_mfma_f32_16x16x32_bf16 a[140:143], a[248:251], v[228:231], a[140:143]
    v_add_f32 v252, v252, v248
    v_add_f32 v227, v227, v219
    v_mfma_f32_16x16x32_bf16 a[120:123], a[252:255], v[228:231], a[120:123]
    s_waitcnt lgkmcnt(1)
    v_fmac_f32 v252, s23, v250
    v_fmac_f32 v227, s23, v223
    v_mfma_f32_16x16x32_bf16 a[124:127], v[240:243], v[228:231], a[124:127]
    buffer_load_dwordx2 v[214:215], v215, s[4:7], s21 offen offset:1472
    v_mfma_f32_16x16x32_bf16 a[128:131], v[244:247], v[228:231], a[128:131]
    ds_read_b128 v[228:231], v253 offset:3392
    v_cvt_pk_bf16_f32 v227, v252, v227
    v_fma_f32 v252, v249, s24, v251
    v_mfma_f32_16x16x32_bf16 a[156:159], a[228:231], v[232:235], a[156:159]
    v_fmac_f32 v251, s25, v249
    v_fma_f32 v249, v248, s24, v250
    v_mfma_f32_16x16x32_bf16 a[160:163], a[232:235], v[232:235], a[160:163]
    v_fmac_f32 v250, s25, v248
    v_fma_f32 v248, v250, s26, v251
    v_mfma_f32_16x16x32_bf16 a[164:167], a[236:239], v[232:235], a[164:167]
    v_fmac_f32 v251, s27, v250
    v_fma_f32 v250, v249, s28, v252
    v_mfma_f32_16x16x32_bf16 a[144:147], a[240:243], v[232:235], a[144:147]
    v_fmac_f32 v252, s29, v249
    v_fma_f32 v249, v221, s24, v225
    v_mfma_f32_16x16x32_bf16 a[148:151], a[244:247], v[232:235], a[148:151]
    v_fmac_f32 v225, s25, v221
    v_fma_f32 v221, v219, s24, v223
    v_mfma_f32_16x16x32_bf16 a[152:155], a[248:251], v[232:235], a[152:155]
    v_fmac_f32 v223, s25, v219
    v_fma_f32 v219, v223, s26, v225
    v_mfma_f32_16x16x32_bf16 a[132:135], a[252:255], v[232:235], a[132:135]
    v_fmac_f32 v225, s27, v223
    v_fma_f32 v223, v221, s28, v249
    v_mfma_f32_16x16x32_bf16 a[136:139], v[240:243], v[232:235], a[136:139]
    s_waitcnt lgkmcnt(1)
    v_fmac_f32 v249, s29, v221
    v_cvt_pk_bf16_f32 v219, v248, v219
    v_mfma_f32_16x16x32_bf16 a[140:143], v[244:247], v[232:235], a[140:143]
    ds_read_b128 v[232:235], v253 offset:3136
    v_cvt_pk_bf16_f32 v225, v251, v225
    v_mfma_f32_16x16x32_bf16 a[168:171], a[228:231], v[236:239], a[168:171]
    v_cvt_pk_bf16_f32 v223, v250, v223
    v_cvt_pk_bf16_f32 v221, v252, v249
    v_lshrrev_b32 v252, 15, v255
    v_mfma_f32_16x16x32_bf16 a[172:175], a[232:235], v[236:239], a[172:175]
    ds_write_b64 v252, v[218:219] offset:8832
    v_mfma_f32_16x16x32_bf16 a[176:179], a[236:239], v[236:239], a[176:179]
    s_waitcnt vmcnt(15)
    v_lshlrev_b32 v248, 16, v194
    v_lshlrev_b32 v249, 16, v196
    v_mfma_f32_16x16x32_bf16 a[156:159], a[240:243], v[236:239], a[156:159]
    ds_write_b64 v252, v[224:225] offset:10912
    v_mfma_f32_16x16x32_bf16 a[160:163], a[244:247], v[236:239], a[160:163]
    v_lshlrev_b32 v250, 16, v198
    v_lshlrev_b32 v251, 16, v200
    v_mfma_f32_16x16x32_bf16 a[164:167], a[248:251], v[236:239], a[164:167]
    ds_write_b64 v252, v[222:223] offset:12992
    v_mfma_f32_16x16x32_bf16 a[144:147], a[252:255], v[236:239], a[144:147]
    s_waitcnt lgkmcnt(4)
    v_and_b32 v194, s22, v194
    v_and_b32 v196, s22, v196
    v_mfma_f32_16x16x32_bf16 a[148:151], v[240:243], v[236:239], a[148:151]
    ds_write_b64 v252, v[216:217] offset:23392
    v_mfma_f32_16x16x32_bf16 a[152:155], v[244:247], v[236:239], a[152:155]
    ds_read_b128 v[236:239], v253 offset:2864
    v_and_b32 v198, s22, v198
    v_mfma_f32_16x16x32_bf16 a[180:183], a[228:231], v[228:231], a[180:183]
    v_and_b32 v200, s22, v200
    v_mfma_f32_16x16x32_bf16 a[184:187], a[232:235], v[228:231], a[184:187]
    ds_write_b64 v252, v[226:227] offset:31712
    v_mfma_f32_16x16x32_bf16 a[188:191], a[236:239], v[228:231], a[188:191]
    s_add_u32 s42, s32, 700416
    v_mfma_f32_16x16x32_bf16 a[168:171], a[240:243], v[228:231], a[168:171]
    buffer_load_dwordx4 a[228:231], v254, s[8:11], s42 offen offset:0 sc1
    v_mfma_f32_16x16x32_bf16 a[172:175], a[244:247], v[228:231], a[172:175]
    ds_write_b64 v252, v[220:221] offset:512
    v_mfma_f32_16x16x32_bf16 a[176:179], a[248:251], v[228:231], a[176:179]
    v_mfma_f32_16x16x32_bf16 a[156:159], a[252:255], v[228:231], a[156:159]
    buffer_load_dwordx4 a[232:235], v254, s[8:11], s42 offen offset:1024 sc1
    v_mfma_f32_16x16x32_bf16 a[160:163], v[240:243], v[228:231], a[160:163]
    v_lshlrev_b32 v252, 16, v192
    v_and_b32 v192, s22, v192
    v_mfma_f32_16x16x32_bf16 a[164:167], v[244:247], v[228:231], a[164:167]
    s_waitcnt lgkmcnt(2)
    v_add_f32 v252, v252, v251
    v_add_f32 v192, v192, v200
    v_fmac_f32 v252, s23, v249
    v_mfma_f32_16x16x32_bf16 a[180:183], a[240:243], v[232:235], a[180:183]
    ds_read_b128 v[228:231], v253 offset:5200
    v_fmac_f32 v192, s23, v196
    v_mfma_f32_16x16x32_bf16 a[184:187], a[244:247], v[232:235], a[184:187]
    ds_read_b128 v[216:219], v253 offset:40480
    v_cvt_pk_bf16_f32 v192, v252, v192
    v_mfma_f32_16x16x32_bf16 a[188:191], a[248:251], v[232:235], a[188:191]
    buffer_load_dwordx4 a[236:239], v254, s[8:11], s42 offen offset:2048 sc1
    v_mfma_f32_16x16x32_bf16 a[168:171], a[252:255], v[232:235], a[168:171]
    s_mov_b32 s45, 503518347
    v_lshlrev_b32 v252, 16, v202
    v_and_b32 v202, s22, v202
    v_mfma_f32_16x16x32_bf16 a[172:175], v[240:243], v[232:235], a[172:175]
    s_add_u32 s42, s32, 703488
    v_add_f32 v252, v252, v248
    v_add_f32 v202, v202, v194
    v_mfma_f32_16x16x32_bf16 a[176:179], v[244:247], v[232:235], a[176:179]
    ds_read_b128 v[232:235], v253 offset:4928
    v_bfe_u32 v220, v254, 5, 3
    v_mfma_f32_16x16x32_bf16 a[180:183], a[252:255], v[236:239], a[180:183]
    buffer_load_dwordx4 a[240:243], v254, s[8:11], s42 offen offset:0 sc1
    v_fmac_f32 v252, s23, v250
    v_mfma_f32_16x16x32_bf16 a[184:187], v[240:243], v[236:239], a[184:187]
    s_waitcnt vmcnt(16) lgkmcnt(2)
    v_fmac_f32 v202, s23, v198
    v_cvt_pk_bf16_f32 v202, v252, v202
    v_mfma_f32_16x16x32_bf16 a[188:191], v[244:247], v[236:239], a[188:191]
    ds_read_b128 v[236:239], v253 offset:4672
    v_mul_u32_u24 v221, 5, v220
    v_mfma_f32_16x16x32_bf16 v[0:3], a[192:195], v[228:231], v[0:3]
    s_waitcnt lgkmcnt(1)
    v_fma_f32 v252, v249, s24, v251
    v_fmac_f32 v251, s25, v249
    v_mfma_f32_16x16x32_bf16 v[4:7], a[196:199], v[228:231], v[4:7]
    buffer_load_dwordx4 a[244:247], v254, s[8:11], s42 offen offset:1024 sc1
    v_mfma_f32_16x16x32_bf16 v[8:11], a[200:203], v[228:231], v[8:11]
    ds_read_b128 v[228:231], v253 offset:4416
    v_bfe_u32 v221, s45, v221, 5
    v_mfma_f32_16x16x32_bf16 v[12:15], a[192:195], v[232:235], v[12:15]
    v_fma_f32 v249, v248, s24, v250
    v_fmac_f32 v250, s25, v248
    v_fma_f32 v248, v250, s26, v251
    v_mfma_f32_16x16x32_bf16 v[16:19], a[196:199], v[232:235], v[16:19]
    s_waitcnt vmcnt(14)
    v_mul_u32_u24 v221, 65, v221
    v_fmac_f32 v251, s27, v250
    v_mfma_f32_16x16x32_bf16 v[20:23], a[200:203], v[232:235], v[20:23]
    buffer_load_dwordx4 a[248:251], v254, s[8:11], s42 offen offset:2048 sc1
    v_mfma_f32_16x16x32_bf16 v[0:3], a[204:207], v[232:235], v[0:3]
    s_waitcnt lgkmcnt(1)
    v_sub_u32 v221, v221, v220
    v_fma_f32 v250, v249, s28, v252
    v_mfma_f32_16x16x32_bf16 v[4:7], a[208:211], v[232:235], v[4:7]
    s_add_u32 s42, s32, 706560
    v_fmac_f32 v252, s29, v249
    v_fma_f32 v249, v196, s24, v200
    v_mfma_f32_16x16x32_bf16 v[8:11], a[212:215], v[232:235], v[8:11]
    ds_read_b128 v[232:235], v253 offset:4160
    v_lshl_add_u32 v220, v221, 5, v253
    v_mfma_f32_16x16x32_bf16 v[24:27], a[192:195], v[236:239], v[24:27]
    buffer_load_dwordx4 a[252:255], v254, s[8:11], s42 offen offset:0 sc1
    v_mfma_f32_16x16x32_bf16 v[28:31], a[196:199], v[236:239], v[28:31]
    v_fmac_f32 v200, s25, v196
    v_fma_f32 v196, v194, s24, v198
    v_fmac_f32 v198, s25, v194
    v_mfma_f32_16x16x32_bf16 v[32:35], a[200:203], v[236:239], v[32:35]
    v_fma_f32 v194, v198, s26, v200
    v_fmac_f32 v200, s27, v198
    v_mfma_f32_16x16x32_bf16 v[12:15], a[204:207], v[236:239], v[12:15]
    s_waitcnt vmcnt(13)
    v_fma_f32 v198, v196, s28, v249
    v_fmac_f32 v249, s29, v196
    v_mfma_f32_16x16x32_bf16 v[16:19], a[208:211], v[236:239], v[16:19]
    buffer_load_dwordx4 v[240:243], v254, s[8:11], s42 offen offset:1024 sc1
    v_mfma_f32_16x16x32_bf16 v[20:23], a[212:215], v[236:239], v[20:23]
    s_mov_b64 exec, s[46:47]
    ds_write_b128 v220, v[216:219] offset:1024
    s_mov_b64 exec, -1
    v_mfma_f32_16x16x32_bf16 v[0:3], a[216:219], v[236:239], v[0:3]
    s_waitcnt lgkmcnt(2)
    v_cvt_pk_bf16_f32 v194, v248, v194
    v_cvt_pk_bf16_f32 v200, v251, v200
    v_mfma_f32_16x16x32_bf16 v[4:7], a[220:223], v[236:239], v[4:7]
    buffer_load_dwordx4 v[244:247], v254, s[8:11], s42 offen offset:2048 sc1
    v_mfma_f32_16x16x32_bf16 v[8:11], a[224:227], v[236:239], v[8:11]
    ds_read_b128 v[236:239], v253 offset:5984
    v_and_b32 v222, 0x1f0, v254
    v_cvt_pk_bf16_f32 v198, v250, v198
    v_mfma_f32_16x16x32_bf16 v[36:39], a[192:195], v[228:231], v[36:39]
    v_mul_u32_u24 v222, 96, v222
    v_cvt_pk_bf16_f32 v196, v252, v249
    v_mfma_f32_16x16x32_bf16 v[40:43], a[196:199], v[228:231], v[40:43]
    buffer_load_dword v222, v222, s[4:7], s33 offen offset:0
    v_mfma_f32_16x16x32_bf16 v[44:47], a[200:203], v[228:231], v[44:47]
    s_add_u32 s49, s49, 8
    v_lshlrev_b32 v248, 16, v195
    v_lshlrev_b32 v249, 16, v197
    v_mfma_f32_16x16x32_bf16 v[24:27], a[204:207], v[228:231], v[24:27]
    v_lshlrev_b32 v250, 16, v199
    v_lshlrev_b32 v251, 16, v201
    v_mfma_f32_16x16x32_bf16 v[28:31], a[208:211], v[228:231], v[28:31]
    s_cmp_eq_u32 s39, 1
    s_cselect_b32 s49, 128, s49
    v_and_b32 v195, s22, v195
    v_mfma_f32_16x16x32_bf16 v[32:35], a[212:215], v[228:231], v[32:35]
    v_and_b32 v197, s22, v197
    v_and_b32 v199, s22, v199
    v_and_b32 v201, s22, v201
    v_mfma_f32_16x16x32_bf16 v[12:15], a[216:219], v[228:231], v[12:15]
    s_waitcnt lgkmcnt(2)
    v_lshlrev_b32 v252, 16, v193
    v_and_b32 v193, s22, v193
    v_mfma_f32_16x16x32_bf16 v[16:19], a[220:223], v[228:231], v[16:19]
    s_mul_i32 s43, s49, 786432
    v_add_f32 v252, v252, v251
    v_add_f32 v193, v193, v201
    v_mfma_f32_16x16x32_bf16 v[20:23], a[224:227], v[228:231], v[20:23]
    ds_read_b128 v[228:231], v253 offset:5728
    v_fmac_f32 v252, s23, v249
    v_mfma_f32_16x16x32_bf16 v[48:51], a[192:195], v[232:235], v[48:51]
    v_fmac_f32 v193, s23, v197
    v_cvt_pk_bf16_f32 v193, v252, v193
    v_mfma_f32_16x16x32_bf16 v[52:55], a[196:199], v[232:235], v[52:55]
    s_add_u32 s43, s43, s53
    v_lshlrev_b32 v252, 16, v203
    v_and_b32 v203, s22, v203
    v_mfma_f32_16x16x32_bf16 v[56:59], a[200:203], v[232:235], v[56:59]
    v_add_f32 v252, v252, v248
    v_add_f32 v203, v203, v195
    v_mfma_f32_16x16x32_bf16 v[36:39], a[204:207], v[232:235], v[36:39]
    v_fmac_f32 v252, s23, v250
    v_fmac_f32 v203, s23, v199
    v_cvt_pk_bf16_f32 v203, v252, v203
    v_mfma_f32_16x16x32_bf16 v[40:43], a[208:211], v[232:235], v[40:43]
    s_cmp_ge_u32 s49, 128
    s_cselect_b32 s43, 2130706432, s43
    v_fma_f32 v252, v249, s24, v251
    v_mfma_f32_16x16x32_bf16 v[44:47], a[212:215], v[232:235], v[44:47]
    v_fmac_f32 v251, s25, v249
    v_fma_f32 v249, v248, s24, v250
    v_mfma_f32_16x16x32_bf16 v[24:27], a[216:219], v[232:235], v[24:27]
    s_sub_u32 s16, s43, 196608
    v_fmac_f32 v250, s25, v248
    v_fma_f32 v248, v250, s26, v251
    v_mfma_f32_16x16x32_bf16 v[28:31], a[220:223], v[232:235], v[28:31]
    s_waitcnt lgkmcnt(1)
    v_fmac_f32 v251, s27, v250
    v_fma_f32 v250, v249, s28, v252
    v_mfma_f32_16x16x32_bf16 v[32:35], a[224:227], v[232:235], v[32:35]
    ds_read_b128 v[232:235], v253 offset:5472
    v_fmac_f32 v252, s29, v249
    v_mfma_f32_16x16x32_bf16 v[60:63], a[192:195], v[236:239], v[60:63]
    s_cmp_eq_u32 s49, 0
    s_cselect_b32 s16, 2130706432, s16
    v_fma_f32 v249, v197, s24, v201
    v_mfma_f32_16x16x32_bf16 v[64:67], a[196:199], v[236:239], v[64:67]
    v_fmac_f32 v201, s25, v197
    v_fma_f32 v197, v195, s24, v199
    v_fmac_f32 v199, s25, v195
    v_mfma_f32_16x16x32_bf16 v[68:71], a[200:203], v[236:239], v[68:71]
    v_fma_f32 v195, v199, s26, v201
    v_fmac_f32 v201, s27, v199
    v_mfma_f32_16x16x32_bf16 v[48:51], a[204:207], v[236:239], v[48:51]
    s_mov_b32 s17, s43
    v_fma_f32 v199, v197, s28, v249
    v_fmac_f32 v249, s29, v197
    v_mfma_f32_16x16x32_bf16 v[52:55], a[208:211], v[236:239], v[52:55]
    v_cvt_pk_bf16_f32 v195, v248, v195
    v_cvt_pk_bf16_f32 v201, v251, v201
    v_mfma_f32_16x16x32_bf16 v[56:59], a[212:215], v[236:239], v[56:59]
    s_waitcnt lgkmcnt(1)
    v_cvt_pk_bf16_f32 v199, v250, v199
    v_cvt_pk_bf16_f32 v197, v252, v249
    v_mfma_f32_16x16x32_bf16 v[36:39], a[216:219], v[236:239], v[36:39]
    s_add_u32 s18, s43, 196608
    v_lshrrev_b32 v252, 15, v255
    v_mfma_f32_16x16x32_bf16 v[40:43], a[220:223], v[236:239], v[40:43]
    ds_write_b64 v252, v[194:195] offset:8576
    s_waitcnt vmcnt(10)
    v_mfma_f32_16x16x32_bf16 v[44:47], a[224:227], v[236:239], v[44:47]
    ds_read_b128 v[236:239], v253 offset:5216
    s_add_u32 s19, s43, 393216
    v_mfma_f32_16x16x32_bf16 v[72:75], a[192:195], v[228:231], v[72:75]
    v_lshlrev_b32 v248, 16, v206
    v_lshlrev_b32 v249, 16, v208
    v_mfma_f32_16x16x32_bf16 v[76:79], a[196:199], v[228:231], v[76:79]
    ds_write_b64 v252, v[200:201] offset:10656
    v_mfma_f32_16x16x32_bf16 v[80:83], a[200:203], v[228:231], v[80:83]
    s_add_u32 s20, s43, 589824
    v_lshlrev_b32 v250, 16, v210
    v_lshlrev_b32 v251, 16, v212
    v_mfma_f32_16x16x32_bf16 v[60:63], a[204:207], v[228:231], v[60:63]
    ds_write_b64 v252, v[198:199] offset:12736
    v_mfma_f32_16x16x32_bf16 v[64:67], a[208:211], v[228:231], v[64:67]
    v_and_b32 v206, s22, v206
    v_and_b32 v208, s22, v208
    v_mfma_f32_16x16x32_bf16 v[68:71], a[212:215], v[228:231], v[68:71]
    s_add_u32 s21, s43, 786432
    v_mfma_f32_16x16x32_bf16 v[48:51], a[216:219], v[228:231], v[48:51]
    ds_write_b64 v252, v[192:193] offset:23136
    v_mfma_f32_16x16x32_bf16 v[52:55], a[220:223], v[228:231], v[52:55]
    s_waitcnt lgkmcnt(5)
    v_and_b32 v210, s22, v210
    v_and_b32 v212, s22, v212
    v_mfma_f32_16x16x32_bf16 v[56:59], a[224:227], v[228:231], v[56:59]
    ds_read_b128 v[228:231], v253 offset:4944
    s_add_u32 s100, s43, s101
    v_mfma_f32_16x16x32_bf16 v[84:87], a[192:195], v[232:235], v[84:87]
    ds_write_b64 v252, v[202:203] offset:31456
    v_mfma_f32_16x16x32_bf16 v[88:91], a[196:199], v[232:235], v[88:91]
    v_mfma_f32_16x16x32_bf16 v[92:95], a[200:203], v[232:235], v[92:95]
    s_add_u32 s42, s35, 737280
    v_mfma_f32_16x16x32_bf16 v[72:75], a[204:207], v[232:235], v[72:75]
    buffer_load_dwordx4 a[192:195], v254, s[8:11], s42 offen offset:0 sc1
    v_mfma_f32_16x16x32_bf16 v[76:79], a[208:211], v[232:235], v[76:79]
    ds_write_b64 v252, v[196:197] offset:256
    v_mfma_f32_16x16x32_bf16 v[80:83], a[212:215], v[232:235], v[80:83]
    v_mfma_f32_16x16x32_bf16 v[60:63], a[216:219], v[232:235], v[60:63]
    buffer_load_dwordx4 a[196:199], v254, s[8:11], s42 offen offset:1024 sc1
    v_mfma_f32_16x16x32_bf16 v[64:67], a[220:223], v[232:235], v[64:67]
    v_lshlrev_b32 v252, 16, v204
    v_and_b32 v204, s22, v204
    v_mfma_f32_16x16x32_bf16 v[68:71], a[224:227], v[232:235], v[68:71]
    s_waitcnt lgkmcnt(6)
    v_add_f32 v252, v252, v251
    v_add_f32 v204, v204, v212
    v_mfma_f32_16x16x32_bf16 v[84:87], a[204:207], v[236:239], v[84:87]
    ds_read_b128 v[232:235], v253 offset:7280
    v_fmac_f32 v252, s23, v249
    v_fmac_f32 v204, s23, v208
    v_mfma_f32_16x16x32_bf16 v[88:91], a[208:211], v[236:239], v[88:91]
    v_cvt_pk_bf16_f32 v204, v252, v204
    v_lshlrev_b32 v252, 16, v214
    v_mfma_f32_16x16x32_bf16 v[92:95], a[212:215], v[236:239], v[92:95]
    buffer_load_dwordx4 a[200:203], v254, s[8:11], s42 offen offset:2048 sc1
    v_mfma_f32_16x16x32_bf16 v[72:75], a[216:219], v[236:239], v[72:75]
    s_waitcnt lgkmcnt(3)
    v_and_b32 v214, s22, v214
    v_add_f32 v252, v252, v248
    v_mfma_f32_16x16x32_bf16 v[76:79], a[220:223], v[236:239], v[76:79]
    s_add_u32 s42, s35, 740352
    v_add_f32 v214, v214, v206
    v_fmac_f32 v252, s23, v250
    v_mfma_f32_16x16x32_bf16 v[80:83], a[224:227], v[236:239], v[80:83]
    ds_read_b128 v[236:239], v253 offset:7008
    v_fmac_f32 v214, s23, v210
    v_mfma_f32_16x16x32_bf16 v[84:87], a[216:219], v[228:231], v[84:87]
    buffer_load_dwordx4 a[204:207], v254, s[8:11], s42 offen offset:0 sc1
    v_mfma_f32_16x16x32_bf16 v[88:91], a[220:223], v[228:231], v[88:91]
    s_waitcnt vmcnt(11) lgkmcnt(1)
    v_cvt_pk_bf16_f32 v214, v252, v214
    v_fma_f32 v252, v249, s24, v251
    v_mfma_f32_16x16x32_bf16 v[92:95], a[224:227], v[228:231], v[92:95]
    ds_read_b128 v[228:231], v253 offset:6752
    v_fmac_f32 v251, s25, v249
    v_mfma_f32_16x16x32_bf16 v[96:99], a[228:231], v[232:235], v[96:99]
    s_waitcnt lgkmcnt(1)
    v_fma_f32 v249, v248, s24, v250
    v_fmac_f32 v250, s25, v248
    v_mfma_f32_16x16x32_bf16 v[100:103], a[232:235], v[232:235], v[100:103]
    buffer_load_dwordx4 a[208:211], v254, s[8:11], s42 offen offset:1024 sc1
    v_fma_f32 v248, v250, s26, v251
    v_mfma_f32_16x16x32_bf16 v[104:107], a[236:239], v[232:235], v[104:107]
    ds_read_b128 v[232:235], v253 offset:6496
    v_fmac_f32 v251, s27, v250
    v_mfma_f32_16x16x32_bf16 v[108:111], a[228:231], v[236:239], v[108:111]
    v_fma_f32 v250, v249, s28, v252
    v_fmac_f32 v252, s29, v249
    v_mfma_f32_16x16x32_bf16 v[112:115], a[232:235], v[236:239], v[112:115]
    s_waitcnt vmcnt(9)
    v_fma_f32 v249, v208, s24, v212
    v_fmac_f32 v212, s25, v208
    v_mfma_f32_16x16x32_bf16 v[116:119], a[236:239], v[236:239], v[116:119]
    buffer_load_dwordx4 a[212:215], v254, s[8:11], s42 offen offset:2048 sc1
    v_mfma_f32_16x16x32_bf16 v[96:99], a[240:243], v[236:239], v[96:99]
    s_waitcnt lgkmcnt(1)
    v_fma_f32 v208, v206, s24, v210
    v_fmac_f32 v210, s25, v206
    v_mfma_f32_16x16x32_bf16 v[100:103], a[244:247], v[236:239], v[100:103]
    s_add_u32 s42, s35, 743424
    v_fma_f32 v206, v210, s26, v212
    v_fmac_f32 v212, s27, v210
    v_mfma_f32_16x16x32_bf16 v[104:107], a[248:251], v[236:239], v[104:107]
    ds_read_b128 v[236:239], v253 offset:6240
    v_and_b32 v203, 0xf0, v254
    v_mfma_f32_16x16x32_bf16 v[120:123], a[228:231], v[228:231], v[120:123]
    buffer_load_dwordx4 a[216:219], v254, s[8:11], s42 offen offset:0 sc1
    v_mfma_f32_16x16x32_bf16 v[124:127], a[232:235], v[228:231], v[124:127]
    v_lshrrev_b32 v203, 1, v203
    v_add_u32 v203, s52, v203
    v_mfma_f32_16x16x32_bf16 v[128:131], a[236:239], v[228:231], v[128:131]
    v_mov_b32 v202, s54
    v_mov_b32 v201, s55
    v_fma_f32 v210, v208, s28, v249
    v_mfma_f32_16x16x32_bf16 v[108:111], a[240:243], v[228:231], v[108:111]
    s_waitcnt vmcnt(8)
    v_cndmask_b32 v202, v202, v201, s[56:57]
    v_add_u32 v203, v203, v202
    v_mfma_f32_16x16x32_bf16 v[112:115], a[244:247], v[228:231], v[112:115]
    buffer_load_dwordx4 a[220:223], v254, s[8:11], s42 offen offset:1024 sc1
    v_mfma_f32_16x16x32_bf16 v[116:119], a[248:251], v[228:231], v[116:119]
    s_sub_u32 s45, s16, s50
    v_fmac_f32 v249, s29, v208
    v_cvt_pk_bf16_f32 v206, v248, v206
    v_mfma_f32_16x16x32_bf16 v[96:99], a[252:255], v[228:231], v[96:99]
    s_waitcnt lgkmcnt(1)
    v_cvt_pk_bf16_f32 v212, v251, v212
    v_cvt_pk_bf16_f32 v210, v250, v210
    v_mfma_f32_16x16x32_bf16 v[100:103], v[240:243], v[228:231], v[100:103]
    buffer_load_dwordx4 a[224:227], v254, s[8:11], s42 offen offset:2048 sc1
    v_mfma_f32_16x16x32_bf16 v[104:107], v[244:247], v[228:231], v[104:107]
    ds_read_b128 v[228:231], v253 offset:8064
    v_cvt_pk_bf16_f32 v208, v252, v249
    v_mfma_f32_16x16x32_bf16 v[132:135], a[228:231], v[232:235], v[132:135]
    v_lshlrev_b32 v248, 16, v207
    v_lshlrev_b32 v249, 16, v209
    v_mfma_f32_16x16x32_bf16 v[136:139], a[232:235], v[232:235], v[136:139]
    buffer_load_dwordx2 v[192:193], v203, s[4:7], s45 offen
    v_mfma_f32_16x16x32_bf16 v[140:143], a[236:239], v[232:235], v[140:143]
    s_sub_u32 s45, s17, s50
    v_lshlrev_b32 v250, 16, v211
    v_lshlrev_b32 v251, 16, v213
    v_mfma_f32_16x16x32_bf16 v[120:123], a[240:243], v[232:235], v[120:123]
    v_and_b32 v207, s22, v207
    v_and_b32 v209, s22, v209
    v_and_b32 v211, s22, v211
    v_mfma_f32_16x16x32_bf16 v[124:127], a[244:247], v[232:235], v[124:127]
    buffer_load_dwordx2 v[194:195], v203, s[4:7], s45 offen
    v_mfma_f32_16x16x32_bf16 v[128:131], a[248:251], v[232:235], v[128:131]
    s_sub_u32 s45, s18, s50
    v_and_b32 v213, s22, v213
    v_lshlrev_b32 v252, 16, v205
    v_mfma_f32_16x16x32_bf16 v[108:111], a[252:255], v[232:235], v[108:111]
    s_waitcnt lgkmcnt(1)
    v_and_b32 v205, s22, v205
    v_add_f32 v252, v252, v251
    v_mfma_f32_16x16x32_bf16 v[112:115], v[240:243], v[232:235], v[112:115]
    buffer_load_dwordx2 v[196:197], v203, s[4:7], s45 offen
    v_mfma_f32_16x16x32_bf16 v[116:119], v[244:247], v[232:235], v[116:119]
    ds_read_b128 v[232:235], v253 offset:7808
    s_sub_u32 s45, s19, s50
    v_mfma_f32_16x16x32_bf16 v[144:147], a[228:231], v[236:239], v[144:147]
    v_add_f32 v205, v205, v213
    v_fmac_f32 v252, s23, v249
    v_mfma_f32_16x16x32_bf16 v[148:151], a[232:235], v[236:239], v[148:151]
    buffer_load_dwordx2 v[198:199], v203, s[4:7], s45 offen
    v_mfma_f32_16x16x32_bf16 v[152:155], a[236:239], v[236:239], v[152:155]
    s_sub_u32 s45, s20, s50
    v_fmac_f32 v205, s23, v209
    v_cvt_pk_bf16_f32 v205, v252, v205
    v_mfma_f32_16x16x32_bf16 v[132:135], a[240:243], v[236:239], v[132:135]
    v_lshlrev_b32 v252, 16, v215
    v_and_b32 v215, s22, v215
    v_mfma_f32_16x16x32_bf16 v[136:139], a[244:247], v[236:239], v[136:139]
    buffer_load_dwordx2 v[200:201], v203, s[4:7], s45 offen
    v_add_f32 v252, v252, v248
    v_mfma_f32_16x16x32_bf16 v[140:143], a[248:251], v[236:239], v[140:143]
    s_sub_u32 s45, s21, s50
    v_add_f32 v215, v215, v207
    v_fmac_f32 v252, s23, v250
    v_mfma_f32_16x16x32_bf16 v[120:123], a[252:255], v[236:239], v[120:123]
    s_waitcnt lgkmcnt(1)
    v_fmac_f32 v215, s23, v211
    v_cvt_pk_bf16_f32 v215, v252, v215
    v_mfma_f32_16x16x32_bf16 v[124:127], v[240:243], v[236:239], v[124:127]
    buffer_load_dwordx2 v[202:203], v203, s[4:7], s45 offen
    v_mfma_f32_16x16x32_bf16 v[128:131], v[244:247], v[236:239], v[128:131]
    ds_read_b128 v[236:239], v253 offset:7552
    v_fma_f32 v252, v249, s24, v251
    v_mfma_f32_16x16x32_bf16 v[156:159], a[228:231], v[228:231], v[156:159]
    v_fmac_f32 v251, s25, v249
    v_fma_f32 v249, v248, s24, v250
    v_mfma_f32_16x16x32_bf16 v[160:163], a[232:235], v[228:231], v[160:163]
    v_fmac_f32 v250, s25, v248
    v_fma_f32 v248, v250, s26, v251
    v_mfma_f32_16x16x32_bf16 v[164:167], a[236:239], v[228:231], v[164:167]
    v_fmac_f32 v251, s27, v250
    v_fma_f32 v250, v249, s28, v252
    v_mfma_f32_16x16x32_bf16 v[144:147], a[240:243], v[228:231], v[144:147]
    v_fmac_f32 v252, s29, v249
    v_fma_f32 v249, v209, s24, v213
    v_mfma_f32_16x16x32_bf16 v[148:151], a[244:247], v[228:231], v[148:151]
    v_fmac_f32 v213, s25, v209
    v_fma_f32 v209, v207, s24, v211
    v_mfma_f32_16x16x32_bf16 v[152:155], a[248:251], v[228:231], v[152:155]
    v_fmac_f32 v211, s25, v207
    v_fma_f32 v207, v211, s26, v213
    v_fmac_f32 v213, s27, v211
    v_mfma_f32_16x16x32_bf16 v[132:135], a[252:255], v[228:231], v[132:135]
    v_fma_f32 v211, v209, s28, v249
    v_fmac_f32 v249, s29, v209
    v_mfma_f32_16x16x32_bf16 v[136:139], v[240:243], v[228:231], v[136:139]
    s_waitcnt lgkmcnt(1)
    v_cvt_pk_bf16_f32 v207, v248, v207
    v_cvt_pk_bf16_f32 v213, v251, v213
    v_mfma_f32_16x16x32_bf16 v[140:143], v[244:247], v[228:231], v[140:143]
    ds_read_b128 v[228:231], v253 offset:7296
    v_cvt_pk_bf16_f32 v211, v250, v211
    v_mfma_f32_16x16x32_bf16 v[168:171], a[228:231], v[232:235], v[168:171]
    v_cvt_pk_bf16_f32 v209, v252, v249
    v_lshrrev_b32 v252, 15, v255
    v_mfma_f32_16x16x32_bf16 v[172:175], a[232:235], v[232:235], v[172:175]
    ds_write_b64 v252, v[206:207] offset:8320
    v_mfma_f32_16x16x32_bf16 v[176:179], a[236:239], v[232:235], v[176:179]
    v_mfma_f32_16x16x32_bf16 v[156:159], a[240:243], v[232:235], v[156:159]
    ds_write_b64 v252, v[212:213] offset:10400
    v_mfma_f32_16x16x32_bf16 v[160:163], a[244:247], v[232:235], v[160:163]
    v_mfma_f32_16x16x32_bf16 v[164:167], a[248:251], v[232:235], v[164:167]
    ds_write_b64 v252, v[210:211] offset:12480
    v_mfma_f32_16x16x32_bf16 v[144:147], a[252:255], v[232:235], v[144:147]
    s_waitcnt lgkmcnt(4)
    v_mfma_f32_16x16x32_bf16 v[148:151], v[240:243], v[232:235], v[148:151]
    ds_write_b64 v252, v[204:205] offset:22880
    v_mfma_f32_16x16x32_bf16 v[152:155], v[244:247], v[232:235], v[152:155]
    ds_read_b128 v[232:235], v253 offset:7024
    v_mfma_f32_16x16x32_bf16 v[180:183], a[228:231], v[236:239], v[180:183]
    ds_write_b64 v252, v[214:215] offset:31200
    v_mfma_f32_16x16x32_bf16 v[184:187], a[232:235], v[236:239], v[184:187]
    v_mfma_f32_16x16x32_bf16 v[188:191], a[236:239], v[236:239], v[188:191]
    s_add_u32 s42, s35, 774144
    v_mfma_f32_16x16x32_bf16 v[168:171], a[240:243], v[236:239], v[168:171]
    buffer_load_dwordx4 a[228:231], v254, s[8:11], s42 offen offset:0 sc1
    v_mfma_f32_16x16x32_bf16 v[172:175], a[244:247], v[236:239], v[172:175]
    ds_write_b64 v252, v[208:209] offset:0
    v_mfma_f32_16x16x32_bf16 v[176:179], a[248:251], v[236:239], v[176:179]
    s_waitcnt lgkmcnt(7)
    v_mfma_f32_16x16x32_bf16 v[156:159], a[252:255], v[236:239], v[156:159]
    buffer_load_dwordx4 a[232:235], v254, s[8:11], s42 offen offset:1024 sc1
    v_mfma_f32_16x16x32_bf16 v[160:163], v[240:243], v[236:239], v[160:163]
    s_waitcnt lgkmcnt(0)
    v_mfma_f32_16x16x32_bf16 v[164:167], v[244:247], v[236:239], v[164:167]
    s_barrier
    v_mfma_f32_16x16x32_bf16 v[180:183], a[240:243], v[228:231], v[180:183]
    ds_read_b128 v[236:239], v253 offset:9360
    v_mfma_f32_16x16x32_bf16 v[184:187], a[244:247], v[228:231], v[184:187]
    v_mfma_f32_16x16x32_bf16 v[188:191], a[248:251], v[228:231], v[188:191]
    buffer_load_dwordx4 a[236:239], v254, s[8:11], s42 offen offset:2048 sc1
    v_mfma_f32_16x16x32_bf16 v[168:171], a[252:255], v[228:231], v[168:171]
    v_mfma_f32_16x16x32_bf16 v[172:175], v[240:243], v[228:231], v[172:175]
    s_add_u32 s42, s35, 777216
    v_mfma_f32_16x16x32_bf16 v[176:179], v[244:247], v[228:231], v[176:179]
    ds_read_b128 v[228:231], v253 offset:9088
    v_mfma_f32_16x16x32_bf16 v[180:183], a[252:255], v[232:235], v[180:183]
    buffer_load_dwordx4 a[240:243], v254, s[8:11], s42 offen offset:0 sc1
    v_mfma_f32_16x16x32_bf16 v[184:187], v[240:243], v[232:235], v[184:187]
    s_waitcnt vmcnt(16) lgkmcnt(1)
    v_mfma_f32_16x16x32_bf16 v[188:191], v[244:247], v[232:235], v[188:191]
    ds_read_b128 v[232:235], v253 offset:8832
    v_mfma_f32_16x16x32_bf16 a[0:3], a[192:195], v[236:239], a[0:3]
    s_waitcnt lgkmcnt(1)
    v_mfma_f32_16x16x32_bf16 a[4:7], a[196:199], v[236:239], a[4:7]
    buffer_load_dwordx4 a[244:247], v254, s[8:11], s42 offen offset:1024 sc1
    v_mfma_f32_16x16x32_bf16 a[8:11], a[200:203], v[236:239], a[8:11]
    ds_read_b128 v[236:239], v253 offset:8576
    v_mfma_f32_16x16x32_bf16 a[12:15], a[192:195], v[228:231], a[12:15]
    v_mfma_f32_16x16x32_bf16 a[16:19], a[196:199], v[228:231], a[16:19]
    s_waitcnt vmcnt(14)
    v_mfma_f32_16x16x32_bf16 a[20:23], a[200:203], v[228:231], a[20:23]
    buffer_load_dwordx4 a[248:251], v254, s[8:11], s42 offen offset:2048 sc1
    v_mfma_f32_16x16x32_bf16 a[0:3], a[204:207], v[228:231], a[0:3]
    s_waitcnt lgkmcnt(1)
    v_mfma_f32_16x16x32_bf16 a[4:7], a[208:211], v[228:231], a[4:7]
    s_add_u32 s42, s35, 780288
    v_mfma_f32_16x16x32_bf16 a[8:11], a[212:215], v[228:231], a[8:11]
    ds_read_b128 v[228:231], v253 offset:8320
    v_mfma_f32_16x16x32_bf16 a[24:27], a[192:195], v[232:235], a[24:27]
    buffer_load_dwordx4 a[252:255], v254, s[8:11], s42 offen offset:0 sc1
    v_mfma_f32_16x16x32_bf16 a[28:31], a[196:199], v[232:235], a[28:31]
    v_mfma_f32_16x16x32_bf16 a[32:35], a[200:203], v[232:235], a[32:35]
    v_mfma_f32_16x16x32_bf16 a[12:15], a[204:207], v[232:235], a[12:15]
    v_mfma_f32_16x16x32_bf16 a[16:19], a[208:211], v[232:235], a[16:19]
    buffer_load_dwordx4 v[240:243], v254, s[8:11], s42 offen offset:1024 sc1
    v_mfma_f32_16x16x32_bf16 a[20:23], a[212:215], v[232:235], a[20:23]
    s_waitcnt vmcnt(14)
    v_mfma_f32_16x16x32_bf16 a[0:3], a[216:219], v[232:235], a[0:3]
    s_waitcnt lgkmcnt(1)
    v_mfma_f32_16x16x32_bf16 a[4:7], a[220:223], v[232:235], a[4:7]
    buffer_load_dwordx4 v[244:247], v254, s[8:11], s42 offen offset:2048 sc1
    v_mfma_f32_16x16x32_bf16 a[8:11], a[224:227], v[232:235], a[8:11]
    ds_read_b128 v[232:235], v253 offset:10144
    v_and_b32 v226, 0x1f0, v254
    v_mfma_f32_16x16x32_bf16 a[36:39], a[192:195], v[236:239], a[36:39]
    v_mul_u32_u24 v226, 96, v226
    v_mfma_f32_16x16x32_bf16 a[40:43], a[196:199], v[236:239], a[40:43]
    buffer_load_dword v226, v226, s[4:7], s33 offen offset:384
    v_mfma_f32_16x16x32_bf16 a[44:47], a[200:203], v[236:239], a[44:47]
    v_mfma_f32_16x16x32_bf16 a[24:27], a[204:207], v[236:239], a[24:27]
    v_mfma_f32_16x16x32_bf16 a[28:31], a[208:211], v[236:239], a[28:31]
    v_mfma_f32_16x16x32_bf16 a[32:35], a[212:215], v[236:239], a[32:35]
    v_mfma_f32_16x16x32_bf16 a[12:15], a[216:219], v[236:239], a[12:15]
    v_mfma_f32_16x16x32_bf16 a[16:19], a[220:223], v[236:239], a[16:19]
    s_waitcnt lgkmcnt(1)
    v_mfma_f32_16x16x32_bf16 a[20:23], a[224:227], v[236:239], a[20:23]
    ds_read_b128 v[236:239], v253 offset:9888
    v_mfma_f32_16x16x32_bf16 a[48:51], a[192:195], v[228:231], a[48:51]
    v_mfma_f32_16x16x32_bf16 a[52:55], a[196:199], v[228:231], a[52:55]
    v_mfma_f32_16x16x32_bf16 a[56:59], a[200:203], v[228:231], a[56:59]
    v_mfma_f32_16x16x32_bf16 a[36:39], a[204:207], v[228:231], a[36:39]
    v_mfma_f32_16x16x32_bf16 a[40:43], a[208:211], v[228:231], a[40:43]
    v_mfma_f32_16x16x32_bf16 a[44:47], a[212:215], v[228:231], a[44:47]
    v_mfma_f32_16x16x32_bf16 a[24:27], a[216:219], v[228:231], a[24:27]
    v_mfma_f32_16x16x32_bf16 a[28:31], a[220:223], v[228:231], a[28:31]
    s_waitcnt lgkmcnt(1)
    v_mfma_f32_16x16x32_bf16 a[32:35], a[224:227], v[228:231], a[32:35]
    ds_read_b128 v[228:231], v253 offset:9632
    v_mfma_f32_16x16x32_bf16 a[60:63], a[192:195], v[232:235], a[60:63]
    v_mfma_f32_16x16x32_bf16 a[64:67], a[196:199], v[232:235], a[64:67]
    v_mfma_f32_16x16x32_bf16 a[68:71], a[200:203], v[232:235], a[68:71]
    v_mfma_f32_16x16x32_bf16 a[48:51], a[204:207], v[232:235], a[48:51]
    v_mfma_f32_16x16x32_bf16 a[52:55], a[208:211], v[232:235], a[52:55]
    v_mfma_f32_16x16x32_bf16 a[56:59], a[212:215], v[232:235], a[56:59]
    v_mfma_f32_16x16x32_bf16 a[36:39], a[216:219], v[232:235], a[36:39]
    v_mfma_f32_16x16x32_bf16 a[40:43], a[220:223], v[232:235], a[40:43]
    s_waitcnt lgkmcnt(1)
    v_mfma_f32_16x16x32_bf16 a[44:47], a[224:227], v[232:235], a[44:47]
    ds_read_b128 v[232:235], v253 offset:9376
    v_mfma_f32_16x16x32_bf16 a[72:75], a[192:195], v[236:239], a[72:75]
    v_mfma_f32_16x16x32_bf16 a[76:79], a[196:199], v[236:239], a[76:79]
    v_mfma_f32_16x16x32_bf16 a[80:83], a[200:203], v[236:239], a[80:83]
    v_mfma_f32_16x16x32_bf16 a[60:63], a[204:207], v[236:239], a[60:63]
    v_mfma_f32_16x16x32_bf16 a[64:67], a[208:211], v[236:239], a[64:67]
    v_mfma_f32_16x16x32_bf16 a[68:71], a[212:215], v[236:239], a[68:71]
    v_mfma_f32_16x16x32_bf16 a[48:51], a[216:219], v[236:239], a[48:51]
    v_mfma_f32_16x16x32_bf16 a[52:55], a[220:223], v[236:239], a[52:55]
    s_waitcnt lgkmcnt(1)
    v_mfma_f32_16x16x32_bf16 a[56:59], a[224:227], v[236:239], a[56:59]
    ds_read_b128 v[236:239], v253 offset:9104
    v_mfma_f32_16x16x32_bf16 a[84:87], a[192:195], v[228:231], a[84:87]
    v_mfma_f32_16x16x32_bf16 a[88:91], a[196:199], v[228:231], a[88:91]
    v_mfma_f32_16x16x32_bf16 a[92:95], a[200:203], v[228:231], a[92:95]
    s_add_u32 s42, s35, 811008
    v_mfma_f32_16x16x32_bf16 a[72:75], a[204:207], v[228:231], a[72:75]
    buffer_load_dwordx4 a[192:195], v254, s[8:11], s42 offen offset:0 sc1
    v_mfma_f32_16x16x32_bf16 a[76:79], a[208:211], v[228:231], a[76:79]
    v_mfma_f32_16x16x32_bf16 a[80:83], a[212:215], v[228:231], a[80:83]
    v_mfma_f32_16x16x32_bf16 a[60:63], a[216:219], v[228:231], a[60:63]
    buffer_load_dwordx4 a[196:199], v254, s[8:11], s42 offen offset:1024 sc1
    v_mfma_f32_16x16x32_bf16 a[64:67], a[220:223], v[228:231], a[64:67]
    v_mfma_f32_16x16x32_bf16 a[68:71], a[224:227], v[228:231], a[68:71]
    s_waitcnt lgkmcnt(1)
    v_mfma_f32_16x16x32_bf16 a[84:87], a[204:207], v[232:235], a[84:87]
    ds_read_b128 v[228:231], v253 offset:11440
    s_waitcnt vmcnt(12)
    v_mfma_f32_16x16x32_bf16 a[88:91], a[208:211], v[232:235], a[88:91]
    v_lshlrev_b32 v248, 16, v194
    v_lshlrev_b32 v249, 16, v196
    v_mfma_f32_16x16x32_bf16 a[92:95], a[212:215], v[232:235], a[92:95]
    buffer_load_dwordx4 a[200:203], v254, s[8:11], s42 offen offset:2048 sc1
    v_mfma_f32_16x16x32_bf16 a[72:75], a[216:219], v[232:235], a[72:75]
    s_waitcnt lgkmcnt(1)
    v_lshlrev_b32 v250, 16, v198
    v_lshlrev_b32 v251, 16, v200
    v_mfma_f32_16x16x32_bf16 a[76:79], a[220:223], v[232:235], a[76:79]
    s_add_u32 s42, s35, 814080
    v_and_b32 v194, s22, v194
    v_and_b32 v196, s22, v196
    v_mfma_f32_16x16x32_bf16 a[80:83], a[224:227], v[232:235], a[80:83]
    ds_read_b128 v[232:235], v253 offset:11168
    v_and_b32 v198, s22, v198
    v_mfma_f32_16x16x32_bf16 a[84:87], a[216:219], v[236:239], a[84:87]
    buffer_load_dwordx4 a[204:207], v254, s[8:11], s42 offen offset:0 sc1
    v_mfma_f32_16x16x32_bf16 a[88:91], a[220:223], v[236:239], a[88:91]
    s_waitcnt vmcnt(11) lgkmcnt(1)
    v_and_b32 v200, s22, v200
    v_lshlrev_b32 v252, 16, v192
    v_mfma_f32_16x16x32_bf16 a[92:95], a[224:227], v[236:239], a[92:95]
    ds_read_b128 v[236:239], v253 offset:10912
    v_and_b32 v192, s22, v192
    v_mfma_f32_16x16x32_bf16 a[96:99], a[228:231], v[228:231], a[96:99]
    s_waitcnt lgkmcnt(1)
    v_add_f32 v252, v252, v251
    v_add_f32 v192, v192, v200
    v_mfma_f32_16x16x32_bf16 a[100:103], a[232:235], v[228:231], a[100:103]
    buffer_load_dwordx4 a[208:211], v254, s[8:11], s42 offen offset:1024 sc1
    v_mfma_f32_16x16x32_bf16 a[104:107], a[236:239], v[228:231], a[104:107]
    ds_read_b128 v[228:231], v253 offset:10656
    v_fmac_f32 v252, s23, v249
    v_mfma_f32_16x16x32_bf16 a[108:111], a[228:231], v[232:235], a[108:111]
    v_fmac_f32 v192, s23, v196
    v_cvt_pk_bf16_f32 v192, v252, v192
    v_mfma_f32_16x16x32_bf16 a[112:115], a[232:235], v[232:235], a[112:115]
    s_waitcnt vmcnt(9)
    v_lshlrev_b32 v252, 16, v202
    v_and_b32 v202, s22, v202
    v_mfma_f32_16x16x32_bf16 a[116:119], a[236:239], v[232:235], a[116:119]
    buffer_load_dwordx4 a[212:215], v254, s[8:11], s42 offen offset:2048 sc1
    v_mfma_f32_16x16x32_bf16 a[96:99], a[240:243], v[232:235], a[96:99]
    s_waitcnt lgkmcnt(1)
    v_add_f32 v252, v252, v248
    v_add_f32 v202, v202, v194
    v_mfma_f32_16x16x32_bf16 a[100:103], a[244:247], v[232:235], a[100:103]
    s_add_u32 s42, s35, 817152
    v_fmac_f32 v252, s23, v250
    v_fmac_f32 v202, s23, v198
    v_mfma_f32_16x16x32_bf16 a[104:107], a[248:251], v[232:235], a[104:107]
    ds_read_b128 v[232:235], v253 offset:10400
    v_cvt_pk_bf16_f32 v202, v252, v202
    v_mfma_f32_16x16x32_bf16 a[120:123], a[228:231], v[236:239], a[120:123]
    buffer_load_dwordx4 a[216:219], v254, s[8:11], s42 offen offset:0 sc1
    v_mfma_f32_16x16x32_bf16 a[124:127], a[232:235], v[236:239], a[124:127]
    v_fma_f32 v252, v249, s24, v251
    v_fmac_f32 v251, s25, v249
    v_mfma_f32_16x16x32_bf16 a[128:131], a[236:239], v[236:239], a[128:131]
    v_fma_f32 v249, v248, s24, v250
    v_fmac_f32 v250, s25, v248
    v_mfma_f32_16x16x32_bf16 a[108:111], a[240:243], v[236:239], a[108:111]
    v_fma_f32 v248, v250, s26, v251
    v_fmac_f32 v251, s27, v250
    v_mfma_f32_16x16x32_bf16 a[112:115], a[244:247], v[236:239], a[112:115]
    buffer_load_dwordx4 a[220:223], v254, s[8:11], s42 offen offset:1024 sc1
    v_mfma_f32_16x16x32_bf16 a[116:119], a[248:251], v[236:239], a[116:119]
    s_waitcnt vmcnt(9)
    v_fma_f32 v250, v249, s28, v252
    v_fmac_f32 v252, s29, v249
    v_mfma_f32_16x16x32_bf16 a[96:99], a[252:255], v[236:239], a[96:99]
    s_waitcnt lgkmcnt(1)
    v_fma_f32 v249, v196, s24, v200
    v_fmac_f32 v200, s25, v196
    v_mfma_f32_16x16x32_bf16 a[100:103], v[240:243], v[236:239], a[100:103]
    buffer_load_dwordx4 a[224:227], v254, s[8:11], s42 offen offset:2048 sc1
    v_mfma_f32_16x16x32_bf16 a[104:107], v[244:247], v[236:239], a[104:107]
    ds_read_b128 v[236:239], v253 offset:12224
    v_and_b32 v222, 0x1f0, v254
    v_mfma_f32_16x16x32_bf16 a[132:135], a[228:231], v[228:231], a[132:135]
    v_mul_u32_u24 v222, 96, v222
    v_fma_f32 v196, v194, s24, v198
    v_mfma_f32_16x16x32_bf16 a[136:139], a[232:235], v[228:231], a[136:139]
    buffer_load_dword v222, v222, s[4:7], s33 offen offset:768
    v_mfma_f32_16x16x32_bf16 a[140:143], a[236:239], v[228:231], a[140:143]
    v_fmac_f32 v198, s25, v194
    v_fma_f32 v194, v198, s26, v200
    v_mfma_f32_16x16x32_bf16 a[120:123], a[240:243], v[228:231], a[120:123]
    v_fmac_f32 v200, s27, v198
    v_fma_f32 v198, v196, s28, v249
    v_mfma_f32_16x16x32_bf16 a[124:127], a[244:247], v[228:231], a[124:127]
    v_fmac_f32 v249, s29, v196
    v_cvt_pk_bf16_f32 v194, v248, v194
    v_mfma_f32_16x16x32_bf16 a[128:131], a[248:251], v[228:231], a[128:131]
    v_cvt_pk_bf16_f32 v200, v251, v200
    v_cvt_pk_bf16_f32 v198, v250, v198
    v_mfma_f32_16x16x32_bf16 a[108:111], a[252:255], v[228:231], a[108:111]
    v_cvt_pk_bf16_f32 v196, v252, v249
    v_lshlrev_b32 v248, 16, v195
    v_mfma_f32_16x16x32_bf16 a[112:115], v[240:243], v[228:231], a[112:115]
    s_waitcnt lgkmcnt(1)
    v_lshlrev_b32 v249, 16, v197
    v_lshlrev_b32 v250, 16, v199
    v_mfma_f32_16x16x32_bf16 a[116:119], v[244:247], v[228:231], a[116:119]
    ds_read_b128 v[228:231], v253 offset:11968
    v_lshlrev_b32 v251, 16, v201
    v_mfma_f32_16x16x32_bf16 a[144:147], a[228:231], v[232:235], a[144:147]
    v_and_b32 v195, s22, v195
    v_and_b32 v197, s22, v197
    v_mfma_f32_16x16x32_bf16 a[148:151], a[232:235], v[232:235], a[148:151]
    v_and_b32 v199, s22, v199
    v_and_b32 v201, s22, v201
    v_mfma_f32_16x16x32_bf16 a[152:155], a[236:239], v[232:235], a[152:155]
    v_lshlrev_b32 v252, 16, v193
    v_and_b32 v193, s22, v193
    v_mfma_f32_16x16x32_bf16 a[132:135], a[240:243], v[232:235], a[132:135]
    v_add_f32 v252, v252, v251
    v_add_f32 v193, v193, v201
    v_mfma_f32_16x16x32_bf16 a[136:139], a[244:247], v[232:235], a[136:139]
    v_fmac_f32 v252, s23, v249
    v_fmac_f32 v193, s23, v197
    v_mfma_f32_16x16x32_bf16 a[140:143], a[248:251], v[232:235], a[140:143]
    v_cvt_pk_bf16_f32 v193, v252, v193
    v_lshlrev_b32 v252, 16, v203
    v_mfma_f32_16x16x32_bf16 a[120:123], a[252:255], v[232:235], a[120:123]
    v_and_b32 v203, s22, v203
    v_add_f32 v252, v252, v248
    v_mfma_f32_16x16x32_bf16 a[124:127], v[240:243], v[232:235], a[124:127]
    s_waitcnt lgkmcnt(1)
    v_add_f32 v203, v203, v195
    v_fmac_f32 v252, s23, v250
    v_mfma_f32_16x16x32_bf16 a[128:131], v[244:247], v[232:235], a[128:131]
    ds_read_b128 v[232:235], v253 offset:11712
    v_fmac_f32 v203, s23, v199
    v_mfma_f32_16x16x32_bf16 a[156:159], a[228:231], v[236:239], a[156:159]
    v_cvt_pk_bf16_f32 v203, v252, v203
    v_fma_f32 v252, v249, s24, v251
    v_mfma_f32_16x16x32_bf16 a[160:163], a[232:235], v[236:239], a[160:163]
    v_fmac_f32 v251, s25, v249
    v_fma_f32 v249, v248, s24, v250
    v_mfma_f32_16x16x32_bf16 a[164:167], a[236:239], v[236:239], a[164:167]
    v_fmac_f32 v250, s25, v248
    v_fma_f32 v248, v250, s26, v251
    v_mfma_f32_16x16x32_bf16 a[144:147], a[240:243], v[236:239], a[144:147]
    v_fmac_f32 v251, s27, v250
    v_fma_f32 v250, v249, s28, v252
    v_mfma_f32_16x16x32_bf16 a[148:151], a[244:247], v[236:239], a[148:151]
    v_fmac_f32 v252, s29, v249
    v_fma_f32 v249, v197, s24, v201
    v_mfma_f32_16x16x32_bf16 a[152:155], a[248:251], v[236:239], a[152:155]
    v_fmac_f32 v201, s25, v197
    v_fma_f32 v197, v195, s24, v199
    v_mfma_f32_16x16x32_bf16 a[132:135], a[252:255], v[236:239], a[132:135]
    v_fmac_f32 v199, s25, v195
    v_fma_f32 v195, v199, s26, v201
    v_mfma_f32_16x16x32_bf16 a[136:139], v[240:243], v[236:239], a[136:139]
    s_waitcnt lgkmcnt(1)
    v_fmac_f32 v201, s27, v199
    v_fma_f32 v199, v197, s28, v249
    v_mfma_f32_16x16x32_bf16 a[140:143], v[244:247], v[236:239], a[140:143]
    ds_read_b128 v[236:239], v253 offset:11456
    v_fmac_f32 v249, s29, v197
    v_mfma_f32_16x16x32_bf16 a[168:171], a[228:231], v[228:231], a[168:171]
    v_cvt_pk_bf16_f32 v195, v248, v195
    v_cvt_pk_bf16_f32 v201, v251, v201
    v_mfma_f32_16x16x32_bf16 a[172:175], a[232:235], v[228:231], a[172:175]
    v_cvt_pk_bf16_f32 v199, v250, v199
    v_cvt_pk_bf16_f32 v197, v252, v249
    v_mfma_f32_16x16x32_bf16 a[176:179], a[236:239], v[228:231], a[176:179]
    v_and_b32 v248, 0xf0, v254
    v_lshrrev_b32 v248, 1, v248
    v_mfma_f32_16x16x32_bf16 a[156:159], a[240:243], v[228:231], a[156:159]
    v_add_u32 v248, s52, v248
    v_mfma_f32_16x16x32_bf16 a[160:163], a[244:247], v[228:231], a[160:163]
    v_and_b32 v252, 8, v248
    v_lshrrev_b32 v249, 6, v248
    v_mfma_f32_16x16x32_bf16 a[164:167], a[248:251], v[228:231], a[164:167]
    v_mul_u32_u24 v249, 384, v249
    v_mfma_f32_16x16x32_bf16 a[144:147], a[252:255], v[228:231], a[144:147]
    v_subrev_u32 v249, s3, v249
    v_min_u32 v249, 1920, v249
    v_mfma_f32_16x16x32_bf16 a[148:151], v[240:243], v[228:231], a[148:151]
    s_waitcnt lgkmcnt(1)
    v_lshrrev_b32 v249, 1, v249
    v_mfma_f32_16x16x32_bf16 a[152:155], v[244:247], v[228:231], a[152:155]
    ds_read_b128 v[228:231], v253 offset:11184
    v_add_u32 v252, v252, v249
    v_mfma_f32_16x16x32_bf16 a[180:183], a[228:231], v[232:235], a[180:183]
    v_bfe_u32 v249, v248, 4, 2
    v_mul_u32_u24 v249, 40704, v249
    v_mfma_f32_16x16x32_bf16 a[184:187], a[232:235], v[232:235], a[184:187]
    v_add_u32 v252, v252, v249
    v_and_b32 v249, 32, v248
    v_mfma_f32_16x16x32_bf16 a[188:191], a[236:239], v[232:235], a[188:191]
    s_add_u32 s42, s35, 847872
    v_lshl_add_u32 v252, v249, 1, v252
    v_mfma_f32_16x16x32_bf16 a[168:171], a[240:243], v[232:235], a[168:171]
    buffer_load_dwordx4 a[228:231], v254, s[8:11], s42 offen offset:0 sc1
    v_mfma_f32_16x16x32_bf16 a[172:175], a[244:247], v[232:235], a[172:175]
    v_bfe_u32 v249, v254, 8, 1
    v_lshl_add_u32 v252, v249, 4, v252
    v_mfma_f32_16x16x32_bf16 a[176:179], a[248:251], v[232:235], a[176:179]
    v_mov_b32 v249, 123328
    v_cndmask_b32 v252, v249, v252, s[58:59]
    v_mfma_f32_16x16x32_bf16 a[156:159], a[252:255], v[232:235], a[156:159]
    buffer_load_dwordx4 a[232:235], v254, s[8:11], s42 offen offset:1024 sc1
    v_mfma_f32_16x16x32_bf16 a[160:163], v[240:243], v[232:235], a[160:163]
    ds_write_b64 v252, v[192:193] offset:39520
    v_mfma_f32_16x16x32_bf16 a[164:167], v[244:247], v[232:235], a[164:167]
    s_waitcnt lgkmcnt(1)
    v_mfma_f32_16x16x32_bf16 a[180:183], a[240:243], v[236:239], a[180:183]
    ds_read_b128 v[232:235], v253 offset:13520
    v_mfma_f32_16x16x32_bf16 a[184:187], a[244:247], v[236:239], a[184:187]
    ds_write_b64 v252, v[194:195] offset:39552
    v_mfma_f32_16x16x32_bf16 a[188:191], a[248:251], v[236:239], a[188:191]
    buffer_load_dwordx4 a[236:239], v254, s[8:11], s42 offen offset:2048 sc1
    v_mfma_f32_16x16x32_bf16 a[168:171], a[252:255], v[236:239], a[168:171]
    ds_write_b64 v252, v[200:201] offset:39584
    v_mfma_f32_16x16x32_bf16 a[172:175], v[240:243], v[236:239], a[172:175]
    s_add_u32 s42, s35, 850944
    v_mfma_f32_16x16x32_bf16 a[176:179], v[244:247], v[236:239], a[176:179]
    ds_read_b128 v[236:239], v253 offset:13248
    v_mfma_f32_16x16x32_bf16 a[180:183], a[252:255], v[228:231], a[180:183]
    buffer_load_dwordx4 a[240:243], v254, s[8:11], s42 offen offset:0 sc1
    v_mfma_f32_16x16x32_bf16 a[184:187], v[240:243], v[228:231], a[184:187]
    ds_write_b64 v252, v[198:199] offset:39616
    v_mfma_f32_16x16x32_bf16 a[188:191], v[244:247], v[228:231], a[188:191]
    ds_read_b128 v[228:231], v253 offset:12992
    s_waitcnt vmcnt(11)
    s_waitcnt lgkmcnt(5)
    v_mfma_f32_16x16x32_bf16 v[0:3], a[192:195], v[232:235], v[0:3]
    ds_write_b64 v252, v[196:197] offset:39648
    v_mfma_f32_16x16x32_bf16 v[4:7], a[196:199], v[232:235], v[4:7]
    buffer_load_dwordx4 a[244:247], v254, s[8:11], s42 offen offset:1024 sc1
    v_mfma_f32_16x16x32_bf16 v[8:11], a[200:203], v[232:235], v[8:11]
    ds_read_b128 v[232:235], v253 offset:12736
    s_waitcnt lgkmcnt(4)
    v_mfma_f32_16x16x32_bf16 v[12:15], a[192:195], v[236:239], v[12:15]
    ds_write_b64 v252, v[202:203] offset:39680
    v_mfma_f32_16x16x32_bf16 v[16:19], a[196:199], v[236:239], v[16:19]
    s_waitcnt vmcnt(9)
    v_mfma_f32_16x16x32_bf16 v[20:23], a[200:203], v[236:239], v[20:23]
    buffer_load_dwordx4 a[248:251], v254, s[8:11], s42 offen offset:2048 sc1
    v_mfma_f32_16x16x32_bf16 v[0:3], a[204:207], v[236:239], v[0:3]
    s_waitcnt lgkmcnt(3)
    v_mfma_f32_16x16x32_bf16 v[4:7], a[208:211], v[236:239], v[4:7]
    s_add_u32 s42, s35, 854016
    v_mfma_f32_16x16x32_bf16 v[8:11], a[212:215], v[236:239], v[8:11]
    ds_read_b128 v[236:239], v253 offset:12480
    v_mfma_f32_16x16x32_bf16 v[24:27], a[192:195], v[228:231], v[24:27]
    buffer_load_dwordx4 a[252:255], v254, s[8:11], s42 offen offset:0 sc1
    v_mfma_f32_16x16x32_bf16 v[28:31], a[196:199], v[228:231], v[28:31]
    v_mfma_f32_16x16x32_bf16 v[32:35], a[200:203], v[228:231], v[32:35]
    v_mfma_f32_16x16x32_bf16 v[12:15], a[204:207], v[228:231], v[12:15]
    v_mfma_f32_16x16x32_bf16 v[16:19], a[208:211], v[228:231], v[16:19]
    buffer_load_dwordx4 v[240:243], v254, s[8:11], s42 offen offset:1024 sc1
    v_mfma_f32_16x16x32_bf16 v[20:23], a[212:215], v[228:231], v[20:23]
    s_waitcnt vmcnt(9)
    v_mfma_f32_16x16x32_bf16 v[0:3], a[216:219], v[228:231], v[0:3]
    s_waitcnt lgkmcnt(2)
    v_mfma_f32_16x16x32_bf16 v[4:7], a[220:223], v[228:231], v[4:7]
    buffer_load_dwordx4 v[244:247], v254, s[8:11], s42 offen offset:2048 sc1
    v_mfma_f32_16x16x32_bf16 v[8:11], a[224:227], v[228:231], v[8:11]
    ds_read_b128 v[228:231], v253 offset:14304
    v_mfma_f32_16x16x32_bf16 v[36:39], a[192:195], v[232:235], v[36:39]
    v_mfma_f32_16x16x32_bf16 v[40:43], a[196:199], v[232:235], v[40:43]
    v_mfma_f32_16x16x32_bf16 v[44:47], a[200:203], v[232:235], v[44:47]
    v_mfma_f32_16x16x32_bf16 v[24:27], a[204:207], v[232:235], v[24:27]
    v_mfma_f32_16x16x32_bf16 v[28:31], a[208:211], v[232:235], v[28:31]
    v_mfma_f32_16x16x32_bf16 v[32:35], a[212:215], v[232:235], v[32:35]
    v_mfma_f32_16x16x32_bf16 v[12:15], a[216:219], v[232:235], v[12:15]
    v_mfma_f32_16x16x32_bf16 v[16:19], a[220:223], v[232:235], v[16:19]
    s_waitcnt lgkmcnt(1)
    v_mfma_f32_16x16x32_bf16 v[20:23], a[224:227], v[232:235], v[20:23]
    ds_read_b128 v[232:235], v253 offset:14048
    v_mfma_f32_16x16x32_bf16 v[48:51], a[192:195], v[236:239], v[48:51]
    v_mfma_f32_16x16x32_bf16 v[52:55], a[196:199], v[236:239], v[52:55]
    v_mfma_f32_16x16x32_bf16 v[56:59], a[200:203], v[236:239], v[56:59]
    v_mfma_f32_16x16x32_bf16 v[36:39], a[204:207], v[236:239], v[36:39]
    v_mfma_f32_16x16x32_bf16 v[40:43], a[208:211], v[236:239], v[40:43]
    v_mfma_f32_16x16x32_bf16 v[44:47], a[212:215], v[236:239], v[44:47]
    v_mfma_f32_16x16x32_bf16 v[24:27], a[216:219], v[236:239], v[24:27]
    v_mfma_f32_16x16x32_bf16 v[28:31], a[220:223], v[236:239], v[28:31]
    s_waitcnt lgkmcnt(1)
    v_mfma_f32_16x16x32_bf16 v[32:35], a[224:227], v[236:239], v[32:35]
    ds_read_b128 v[236:239], v253 offset:13792
    v_mfma_f32_16x16x32_bf16 v[60:63], a[192:195], v[228:231], v[60:63]
    v_mfma_f32_16x16x32_bf16 v[64:67], a[196:199], v[228:231], v[64:67]
    v_mfma_f32_16x16x32_bf16 v[68:71], a[200:203], v[228:231], v[68:71]
    v_mfma_f32_16x16x32_bf16 v[48:51], a[204:207], v[228:231], v[48:51]
    v_mfma_f32_16x16x32_bf16 v[52:55], a[208:211], v[228:231], v[52:55]
    v_mfma_f32_16x16x32_bf16 v[56:59], a[212:215], v[228:231], v[56:59]
    v_mfma_f32_16x16x32_bf16 v[36:39], a[216:219], v[228:231], v[36:39]
    v_mfma_f32_16x16x32_bf16 v[40:43], a[220:223], v[228:231], v[40:43]
    s_waitcnt lgkmcnt(1)
    v_mfma_f32_16x16x32_bf16 v[44:47], a[224:227], v[228:231], v[44:47]
    ds_read_b128 v[228:231], v253 offset:13536
    v_mfma_f32_16x16x32_bf16 v[72:75], a[192:195], v[232:235], v[72:75]
    v_mfma_f32_16x16x32_bf16 v[76:79], a[196:199], v[232:235], v[76:79]
    v_mfma_f32_16x16x32_bf16 v[80:83], a[200:203], v[232:235], v[80:83]
    v_mfma_f32_16x16x32_bf16 v[60:63], a[204:207], v[232:235], v[60:63]
    v_mfma_f32_16x16x32_bf16 v[64:67], a[208:211], v[232:235], v[64:67]
    v_mfma_f32_16x16x32_bf16 v[68:71], a[212:215], v[232:235], v[68:71]
    v_mfma_f32_16x16x32_bf16 v[48:51], a[216:219], v[232:235], v[48:51]
    v_mfma_f32_16x16x32_bf16 v[52:55], a[220:223], v[232:235], v[52:55]
    s_waitcnt lgkmcnt(1)
    v_mfma_f32_16x16x32_bf16 v[56:59], a[224:227], v[232:235], v[56:59]
    ds_read_b128 v[232:235], v253 offset:13264
    v_mfma_f32_16x16x32_bf16 v[84:87], a[192:195], v[236:239], v[84:87]
    v_mfma_f32_16x16x32_bf16 v[88:91], a[196:199], v[236:239], v[88:91]
    v_mfma_f32_16x16x32_bf16 v[92:95], a[200:203], v[236:239], v[92:95]
    s_add_u32 s42, s36, 884736
    v_mfma_f32_16x16x32_bf16 v[72:75], a[204:207], v[236:239], v[72:75]
    buffer_load_dwordx4 a[192:195], v254, s[8:11], s42 offen offset:0 sc1
    v_mfma_f32_16x16x32_bf16 v[76:79], a[208:211], v[236:239], v[76:79]
    v_mfma_f32_16x16x32_bf16 v[80:83], a[212:215], v[236:239], v[80:83]
    v_mfma_f32_16x16x32_bf16 v[60:63], a[216:219], v[236:239], v[60:63]
    buffer_load_dwordx4 a[196:199], v254, s[8:11], s42 offen offset:1024 sc1
    v_mfma_f32_16x16x32_bf16 v[64:67], a[220:223], v[236:239], v[64:67]
    v_mfma_f32_16x16x32_bf16 v[68:71], a[224:227], v[236:239], v[68:71]
    s_waitcnt lgkmcnt(1)
    v_mfma_f32_16x16x32_bf16 v[84:87], a[204:207], v[228:231], v[84:87]
    ds_read_b128 v[236:239], v253 offset:1040
    v_mfma_f32_16x16x32_bf16 v[88:91], a[208:211], v[228:231], v[88:91]
    v_mfma_f32_16x16x32_bf16 v[92:95], a[212:215], v[228:231], v[92:95]
    buffer_load_dwordx4 a[200:203], v254, s[8:11], s42 offen offset:2048 sc1
    v_mfma_f32_16x16x32_bf16 v[72:75], a[216:219], v[228:231], v[72:75]
    s_waitcnt lgkmcnt(1)
    v_mfma_f32_16x16x32_bf16 v[76:79], a[220:223], v[228:231], v[76:79]
    s_add_u32 s42, s36, 887808
    v_mfma_f32_16x16x32_bf16 v[80:83], a[224:227], v[228:231], v[80:83]
    ds_read_b128 v[228:231], v253 offset:768
    v_mfma_f32_16x16x32_bf16 v[84:87], a[216:219], v[232:235], v[84:87]
    buffer_load_dwordx4 a[204:207], v254, s[8:11], s42 offen offset:0 sc1
    v_mfma_f32_16x16x32_bf16 v[88:91], a[220:223], v[232:235], v[88:91]
    s_waitcnt vmcnt(10) lgkmcnt(1)
    v_mfma_f32_16x16x32_bf16 v[92:95], a[224:227], v[232:235], v[92:95]
    ds_read_b128 v[232:235], v253 offset:512
    v_mfma_f32_16x16x32_bf16 v[96:99], a[228:231], v[236:239], v[96:99]
    s_waitcnt lgkmcnt(1)
    v_mfma_f32_16x16x32_bf16 v[100:103], a[232:235], v[236:239], v[100:103]
    buffer_load_dwordx4 a[208:211], v254, s[8:11], s42 offen offset:1024 sc1
    v_mfma_f32_16x16x32_bf16 v[104:107], a[236:239], v[236:239], v[104:107]
    ds_read_b128 v[236:239], v253 offset:256
    v_mfma_f32_16x16x32_bf16 v[108:111], a[228:231], v[228:231], v[108:111]
    v_mfma_f32_16x16x32_bf16 v[112:115], a[232:235], v[228:231], v[112:115]
    s_waitcnt vmcnt(8)
    v_mfma_f32_16x16x32_bf16 v[116:119], a[236:239], v[228:231], v[116:119]
    buffer_load_dwordx4 a[212:215], v254, s[8:11], s42 offen offset:2048 sc1
    v_mfma_f32_16x16x32_bf16 v[96:99], a[240:243], v[228:231], v[96:99]
    s_waitcnt lgkmcnt(1)
    v_mfma_f32_16x16x32_bf16 v[100:103], a[244:247], v[228:231], v[100:103]
    s_add_u32 s42, s36, 890880
    v_mfma_f32_16x16x32_bf16 v[104:107], a[248:251], v[228:231], v[104:107]
    ds_read_b128 v[228:231], v253 offset:0
    v_mfma_f32_16x16x32_bf16 v[120:123], a[228:231], v[232:235], v[120:123]
    buffer_load_dwordx4 a[216:219], v254, s[8:11], s42 offen offset:0 sc1
    v_mfma_f32_16x16x32_bf16 v[124:127], a[232:235], v[232:235], v[124:127]
    v_bfe_u32 v251, v254, 6, 2
    v_mfma_f32_16x16x32_bf16 v[128:131], a[236:239], v[232:235], v[128:131]
    v_mfma_f32_16x16x32_bf16 v[108:111], a[240:243], v[232:235], v[108:111]
    v_mfma_f32_16x16x32_bf16 v[112:115], a[244:247], v[232:235], v[112:115]
    buffer_load_dwordx4 a[220:223], v254, s[8:11], s42 offen offset:1024 sc1
    v_mfma_f32_16x16x32_bf16 v[116:119], a[248:251], v[232:235], v[116:119]
    s_waitcnt vmcnt(8)
    v_mul_u32_u24 v248, 40704, v251
    v_mfma_f32_16x16x32_bf16 v[96:99], a[252:255], v[232:235], v[96:99]
    s_waitcnt lgkmcnt(1)
    v_mfma_f32_16x16x32_bf16 v[100:103], v[240:243], v[232:235], v[100:103]
    buffer_load_dwordx4 a[224:227], v254, s[8:11], s42 offen offset:2048 sc1
    v_mfma_f32_16x16x32_bf16 v[104:107], v[244:247], v[232:235], v[104:107]
    ds_read_b128 v[232:235], v253 offset:1824
    v_and_b32 v252, 0x1f0, v254
    v_mfma_f32_16x16x32_bf16 v[132:135], a[228:231], v[236:239], v[132:135]
    v_mul_u32_u24 v252, 96, v252
    v_and_b32 v251, 0x80, v254
    v_mfma_f32_16x16x32_bf16 v[136:139], a[232:235], v[236:239], v[136:139]
    buffer_load_dword v252, v252, s[4:7], s33 offen offset:1152
    v_mfma_f32_16x16x32_bf16 v[140:143], a[236:239], v[236:239], v[140:143]
    v_lshrrev_b32 v251, 1, v251
    v_mfma_f32_16x16x32_bf16 v[120:123], a[240:243], v[236:239], v[120:123]
    v_mfma_f32_16x16x32_bf16 v[124:127], a[244:247], v[236:239], v[124:127]
    v_mfma_f32_16x16x32_bf16 v[128:131], a[248:251], v[236:239], v[128:131]
    v_add_u32 v248, v248, v251
    v_mfma_f32_16x16x32_bf16 v[108:111], a[252:255], v[236:239], v[108:111]
    v_mfma_f32_16x16x32_bf16 v[112:115], v[240:243], v[236:239], v[112:115]
    s_waitcnt lgkmcnt(1)
    v_mfma_f32_16x16x32_bf16 v[116:119], v[244:247], v[236:239], v[116:119]
    ds_read_b128 v[236:239], v253 offset:1568
    v_and_b32 v251, 0x40, v254
    v_mfma_f32_16x16x32_bf16 v[144:147], a[228:231], v[228:231], v[144:147]
    v_mfma_f32_16x16x32_bf16 v[148:151], a[232:235], v[228:231], v[148:151]
    v_mfma_f32_16x16x32_bf16 v[152:155], a[236:239], v[228:231], v[152:155]
    v_mfma_f32_16x16x32_bf16 v[132:135], a[240:243], v[228:231], v[132:135]
    v_lshrrev_b32 v251, 2, v251
    v_mfma_f32_16x16x32_bf16 v[136:139], a[244:247], v[228:231], v[136:139]
    v_mfma_f32_16x16x32_bf16 v[140:143], a[248:251], v[228:231], v[140:143]
    v_mfma_f32_16x16x32_bf16 v[120:123], a[252:255], v[228:231], v[120:123]
    v_add_u32 v248, v248, v251
    v_mfma_f32_16x16x32_bf16 v[124:127], v[240:243], v[228:231], v[124:127]
    s_waitcnt lgkmcnt(1)
    v_mfma_f32_16x16x32_bf16 v[128:131], v[244:247], v[228:231], v[128:131]
    ds_read_b128 v[228:231], v253 offset:1312
    v_mfma_f32_16x16x32_bf16 v[156:159], a[228:231], v[232:235], v[156:159]
    v_bfe_u32 v251, v254, 4, 2
    v_mfma_f32_16x16x32_bf16 v[160:163], a[232:235], v[232:235], v[160:163]
    v_mfma_f32_16x16x32_bf16 v[164:167], a[236:239], v[232:235], v[164:167]
    v_mfma_f32_16x16x32_bf16 v[144:147], a[240:243], v[232:235], v[144:147]
    v_mfma_f32_16x16x32_bf16 v[148:151], a[244:247], v[232:235], v[148:151]
    v_mul_u32_u24 v251, 3104, v251
    v_mfma_f32_16x16x32_bf16 v[152:155], a[248:251], v[232:235], v[152:155]
    v_mfma_f32_16x16x32_bf16 v[132:135], a[252:255], v[232:235], v[132:135]
    v_mfma_f32_16x16x32_bf16 v[136:139], v[240:243], v[232:235], v[136:139]
    s_waitcnt lgkmcnt(1)
    v_add_u32 v248, v248, v251
    v_mfma_f32_16x16x32_bf16 v[140:143], v[244:247], v[232:235], v[140:143]
    ds_read_b128 v[232:235], v253 offset:1056
    v_mfma_f32_16x16x32_bf16 v[168:171], a[228:231], v[236:239], v[168:171]
    v_mfma_f32_16x16x32_bf16 v[172:175], a[232:235], v[236:239], v[172:175]
    v_add_u32 v248, s52, v248
    v_mfma_f32_16x16x32_bf16 v[176:179], a[236:239], v[236:239], v[176:179]
    v_mfma_f32_16x16x32_bf16 v[156:159], a[240:243], v[236:239], v[156:159]
    v_mfma_f32_16x16x32_bf16 v[160:163], a[244:247], v[236:239], v[160:163]
    v_mfma_f32_16x16x32_bf16 v[164:167], a[248:251], v[236:239], v[164:167]
    v_lshrrev_b32 v251, 8, v254
    v_mfma_f32_16x16x32_bf16 v[144:147], a[252:255], v[236:239], v[144:147]
    v_mfma_f32_16x16x32_bf16 v[148:151], v[240:243], v[236:239], v[148:151]
    s_waitcnt lgkmcnt(1)
    v_mfma_f32_16x16x32_bf16 v[152:155], v[244:247], v[236:239], v[152:155]
    ds_read_b128 v[236:239], v253 offset:784
    v_lshl_add_u32 v249, v251, 3, v248
    v_mfma_f32_16x16x32_bf16 v[180:183], a[228:231], v[228:231], v[180:183]
    v_mfma_f32_16x16x32_bf16 v[184:187], a[232:235], v[228:231], v[184:187]
    v_mfma_f32_16x16x32_bf16 v[188:191], a[236:239], v[228:231], v[188:191]
    s_add_u32 s42, s36, 921600
    v_lshl_add_u32 v248, v251, 4, v248
    v_mfma_f32_16x16x32_bf16 v[168:171], a[240:243], v[228:231], v[168:171]
    buffer_load_dwordx4 a[228:231], v254, s[8:11], s42 offen offset:0 sc1
    v_mfma_f32_16x16x32_bf16 v[172:175], a[244:247], v[228:231], v[172:175]
    v_mfma_f32_16x16x32_bf16 v[176:179], a[248:251], v[228:231], v[176:179]
    s_waitcnt lgkmcnt(1)
    v_mfma_f32_16x16x32_bf16 v[156:159], a[252:255], v[228:231], v[156:159]
    buffer_load_dwordx4 a[232:235], v254, s[8:11], s42 offen offset:1024 sc1
    v_mfma_f32_16x16x32_bf16 v[160:163], v[240:243], v[228:231], v[160:163]
    s_waitcnt lgkmcnt(0)
    v_mfma_f32_16x16x32_bf16 v[164:167], v[244:247], v[228:231], v[164:167]
    s_barrier
    v_mfma_f32_16x16x32_bf16 v[180:183], a[240:243], v[232:235], v[180:183]
    ds_read_b128 v[228:231], v253 offset:34320
    v_mfma_f32_16x16x32_bf16 v[184:187], a[244:247], v[232:235], v[184:187]
    v_mfma_f32_16x16x32_bf16 v[188:191], a[248:251], v[232:235], v[188:191]
    buffer_load_dwordx4 a[236:239], v254, s[8:11], s42 offen offset:2048 sc1
    v_mfma_f32_16x16x32_bf16 v[168:171], a[252:255], v[232:235], v[168:171]
    v_mfma_f32_16x16x32_bf16 v[172:175], v[240:243], v[232:235], v[172:175]
    s_add_u32 s42, s36, 924672
    v_mfma_f32_16x16x32_bf16 v[176:179], v[244:247], v[232:235], v[176:179]
    ds_read_b128 v[232:235], v253 offset:34048
    v_mfma_f32_16x16x32_bf16 v[180:183], a[252:255], v[236:239], v[180:183]
    buffer_load_dwordx4 a[240:243], v254, s[8:11], s42 offen offset:0 sc1
    v_mfma_f32_16x16x32_bf16 v[184:187], v[240:243], v[236:239], v[184:187]
    s_waitcnt vmcnt(11) lgkmcnt(1)
    v_mfma_f32_16x16x32_bf16 v[188:191], v[244:247], v[236:239], v[188:191]
    ds_read_b128 v[236:239], v253 offset:33792
    s_nop 7
    v_accvgpr_read_b32 v192, a0
    v_accvgpr_read_b32 v193, a1
    v_accvgpr_read_b32 v194, a2
    v_accvgpr_read_b32 v195, a3
    v_accvgpr_read_b32 v196, a96
    v_accvgpr_read_b32 v197, a97
    v_accvgpr_read_b32 v198, a98
    v_accvgpr_read_b32 v199, a99
    v_pk_add_f32 v[192:193], v[192:193], v[196:197]
    v_pk_add_f32 v[194:195], v[194:195], v[198:199]
    v_pk_add_f32 v[196:197], v[0:1], v[96:97]
    v_pk_add_f32 v[198:199], v[2:3], v[98:99]
    v_pk_add_f32 v[96:97], v[0:1], v[96:97] neg_lo:[0,1] neg_hi:[0,1]
    v_pk_add_f32 v[98:99], v[2:3], v[98:99] neg_lo:[0,1] neg_hi:[0,1]
    v_pk_fma_f32 v[0:1], v[196:197], s[30:31], v[192:193]
    v_pk_fma_f32 v[2:3], v[198:199], s[30:31], v[194:195]
    v_pk_fma_f32 v[192:193], v[192:193], s[30:31], v[196:197]
    v_pk_fma_f32 v[194:195], v[194:195], s[30:31], v[198:199]
    v_cvt_pk_bf16_f32 v208, v192, v193
    v_cvt_pk_bf16_f32 v209, v194, v195
    v_accvgpr_read_b32 v200, a4
    v_accvgpr_read_b32 v201, a5
    v_accvgpr_read_b32 v202, a6
    v_accvgpr_read_b32 v203, a7
    v_accvgpr_read_b32 v204, a100
    v_accvgpr_read_b32 v205, a101
    v_accvgpr_read_b32 v206, a102
    v_accvgpr_read_b32 v207, a103
    v_pk_add_f32 v[200:201], v[200:201], v[204:205]
    v_pk_add_f32 v[202:203], v[202:203], v[206:207]
    v_pk_add_f32 v[204:205], v[4:5], v[100:101]
    v_pk_add_f32 v[206:207], v[6:7], v[102:103]
    v_pk_add_f32 v[100:101], v[4:5], v[100:101] neg_lo:[0,1] neg_hi:[0,1]
    v_pk_add_f32 v[102:103], v[6:7], v[102:103] neg_lo:[0,1] neg_hi:[0,1]
    v_pk_fma_f32 v[4:5], v[204:205], s[30:31], v[200:201]
    v_pk_fma_f32 v[6:7], v[206:207], s[30:31], v[202:203]
    v_pk_fma_f32 v[200:201], v[200:201], s[30:31], v[204:205]
    v_pk_fma_f32 v[202:203], v[202:203], s[30:31], v[206:207]
    v_cvt_pk_bf16_f32 v210, v200, v201
    v_cvt_pk_bf16_f32 v211, v202, v203
    ds_write_b128 v248, v[208:211] offset:0
    v_accvgpr_read_b32 v192, a8
    v_accvgpr_read_b32 v193, a9
    v_accvgpr_read_b32 v194, a10
    v_accvgpr_read_b32 v195, a11
    v_accvgpr_read_b32 v196, a104
    v_accvgpr_read_b32 v197, a105
    v_accvgpr_read_b32 v198, a106
    v_accvgpr_read_b32 v199, a107
    v_pk_add_f32 v[192:193], v[192:193], v[196:197]
    v_pk_add_f32 v[194:195], v[194:195], v[198:199]
    v_pk_add_f32 v[196:197], v[8:9], v[104:105]
    v_pk_add_f32 v[198:199], v[10:11], v[106:107]
    v_pk_add_f32 v[104:105], v[8:9], v[104:105] neg_lo:[0,1] neg_hi:[0,1]
    v_pk_add_f32 v[106:107], v[10:11], v[106:107] neg_lo:[0,1] neg_hi:[0,1]
    v_pk_fma_f32 v[8:9], v[196:197], s[30:31], v[192:193]
    v_pk_fma_f32 v[10:11], v[198:199], s[30:31], v[194:195]
    v_pk_fma_f32 v[192:193], v[192:193], s[30:31], v[196:197]
    v_pk_fma_f32 v[194:195], v[194:195], s[30:31], v[198:199]
    v_cvt_pk_bf16_f32 v212, v192, v193
    v_cvt_pk_bf16_f32 v213, v194, v195
    v_accvgpr_read_b32 v192, a12
    v_accvgpr_read_b32 v193, a13
    v_accvgpr_read_b32 v194, a14
    v_accvgpr_read_b32 v195, a15
    v_accvgpr_read_b32 v196, a108
    v_accvgpr_read_b32 v197, a109
    v_accvgpr_read_b32 v198, a110
    v_accvgpr_read_b32 v199, a111
    v_pk_add_f32 v[192:193], v[192:193], v[196:197]
    v_pk_add_f32 v[194:195], v[194:195], v[198:199]
    v_pk_add_f32 v[196:197], v[12:13], v[108:109]
    v_pk_add_f32 v[198:199], v[14:15], v[110:111]
    v_pk_add_f32 v[108:109], v[12:13], v[108:109] neg_lo:[0,1] neg_hi:[0,1]
    v_pk_add_f32 v[110:111], v[14:15], v[110:111] neg_lo:[0,1] neg_hi:[0,1]
    v_pk_fma_f32 v[12:13], v[196:197], s[30:31], v[192:193]
    v_pk_fma_f32 v[14:15], v[198:199], s[30:31], v[194:195]
    v_pk_fma_f32 v[192:193], v[192:193], s[30:31], v[196:197]
    v_pk_fma_f32 v[194:195], v[194:195], s[30:31], v[198:199]
    v_cvt_pk_bf16_f32 v214, v192, v193
    v_cvt_pk_bf16_f32 v215, v194, v195
    ds_write_b64 v249, v[212:213] offset:64
    v_accvgpr_read_b32 v200, a16
    v_accvgpr_read_b32 v201, a17
    v_accvgpr_read_b32 v202, a18
    v_accvgpr_read_b32 v203, a19
    v_accvgpr_read_b32 v204, a112
    v_accvgpr_read_b32 v205, a113
    v_accvgpr_read_b32 v206, a114
    v_accvgpr_read_b32 v207, a115
    v_pk_add_f32 v[200:201], v[200:201], v[204:205]
    v_pk_add_f32 v[202:203], v[202:203], v[206:207]
    v_pk_add_f32 v[204:205], v[16:17], v[112:113]
    v_pk_add_f32 v[206:207], v[18:19], v[114:115]
    v_pk_add_f32 v[112:113], v[16:17], v[112:113] neg_lo:[0,1] neg_hi:[0,1]
    v_pk_add_f32 v[114:115], v[18:19], v[114:115] neg_lo:[0,1] neg_hi:[0,1]
    v_pk_fma_f32 v[16:17], v[204:205], s[30:31], v[200:201]
    v_pk_fma_f32 v[18:19], v[206:207], s[30:31], v[202:203]
    v_pk_fma_f32 v[200:201], v[200:201], s[30:31], v[204:205]
    v_pk_fma_f32 v[202:203], v[202:203], s[30:31], v[206:207]
    v_cvt_pk_bf16_f32 v216, v200, v201
    v_cvt_pk_bf16_f32 v217, v202, v203
    ds_write_b128 v248, v[214:217] offset:384
    v_accvgpr_read_b32 v192, a20
    v_accvgpr_read_b32 v193, a21
    v_accvgpr_read_b32 v194, a22
    v_accvgpr_read_b32 v195, a23
    v_accvgpr_read_b32 v196, a116
    v_accvgpr_read_b32 v197, a117
    v_accvgpr_read_b32 v198, a118
    v_accvgpr_read_b32 v199, a119
    v_pk_add_f32 v[192:193], v[192:193], v[196:197]
    v_pk_add_f32 v[194:195], v[194:195], v[198:199]
    v_pk_add_f32 v[196:197], v[20:21], v[116:117]
    v_pk_add_f32 v[198:199], v[22:23], v[118:119]
    v_pk_add_f32 v[116:117], v[20:21], v[116:117] neg_lo:[0,1] neg_hi:[0,1]
    v_pk_add_f32 v[118:119], v[22:23], v[118:119] neg_lo:[0,1] neg_hi:[0,1]
    v_pk_fma_f32 v[20:21], v[196:197], s[30:31], v[192:193]
    v_pk_fma_f32 v[22:23], v[198:199], s[30:31], v[194:195]
    v_pk_fma_f32 v[192:193], v[192:193], s[30:31], v[196:197]
    v_pk_fma_f32 v[194:195], v[194:195], s[30:31], v[198:199]
    v_cvt_pk_bf16_f32 v218, v192, v193
    v_cvt_pk_bf16_f32 v219, v194, v195
    v_accvgpr_read_b32 v192, a24
    v_accvgpr_read_b32 v193, a25
    v_accvgpr_read_b32 v194, a26
    v_accvgpr_read_b32 v195, a27
    v_accvgpr_read_b32 v196, a120
    v_accvgpr_read_b32 v197, a121
    v_accvgpr_read_b32 v198, a122
    v_accvgpr_read_b32 v199, a123
    v_pk_add_f32 v[192:193], v[192:193], v[196:197]
    v_pk_add_f32 v[194:195], v[194:195], v[198:199]
    v_pk_add_f32 v[196:197], v[24:25], v[120:121]
    v_pk_add_f32 v[198:199], v[26:27], v[122:123]
    v_pk_add_f32 v[120:121], v[24:25], v[120:121] neg_lo:[0,1] neg_hi:[0,1]
    v_pk_add_f32 v[122:123], v[26:27], v[122:123] neg_lo:[0,1] neg_hi:[0,1]
    v_pk_fma_f32 v[24:25], v[196:197], s[30:31], v[192:193]
    v_pk_fma_f32 v[26:27], v[198:199], s[30:31], v[194:195]
    v_pk_fma_f32 v[192:193], v[192:193], s[30:31], v[196:197]
    v_pk_fma_f32 v[194:195], v[194:195], s[30:31], v[198:199]
    v_cvt_pk_bf16_f32 v208, v192, v193
    v_cvt_pk_bf16_f32 v209, v194, v195
    ds_write_b64 v249, v[218:219] offset:448
    v_accvgpr_read_b32 v200, a28
    v_accvgpr_read_b32 v201, a29
    v_accvgpr_read_b32 v202, a30
    v_accvgpr_read_b32 v203, a31
    v_accvgpr_read_b32 v204, a124
    v_accvgpr_read_b32 v205, a125
    v_accvgpr_read_b32 v206, a126
    v_accvgpr_read_b32 v207, a127
    v_pk_add_f32 v[200:201], v[200:201], v[204:205]
    v_pk_add_f32 v[202:203], v[202:203], v[206:207]
    v_pk_add_f32 v[204:205], v[28:29], v[124:125]
    v_pk_add_f32 v[206:207], v[30:31], v[126:127]
    v_pk_add_f32 v[124:125], v[28:29], v[124:125] neg_lo:[0,1] neg_hi:[0,1]
    v_pk_add_f32 v[126:127], v[30:31], v[126:127] neg_lo:[0,1] neg_hi:[0,1]
    v_pk_fma_f32 v[28:29], v[204:205], s[30:31], v[200:201]
    v_pk_fma_f32 v[30:31], v[206:207], s[30:31], v[202:203]
    v_pk_fma_f32 v[200:201], v[200:201], s[30:31], v[204:205]
    v_pk_fma_f32 v[202:203], v[202:203], s[30:31], v[206:207]
    v_cvt_pk_bf16_f32 v210, v200, v201
    v_cvt_pk_bf16_f32 v211, v202, v203
    ds_write_b128 v248, v[208:211] offset:768
    v_accvgpr_read_b32 v192, a32
    v_accvgpr_read_b32 v193, a33
    v_accvgpr_read_b32 v194, a34
    v_accvgpr_read_b32 v195, a35
    v_accvgpr_read_b32 v196, a128
    v_accvgpr_read_b32 v197, a129
    v_accvgpr_read_b32 v198, a130
    v_accvgpr_read_b32 v199, a131
    v_pk_add_f32 v[192:193], v[192:193], v[196:197]
    v_pk_add_f32 v[194:195], v[194:195], v[198:199]
    v_pk_add_f32 v[196:197], v[32:33], v[128:129]
    v_pk_add_f32 v[198:199], v[34:35], v[130:131]
    v_pk_add_f32 v[128:129], v[32:33], v[128:129] neg_lo:[0,1] neg_hi:[0,1]
    v_pk_add_f32 v[130:131], v[34:35], v[130:131] neg_lo:[0,1] neg_hi:[0,1]
    v_pk_fma_f32 v[32:33], v[196:197], s[30:31], v[192:193]
    v_pk_fma_f32 v[34:35], v[198:199], s[30:31], v[194:195]
    v_pk_fma_f32 v[192:193], v[192:193], s[30:31], v[196:197]
    v_pk_fma_f32 v[194:195], v[194:195], s[30:31], v[198:199]
    v_cvt_pk_bf16_f32 v212, v192, v193
    v_cvt_pk_bf16_f32 v213, v194, v195
    v_accvgpr_read_b32 v192, a36
    v_accvgpr_read_b32 v193, a37
    v_accvgpr_read_b32 v194, a38
    v_accvgpr_read_b32 v195, a39
    v_accvgpr_read_b32 v196, a132
    v_accvgpr_read_b32 v197, a133
    v_accvgpr_read_b32 v198, a134
    v_accvgpr_read_b32 v199, a135
    v_pk_add_f32 v[192:193], v[192:193], v[196:197]
    v_pk_add_f32 v[194:195], v[194:195], v[198:199]
    v_pk_add_f32 v[196:197], v[36:37], v[132:133]
    v_pk_add_f32 v[198:199], v[38:39], v[134:135]
    v_pk_add_f32 v[132:133], v[36:37], v[132:133] neg_lo:[0,1] neg_hi:[0,1]
    v_pk_add_f32 v[134:135], v[38:39], v[134:135] neg_lo:[0,1] neg_hi:[0,1]
    v_pk_fma_f32 v[36:37], v[196:197], s[30:31], v[192:193]
    v_pk_fma_f32 v[38:39], v[198:199], s[30:31], v[194:195]
    v_pk_fma_f32 v[192:193], v[192:193], s[30:31], v[196:197]
    v_pk_fma_f32 v[194:195], v[194:195], s[30:31], v[198:199]
    v_cvt_pk_bf16_f32 v214, v192, v193
    v_cvt_pk_bf16_f32 v215, v194, v195
    ds_write_b64 v249, v[212:213] offset:832
    v_accvgpr_read_b32 v200, a40
    v_accvgpr_read_b32 v201, a41
    v_accvgpr_read_b32 v202, a42
    v_accvgpr_read_b32 v203, a43
    v_accvgpr_read_b32 v204, a136
    v_accvgpr_read_b32 v205, a137
    v_accvgpr_read_b32 v206, a138
    v_accvgpr_read_b32 v207, a139
    v_pk_add_f32 v[200:201], v[200:201], v[204:205]
    v_pk_add_f32 v[202:203], v[202:203], v[206:207]
    v_pk_add_f32 v[204:205], v[40:41], v[136:137]
    v_pk_add_f32 v[206:207], v[42:43], v[138:139]
    v_pk_add_f32 v[136:137], v[40:41], v[136:137] neg_lo:[0,1] neg_hi:[0,1]
    v_pk_add_f32 v[138:139], v[42:43], v[138:139] neg_lo:[0,1] neg_hi:[0,1]
    v_pk_fma_f32 v[40:41], v[204:205], s[30:31], v[200:201]
    v_pk_fma_f32 v[42:43], v[206:207], s[30:31], v[202:203]
    v_pk_fma_f32 v[200:201], v[200:201], s[30:31], v[204:205]
    v_pk_fma_f32 v[202:203], v[202:203], s[30:31], v[206:207]
    v_cvt_pk_bf16_f32 v216, v200, v201
    v_cvt_pk_bf16_f32 v217, v202, v203
    ds_write_b128 v248, v[214:217] offset:1152
    v_accvgpr_read_b32 v192, a44
    v_accvgpr_read_b32 v193, a45
    v_accvgpr_read_b32 v194, a46
    v_accvgpr_read_b32 v195, a47
    v_accvgpr_read_b32 v196, a140
    v_accvgpr_read_b32 v197, a141
    v_accvgpr_read_b32 v198, a142
    v_accvgpr_read_b32 v199, a143
    v_pk_add_f32 v[192:193], v[192:193], v[196:197]
    v_pk_add_f32 v[194:195], v[194:195], v[198:199]
    v_pk_add_f32 v[196:197], v[44:45], v[140:141]
    v_pk_add_f32 v[198:199], v[46:47], v[142:143]
    v_pk_add_f32 v[140:141], v[44:45], v[140:141] neg_lo:[0,1] neg_hi:[0,1]
    v_pk_add_f32 v[142:143], v[46:47], v[142:143] neg_lo:[0,1] neg_hi:[0,1]
    v_pk_fma_f32 v[44:45], v[196:197], s[30:31], v[192:193]
    v_pk_fma_f32 v[46:47], v[198:199], s[30:31], v[194:195]
    v_pk_fma_f32 v[192:193], v[192:193], s[30:31], v[196:197]
    v_pk_fma_f32 v[194:195], v[194:195], s[30:31], v[198:199]
    v_cvt_pk_bf16_f32 v218, v192, v193
    v_cvt_pk_bf16_f32 v219, v194, v195
    v_accvgpr_read_b32 v192, a48
    v_accvgpr_read_b32 v193, a49
    v_accvgpr_read_b32 v194, a50
    v_accvgpr_read_b32 v195, a51
    v_accvgpr_read_b32 v196, a144
    v_accvgpr_read_b32 v197, a145
    v_accvgpr_read_b32 v198, a146
    v_accvgpr_read_b32 v199, a147
    v_pk_add_f32 v[192:193], v[192:193], v[196:197]
    v_pk_add_f32 v[194:195], v[194:195], v[198:199]
    v_pk_add_f32 v[196:197], v[48:49], v[144:145]
    v_pk_add_f32 v[198:199], v[50:51], v[146:147]
    v_pk_add_f32 v[144:145], v[48:49], v[144:145] neg_lo:[0,1] neg_hi:[0,1]
    v_pk_add_f32 v[146:147], v[50:51], v[146:147] neg_lo:[0,1] neg_hi:[0,1]
    v_pk_fma_f32 v[48:49], v[196:197], s[30:31], v[192:193]
    v_pk_fma_f32 v[50:51], v[198:199], s[30:31], v[194:195]
    v_pk_fma_f32 v[192:193], v[192:193], s[30:31], v[196:197]
    v_pk_fma_f32 v[194:195], v[194:195], s[30:31], v[198:199]
    v_cvt_pk_bf16_f32 v208, v192, v193
    v_cvt_pk_bf16_f32 v209, v194, v195
    ds_write_b64 v249, v[218:219] offset:1216
    v_accvgpr_read_b32 v200, a52
    v_accvgpr_read_b32 v201, a53
    v_accvgpr_read_b32 v202, a54
    v_accvgpr_read_b32 v203, a55
    v_accvgpr_read_b32 v204, a148
    v_accvgpr_read_b32 v205, a149
    v_accvgpr_read_b32 v206, a150
    v_accvgpr_read_b32 v207, a151
    v_pk_add_f32 v[200:201], v[200:201], v[204:205]
    v_pk_add_f32 v[202:203], v[202:203], v[206:207]
    v_pk_add_f32 v[204:205], v[52:53], v[148:149]
    v_pk_add_f32 v[206:207], v[54:55], v[150:151]
    v_pk_add_f32 v[148:149], v[52:53], v[148:149] neg_lo:[0,1] neg_hi:[0,1]
    v_pk_add_f32 v[150:151], v[54:55], v[150:151] neg_lo:[0,1] neg_hi:[0,1]
    v_pk_fma_f32 v[52:53], v[204:205], s[30:31], v[200:201]
    v_pk_fma_f32 v[54:55], v[206:207], s[30:31], v[202:203]
    v_pk_fma_f32 v[200:201], v[200:201], s[30:31], v[204:205]
    v_pk_fma_f32 v[202:203], v[202:203], s[30:31], v[206:207]
    v_cvt_pk_bf16_f32 v210, v200, v201
    v_cvt_pk_bf16_f32 v211, v202, v203
    ds_write_b128 v248, v[208:211] offset:1536
    v_accvgpr_read_b32 v192, a56
    v_accvgpr_read_b32 v193, a57
    v_accvgpr_read_b32 v194, a58
    v_accvgpr_read_b32 v195, a59
    v_accvgpr_read_b32 v196, a152
    v_accvgpr_read_b32 v197, a153
    v_accvgpr_read_b32 v198, a154
    v_accvgpr_read_b32 v199, a155
    v_pk_add_f32 v[192:193], v[192:193], v[196:197]
    v_pk_add_f32 v[194:195], v[194:195], v[198:199]
    v_pk_add_f32 v[196:197], v[56:57], v[152:153]
    v_pk_add_f32 v[198:199], v[58:59], v[154:155]
    v_pk_add_f32 v[152:153], v[56:57], v[152:153] neg_lo:[0,1] neg_hi:[0,1]
    v_pk_add_f32 v[154:155], v[58:59], v[154:155] neg_lo:[0,1] neg_hi:[0,1]
    v_pk_fma_f32 v[56:57], v[196:197], s[30:31], v[192:193]
    v_pk_fma_f32 v[58:59], v[198:199], s[30:31], v[194:195]
    v_pk_fma_f32 v[192:193], v[192:193], s[30:31], v[196:197]
    v_pk_fma_f32 v[194:195], v[194:195], s[30:31], v[198:199]
    v_cvt_pk_bf16_f32 v212, v192, v193
    v_cvt_pk_bf16_f32 v213, v194, v195
    v_accvgpr_read_b32 v192, a60
    v_accvgpr_read_b32 v193, a61
    v_accvgpr_read_b32 v194, a62
    v_accvgpr_read_b32 v195, a63
    v_accvgpr_read_b32 v196, a156
    v_accvgpr_read_b32 v197, a157
    v_accvgpr_read_b32 v198, a158
    v_accvgpr_read_b32 v199, a159
    v_pk_add_f32 v[192:193], v[192:193], v[196:197]
    v_pk_add_f32 v[194:195], v[194:195], v[198:199]
    v_pk_add_f32 v[196:197], v[60:61], v[156:157]
    v_pk_add_f32 v[198:199], v[62:63], v[158:159]
    v_pk_add_f32 v[156:157], v[60:61], v[156:157] neg_lo:[0,1] neg_hi:[0,1]
    v_pk_add_f32 v[158:159], v[62:63], v[158:159] neg_lo:[0,1] neg_hi:[0,1]
    v_pk_fma_f32 v[60:61], v[196:197], s[30:31], v[192:193]
    v_pk_fma_f32 v[62:63], v[198:199], s[30:31], v[194:195]
    v_pk_fma_f32 v[192:193], v[192:193], s[30:31], v[196:197]
    v_pk_fma_f32 v[194:195], v[194:195], s[30:31], v[198:199]
    v_cvt_pk_bf16_f32 v214, v192, v193
    v_cvt_pk_bf16_f32 v215, v194, v195
    ds_write_b64 v249, v[212:213] offset:1600
    v_accvgpr_read_b32 v200, a64
    v_accvgpr_read_b32 v201, a65
    v_accvgpr_read_b32 v202, a66
    v_accvgpr_read_b32 v203, a67
    v_accvgpr_read_b32 v204, a160
    v_accvgpr_read_b32 v205, a161
    v_accvgpr_read_b32 v206, a162
    v_accvgpr_read_b32 v207, a163
    v_pk_add_f32 v[200:201], v[200:201], v[204:205]
    v_pk_add_f32 v[202:203], v[202:203], v[206:207]
    v_pk_add_f32 v[204:205], v[64:65], v[160:161]
    v_pk_add_f32 v[206:207], v[66:67], v[162:163]
    v_pk_add_f32 v[160:161], v[64:65], v[160:161] neg_lo:[0,1] neg_hi:[0,1]
    v_pk_add_f32 v[162:163], v[66:67], v[162:163] neg_lo:[0,1] neg_hi:[0,1]
    v_pk_fma_f32 v[64:65], v[204:205], s[30:31], v[200:201]
    v_pk_fma_f32 v[66:67], v[206:207], s[30:31], v[202:203]
    v_pk_fma_f32 v[200:201], v[200:201], s[30:31], v[204:205]
    v_pk_fma_f32 v[202:203], v[202:203], s[30:31], v[206:207]
    v_cvt_pk_bf16_f32 v216, v200, v201
    v_cvt_pk_bf16_f32 v217, v202, v203
    ds_write_b128 v248, v[214:217] offset:1920
    v_accvgpr_read_b32 v192, a68
    v_accvgpr_read_b32 v193, a69
    v_accvgpr_read_b32 v194, a70
    v_accvgpr_read_b32 v195, a71
    v_accvgpr_read_b32 v196, a164
    v_accvgpr_read_b32 v197, a165
    v_accvgpr_read_b32 v198, a166
    v_accvgpr_read_b32 v199, a167
    v_pk_add_f32 v[192:193], v[192:193], v[196:197]
    v_pk_add_f32 v[194:195], v[194:195], v[198:199]
    v_pk_add_f32 v[196:197], v[68:69], v[164:165]
    v_pk_add_f32 v[198:199], v[70:71], v[166:167]
    v_pk_add_f32 v[164:165], v[68:69], v[164:165] neg_lo:[0,1] neg_hi:[0,1]
    v_pk_add_f32 v[166:167], v[70:71], v[166:167] neg_lo:[0,1] neg_hi:[0,1]
    v_pk_fma_f32 v[68:69], v[196:197], s[30:31], v[192:193]
    v_pk_fma_f32 v[70:71], v[198:199], s[30:31], v[194:195]
    v_pk_fma_f32 v[192:193], v[192:193], s[30:31], v[196:197]
    v_pk_fma_f32 v[194:195], v[194:195], s[30:31], v[198:199]
    v_cvt_pk_bf16_f32 v218, v192, v193
    v_cvt_pk_bf16_f32 v219, v194, v195
    v_accvgpr_read_b32 v192, a72
    v_accvgpr_read_b32 v193, a73
    v_accvgpr_read_b32 v194, a74
    v_accvgpr_read_b32 v195, a75
    v_accvgpr_read_b32 v196, a168
    v_accvgpr_read_b32 v197, a169
    v_accvgpr_read_b32 v198, a170
    v_accvgpr_read_b32 v199, a171
    v_pk_add_f32 v[192:193], v[192:193], v[196:197]
    v_pk_add_f32 v[194:195], v[194:195], v[198:199]
    v_pk_add_f32 v[196:197], v[72:73], v[168:169]
    v_pk_add_f32 v[198:199], v[74:75], v[170:171]
    v_pk_add_f32 v[168:169], v[72:73], v[168:169] neg_lo:[0,1] neg_hi:[0,1]
    v_pk_add_f32 v[170:171], v[74:75], v[170:171] neg_lo:[0,1] neg_hi:[0,1]
    v_pk_fma_f32 v[72:73], v[196:197], s[30:31], v[192:193]
    v_pk_fma_f32 v[74:75], v[198:199], s[30:31], v[194:195]
    v_pk_fma_f32 v[192:193], v[192:193], s[30:31], v[196:197]
    v_pk_fma_f32 v[194:195], v[194:195], s[30:31], v[198:199]
    v_cvt_pk_bf16_f32 v208, v192, v193
    v_cvt_pk_bf16_f32 v209, v194, v195
    ds_write_b64 v249, v[218:219] offset:1984
    v_accvgpr_read_b32 v200, a76
    v_accvgpr_read_b32 v201, a77
    v_accvgpr_read_b32 v202, a78
    v_accvgpr_read_b32 v203, a79
    v_accvgpr_read_b32 v204, a172
    v_accvgpr_read_b32 v205, a173
    v_accvgpr_read_b32 v206, a174
    v_accvgpr_read_b32 v207, a175
    v_pk_add_f32 v[200:201], v[200:201], v[204:205]
    v_pk_add_f32 v[202:203], v[202:203], v[206:207]
    v_pk_add_f32 v[204:205], v[76:77], v[172:173]
    v_pk_add_f32 v[206:207], v[78:79], v[174:175]
    v_pk_add_f32 v[172:173], v[76:77], v[172:173] neg_lo:[0,1] neg_hi:[0,1]
    v_pk_add_f32 v[174:175], v[78:79], v[174:175] neg_lo:[0,1] neg_hi:[0,1]
    v_pk_fma_f32 v[76:77], v[204:205], s[30:31], v[200:201]
    v_pk_fma_f32 v[78:79], v[206:207], s[30:31], v[202:203]
    v_pk_fma_f32 v[200:201], v[200:201], s[30:31], v[204:205]
    v_pk_fma_f32 v[202:203], v[202:203], s[30:31], v[206:207]
    v_cvt_pk_bf16_f32 v210, v200, v201
    v_cvt_pk_bf16_f32 v211, v202, v203
    ds_write_b128 v248, v[208:211] offset:2304
    v_accvgpr_read_b32 v192, a80
    v_accvgpr_read_b32 v193, a81
    v_accvgpr_read_b32 v194, a82
    v_accvgpr_read_b32 v195, a83
    v_accvgpr_read_b32 v196, a176
    v_accvgpr_read_b32 v197, a177
    v_accvgpr_read_b32 v198, a178
    v_accvgpr_read_b32 v199, a179
    v_pk_add_f32 v[192:193], v[192:193], v[196:197]
    v_pk_add_f32 v[194:195], v[194:195], v[198:199]
    v_pk_add_f32 v[196:197], v[80:81], v[176:177]
    v_pk_add_f32 v[198:199], v[82:83], v[178:179]
    v_pk_add_f32 v[176:177], v[80:81], v[176:177] neg_lo:[0,1] neg_hi:[0,1]
    v_pk_add_f32 v[178:179], v[82:83], v[178:179] neg_lo:[0,1] neg_hi:[0,1]
    v_pk_fma_f32 v[80:81], v[196:197], s[30:31], v[192:193]
    v_pk_fma_f32 v[82:83], v[198:199], s[30:31], v[194:195]
    v_pk_fma_f32 v[192:193], v[192:193], s[30:31], v[196:197]
    v_pk_fma_f32 v[194:195], v[194:195], s[30:31], v[198:199]
    v_cvt_pk_bf16_f32 v212, v192, v193
    v_cvt_pk_bf16_f32 v213, v194, v195
    v_accvgpr_read_b32 v192, a84
    v_accvgpr_read_b32 v193, a85
    v_accvgpr_read_b32 v194, a86
    v_accvgpr_read_b32 v195, a87
    v_accvgpr_read_b32 v196, a180
    v_accvgpr_read_b32 v197, a181
    v_accvgpr_read_b32 v198, a182
    v_accvgpr_read_b32 v199, a183
    v_pk_add_f32 v[192:193], v[192:193], v[196:197]
    v_pk_add_f32 v[194:195], v[194:195], v[198:199]
    v_pk_add_f32 v[196:197], v[84:85], v[180:181]
    v_pk_add_f32 v[198:199], v[86:87], v[182:183]
    v_pk_add_f32 v[180:181], v[84:85], v[180:181] neg_lo:[0,1] neg_hi:[0,1]
    v_pk_add_f32 v[182:183], v[86:87], v[182:183] neg_lo:[0,1] neg_hi:[0,1]
    v_pk_fma_f32 v[84:85], v[196:197], s[30:31], v[192:193]
    v_pk_fma_f32 v[86:87], v[198:199], s[30:31], v[194:195]
    v_pk_fma_f32 v[192:193], v[192:193], s[30:31], v[196:197]
    v_pk_fma_f32 v[194:195], v[194:195], s[30:31], v[198:199]
    v_cvt_pk_bf16_f32 v214, v192, v193
    v_cvt_pk_bf16_f32 v215, v194, v195
    ds_write_b64 v249, v[212:213] offset:2368
    v_accvgpr_read_b32 v200, a88
    v_accvgpr_read_b32 v201, a89
    v_accvgpr_read_b32 v202, a90
    v_accvgpr_read_b32 v203, a91
    v_accvgpr_read_b32 v204, a184
    v_accvgpr_read_b32 v205, a185
    v_accvgpr_read_b32 v206, a186
    v_accvgpr_read_b32 v207, a187
    v_pk_add_f32 v[200:201], v[200:201], v[204:205]
    v_pk_add_f32 v[202:203], v[202:203], v[206:207]
    v_pk_add_f32 v[204:205], v[88:89], v[184:185]
    v_pk_add_f32 v[206:207], v[90:91], v[186:187]
    v_pk_add_f32 v[184:185], v[88:89], v[184:185] neg_lo:[0,1] neg_hi:[0,1]
    v_pk_add_f32 v[186:187], v[90:91], v[186:187] neg_lo:[0,1] neg_hi:[0,1]
    v_pk_fma_f32 v[88:89], v[204:205], s[30:31], v[200:201]
    v_pk_fma_f32 v[90:91], v[206:207], s[30:31], v[202:203]
    v_pk_fma_f32 v[200:201], v[200:201], s[30:31], v[204:205]
    v_pk_fma_f32 v[202:203], v[202:203], s[30:31], v[206:207]
    v_cvt_pk_bf16_f32 v216, v200, v201
    v_cvt_pk_bf16_f32 v217, v202, v203
    ds_write_b128 v248, v[214:217] offset:2688
    v_accvgpr_read_b32 v192, a92
    v_accvgpr_read_b32 v193, a93
    v_accvgpr_read_b32 v194, a94
    v_accvgpr_read_b32 v195, a95
    v_accvgpr_read_b32 v196, a188
    v_accvgpr_read_b32 v197, a189
    v_accvgpr_read_b32 v198, a190
    v_accvgpr_read_b32 v199, a191
    v_pk_add_f32 v[192:193], v[192:193], v[196:197]
    v_pk_add_f32 v[194:195], v[194:195], v[198:199]
    v_pk_add_f32 v[196:197], v[92:93], v[188:189]
    v_pk_add_f32 v[198:199], v[94:95], v[190:191]
    v_pk_add_f32 v[188:189], v[92:93], v[188:189] neg_lo:[0,1] neg_hi:[0,1]
    v_pk_add_f32 v[190:191], v[94:95], v[190:191] neg_lo:[0,1] neg_hi:[0,1]
    v_pk_fma_f32 v[92:93], v[196:197], s[30:31], v[192:193]
    v_pk_fma_f32 v[94:95], v[198:199], s[30:31], v[194:195]
    v_pk_fma_f32 v[192:193], v[192:193], s[30:31], v[196:197]
    v_pk_fma_f32 v[194:195], v[194:195], s[30:31], v[198:199]
    v_cvt_pk_bf16_f32 v218, v192, v193
    v_cvt_pk_bf16_f32 v219, v194, v195
    ds_write_b64 v249, v[218:219] offset:2752
    s_waitcnt lgkmcnt(0)
    s_barrier
    v_mfma_f32_16x16x32_bf16 v[0:3], a[192:195], v[228:231], v[0:3]
    v_add_u32 v250, s51, v254
    v_accvgpr_read_b32 v220, a0
    v_mfma_f32_16x16x32_bf16 v[4:7], a[196:199], v[228:231], v[4:7]
    buffer_load_dwordx4 a[244:247], v254, s[8:11], s42 offen offset:1024 sc1
    v_accvgpr_read_b32 v221, a1
    v_mfma_f32_16x16x32_bf16 v[8:11], a[200:203], v[228:231], v[8:11]
    ds_read_b128 v[228:231], v253 offset:33536
    v_accvgpr_read_b32 v222, a2
    v_mfma_f32_16x16x32_bf16 v[12:15], a[192:195], v[232:235], v[12:15]
    ds_read_b128 v[204:207], v250 offset:0
    v_accvgpr_read_b32 v223, a3
    v_mfma_f32_16x16x32_bf16 v[16:19], a[196:199], v[232:235], v[16:19]
    ds_read_b128 v[208:211], v250 offset:1024
    v_accvgpr_read_b32 v224, a96
    v_accvgpr_read_b32 v225, a97
    v_mfma_f32_16x16x32_bf16 v[20:23], a[200:203], v[232:235], v[20:23]
    buffer_load_dwordx4 a[248:251], v254, s[8:11], s42 offen offset:2048 sc1
    s_waitcnt vmcnt(10)
    v_mfma_f32_16x16x32_bf16 v[0:3], a[204:207], v[232:235], v[0:3]
    ds_read_b128 v[212:215], v250 offset:2048
    v_accvgpr_read_b32 v226, a98
    v_accvgpr_read_b32 v227, a99
    v_mfma_f32_16x16x32_bf16 v[4:7], a[208:211], v[232:235], v[4:7]
    s_add_u32 s42, s36, 927744
    s_add_u32 s44, s40, 393216
    v_sub_f32 v220, v220, v224
    v_mfma_f32_16x16x32_bf16 v[8:11], a[212:215], v[232:235], v[8:11]
    ds_read_b128 v[232:235], v253 offset:33280
    v_sub_f32 v221, v221, v225
    v_mfma_f32_16x16x32_bf16 v[24:27], a[192:195], v[236:239], v[24:27]
    buffer_load_dwordx4 a[252:255], v254, s[8:11], s42 offen offset:0 sc1
    v_sub_f32 v222, v222, v226
    v_mfma_f32_16x16x32_bf16 v[28:31], a[196:199], v[236:239], v[28:31]
    ds_read_b128 v[216:219], v250 offset:3104
    v_sub_f32 v223, v223, v227
    v_mfma_f32_16x16x32_bf16 v[32:35], a[200:203], v[236:239], v[32:35]
    s_waitcnt lgkmcnt(4)
    v_add_f32 v224, v220, v96
    v_add_f32 v225, v221, v97
    v_add_f32 v226, v222, v98
    v_mfma_f32_16x16x32_bf16 v[12:15], a[204:207], v[236:239], v[12:15]
    v_add_f32 v227, v223, v99
    v_mul_f32 v96, s28, v96
    v_mfma_f32_16x16x32_bf16 v[16:19], a[208:211], v[236:239], v[16:19]
    buffer_load_dwordx4 v[240:243], v254, s[8:11], s42 offen offset:1024 sc1
    v_mfma_f32_16x16x32_bf16 v[20:23], a[212:215], v[236:239], v[20:23]
    s_waitcnt vmcnt(9)
    v_mul_f32 v97, s28, v97
    v_mul_f32 v98, s28, v98
    v_mul_f32 v99, s28, v99
    v_mfma_f32_16x16x32_bf16 v[0:3], a[216:219], v[236:239], v[0:3]
    v_mul_f32 v224, s26, v224
    v_mul_f32 v225, s26, v225
    v_mfma_f32_16x16x32_bf16 v[4:7], a[220:223], v[236:239], v[4:7]
    buffer_load_dwordx4 v[244:247], v254, s[8:11], s42 offen offset:2048 sc1
    v_mul_f32 v226, s26, v226
    v_mfma_f32_16x16x32_bf16 v[8:11], a[224:227], v[236:239], v[8:11]
    ds_read_b128 v[236:239], v253 offset:35104
    v_mul_f32 v227, s26, v227
    v_mfma_f32_16x16x32_bf16 v[36:39], a[192:195], v[228:231], v[36:39]
    v_fmac_f32 v96, s34, v220
    v_fmac_f32 v97, s34, v221
    v_mfma_f32_16x16x32_bf16 v[40:43], a[196:199], v[228:231], v[40:43]
    buffer_store_dwordx4 v[204:207], v254, s[12:15], s44 offen sc1
    s_add_u32 s44, s40, 394240
    v_fmac_f32 v98, s34, v222
    v_fmac_f32 v99, s34, v223
    v_mfma_f32_16x16x32_bf16 v[44:47], a[200:203], v[228:231], v[44:47]
    v_cvt_pk_bf16_f32 v192, v224, v225
    v_cvt_pk_bf16_f32 v193, v226, v227
    v_mfma_f32_16x16x32_bf16 v[24:27], a[204:207], v[228:231], v[24:27]
    v_accvgpr_write_b32 a0, v192
    v_accvgpr_write_b32 a1, v193
    v_accvgpr_read_b32 v220, a4
    v_mfma_f32_16x16x32_bf16 v[28:31], a[208:211], v[228:231], v[28:31]
    v_accvgpr_read_b32 v221, a5
    v_accvgpr_read_b32 v222, a6
    v_mfma_f32_16x16x32_bf16 v[32:35], a[212:215], v[228:231], v[32:35]
    s_waitcnt lgkmcnt(4)
    v_accvgpr_read_b32 v223, a7
    v_accvgpr_read_b32 v224, a100
    v_mfma_f32_16x16x32_bf16 v[12:15], a[216:219], v[228:231], v[12:15]
    v_accvgpr_read_b32 v225, a101
    v_accvgpr_read_b32 v226, a102
    v_accvgpr_read_b32 v227, a103
    v_mfma_f32_16x16x32_bf16 v[16:19], a[220:223], v[228:231], v[16:19]
    s_waitcnt lgkmcnt(2)
    v_sub_f32 v220, v220, v224
    v_sub_f32 v221, v221, v225
    v_mfma_f32_16x16x32_bf16 v[20:23], a[224:227], v[228:231], v[20:23]
    ds_read_b128 v[228:231], v253 offset:34848
    v_sub_f32 v222, v222, v226
    v_sub_f32 v223, v223, v227
    v_mfma_f32_16x16x32_bf16 v[48:51], a[192:195], v[232:235], v[48:51]
    buffer_store_dwordx4 v[208:211], v254, s[12:15], s44 offen sc1
    v_add_f32 v224, v220, v100
    v_add_f32 v225, v221, v101
    v_mfma_f32_16x16x32_bf16 v[52:55], a[196:199], v[232:235], v[52:55]
    v_add_f32 v226, v222, v102
    v_add_f32 v227, v223, v103
    v_mfma_f32_16x16x32_bf16 v[56:59], a[200:203], v[232:235], v[56:59]
    ds_read_b128 v[204:207], v250 offset:4128
    v_mul_f32 v100, s28, v100
    v_mul_f32 v101, s28, v101
    v_mfma_f32_16x16x32_bf16 v[36:39], a[204:207], v[232:235], v[36:39]
    ds_read_b128 v[208:211], v250 offset:5152
    v_mul_f32 v102, s28, v102
    v_mfma_f32_16x16x32_bf16 v[40:43], a[208:211], v[232:235], v[40:43]
    s_add_u32 s44, s40, 395264
    v_mul_f32 v103, s28, v103
    v_mul_f32 v224, s26, v224
    v_mul_f32 v225, s26, v225
    v_mfma_f32_16x16x32_bf16 v[44:47], a[212:215], v[232:235], v[44:47]
    v_mul_f32 v226, s26, v226
    v_mul_f32 v227, s26, v227
    v_mfma_f32_16x16x32_bf16 v[24:27], a[216:219], v[232:235], v[24:27]
    v_fmac_f32 v100, s34, v220
    v_fmac_f32 v101, s34, v221
    v_mfma_f32_16x16x32_bf16 v[28:31], a[220:223], v[232:235], v[28:31]
    s_waitcnt lgkmcnt(3)
    v_fmac_f32 v102, s34, v222
    v_fmac_f32 v103, s34, v223
    v_cvt_pk_bf16_f32 v194, v224, v225
    v_mfma_f32_16x16x32_bf16 v[32:35], a[224:227], v[232:235], v[32:35]
    ds_read_b128 v[232:235], v253 offset:34592
    v_mfma_f32_16x16x32_bf16 v[60:63], a[192:195], v[236:239], v[60:63]
    v_cvt_pk_bf16_f32 v195, v226, v227
    v_accvgpr_write_b32 a2, v194
    v_accvgpr_write_b32 a3, v195
    v_mfma_f32_16x16x32_bf16 v[64:67], a[196:199], v[236:239], v[64:67]
    v_accvgpr_read_b32 v220, a8
    v_accvgpr_read_b32 v221, a9
    v_mfma_f32_16x16x32_bf16 v[68:71], a[200:203], v[236:239], v[68:71]
    v_accvgpr_read_b32 v222, a10
    v_accvgpr_read_b32 v223, a11
    v_mfma_f32_16x16x32_bf16 v[48:51], a[204:207], v[236:239], v[48:51]
    buffer_store_dwordx4 v[212:215], v254, s[12:15], s44 offen sc1
    v_accvgpr_read_b32 v224, a104
    v_accvgpr_read_b32 v225, a105
    v_accvgpr_read_b32 v226, a106
    v_mfma_f32_16x16x32_bf16 v[52:55], a[208:211], v[236:239], v[52:55]
    v_accvgpr_read_b32 v227, a107
    v_sub_f32 v220, v220, v224
    v_mfma_f32_16x16x32_bf16 v[56:59], a[212:215], v[236:239], v[56:59]
    v_sub_f32 v221, v221, v225
    v_sub_f32 v222, v222, v226
    v_sub_f32 v223, v223, v227
    v_mfma_f32_16x16x32_bf16 v[36:39], a[216:219], v[236:239], v[36:39]
    s_waitcnt lgkmcnt(3)
    v_add_f32 v224, v220, v104
    v_add_f32 v225, v221, v105
    v_mfma_f32_16x16x32_bf16 v[40:43], a[220:223], v[236:239], v[40:43]
    s_add_u32 s44, s40, 396288
    v_add_f32 v226, v222, v106
    v_add_f32 v227, v223, v107
    v_mfma_f32_16x16x32_bf16 v[44:47], a[224:227], v[236:239], v[44:47]
    ds_read_b128 v[236:239], v253 offset:34336
    v_mul_f32 v104, s28, v104
    v_mul_f32 v105, s28, v105
    v_mfma_f32_16x16x32_bf16 v[72:75], a[192:195], v[228:231], v[72:75]
    v_mul_f32 v106, s28, v106
    v_mul_f32 v107, s28, v107
    v_mfma_f32_16x16x32_bf16 v[76:79], a[196:199], v[228:231], v[76:79]
    v_mul_f32 v224, s26, v224
    v_mul_f32 v225, s26, v225
    v_mul_f32 v226, s26, v226
    v_mfma_f32_16x16x32_bf16 v[80:83], a[200:203], v[228:231], v[80:83]
    v_mul_f32 v227, s26, v227
    v_fmac_f32 v104, s34, v220
    v_mfma_f32_16x16x32_bf16 v[60:63], a[204:207], v[228:231], v[60:63]
    v_fmac_f32 v105, s34, v221
    v_fmac_f32 v106, s34, v222
    v_mfma_f32_16x16x32_bf16 v[64:67], a[208:211], v[228:231], v[64:67]
    v_fmac_f32 v107, s34, v223
    v_cvt_pk_bf16_f32 v196, v224, v225
    v_cvt_pk_bf16_f32 v197, v226, v227
    v_mfma_f32_16x16x32_bf16 v[68:71], a[212:215], v[228:231], v[68:71]
    v_accvgpr_write_b32 a4, v196
    v_accvgpr_write_b32 a5, v197
    v_mfma_f32_16x16x32_bf16 v[48:51], a[216:219], v[228:231], v[48:51]
    s_waitcnt lgkmcnt(1)
    v_accvgpr_read_b32 v220, a12
    v_accvgpr_read_b32 v221, a13
    v_accvgpr_read_b32 v222, a14
    v_mfma_f32_16x16x32_bf16 v[52:55], a[220:223], v[228:231], v[52:55]
    buffer_store_dwordx4 v[216:219], v254, s[12:15], s44 offen sc1
    v_accvgpr_read_b32 v223, a15
    v_accvgpr_read_b32 v224, a108
    v_mfma_f32_16x16x32_bf16 v[56:59], a[224:227], v[228:231], v[56:59]
    ds_read_b128 v[228:231], v253 offset:34064
    v_accvgpr_read_b32 v225, a109
    v_mfma_f32_16x16x32_bf16 v[84:87], a[192:195], v[232:235], v[84:87]
    v_accvgpr_read_b32 v226, a110
    v_accvgpr_read_b32 v227, a111
    v_sub_f32 v220, v220, v224
    v_mfma_f32_16x16x32_bf16 v[88:91], a[196:199], v[232:235], v[88:91]
    v_sub_f32 v221, v221, v225
    v_sub_f32 v222, v222, v226
    v_mfma_f32_16x16x32_bf16 v[92:95], a[200:203], v[232:235], v[92:95]
    s_add_u32 s42, s36, 958464
    v_sub_f32 v223, v223, v227
    v_add_f32 v224, v220, v108
    v_add_f32 v225, v221, v109
    v_mfma_f32_16x16x32_bf16 v[72:75], a[204:207], v[232:235], v[72:75]
    buffer_load_dwordx4 a[192:195], v254, s[8:11], s42 offen offset:0 sc1
    v_mfma_f32_16x16x32_bf16 v[76:79], a[208:211], v[232:235], v[76:79]
    v_add_f32 v226, v222, v110
    v_add_f32 v227, v223, v111
    v_mfma_f32_16x16x32_bf16 v[80:83], a[212:215], v[232:235], v[80:83]
    v_mul_f32 v108, s28, v108
    v_mul_f32 v109, s28, v109
    v_mul_f32 v110, s28, v110
    v_mfma_f32_16x16x32_bf16 v[60:63], a[216:219], v[232:235], v[60:63]
    buffer_load_dwordx4 a[196:199], v254, s[8:11], s42 offen offset:1024 sc1
    v_mfma_f32_16x16x32_bf16 v[64:67], a[220:223], v[232:235], v[64:67]
    v_mul_f32 v111, s28, v111
    v_mul_f32 v224, s26, v224
    v_mul_f32 v225, s26, v225
    v_mfma_f32_16x16x32_bf16 v[68:71], a[224:227], v[232:235], v[68:71]
    s_waitcnt lgkmcnt(1)
    v_mul_f32 v226, s26, v226
    v_mul_f32 v227, s26, v227
    v_mfma_f32_16x16x32_bf16 v[84:87], a[204:207], v[236:239], v[84:87]
    ds_read_b128 v[232:235], v253 offset:15600
    v_fmac_f32 v108, s34, v220
    v_mfma_f32_16x16x32_bf16 v[88:91], a[208:211], v[236:239], v[88:91]
    v_fmac_f32 v109, s34, v221
    v_fmac_f32 v110, s34, v222
    v_fmac_f32 v111, s34, v223
    v_mfma_f32_16x16x32_bf16 v[92:95], a[212:215], v[236:239], v[92:95]
    buffer_load_dwordx4 a[200:203], v254, s[8:11], s42 offen offset:2048 sc1
    v_mfma_f32_16x16x32_bf16 v[72:75], a[216:219], v[236:239], v[72:75]
    s_waitcnt lgkmcnt(1)
    v_cvt_pk_bf16_f32 v198, v224, v225
    v_cvt_pk_bf16_f32 v199, v226, v227
    v_accvgpr_write_b32 a12, v198
    v_mfma_f32_16x16x32_bf16 v[76:79], a[220:223], v[236:239], v[76:79]
    s_add_u32 s42, s36, 961536
    v_accvgpr_write_b32 a13, v199
    v_accvgpr_read_b32 v220, a16
    v_mfma_f32_16x16x32_bf16 v[80:83], a[224:227], v[236:239], v[80:83]
    ds_read_b128 v[236:239], v253 offset:15328
    v_accvgpr_read_b32 v221, a17
    v_mfma_f32_16x16x32_bf16 v[84:87], a[216:219], v[228:231], v[84:87]
    buffer_load_dwordx4 a[204:207], v254, s[8:11], s42 offen offset:0 sc1
    v_accvgpr_read_b32 v222, a18
    v_mfma_f32_16x16x32_bf16 v[88:91], a[220:223], v[228:231], v[88:91]
    s_waitcnt vmcnt(14) lgkmcnt(1)
    v_accvgpr_read_b32 v223, a19
    v_accvgpr_read_b32 v224, a112
    v_mfma_f32_16x16x32_bf16 v[92:95], a[224:227], v[228:231], v[92:95]
    ds_read_b128 v[228:231], v253 offset:15072
    v_accvgpr_read_b32 v225, a113
    v_accvgpr_read_b32 v226, a114
    v_mfma_f32_16x16x32_bf16 v[0:3], a[228:231], v[232:235], v[0:3]
    s_waitcnt lgkmcnt(1)
    v_accvgpr_read_b32 v227, a115
    v_sub_f32 v220, v220, v224
    v_mfma_f32_16x16x32_bf16 v[4:7], a[232:235], v[232:235], v[4:7]
    buffer_load_dwordx4 a[208:211], v254, s[8:11], s42 offen offset:1024 sc1
    v_mfma_f32_16x16x32_bf16 v[8:11], a[236:239], v[232:235], v[8:11]
    ds_read_b128 v[232:235], v253 offset:14816
    v_sub_f32 v221, v221, v225
    v_sub_f32 v222, v222, v226
    v_mfma_f32_16x16x32_bf16 v[12:15], a[228:231], v[236:239], v[12:15]
    v_sub_f32 v223, v223, v227
    v_add_f32 v224, v220, v112
    v_mfma_f32_16x16x32_bf16 v[16:19], a[232:235], v[236:239], v[16:19]
    s_waitcnt vmcnt(12)
    v_add_f32 v225, v221, v113
    v_add_f32 v226, v222, v114
    v_add_f32 v227, v223, v115
    v_mfma_f32_16x16x32_bf16 v[20:23], a[236:239], v[236:239], v[20:23]
    buffer_load_dwordx4 a[212:215], v254, s[8:11], s42 offen offset:2048 sc1
    v_mfma_f32_16x16x32_bf16 v[0:3], a[240:243], v[236:239], v[0:3]
    s_waitcnt lgkmcnt(1)
    v_mul_f32 v112, s28, v112
    v_mul_f32 v113, s28, v113
    v_mfma_f32_16x16x32_bf16 v[4:7], a[244:247], v[236:239], v[4:7]
    s_add_u32 s42, s36, 964608
    v_mul_f32 v114, s28, v114
    v_mul_f32 v115, s28, v115
    v_mul_f32 v224, s26, v224
    v_mfma_f32_16x16x32_bf16 v[8:11], a[248:251], v[236:239], v[8:11]
    ds_read_b128 v[236:239], v253 offset:14560
    v_mul_f32 v225, s26, v225
    v_mfma_f32_16x16x32_bf16 v[24:27], a[228:231], v[228:231], v[24:27]
    buffer_load_dwordx4 a[216:219], v254, s[8:11], s42 offen offset:0 sc1
    v_mul_f32 v226, s26, v226
    v_mfma_f32_16x16x32_bf16 v[28:31], a[232:235], v[228:231], v[28:31]
    v_mul_f32 v227, s26, v227
    v_fmac_f32 v112, s34, v220
    v_mfma_f32_16x16x32_bf16 v[32:35], a[236:239], v[228:231], v[32:35]
    v_fmac_f32 v113, s34, v221
    v_fmac_f32 v114, s34, v222
    v_mfma_f32_16x16x32_bf16 v[12:15], a[240:243], v[228:231], v[12:15]
    v_fmac_f32 v115, s34, v223
    v_cvt_pk_bf16_f32 v200, v224, v225
    v_cvt_pk_bf16_f32 v201, v226, v227
    v_mfma_f32_16x16x32_bf16 v[16:19], a[244:247], v[228:231], v[16:19]
    buffer_load_dwordx4 a[220:223], v254, s[8:11], s42 offen offset:1024 sc1
    v_mfma_f32_16x16x32_bf16 v[20:23], a[248:251], v[228:231], v[20:23]
    s_waitcnt vmcnt(12)
    v_accvgpr_write_b32 a14, v200
    v_accvgpr_write_b32 a15, v201
    v_accvgpr_read_b32 v220, a20
    v_mfma_f32_16x16x32_bf16 v[0:3], a[252:255], v[228:231], v[0:3]
    s_waitcnt lgkmcnt(1)
    v_accvgpr_read_b32 v221, a21
    v_accvgpr_read_b32 v222, a22
    v_mfma_f32_16x16x32_bf16 v[4:7], v[240:243], v[228:231], v[4:7]
    buffer_load_dwordx4 a[224:227], v254, s[8:11], s42 offen offset:2048 sc1
    v_mfma_f32_16x16x32_bf16 v[8:11], v[244:247], v[228:231], v[8:11]
    ds_read_b128 v[228:231], v253 offset:16384
    v_accvgpr_read_b32 v223, a23
    v_accvgpr_read_b32 v224, a116
    v_mfma_f32_16x16x32_bf16 v[36:39], a[228:231], v[232:235], v[36:39]
    s_add_u32 s44, s40, 397312
    v_accvgpr_read_b32 v225, a117
    v_accvgpr_read_b32 v226, a118
    v_mfma_f32_16x16x32_bf16 v[40:43], a[232:235], v[232:235], v[40:43]
    v_accvgpr_read_b32 v227, a119
    v_sub_f32 v220, v220, v224
    v_sub_f32 v221, v221, v225
    v_mfma_f32_16x16x32_bf16 v[44:47], a[236:239], v[232:235], v[44:47]
    v_sub_f32 v222, v222, v226
    v_sub_f32 v223, v223, v227
    v_mfma_f32_16x16x32_bf16 v[24:27], a[240:243], v[232:235], v[24:27]
    v_add_f32 v224, v220, v116
    v_add_f32 v225, v221, v117
    v_mfma_f32_16x16x32_bf16 v[28:31], a[244:247], v[232:235], v[28:31]
    v_add_f32 v226, v222, v118
    v_add_f32 v227, v223, v119
    v_mul_f32 v116, s28, v116
    v_mfma_f32_16x16x32_bf16 v[32:35], a[248:251], v[232:235], v[32:35]
    v_mul_f32 v117, s28, v117
    v_mul_f32 v118, s28, v118
    v_mfma_f32_16x16x32_bf16 v[12:15], a[252:255], v[232:235], v[12:15]
    v_mul_f32 v119, s28, v119
    v_mul_f32 v224, s26, v224
    v_mul_f32 v225, s26, v225
    v_mfma_f32_16x16x32_bf16 v[16:19], v[240:243], v[232:235], v[16:19]
    s_waitcnt lgkmcnt(1)
    v_mul_f32 v226, s26, v226
    v_mul_f32 v227, s26, v227
    v_mfma_f32_16x16x32_bf16 v[20:23], v[244:247], v[232:235], v[20:23]
    ds_read_b128 v[232:235], v253 offset:16128
    v_fmac_f32 v116, s34, v220
    v_mfma_f32_16x16x32_bf16 v[48:51], a[228:231], v[236:239], v[48:51]
    v_fmac_f32 v117, s34, v221
    v_fmac_f32 v118, s34, v222
    v_fmac_f32 v119, s34, v223
    v_mfma_f32_16x16x32_bf16 v[52:55], a[232:235], v[236:239], v[52:55]
    v_cvt_pk_bf16_f32 v202, v224, v225
    v_cvt_pk_bf16_f32 v203, v226, v227
    v_mfma_f32_16x16x32_bf16 v[56:59], a[236:239], v[236:239], v[56:59]
    v_accvgpr_write_b32 a16, v202
    v_accvgpr_write_b32 a17, v203
    v_accvgpr_read_b32 v220, a24
    v_mfma_f32_16x16x32_bf16 v[36:39], a[240:243], v[236:239], v[36:39]
    v_accvgpr_read_b32 v221, a25
    v_accvgpr_read_b32 v222, a26
    v_mfma_f32_16x16x32_bf16 v[40:43], a[244:247], v[236:239], v[40:43]
    buffer_store_dwordx4 v[204:207], v254, s[12:15], s44 offen sc1
    v_accvgpr_read_b32 v223, a27
    v_accvgpr_read_b32 v224, a120
    v_mfma_f32_16x16x32_bf16 v[44:47], a[248:251], v[236:239], v[44:47]
    v_accvgpr_read_b32 v225, a121
    v_accvgpr_read_b32 v226, a122
    v_accvgpr_read_b32 v227, a123
    v_mfma_f32_16x16x32_bf16 v[24:27], a[252:255], v[236:239], v[24:27]
    v_sub_f32 v220, v220, v224
    v_sub_f32 v221, v221, v225
    v_mfma_f32_16x16x32_bf16 v[28:31], v[240:243], v[236:239], v[28:31]
    s_waitcnt lgkmcnt(1)
    v_sub_f32 v222, v222, v226
    v_sub_f32 v223, v223, v227
    v_add_f32 v224, v220, v120
    v_mfma_f32_16x16x32_bf16 v[32:35], v[244:247], v[236:239], v[32:35]
    ds_read_b128 v[236:239], v253 offset:15872
    v_add_f32 v225, v221, v121
    v_mfma_f32_16x16x32_bf16 v[60:63], a[228:231], v[228:231], v[60:63]
    v_add_f32 v226, v222, v122
    v_add_f32 v227, v223, v123
    v_mfma_f32_16x16x32_bf16 v[64:67], a[232:235], v[228:231], v[64:67]
    v_mul_f32 v120, s28, v120
    v_mul_f32 v121, s28, v121
    v_mul_f32 v122, s28, v122
    v_mfma_f32_16x16x32_bf16 v[68:71], a[236:239], v[228:231], v[68:71]
    ds_read_b128 a[96:99], v250 offset:6208
    s_add_u32 s44, s40, 398336
    v_mfma_f32_16x16x32_bf16 v[48:51], a[240:243], v[228:231], v[48:51]
    v_mul_f32 v123, s28, v123
    v_mul_f32 v224, s26, v224
    v_mul_f32 v225, s26, v225
    v_mfma_f32_16x16x32_bf16 v[52:55], a[244:247], v[228:231], v[52:55]
    v_mul_f32 v226, s26, v226
    v_mul_f32 v227, s26, v227
    v_mfma_f32_16x16x32_bf16 v[56:59], a[248:251], v[228:231], v[56:59]
    ds_read_b128 a[100:103], v250 offset:7232
    v_fmac_f32 v120, s34, v220
    v_mfma_f32_16x16x32_bf16 v[36:39], a[252:255], v[228:231], v[36:39]
    v_fmac_f32 v121, s34, v221
    v_fmac_f32 v122, s34, v222
    v_fmac_f32 v123, s34, v223
    v_mfma_f32_16x16x32_bf16 v[40:43], v[240:243], v[228:231], v[40:43]
    s_waitcnt lgkmcnt(3)
    v_cvt_pk_bf16_f32 v192, v224, v225
    v_cvt_pk_bf16_f32 v193, v226, v227
    v_mfma_f32_16x16x32_bf16 v[44:47], v[244:247], v[228:231], v[44:47]
    ds_read_b128 v[228:231], v253 offset:15616
    v_accvgpr_write_b32 a24, v192
    v_accvgpr_write_b32 a25, v193
    v_mfma_f32_16x16x32_bf16 v[72:75], a[228:231], v[232:235], v[72:75]
    ds_read_b128 a[104:107], v250 offset:8256
    v_mfma_f32_16x16x32_bf16 v[76:79], a[232:235], v[232:235], v[76:79]
    v_accvgpr_read_b32 v220, a28
    v_accvgpr_read_b32 v221, a29
    v_mfma_f32_16x16x32_bf16 v[80:83], a[236:239], v[232:235], v[80:83]
    v_accvgpr_read_b32 v222, a30
    v_accvgpr_read_b32 v223, a31
    v_accvgpr_read_b32 v224, a124
    v_mfma_f32_16x16x32_bf16 v[60:63], a[240:243], v[232:235], v[60:63]
    ds_read_b128 a[108:111], v250 offset:9312
    v_accvgpr_read_b32 v225, a125
    v_mfma_f32_16x16x32_bf16 v[64:67], a[244:247], v[232:235], v[64:67]
    v_accvgpr_read_b32 v226, a126
    v_accvgpr_read_b32 v227, a127
    v_sub_f32 v220, v220, v224
    v_mfma_f32_16x16x32_bf16 v[68:71], a[248:251], v[232:235], v[68:71]
    s_waitcnt lgkmcnt(5)
    v_sub_f32 v221, v221, v225
    v_sub_f32 v222, v222, v226
    v_mfma_f32_16x16x32_bf16 v[48:51], a[252:255], v[232:235], v[48:51]
    buffer_store_dwordx4 v[208:211], v254, s[12:15], s44 offen sc1
    v_sub_f32 v223, v223, v227
    v_add_f32 v224, v220, v124
    v_mfma_f32_16x16x32_bf16 v[52:55], v[240:243], v[232:235], v[52:55]
    ds_read_b128 a[112:115], v250 offset:10336
    v_add_f32 v225, v221, v125
    v_add_f32 v226, v222, v126
    v_mfma_f32_16x16x32_bf16 v[56:59], v[244:247], v[232:235], v[56:59]
    ds_read_b128 v[232:235], v253 offset:15344
    v_add_f32 v227, v223, v127
    v_mfma_f32_16x16x32_bf16 v[84:87], a[228:231], v[236:239], v[84:87]
    v_mul_f32 v124, s28, v124
    v_mul_f32 v125, s28, v125
    v_mul_f32 v126, s28, v126
    v_mfma_f32_16x16x32_bf16 v[88:91], a[232:235], v[236:239], v[88:91]
    ds_read_b128 a[116:119], v250 offset:11360
    v_mul_f32 v127, s28, v127
    v_mfma_f32_16x16x32_bf16 v[92:95], a[236:239], v[236:239], v[92:95]
    s_add_u32 s42, s36, 995328
    v_mul_f32 v224, s26, v224
    v_mul_f32 v225, s26, v225
    v_mfma_f32_16x16x32_bf16 v[72:75], a[240:243], v[236:239], v[72:75]
    buffer_load_dwordx4 a[228:231], v254, s[8:11], s42 offen offset:0 sc1
    v_mul_f32 v226, s26, v226
    v_mfma_f32_16x16x32_bf16 v[76:79], a[244:247], v[236:239], v[76:79]
    s_add_u32 s44, s40, 399360
    v_mul_f32 v227, s26, v227
    v_fmac_f32 v124, s34, v220
    v_mfma_f32_16x16x32_bf16 v[80:83], a[248:251], v[236:239], v[80:83]
    s_waitcnt lgkmcnt(5)
    v_fmac_f32 v125, s34, v221
    v_fmac_f32 v126, s34, v222
    v_fmac_f32 v127, s34, v223
    v_mfma_f32_16x16x32_bf16 v[60:63], a[252:255], v[236:239], v[60:63]
    buffer_load_dwordx4 a[232:235], v254, s[8:11], s42 offen offset:1024 sc1
    v_mfma_f32_16x16x32_bf16 v[64:67], v[240:243], v[236:239], v[64:67]
    s_waitcnt lgkmcnt(0)
    v_cvt_pk_bf16_f32 v194, v224, v225
    v_cvt_pk_bf16_f32 v195, v226, v227
    v_mfma_f32_16x16x32_bf16 v[68:71], v[244:247], v[236:239], v[68:71]
    s_barrier
    v_accvgpr_write_b32 a26, v194
    v_mfma_f32_16x16x32_bf16 v[84:87], a[240:243], v[228:231], v[84:87]
    ds_read_b128 v[236:239], v253 offset:17680
    v_accvgpr_write_b32 a27, v195
    v_mfma_f32_16x16x32_bf16 v[88:91], a[244:247], v[228:231], v[88:91]
    ds_write_b128 v248, a[0:3] offset:0
    v_accvgpr_read_b32 v220, a32
    v_mfma_f32_16x16x32_bf16 v[92:95], a[248:251], v[228:231], v[92:95]
    buffer_load_dwordx4 a[236:239], v254, s[8:11], s42 offen offset:2048 sc1
    v_mfma_f32_16x16x32_bf16 v[72:75], a[252:255], v[228:231], v[72:75]
    v_accvgpr_read_b32 v221, a33
    v_accvgpr_read_b32 v222, a34
    v_mfma_f32_16x16x32_bf16 v[76:79], v[240:243], v[228:231], v[76:79]
    s_add_u32 s42, s36, 998400
    v_accvgpr_read_b32 v223, a35
    v_accvgpr_read_b32 v224, a128
    v_accvgpr_read_b32 v225, a129
    v_mfma_f32_16x16x32_bf16 v[80:83], v[244:247], v[228:231], v[80:83]
    ds_read_b128 v[228:231], v253 offset:17408
    v_accvgpr_read_b32 v226, a130
    v_mfma_f32_16x16x32_bf16 v[84:87], a[252:255], v[232:235], v[84:87]
    buffer_load_dwordx4 a[240:243], v254, s[8:11], s42 offen offset:0 sc1
    v_accvgpr_read_b32 v227, a131
    v_mfma_f32_16x16x32_bf16 v[88:91], v[240:243], v[232:235], v[88:91]
    s_waitcnt vmcnt(12) lgkmcnt(2)
    v_sub_f32 v220, v220, v224
    v_sub_f32 v221, v221, v225
    v_mfma_f32_16x16x32_bf16 v[92:95], v[244:247], v[232:235], v[92:95]
    ds_read_b128 v[232:235], v253 offset:17152
    v_sub_f32 v222, v222, v226
    v_mfma_f32_16x16x32_bf16 v[0:3], a[192:195], v[236:239], v[0:3]
    s_waitcnt lgkmcnt(1)
    v_sub_f32 v223, v223, v227
    v_add_f32 v224, v220, v128
    v_add_f32 v225, v221, v129
    v_mfma_f32_16x16x32_bf16 v[4:7], a[196:199], v[236:239], v[4:7]
    buffer_load_dwordx4 a[244:247], v254, s[8:11], s42 offen offset:1024 sc1
    v_mfma_f32_16x16x32_bf16 v[8:11], a[200:203], v[236:239], v[8:11]
    ds_read_b128 v[236:239], v253 offset:16896
    v_add_f32 v226, v222, v130
    v_add_f32 v227, v223, v131
    v_mfma_f32_16x16x32_bf16 v[12:15], a[192:195], v[228:231], v[12:15]
    ds_write_b64 v249, a[4:5] offset:64
    v_mfma_f32_16x16x32_bf16 v[16:19], a[196:199], v[228:231], v[16:19]
    s_waitcnt vmcnt(10)
    v_mul_f32 v128, s28, v128
    v_mul_f32 v129, s28, v129
    v_mfma_f32_16x16x32_bf16 v[20:23], a[200:203], v[228:231], v[20:23]
    buffer_load_dwordx4 a[248:251], v254, s[8:11], s42 offen offset:2048 sc1
    v_mul_f32 v130, s28, v130
    v_mfma_f32_16x16x32_bf16 v[0:3], a[204:207], v[228:231], v[0:3]
    s_waitcnt lgkmcnt(2)
    v_mul_f32 v131, s28, v131
    v_mul_f32 v224, s26, v224
    v_mfma_f32_16x16x32_bf16 v[4:7], a[208:211], v[228:231], v[4:7]
    s_add_u32 s42, s36, 1001472
    v_mul_f32 v225, s26, v225
    v_mul_f32 v226, s26, v226
    v_mul_f32 v227, s26, v227
    v_mfma_f32_16x16x32_bf16 v[8:11], a[212:215], v[228:231], v[8:11]
    ds_read_b128 v[228:231], v253 offset:16640
    v_fmac_f32 v128, s34, v220
    v_mfma_f32_16x16x32_bf16 v[24:27], a[192:195], v[232:235], v[24:27]
    buffer_load_dwordx4 a[252:255], v254, s[8:11], s42 offen offset:0 sc1
    v_mfma_f32_16x16x32_bf16 v[28:31], a[196:199], v[232:235], v[28:31]
    v_fmac_f32 v129, s34, v221
    v_fmac_f32 v130, s34, v222
    v_fmac_f32 v131, s34, v223
    v_mfma_f32_16x16x32_bf16 v[32:35], a[200:203], v[232:235], v[32:35]
    ds_write_b128 v248, a[12:15] offset:384
    v_mfma_f32_16x16x32_bf16 v[12:15], a[204:207], v[232:235], v[12:15]
    v_cvt_pk_bf16_f32 v196, v224, v225
    v_cvt_pk_bf16_f32 v197, v226, v227
    v_accvgpr_write_b32 a28, v196
    v_mfma_f32_16x16x32_bf16 v[16:19], a[208:211], v[232:235], v[16:19]
    buffer_load_dwordx4 v[240:243], v254, s[8:11], s42 offen offset:1024 sc1
    v_mfma_f32_16x16x32_bf16 v[20:23], a[212:215], v[232:235], v[20:23]
    s_waitcnt vmcnt(10)
    v_accvgpr_write_b32 a29, v197
    v_accvgpr_read_b32 v220, a36
    v_mfma_f32_16x16x32_bf16 v[0:3], a[216:219], v[232:235], v[0:3]
    s_waitcnt lgkmcnt(3)
    v_accvgpr_read_b32 v221, a37
    v_accvgpr_read_b32 v222, a38
    v_accvgpr_read_b32 v223, a39
    v_mfma_f32_16x16x32_bf16 v[4:7], a[220:223], v[232:235], v[4:7]
    buffer_load_dwordx4 v[244:247], v254, s[8:11], s42 offen offset:2048 sc1
    v_mfma_f32_16x16x32_bf16 v[8:11], a[224:227], v[232:235], v[8:11]
    ds_read_b128 v[232:235], v253 offset:18464
    v_accvgpr_read_b32 v224, a132
    v_accvgpr_read_b32 v225, a133
    v_mfma_f32_16x16x32_bf16 v[36:39], a[192:195], v[236:239], v[36:39]
    v_accvgpr_read_b32 v226, a134
    v_accvgpr_read_b32 v227, a135
    v_mfma_f32_16x16x32_bf16 v[40:43], a[196:199], v[236:239], v[40:43]
    buffer_store_dwordx4 a[96:99], v254, s[12:15], s44 offen sc1
    s_add_u32 s44, s40, 400384
    v_mfma_f32_16x16x32_bf16 v[44:47], a[200:203], v[236:239], v[44:47]
    ds_write_b64 v249, a[16:17] offset:448
    v_sub_f32 v220, v220, v224
    v_mfma_f32_16x16x32_bf16 v[24:27], a[204:207], v[236:239], v[24:27]
    v_sub_f32 v221, v221, v225
    v_sub_f32 v222, v222, v226
    v_mfma_f32_16x16x32_bf16 v[28:31], a[208:211], v[236:239], v[28:31]
    buffer_store_dwordx4 a[100:103], v254, s[12:15], s44 offen sc1
    v_sub_f32 v223, v223, v227
    v_add_f32 v224, v220, v132
    v_add_f32 v225, v221, v133
    v_mfma_f32_16x16x32_bf16 v[32:35], a[212:215], v[236:239], v[32:35]
    v_add_f32 v226, v222, v134
    v_add_f32 v227, v223, v135
    v_mfma_f32_16x16x32_bf16 v[12:15], a[216:219], v[236:239], v[12:15]
    v_mul_f32 v132, s28, v132
    v_mul_f32 v133, s28, v133
    v_mfma_f32_16x16x32_bf16 v[16:19], a[220:223], v[236:239], v[16:19]
    s_waitcnt lgkmcnt(3)
    v_mul_f32 v134, s28, v134
    v_mul_f32 v135, s28, v135
    v_mul_f32 v224, s26, v224
    v_mfma_f32_16x16x32_bf16 v[20:23], a[224:227], v[236:239], v[20:23]
    ds_read_b128 v[236:239], v253 offset:18208
    v_mul_f32 v225, s26, v225
    v_mfma_f32_16x16x32_bf16 v[48:51], a[192:195], v[228:231], v[48:51]
    s_add_u32 s44, s40, 401408
    v_mul_f32 v226, s26, v226
    v_mul_f32 v227, s26, v227
    v_fmac_f32 v132, s34, v220
    v_mfma_f32_16x16x32_bf16 v[52:55], a[196:199], v[228:231], v[52:55]
    v_fmac_f32 v133, s34, v221
    v_fmac_f32 v134, s34, v222
    v_mfma_f32_16x16x32_bf16 v[56:59], a[200:203], v[228:231], v[56:59]
    v_fmac_f32 v135, s34, v223
    v_cvt_pk_bf16_f32 v198, v224, v225
    v_mfma_f32_16x16x32_bf16 v[36:39], a[204:207], v[228:231], v[36:39]
    v_cvt_pk_bf16_f32 v199, v226, v227
    v_accvgpr_read_b32 v220, a40
    v_accvgpr_read_b32 v221, a41
    v_mfma_f32_16x16x32_bf16 v[40:43], a[208:211], v[228:231], v[40:43]
    v_accvgpr_read_b32 v222, a42
    v_accvgpr_read_b32 v223, a43
    v_mfma_f32_16x16x32_bf16 v[44:47], a[212:215], v[228:231], v[44:47]
    v_accvgpr_read_b32 v224, a136
    v_accvgpr_read_b32 v225, a137
    v_accvgpr_read_b32 v226, a138
    v_mfma_f32_16x16x32_bf16 v[24:27], a[216:219], v[228:231], v[24:27]
    v_accvgpr_read_b32 v227, a139
    v_sub_f32 v220, v220, v224
    v_mfma_f32_16x16x32_bf16 v[28:31], a[220:223], v[228:231], v[28:31]
    s_waitcnt lgkmcnt(2)
    v_sub_f32 v221, v221, v225
    v_sub_f32 v222, v222, v226
    v_mfma_f32_16x16x32_bf16 v[32:35], a[224:227], v[228:231], v[32:35]
    ds_read_b128 v[228:231], v253 offset:17952
    v_sub_f32 v223, v223, v227
    v_add_f32 v224, v220, v136
    v_mfma_f32_16x16x32_bf16 v[60:63], a[192:195], v[232:235], v[60:63]
    v_add_f32 v225, v221, v137
    v_add_f32 v226, v222, v138
    v_mfma_f32_16x16x32_bf16 v[64:67], a[196:199], v[232:235], v[64:67]
    v_add_f32 v227, v223, v139
    v_mul_f32 v136, s28, v136
    v_mul_f32 v137, s28, v137
    v_mfma_f32_16x16x32_bf16 v[68:71], a[200:203], v[232:235], v[68:71]
    v_mul_f32 v138, s28, v138
    v_mul_f32 v139, s28, v139
    v_mfma_f32_16x16x32_bf16 v[48:51], a[204:207], v[232:235], v[48:51]
    v_mul_f32 v224, s26, v224
    v_mul_f32 v225, s26, v225
    v_mfma_f32_16x16x32_bf16 v[52:55], a[208:211], v[232:235], v[52:55]
    buffer_store_dwordx4 a[104:107], v254, s[12:15], s44 offen sc1
    v_mul_f32 v226, s26, v226
    v_mul_f32 v227, s26, v227
    v_fmac_f32 v136, s34, v220
    v_mfma_f32_16x16x32_bf16 v[56:59], a[212:215], v[232:235], v[56:59]
    ds_write_b128 v248, a[24:27] offset:768
    v_mfma_f32_16x16x32_bf16 v[36:39], a[216:219], v[232:235], v[36:39]
    v_fmac_f32 v137, s34, v221
    v_fmac_f32 v138, s34, v222
    v_fmac_f32 v139, s34, v223
    v_mfma_f32_16x16x32_bf16 v[40:43], a[220:223], v[232:235], v[40:43]
    s_waitcnt lgkmcnt(2)
    v_cvt_pk_bf16_f32 v200, v224, v225
    v_cvt_pk_bf16_f32 v201, v226, v227
    v_mfma_f32_16x16x32_bf16 v[44:47], a[224:227], v[232:235], v[44:47]
    ds_read_b128 v[232:235], v253 offset:17696
    v_mfma_f32_16x16x32_bf16 v[72:75], a[192:195], v[236:239], v[72:75]
    ds_write_b128 v248, v[198:201] offset:1152
    v_accvgpr_read_b32 v220, a44
    v_mfma_f32_16x16x32_bf16 v[76:79], a[196:199], v[236:239], v[76:79]
    v_accvgpr_read_b32 v221, a45
    v_accvgpr_read_b32 v222, a46
    v_mfma_f32_16x16x32_bf16 v[80:83], a[200:203], v[236:239], v[80:83]
    s_add_u32 s44, s40, 402432
    v_accvgpr_read_b32 v223, a47
    v_accvgpr_read_b32 v224, a140
    v_accvgpr_read_b32 v225, a141
    v_mfma_f32_16x16x32_bf16 v[60:63], a[204:207], v[236:239], v[60:63]
    v_accvgpr_read_b32 v226, a142
    v_accvgpr_read_b32 v227, a143
    v_mfma_f32_16x16x32_bf16 v[64:67], a[208:211], v[236:239], v[64:67]
    ds_write_b64 v249, a[28:29] offset:832
    v_mfma_f32_16x16x32_bf16 v[68:71], a[212:215], v[236:239], v[68:71]
    v_sub_f32 v220, v220, v224
    v_sub_f32 v221, v221, v225
    v_sub_f32 v222, v222, v226
    v_mfma_f32_16x16x32_bf16 v[48:51], a[216:219], v[236:239], v[48:51]
    v_sub_f32 v223, v223, v227
    v_add_f32 v224, v220, v140
    v_mfma_f32_16x16x32_bf16 v[52:55], a[220:223], v[236:239], v[52:55]
    s_waitcnt lgkmcnt(4)
    v_add_f32 v225, v221, v141
    v_add_f32 v226, v222, v142
    v_add_f32 v227, v223, v143
    v_mfma_f32_16x16x32_bf16 v[56:59], a[224:227], v[236:239], v[56:59]
    ds_read_b128 v[236:239], v253 offset:17424
    v_mul_f32 v140, s28, v140
    v_mfma_f32_16x16x32_bf16 v[84:87], a[192:195], v[228:231], v[84:87]
    v_mul_f32 v141, s28, v141
    v_mul_f32 v142, s28, v142
    v_mfma_f32_16x16x32_bf16 v[88:91], a[196:199], v[228:231], v[88:91]
    v_mul_f32 v143, s28, v143
    v_mul_f32 v224, s26, v224
    v_mul_f32 v225, s26, v225
    v_mfma_f32_16x16x32_bf16 v[92:95], a[200:203], v[228:231], v[92:95]
    s_add_u32 s42, s36, 1032192
    v_mul_f32 v226, s26, v226
    v_mul_f32 v227, s26, v227
    v_mfma_f32_16x16x32_bf16 v[72:75], a[204:207], v[228:231], v[72:75]
    buffer_load_dwordx4 a[192:195], v254, s[8:11], s42 offen offset:0 sc1
    v_fmac_f32 v140, s34, v220
    v_mfma_f32_16x16x32_bf16 v[76:79], a[208:211], v[228:231], v[76:79]
    v_fmac_f32 v141, s34, v221
    v_fmac_f32 v142, s34, v222
    v_mfma_f32_16x16x32_bf16 v[80:83], a[212:215], v[228:231], v[80:83]
    s_waitcnt lgkmcnt(3)
    v_fmac_f32 v143, s34, v223
    v_cvt_pk_bf16_f32 v202, v224, v225
    v_mfma_f32_16x16x32_bf16 v[60:63], a[216:219], v[228:231], v[60:63]
    buffer_load_dwordx4 a[196:199], v254, s[8:11], s42 offen offset:1024 sc1
    v_cvt_pk_bf16_f32 v203, v226, v227
    v_mfma_f32_16x16x32_bf16 v[64:67], a[220:223], v[228:231], v[64:67]
    s_waitcnt lgkmcnt(0)
    v_mfma_f32_16x16x32_bf16 v[68:71], a[224:227], v[228:231], v[68:71]
    s_barrier
    v_mfma_f32_16x16x32_bf16 v[84:87], a[204:207], v[232:235], v[84:87]
    ds_read_b128 v[228:231], v253 offset:19760
    v_mfma_f32_16x16x32_bf16 v[88:91], a[208:211], v[232:235], v[88:91]
    ds_read_b128 a[120:123], v250 offset:0
    v_mfma_f32_16x16x32_bf16 v[92:95], a[212:215], v[232:235], v[92:95]
    buffer_load_dwordx4 a[200:203], v254, s[8:11], s42 offen offset:2048 sc1
    v_mfma_f32_16x16x32_bf16 v[72:75], a[216:219], v[232:235], v[72:75]
    ds_write_b64 v249, v[202:203] offset:1216
    v_mfma_f32_16x16x32_bf16 v[76:79], a[220:223], v[232:235], v[76:79]
    s_add_u32 s42, s36, 1035264
    v_accvgpr_read_b32 v220, a48
    v_accvgpr_read_b32 v221, a49
    v_accvgpr_read_b32 v222, a50
    v_mfma_f32_16x16x32_bf16 v[80:83], a[224:227], v[232:235], v[80:83]
    ds_read_b128 v[232:235], v253 offset:19488
    v_accvgpr_read_b32 v223, a51
    v_mfma_f32_16x16x32_bf16 v[84:87], a[216:219], v[236:239], v[84:87]
    buffer_load_dwordx4 a[204:207], v254, s[8:11], s42 offen offset:0 sc1
    v_mfma_f32_16x16x32_bf16 v[88:91], a[220:223], v[236:239], v[88:91]
    s_waitcnt vmcnt(13) lgkmcnt(3)
    v_accvgpr_read_b32 v224, a144
    v_accvgpr_read_b32 v225, a145
    v_accvgpr_read_b32 v226, a146
    v_mfma_f32_16x16x32_bf16 v[92:95], a[224:227], v[236:239], v[92:95]
    ds_read_b128 v[236:239], v253 offset:19232
    v_accvgpr_read_b32 v227, a147
    v_mfma_f32_16x16x32_bf16 v[0:3], a[228:231], v[228:231], v[0:3]
    s_waitcnt lgkmcnt(1)
    v_sub_f32 v220, v220, v224
    v_sub_f32 v221, v221, v225
    v_sub_f32 v222, v222, v226
    v_mfma_f32_16x16x32_bf16 v[4:7], a[232:235], v[228:231], v[4:7]
    buffer_load_dwordx4 a[208:211], v254, s[8:11], s42 offen offset:1024 sc1
    v_mfma_f32_16x16x32_bf16 v[8:11], a[236:239], v[228:231], v[8:11]
    ds_read_b128 v[228:231], v253 offset:18976
    v_sub_f32 v223, v223, v227
    v_mfma_f32_16x16x32_bf16 v[12:15], a[228:231], v[232:235], v[12:15]
    ds_read_b128 a[124:127], v250 offset:3104
    v_add_f32 v224, v220, v144
    v_add_f32 v225, v221, v145
    v_mfma_f32_16x16x32_bf16 v[16:19], a[232:235], v[232:235], v[16:19]
    s_waitcnt vmcnt(11)
    v_add_f32 v226, v222, v146
    v_add_f32 v227, v223, v147
    v_mfma_f32_16x16x32_bf16 v[20:23], a[236:239], v[232:235], v[20:23]
    buffer_load_dwordx4 a[212:215], v254, s[8:11], s42 offen offset:2048 sc1
    v_mul_f32 v144, s28, v144
    v_mfma_f32_16x16x32_bf16 v[0:3], a[240:243], v[232:235], v[0:3]
    s_waitcnt lgkmcnt(2)
    v_mul_f32 v145, s28, v145
    v_mul_f32 v146, s28, v146
    v_mfma_f32_16x16x32_bf16 v[4:7], a[244:247], v[232:235], v[4:7]
    s_add_u32 s42, s36, 1038336
    v_mul_f32 v147, s28, v147
    v_mul_f32 v224, s26, v224
    v_mfma_f32_16x16x32_bf16 v[8:11], a[248:251], v[232:235], v[8:11]
    ds_read_b128 v[232:235], v253 offset:18720
    v_mul_f32 v225, s26, v225
    v_mul_f32 v226, s26, v226
    v_mfma_f32_16x16x32_bf16 v[24:27], a[228:231], v[236:239], v[24:27]
    buffer_load_dwordx4 a[216:219], v254, s[8:11], s42 offen offset:0 sc1
    v_mfma_f32_16x16x32_bf16 v[28:31], a[232:235], v[236:239], v[28:31]
    v_mul_f32 v227, s26, v227
    v_fmac_f32 v144, s34, v220
    v_fmac_f32 v145, s34, v221
    v_mfma_f32_16x16x32_bf16 v[32:35], a[236:239], v[236:239], v[32:35]
    ds_read_b128 a[128:131], v250 offset:6208
    v_fmac_f32 v146, s34, v222
    v_mfma_f32_16x16x32_bf16 v[12:15], a[240:243], v[236:239], v[12:15]
    v_fmac_f32 v147, s34, v223
    v_cvt_pk_bf16_f32 v192, v224, v225
    v_mfma_f32_16x16x32_bf16 v[16:19], a[244:247], v[236:239], v[16:19]
    buffer_load_dwordx4 a[220:223], v254, s[8:11], s42 offen offset:1024 sc1
    v_cvt_pk_bf16_f32 v193, v226, v227
    v_mfma_f32_16x16x32_bf16 v[20:23], a[248:251], v[236:239], v[20:23]
    s_waitcnt vmcnt(11)
    v_accvgpr_read_b32 v220, a52
    v_accvgpr_read_b32 v221, a53
    v_mfma_f32_16x16x32_bf16 v[0:3], a[252:255], v[236:239], v[0:3]
    s_waitcnt lgkmcnt(3)
    v_accvgpr_read_b32 v222, a54
    v_accvgpr_read_b32 v223, a55
    v_accvgpr_read_b32 v224, a148
    v_mfma_f32_16x16x32_bf16 v[4:7], v[240:243], v[236:239], v[4:7]
    buffer_load_dwordx4 a[224:227], v254, s[8:11], s42 offen offset:2048 sc1
    v_mfma_f32_16x16x32_bf16 v[8:11], v[244:247], v[236:239], v[8:11]
    ds_read_b128 v[236:239], v253 offset:20544
    v_accvgpr_read_b32 v225, a149
    v_mfma_f32_16x16x32_bf16 v[36:39], a[228:231], v[228:231], v[36:39]
    v_accvgpr_read_b32 v226, a150
    v_accvgpr_read_b32 v227, a151
    v_sub_f32 v220, v220, v224
    v_mfma_f32_16x16x32_bf16 v[40:43], a[232:235], v[228:231], v[40:43]
    buffer_store_dwordx4 a[108:111], v254, s[12:15], s44 offen sc1
    s_add_u32 s44, s40, 403456
    v_mfma_f32_16x16x32_bf16 v[44:47], a[236:239], v[228:231], v[44:47]
    ds_read_b128 a[132:135], v250 offset:9312
    v_sub_f32 v221, v221, v225
    v_sub_f32 v222, v222, v226
    v_mfma_f32_16x16x32_bf16 v[24:27], a[240:243], v[228:231], v[24:27]
    v_sub_f32 v223, v223, v227
    v_add_f32 v224, v220, v148
    v_mfma_f32_16x16x32_bf16 v[28:31], a[244:247], v[228:231], v[28:31]
    buffer_store_dwordx4 a[112:115], v254, s[12:15], s44 offen sc1
    s_add_u32 s44, s40, 404480
    v_mfma_f32_16x16x32_bf16 v[32:35], a[248:251], v[228:231], v[32:35]
    v_add_f32 v225, v221, v149
    v_add_f32 v226, v222, v150
    v_add_f32 v227, v223, v151
    v_mfma_f32_16x16x32_bf16 v[12:15], a[252:255], v[228:231], v[12:15]
    v_mul_f32 v148, s28, v148
    v_mul_f32 v149, s28, v149
    v_mfma_f32_16x16x32_bf16 v[16:19], v[240:243], v[228:231], v[16:19]
    s_waitcnt lgkmcnt(3)
    v_mul_f32 v150, s28, v150
    v_mul_f32 v151, s28, v151
    v_mul_f32 v224, s26, v224
    v_mfma_f32_16x16x32_bf16 v[20:23], v[244:247], v[228:231], v[20:23]
    ds_read_b128 v[228:231], v253 offset:20288
    v_mul_f32 v225, s26, v225
    v_mfma_f32_16x16x32_bf16 v[48:51], a[228:231], v[232:235], v[48:51]
    v_mul_f32 v226, s26, v226
    v_mul_f32 v227, s26, v227
    v_mfma_f32_16x16x32_bf16 v[52:55], a[232:235], v[232:235], v[52:55]
    v_fmac_f32 v148, s34, v220
    v_fmac_f32 v149, s34, v221
    v_fmac_f32 v150, s34, v222
    v_mfma_f32_16x16x32_bf16 v[56:59], a[236:239], v[232:235], v[56:59]
    buffer_store_dwordx4 a[116:119], v254, s[12:15], s44 offen sc1
    v_fmac_f32 v151, s34, v223
    v_cvt_pk_bf16_f32 v194, v224, v225
    v_mfma_f32_16x16x32_bf16 v[36:39], a[240:243], v[232:235], v[36:39]
    v_cvt_pk_bf16_f32 v195, v226, v227
    v_mfma_f32_16x16x32_bf16 v[40:43], a[244:247], v[232:235], v[40:43]
    ds_write_b128 v248, v[192:195] offset:1536
    v_mfma_f32_16x16x32_bf16 v[44:47], a[248:251], v[232:235], v[44:47]
    v_accvgpr_read_b32 v220, a56
    v_accvgpr_read_b32 v221, a57
    v_mfma_f32_16x16x32_bf16 v[24:27], a[252:255], v[232:235], v[24:27]
    v_accvgpr_read_b32 v222, a58
    v_accvgpr_read_b32 v223, a59
    v_accvgpr_read_b32 v224, a152
    v_mfma_f32_16x16x32_bf16 v[28:31], v[240:243], v[232:235], v[28:31]
    s_waitcnt lgkmcnt(3)
    v_accvgpr_read_b32 v225, a153
    v_accvgpr_read_b32 v226, a154
    v_mfma_f32_16x16x32_bf16 v[32:35], v[244:247], v[232:235], v[32:35]
    ds_read_b128 v[232:235], v253 offset:20032
    v_accvgpr_read_b32 v227, a155
    v_sub_f32 v220, v220, v224
    v_mfma_f32_16x16x32_bf16 v[60:63], a[228:231], v[236:239], v[60:63]
    v_sub_f32 v221, v221, v225
    v_sub_f32 v222, v222, v226
    v_mfma_f32_16x16x32_bf16 v[64:67], a[232:235], v[236:239], v[64:67]
    s_add_u32 s44, s40, 196608
    v_sub_f32 v223, v223, v227
    v_add_f32 v224, v220, v152
    v_mfma_f32_16x16x32_bf16 v[68:71], a[236:239], v[236:239], v[68:71]
    v_add_f32 v225, v221, v153
    v_add_f32 v226, v222, v154
    v_add_f32 v227, v223, v155
    v_mfma_f32_16x16x32_bf16 v[48:51], a[240:243], v[236:239], v[48:51]
    v_mul_f32 v152, s28, v152
    v_mul_f32 v153, s28, v153
    v_mfma_f32_16x16x32_bf16 v[52:55], a[244:247], v[236:239], v[52:55]
    v_mul_f32 v154, s28, v154
    v_mul_f32 v155, s28, v155
    v_mul_f32 v224, s26, v224
    v_mfma_f32_16x16x32_bf16 v[56:59], a[248:251], v[236:239], v[56:59]
    v_mul_f32 v225, s26, v225
    v_mul_f32 v226, s26, v226
    v_mfma_f32_16x16x32_bf16 v[36:39], a[252:255], v[236:239], v[36:39]
    v_mul_f32 v227, s26, v227
    v_fmac_f32 v152, s34, v220
    v_mfma_f32_16x16x32_bf16 v[40:43], v[240:243], v[236:239], v[40:43]
    s_waitcnt lgkmcnt(2)
    v_fmac_f32 v153, s34, v221
    v_fmac_f32 v154, s34, v222
    v_fmac_f32 v155, s34, v223
    v_mfma_f32_16x16x32_bf16 v[44:47], v[244:247], v[236:239], v[44:47]
    ds_read_b128 v[236:239], v253 offset:19776
    v_cvt_pk_bf16_f32 v196, v224, v225
    v_mfma_f32_16x16x32_bf16 v[72:75], a[228:231], v[228:231], v[72:75]
    v_cvt_pk_bf16_f32 v197, v226, v227
    v_mfma_f32_16x16x32_bf16 v[76:79], a[232:235], v[228:231], v[76:79]
    ds_write_b64 v249, v[196:197] offset:1600
    v_mfma_f32_16x16x32_bf16 v[80:83], a[236:239], v[228:231], v[80:83]
    v_accvgpr_read_b32 v220, a60
    v_accvgpr_read_b32 v221, a61
    v_mfma_f32_16x16x32_bf16 v[60:63], a[240:243], v[228:231], v[60:63]
    v_accvgpr_read_b32 v222, a62
    v_accvgpr_read_b32 v223, a63
    v_accvgpr_read_b32 v224, a156
    v_mfma_f32_16x16x32_bf16 v[64:67], a[244:247], v[228:231], v[64:67]
    v_accvgpr_read_b32 v225, a157
    v_accvgpr_read_b32 v226, a158
    v_mfma_f32_16x16x32_bf16 v[68:71], a[248:251], v[228:231], v[68:71]
    v_accvgpr_read_b32 v227, a159
    v_sub_f32 v220, v220, v224
    v_sub_f32 v221, v221, v225
    v_mfma_f32_16x16x32_bf16 v[48:51], a[252:255], v[228:231], v[48:51]
    v_sub_f32 v222, v222, v226
    v_sub_f32 v223, v223, v227
    v_mfma_f32_16x16x32_bf16 v[52:55], v[240:243], v[228:231], v[52:55]
    s_waitcnt lgkmcnt(2)
    v_add_f32 v224, v220, v156
    v_add_f32 v225, v221, v157
    v_mfma_f32_16x16x32_bf16 v[56:59], v[244:247], v[228:231], v[56:59]
    ds_read_b128 v[228:231], v253 offset:19504
    v_add_f32 v226, v222, v158
    v_add_f32 v227, v223, v159
    v_mfma_f32_16x16x32_bf16 v[84:87], a[228:231], v[232:235], v[84:87]
    buffer_store_dwordx4 a[120:123], v254, s[12:15], s44 offen sc1
    v_mul_f32 v156, s28, v156
    v_mul_f32 v157, s28, v157
    v_mfma_f32_16x16x32_bf16 v[88:91], a[232:235], v[232:235], v[88:91]
    v_mul_f32 v158, s28, v158
    v_mul_f32 v159, s28, v159
    v_mul_f32 v224, s26, v224
    v_mfma_f32_16x16x32_bf16 v[92:95], a[236:239], v[232:235], v[92:95]
    s_add_u32 s42, s37, 1069056
    v_mul_f32 v225, s26, v225
    v_mul_f32 v226, s26, v226
    v_mfma_f32_16x16x32_bf16 v[72:75], a[240:243], v[232:235], v[72:75]
    buffer_load_dwordx4 a[228:231], v254, s[8:11], s42 offen offset:0 sc1
    v_mfma_f32_16x16x32_bf16 v[76:79], a[244:247], v[232:235], v[76:79]
    v_mul_f32 v227, s26, v227
    v_fmac_f32 v156, s34, v220
    v_fmac_f32 v157, s34, v221
    v_mfma_f32_16x16x32_bf16 v[80:83], a[248:251], v[232:235], v[80:83]
    v_fmac_f32 v158, s34, v222
    v_fmac_f32 v159, s34, v223
    v_mfma_f32_16x16x32_bf16 v[60:63], a[252:255], v[232:235], v[60:63]
    buffer_load_dwordx4 a[232:235], v254, s[8:11], s42 offen offset:1024 sc1
    v_cvt_pk_bf16_f32 v198, v224, v225
    v_mfma_f32_16x16x32_bf16 v[64:67], v[240:243], v[232:235], v[64:67]
    s_waitcnt lgkmcnt(2)
    v_cvt_pk_bf16_f32 v199, v226, v227
    v_accvgpr_read_b32 v220, a64
    v_mfma_f32_16x16x32_bf16 v[68:71], v[244:247], v[232:235], v[68:71]
    s_add_u32 s44, s40, 199680
    v_accvgpr_read_b32 v221, a65
    v_accvgpr_read_b32 v222, a66
    v_mfma_f32_16x16x32_bf16 v[84:87], a[240:243], v[236:239], v[84:87]
    ds_read_b128 v[232:235], v253 offset:21840
    v_accvgpr_read_b32 v223, a67
    v_accvgpr_read_b32 v224, a160
    v_mfma_f32_16x16x32_bf16 v[88:91], a[244:247], v[236:239], v[88:91]
    v_accvgpr_read_b32 v225, a161
    v_accvgpr_read_b32 v226, a162
    v_mfma_f32_16x16x32_bf16 v[92:95], a[248:251], v[236:239], v[92:95]
    buffer_load_dwordx4 a[236:239], v254, s[8:11], s42 offen offset:2048 sc1
    v_accvgpr_read_b32 v227, a163
    v_mfma_f32_16x16x32_bf16 v[72:75], a[252:255], v[236:239], v[72:75]
    s_waitcnt lgkmcnt(1)
    v_sub_f32 v220, v220, v224
    v_sub_f32 v221, v221, v225
    v_mfma_f32_16x16x32_bf16 v[76:79], v[240:243], v[236:239], v[76:79]
    s_add_u32 s42, s37, 1072128
    v_sub_f32 v222, v222, v226
    v_sub_f32 v223, v223, v227
    v_mfma_f32_16x16x32_bf16 v[80:83], v[244:247], v[236:239], v[80:83]
    ds_read_b128 v[236:239], v253 offset:21568
    v_add_f32 v224, v220, v160
    v_add_f32 v225, v221, v161
    v_mfma_f32_16x16x32_bf16 v[84:87], a[252:255], v[228:231], v[84:87]
    buffer_load_dwordx4 a[240:243], v254, s[8:11], s42 offen offset:0 sc1
    v_mfma_f32_16x16x32_bf16 v[88:91], v[240:243], v[228:231], v[88:91]
    s_waitcnt vmcnt(14) lgkmcnt(1)
    v_add_f32 v226, v222, v162
    v_add_f32 v227, v223, v163
    v_mul_f32 v160, s28, v160
    v_mfma_f32_16x16x32_bf16 v[92:95], v[244:247], v[228:231], v[92:95]
    ds_read_b128 v[228:231], v253 offset:21312
    v_mul_f32 v161, s28, v161
    v_mfma_f32_16x16x32_bf16 v[0:3], a[192:195], v[232:235], v[0:3]
    s_waitcnt lgkmcnt(1)
    v_mul_f32 v162, s28, v162
    v_mul_f32 v163, s28, v163
    v_mfma_f32_16x16x32_bf16 v[4:7], a[196:199], v[232:235], v[4:7]
    buffer_load_dwordx4 a[244:247], v254, s[8:11], s42 offen offset:1024 sc1
    v_mul_f32 v224, s26, v224
    v_mfma_f32_16x16x32_bf16 v[8:11], a[200:203], v[232:235], v[8:11]
    ds_read_b128 v[232:235], v253 offset:21056
    v_mul_f32 v225, s26, v225
    v_mfma_f32_16x16x32_bf16 v[12:15], a[192:195], v[236:239], v[12:15]
    v_mul_f32 v226, s26, v226
    v_mul_f32 v227, s26, v227
    v_fmac_f32 v160, s34, v220
    v_mfma_f32_16x16x32_bf16 v[16:19], a[196:199], v[236:239], v[16:19]
    s_waitcnt vmcnt(12)
    v_fmac_f32 v161, s34, v221
    v_fmac_f32 v162, s34, v222
    v_mfma_f32_16x16x32_bf16 v[20:23], a[200:203], v[236:239], v[20:23]
    buffer_load_dwordx4 a[248:251], v254, s[8:11], s42 offen offset:2048 sc1
    v_mfma_f32_16x16x32_bf16 v[0:3], a[204:207], v[236:239], v[0:3]
    s_waitcnt lgkmcnt(1)
    v_fmac_f32 v163, s34, v223
    v_cvt_pk_bf16_f32 v200, v224, v225
    v_cvt_pk_bf16_f32 v201, v226, v227
    v_mfma_f32_16x16x32_bf16 v[4:7], a[208:211], v[236:239], v[4:7]
    s_add_u32 s42, s37, 1075200
    v_mfma_f32_16x16x32_bf16 v[8:11], a[212:215], v[236:239], v[8:11]
    ds_read_b128 v[236:239], v253 offset:20800
    v_mfma_f32_16x16x32_bf16 v[24:27], a[192:195], v[228:231], v[24:27]
    buffer_load_dwordx4 a[252:255], v254, s[8:11], s42 offen offset:0 sc1
    v_mfma_f32_16x16x32_bf16 v[28:31], a[196:199], v[228:231], v[28:31]
    ds_write_b128 v248, v[198:201] offset:1920
    v_mfma_f32_16x16x32_bf16 v[32:35], a[200:203], v[228:231], v[32:35]
    v_accvgpr_read_b32 v220, a68
    v_accvgpr_read_b32 v221, a69
    v_accvgpr_read_b32 v222, a70
    v_mfma_f32_16x16x32_bf16 v[12:15], a[204:207], v[228:231], v[12:15]
    v_accvgpr_read_b32 v223, a71
    v_accvgpr_read_b32 v224, a164
    v_mfma_f32_16x16x32_bf16 v[16:19], a[208:211], v[228:231], v[16:19]
    buffer_load_dwordx4 v[240:243], v254, s[8:11], s42 offen offset:1024 sc1
    v_accvgpr_read_b32 v225, a165
    v_mfma_f32_16x16x32_bf16 v[20:23], a[212:215], v[228:231], v[20:23]
    s_waitcnt vmcnt(12)
    v_accvgpr_read_b32 v226, a166
    v_accvgpr_read_b32 v227, a167
    v_mfma_f32_16x16x32_bf16 v[0:3], a[216:219], v[228:231], v[0:3]
    s_waitcnt lgkmcnt(2)
    v_sub_f32 v220, v220, v224
    v_sub_f32 v221, v221, v225
    v_mfma_f32_16x16x32_bf16 v[4:7], a[220:223], v[228:231], v[4:7]
    buffer_load_dwordx4 v[244:247], v254, s[8:11], s42 offen offset:2048 sc1
    v_sub_f32 v222, v222, v226
    v_mfma_f32_16x16x32_bf16 v[8:11], a[224:227], v[228:231], v[8:11]
    ds_read_b128 v[228:231], v253 offset:22624
    v_sub_f32 v223, v223, v227
    v_mfma_f32_16x16x32_bf16 v[36:39], a[192:195], v[232:235], v[36:39]
    v_add_f32 v224, v220, v164
    v_add_f32 v225, v221, v165
    v_add_f32 v226, v222, v166
    v_mfma_f32_16x16x32_bf16 v[40:43], a[196:199], v[232:235], v[40:43]
    buffer_store_dwordx4 a[124:127], v254, s[12:15], s44 offen sc1
    s_add_u32 s44, s40, 202752
    v_add_f32 v227, v223, v167
    v_mfma_f32_16x16x32_bf16 v[44:47], a[200:203], v[232:235], v[44:47]
    v_mul_f32 v164, s28, v164
    v_mul_f32 v165, s28, v165
    v_mfma_f32_16x16x32_bf16 v[24:27], a[204:207], v[232:235], v[24:27]
    v_mul_f32 v166, s28, v166
    v_mul_f32 v167, s28, v167
    v_mul_f32 v224, s26, v224
    v_mfma_f32_16x16x32_bf16 v[28:31], a[208:211], v[232:235], v[28:31]
    v_mul_f32 v225, s26, v225
    v_mul_f32 v226, s26, v226
    v_mfma_f32_16x16x32_bf16 v[32:35], a[212:215], v[232:235], v[32:35]
    v_mul_f32 v227, s26, v227
    v_fmac_f32 v164, s34, v220
    v_fmac_f32 v165, s34, v221
    v_mfma_f32_16x16x32_bf16 v[12:15], a[216:219], v[232:235], v[12:15]
    v_fmac_f32 v166, s34, v222
    v_fmac_f32 v167, s34, v223
    v_mfma_f32_16x16x32_bf16 v[16:19], a[220:223], v[232:235], v[16:19]
    s_waitcnt lgkmcnt(2)
    v_cvt_pk_bf16_f32 v202, v224, v225
    v_cvt_pk_bf16_f32 v203, v226, v227
    v_mfma_f32_16x16x32_bf16 v[20:23], a[224:227], v[232:235], v[20:23]
    ds_read_b128 v[232:235], v253 offset:22368
    v_mfma_f32_16x16x32_bf16 v[48:51], a[192:195], v[236:239], v[48:51]
    ds_write_b64 v249, v[202:203] offset:1984
    v_mfma_f32_16x16x32_bf16 v[52:55], a[196:199], v[236:239], v[52:55]
    v_accvgpr_read_b32 v220, a72
    v_accvgpr_read_b32 v221, a73
    v_accvgpr_read_b32 v222, a74
    v_mfma_f32_16x16x32_bf16 v[56:59], a[200:203], v[236:239], v[56:59]
    v_accvgpr_read_b32 v223, a75
    v_accvgpr_read_b32 v224, a168
    v_mfma_f32_16x16x32_bf16 v[36:39], a[204:207], v[236:239], v[36:39]
    v_accvgpr_read_b32 v225, a169
    v_accvgpr_read_b32 v226, a170
    v_mfma_f32_16x16x32_bf16 v[40:43], a[208:211], v[236:239], v[40:43]
    buffer_store_dwordx4 a[128:131], v254, s[12:15], s44 offen sc1
    v_accvgpr_read_b32 v227, a171
    v_sub_f32 v220, v220, v224
    v_sub_f32 v221, v221, v225
    v_mfma_f32_16x16x32_bf16 v[44:47], a[212:215], v[236:239], v[44:47]
    v_sub_f32 v222, v222, v226
    v_sub_f32 v223, v223, v227
    v_mfma_f32_16x16x32_bf16 v[24:27], a[216:219], v[236:239], v[24:27]
    v_add_f32 v224, v220, v168
    v_add_f32 v225, v221, v169
    v_add_f32 v226, v222, v170
    v_mfma_f32_16x16x32_bf16 v[28:31], a[220:223], v[236:239], v[28:31]
    s_waitcnt lgkmcnt(2)
    v_add_f32 v227, v223, v171
    v_mul_f32 v168, s28, v168
    v_mfma_f32_16x16x32_bf16 v[32:35], a[224:227], v[236:239], v[32:35]
    ds_read_b128 v[236:239], v253 offset:22112
    v_mul_f32 v169, s28, v169
    v_mfma_f32_16x16x32_bf16 v[60:63], a[192:195], v[228:231], v[60:63]
    v_mul_f32 v170, s28, v170
    v_mul_f32 v171, s28, v171
    v_mul_f32 v224, s26, v224
    v_mfma_f32_16x16x32_bf16 v[64:67], a[196:199], v[228:231], v[64:67]
    v_mul_f32 v225, s26, v225
    v_mul_f32 v226, s26, v226
    v_mfma_f32_16x16x32_bf16 v[68:71], a[200:203], v[228:231], v[68:71]
    v_mul_f32 v227, s26, v227
    v_fmac_f32 v168, s34, v220
    v_fmac_f32 v169, s34, v221
    v_mfma_f32_16x16x32_bf16 v[48:51], a[204:207], v[228:231], v[48:51]
    v_fmac_f32 v170, s34, v222
    v_fmac_f32 v171, s34, v223
    v_mfma_f32_16x16x32_bf16 v[52:55], a[208:211], v[228:231], v[52:55]
    s_add_u32 s44, s40, 205824
    v_cvt_pk_bf16_f32 v192, v224, v225
    v_cvt_pk_bf16_f32 v193, v226, v227
    v_mfma_f32_16x16x32_bf16 v[56:59], a[212:215], v[228:231], v[56:59]
    v_accvgpr_read_b32 v220, a76
    v_accvgpr_read_b32 v221, a77
    v_accvgpr_read_b32 v222, a78
    v_mfma_f32_16x16x32_bf16 v[36:39], a[216:219], v[228:231], v[36:39]
    v_accvgpr_read_b32 v223, a79
    v_accvgpr_read_b32 v224, a172
    v_mfma_f32_16x16x32_bf16 v[40:43], a[220:223], v[228:231], v[40:43]
    s_waitcnt lgkmcnt(2)
    v_accvgpr_read_b32 v225, a173
    v_accvgpr_read_b32 v226, a174
    v_accvgpr_read_b32 v227, a175
    v_mfma_f32_16x16x32_bf16 v[44:47], a[224:227], v[228:231], v[44:47]
    ds_read_b128 v[228:231], v253 offset:21856
    v_sub_f32 v220, v220, v224
    v_mfma_f32_16x16x32_bf16 v[72:75], a[192:195], v[232:235], v[72:75]
    v_sub_f32 v221, v221, v225
    v_sub_f32 v222, v222, v226
    v_mfma_f32_16x16x32_bf16 v[76:79], a[196:199], v[232:235], v[76:79]
    v_sub_f32 v223, v223, v227
    v_add_f32 v224, v220, v172
    v_add_f32 v225, v221, v173
    v_mfma_f32_16x16x32_bf16 v[80:83], a[200:203], v[232:235], v[80:83]
    v_add_f32 v226, v222, v174
    v_add_f32 v227, v223, v175
    v_mfma_f32_16x16x32_bf16 v[60:63], a[204:207], v[232:235], v[60:63]
    v_mul_f32 v172, s28, v172
    v_mul_f32 v173, s28, v173
    v_mul_f32 v174, s28, v174
    v_mfma_f32_16x16x32_bf16 v[64:67], a[208:211], v[232:235], v[64:67]
    v_mul_f32 v175, s28, v175
    v_mul_f32 v224, s26, v224
    v_mfma_f32_16x16x32_bf16 v[68:71], a[212:215], v[232:235], v[68:71]
    v_mul_f32 v225, s26, v225
    v_mul_f32 v226, s26, v226
    v_mfma_f32_16x16x32_bf16 v[48:51], a[216:219], v[232:235], v[48:51]
    v_mul_f32 v227, s26, v227
    v_fmac_f32 v172, s34, v220
    v_fmac_f32 v173, s34, v221
    v_mfma_f32_16x16x32_bf16 v[52:55], a[220:223], v[232:235], v[52:55]
    s_waitcnt lgkmcnt(1)
    v_fmac_f32 v174, s34, v222
    v_fmac_f32 v175, s34, v223
    v_mfma_f32_16x16x32_bf16 v[56:59], a[224:227], v[232:235], v[56:59]
    ds_read_b128 v[232:235], v253 offset:21584
    v_cvt_pk_bf16_f32 v194, v224, v225
    v_cvt_pk_bf16_f32 v195, v226, v227
    v_mfma_f32_16x16x32_bf16 v[84:87], a[192:195], v[236:239], v[84:87]
    ds_write_b128 v248, v[192:195] offset:2304
    v_mfma_f32_16x16x32_bf16 v[88:91], a[196:199], v[236:239], v[88:91]
    v_accvgpr_read_b32 v220, a80
    v_accvgpr_read_b32 v221, a81
    v_mfma_f32_16x16x32_bf16 v[92:95], a[200:203], v[236:239], v[92:95]
    s_add_u32 s42, s36, 1105920
    v_accvgpr_read_b32 v222, a82
    v_accvgpr_read_b32 v223, a83
    v_accvgpr_read_b32 v224, a176
    v_mfma_f32_16x16x32_bf16 v[72:75], a[204:207], v[236:239], v[72:75]
    buffer_load_dwordx4 a[192:195], v254, s[8:11], s42 offen offset:0 sc1
    v_mfma_f32_16x16x32_bf16 v[76:79], a[208:211], v[236:239], v[76:79]
    v_accvgpr_read_b32 v225, a177
    v_accvgpr_read_b32 v226, a178
    v_accvgpr_read_b32 v227, a179
    v_mfma_f32_16x16x32_bf16 v[80:83], a[212:215], v[236:239], v[80:83]
    s_waitcnt lgkmcnt(2)
    v_sub_f32 v220, v220, v224
    v_sub_f32 v221, v221, v225
    v_mfma_f32_16x16x32_bf16 v[60:63], a[216:219], v[236:239], v[60:63]
    buffer_load_dwordx4 a[196:199], v254, s[8:11], s42 offen offset:1024 sc1
    v_mfma_f32_16x16x32_bf16 v[64:67], a[220:223], v[236:239], v[64:67]
    s_waitcnt lgkmcnt(0)
    v_sub_f32 v222, v222, v226
    v_sub_f32 v223, v223, v227
    v_add_f32 v224, v220, v176
    v_mfma_f32_16x16x32_bf16 v[68:71], a[224:227], v[236:239], v[68:71]
    s_barrier
    v_mfma_f32_16x16x32_bf16 v[84:87], a[204:207], v[228:231], v[84:87]
    ds_read_b128 v[236:239], v253 offset:23920
    v_add_f32 v225, v221, v177
    v_add_f32 v226, v222, v178
    v_mfma_f32_16x16x32_bf16 v[88:91], a[208:211], v[228:231], v[88:91]
    ds_read_b128 a[136:139], v250 offset:1024
    v_add_f32 v227, v223, v179
    v_mfma_f32_16x16x32_bf16 v[92:95], a[212:215], v[228:231], v[92:95]
    buffer_load_dwordx4 a[200:203], v254, s[8:11], s42 offen offset:2048 sc1
    v_mfma_f32_16x16x32_bf16 v[72:75], a[216:219], v[228:231], v[72:75]
    v_mul_f32 v176, s28, v176
    v_mul_f32 v177, s28, v177
    v_mul_f32 v178, s28, v178
    v_mfma_f32_16x16x32_bf16 v[76:79], a[220:223], v[228:231], v[76:79]
    s_add_u32 s42, s36, 1108992
    v_mul_f32 v179, s28, v179
    v_mul_f32 v224, s26, v224
    v_mfma_f32_16x16x32_bf16 v[80:83], a[224:227], v[228:231], v[80:83]
    ds_read_b128 v[228:231], v253 offset:23648
    v_mul_f32 v225, s26, v225
    v_mul_f32 v226, s26, v226
    v_mfma_f32_16x16x32_bf16 v[84:87], a[216:219], v[232:235], v[84:87]
    buffer_load_dwordx4 a[204:207], v254, s[8:11], s42 offen offset:0 sc1
    v_mfma_f32_16x16x32_bf16 v[88:91], a[220:223], v[232:235], v[88:91]
    s_waitcnt vmcnt(12) lgkmcnt(2)
    v_mul_f32 v227, s26, v227
    v_fmac_f32 v176, s34, v220
    v_mfma_f32_16x16x32_bf16 v[92:95], a[224:227], v[232:235], v[92:95]
    ds_read_b128 v[232:235], v253 offset:23392
    v_fmac_f32 v177, s34, v221
    v_fmac_f32 v178, s34, v222
    v_mfma_f32_16x16x32_bf16 v[0:3], a[228:231], v[236:239], v[0:3]
    ds_read_b128 a[140:143], v250 offset:4128
    v_fmac_f32 v179, s34, v223
    v_mfma_f32_16x16x32_bf16 v[4:7], a[232:235], v[236:239], v[4:7]
    buffer_load_dwordx4 a[208:211], v254, s[8:11], s42 offen offset:1024 sc1
    v_cvt_pk_bf16_f32 v196, v224, v225
    v_mfma_f32_16x16x32_bf16 v[8:11], a[236:239], v[236:239], v[8:11]
    ds_read_b128 v[236:239], v253 offset:23136
    v_cvt_pk_bf16_f32 v197, v226, v227
    s_waitcnt lgkmcnt(3)
    v_mfma_f32_16x16x32_bf16 v[12:15], a[228:231], v[228:231], v[12:15]
    ds_write_b64 v249, v[196:197] offset:2368
    v_mfma_f32_16x16x32_bf16 v[16:19], a[232:235], v[228:231], v[16:19]
    s_waitcnt vmcnt(10) lgkmcnt(3)
    v_accvgpr_read_b32 v220, a84
    v_accvgpr_read_b32 v221, a85
    v_accvgpr_read_b32 v222, a86
    v_mfma_f32_16x16x32_bf16 v[20:23], a[236:239], v[228:231], v[20:23]
    buffer_load_dwordx4 a[212:215], v254, s[8:11], s42 offen offset:2048 sc1
    v_mfma_f32_16x16x32_bf16 v[0:3], a[240:243], v[228:231], v[0:3]
    ds_read_b128 a[144:147], v250 offset:7232
    v_accvgpr_read_b32 v223, a87
    v_accvgpr_read_b32 v224, a180
    v_mfma_f32_16x16x32_bf16 v[4:7], a[244:247], v[228:231], v[4:7]
    s_add_u32 s42, s36, 1112064
    v_accvgpr_read_b32 v225, a181
    v_accvgpr_read_b32 v226, a182
    v_mfma_f32_16x16x32_bf16 v[8:11], a[248:251], v[228:231], v[8:11]
    ds_read_b128 v[228:231], v253 offset:22880
    v_accvgpr_read_b32 v227, a183
    v_mfma_f32_16x16x32_bf16 v[24:27], a[228:231], v[232:235], v[24:27]
    buffer_load_dwordx4 a[216:219], v254, s[8:11], s42 offen offset:0 sc1
    v_sub_f32 v220, v220, v224
    v_mfma_f32_16x16x32_bf16 v[28:31], a[232:235], v[232:235], v[28:31]
    v_sub_f32 v221, v221, v225
    v_sub_f32 v222, v222, v226
    v_mfma_f32_16x16x32_bf16 v[32:35], a[236:239], v[232:235], v[32:35]
    v_sub_f32 v223, v223, v227
    v_add_f32 v224, v220, v180
    v_add_f32 v225, v221, v181
    v_mfma_f32_16x16x32_bf16 v[12:15], a[240:243], v[232:235], v[12:15]
    s_waitcnt vmcnt(9)
    v_add_f32 v226, v222, v182
    v_add_f32 v227, v223, v183
    v_mfma_f32_16x16x32_bf16 v[16:19], a[244:247], v[232:235], v[16:19]
    buffer_load_dwordx4 a[220:223], v254, s[8:11], s42 offen offset:1024 sc1
    v_mfma_f32_16x16x32_bf16 v[20:23], a[248:251], v[232:235], v[20:23]
    ds_read_b128 a[148:151], v250 offset:10336
    v_mul_f32 v180, s28, v180
    v_mul_f32 v181, s28, v181
    v_mfma_f32_16x16x32_bf16 v[0:3], a[252:255], v[232:235], v[0:3]
    s_waitcnt lgkmcnt(4)
    v_mul_f32 v182, s28, v182
    v_mul_f32 v183, s28, v183
    v_mfma_f32_16x16x32_bf16 v[4:7], v[240:243], v[232:235], v[4:7]
    buffer_load_dwordx4 a[224:227], v254, s[8:11], s42 offen offset:2048 sc1
    v_mul_f32 v224, s26, v224
    v_mfma_f32_16x16x32_bf16 v[8:11], v[244:247], v[232:235], v[8:11]
    ds_read_b128 v[232:235], v253 offset:24704
    v_and_b32 v215, 0x7fff, v255
    v_mfma_f32_16x16x32_bf16 v[36:39], a[228:231], v[236:239], v[36:39]
    v_mul_f32 v225, s26, v225
    v_mul_f32 v226, s26, v226
    v_mfma_f32_16x16x32_bf16 v[40:43], a[232:235], v[236:239], v[40:43]
    buffer_load_dwordx2 v[204:205], v215, s[4:7], s16 offen offset:0
    v_mul_f32 v227, s26, v227
    v_mfma_f32_16x16x32_bf16 v[44:47], a[236:239], v[236:239], v[44:47]
    v_fmac_f32 v180, s34, v220
    v_fmac_f32 v181, s34, v221
    v_mfma_f32_16x16x32_bf16 v[24:27], a[240:243], v[236:239], v[24:27]
    v_fmac_f32 v182, s34, v222
    v_fmac_f32 v183, s34, v223
    v_cvt_pk_bf16_f32 v198, v224, v225
    v_mfma_f32_16x16x32_bf16 v[28:31], a[244:247], v[236:239], v[28:31]
    buffer_load_dwordx2 v[206:207], v215, s[4:7], s17 offen offset:0
    v_mfma_f32_16x16x32_bf16 v[32:35], a[248:251], v[236:239], v[32:35]
    v_cvt_pk_bf16_f32 v199, v226, v227
    v_accvgpr_read_b32 v220, a88
    v_mfma_f32_16x16x32_bf16 v[12:15], a[252:255], v[236:239], v[12:15]
    s_waitcnt lgkmcnt(2)
    v_accvgpr_read_b32 v221, a89
    v_accvgpr_read_b32 v222, a90
    v_accvgpr_read_b32 v223, a91
    v_mfma_f32_16x16x32_bf16 v[16:19], v[240:243], v[236:239], v[16:19]
    buffer_load_dwordx2 v[208:209], v215, s[4:7], s18 offen offset:0
    v_mfma_f32_16x16x32_bf16 v[20:23], v[244:247], v[236:239], v[20:23]
    ds_read_b128 v[236:239], v253 offset:24448
    v_accvgpr_read_b32 v224, a184
    v_accvgpr_read_b32 v225, a185
    v_mfma_f32_16x16x32_bf16 v[48:51], a[228:231], v[228:231], v[48:51]
    v_accvgpr_read_b32 v226, a186
    v_accvgpr_read_b32 v227, a187
    v_mfma_f32_16x16x32_bf16 v[52:55], a[232:235], v[228:231], v[52:55]
    buffer_load_dwordx2 v[210:211], v215, s[4:7], s19 offen offset:0
    v_mfma_f32_16x16x32_bf16 v[56:59], a[236:239], v[228:231], v[56:59]
    v_sub_f32 v220, v220, v224
    v_sub_f32 v221, v221, v225
    v_sub_f32 v222, v222, v226
    v_mfma_f32_16x16x32_bf16 v[36:39], a[240:243], v[228:231], v[36:39]
    v_sub_f32 v223, v223, v227
    v_add_f32 v224, v220, v184
    v_mfma_f32_16x16x32_bf16 v[40:43], a[244:247], v[228:231], v[40:43]
    buffer_load_dwordx2 v[212:213], v215, s[4:7], s20 offen offset:0
    v_add_f32 v225, v221, v185
    v_mfma_f32_16x16x32_bf16 v[44:47], a[248:251], v[228:231], v[44:47]
    v_add_f32 v226, v222, v186
    v_add_f32 v227, v223, v187
    v_mfma_f32_16x16x32_bf16 v[24:27], a[252:255], v[228:231], v[24:27]
    s_waitcnt lgkmcnt(1)
    v_mul_f32 v184, s28, v184
    v_mul_f32 v185, s28, v185
    v_mfma_f32_16x16x32_bf16 v[28:31], v[240:243], v[228:231], v[28:31]
    buffer_load_dwordx2 v[214:215], v215, s[4:7], s21 offen offset:0
    v_mul_f32 v186, s28, v186
    v_mfma_f32_16x16x32_bf16 v[32:35], v[244:247], v[228:231], v[32:35]
    ds_read_b128 v[228:231], v253 offset:24192
    v_mul_f32 v187, s28, v187
    v_mfma_f32_16x16x32_bf16 v[60:63], a[228:231], v[232:235], v[60:63]
    v_mul_f32 v224, s26, v224
    v_mul_f32 v225, s26, v225
    v_mul_f32 v226, s26, v226
    v_mfma_f32_16x16x32_bf16 v[64:67], a[232:235], v[232:235], v[64:67]
    buffer_store_dwordx4 a[132:135], v254, s[12:15], s44 offen sc1
    s_add_u32 s44, s40, 197632
    v_mfma_f32_16x16x32_bf16 v[68:71], a[236:239], v[232:235], v[68:71]
    v_mul_f32 v227, s26, v227
    v_fmac_f32 v184, s34, v220
    v_mfma_f32_16x16x32_bf16 v[48:51], a[240:243], v[232:235], v[48:51]
    v_fmac_f32 v185, s34, v221
    v_fmac_f32 v186, s34, v222
    v_fmac_f32 v187, s34, v223
    v_mfma_f32_16x16x32_bf16 v[52:55], a[244:247], v[232:235], v[52:55]
    buffer_store_dwordx4 a[136:139], v254, s[12:15], s44 offen sc1
    s_add_u32 s44, s40, 200704
    v_mfma_f32_16x16x32_bf16 v[56:59], a[248:251], v[232:235], v[56:59]
    s_waitcnt lgkmcnt(1)
    v_cvt_pk_bf16_f32 v200, v224, v225
    v_cvt_pk_bf16_f32 v201, v226, v227
    v_mfma_f32_16x16x32_bf16 v[36:39], a[252:255], v[232:235], v[36:39]
    ds_write_b128 v248, v[198:201] offset:2688
    v_mfma_f32_16x16x32_bf16 v[40:43], v[240:243], v[232:235], v[40:43]
    buffer_store_dwordx4 a[140:143], v254, s[12:15], s44 offen sc1
    s_add_u32 s44, s40, 203776
    v_accvgpr_read_b32 v220, a92
    v_mfma_f32_16x16x32_bf16 v[44:47], v[244:247], v[232:235], v[44:47]
    ds_read_b128 v[232:235], v253 offset:23936
    v_accvgpr_read_b32 v221, a93
    v_accvgpr_read_b32 v222, a94
    v_mfma_f32_16x16x32_bf16 v[72:75], a[228:231], v[236:239], v[72:75]
    v_accvgpr_read_b32 v223, a95
    v_accvgpr_read_b32 v224, a188
    v_mfma_f32_16x16x32_bf16 v[76:79], a[232:235], v[236:239], v[76:79]
    v_accvgpr_read_b32 v225, a189
    v_accvgpr_read_b32 v226, a190
    v_accvgpr_read_b32 v227, a191
    v_mfma_f32_16x16x32_bf16 v[80:83], a[236:239], v[236:239], v[80:83]
    v_sub_f32 v220, v220, v224
    v_sub_f32 v221, v221, v225
    v_mfma_f32_16x16x32_bf16 v[60:63], a[240:243], v[236:239], v[60:63]
    v_sub_f32 v222, v222, v226
    v_sub_f32 v223, v223, v227
    v_mfma_f32_16x16x32_bf16 v[64:67], a[244:247], v[236:239], v[64:67]
    v_add_f32 v224, v220, v188
    v_add_f32 v225, v221, v189
    v_add_f32 v226, v222, v190
    v_mfma_f32_16x16x32_bf16 v[68:71], a[248:251], v[236:239], v[68:71]
    v_add_f32 v227, v223, v191
    v_mul_f32 v188, s28, v188
    v_mfma_f32_16x16x32_bf16 v[48:51], a[252:255], v[236:239], v[48:51]
    v_mul_f32 v189, s28, v189
    v_mul_f32 v190, s28, v190
    v_mul_f32 v191, s28, v191
    v_mfma_f32_16x16x32_bf16 v[52:55], v[240:243], v[236:239], v[52:55]
    s_waitcnt lgkmcnt(2)
    v_mul_f32 v224, s26, v224
    v_mul_f32 v225, s26, v225
    v_mfma_f32_16x16x32_bf16 v[56:59], v[244:247], v[236:239], v[56:59]
    ds_read_b128 v[236:239], v253 offset:23664
    v_mul_f32 v226, s26, v226
    v_mfma_f32_16x16x32_bf16 v[84:87], a[228:231], v[228:231], v[84:87]
    v_mul_f32 v227, s26, v227
    v_fmac_f32 v188, s34, v220
    v_fmac_f32 v189, s34, v221
    v_mfma_f32_16x16x32_bf16 v[88:91], a[232:235], v[228:231], v[88:91]
    v_fmac_f32 v190, s34, v222
    v_fmac_f32 v191, s34, v223
    v_mfma_f32_16x16x32_bf16 v[92:95], a[236:239], v[228:231], v[92:95]
    s_add_u32 s42, s36, 1142784
    v_cvt_pk_bf16_f32 v202, v224, v225
    v_cvt_pk_bf16_f32 v203, v226, v227
    v_mfma_f32_16x16x32_bf16 v[72:75], a[240:243], v[228:231], v[72:75]
    buffer_load_dwordx4 a[228:231], v254, s[8:11], s42 offen offset:0 sc1
    v_mfma_f32_16x16x32_bf16 v[76:79], a[244:247], v[228:231], v[76:79]
    ds_write_b64 v249, v[202:203] offset:2752
    v_mfma_f32_16x16x32_bf16 v[80:83], a[248:251], v[228:231], v[80:83]
    s_waitcnt lgkmcnt(2)
    v_mfma_f32_16x16x32_bf16 v[60:63], a[252:255], v[228:231], v[60:63]
    buffer_load_dwordx4 a[232:235], v254, s[8:11], s42 offen offset:1024 sc1
    v_mfma_f32_16x16x32_bf16 v[64:67], v[240:243], v[228:231], v[64:67]
    s_waitcnt lgkmcnt(0)
    v_mfma_f32_16x16x32_bf16 v[68:71], v[244:247], v[228:231], v[68:71]
    s_barrier
    v_mfma_f32_16x16x32_bf16 v[84:87], a[240:243], v[232:235], v[84:87]
    ds_read_b128 v[228:231], v253 offset:36400
    v_mfma_f32_16x16x32_bf16 v[88:91], a[244:247], v[232:235], v[88:91]
    ds_read_b128 a[152:155], v250 offset:2048
    v_cvt_pk_bf16_f32 v8, v8, v9
    v_cvt_pk_bf16_f32 v9, v10, v11
    v_mfma_f32_16x16x32_bf16 v[92:95], a[248:251], v[232:235], v[92:95]
    buffer_load_dwordx4 a[236:239], v254, s[8:11], s42 offen offset:2048 sc1
    v_mfma_f32_16x16x32_bf16 v[72:75], a[252:255], v[232:235], v[72:75]
    ds_write_b64 v249, v[8:9] offset:12544
    v_cvt_pk_bf16_f32 v0, v0, v1
    v_cvt_pk_bf16_f32 v1, v2, v3
    v_mfma_f32_16x16x32_bf16 v[76:79], v[240:243], v[232:235], v[76:79]
    s_add_u32 s42, s36, 1145856
    v_cvt_pk_bf16_f32 v2, v4, v5
    v_cvt_pk_bf16_f32 v3, v6, v7
    v_mfma_f32_16x16x32_bf16 v[80:83], v[244:247], v[232:235], v[80:83]
    ds_read_b128 v[232:235], v253 offset:36128
    v_mfma_f32_16x16x32_bf16 v[84:87], a[252:255], v[236:239], v[84:87]
    buffer_load_dwordx4 a[240:243], v254, s[8:11], s42 offen offset:0 sc1
    v_mfma_f32_16x16x32_bf16 v[88:91], v[240:243], v[236:239], v[88:91]
    ds_write_b128 v248, v[0:3] offset:12480
    v_mov_b32 v4, v248
    v_mov_b32 v5, v249
    v_mfma_f32_16x16x32_bf16 v[92:95], v[244:247], v[236:239], v[92:95]
    ds_read_b128 v[236:239], v253 offset:35872
    v_mov_b32 v6, v250
    v_cvt_pk_bf16_f32 v20, v20, v21
    v_cvt_pk_bf16_f32 v21, v22, v23
    s_waitcnt vmcnt(19)
    s_waitcnt lgkmcnt(5)
    v_mfma_f32_16x16x32_bf16 v[96:99], a[192:195], v[228:231], v[96:99]
    s_waitcnt lgkmcnt(2)
    v_mfma_f32_16x16x32_bf16 v[100:103], a[196:199], v[228:231], v[100:103]
    buffer_load_dwordx4 a[244:247], v254, s[8:11], s42 offen offset:1024 sc1
    v_mfma_f32_16x16x32_bf16 v[104:107], a[200:203], v[228:231], v[104:107]
    ds_read_b128 v[228:231], v253 offset:35616
    v_mfma_f32_16x16x32_bf16 v[108:111], a[192:195], v[232:235], v[108:111]
    ds_read_b128 a[156:159], v250 offset:5152
    v_mfma_f32_16x16x32_bf16 v[112:115], a[196:199], v[232:235], v[112:115]
    ds_write_b64 v249, v[20:21] offset:12928
    v_cvt_pk_bf16_f32 v12, v12, v13
    v_cvt_pk_bf16_f32 v13, v14, v15
    v_mfma_f32_16x16x32_bf16 v[116:119], a[200:203], v[232:235], v[116:119]
    buffer_load_dwordx4 a[248:251], v254, s[8:11], s42 offen offset:2048 sc1
    v_cvt_pk_bf16_f32 v14, v16, v17
    v_cvt_pk_bf16_f32 v15, v18, v19
    s_waitcnt vmcnt(18)
    v_mfma_f32_16x16x32_bf16 v[96:99], a[204:207], v[232:235], v[96:99]
    ds_write_b128 v248, v[12:15] offset:12864
    v_cvt_pk_bf16_f32 v32, v32, v33
    v_mfma_f32_16x16x32_bf16 v[100:103], a[208:211], v[232:235], v[100:103]
    s_add_u32 s42, s36, 1148928
    v_cvt_pk_bf16_f32 v33, v34, v35
    v_mfma_f32_16x16x32_bf16 v[104:107], a[212:215], v[232:235], v[104:107]
    ds_read_b128 v[232:235], v253 offset:35360
    s_waitcnt lgkmcnt(5)
    v_mfma_f32_16x16x32_bf16 v[120:123], a[192:195], v[236:239], v[120:123]
    buffer_load_dwordx4 a[252:255], v254, s[8:11], s42 offen offset:0 sc1
    v_mfma_f32_16x16x32_bf16 v[124:127], a[196:199], v[236:239], v[124:127]
    ds_write_b64 v249, v[32:33] offset:13312
    v_cvt_pk_bf16_f32 v24, v24, v25
    v_mfma_f32_16x16x32_bf16 v[128:131], a[200:203], v[236:239], v[128:131]
    ds_read_b128 a[160:163], v250 offset:8256
    v_cvt_pk_bf16_f32 v25, v26, v27
    v_cvt_pk_bf16_f32 v26, v28, v29
    v_cvt_pk_bf16_f32 v27, v30, v31
    v_mfma_f32_16x16x32_bf16 v[108:111], a[204:207], v[236:239], v[108:111]
    ds_write_b128 v248, v[24:27] offset:13248
    v_cvt_pk_bf16_f32 v44, v44, v45
    v_cvt_pk_bf16_f32 v45, v46, v47
    v_mfma_f32_16x16x32_bf16 v[112:115], a[208:211], v[236:239], v[112:115]
    buffer_load_dwordx4 v[240:243], v254, s[8:11], s42 offen offset:1024 sc1
    v_mfma_f32_16x16x32_bf16 v[116:119], a[212:215], v[236:239], v[116:119]
    s_waitcnt vmcnt(17)
    v_mfma_f32_16x16x32_bf16 v[96:99], a[216:219], v[236:239], v[96:99]
    s_waitcnt lgkmcnt(7)
    v_mfma_f32_16x16x32_bf16 v[100:103], a[220:223], v[236:239], v[100:103]
    buffer_load_dwordx4 v[244:247], v254, s[8:11], s42 offen offset:2048 sc1
    v_mfma_f32_16x16x32_bf16 v[104:107], a[224:227], v[236:239], v[104:107]
    ds_read_b128 v[236:239], v253 offset:37184
    v_and_b32 v227, 0x7fff, v255
    v_mfma_f32_16x16x32_bf16 v[132:135], a[192:195], v[228:231], v[132:135]
    ds_write_b64 v249, v[44:45] offset:13696
    v_cvt_pk_bf16_f32 v36, v36, v37
    v_cvt_pk_bf16_f32 v37, v38, v39
    v_mfma_f32_16x16x32_bf16 v[136:139], a[196:199], v[228:231], v[136:139]
    buffer_load_dwordx2 v[216:217], v227, s[4:7], s16 offen offset:384
    v_cvt_pk_bf16_f32 v38, v40, v41
    v_cvt_pk_bf16_f32 v39, v42, v43
    v_mfma_f32_16x16x32_bf16 v[140:143], a[200:203], v[228:231], v[140:143]
    ds_read_b128 a[164:167], v250 offset:11360
    v_mfma_f32_16x16x32_bf16 v[120:123], a[204:207], v[228:231], v[120:123]
    ds_write_b128 v248, v[36:39] offset:13632
    v_cvt_pk_bf16_f32 v56, v56, v57
    v_cvt_pk_bf16_f32 v57, v58, v59
    v_mfma_f32_16x16x32_bf16 v[124:127], a[208:211], v[228:231], v[124:127]
    buffer_load_dwordx2 v[218:219], v227, s[4:7], s17 offen offset:384
    v_mfma_f32_16x16x32_bf16 v[128:131], a[212:215], v[228:231], v[128:131]
    v_mfma_f32_16x16x32_bf16 v[108:111], a[216:219], v[228:231], v[108:111]
    s_waitcnt lgkmcnt(7)
    v_mfma_f32_16x16x32_bf16 v[112:115], a[220:223], v[228:231], v[112:115]
    buffer_load_dwordx2 v[220:221], v227, s[4:7], s18 offen offset:384
    v_mfma_f32_16x16x32_bf16 v[116:119], a[224:227], v[228:231], v[116:119]
    ds_read_b128 v[228:231], v253 offset:36928
    v_mfma_f32_16x16x32_bf16 v[144:147], a[192:195], v[232:235], v[144:147]
    ds_write_b64 v249, v[56:57] offset:14080
    v_cvt_pk_bf16_f32 v48, v48, v49
    v_cvt_pk_bf16_f32 v49, v50, v51
    v_mfma_f32_16x16x32_bf16 v[148:151], a[196:199], v[232:235], v[148:151]
    buffer_load_dwordx2 v[222:223], v227, s[4:7], s19 offen offset:384
    v_cvt_pk_bf16_f32 v50, v52, v53
    v_cvt_pk_bf16_f32 v51, v54, v55
    v_mfma_f32_16x16x32_bf16 v[152:155], a[200:203], v[232:235], v[152:155]
    ds_write_b128 v248, v[48:51] offset:14016
    v_cvt_pk_bf16_f32 v68, v68, v69
    v_cvt_pk_bf16_f32 v69, v70, v71
    v_mfma_f32_16x16x32_bf16 v[132:135], a[204:207], v[232:235], v[132:135]
    v_mfma_f32_16x16x32_bf16 v[136:139], a[208:211], v[232:235], v[136:139]
    buffer_load_dwordx2 v[224:225], v227, s[4:7], s20 offen offset:384
    v_mfma_f32_16x16x32_bf16 v[140:143], a[212:215], v[232:235], v[140:143]
    s_waitcnt lgkmcnt(6)
    v_mfma_f32_16x16x32_bf16 v[120:123], a[216:219], v[232:235], v[120:123]
    ds_write_b64 v249, v[68:69] offset:14464
    v_cvt_pk_bf16_f32 v60, v60, v61
    v_mfma_f32_16x16x32_bf16 v[124:127], a[220:223], v[232:235], v[124:127]
    buffer_load_dwordx2 v[226:227], v227, s[4:7], s21 offen offset:384
    v_cvt_pk_bf16_f32 v61, v62, v63
    v_cvt_pk_bf16_f32 v62, v64, v65
    v_mfma_f32_16x16x32_bf16 v[128:131], a[224:227], v[232:235], v[128:131]
    ds_read_b128 v[232:235], v253 offset:36672
    v_cvt_pk_bf16_f32 v63, v66, v67
    v_mfma_f32_16x16x32_bf16 v[156:159], a[192:195], v[236:239], v[156:159]
    ds_write_b128 v248, v[60:63] offset:14400
    v_cvt_pk_bf16_f32 v80, v80, v81
    v_mfma_f32_16x16x32_bf16 v[160:163], a[196:199], v[236:239], v[160:163]
    buffer_store_dwordx4 a[144:147], v254, s[12:15], s44 offen sc1
    s_add_u32 s44, s40, 206848
    v_cvt_pk_bf16_f32 v81, v82, v83
    v_mfma_f32_16x16x32_bf16 v[164:167], a[200:203], v[236:239], v[164:167]
    v_mfma_f32_16x16x32_bf16 v[144:147], a[204:207], v[236:239], v[144:147]
    v_mfma_f32_16x16x32_bf16 v[148:151], a[208:211], v[236:239], v[148:151]
    buffer_store_dwordx4 a[148:151], v254, s[12:15], s44 offen sc1
    s_add_u32 s44, s40, 198656
    v_mfma_f32_16x16x32_bf16 v[152:155], a[212:215], v[236:239], v[152:155]
    ds_write_b64 v249, v[80:81] offset:14848
    v_cvt_pk_bf16_f32 v72, v72, v73
    v_cvt_pk_bf16_f32 v73, v74, v75
    v_mfma_f32_16x16x32_bf16 v[132:135], a[216:219], v[236:239], v[132:135]
    s_waitcnt lgkmcnt(6)
    v_cvt_pk_bf16_f32 v74, v76, v77
    v_cvt_pk_bf16_f32 v75, v78, v79
    v_mfma_f32_16x16x32_bf16 v[136:139], a[220:223], v[236:239], v[136:139]
    buffer_store_dwordx4 a[152:155], v254, s[12:15], s44 offen sc1
    v_mfma_f32_16x16x32_bf16 v[140:143], a[224:227], v[236:239], v[140:143]
    ds_read_b128 v[236:239], v253 offset:36416
    v_mfma_f32_16x16x32_bf16 v[168:171], a[192:195], v[228:231], v[168:171]
    ds_write_b128 v248, v[72:75] offset:14784
    v_cvt_pk_bf16_f32 v92, v92, v93
    v_cvt_pk_bf16_f32 v93, v94, v95
    v_mfma_f32_16x16x32_bf16 v[172:175], a[196:199], v[228:231], v[172:175]
    s_add_u32 s44, s40, 201728
    v_mfma_f32_16x16x32_bf16 v[176:179], a[200:203], v[228:231], v[176:179]
    v_mfma_f32_16x16x32_bf16 v[156:159], a[204:207], v[228:231], v[156:159]
    v_mfma_f32_16x16x32_bf16 v[160:163], a[208:211], v[228:231], v[160:163]
    ds_write_b64 v249, v[92:93] offset:15232
    v_cvt_pk_bf16_f32 v84, v84, v85
    v_cvt_pk_bf16_f32 v85, v86, v87
    v_mfma_f32_16x16x32_bf16 v[164:167], a[212:215], v[228:231], v[164:167]
    v_cvt_pk_bf16_f32 v86, v88, v89
    v_cvt_pk_bf16_f32 v87, v90, v91
    v_mfma_f32_16x16x32_bf16 v[144:147], a[216:219], v[228:231], v[144:147]
    ds_write_b128 v248, v[84:87] offset:15168
    v_mfma_f32_16x16x32_bf16 v[148:151], a[220:223], v[228:231], v[148:151]
    s_waitcnt lgkmcnt(6)
    v_mfma_f32_16x16x32_bf16 v[152:155], a[224:227], v[228:231], v[152:155]
    ds_read_b128 v[228:231], v253 offset:36144
    v_mfma_f32_16x16x32_bf16 v[180:183], a[192:195], v[232:235], v[180:183]
    v_mfma_f32_16x16x32_bf16 v[184:187], a[196:199], v[232:235], v[184:187]
    v_mfma_f32_16x16x32_bf16 v[188:191], a[200:203], v[232:235], v[188:191]
    s_add_u32 s42, s36, 1179648
    v_mfma_f32_16x16x32_bf16 v[168:171], a[204:207], v[232:235], v[168:171]
    buffer_load_dwordx4 a[192:195], v254, s[8:11], s42 offen offset:0 sc1
    v_mfma_f32_16x16x32_bf16 v[172:175], a[208:211], v[232:235], v[172:175]
    v_mfma_f32_16x16x32_bf16 v[176:179], a[212:215], v[232:235], v[176:179]
    s_waitcnt lgkmcnt(4)
    v_mfma_f32_16x16x32_bf16 v[156:159], a[216:219], v[232:235], v[156:159]
    buffer_load_dwordx4 a[196:199], v254, s[8:11], s42 offen offset:1024 sc1
    v_mfma_f32_16x16x32_bf16 v[160:163], a[220:223], v[232:235], v[160:163]
    s_waitcnt lgkmcnt(0)
    s_waitcnt vmcnt(23)
    v_lshlrev_b32 v248, 16, v206
    v_mfma_f32_16x16x32_bf16 v[164:167], a[224:227], v[232:235], v[164:167]
    s_barrier
    v_mfma_f32_16x16x32_bf16 v[180:183], a[204:207], v[236:239], v[180:183]
    ds_read_b128 v[232:235], v253 offset:38480
    v_lshlrev_b32 v249, 16, v208
    v_lshlrev_b32 v250, 16, v210
    v_mfma_f32_16x16x32_bf16 v[184:187], a[208:211], v[236:239], v[184:187]
    ds_read_b128 a[0:3], v6 offset:12480
    v_lshlrev_b32 v251, 16, v212
    v_mfma_f32_16x16x32_bf16 v[188:191], a[212:215], v[236:239], v[188:191]
    buffer_load_dwordx4 a[200:203], v254, s[8:11], s42 offen offset:2048 sc1
    v_mfma_f32_16x16x32_bf16 v[168:171], a[216:219], v[236:239], v[168:171]
    v_and_b32 v206, s22, v206
    v_and_b32 v208, s22, v208
    v_and_b32 v210, s22, v210
    v_mfma_f32_16x16x32_bf16 v[172:175], a[220:223], v[236:239], v[172:175]
    s_add_u32 s42, s36, 1182720
    v_and_b32 v212, s22, v212
    v_lshlrev_b32 v252, 16, v204
    v_mfma_f32_16x16x32_bf16 v[176:179], a[224:227], v[236:239], v[176:179]
    ds_read_b128 v[236:239], v253 offset:38208
    v_and_b32 v204, s22, v204
    v_mfma_f32_16x16x32_bf16 v[180:183], a[216:219], v[228:231], v[180:183]
    buffer_load_dwordx4 a[204:207], v254, s[8:11], s42 offen offset:0 sc1
    v_add_f32 v252, v252, v251
    v_mfma_f32_16x16x32_bf16 v[184:187], a[220:223], v[228:231], v[184:187]
    s_waitcnt vmcnt(19) lgkmcnt(2)
    v_add_f32 v204, v204, v212
    v_fmac_f32 v252, s23, v249
    v_mfma_f32_16x16x32_bf16 v[188:191], a[224:227], v[228:231], v[188:191]
    ds_read_b128 v[228:231], v253 offset:37952
    v_fmac_f32 v204, s23, v208
    v_mfma_f32_16x16x32_bf16 v[96:99], a[228:231], v[232:235], v[96:99]
    s_waitcnt lgkmcnt(1)
    v_cvt_pk_bf16_f32 v204, v252, v204
    v_lshlrev_b32 v252, 16, v214
    v_mfma_f32_16x16x32_bf16 v[100:103], a[232:235], v[232:235], v[100:103]
    buffer_load_dwordx4 a[208:211], v254, s[8:11], s42 offen offset:1024 sc1
    v_and_b32 v214, s22, v214
    v_mfma_f32_16x16x32_bf16 v[104:107], a[236:239], v[232:235], v[104:107]
    ds_read_b128 v[232:235], v253 offset:37696
    v_add_f32 v252, v252, v248
    v_mfma_f32_16x16x32_bf16 v[108:111], a[228:231], v[236:239], v[108:111]
    v_add_f32 v214, v214, v206
    v_fmac_f32 v252, s23, v250
    v_mfma_f32_16x16x32_bf16 v[112:115], a[232:235], v[236:239], v[112:115]
    s_waitcnt vmcnt(17)
    v_fmac_f32 v214, s23, v210
    v_cvt_pk_bf16_f32 v214, v252, v214
    v_fma_f32 v252, v249, s24, v251
    v_mfma_f32_16x16x32_bf16 v[116:119], a[236:239], v[236:239], v[116:119]
    buffer_load_dwordx4 a[212:215], v254, s[8:11], s42 offen offset:2048 sc1
    v_mfma_f32_16x16x32_bf16 v[96:99], a[240:243], v[236:239], v[96:99]
    s_waitcnt lgkmcnt(1)
    v_fmac_f32 v251, s25, v249
    v_fma_f32 v249, v248, s24, v250
    v_mfma_f32_16x16x32_bf16 v[100:103], a[244:247], v[236:239], v[100:103]
    s_add_u32 s42, s36, 1185792
    v_fmac_f32 v250, s25, v248
    v_fma_f32 v248, v250, s26, v251
    v_fmac_f32 v251, s27, v250
    v_mfma_f32_16x16x32_bf16 v[104:107], a[248:251], v[236:239], v[104:107]
    ds_read_b128 v[236:239], v253 offset:37440
    v_fma_f32 v250, v249, s28, v252
    v_mfma_f32_16x16x32_bf16 v[120:123], a[228:231], v[228:231], v[120:123]
    buffer_load_dwordx4 a[216:219], v254, s[8:11], s42 offen offset:0 sc1
    v_mfma_f32_16x16x32_bf16 v[124:127], a[232:235], v[228:231], v[124:127]
    v_fmac_f32 v252, s29, v249
    v_fma_f32 v249, v208, s24, v212
    v_mfma_f32_16x16x32_bf16 v[128:131], a[236:239], v[228:231], v[128:131]
    v_fmac_f32 v212, s25, v208
    v_fma_f32 v208, v206, s24, v210
    v_fmac_f32 v210, s25, v206
    v_mfma_f32_16x16x32_bf16 v[108:111], a[240:243], v[228:231], v[108:111]
    ds_read_b128 a[4:7], v6 offset:13504
    v_fma_f32 v206, v210, s26, v212
    v_mfma_f32_16x16x32_bf16 v[112:115], a[244:247], v[228:231], v[112:115]
    buffer_load_dwordx4 a[220:223], v254, s[8:11], s42 offen offset:1024 sc1
    v_mfma_f32_16x16x32_bf16 v[116:119], a[248:251], v[228:231], v[116:119]
    s_waitcnt vmcnt(17)
    v_fmac_f32 v212, s27, v210
    v_fma_f32 v210, v208, s28, v249
    v_fmac_f32 v249, s29, v208
    v_mfma_f32_16x16x32_bf16 v[96:99], a[252:255], v[228:231], v[96:99]
    s_waitcnt lgkmcnt(2)
    v_cvt_pk_bf16_f32 v206, v248, v206
    v_cvt_pk_bf16_f32 v212, v251, v212
    v_mfma_f32_16x16x32_bf16 v[100:103], v[240:243], v[228:231], v[100:103]
    buffer_load_dwordx4 a[224:227], v254, s[8:11], s42 offen offset:2048 sc1
    v_mfma_f32_16x16x32_bf16 v[104:107], v[244:247], v[228:231], v[104:107]
    ds_read_b128 v[228:231], v253 offset:39264
    v_and_b32 v203, 0x7fff, v255
    v_cvt_pk_bf16_f32 v210, v250, v210
    v_mfma_f32_16x16x32_bf16 v[132:135], a[228:231], v[232:235], v[132:135]
    v_cvt_pk_bf16_f32 v208, v252, v249
    v_lshlrev_b32 v248, 16, v207
    v_mfma_f32_16x16x32_bf16 v[136:139], a[232:235], v[232:235], v[136:139]
    buffer_load_dwordx2 v[192:193], v203, s[4:7], s16 offen offset:768
    v_mfma_f32_16x16x32_bf16 v[140:143], a[236:239], v[232:235], v[140:143]
    v_lshlrev_b32 v249, 16, v209
    v_lshlrev_b32 v250, 16, v211
    v_mfma_f32_16x16x32_bf16 v[120:123], a[240:243], v[232:235], v[120:123]
    v_lshlrev_b32 v251, 16, v213
    v_and_b32 v207, s22, v207
    v_and_b32 v209, s22, v209
    v_mfma_f32_16x16x32_bf16 v[124:127], a[244:247], v[232:235], v[124:127]
    buffer_load_dwordx2 v[194:195], v203, s[4:7], s17 offen offset:768
    v_mfma_f32_16x16x32_bf16 v[128:131], a[248:251], v[232:235], v[128:131]
    v_and_b32 v211, s22, v211
    v_and_b32 v213, s22, v213
    v_mfma_f32_16x16x32_bf16 v[108:111], a[252:255], v[232:235], v[108:111]
    s_waitcnt lgkmcnt(2)
    v_lshlrev_b32 v252, 16, v205
    v_and_b32 v205, s22, v205
    v_add_f32 v252, v252, v251
    v_mfma_f32_16x16x32_bf16 v[112:115], v[240:243], v[232:235], v[112:115]
    buffer_load_dwordx2 v[196:197], v203, s[4:7], s18 offen offset:768
    v_mfma_f32_16x16x32_bf16 v[116:119], v[244:247], v[232:235], v[116:119]
    ds_read_b128 v[232:235], v253 offset:39008
    v_add_f32 v205, v205, v213
    v_mfma_f32_16x16x32_bf16 v[144:147], a[228:231], v[236:239], v[144:147]
    v_fmac_f32 v252, s23, v249
    v_fmac_f32 v205, s23, v209
    v_cvt_pk_bf16_f32 v205, v252, v205
    v_mfma_f32_16x16x32_bf16 v[148:151], a[232:235], v[236:239], v[148:151]
    buffer_load_dwordx2 v[198:199], v203, s[4:7], s19 offen offset:768
    v_mfma_f32_16x16x32_bf16 v[152:155], a[236:239], v[236:239], v[152:155]
    v_lshlrev_b32 v252, 16, v215
    v_and_b32 v215, s22, v215
    v_mfma_f32_16x16x32_bf16 v[132:135], a[240:243], v[236:239], v[132:135]
    v_add_f32 v252, v252, v248
    v_add_f32 v215, v215, v207
    v_mfma_f32_16x16x32_bf16 v[136:139], a[244:247], v[236:239], v[136:139]
    buffer_load_dwordx2 v[200:201], v203, s[4:7], s20 offen offset:768
    v_fmac_f32 v252, s23, v250
    v_mfma_f32_16x16x32_bf16 v[140:143], a[248:251], v[236:239], v[140:143]
    ds_read_b128 a[8:11], v6 offset:14528
    v_fmac_f32 v215, s23, v211
    v_mfma_f32_16x16x32_bf16 v[120:123], a[252:255], v[236:239], v[120:123]
    s_waitcnt lgkmcnt(2)
    v_cvt_pk_bf16_f32 v215, v252, v215
    v_fma_f32 v252, v249, s24, v251
    v_mfma_f32_16x16x32_bf16 v[124:127], v[240:243], v[236:239], v[124:127]
    buffer_load_dwordx2 v[202:203], v203, s[4:7], s21 offen offset:768
    v_fmac_f32 v251, s25, v249
    v_mfma_f32_16x16x32_bf16 v[128:131], v[244:247], v[236:239], v[128:131]
    ds_read_b128 v[236:239], v253 offset:38752
    v_fma_f32 v249, v248, s24, v250
    v_mfma_f32_16x16x32_bf16 v[156:159], a[228:231], v[228:231], v[156:159]
    v_fmac_f32 v250, s25, v248
    v_fma_f32 v248, v250, s26, v251
    v_mfma_f32_16x16x32_bf16 v[160:163], a[232:235], v[228:231], v[160:163]
    buffer_store_dwordx4 a[156:159], v254, s[12:15], s44 offen sc1
    s_add_u32 s44, s40, 204800
    v_fmac_f32 v251, s27, v250
    v_mfma_f32_16x16x32_bf16 v[164:167], a[236:239], v[228:231], v[164:167]
    v_fma_f32 v250, v249, s28, v252
    v_fmac_f32 v252, s29, v249
    v_mfma_f32_16x16x32_bf16 v[144:147], a[240:243], v[228:231], v[144:147]
    v_fma_f32 v249, v209, s24, v213
    v_fmac_f32 v213, s25, v209
    v_mfma_f32_16x16x32_bf16 v[148:151], a[244:247], v[228:231], v[148:151]
    buffer_store_dwordx4 a[160:163], v254, s[12:15], s44 offen sc1
    s_add_u32 s44, s40, 207872
    v_mfma_f32_16x16x32_bf16 v[152:155], a[248:251], v[228:231], v[152:155]
    v_fma_f32 v209, v207, s24, v211
    v_fmac_f32 v211, s25, v207
    v_fma_f32 v207, v211, s26, v213
    v_mfma_f32_16x16x32_bf16 v[132:135], a[252:255], v[228:231], v[132:135]
    s_waitcnt lgkmcnt(2)
    v_fmac_f32 v213, s27, v211
    v_fma_f32 v211, v209, s28, v249
    v_mfma_f32_16x16x32_bf16 v[136:139], v[240:243], v[228:231], v[136:139]
    buffer_store_dwordx4 a[164:167], v254, s[12:15], s44 offen sc1
    v_fmac_f32 v249, s29, v209
    v_cvt_pk_bf16_f32 v207, v248, v207
    v_mfma_f32_16x16x32_bf16 v[140:143], v[244:247], v[228:231], v[140:143]
    ds_read_b128 v[228:231], v253 offset:38496
    v_cvt_pk_bf16_f32 v213, v251, v213
    v_cvt_pk_bf16_f32 v211, v250, v211
    v_mfma_f32_16x16x32_bf16 v[168:171], a[228:231], v[232:235], v[168:171]
    v_cvt_pk_bf16_f32 v209, v252, v249
    v_lshrrev_b32 v252, 15, v255
    v_mfma_f32_16x16x32_bf16 v[172:175], a[232:235], v[232:235], v[172:175]
    ds_write_b64 v252, v[206:207] offset:768
    v_mfma_f32_16x16x32_bf16 v[176:179], a[236:239], v[232:235], v[176:179]
    s_waitcnt vmcnt(21)
    v_lshlrev_b32 v248, 16, v218
    v_lshlrev_b32 v249, 16, v220
    v_mfma_f32_16x16x32_bf16 v[156:159], a[240:243], v[232:235], v[156:159]
    ds_write_b64 v252, v[212:213] offset:2848
    v_mfma_f32_16x16x32_bf16 v[160:163], a[244:247], v[232:235], v[160:163]
    s_waitcnt lgkmcnt(3)
    v_lshlrev_b32 v250, 16, v222
    v_lshlrev_b32 v251, 16, v224
    v_mfma_f32_16x16x32_bf16 v[164:167], a[248:251], v[232:235], v[164:167]
    ds_write_b64 v252, v[210:211] offset:4928
    v_mfma_f32_16x16x32_bf16 v[144:147], a[252:255], v[232:235], v[144:147]
    s_add_u32 s44, s40, 0
    v_and_b32 v218, s22, v218
    v_and_b32 v220, s22, v220
    v_mfma_f32_16x16x32_bf16 v[148:151], v[240:243], v[232:235], v[148:151]
    ds_write_b64 v252, v[204:205] offset:34048
    v_mfma_f32_16x16x32_bf16 v[152:155], v[244:247], v[232:235], v[152:155]
    ds_read_b128 v[232:235], v253 offset:38224
    v_and_b32 v222, s22, v222
    v_mfma_f32_16x16x32_bf16 v[180:183], a[228:231], v[236:239], v[180:183]
    ds_read_b128 a[12:15], v6 offset:15584
    v_and_b32 v224, s22, v224
    v_mfma_f32_16x16x32_bf16 v[184:187], a[232:235], v[236:239], v[184:187]
    ds_write_b64 v252, v[214:215] offset:36128
    v_mfma_f32_16x16x32_bf16 v[188:191], a[236:239], v[236:239], v[188:191]
    s_add_u32 s42, s36, 1216512
    v_mfma_f32_16x16x32_bf16 v[168:171], a[240:243], v[236:239], v[168:171]
    buffer_load_dwordx4 a[228:231], v254, s[8:11], s42 offen offset:0 sc1
    v_mfma_f32_16x16x32_bf16 v[172:175], a[244:247], v[236:239], v[172:175]
    v_mfma_f32_16x16x32_bf16 v[176:179], a[248:251], v[236:239], v[176:179]
    ds_write_b64 v252, v[208:209] offset:7008
    v_mfma_f32_16x16x32_bf16 v[156:159], a[252:255], v[236:239], v[156:159]
    buffer_load_dwordx4 a[232:235], v254, s[8:11], s42 offen offset:1024 sc1
    v_mfma_f32_16x16x32_bf16 v[160:163], v[240:243], v[236:239], v[160:163]
    v_lshlrev_b32 v252, 16, v216
    v_and_b32 v216, s22, v216
    v_add_f32 v252, v252, v251
    v_mfma_f32_16x16x32_bf16 v[164:167], v[244:247], v[236:239], v[164:167]
    s_waitcnt lgkmcnt(8)
    v_add_f32 v216, v216, v224
    v_fmac_f32 v252, s23, v249
    v_mfma_f32_16x16x32_bf16 v[180:183], a[240:243], v[228:231], v[180:183]
    ds_read_b128 v[236:239], v253 offset:26000
    v_fmac_f32 v216, s23, v220
    v_mfma_f32_16x16x32_bf16 v[184:187], a[244:247], v[228:231], v[184:187]
    v_cvt_pk_bf16_f32 v216, v252, v216
    v_lshlrev_b32 v252, 16, v226
    v_and_b32 v226, s22, v226
    v_mfma_f32_16x16x32_bf16 v[188:191], a[248:251], v[228:231], v[188:191]
    buffer_load_dwordx4 a[236:239], v254, s[8:11], s42 offen offset:2048 sc1
    v_mfma_f32_16x16x32_bf16 v[168:171], a[252:255], v[228:231], v[168:171]
    s_waitcnt lgkmcnt(4)
    v_add_f32 v252, v252, v248
    v_add_f32 v226, v226, v218
    v_mfma_f32_16x16x32_bf16 v[172:175], v[240:243], v[228:231], v[172:175]
    s_add_u32 s42, s36, 1219584
    v_fmac_f32 v252, s23, v250
    v_fmac_f32 v226, s23, v222
    v_cvt_pk_bf16_f32 v226, v252, v226
    v_mfma_f32_16x16x32_bf16 v[176:179], v[244:247], v[228:231], v[176:179]
    ds_read_b128 v[228:231], v253 offset:25728
    v_fma_f32 v252, v249, s24, v251
    v_mfma_f32_16x16x32_bf16 v[180:183], a[252:255], v[232:235], v[180:183]
    buffer_load_dwordx4 a[240:243], v254, s[8:11], s42 offen offset:0 sc1
    v_mfma_f32_16x16x32_bf16 v[184:187], v[240:243], v[232:235], v[184:187]
    s_waitcnt vmcnt(19) lgkmcnt(1)
    v_fmac_f32 v251, s25, v249
    v_fma_f32 v249, v248, s24, v250
    v_mfma_f32_16x16x32_bf16 v[188:191], v[244:247], v[232:235], v[188:191]
    ds_read_b128 v[232:235], v253 offset:25472
    v_fmac_f32 v250, s25, v248
    v_fma_f32 v248, v250, s26, v251
    v_mfma_f32_16x16x32_bf16 v[96:99], a[192:195], v[236:239], v[96:99]
    s_waitcnt lgkmcnt(1)
    v_fmac_f32 v251, s27, v250
    v_fma_f32 v250, v249, s28, v252
    v_mfma_f32_16x16x32_bf16 v[100:103], a[196:199], v[236:239], v[100:103]
    buffer_load_dwordx4 a[244:247], v254, s[8:11], s42 offen offset:1024 sc1
    v_mfma_f32_16x16x32_bf16 v[104:107], a[200:203], v[236:239], v[104:107]
    ds_read_b128 v[236:239], v253 offset:25216
    v_fmac_f32 v252, s29, v249
    v_fma_f32 v249, v220, s24, v224
    v_mfma_f32_16x16x32_bf16 v[108:111], a[192:195], v[228:231], v[108:111]
    ds_read_b128 a[16:19], v6 offset:16608
    v_fmac_f32 v224, s25, v220
    v_mfma_f32_16x16x32_bf16 v[112:115], a[196:199], v[228:231], v[112:115]
    s_waitcnt vmcnt(17)
    v_fma_f32 v220, v218, s24, v222
    v_fmac_f32 v222, s25, v218
    v_mfma_f32_16x16x32_bf16 v[116:119], a[200:203], v[228:231], v[116:119]
    buffer_load_dwordx4 a[248:251], v254, s[8:11], s42 offen offset:2048 sc1
    v_fma_f32 v218, v222, s26, v224
    v_mfma_f32_16x16x32_bf16 v[96:99], a[204:207], v[228:231], v[96:99]
    s_waitcnt lgkmcnt(2)
    v_fmac_f32 v224, s27, v222
    v_fma_f32 v222, v220, s28, v249
    v_mfma_f32_16x16x32_bf16 v[100:103], a[208:211], v[228:231], v[100:103]
    s_add_u32 s42, s36, 1222656
    v_fmac_f32 v249, s29, v220
    v_cvt_pk_bf16_f32 v218, v248, v218
    v_mfma_f32_16x16x32_bf16 v[104:107], a[212:215], v[228:231], v[104:107]
    ds_read_b128 v[228:231], v253 offset:24960
    v_cvt_pk_bf16_f32 v224, v251, v224
    v_mfma_f32_16x16x32_bf16 v[120:123], a[192:195], v[232:235], v[120:123]
    buffer_load_dwordx4 a[252:255], v254, s[8:11], s42 offen offset:0 sc1
    v_cvt_pk_bf16_f32 v222, v250, v222
    v_mfma_f32_16x16x32_bf16 v[124:127], a[196:199], v[232:235], v[124:127]
    v_cvt_pk_bf16_f32 v220, v252, v249
    v_lshlrev_b32 v248, 16, v219
    v_mfma_f32_16x16x32_bf16 v[128:131], a[200:203], v[232:235], v[128:131]
    v_lshlrev_b32 v249, 16, v221
    v_lshlrev_b32 v250, 16, v223
    v_mfma_f32_16x16x32_bf16 v[108:111], a[204:207], v[232:235], v[108:111]
    v_lshlrev_b32 v251, 16, v225
    v_and_b32 v219, s22, v219
    v_and_b32 v221, s22, v221
    v_mfma_f32_16x16x32_bf16 v[112:115], a[208:211], v[232:235], v[112:115]
    buffer_load_dwordx4 v[240:243], v254, s[8:11], s42 offen offset:1024 sc1
    v_mfma_f32_16x16x32_bf16 v[116:119], a[212:215], v[232:235], v[116:119]
    s_waitcnt vmcnt(17)
    v_and_b32 v223, s22, v223
    v_and_b32 v225, s22, v225
    v_mfma_f32_16x16x32_bf16 v[96:99], a[216:219], v[232:235], v[96:99]
    s_waitcnt lgkmcnt(2)
    v_lshlrev_b32 v252, 16, v217
    v_and_b32 v217, s22, v217
    v_add_f32 v252, v252, v251
    v_mfma_f32_16x16x32_bf16 v[100:103], a[220:223], v[232:235], v[100:103]
    buffer_load_dwordx4 v[244:247], v254, s[8:11], s42 offen offset:2048 sc1
    v_mfma_f32_16x16x32_bf16 v[104:107], a[224:227], v[232:235], v[104:107]
    ds_read_b128 v[232:235], v253 offset:26784
    v_and_b32 v215, 0x7fff, v255
    v_mfma_f32_16x16x32_bf16 v[132:135], a[192:195], v[236:239], v[132:135]
    v_add_f32 v217, v217, v225
    v_fmac_f32 v252, s23, v249
    v_mfma_f32_16x16x32_bf16 v[136:139], a[196:199], v[236:239], v[136:139]
    buffer_load_dwordx2 v[204:205], v215, s[4:7], s16 offen offset:1152
    v_fmac_f32 v217, s23, v221
    v_mfma_f32_16x16x32_bf16 v[140:143], a[200:203], v[236:239], v[140:143]
    v_cvt_pk_bf16_f32 v217, v252, v217
    v_lshlrev_b32 v252, 16, v227
    v_mfma_f32_16x16x32_bf16 v[120:123], a[204:207], v[236:239], v[120:123]
    ds_read_b128 a[20:23], v6 offset:17632
    v_and_b32 v227, s22, v227
    v_mfma_f32_16x16x32_bf16 v[124:127], a[208:211], v[236:239], v[124:127]
    buffer_load_dwordx2 v[206:207], v215, s[4:7], s17 offen offset:1152
    v_add_f32 v252, v252, v248
    v_mfma_f32_16x16x32_bf16 v[128:131], a[212:215], v[236:239], v[128:131]
    v_add_f32 v227, v227, v219
    v_fmac_f32 v252, s23, v250
    v_mfma_f32_16x16x32_bf16 v[108:111], a[216:219], v[236:239], v[108:111]
    s_waitcnt lgkmcnt(2)
    v_fmac_f32 v227, s23, v223
    v_cvt_pk_bf16_f32 v227, v252, v227
    v_mfma_f32_16x16x32_bf16 v[112:115], a[220:223], v[236:239], v[112:115]
    buffer_load_dwordx2 v[208:209], v215, s[4:7], s18 offen offset:1152
    v_fma_f32 v252, v249, s24, v251
    v_mfma_f32_16x16x32_bf16 v[116:119], a[224:227], v[236:239], v[116:119]
    ds_read_b128 v[236:239], v253 offset:26528
    v_fmac_f32 v251, s25, v249
    v_mfma_f32_16x16x32_bf16 v[144:147], a[192:195], v[228:231], v[144:147]
    v_fma_f32 v249, v248, s24, v250
    v_fmac_f32 v250, s25, v248
    v_mfma_f32_16x16x32_bf16 v[148:151], a[196:199], v[228:231], v[148:151]
    buffer_load_dwordx2 v[210:211], v215, s[4:7], s19 offen offset:1152
    v_mfma_f32_16x16x32_bf16 v[152:155], a[200:203], v[228:231], v[152:155]
    v_fma_f32 v248, v250, s26, v251
    v_fmac_f32 v251, s27, v250
    v_fma_f32 v250, v249, s28, v252
    v_mfma_f32_16x16x32_bf16 v[132:135], a[204:207], v[228:231], v[132:135]
    v_fmac_f32 v252, s29, v249
    v_fma_f32 v249, v221, s24, v225
    v_mfma_f32_16x16x32_bf16 v[136:139], a[208:211], v[228:231], v[136:139]
    buffer_load_dwordx2 v[212:213], v215, s[4:7], s20 offen offset:1152
    v_mfma_f32_16x16x32_bf16 v[140:143], a[212:215], v[228:231], v[140:143]
    v_fmac_f32 v225, s25, v221
    v_fma_f32 v221, v219, s24, v223
    v_fmac_f32 v223, s25, v219
    v_mfma_f32_16x16x32_bf16 v[120:123], a[216:219], v[228:231], v[120:123]
    s_waitcnt lgkmcnt(2)
    v_fma_f32 v219, v223, s26, v225
    v_fmac_f32 v225, s27, v223
    v_mfma_f32_16x16x32_bf16 v[124:127], a[220:223], v[228:231], v[124:127]
    buffer_load_dwordx2 v[214:215], v215, s[4:7], s21 offen offset:1152
    v_mfma_f32_16x16x32_bf16 v[128:131], a[224:227], v[228:231], v[128:131]
    ds_read_b128 v[228:231], v253 offset:26272
    v_fma_f32 v223, v221, s28, v249
    v_fmac_f32 v249, s29, v221
    v_mfma_f32_16x16x32_bf16 v[156:159], a[192:195], v[232:235], v[156:159]
    v_cvt_pk_bf16_f32 v219, v248, v219
    v_cvt_pk_bf16_f32 v225, v251, v225
    v_mfma_f32_16x16x32_bf16 v[160:163], a[196:199], v[232:235], v[160:163]
    buffer_store_dwordx4 a[0:3], v254, s[12:15], s44 offen sc1
    s_add_u32 s44, s40, 1024
    v_mfma_f32_16x16x32_bf16 v[164:167], a[200:203], v[232:235], v[164:167]
    v_cvt_pk_bf16_f32 v223, v250, v223
    v_cvt_pk_bf16_f32 v221, v252, v249
    v_mfma_f32_16x16x32_bf16 v[144:147], a[204:207], v[232:235], v[144:147]
    s_waitcnt lgkmcnt(1)
    v_lshrrev_b32 v252, 15, v255
    v_mfma_f32_16x16x32_bf16 v[148:151], a[208:211], v[232:235], v[148:151]
    buffer_store_dwordx4 a[4:7], v254, s[12:15], s44 offen sc1
    s_add_u32 s44, s40, 2048
    v_mfma_f32_16x16x32_bf16 v[152:155], a[212:215], v[232:235], v[152:155]
    ds_write_b64 v252, v[218:219] offset:512
    v_mfma_f32_16x16x32_bf16 v[132:135], a[216:219], v[232:235], v[132:135]
    ds_read_b128 a[24:27], v6 offset:18688
    s_waitcnt vmcnt(20)
    v_lshlrev_b32 v248, 16, v194
    v_mfma_f32_16x16x32_bf16 v[136:139], a[220:223], v[232:235], v[136:139]
    buffer_store_dwordx4 a[8:11], v254, s[12:15], s44 offen sc1
    v_lshlrev_b32 v249, 16, v196
    v_mfma_f32_16x16x32_bf16 v[140:143], a[224:227], v[232:235], v[140:143]
    ds_read_b128 v[232:235], v253 offset:26016
    v_mfma_f32_16x16x32_bf16 v[168:171], a[192:195], v[236:239], v[168:171]
    ds_write_b64 v252, v[224:225] offset:2592
    v_lshlrev_b32 v250, 16, v198
    v_mfma_f32_16x16x32_bf16 v[172:175], a[196:199], v[236:239], v[172:175]
    v_lshlrev_b32 v251, 16, v200
    v_mfma_f32_16x16x32_bf16 v[176:179], a[200:203], v[236:239], v[176:179]
    s_add_u32 s44, s40, 3072
    v_mfma_f32_16x16x32_bf16 v[156:159], a[204:207], v[236:239], v[156:159]
    ds_write_b64 v252, v[222:223] offset:4672
    v_mfma_f32_16x16x32_bf16 v[160:163], a[208:211], v[236:239], v[160:163]
    v_and_b32 v194, s22, v194
    v_and_b32 v196, s22, v196
    v_mfma_f32_16x16x32_bf16 v[164:167], a[212:215], v[236:239], v[164:167]
    ds_write_b64 v252, v[216:217] offset:33792
    v_mfma_f32_16x16x32_bf16 v[144:147], a[216:219], v[236:239], v[144:147]
    s_waitcnt lgkmcnt(6)
    v_and_b32 v198, s22, v198
    v_and_b32 v200, s22, v200
    v_mfma_f32_16x16x32_bf16 v[148:151], a[220:223], v[236:239], v[148:151]
    ds_write_b64 v252, v[226:227] offset:35872
    v_mfma_f32_16x16x32_bf16 v[152:155], a[224:227], v[236:239], v[152:155]
    ds_read_b128 v[236:239], v253 offset:25744
    v_mfma_f32_16x16x32_bf16 v[180:183], a[192:195], v[228:231], v[180:183]
    ds_write_b64 v252, v[220:221] offset:6752
    v_mfma_f32_16x16x32_bf16 v[184:187], a[196:199], v[228:231], v[184:187]
    v_mfma_f32_16x16x32_bf16 v[188:191], a[200:203], v[228:231], v[188:191]
    s_add_u32 s42, s36, 1253376
    v_mfma_f32_16x16x32_bf16 v[168:171], a[204:207], v[228:231], v[168:171]
    buffer_load_dwordx4 a[192:195], v254, s[8:11], s42 offen offset:0 sc1
    v_mfma_f32_16x16x32_bf16 v[172:175], a[208:211], v[228:231], v[172:175]
    v_mfma_f32_16x16x32_bf16 v[176:179], a[212:215], v[228:231], v[176:179]
    v_mfma_f32_16x16x32_bf16 v[156:159], a[216:219], v[228:231], v[156:159]
    buffer_load_dwordx4 a[196:199], v254, s[8:11], s42 offen offset:1024 sc1
    v_mfma_f32_16x16x32_bf16 v[160:163], a[220:223], v[228:231], v[160:163]
    s_waitcnt lgkmcnt(6)
    v_lshlrev_b32 v252, 16, v192
    v_and_b32 v192, s22, v192
    v_mfma_f32_16x16x32_bf16 v[164:167], a[224:227], v[228:231], v[164:167]
    ds_read_b128 a[28:31], v6 offset:19712
    v_add_f32 v252, v252, v251
    v_mfma_f32_16x16x32_bf16 v[180:183], a[204:207], v[232:235], v[180:183]
    ds_read_b128 v[228:231], v253 offset:28080
    v_add_f32 v192, v192, v200
    v_mfma_f32_16x16x32_bf16 v[184:187], a[208:211], v[232:235], v[184:187]
    ds_read_b128 v[216:219], v253 offset:39520
    v_fmac_f32 v252, s23, v249
    v_mfma_f32_16x16x32_bf16 v[188:191], a[212:215], v[232:235], v[188:191]
    buffer_load_dwordx4 a[200:203], v254, s[8:11], s42 offen offset:2048 sc1
    v_fmac_f32 v192, s23, v196
    v_mfma_f32_16x16x32_bf16 v[168:171], a[216:219], v[232:235], v[168:171]
    s_mov_b32 s45, 573637648
    v_cvt_pk_bf16_f32 v192, v252, v192
    v_lshlrev_b32 v252, 16, v202
    v_mfma_f32_16x16x32_bf16 v[172:175], a[220:223], v[232:235], v[172:175]
    s_add_u32 s42, s36, 1256448
    v_and_b32 v202, s22, v202
    v_add_f32 v252, v252, v248
    v_mfma_f32_16x16x32_bf16 v[176:179], a[224:227], v[232:235], v[176:179]
    ds_read_b128 v[232:235], v253 offset:27808
    v_bfe_u32 v220, v254, 5, 3
    s_waitcnt lgkmcnt(5)
    v_mfma_f32_16x16x32_bf16 v[180:183], a[216:219], v[236:239], v[180:183]
    buffer_load_dwordx4 a[204:207], v254, s[8:11], s42 offen offset:0 sc1
    v_mfma_f32_16x16x32_bf16 v[184:187], a[220:223], v[236:239], v[184:187]
    s_waitcnt vmcnt(19) lgkmcnt(2)
    v_add_f32 v202, v202, v194
    v_fmac_f32 v252, s23, v250
    v_mfma_f32_16x16x32_bf16 v[188:191], a[224:227], v[236:239], v[188:191]
    ds_read_b128 v[236:239], v253 offset:27552
    v_mul_u32_u24 v221, 5, v220
    v_mfma_f32_16x16x32_bf16 v[96:99], a[228:231], v[228:231], v[96:99]
    s_waitcnt lgkmcnt(1)
    v_fmac_f32 v202, s23, v198
    v_cvt_pk_bf16_f32 v202, v252, v202
    v_mfma_f32_16x16x32_bf16 v[100:103], a[232:235], v[228:231], v[100:103]
    buffer_load_dwordx4 a[208:211], v254, s[8:11], s42 offen offset:1024 sc1
    v_mfma_f32_16x16x32_bf16 v[104:107], a[236:239], v[228:231], v[104:107]
    ds_read_b128 v[228:231], v253 offset:27296
    v_bfe_u32 v221, s45, v221, 5
    v_mfma_f32_16x16x32_bf16 v[108:111], a[228:231], v[232:235], v[108:111]
    v_fma_f32 v252, v249, s24, v251
    v_fmac_f32 v251, s25, v249
    v_fma_f32 v249, v248, s24, v250
    v_mfma_f32_16x16x32_bf16 v[112:115], a[232:235], v[232:235], v[112:115]
    s_waitcnt vmcnt(17)
    v_mul_u32_u24 v221, 65, v221
    v_fmac_f32 v250, s25, v248
    v_mfma_f32_16x16x32_bf16 v[116:119], a[236:239], v[232:235], v[116:119]
    buffer_load_dwordx4 a[212:215], v254, s[8:11], s42 offen offset:2048 sc1
    v_mfma_f32_16x16x32_bf16 v[96:99], a[240:243], v[232:235], v[96:99]
    s_waitcnt lgkmcnt(1)
    v_sub_u32 v221, v221, v220
    v_fma_f32 v248, v250, s26, v251
    v_mfma_f32_16x16x32_bf16 v[100:103], a[244:247], v[232:235], v[100:103]
    s_add_u32 s42, s36, 1259520
    v_fmac_f32 v251, s27, v250
    v_fma_f32 v250, v249, s28, v252
    v_mfma_f32_16x16x32_bf16 v[104:107], a[248:251], v[232:235], v[104:107]
    ds_read_b128 v[232:235], v253 offset:27040
    v_lshl_add_u32 v220, v221, 5, v253
    v_mfma_f32_16x16x32_bf16 v[120:123], a[228:231], v[236:239], v[120:123]
    buffer_load_dwordx4 a[216:219], v254, s[8:11], s42 offen offset:0 sc1
    v_mfma_f32_16x16x32_bf16 v[124:127], a[232:235], v[236:239], v[124:127]
    ds_read_b128 a[32:35], v6 offset:20736
    v_fmac_f32 v252, s29, v249
    v_mfma_f32_16x16x32_bf16 v[128:131], a[236:239], v[236:239], v[128:131]
    v_fma_f32 v249, v196, s24, v200
    v_fmac_f32 v200, s25, v196
    v_mfma_f32_16x16x32_bf16 v[108:111], a[240:243], v[236:239], v[108:111]
    s_waitcnt vmcnt(16)
    v_fma_f32 v196, v194, s24, v198
    v_fmac_f32 v198, s25, v194
    v_mfma_f32_16x16x32_bf16 v[112:115], a[244:247], v[236:239], v[112:115]
    buffer_load_dwordx4 a[220:223], v254, s[8:11], s42 offen offset:1024 sc1
    v_fma_f32 v194, v198, s26, v200
    v_mfma_f32_16x16x32_bf16 v[116:119], a[248:251], v[236:239], v[116:119]
    s_mov_b64 exec, s[46:47]
    ds_write_b128 v220, v[216:219] offset:1024
    s_mov_b64 exec, -1
    v_mfma_f32_16x16x32_bf16 v[96:99], a[252:255], v[236:239], v[96:99]
    s_waitcnt lgkmcnt(3)
    v_fmac_f32 v200, s27, v198
    v_fma_f32 v198, v196, s28, v249
    v_mfma_f32_16x16x32_bf16 v[100:103], v[240:243], v[236:239], v[100:103]
    buffer_load_dwordx4 a[224:227], v254, s[8:11], s42 offen offset:2048 sc1
    v_mfma_f32_16x16x32_bf16 v[104:107], v[244:247], v[236:239], v[104:107]
    ds_read_b128 v[236:239], v253 offset:28864
    v_fmac_f32 v249, s29, v196
    v_mfma_f32_16x16x32_bf16 v[132:135], a[228:231], v[228:231], v[132:135]
    v_cvt_pk_bf16_f32 v194, v248, v194
    v_cvt_pk_bf16_f32 v200, v251, v200
    v_mfma_f32_16x16x32_bf16 v[136:139], a[232:235], v[228:231], v[136:139]
    buffer_store_dwordx4 a[12:15], v254, s[12:15], s44 offen sc1
    s_add_u32 s44, s40, 4096
    v_mfma_f32_16x16x32_bf16 v[140:143], a[236:239], v[228:231], v[140:143]
    v_cvt_pk_bf16_f32 v198, v250, v198
    v_cvt_pk_bf16_f32 v196, v252, v249
    v_mfma_f32_16x16x32_bf16 v[120:123], a[240:243], v[228:231], v[120:123]
    v_lshlrev_b32 v248, 16, v195
    v_lshlrev_b32 v249, 16, v197
    v_mfma_f32_16x16x32_bf16 v[124:127], a[244:247], v[228:231], v[124:127]
    buffer_store_dwordx4 a[16:19], v254, s[12:15], s44 offen sc1
    s_add_u32 s44, s40, 5120
    v_lshlrev_b32 v250, 16, v199
    v_mfma_f32_16x16x32_bf16 v[128:131], a[248:251], v[228:231], v[128:131]
    v_lshlrev_b32 v251, 16, v201
    v_and_b32 v195, s22, v195
    v_and_b32 v197, s22, v197
    v_mfma_f32_16x16x32_bf16 v[108:111], a[252:255], v[228:231], v[108:111]
    v_and_b32 v199, s22, v199
    v_and_b32 v201, s22, v201
    v_mfma_f32_16x16x32_bf16 v[112:115], v[240:243], v[228:231], v[112:115]
    s_waitcnt lgkmcnt(3)
    v_lshlrev_b32 v252, 16, v193
    v_and_b32 v193, s22, v193
    v_mfma_f32_16x16x32_bf16 v[116:119], v[244:247], v[228:231], v[116:119]
    ds_read_b128 v[228:231], v253 offset:28608
    v_add_f32 v252, v252, v251
    v_mfma_f32_16x16x32_bf16 v[144:147], a[228:231], v[232:235], v[144:147]
    v_add_f32 v193, v193, v201
    v_fmac_f32 v252, s23, v249
    v_mfma_f32_16x16x32_bf16 v[148:151], a[232:235], v[232:235], v[148:151]
    v_fmac_f32 v193, s23, v197
    v_cvt_pk_bf16_f32 v193, v252, v193
    v_mfma_f32_16x16x32_bf16 v[152:155], a[236:239], v[232:235], v[152:155]
    v_lshlrev_b32 v252, 16, v203
    v_and_b32 v203, s22, v203
    v_mfma_f32_16x16x32_bf16 v[132:135], a[240:243], v[232:235], v[132:135]
    v_add_f32 v252, v252, v248
    v_add_f32 v203, v203, v195
    v_mfma_f32_16x16x32_bf16 v[136:139], a[244:247], v[232:235], v[136:139]
    ds_read_b128 a[36:39], v6 offset:21792
    v_fmac_f32 v252, s23, v250
    v_mfma_f32_16x16x32_bf16 v[140:143], a[248:251], v[232:235], v[140:143]
    v_fmac_f32 v203, s23, v199
    v_cvt_pk_bf16_f32 v203, v252, v203
    v_mfma_f32_16x16x32_bf16 v[120:123], a[252:255], v[232:235], v[120:123]
    v_fma_f32 v252, v249, s24, v251
    v_fmac_f32 v251, s25, v249
    v_fma_f32 v249, v248, s24, v250
    v_mfma_f32_16x16x32_bf16 v[124:127], v[240:243], v[232:235], v[124:127]
    s_waitcnt lgkmcnt(2)
    v_fmac_f32 v250, s25, v248
    v_fma_f32 v248, v250, s26, v251
    v_mfma_f32_16x16x32_bf16 v[128:131], v[244:247], v[232:235], v[128:131]
    ds_read_b128 v[232:235], v253 offset:28352
    v_fmac_f32 v251, s27, v250
    v_mfma_f32_16x16x32_bf16 v[156:159], a[228:231], v[236:239], v[156:159]
    buffer_store_dwordx4 a[20:23], v254, s[12:15], s44 offen sc1
    v_fma_f32 v250, v249, s28, v252
    v_fmac_f32 v252, s29, v249
    v_mfma_f32_16x16x32_bf16 v[160:163], a[232:235], v[236:239], v[160:163]
    v_fma_f32 v249, v197, s24, v201
    v_fmac_f32 v201, s25, v197
    v_mfma_f32_16x16x32_bf16 v[164:167], a[236:239], v[236:239], v[164:167]
    v_fma_f32 v197, v195, s24, v199
    v_fmac_f32 v199, s25, v195
    v_mfma_f32_16x16x32_bf16 v[144:147], a[240:243], v[236:239], v[144:147]
    v_fma_f32 v195, v199, s26, v201
    v_fmac_f32 v201, s27, v199
    v_mfma_f32_16x16x32_bf16 v[148:151], a[244:247], v[236:239], v[148:151]
    v_fma_f32 v199, v197, s28, v249
    v_fmac_f32 v249, s29, v197
    v_mfma_f32_16x16x32_bf16 v[152:155], a[248:251], v[236:239], v[152:155]
    v_cvt_pk_bf16_f32 v195, v248, v195
    v_cvt_pk_bf16_f32 v201, v251, v201
    v_mfma_f32_16x16x32_bf16 v[132:135], a[252:255], v[236:239], v[132:135]
    v_cvt_pk_bf16_f32 v199, v250, v199
    v_cvt_pk_bf16_f32 v197, v252, v249
    v_mfma_f32_16x16x32_bf16 v[136:139], v[240:243], v[236:239], v[136:139]
    s_waitcnt lgkmcnt(2)
    v_lshrrev_b32 v252, 15, v255
    v_mfma_f32_16x16x32_bf16 v[140:143], v[244:247], v[236:239], v[140:143]
    ds_read_b128 v[236:239], v253 offset:28096
    s_add_u32 s44, s40, 6144
    v_mfma_f32_16x16x32_bf16 v[168:171], a[228:231], v[228:231], v[168:171]
    ds_write_b64 v252, v[194:195] offset:256
    v_mfma_f32_16x16x32_bf16 v[172:175], a[232:235], v[228:231], v[172:175]
    s_waitcnt vmcnt(15)
    v_lshlrev_b32 v248, 16, v206
    v_lshlrev_b32 v249, 16, v208
    v_mfma_f32_16x16x32_bf16 v[176:179], a[236:239], v[228:231], v[176:179]
    ds_write_b64 v252, v[200:201] offset:2336
    v_mfma_f32_16x16x32_bf16 v[156:159], a[240:243], v[228:231], v[156:159]
    v_lshlrev_b32 v250, 16, v210
    v_lshlrev_b32 v251, 16, v212
    v_mfma_f32_16x16x32_bf16 v[160:163], a[244:247], v[228:231], v[160:163]
    ds_write_b64 v252, v[198:199] offset:4416
    v_mfma_f32_16x16x32_bf16 v[164:167], a[248:251], v[228:231], v[164:167]
    s_waitcnt lgkmcnt(4)
    v_and_b32 v206, s22, v206
    v_and_b32 v208, s22, v208
    v_mfma_f32_16x16x32_bf16 v[144:147], a[252:255], v[228:231], v[144:147]
    ds_read_b128 a[40:43], v6 offset:22816
    v_mfma_f32_16x16x32_bf16 v[148:151], v[240:243], v[228:231], v[148:151]
    ds_write_b64 v252, v[192:193] offset:33536
    v_mfma_f32_16x16x32_bf16 v[152:155], v[244:247], v[228:231], v[152:155]
    ds_read_b128 v[228:231], v253 offset:27824
    v_and_b32 v210, s22, v210
    v_and_b32 v212, s22, v212
    v_mfma_f32_16x16x32_bf16 v[180:183], a[228:231], v[232:235], v[180:183]
    ds_write_b64 v252, v[202:203] offset:35616
    v_mfma_f32_16x16x32_bf16 v[184:187], a[232:235], v[232:235], v[184:187]
    v_mfma_f32_16x16x32_bf16 v[188:191], a[236:239], v[232:235], v[188:191]
    s_add_u32 s42, s37, 1290240
    v_mfma_f32_16x16x32_bf16 v[168:171], a[240:243], v[232:235], v[168:171]
    buffer_load_dwordx4 a[228:231], v254, s[8:11], s42 offen offset:0 sc1
    v_mfma_f32_16x16x32_bf16 v[172:175], a[244:247], v[232:235], v[172:175]
    ds_write_b64 v252, v[196:197] offset:6496
    v_mfma_f32_16x16x32_bf16 v[176:179], a[248:251], v[232:235], v[176:179]
    v_mfma_f32_16x16x32_bf16 v[156:159], a[252:255], v[232:235], v[156:159]
    buffer_load_dwordx4 a[232:235], v254, s[8:11], s42 offen offset:1024 sc1
    v_mfma_f32_16x16x32_bf16 v[160:163], v[240:243], v[232:235], v[160:163]
    v_lshlrev_b32 v252, 16, v204
    v_and_b32 v204, s22, v204
    v_mfma_f32_16x16x32_bf16 v[164:167], v[244:247], v[232:235], v[164:167]
    s_waitcnt lgkmcnt(8)
    v_add_f32 v252, v252, v251
    v_add_f32 v204, v204, v212
    v_mfma_f32_16x16x32_bf16 v[180:183], a[240:243], v[236:239], v[180:183]
    ds_read_b128 v[232:235], v253 offset:30160
    v_fmac_f32 v252, s23, v249
    v_fmac_f32 v204, s23, v208
    v_mfma_f32_16x16x32_bf16 v[184:187], a[244:247], v[236:239], v[184:187]
    v_cvt_pk_bf16_f32 v204, v252, v204
    v_lshlrev_b32 v252, 16, v214
    v_mfma_f32_16x16x32_bf16 v[188:191], a[248:251], v[236:239], v[188:191]
    buffer_load_dwordx4 a[236:239], v254, s[8:11], s42 offen offset:2048 sc1
    v_mfma_f32_16x16x32_bf16 v[168:171], a[252:255], v[236:239], v[168:171]
    s_waitcnt lgkmcnt(3)
    v_and_b32 v214, s22, v214
    v_add_f32 v252, v252, v248
    v_mfma_f32_16x16x32_bf16 v[172:175], v[240:243], v[236:239], v[172:175]
    s_add_u32 s42, s37, 1293312
    v_add_f32 v214, v214, v206
    v_fmac_f32 v252, s23, v250
    v_mfma_f32_16x16x32_bf16 v[176:179], v[244:247], v[236:239], v[176:179]
    ds_read_b128 v[236:239], v253 offset:29888
    v_fmac_f32 v214, s23, v210
    v_mfma_f32_16x16x32_bf16 v[180:183], a[252:255], v[228:231], v[180:183]
    buffer_load_dwordx4 a[240:243], v254, s[8:11], s42 offen offset:0 sc1
    v_mfma_f32_16x16x32_bf16 v[184:187], v[240:243], v[228:231], v[184:187]
    s_waitcnt vmcnt(13) lgkmcnt(1)
    v_cvt_pk_bf16_f32 v214, v252, v214
    v_fma_f32 v252, v249, s24, v251
    v_fmac_f32 v251, s25, v249
    v_mfma_f32_16x16x32_bf16 v[188:191], v[244:247], v[228:231], v[188:191]
    ds_read_b128 v[228:231], v253 offset:29632
    v_fma_f32 v249, v248, s24, v250
    v_mfma_f32_16x16x32_bf16 v[96:99], a[192:195], v[232:235], v[96:99]
    ds_read_b128 a[44:47], v6 offset:23840
    v_fmac_f32 v250, s25, v248
    v_mfma_f32_16x16x32_bf16 v[100:103], a[196:199], v[232:235], v[100:103]
    buffer_load_dwordx4 a[244:247], v254, s[8:11], s42 offen offset:1024 sc1
    v_mfma_f32_16x16x32_bf16 v[104:107], a[200:203], v[232:235], v[104:107]
    ds_read_b128 v[232:235], v253 offset:29376
    v_fma_f32 v248, v250, s26, v251
    s_waitcnt lgkmcnt(3)
    v_mfma_f32_16x16x32_bf16 v[108:111], a[192:195], v[236:239], v[108:111]
    v_fmac_f32 v251, s27, v250
    v_fma_f32 v250, v249, s28, v252
    v_mfma_f32_16x16x32_bf16 v[112:115], a[196:199], v[236:239], v[112:115]
    s_waitcnt vmcnt(11)
    v_fmac_f32 v252, s29, v249
    v_fma_f32 v249, v208, s24, v212
    v_mfma_f32_16x16x32_bf16 v[116:119], a[200:203], v[236:239], v[116:119]
    buffer_load_dwordx4 a[248:251], v254, s[8:11], s42 offen offset:2048 sc1
    v_fmac_f32 v212, s25, v208
    v_mfma_f32_16x16x32_bf16 v[96:99], a[204:207], v[236:239], v[96:99]
    s_waitcnt lgkmcnt(2)
    v_fma_f32 v208, v206, s24, v210
    v_fmac_f32 v210, s25, v206
    v_mfma_f32_16x16x32_bf16 v[100:103], a[208:211], v[236:239], v[100:103]
    s_add_u32 s42, s37, 1296384
    v_fma_f32 v206, v210, s26, v212
    v_fmac_f32 v212, s27, v210
    v_mfma_f32_16x16x32_bf16 v[104:107], a[212:215], v[236:239], v[104:107]
    ds_read_b128 v[236:239], v253 offset:29120
    v_fma_f32 v210, v208, s28, v249
    v_mfma_f32_16x16x32_bf16 v[120:123], a[192:195], v[228:231], v[120:123]
    buffer_load_dwordx4 a[252:255], v254, s[8:11], s42 offen offset:0 sc1
    v_mfma_f32_16x16x32_bf16 v[124:127], a[196:199], v[228:231], v[124:127]
    v_fmac_f32 v249, s29, v208
    v_cvt_pk_bf16_f32 v206, v248, v206
    v_mfma_f32_16x16x32_bf16 v[128:131], a[200:203], v[228:231], v[128:131]
    v_cvt_pk_bf16_f32 v212, v251, v212
    v_cvt_pk_bf16_f32 v210, v250, v210
    v_cvt_pk_bf16_f32 v208, v252, v249
    v_mfma_f32_16x16x32_bf16 v[108:111], a[204:207], v[228:231], v[108:111]
    v_lshlrev_b32 v248, 16, v207
    v_lshlrev_b32 v249, 16, v209
    v_mfma_f32_16x16x32_bf16 v[112:115], a[208:211], v[228:231], v[112:115]
    buffer_load_dwordx4 v[240:243], v254, s[8:11], s42 offen offset:1024 sc1
    v_mfma_f32_16x16x32_bf16 v[116:119], a[212:215], v[228:231], v[116:119]
    s_waitcnt vmcnt(11)
    v_lshlrev_b32 v250, 16, v211
    v_lshlrev_b32 v251, 16, v213
    v_mfma_f32_16x16x32_bf16 v[96:99], a[216:219], v[228:231], v[96:99]
    s_waitcnt lgkmcnt(1)
    v_and_b32 v207, s22, v207
    v_and_b32 v209, s22, v209
    v_mfma_f32_16x16x32_bf16 v[100:103], a[220:223], v[228:231], v[100:103]
    buffer_load_dwordx4 v[244:247], v254, s[8:11], s42 offen offset:2048 sc1
    v_mfma_f32_16x16x32_bf16 v[104:107], a[224:227], v[228:231], v[104:107]
    ds_read_b128 v[228:231], v253 offset:30944
    v_and_b32 v203, 0x7fff, v255
    v_mfma_f32_16x16x32_bf16 v[132:135], a[192:195], v[232:235], v[132:135]
    v_and_b32 v211, s22, v211
    v_and_b32 v213, s22, v213
    v_lshlrev_b32 v252, 16, v205
    v_mfma_f32_16x16x32_bf16 v[136:139], a[196:199], v[232:235], v[136:139]
    buffer_load_dwordx2 v[192:193], v203, s[4:7], s16 offen offset:64
    v_mfma_f32_16x16x32_bf16 v[140:143], a[200:203], v[232:235], v[140:143]
    v_and_b32 v205, s22, v205
    v_add_f32 v252, v252, v251
    v_mfma_f32_16x16x32_bf16 v[120:123], a[204:207], v[232:235], v[120:123]
    v_add_f32 v205, v205, v213
    v_fmac_f32 v252, s23, v249
    v_mfma_f32_16x16x32_bf16 v[124:127], a[208:211], v[232:235], v[124:127]
    buffer_load_dwordx2 v[194:195], v203, s[4:7], s17 offen offset:64
    v_mfma_f32_16x16x32_bf16 v[128:131], a[212:215], v[232:235], v[128:131]
    v_fmac_f32 v205, s23, v209
    v_cvt_pk_bf16_f32 v205, v252, v205
    v_mfma_f32_16x16x32_bf16 v[108:111], a[216:219], v[232:235], v[108:111]
    s_waitcnt lgkmcnt(1)
    v_lshlrev_b32 v252, 16, v215
    v_and_b32 v215, s22, v215
    v_mfma_f32_16x16x32_bf16 v[112:115], a[220:223], v[232:235], v[112:115]
    buffer_load_dwordx2 v[196:197], v203, s[4:7], s18 offen offset:64
    v_add_f32 v252, v252, v248
    v_mfma_f32_16x16x32_bf16 v[116:119], a[224:227], v[232:235], v[116:119]
    ds_read_b128 v[232:235], v253 offset:30688
    v_add_f32 v215, v215, v207
    v_mfma_f32_16x16x32_bf16 v[144:147], a[192:195], v[236:239], v[144:147]
    v_fmac_f32 v252, s23, v250
    v_fmac_f32 v215, s23, v211
    v_mfma_f32_16x16x32_bf16 v[148:151], a[196:199], v[236:239], v[148:151]
    buffer_load_dwordx2 v[198:199], v203, s[4:7], s19 offen offset:64
    v_mfma_f32_16x16x32_bf16 v[152:155], a[200:203], v[236:239], v[152:155]
    v_cvt_pk_bf16_f32 v215, v252, v215
    v_fma_f32 v252, v249, s24, v251
    v_mfma_f32_16x16x32_bf16 v[132:135], a[204:207], v[236:239], v[132:135]
    v_fmac_f32 v251, s25, v249
    v_fma_f32 v249, v248, s24, v250
    v_mfma_f32_16x16x32_bf16 v[136:139], a[208:211], v[236:239], v[136:139]
    buffer_load_dwordx2 v[200:201], v203, s[4:7], s20 offen offset:64
    v_fmac_f32 v250, s25, v248
    v_mfma_f32_16x16x32_bf16 v[140:143], a[212:215], v[236:239], v[140:143]
    v_fma_f32 v248, v250, s26, v251
    v_fmac_f32 v251, s27, v250
    v_mfma_f32_16x16x32_bf16 v[120:123], a[216:219], v[236:239], v[120:123]
    s_waitcnt lgkmcnt(1)
    v_fma_f32 v250, v249, s28, v252
    v_fmac_f32 v252, s29, v249
    v_mfma_f32_16x16x32_bf16 v[124:127], a[220:223], v[236:239], v[124:127]
    buffer_load_dwordx2 v[202:203], v203, s[4:7], s21 offen offset:64
    v_mfma_f32_16x16x32_bf16 v[128:131], a[224:227], v[236:239], v[128:131]
    ds_read_b128 v[236:239], v253 offset:30432
    v_fma_f32 v249, v209, s24, v213
    v_mfma_f32_16x16x32_bf16 v[156:159], a[192:195], v[228:231], v[156:159]
    v_fmac_f32 v213, s25, v209
    v_fma_f32 v209, v207, s24, v211
    v_mfma_f32_16x16x32_bf16 v[160:163], a[196:199], v[228:231], v[160:163]
    buffer_store_dwordx4 a[24:27], v254, s[12:15], s44 offen sc1
    s_add_u32 s44, s40, 7168
    v_mfma_f32_16x16x32_bf16 v[164:167], a[200:203], v[228:231], v[164:167]
    v_fmac_f32 v211, s25, v207
    v_fma_f32 v207, v211, s26, v213
    v_fmac_f32 v213, s27, v211
    v_mfma_f32_16x16x32_bf16 v[144:147], a[204:207], v[228:231], v[144:147]
    v_fma_f32 v211, v209, s28, v249
    v_fmac_f32 v249, s29, v209
    v_mfma_f32_16x16x32_bf16 v[148:151], a[208:211], v[228:231], v[148:151]
    buffer_store_dwordx4 a[28:31], v254, s[12:15], s44 offen sc1
    s_add_u32 s44, s40, 8192
    v_mfma_f32_16x16x32_bf16 v[152:155], a[212:215], v[228:231], v[152:155]
    v_cvt_pk_bf16_f32 v207, v248, v207
    v_cvt_pk_bf16_f32 v213, v251, v213
    v_mfma_f32_16x16x32_bf16 v[132:135], a[216:219], v[228:231], v[132:135]
    s_waitcnt lgkmcnt(1)
    v_cvt_pk_bf16_f32 v211, v250, v211
    v_cvt_pk_bf16_f32 v209, v252, v249
    v_mfma_f32_16x16x32_bf16 v[136:139], a[220:223], v[228:231], v[136:139]
    buffer_store_dwordx4 a[32:35], v254, s[12:15], s44 offen sc1
    s_add_u32 s44, s40, 9216
    v_lshrrev_b32 v252, 15, v255
    v_mfma_f32_16x16x32_bf16 v[140:143], a[224:227], v[228:231], v[140:143]
    ds_read_b128 v[228:231], v253 offset:30176
    v_mfma_f32_16x16x32_bf16 v[168:171], a[192:195], v[232:235], v[168:171]
    ds_write_b64 v252, v[206:207] offset:0
    v_mfma_f32_16x16x32_bf16 v[172:175], a[196:199], v[232:235], v[172:175]
    v_mfma_f32_16x16x32_bf16 v[176:179], a[200:203], v[232:235], v[176:179]
    ds_write_b64 v252, v[212:213] offset:2080
    v_mfma_f32_16x16x32_bf16 v[156:159], a[204:207], v[232:235], v[156:159]
    v_mfma_f32_16x16x32_bf16 v[160:163], a[208:211], v[232:235], v[160:163]
    ds_write_b64 v252, v[210:211] offset:4160
    v_mfma_f32_16x16x32_bf16 v[164:167], a[212:215], v[232:235], v[164:167]
    v_mfma_f32_16x16x32_bf16 v[144:147], a[216:219], v[232:235], v[144:147]
    ds_write_b64 v252, v[204:205] offset:33280
    v_mfma_f32_16x16x32_bf16 v[148:151], a[220:223], v[232:235], v[148:151]
    s_waitcnt lgkmcnt(5)
    v_mfma_f32_16x16x32_bf16 v[152:155], a[224:227], v[232:235], v[152:155]
    ds_read_b128 v[232:235], v253 offset:29904
    v_mfma_f32_16x16x32_bf16 v[180:183], a[192:195], v[236:239], v[180:183]
    ds_write_b64 v252, v[214:215] offset:35360
    v_mfma_f32_16x16x32_bf16 v[184:187], a[196:199], v[236:239], v[184:187]
    v_mfma_f32_16x16x32_bf16 v[188:191], a[200:203], v[236:239], v[188:191]
    s_add_u32 s42, s32, 0
    v_mfma_f32_16x16x32_bf16 v[168:171], a[204:207], v[236:239], v[168:171]
    buffer_load_dwordx4 a[192:195], v254, s[8:11], s42 offen offset:0 sc1
    v_mfma_f32_16x16x32_bf16 v[172:175], a[208:211], v[236:239], v[172:175]
    ds_write_b64 v252, v[208:209] offset:6240
    v_mfma_f32_16x16x32_bf16 v[176:179], a[212:215], v[236:239], v[176:179]
    s_waitcnt lgkmcnt(7)
    v_mfma_f32_16x16x32_bf16 v[156:159], a[216:219], v[236:239], v[156:159]
    buffer_load_dwordx4 a[196:199], v254, s[8:11], s42 offen offset:1024 sc1
    v_mfma_f32_16x16x32_bf16 v[160:163], a[220:223], v[236:239], v[160:163]
    s_waitcnt lgkmcnt(0)
    v_mfma_f32_16x16x32_bf16 v[164:167], a[224:227], v[236:239], v[164:167]
    s_barrier
    v_mfma_f32_16x16x32_bf16 v[180:183], a[204:207], v[228:231], v[180:183]
    ds_read_b128 v[236:239], v253 offset:32240
    v_mfma_f32_16x16x32_bf16 v[184:187], a[208:211], v[228:231], v[184:187]
    v_mfma_f32_16x16x32_bf16 v[188:191], a[212:215], v[228:231], v[188:191]
    buffer_load_dwordx4 a[200:203], v254, s[8:11], s42 offen offset:2048 sc1
    v_mfma_f32_16x16x32_bf16 v[168:171], a[216:219], v[228:231], v[168:171]
    v_mfma_f32_16x16x32_bf16 v[172:175], a[220:223], v[228:231], v[172:175]
    s_add_u32 s42, s32, 3072
    v_mfma_f32_16x16x32_bf16 v[176:179], a[224:227], v[228:231], v[176:179]
    ds_read_b128 v[228:231], v253 offset:31968
    v_mfma_f32_16x16x32_bf16 v[180:183], a[216:219], v[232:235], v[180:183]
    buffer_load_dwordx4 a[204:207], v254, s[8:11], s42 offen offset:0 sc1
    v_mfma_f32_16x16x32_bf16 v[184:187], a[220:223], v[232:235], v[184:187]
    s_waitcnt vmcnt(19) lgkmcnt(1)
    v_mfma_f32_16x16x32_bf16 v[188:191], a[224:227], v[232:235], v[188:191]
    ds_read_b128 v[232:235], v253 offset:31712
    v_mfma_f32_16x16x32_bf16 v[96:99], a[228:231], v[236:239], v[96:99]
    s_waitcnt lgkmcnt(1)
    v_mfma_f32_16x16x32_bf16 v[100:103], a[232:235], v[236:239], v[100:103]
    buffer_load_dwordx4 a[208:211], v254, s[8:11], s42 offen offset:1024 sc1
    v_mfma_f32_16x16x32_bf16 v[104:107], a[236:239], v[236:239], v[104:107]
    ds_read_b128 v[236:239], v253 offset:31456
    v_mfma_f32_16x16x32_bf16 v[108:111], a[228:231], v[228:231], v[108:111]
    v_mfma_f32_16x16x32_bf16 v[112:115], a[232:235], v[228:231], v[112:115]
    s_waitcnt vmcnt(17)
    v_mfma_f32_16x16x32_bf16 v[116:119], a[236:239], v[228:231], v[116:119]
    buffer_load_dwordx4 a[212:215], v254, s[8:11], s42 offen offset:2048 sc1
    v_mfma_f32_16x16x32_bf16 v[96:99], a[240:243], v[228:231], v[96:99]
    s_waitcnt lgkmcnt(1)
    v_mfma_f32_16x16x32_bf16 v[100:103], a[244:247], v[228:231], v[100:103]
    s_add_u32 s42, s32, 6144
    v_mfma_f32_16x16x32_bf16 v[104:107], a[248:251], v[228:231], v[104:107]
    ds_read_b128 v[228:231], v253 offset:31200
    v_mfma_f32_16x16x32_bf16 v[120:123], a[228:231], v[232:235], v[120:123]
    buffer_load_dwordx4 a[216:219], v254, s[8:11], s42 offen offset:0 sc1
    v_mfma_f32_16x16x32_bf16 v[124:127], a[232:235], v[232:235], v[124:127]
    v_mfma_f32_16x16x32_bf16 v[128:131], a[236:239], v[232:235], v[128:131]
    v_mfma_f32_16x16x32_bf16 v[108:111], a[240:243], v[232:235], v[108:111]
    v_mfma_f32_16x16x32_bf16 v[112:115], a[244:247], v[232:235], v[112:115]
    buffer_load_dwordx4 a[220:223], v254, s[8:11], s42 offen offset:1024 sc1
    v_mfma_f32_16x16x32_bf16 v[116:119], a[248:251], v[232:235], v[116:119]
    s_waitcnt vmcnt(17)
    v_mfma_f32_16x16x32_bf16 v[96:99], a[252:255], v[232:235], v[96:99]
    s_waitcnt lgkmcnt(1)
    v_mfma_f32_16x16x32_bf16 v[100:103], v[240:243], v[232:235], v[100:103]
    buffer_load_dwordx4 a[224:227], v254, s[8:11], s42 offen offset:2048 sc1
    v_mfma_f32_16x16x32_bf16 v[104:107], v[244:247], v[232:235], v[104:107]
    ds_read_b128 v[232:235], v253 offset:33024
    v_and_b32 v215, 0x7fff, v255
    v_mfma_f32_16x16x32_bf16 v[132:135], a[228:231], v[236:239], v[132:135]
    v_mfma_f32_16x16x32_bf16 v[136:139], a[232:235], v[236:239], v[136:139]
    buffer_load_dwordx2 v[204:205], v215, s[4:7], s16 offen offset:448
    v_mfma_f32_16x16x32_bf16 v[140:143], a[236:239], v[236:239], v[140:143]
    v_mfma_f32_16x16x32_bf16 v[120:123], a[240:243], v[236:239], v[120:123]
    v_mfma_f32_16x16x32_bf16 v[124:127], a[244:247], v[236:239], v[124:127]
    buffer_load_dwordx2 v[206:207], v215, s[4:7], s17 offen offset:448
    v_mfma_f32_16x16x32_bf16 v[128:131], a[248:251], v[236:239], v[128:131]
    s_waitcnt lgkmcnt(1)
    v_cvt_pk_bf16_f32 v104, v104, v105
    v_cvt_pk_bf16_f32 v105, v106, v107
    v_mfma_f32_16x16x32_bf16 v[108:111], a[252:255], v[236:239], v[108:111]
    ds_write_b64 v5, v[104:105] offset:16704
    v_mfma_f32_16x16x32_bf16 v[112:115], v[240:243], v[236:239], v[112:115]
    buffer_load_dwordx2 v[208:209], v215, s[4:7], s18 offen offset:448
    v_mfma_f32_16x16x32_bf16 v[116:119], v[244:247], v[236:239], v[116:119]
    ds_read_b128 v[236:239], v253 offset:32768
    v_cvt_pk_bf16_f32 v96, v96, v97
    v_mfma_f32_16x16x32_bf16 v[144:147], a[228:231], v[228:231], v[144:147]
    v_cvt_pk_bf16_f32 v97, v98, v99
    v_cvt_pk_bf16_f32 v98, v100, v101
    v_mfma_f32_16x16x32_bf16 v[148:151], a[232:235], v[228:231], v[148:151]
    buffer_load_dwordx2 v[210:211], v215, s[4:7], s19 offen offset:448
    v_mfma_f32_16x16x32_bf16 v[152:155], a[236:239], v[228:231], v[152:155]
    v_cvt_pk_bf16_f32 v99, v102, v103
    v_mfma_f32_16x16x32_bf16 v[132:135], a[240:243], v[228:231], v[132:135]
    ds_write_b128 v4, v[96:99] offset:16640
    v_mfma_f32_16x16x32_bf16 v[136:139], a[244:247], v[228:231], v[136:139]
    buffer_load_dwordx2 v[212:213], v215, s[4:7], s20 offen offset:448
    v_mfma_f32_16x16x32_bf16 v[140:143], a[248:251], v[228:231], v[140:143]
    v_cvt_pk_bf16_f32 v116, v116, v117
    v_cvt_pk_bf16_f32 v117, v118, v119
    v_mfma_f32_16x16x32_bf16 v[120:123], a[252:255], v[228:231], v[120:123]
    s_waitcnt lgkmcnt(3)
    v_mfma_f32_16x16x32_bf16 v[124:127], v[240:243], v[228:231], v[124:127]
    buffer_load_dwordx2 v[214:215], v215, s[4:7], s21 offen offset:448
    v_mfma_f32_16x16x32_bf16 v[128:131], v[244:247], v[228:231], v[128:131]
    ds_read_b128 v[228:231], v253 offset:32512
    v_mfma_f32_16x16x32_bf16 v[156:159], a[228:231], v[232:235], v[156:159]
    ds_write_b64 v5, v[116:117] offset:17088
    v_mfma_f32_16x16x32_bf16 v[160:163], a[232:235], v[232:235], v[160:163]
    buffer_store_dwordx4 a[36:39], v254, s[12:15], s44 offen sc1
    s_add_u32 s44, s40, 10240
    v_mfma_f32_16x16x32_bf16 v[164:167], a[236:239], v[232:235], v[164:167]
    v_cvt_pk_bf16_f32 v108, v108, v109
    v_cvt_pk_bf16_f32 v109, v110, v111
    v_mfma_f32_16x16x32_bf16 v[144:147], a[240:243], v[232:235], v[144:147]
    v_cvt_pk_bf16_f32 v110, v112, v113
    v_cvt_pk_bf16_f32 v111, v114, v115
    v_mfma_f32_16x16x32_bf16 v[148:151], a[244:247], v[232:235], v[148:151]
    buffer_store_dwordx4 a[40:43], v254, s[12:15], s44 offen sc1
    s_add_u32 s44, s40, 11264
    v_mfma_f32_16x16x32_bf16 v[152:155], a[248:251], v[232:235], v[152:155]
    ds_write_b128 v4, v[108:111] offset:17024
    v_mfma_f32_16x16x32_bf16 v[132:135], a[252:255], v[232:235], v[132:135]
    s_waitcnt lgkmcnt(4)
    v_cvt_pk_bf16_f32 v128, v128, v129
    v_cvt_pk_bf16_f32 v129, v130, v131
    v_mfma_f32_16x16x32_bf16 v[136:139], v[240:243], v[232:235], v[136:139]
    buffer_store_dwordx4 a[44:47], v254, s[12:15], s44 offen sc1
    v_mfma_f32_16x16x32_bf16 v[140:143], v[244:247], v[232:235], v[140:143]
    ds_read_b128 v[232:235], v253 offset:32256
    v_mfma_f32_16x16x32_bf16 v[168:171], a[228:231], v[236:239], v[168:171]
    ds_write_b64 v5, v[128:129] offset:17472
    v_mfma_f32_16x16x32_bf16 v[172:175], a[232:235], v[236:239], v[172:175]
    v_cvt_pk_bf16_f32 v120, v120, v121
    v_cvt_pk_bf16_f32 v121, v122, v123
    v_mfma_f32_16x16x32_bf16 v[176:179], a[236:239], v[236:239], v[176:179]
    v_cvt_pk_bf16_f32 v122, v124, v125
    v_cvt_pk_bf16_f32 v123, v126, v127
    v_mfma_f32_16x16x32_bf16 v[156:159], a[240:243], v[236:239], v[156:159]
    ds_write_b128 v4, v[120:123] offset:17408
    v_mfma_f32_16x16x32_bf16 v[160:163], a[244:247], v[236:239], v[160:163]
    v_mfma_f32_16x16x32_bf16 v[164:167], a[248:251], v[236:239], v[164:167]
    v_cvt_pk_bf16_f32 v140, v140, v141
    v_cvt_pk_bf16_f32 v141, v142, v143
    v_mfma_f32_16x16x32_bf16 v[144:147], a[252:255], v[236:239], v[144:147]
    s_waitcnt lgkmcnt(5)
    v_mfma_f32_16x16x32_bf16 v[148:151], v[240:243], v[236:239], v[148:151]
    ds_write_b64 v5, v[140:141] offset:17856
    v_mfma_f32_16x16x32_bf16 v[152:155], v[244:247], v[236:239], v[152:155]
    ds_read_b128 v[236:239], v253 offset:31984
    v_cvt_pk_bf16_f32 v132, v132, v133
    v_mfma_f32_16x16x32_bf16 v[180:183], a[228:231], v[228:231], v[180:183]
    v_cvt_pk_bf16_f32 v133, v134, v135
    v_cvt_pk_bf16_f32 v134, v136, v137
    v_mfma_f32_16x16x32_bf16 v[184:187], a[232:235], v[228:231], v[184:187]
    v_cvt_pk_bf16_f32 v135, v138, v139
    v_mfma_f32_16x16x32_bf16 v[188:191], a[236:239], v[228:231], v[188:191]
    s_add_u32 s42, s32, 36864
    v_mfma_f32_16x16x32_bf16 v[168:171], a[240:243], v[228:231], v[168:171]
    buffer_load_dwordx4 a[228:231], v254, s[8:11], s42 offen offset:0 sc1
    v_mfma_f32_16x16x32_bf16 v[172:175], a[244:247], v[228:231], v[172:175]
    ds_write_b128 v4, v[132:135] offset:17792
    v_mfma_f32_16x16x32_bf16 v[176:179], a[248:251], v[228:231], v[176:179]
    v_cvt_pk_bf16_f32 v152, v152, v153
    v_cvt_pk_bf16_f32 v153, v154, v155
    v_mfma_f32_16x16x32_bf16 v[156:159], a[252:255], v[228:231], v[156:159]
    buffer_load_dwordx4 a[232:235], v254, s[8:11], s42 offen offset:1024 sc1
    v_mfma_f32_16x16x32_bf16 v[160:163], v[240:243], v[228:231], v[160:163]
    s_waitcnt lgkmcnt(5)
    v_mfma_f32_16x16x32_bf16 v[164:167], v[244:247], v[228:231], v[164:167]
    ds_write_b64 v5, v[152:153] offset:18240
    v_mfma_f32_16x16x32_bf16 v[180:183], a[240:243], v[232:235], v[180:183]
    ds_read_b128 v[228:231], v253 offset:1040
    v_cvt_pk_bf16_f32 v144, v144, v145
    v_mfma_f32_16x16x32_bf16 v[184:187], a[244:247], v[232:235], v[184:187]
    v_cvt_pk_bf16_f32 v145, v146, v147
    v_cvt_pk_bf16_f32 v146, v148, v149
    v_mfma_f32_16x16x32_bf16 v[188:191], a[248:251], v[232:235], v[188:191]
    buffer_load_dwordx4 a[236:239], v254, s[8:11], s42 offen offset:2048 sc1
    v_mfma_f32_16x16x32_bf16 v[168:171], a[252:255], v[232:235], v[168:171]
    s_waitcnt lgkmcnt(3)
    v_cvt_pk_bf16_f32 v147, v150, v151
    v_mfma_f32_16x16x32_bf16 v[172:175], v[240:243], v[232:235], v[172:175]
    s_add_u32 s42, s32, 39936
    v_mfma_f32_16x16x32_bf16 v[176:179], v[244:247], v[232:235], v[176:179]
    ds_read_b128 v[232:235], v253 offset:768
    v_mfma_f32_16x16x32_bf16 v[180:183], a[252:255], v[236:239], v[180:183]
    buffer_load_dwordx4 a[240:243], v254, s[8:11], s42 offen offset:0 sc1
    v_mfma_f32_16x16x32_bf16 v[184:187], v[240:243], v[236:239], v[184:187]
    ds_write_b128 v4, v[144:147] offset:18176
    v_mfma_f32_16x16x32_bf16 v[188:191], v[244:247], v[236:239], v[188:191]
    ds_read_b128 v[236:239], v253 offset:512
    s_waitcnt vmcnt(19)
    s_waitcnt lgkmcnt(3)
    s_add_u32 s41, s40, 589824
    s_add_u32 s40, s40, 6291456
    s_mov_b32 s33, 2130706432
    s_add_u32 s39, s39, 1
    s_cmp_lt_u32 s39, 2
    s_cbranch_scc1 blk_loop
    v_cvt_pk_bf16_f32 v164, v164, v165
    v_cvt_pk_bf16_f32 v165, v166, v167
    ds_write_b64 v5, v[164:165] offset:18624
    v_cvt_pk_bf16_f32 v156, v156, v157
    v_cvt_pk_bf16_f32 v157, v158, v159
    v_cvt_pk_bf16_f32 v158, v160, v161
    v_cvt_pk_bf16_f32 v159, v162, v163
    ds_write_b128 v4, v[156:159] offset:18560
    v_cvt_pk_bf16_f32 v176, v176, v177
    v_cvt_pk_bf16_f32 v177, v178, v179
    ds_write_b64 v5, v[176:177] offset:19008
    v_cvt_pk_bf16_f32 v168, v168, v169
    v_cvt_pk_bf16_f32 v169, v170, v171
    v_cvt_pk_bf16_f32 v170, v172, v173
    v_cvt_pk_bf16_f32 v171, v174, v175
    ds_write_b128 v4, v[168:171] offset:18944
    v_cvt_pk_bf16_f32 v188, v188, v189
    v_cvt_pk_bf16_f32 v189, v190, v191
    ds_write_b64 v5, v[188:189] offset:19392
    v_cvt_pk_bf16_f32 v180, v180, v181
    v_cvt_pk_bf16_f32 v181, v182, v183
    v_cvt_pk_bf16_f32 v182, v184, v185
    v_cvt_pk_bf16_f32 v183, v186, v187
    ds_write_b128 v4, v[180:183] offset:19328
    s_waitcnt lgkmcnt(0)
    s_barrier
    ds_read_b128 v[144:147], v6 offset:16640
    ds_read_b128 v[148:151], v6 offset:17664
    ds_read_b128 v[152:155], v6 offset:18688
    ds_read_b128 v[156:159], v6 offset:19744
    ds_read_b128 v[160:163], v6 offset:20768
    ds_read_b128 v[164:167], v6 offset:21792
    ds_read_b128 v[168:171], v6 offset:22848
    ds_read_b128 v[172:175], v6 offset:23872
    ds_read_b128 v[176:179], v6 offset:24896
    ds_read_b128 v[180:183], v6 offset:25952
    ds_read_b128 v[184:187], v6 offset:26976
    ds_read_b128 v[188:191], v6 offset:28000
    s_add_u32 s44, s41, 0
    s_waitcnt lgkmcnt(11)
    buffer_store_dwordx4 v[144:147], v254, s[12:15], s44 offen sc1
    s_add_u32 s44, s41, 1024
    s_waitcnt lgkmcnt(10)
    buffer_store_dwordx4 v[148:151], v254, s[12:15], s44 offen sc1
    s_add_u32 s44, s41, 2048
    s_waitcnt lgkmcnt(9)
    buffer_store_dwordx4 v[152:155], v254, s[12:15], s44 offen sc1
    s_add_u32 s44, s41, 3072
    s_waitcnt lgkmcnt(8)
    buffer_store_dwordx4 v[156:159], v254, s[12:15], s44 offen sc1
    s_add_u32 s44, s41, 4096
    s_waitcnt lgkmcnt(7)
    buffer_store_dwordx4 v[160:163], v254, s[12:15], s44 offen sc1
    s_add_u32 s44, s41, 5120
    s_waitcnt lgkmcnt(6)
    buffer_store_dwordx4 v[164:167], v254, s[12:15], s44 offen sc1
    s_add_u32 s44, s41, 6144
    s_waitcnt lgkmcnt(5)
    buffer_store_dwordx4 v[168:171], v254, s[12:15], s44 offen sc1
    s_add_u32 s44, s41, 7168
    s_waitcnt lgkmcnt(4)
    buffer_store_dwordx4 v[172:175], v254, s[12:15], s44 offen sc1
    s_add_u32 s44, s41, 8192
    s_waitcnt lgkmcnt(3)
    buffer_store_dwordx4 v[176:179], v254, s[12:15], s44 offen sc1
    s_add_u32 s44, s41, 9216
    s_waitcnt lgkmcnt(2)
    buffer_store_dwordx4 v[180:183], v254, s[12:15], s44 offen sc1
    s_add_u32 s44, s41, 10240
    s_waitcnt lgkmcnt(1)
    buffer_store_dwordx4 v[184:187], v254, s[12:15], s44 offen sc1
    s_add_u32 s44, s41, 11264
    s_waitcnt lgkmcnt(0)
    buffer_store_dwordx4 v[188:191], v254, s[12:15], s44 offen sc1
main_done:
    s_endpgm
code_end:
wt_loop:
    s_mul_i32 s73, s70, 43691
    s_lshr_b32 s73, s73, 17
    s_mul_i32 s74, s73, 3
    s_sub_u32 s74, s70, s74
    s_mul_i32 s75, s73, 43691
    s_lshr_b32 s75, s75, 17
    s_mul_i32 s76, s75, 3
    s_sub_u32 s76, s73, s76
    v_and_b32 v101, 15, v2
    v_lshrrev_b32 v102, 4, v2
    v_and_b32 v103, 12, v101
    s_lshl_b32 s78, s74, 2
    s_cmp_lt_u32 s74, 2
    s_cselect_b32 s77, 1, 0
    s_cselect_b32 s78, s78, 32
    v_mul_u32_u24 v103, s77, v103
    v_add_u32 v103, v103, v101
    v_add_u32 v103, s78, v103
    v_lshl_add_u32 v103, v103, 1, s52
    v_mul_u32_u24 v104, 3072, v102
    v_add_u32 v103, v103, v104
    s_mul_i32 s79, s76, 73728
    s_mul_i32 s80, s75, 12288
    s_add_u32 s79, s79, s80
    s_add_u32 s80, s79, 221184
    s_add_u32 s81, s79, 442368
    buffer_load_ushort v110, v103, s[60:63], s79 offen offset:0
    buffer_load_ushort v111, v103, s[60:63], s79 offen offset:384
    buffer_load_ushort v112, v103, s[60:63], s79 offen offset:768
    buffer_load_ushort v113, v103, s[60:63], s79 offen offset:1152
    buffer_load_ushort v114, v103, s[60:63], s79 offen offset:1536
    buffer_load_ushort v115, v103, s[60:63], s79 offen offset:1920
    buffer_load_ushort v116, v103, s[60:63], s79 offen offset:2304
    buffer_load_ushort v117, v103, s[60:63], s79 offen offset:2688
    buffer_load_ushort v118, v103, s[60:63], s80 offen offset:0
    buffer_load_ushort v119, v103, s[60:63], s80 offen offset:384
    buffer_load_ushort v120, v103, s[60:63], s80 offen offset:768
    buffer_load_ushort v121, v103, s[60:63], s80 offen offset:1152
    buffer_load_ushort v122, v103, s[60:63], s80 offen offset:1536
    buffer_load_ushort v123, v103, s[60:63], s80 offen offset:1920
    buffer_load_ushort v124, v103, s[60:63], s80 offen offset:2304
    buffer_load_ushort v125, v103, s[60:63], s80 offen offset:2688
    buffer_load_ushort v126, v103, s[60:63], s81 offen offset:0
    buffer_load_ushort v127, v103, s[60:63], s81 offen offset:384
    buffer_load_ushort v128, v103, s[60:63], s81 offen offset:768
    buffer_load_ushort v129, v103, s[60:63], s81 offen offset:1152
    buffer_load_ushort v130, v103, s[60:63], s81 offen offset:1536
    buffer_load_ushort v131, v103, s[60:63], s81 offen offset:1920
    buffer_load_ushort v132, v103, s[60:63], s81 offen offset:2304
    buffer_load_ushort v133, v103, s[60:63], s81 offen offset:2688
    s_mul_i32 s82, s76, 3072
    s_lshl_b32 s83, s74, 10
    s_add_u32 s82, s82, s83
    s_mul_i32 s83, s75, 36864
    s_lshl_b32 s84, s83, 2
    s_add_u32 s83, s83, s82
    s_add_u32 s84, s84, s82
    s_waitcnt vmcnt(0)
    v_lshlrev_b32 v110, 16, v110
    v_lshlrev_b32 v111, 16, v111
    v_lshlrev_b32 v112, 16, v112
    v_lshlrev_b32 v113, 16, v113
    v_lshlrev_b32 v114, 16, v114
    v_lshlrev_b32 v115, 16, v115
    v_lshlrev_b32 v116, 16, v116
    v_lshlrev_b32 v117, 16, v117
    v_lshlrev_b32 v118, 16, v118
    v_lshlrev_b32 v119, 16, v119
    v_lshlrev_b32 v120, 16, v120
    v_lshlrev_b32 v121, 16, v121
    v_lshlrev_b32 v122, 16, v122
    v_lshlrev_b32 v123, 16, v123
    v_lshlrev_b32 v124, 16, v124
    v_lshlrev_b32 v125, 16, v125
    v_lshlrev_b32 v126, 16, v126
    v_lshlrev_b32 v127, 16, v127
    v_lshlrev_b32 v128, 16, v128
    v_lshlrev_b32 v129, 16, v129
    v_lshlrev_b32 v130, 16, v130
    v_lshlrev_b32 v131, 16, v131
    v_lshlrev_b32 v132, 16, v132
    v_lshlrev_b32 v133, 16, v133
    v_mul_f32 v136, 0xbf170c51, v110
    v_fmac_f32 v136, 0xbe6c033f, v126
    v_fmamk_f32 v144, v118, 0xbebccf65, v136
    v_fmac_f32 v136, 0x3ebccf65, v118
    v_mul_f32 v137, 0xbf170c51, v111
    v_fmac_f32 v137, 0xbe6c033f, v127
    v_fmamk_f32 v145, v119, 0xbebccf65, v137
    v_fmac_f32 v137, 0x3ebccf65, v119
    v_mul_f32 v138, 0xbf170c51, v112
    v_fmac_f32 v138, 0xbe6c033f, v128
    v_fmamk_f32 v146, v120, 0xbebccf65, v138
    v_fmac_f32 v138, 0x3ebccf65, v120
    v_mul_f32 v139, 0xbf170c51, v113
    v_fmac_f32 v139, 0xbe6c033f, v129
    v_fmamk_f32 v147, v121, 0xbebccf65, v139
    v_fmac_f32 v139, 0x3ebccf65, v121
    v_mul_f32 v140, 0xbf170c51, v114
    v_fmac_f32 v140, 0xbe6c033f, v130
    v_fmamk_f32 v148, v122, 0xbebccf65, v140
    v_fmac_f32 v140, 0x3ebccf65, v122
    v_mul_f32 v141, 0xbf170c51, v115
    v_fmac_f32 v141, 0xbe6c033f, v131
    v_fmamk_f32 v149, v123, 0xbebccf65, v141
    v_fmac_f32 v141, 0x3ebccf65, v123
    v_mul_f32 v142, 0xbf170c51, v116
    v_fmac_f32 v142, 0xbe6c033f, v132
    v_fmamk_f32 v150, v124, 0xbebccf65, v142
    v_fmac_f32 v142, 0x3ebccf65, v124
    v_mul_f32 v143, 0xbf170c51, v117
    v_fmac_f32 v143, 0xbe6c033f, v133
    v_fmamk_f32 v151, v125, 0xbebccf65, v143
    v_fmac_f32 v143, 0x3ebccf65, v125
    v_cvt_pk_bf16_f32 v156, v144, v145
    v_cvt_pk_bf16_f32 v157, v146, v147
    v_cvt_pk_bf16_f32 v158, v148, v149
    v_cvt_pk_bf16_f32 v159, v150, v151
    s_add_u32 s85, s84, 0
    buffer_store_dwordx4 v[156:159], v254, s[8:11], s85 offen sc1
    v_cvt_pk_bf16_f32 v160, v136, v137
    v_cvt_pk_bf16_f32 v161, v138, v139
    v_cvt_pk_bf16_f32 v162, v140, v141
    v_cvt_pk_bf16_f32 v163, v142, v143
    s_add_u32 s85, s84, 36864
    buffer_store_dwordx4 v[160:163], v254, s[8:11], s85 offen sc1
    v_mul_f32 v136, 0x3e6c033f, v110
    v_fmac_f32 v136, 0x3f170c51, v126
    v_fmamk_f32 v144, v118, 0x3ebccf65, v136
    v_fmac_f32 v136, 0xbebccf65, v118
    v_mul_f32 v137, 0x3e6c033f, v111
    v_fmac_f32 v137, 0x3f170c51, v127
    v_fmamk_f32 v145, v119, 0x3ebccf65, v137
    v_fmac_f32 v137, 0xbebccf65, v119
    v_mul_f32 v138, 0x3e6c033f, v112
    v_fmac_f32 v138, 0x3f170c51, v128
    v_fmamk_f32 v146, v120, 0x3ebccf65, v138
    v_fmac_f32 v138, 0xbebccf65, v120
    v_mul_f32 v139, 0x3e6c033f, v113
    v_fmac_f32 v139, 0x3f170c51, v129
    v_fmamk_f32 v147, v121, 0x3ebccf65, v139
    v_fmac_f32 v139, 0xbebccf65, v121
    v_mul_f32 v140, 0x3e6c033f, v114
    v_fmac_f32 v140, 0x3f170c51, v130
    v_fmamk_f32 v148, v122, 0x3ebccf65, v140
    v_fmac_f32 v140, 0xbebccf65, v122
    v_mul_f32 v141, 0x3e6c033f, v115
    v_fmac_f32 v141, 0x3f170c51, v131
    v_fmamk_f32 v149, v123, 0x3ebccf65, v141
    v_fmac_f32 v141, 0xbebccf65, v123
    v_mul_f32 v142, 0x3e6c033f, v116
    v_fmac_f32 v142, 0x3f170c51, v132
    v_fmamk_f32 v150, v124, 0x3ebccf65, v142
    v_fmac_f32 v142, 0xbebccf65, v124
    v_mul_f32 v143, 0x3e6c033f, v117
    v_fmac_f32 v143, 0x3f170c51, v133
    v_fmamk_f32 v151, v125, 0x3ebccf65, v143
    v_fmac_f32 v143, 0xbebccf65, v125
    v_cvt_pk_bf16_f32 v164, v144, v145
    v_cvt_pk_bf16_f32 v165, v146, v147
    v_cvt_pk_bf16_f32 v166, v148, v149
    v_cvt_pk_bf16_f32 v167, v150, v151
    s_add_u32 s85, s84, 73728
    buffer_store_dwordx4 v[164:167], v254, s[8:11], s85 offen sc1
    v_cvt_pk_bf16_f32 v168, v136, v137
    v_cvt_pk_bf16_f32 v169, v138, v139
    v_cvt_pk_bf16_f32 v170, v140, v141
    v_cvt_pk_bf16_f32 v171, v142, v143
    s_add_u32 s85, s84, 110592
    buffer_store_dwordx4 v[168:171], v254, s[8:11], s85 offen sc1
    v_cvt_pk_bf16_f32 v152, v110, v111
    v_cvt_pk_bf16_f32 v153, v112, v113
    v_cvt_pk_bf16_f32 v154, v114, v115
    v_cvt_pk_bf16_f32 v155, v116, v117
    s_add_u32 s85, s83, 884736
    buffer_store_dwordx4 v[152:155], v254, s[8:11], s85 offen sc1
    v_cvt_pk_bf16_f32 v172, v126, v127
    v_cvt_pk_bf16_f32 v173, v128, v129
    v_cvt_pk_bf16_f32 v174, v130, v131
    v_cvt_pk_bf16_f32 v175, v132, v133
    s_add_u32 s85, s83, 1105920
    buffer_store_dwordx4 v[172:175], v254, s[8:11], s85 offen sc1
    s_add_u32 s70, s70, 1
    s_cmp_lt_u32 s70, 54
    s_cbranch_scc1 wt_loop
    s_waitcnt vmcnt(0)
    s_branch u_ready
.section .rodata,"a"
.p2align 6
.amdhsa_kernel standalone__winograd__vision_kernel
  .amdhsa_next_free_vgpr 512
  .amdhsa_next_free_sgpr 102
  .amdhsa_accum_offset 256
  .amdhsa_group_segment_fixed_size 0
  .amdhsa_kernarg_size 40
  .amdhsa_user_sgpr_count 2
  .amdhsa_user_sgpr_kernarg_segment_ptr 1
  .amdhsa_system_sgpr_workgroup_id_x 1
  .amdhsa_float_denorm_mode_32 3
.end_amdhsa_kernel
```

```asm
; @launch grid=(256,1,1) block=(256,1,1) lds=163840
.amdgcn_target "amdgcn-amd-amdhsa--gfx950"
.text
.globl standalone__winograd__vision_kernel
.p2align 8
.type standalone__winograd__vision_kernel,@function
standalone__winograd__vision_kernel:
    s_cmp_ge_u32 s2, 256
    s_cbranch_scc1 main_done
    s_load_dwordx4 s[4:7], s[0:1], 0
    s_load_dwordx4 s[12:15], s[0:1], 16
    s_load_dwordx2 s[8:9], s[0:1], 32
    s_getpc_b64 s[92:93]
pcref:
    v_and_b32 v70, 3, v0
    v_lshrrev_b32 v71, 6, v0
    v_lshl_add_u32 v70, v70, 7, v71
    s_lshr_b32 s94, s2, 3
    s_lshl_b32 s94, s94, 2
    v_add_lshl_u32 v70, v70, s94, 7
    v_min_u32 v70, code_end-pcref-4, v70
    v_add_co_u32 v72, vcc, s92, v70
    v_mov_b32 v73, s93
    s_nop 0
    v_addc_co_u32 v73, vcc, 0, v73, vcc
    global_load_dword v76, v[72:73], off
    v_lshrrev_b32 v1, 6, v0
    v_and_b32 v2, 63, v0
    v_readfirstlane_b32 s38, v1
    v_lshlrev_b32 v254, 4, v2
    v_mov_b32 v98, 0
    v_lshrrev_b32 v3, 3, v2
    v_and_b32 v4, 7, v2
    v_mul_u32_u24 v5, 3072, v3
    v_lshl_add_u32 v255, v4, 3, v5
    s_lshr_b32 s44, s2, 3
    s_and_b32 s48, s44, 3
    s_lshr_b32 s44, s44, 2
    s_and_b32 s49, s2, 7
    s_lshl_b32 s49, s49, 4
    s_add_u32 s49, s49, s44
    s_and_b32 s90, s38, 1
    s_lshr_b32 s91, s38, 1
    s_and_b32 s89, s48, 0
    s_mul_i32 s50, s90, 24576
    s_mul_i32 s45, s91, 1536
    s_add_u32 s50, s50, s45
    s_lshl_b32 s45, s89, 6
    s_add_u32 s50, s50, s45
    s_mul_i32 s101, s38, 196608
    s_sub_u32 s101, s101, s50
    s_mul_i32 s53, s48, 49152
    s_add_u32 s53, s53, s50
    s_mul_i32 s43, s49, 786432
    s_add_u32 s43, s43, s53
    s_cmp_ge_u32 s49, 128
    s_cselect_b32 s43, 2130706432, s43
    s_sub_u32 s16, s43, 196608
    s_cmp_eq_u32 s49, 0
    s_cselect_b32 s16, 2130706432, s16
    s_mov_b32 s17, s43
    s_add_u32 s18, s43, 196608
    s_add_u32 s19, s43, 393216
    s_add_u32 s20, s43, 589824
    s_add_u32 s21, s43, 786432
    s_add_u32 s100, s43, s101
    s_mul_i32 s52, s38, 96
    s_mul_i32 s44, s38, 9216
    s_mov_b32 s70, s2
    v_mov_b32 v80, v255
    s_mul_i32 s73, s70, 43691
    s_lshr_b32 s73, s73, 17
    s_mul_i32 s74, s73, 3
    s_sub_u32 s74, s70, s74
    s_mul_i32 s75, s73, 43691
    s_lshr_b32 s75, s75, 17
    s_mul_i32 s76, s75, 3
    s_sub_u32 s76, s73, s76
    v_and_b32 v101, 15, v2
    v_lshrrev_b32 v102, 4, v2
    v_and_b32 v103, 12, v101
    s_lshl_b32 s78, s74, 2
    s_cmp_lt_u32 s74, 2
    s_cselect_b32 s77, 1, 0
    s_cselect_b32 s78, s78, 32
    v_mul_u32_u24 v103, s77, v103
    v_add_u32 v103, v103, v101
    v_add_u32 v103, s78, v103
    v_lshl_add_u32 v103, v103, 1, s52
    v_mul_u32_u24 v104, 3072, v102
    v_add_u32 v103, v103, v104
    s_mul_i32 s79, s76, 73728
    s_mul_i32 s80, s75, 12288
    s_add_u32 s79, s79, s80
    s_add_u32 s80, s79, 221184
    s_add_u32 s81, s79, 442368
    s_waitcnt lgkmcnt(0)
    s_mov_b32 s60, s6
    s_and_b32 s61, s7, 0xffff
    s_mov_b32 s62, 663552
    s_mov_b32 s63, 0x20000
    s_and_b32 s5, s5, 0xffff
    s_mov_b32 s6, 100663296
    s_mov_b32 s7, 0x20000
    s_add_u32 s8, s8, s44
    s_addc_u32 s9, s9, 0
    s_and_b32 s9, s9, 0xffff
    s_mov_b32 s10, 1299456
    s_mov_b32 s11, 0x20000
    s_mov_b32 s64, s14
    s_and_b32 s65, s15, 0xffff
    s_mov_b32 s66, 256
    s_mov_b32 s67, 0x20000
    s_mov_b64 s[68:69], s[14:15]
    s_mov_b32 s10, 1331200
    s_mov_b32 s88, 1327104
    buffer_load_dword v78, v98, s[8:11], s88 offen
    buffer_load_dword v79, v98, s[64:67], 0 offen offset:128 sc1
    s_cmp_lt_u32 s2, 54
    s_cbranch_scc1 wt_path
    buffer_load_dwordx2 v[8:9], v80, s[4:7], s16 offen offset:0
    buffer_load_dwordx2 v[10:11], v80, s[4:7], s17 offen offset:0
    buffer_load_dwordx2 v[12:13], v80, s[4:7], s18 offen offset:0
    buffer_load_dwordx2 v[14:15], v80, s[4:7], s19 offen offset:0
    buffer_load_dwordx2 v[16:17], v80, s[4:7], s20 offen offset:0
    buffer_load_dwordx2 v[18:19], v80, s[4:7], s21 offen offset:0
    buffer_load_dwordx2 v[20:21], v80, s[4:7], s16 offen offset:384
    buffer_load_dwordx2 v[22:23], v80, s[4:7], s17 offen offset:384
    buffer_load_dwordx2 v[24:25], v80, s[4:7], s18 offen offset:384
    buffer_load_dwordx2 v[26:27], v80, s[4:7], s19 offen offset:384
    buffer_load_dwordx2 v[28:29], v80, s[4:7], s20 offen offset:384
    buffer_load_dwordx2 v[30:31], v80, s[4:7], s21 offen offset:384
    s_branch wt_join
wt_path:
    buffer_load_ushort v110, v103, s[60:63], s79 offen offset:0
    buffer_load_ushort v111, v103, s[60:63], s79 offen offset:384
    buffer_load_ushort v112, v103, s[60:63], s79 offen offset:768
    buffer_load_ushort v113, v103, s[60:63], s79 offen offset:1152
    buffer_load_ushort v114, v103, s[60:63], s79 offen offset:1536
    buffer_load_ushort v115, v103, s[60:63], s79 offen offset:1920
    buffer_load_ushort v116, v103, s[60:63], s79 offen offset:2304
    buffer_load_ushort v117, v103, s[60:63], s79 offen offset:2688
    buffer_load_ushort v118, v103, s[60:63], s80 offen offset:0
    buffer_load_ushort v119, v103, s[60:63], s80 offen offset:384
    buffer_load_ushort v120, v103, s[60:63], s80 offen offset:768
    buffer_load_ushort v121, v103, s[60:63], s80 offen offset:1152
    buffer_load_ushort v122, v103, s[60:63], s80 offen offset:1536
    buffer_load_ushort v123, v103, s[60:63], s80 offen offset:1920
    buffer_load_ushort v124, v103, s[60:63], s80 offen offset:2304
    buffer_load_ushort v125, v103, s[60:63], s80 offen offset:2688
    buffer_load_ushort v126, v103, s[60:63], s81 offen offset:0
    buffer_load_ushort v127, v103, s[60:63], s81 offen offset:384
    buffer_load_ushort v128, v103, s[60:63], s81 offen offset:768
    buffer_load_ushort v129, v103, s[60:63], s81 offen offset:1152
    buffer_load_ushort v130, v103, s[60:63], s81 offen offset:1536
    buffer_load_ushort v131, v103, s[60:63], s81 offen offset:1920
    buffer_load_ushort v132, v103, s[60:63], s81 offen offset:2304
    buffer_load_ushort v133, v103, s[60:63], s81 offen offset:2688
    s_mul_i32 s82, s76, 3072
    s_lshl_b32 s83, s74, 10
    s_add_u32 s82, s82, s83
    s_mul_i32 s83, s75, 36864
    s_lshl_b32 s84, s83, 2
    s_add_u32 s83, s83, s82
    s_add_u32 s84, s84, s82
    s_waitcnt vmcnt(0)
    v_lshlrev_b32 v110, 16, v110
    v_lshlrev_b32 v111, 16, v111
    v_lshlrev_b32 v112, 16, v112
    v_lshlrev_b32 v113, 16, v113
    v_lshlrev_b32 v114, 16, v114
    v_lshlrev_b32 v115, 16, v115
    v_lshlrev_b32 v116, 16, v116
    v_lshlrev_b32 v117, 16, v117
    v_lshlrev_b32 v118, 16, v118
    v_lshlrev_b32 v119, 16, v119
    v_lshlrev_b32 v120, 16, v120
    v_lshlrev_b32 v121, 16, v121
    v_lshlrev_b32 v122, 16, v122
    v_lshlrev_b32 v123, 16, v123
    v_lshlrev_b32 v124, 16, v124
    v_lshlrev_b32 v125, 16, v125
    v_lshlrev_b32 v126, 16, v126
    v_lshlrev_b32 v127, 16, v127
    v_lshlrev_b32 v128, 16, v128
    v_lshlrev_b32 v129, 16, v129
    v_lshlrev_b32 v130, 16, v130
    v_lshlrev_b32 v131, 16, v131
    v_lshlrev_b32 v132, 16, v132
    v_lshlrev_b32 v133, 16, v133
    v_mul_f32 v136, 0xbf170c51, v110
    v_fmac_f32 v136, 0xbe6c033f, v126
    v_fmamk_f32 v144, v118, 0xbebccf65, v136
    v_fmac_f32 v136, 0x3ebccf65, v118
    v_mul_f32 v137, 0xbf170c51, v111
    v_fmac_f32 v137, 0xbe6c033f, v127
    v_fmamk_f32 v145, v119, 0xbebccf65, v137
    v_fmac_f32 v137, 0x3ebccf65, v119
    v_mul_f32 v138, 0xbf170c51, v112
    v_fmac_f32 v138, 0xbe6c033f, v128
    v_fmamk_f32 v146, v120, 0xbebccf65, v138
    v_fmac_f32 v138, 0x3ebccf65, v120
    v_mul_f32 v139, 0xbf170c51, v113
    v_fmac_f32 v139, 0xbe6c033f, v129
    v_fmamk_f32 v147, v121, 0xbebccf65, v139
    v_fmac_f32 v139, 0x3ebccf65, v121
    v_mul_f32 v140, 0xbf170c51, v114
    v_fmac_f32 v140, 0xbe6c033f, v130
    v_fmamk_f32 v148, v122, 0xbebccf65, v140
    v_fmac_f32 v140, 0x3ebccf65, v122
    v_mul_f32 v141, 0xbf170c51, v115
    v_fmac_f32 v141, 0xbe6c033f, v131
    v_fmamk_f32 v149, v123, 0xbebccf65, v141
    v_fmac_f32 v141, 0x3ebccf65, v123
    v_mul_f32 v142, 0xbf170c51, v116
    v_fmac_f32 v142, 0xbe6c033f, v132
    v_fmamk_f32 v150, v124, 0xbebccf65, v142
    v_fmac_f32 v142, 0x3ebccf65, v124
    v_mul_f32 v143, 0xbf170c51, v117
    v_fmac_f32 v143, 0xbe6c033f, v133
    v_fmamk_f32 v151, v125, 0xbebccf65, v143
    v_fmac_f32 v143, 0x3ebccf65, v125
    v_cvt_pk_bf16_f32 v156, v144, v145
    v_cvt_pk_bf16_f32 v157, v146, v147
    v_cvt_pk_bf16_f32 v158, v148, v149
    v_cvt_pk_bf16_f32 v159, v150, v151
    s_add_u32 s85, s84, 0
    buffer_store_dwordx4 v[156:159], v254, s[8:11], s85 offen sc1
    v_cvt_pk_bf16_f32 v160, v136, v137
    v_cvt_pk_bf16_f32 v161, v138, v139
    v_cvt_pk_bf16_f32 v162, v140, v141
    v_cvt_pk_bf16_f32 v163, v142, v143
    s_add_u32 s85, s84, 36864
    buffer_store_dwordx4 v[160:163], v254, s[8:11], s85 offen sc1
    v_mul_f32 v136, 0x3e6c033f, v110
    v_fmac_f32 v136, 0x3f170c51, v126
    v_fmamk_f32 v144, v118, 0x3ebccf65, v136
    v_fmac_f32 v136, 0xbebccf65, v118
    v_mul_f32 v137, 0x3e6c033f, v111
    v_fmac_f32 v137, 0x3f170c51, v127
    v_fmamk_f32 v145, v119, 0x3ebccf65, v137
    v_fmac_f32 v137, 0xbebccf65, v119
    v_mul_f32 v138, 0x3e6c033f, v112
    v_fmac_f32 v138, 0x3f170c51, v128
    v_fmamk_f32 v146, v120, 0x3ebccf65, v138
    v_fmac_f32 v138, 0xbebccf65, v120
    v_mul_f32 v139, 0x3e6c033f, v113
    v_fmac_f32 v139, 0x3f170c51, v129
    v_fmamk_f32 v147, v121, 0x3ebccf65, v139
    v_fmac_f32 v139, 0xbebccf65, v121
    v_mul_f32 v140, 0x3e6c033f, v114
    v_fmac_f32 v140, 0x3f170c51, v130
    v_fmamk_f32 v148, v122, 0x3ebccf65, v140
    v_fmac_f32 v140, 0xbebccf65, v122
    v_mul_f32 v141, 0x3e6c033f, v115
    v_fmac_f32 v141, 0x3f170c51, v131
    v_fmamk_f32 v149, v123, 0x3ebccf65, v141
    v_fmac_f32 v141, 0xbebccf65, v123
    v_mul_f32 v142, 0x3e6c033f, v116
    v_fmac_f32 v142, 0x3f170c51, v132
    v_fmamk_f32 v150, v124, 0x3ebccf65, v142
    v_fmac_f32 v142, 0xbebccf65, v124
    v_mul_f32 v143, 0x3e6c033f, v117
    v_fmac_f32 v143, 0x3f170c51, v133
    v_fmamk_f32 v151, v125, 0x3ebccf65, v143
    v_fmac_f32 v143, 0xbebccf65, v125
    v_cvt_pk_bf16_f32 v164, v144, v145
    v_cvt_pk_bf16_f32 v165, v146, v147
    v_cvt_pk_bf16_f32 v166, v148, v149
    v_cvt_pk_bf16_f32 v167, v150, v151
    s_add_u32 s85, s84, 73728
    buffer_store_dwordx4 v[164:167], v254, s[8:11], s85 offen sc1
    v_cvt_pk_bf16_f32 v168, v136, v137
    v_cvt_pk_bf16_f32 v169, v138, v139
    v_cvt_pk_bf16_f32 v170, v140, v141
    v_cvt_pk_bf16_f32 v171, v142, v143
    s_add_u32 s85, s84, 110592
    buffer_store_dwordx4 v[168:171], v254, s[8:11], s85 offen sc1
    v_cvt_pk_bf16_f32 v152, v110, v111
    v_cvt_pk_bf16_f32 v153, v112, v113
    v_cvt_pk_bf16_f32 v154, v114, v115
    v_cvt_pk_bf16_f32 v155, v116, v117
    s_add_u32 s85, s83, 884736
    buffer_store_dwordx4 v[152:155], v254, s[8:11], s85 offen sc1
    v_cvt_pk_bf16_f32 v172, v126, v127
    v_cvt_pk_bf16_f32 v173, v128, v129
    v_cvt_pk_bf16_f32 v174, v130, v131
    v_cvt_pk_bf16_f32 v175, v132, v133
    s_add_u32 s85, s83, 1105920
    buffer_store_dwordx4 v[172:175], v254, s[8:11], s85 offen sc1
    buffer_load_dwordx2 v[8:9], v80, s[4:7], s16 offen offset:0
    buffer_load_dwordx2 v[10:11], v80, s[4:7], s17 offen offset:0
    buffer_load_dwordx2 v[12:13], v80, s[4:7], s18 offen offset:0
    buffer_load_dwordx2 v[14:15], v80, s[4:7], s19 offen offset:0
    buffer_load_dwordx2 v[16:17], v80, s[4:7], s20 offen offset:0
    buffer_load_dwordx2 v[18:19], v80, s[4:7], s21 offen offset:0
wt_join:
    s_and_b32 s13, s13, 0xffff
    s_mov_b32 s14, 100663296
    s_mov_b32 s15, 0x20000
    v_lshrrev_b32 v5, 4, v2
    v_mul_u32_u24 v6, 40704, v5
    v_lshrrev_b32 v5, 1, v5
    v_lshl_add_u32 v6, v5, 6, v6
    v_and_b32 v5, 0xf0, v254
    v_add_u32 v253, v6, v5
    v_lshrrev_b32 v6, 1, v4
    v_mul_u32_u24 v7, 40704, v6
    v_lshrrev_b32 v6, 1, v6
    v_lshl_add_u32 v7, v6, 6, v7
    v_and_b32 v6, 1, v2
    v_lshl_add_u32 v7, v6, 3, v7
    v_lshl_add_u32 v7, v3, 4, v7
    s_lshl_b32 s44, s90, 7
    s_mul_i32 s45, s91, 1056
    s_add_u32 s44, s44, s45
    v_add_u32 v7, s44, v7
    v_lshl_or_b32 v255, v7, 15, v255
    s_mul_i32 s51, s38, 40704
    s_lshl_b32 s45, s91, 6
    s_add_u32 s51, s51, s45
    s_lshl_b32 s45, s90, 4
    s_add_u32 s51, s51, s45
    s_mul_i32 s40, s49, 786432
    s_mul_i32 s45, s48, 49152
    s_add_u32 s40, s40, s45
    s_mul_i32 s45, s38, 12288
    s_add_u32 s40, s40, s45
    s_mov_b32 s41, 2130706432
    s_mov_b32 s39, 0
    s_lshl_b32 s45, s38, 4
    s_mov_b32 s46, 0xfff
    s_mov_b32 s47, 0
    s_lshl_b64 s[46:47], s[46:47], s45
    s_mov_b32 s58, 0x0fff0fff
    s_mov_b32 s59, 0
    s_mov_b32 s23, 0xc03cd70a
    s_mov_b32 s24, 0xbec80000
    s_mov_b32 s25, 0xc023d70a
    s_mov_b32 s26, 0x3f200000
    s_mov_b32 s27, 0xbf200000
    s_mov_b32 s28, 0x3fcccccd
    s_mov_b32 s29, 0xbfcccccd
    s_mov_b32 s30, 0x3ec80000
    s_mov_b32 s31, 0x3ec80000
    s_mov_b32 s34, 0x3e7a0000
    s_mov_b32 s22, 0xffff0000
    s_mul_i32 s32, s89, 147456
    s_mul_i32 s35, s89, -737280
    s_mul_i32 s36, s89, 36864
    s_mul_i32 s37, s89, -184320
    s_mul_i32 s3, s89, 384
    s_add_u32 s33, s100, 6291456
    v_bfe_u32 v6, v254, 6, 2
    v_mul_u32_u24 v4, 40704, v6
    v_and_b32 v6, 0x80, v254
    v_lshrrev_b32 v6, 1, v6
    v_add_u32 v4, v4, v6
    v_and_b32 v6, 0x40, v254
    v_lshrrev_b32 v6, 2, v6
    v_add_u32 v4, v4, v6
    v_bfe_u32 v6, v254, 4, 2
    v_mul_u32_u24 v6, 3104, v6
    v_add_u32 v4, v4, v6
    v_add_u32 v4, s52, v4
    v_lshrrev_b32 v6, 8, v254
    v_lshl_add_u32 v5, v6, 3, v4
    v_lshl_add_u32 v4, v6, 4, v4
    v_add_u32 v6, s51, v254
    v_mov_b32 v203, 0
    v_mov_b32 v215, 0
    v_mov_b32 v222, 0
    v_mov_b32 v223, 0
    v_mov_b32 v224, 0
    v_mov_b32 v225, 0
    v_mov_b32 v226, 0
    v_mov_b32 v227, 0
    v_mov_b32 v252, 0
    s_mov_b32 s42, 0
    s_cmp_gt_u32 s48, 0
    s_cselect_b32 s45, 384, 0
    s_cselect_b32 s55, 0, 2130706432
    s_add_u32 s50, s50, s45
    s_add_u32 s54, s45, 49152
    s_cmp_eq_u32 s48, 3
    s_cselect_b32 s54, 2130706432, s54
    s_mov_b32 s56, 0xffff0000
    s_mov_b32 s57, 0
    s_cmp_ge_u32 s2, 54
    s_cbranch_scc1 pub_skip
    s_branch do_warm
wt_ret:
    s_mov_b32 s87, 1
    s_cmp_lg_u32 s38, 0
    s_waitcnt vmcnt(6)
    s_barrier
    s_cbranch_scc1 wt_pub
    s_atomic_add s87, s[68:69], 0 glc
    s_waitcnt lgkmcnt(0)
    s_cmp_lg_u32 s87, 53
    s_cbranch_scc1 wt_pub
    s_atomic_add s87, s[68:69], 128
wt_pub:
    buffer_load_dwordx2 v[20:21], v80, s[4:7], s16 offen offset:384
    buffer_load_dwordx2 v[22:23], v80, s[4:7], s17 offen offset:384
    buffer_load_dwordx2 v[24:25], v80, s[4:7], s18 offen offset:384
    buffer_load_dwordx2 v[26:27], v80, s[4:7], s19 offen offset:384
    buffer_load_dwordx2 v[28:29], v80, s[4:7], s20 offen offset:384
    buffer_load_dwordx2 v[30:31], v80, s[4:7], s21 offen offset:384
pub_skip:
    v_and_b32 v67, 0xf0, v254
    v_lshrrev_b32 v67, 1, v67
    v_add_u32 v67, s52, v67
    v_mov_b32 v66, s54
    v_mov_b32 v65, s55
    v_cndmask_b32 v66, v66, v65, s[56:57]
    v_add_u32 v67, v67, v66
    s_sub_u32 s45, s16, s50
    buffer_load_dwordx2 v[56:57], v67, s[4:7], s45 offen
    s_sub_u32 s45, s17, s50
    buffer_load_dwordx2 v[58:59], v67, s[4:7], s45 offen
    s_sub_u32 s45, s18, s50
    buffer_load_dwordx2 v[60:61], v67, s[4:7], s45 offen
    s_sub_u32 s45, s19, s50
    buffer_load_dwordx2 v[62:63], v67, s[4:7], s45 offen
    s_sub_u32 s45, s20, s50
    buffer_load_dwordx2 v[64:65], v67, s[4:7], s45 offen
    s_sub_u32 s45, s21, s50
    buffer_load_dwordx2 v[66:67], v67, s[4:7], s45 offen
    buffer_load_dwordx2 v[32:33], v80, s[4:7], s16 offen offset:768
    buffer_load_dwordx2 v[34:35], v80, s[4:7], s17 offen offset:768
    buffer_load_dwordx2 v[36:37], v80, s[4:7], s18 offen offset:768
    buffer_load_dwordx2 v[38:39], v80, s[4:7], s19 offen offset:768
    buffer_load_dwordx2 v[40:41], v80, s[4:7], s20 offen offset:768
    buffer_load_dwordx2 v[42:43], v80, s[4:7], s21 offen offset:768
    buffer_load_dwordx2 v[44:45], v80, s[4:7], s16 offen offset:1152
    buffer_load_dwordx2 v[46:47], v80, s[4:7], s17 offen offset:1152
    buffer_load_dwordx2 v[48:49], v80, s[4:7], s18 offen offset:1152
    buffer_load_dwordx2 v[50:51], v80, s[4:7], s19 offen offset:1152
    buffer_load_dwordx2 v[52:53], v80, s[4:7], s20 offen offset:1152
    buffer_load_dwordx2 v[54:55], v80, s[4:7], s21 offen offset:1152
    s_waitcnt vmcnt(24)
    v_lshlrev_b32 v176, 16, v8
    v_and_b32 v177, s22, v8
    v_lshlrev_b32 v178, 16, v10
    v_and_b32 v179, s22, v10
    v_lshlrev_b32 v180, 16, v12
    v_and_b32 v181, s22, v12
    v_lshlrev_b32 v182, 16, v14
    v_and_b32 v183, s22, v14
    v_lshlrev_b32 v184, 16, v16
    v_and_b32 v185, s22, v16
    v_lshlrev_b32 v186, 16, v18
    v_and_b32 v187, s22, v18
    v_pk_add_f32 v[176:177], v[176:177], v[184:185]
    v_pk_add_f32 v[186:187], v[186:187], v[178:179]
    v_pk_fma_f32 v[176:177], v[180:181], s[22:23], v[176:177] op_sel:[0,1,0]
    v_pk_fma_f32 v[186:187], v[182:183], s[22:23], v[186:187] op_sel:[0,1,0]
    v_pk_fma_f32 v[188:189], v[180:181], s[24:25], v[184:185] op_sel_hi:[1,0,1]
    v_pk_fma_f32 v[184:185], v[180:181], s[24:25], v[184:185] op_sel:[0,1,0]
    v_pk_fma_f32 v[180:181], v[178:179], s[24:25], v[182:183] op_sel_hi:[1,0,1]
    v_pk_fma_f32 v[182:183], v[178:179], s[24:25], v[182:183] op_sel:[0,1,0]
    v_pk_fma_f32 v[178:179], v[182:183], s[26:27], v[184:185] op_sel_hi:[1,0,1]
    v_pk_fma_f32 v[184:185], v[182:183], s[26:27], v[184:185] op_sel:[0,1,0]
    v_pk_fma_f32 v[182:183], v[180:181], s[28:29], v[188:189] op_sel_hi:[1,0,1]
    v_pk_fma_f32 v[180:181], v[180:181], s[28:29], v[188:189] op_sel:[0,1,0]
    v_cvt_pk_bf16_f32 v8, v176, v177
    v_cvt_pk_bf16_f32 v10, v178, v179
    v_cvt_pk_bf16_f32 v12, v180, v181
    v_cvt_pk_bf16_f32 v14, v182, v183
    v_cvt_pk_bf16_f32 v16, v184, v185
    v_cvt_pk_bf16_f32 v18, v186, v187
    v_lshlrev_b32 v176, 16, v9
    v_and_b32 v177, s22, v9
    v_lshlrev_b32 v178, 16, v11
    v_and_b32 v179, s22, v11
    v_lshlrev_b32 v180, 16, v13
    v_and_b32 v181, s22, v13
    v_lshlrev_b32 v182, 16, v15
    v_and_b32 v183, s22, v15
    v_lshlrev_b32 v184, 16, v17
    v_and_b32 v185, s22, v17
    v_lshlrev_b32 v186, 16, v19
    v_and_b32 v187, s22, v19
    v_pk_add_f32 v[176:177], v[176:177], v[184:185]
    v_pk_add_f32 v[186:187], v[186:187], v[178:179]
    v_pk_fma_f32 v[176:177], v[180:181], s[22:23], v[176:177] op_sel:[0,1,0]
    v_pk_fma_f32 v[186:187], v[182:183], s[22:23], v[186:187] op_sel:[0,1,0]
    v_pk_fma_f32 v[188:189], v[180:181], s[24:25], v[184:185] op_sel_hi:[1,0,1]
    v_pk_fma_f32 v[184:185], v[180:181], s[24:25], v[184:185] op_sel:[0,1,0]
    v_pk_fma_f32 v[180:181], v[178:179], s[24:25], v[182:183] op_sel_hi:[1,0,1]
    v_pk_fma_f32 v[182:183], v[178:179], s[24:25], v[182:183] op_sel:[0,1,0]
    v_pk_fma_f32 v[178:179], v[182:183], s[26:27], v[184:185] op_sel_hi:[1,0,1]
    v_pk_fma_f32 v[184:185], v[182:183], s[26:27], v[184:185] op_sel:[0,1,0]
    v_pk_fma_f32 v[182:183], v[180:181], s[28:29], v[188:189] op_sel_hi:[1,0,1]
    v_pk_fma_f32 v[180:181], v[180:181], s[28:29], v[188:189] op_sel:[0,1,0]
    v_cvt_pk_bf16_f32 v9, v176, v177
    v_cvt_pk_bf16_f32 v11, v178, v179
    v_cvt_pk_bf16_f32 v13, v180, v181
    v_cvt_pk_bf16_f32 v15, v182, v183
    v_cvt_pk_bf16_f32 v17, v184, v185
    v_cvt_pk_bf16_f32 v19, v186, v187
    v_lshrrev_b32 v252, 15, v255
    ds_write_b64 v252, v[8:9] offset:34048
    ds_write_b64 v252, v[10:11] offset:768
    ds_write_b64 v252, v[16:17] offset:2848
    ds_write_b64 v252, v[14:15] offset:4928
    ds_write_b64 v252, v[12:13] offset:7008
    ds_write_b64 v252, v[18:19] offset:36128
    s_waitcnt vmcnt(18)
    v_lshlrev_b32 v176, 16, v20
    v_and_b32 v177, s22, v20
    v_lshlrev_b32 v178, 16, v22
    v_and_b32 v179, s22, v22
    v_lshlrev_b32 v180, 16, v24
    v_and_b32 v181, s22, v24
    v_lshlrev_b32 v182, 16, v26
    v_and_b32 v183, s22, v26
    v_lshlrev_b32 v184, 16, v28
    v_and_b32 v185, s22, v28
    v_lshlrev_b32 v186, 16, v30
    v_and_b32 v187, s22, v30
    v_pk_add_f32 v[176:177], v[176:177], v[184:185]
    v_pk_add_f32 v[186:187], v[186:187], v[178:179]
    v_pk_fma_f32 v[176:177], v[180:181], s[22:23], v[176:177] op_sel:[0,1,0]
    v_pk_fma_f32 v[186:187], v[182:183], s[22:23], v[186:187] op_sel:[0,1,0]
    v_pk_fma_f32 v[188:189], v[180:181], s[24:25], v[184:185] op_sel_hi:[1,0,1]
    v_pk_fma_f32 v[184:185], v[180:181], s[24:25], v[184:185] op_sel:[0,1,0]
    v_pk_fma_f32 v[180:181], v[178:179], s[24:25], v[182:183] op_sel_hi:[1,0,1]
    v_pk_fma_f32 v[182:183], v[178:179], s[24:25], v[182:183] op_sel:[0,1,0]
    v_pk_fma_f32 v[178:179], v[182:183], s[26:27], v[184:185] op_sel_hi:[1,0,1]
    v_pk_fma_f32 v[184:185], v[182:183], s[26:27], v[184:185] op_sel:[0,1,0]
    v_pk_fma_f32 v[182:183], v[180:181], s[28:29], v[188:189] op_sel_hi:[1,0,1]
    v_pk_fma_f32 v[180:181], v[180:181], s[28:29], v[188:189] op_sel:[0,1,0]
    v_cvt_pk_bf16_f32 v20, v176, v177
    v_cvt_pk_bf16_f32 v22, v178, v179
    v_cvt_pk_bf16_f32 v24, v180, v181
    v_cvt_pk_bf16_f32 v26, v182, v183
    v_cvt_pk_bf16_f32 v28, v184, v185
    v_cvt_pk_bf16_f32 v30, v186, v187
    v_lshlrev_b32 v176, 16, v21
    v_and_b32 v177, s22, v21
    v_lshlrev_b32 v178, 16, v23
    v_and_b32 v179, s22, v23
    v_lshlrev_b32 v180, 16, v25
    v_and_b32 v181, s22, v25
    v_lshlrev_b32 v182, 16, v27
    v_and_b32 v183, s22, v27
    v_lshlrev_b32 v184, 16, v29
    v_and_b32 v185, s22, v29
    v_lshlrev_b32 v186, 16, v31
    v_and_b32 v187, s22, v31
    v_pk_add_f32 v[176:177], v[176:177], v[184:185]
    v_pk_add_f32 v[186:187], v[186:187], v[178:179]
    v_pk_fma_f32 v[176:177], v[180:181], s[22:23], v[176:177] op_sel:[0,1,0]
    v_pk_fma_f32 v[186:187], v[182:183], s[22:23], v[186:187] op_sel:[0,1,0]
    v_pk_fma_f32 v[188:189], v[180:181], s[24:25], v[184:185] op_sel_hi:[1,0,1]
    v_pk_fma_f32 v[184:185], v[180:181], s[24:25], v[184:185] op_sel:[0,1,0]
    v_pk_fma_f32 v[180:181], v[178:179], s[24:25], v[182:183] op_sel_hi:[1,0,1]
    v_pk_fma_f32 v[182:183], v[178:179], s[24:25], v[182:183] op_sel:[0,1,0]
    v_pk_fma_f32 v[178:179], v[182:183], s[26:27], v[184:185] op_sel_hi:[1,0,1]
    v_pk_fma_f32 v[184:185], v[182:183], s[26:27], v[184:185] op_sel:[0,1,0]
    v_pk_fma_f32 v[182:183], v[180:181], s[28:29], v[188:189] op_sel_hi:[1,0,1]
    v_pk_fma_f32 v[180:181], v[180:181], s[28:29], v[188:189] op_sel:[0,1,0]
    v_cvt_pk_bf16_f32 v21, v176, v177
    v_cvt_pk_bf16_f32 v23, v178, v179
    v_cvt_pk_bf16_f32 v25, v180, v181
    v_cvt_pk_bf16_f32 v27, v182, v183
    v_cvt_pk_bf16_f32 v29, v184, v185
    v_cvt_pk_bf16_f32 v31, v186, v187
    v_lshrrev_b32 v252, 15, v255
    ds_write_b64 v252, v[20:21] offset:33792
    ds_write_b64 v252, v[22:23] offset:512
    ds_write_b64 v252, v[28:29] offset:2592
    ds_write_b64 v252, v[26:27] offset:4672
    ds_write_b64 v252, v[24:25] offset:6752
    ds_write_b64 v252, v[30:31] offset:35872
    s_waitcnt vmcnt(12)
    v_lshlrev_b32 v176, 16, v56
    v_and_b32 v177, s22, v56
    v_lshlrev_b32 v178, 16, v58
    v_and_b32 v179, s22, v58
    v_lshlrev_b32 v180, 16, v60
    v_and_b32 v181, s22, v60
    v_lshlrev_b32 v182, 16, v62
    v_and_b32 v183, s22, v62
    v_lshlrev_b32 v184, 16, v64
    v_and_b32 v185, s22, v64
    v_lshlrev_b32 v186, 16, v66
    v_and_b32 v187, s22, v66
    v_pk_add_f32 v[176:177], v[176:177], v[184:185]
    v_pk_add_f32 v[186:187], v[186:187], v[178:179]
    v_pk_fma_f32 v[176:177], v[180:181], s[22:23], v[176:177] op_sel:[0,1,0]
    v_pk_fma_f32 v[186:187], v[182:183], s[22:23], v[186:187] op_sel:[0,1,0]
    v_pk_fma_f32 v[188:189], v[180:181], s[24:25], v[184:185] op_sel_hi:[1,0,1]
    v_pk_fma_f32 v[184:185], v[180:181], s[24:25], v[184:185] op_sel:[0,1,0]
    v_pk_fma_f32 v[180:181], v[178:179], s[24:25], v[182:183] op_sel_hi:[1,0,1]
    v_pk_fma_f32 v[182:183], v[178:179], s[24:25], v[182:183] op_sel:[0,1,0]
    v_pk_fma_f32 v[178:179], v[182:183], s[26:27], v[184:185] op_sel_hi:[1,0,1]
    v_pk_fma_f32 v[184:185], v[182:183], s[26:27], v[184:185] op_sel:[0,1,0]
    v_pk_fma_f32 v[182:183], v[180:181], s[28:29], v[188:189] op_sel_hi:[1,0,1]
    v_pk_fma_f32 v[180:181], v[180:181], s[28:29], v[188:189] op_sel:[0,1,0]
    v_cvt_pk_bf16_f32 v56, v176, v177
    v_cvt_pk_bf16_f32 v58, v178, v179
    v_cvt_pk_bf16_f32 v60, v180, v181
    v_cvt_pk_bf16_f32 v62, v182, v183
    v_cvt_pk_bf16_f32 v64, v184, v185
    v_cvt_pk_bf16_f32 v66, v186, v187
    v_lshlrev_b32 v176, 16, v57
    v_and_b32 v177, s22, v57
    v_lshlrev_b32 v178, 16, v59
    v_and_b32 v179, s22, v59
    v_lshlrev_b32 v180, 16, v61
    v_and_b32 v181, s22, v61
    v_lshlrev_b32 v182, 16, v63
    v_and_b32 v183, s22, v63
    v_lshlrev_b32 v184, 16, v65
    v_and_b32 v185, s22, v65
    v_lshlrev_b32 v186, 16, v67
    v_and_b32 v187, s22, v67
    v_pk_add_f32 v[176:177], v[176:177], v[184:185]
    v_pk_add_f32 v[186:187], v[186:187], v[178:179]
    v_pk_fma_f32 v[176:177], v[180:181], s[22:23], v[176:177] op_sel:[0,1,0]
    v_pk_fma_f32 v[186:187], v[182:183], s[22:23], v[186:187] op_sel:[0,1,0]
    v_pk_fma_f32 v[188:189], v[180:181], s[24:25], v[184:185] op_sel_hi:[1,0,1]
    v_pk_fma_f32 v[184:185], v[180:181], s[24:25], v[184:185] op_sel:[0,1,0]
    v_pk_fma_f32 v[180:181], v[178:179], s[24:25], v[182:183] op_sel_hi:[1,0,1]
    v_pk_fma_f32 v[182:183], v[178:179], s[24:25], v[182:183] op_sel:[0,1,0]
    v_pk_fma_f32 v[178:179], v[182:183], s[26:27], v[184:185] op_sel_hi:[1,0,1]
    v_pk_fma_f32 v[184:185], v[182:183], s[26:27], v[184:185] op_sel:[0,1,0]
    v_pk_fma_f32 v[182:183], v[180:181], s[28:29], v[188:189] op_sel_hi:[1,0,1]
    v_pk_fma_f32 v[180:181], v[180:181], s[28:29], v[188:189] op_sel:[0,1,0]
    v_cvt_pk_bf16_f32 v57, v176, v177
    v_cvt_pk_bf16_f32 v59, v178, v179
    v_cvt_pk_bf16_f32 v61, v180, v181
    v_cvt_pk_bf16_f32 v63, v182, v183
    v_cvt_pk_bf16_f32 v65, v184, v185
    v_cvt_pk_bf16_f32 v67, v186, v187
    v_and_b32 v248, 0xf0, v254
    v_lshrrev_b32 v248, 1, v248
    v_add_u32 v248, s52, v248
    v_and_b32 v252, 8, v248
    v_lshrrev_b32 v249, 6, v248
    v_mul_u32_u24 v249, 384, v249
    v_subrev_u32 v249, s3, v249
    v_min_u32 v249, 1920, v249
    v_lshrrev_b32 v249, 1, v249
    v_cmp_eq_u32 s[92:93], 0, v249
    v_add_u32 v252, v252, v249
    v_bfe_u32 v249, v248, 4, 2
    v_mul_u32_u24 v249, 40704, v249
    v_add_u32 v252, v252, v249
    v_and_b32 v249, 32, v248
    v_lshl_add_u32 v252, v249, 1, v252
    v_bfe_u32 v249, v254, 8, 1
    v_lshl_add_u32 v252, v249, 4, v252
    v_mov_b32 v249, 123328
    v_cndmask_b32 v252, v249, v252, s[58:59]
    ds_write_b64 v252, v[56:57] offset:39520
    ds_write_b64 v252, v[58:59] offset:39552
    ds_write_b64 v252, v[64:65] offset:39584
    ds_write_b64 v252, v[62:63] offset:39616
    ds_write_b64 v252, v[60:61] offset:39648
    ds_write_b64 v252, v[66:67] offset:39680
    s_and_b64 exec, s[92:93], s[58:59]
    ds_write_b64 v252, v[56:57] offset:34304
    ds_write_b64 v252, v[58:59] offset:1024
    ds_write_b64 v252, v[64:65] offset:3104
    ds_write_b64 v252, v[62:63] offset:5184
    ds_write_b64 v252, v[60:61] offset:7264
    ds_write_b64 v252, v[66:67] offset:36384
    s_mov_b64 exec, -1
    v_and_b32 v203, 0x7fff, v255
    buffer_load_dwordx2 v[192:193], v203, s[4:7], s16 offen offset:64
    buffer_load_dwordx2 v[194:195], v203, s[4:7], s17 offen offset:64
    buffer_load_dwordx2 v[196:197], v203, s[4:7], s18 offen offset:64
    buffer_load_dwordx2 v[198:199], v203, s[4:7], s19 offen offset:64
    buffer_load_dwordx2 v[200:201], v203, s[4:7], s20 offen offset:64
    buffer_load_dwordx2 v[202:203], v203, s[4:7], s21 offen offset:64
    v_and_b32 v215, 0x7fff, v255
    buffer_load_dwordx2 v[204:205], v215, s[4:7], s16 offen offset:448
    buffer_load_dwordx2 v[206:207], v215, s[4:7], s17 offen offset:448
    buffer_load_dwordx2 v[208:209], v215, s[4:7], s18 offen offset:448
    buffer_load_dwordx2 v[210:211], v215, s[4:7], s19 offen offset:448
    buffer_load_dwordx2 v[212:213], v215, s[4:7], s20 offen offset:448
    buffer_load_dwordx2 v[214:215], v215, s[4:7], s21 offen offset:448
    s_waitcnt vmcnt(18)
    v_lshlrev_b32 v176, 16, v32
    v_and_b32 v177, s22, v32
    v_lshlrev_b32 v178, 16, v34
    v_and_b32 v179, s22, v34
    v_lshlrev_b32 v180, 16, v36
    v_and_b32 v181, s22, v36
    v_lshlrev_b32 v182, 16, v38
    v_and_b32 v183, s22, v38
    v_lshlrev_b32 v184, 16, v40
    v_and_b32 v185, s22, v40
    v_lshlrev_b32 v186, 16, v42
    v_and_b32 v187, s22, v42
    v_pk_add_f32 v[176:177], v[176:177], v[184:185]
    v_pk_add_f32 v[186:187], v[186:187], v[178:179]
    v_pk_fma_f32 v[176:177], v[180:181], s[22:23], v[176:177] op_sel:[0,1,0]
    v_pk_fma_f32 v[186:187], v[182:183], s[22:23], v[186:187] op_sel:[0,1,0]
    v_pk_fma_f32 v[188:189], v[180:181], s[24:25], v[184:185] op_sel_hi:[1,0,1]
    v_pk_fma_f32 v[184:185], v[180:181], s[24:25], v[184:185] op_sel:[0,1,0]
    v_pk_fma_f32 v[180:181], v[178:179], s[24:25], v[182:183] op_sel_hi:[1,0,1]
    v_pk_fma_f32 v[182:183], v[178:179], s[24:25], v[182:183] op_sel:[0,1,0]
    v_pk_fma_f32 v[178:179], v[182:183], s[26:27], v[184:185] op_sel_hi:[1,0,1]
    v_pk_fma_f32 v[184:185], v[182:183], s[26:27], v[184:185] op_sel:[0,1,0]
    v_pk_fma_f32 v[182:183], v[180:181], s[28:29], v[188:189] op_sel_hi:[1,0,1]
    v_pk_fma_f32 v[180:181], v[180:181], s[28:29], v[188:189] op_sel:[0,1,0]
    v_cvt_pk_bf16_f32 v32, v176, v177
    v_cvt_pk_bf16_f32 v34, v178, v179
    v_cvt_pk_bf16_f32 v36, v180, v181
    v_cvt_pk_bf16_f32 v38, v182, v183
    v_cvt_pk_bf16_f32 v40, v184, v185
    v_cvt_pk_bf16_f32 v42, v186, v187
    v_lshlrev_b32 v176, 16, v33
    v_and_b32 v177, s22, v33
    v_lshlrev_b32 v178, 16, v35
    v_and_b32 v179, s22, v35
    v_lshlrev_b32 v180, 16, v37
    v_and_b32 v181, s22, v37
    v_lshlrev_b32 v182, 16, v39
    v_and_b32 v183, s22, v39
    v_lshlrev_b32 v184, 16, v41
    v_and_b32 v185, s22, v41
    v_lshlrev_b32 v186, 16, v43
    v_and_b32 v187, s22, v43
    v_pk_add_f32 v[176:177], v[176:177], v[184:185]
    v_pk_add_f32 v[186:187], v[186:187], v[178:179]
    v_pk_fma_f32 v[176:177], v[180:181], s[22:23], v[176:177] op_sel:[0,1,0]
    v_pk_fma_f32 v[186:187], v[182:183], s[22:23], v[186:187] op_sel:[0,1,0]
    v_pk_fma_f32 v[188:189], v[180:181], s[24:25], v[184:185] op_sel_hi:[1,0,1]
    v_pk_fma_f32 v[184:185], v[180:181], s[24:25], v[184:185] op_sel:[0,1,0]
    v_pk_fma_f32 v[180:181], v[178:179], s[24:25], v[182:183] op_sel_hi:[1,0,1]
    v_pk_fma_f32 v[182:183], v[178:179], s[24:25], v[182:183] op_sel:[0,1,0]
    v_pk_fma_f32 v[178:179], v[182:183], s[26:27], v[184:185] op_sel_hi:[1,0,1]
    v_pk_fma_f32 v[184:185], v[182:183], s[26:27], v[184:185] op_sel:[0,1,0]
    v_pk_fma_f32 v[182:183], v[180:181], s[28:29], v[188:189] op_sel_hi:[1,0,1]
    v_pk_fma_f32 v[180:181], v[180:181], s[28:29], v[188:189] op_sel:[0,1,0]
    v_cvt_pk_bf16_f32 v33, v176, v177
    v_cvt_pk_bf16_f32 v35, v178, v179
    v_cvt_pk_bf16_f32 v37, v180, v181
    v_cvt_pk_bf16_f32 v39, v182, v183
    v_cvt_pk_bf16_f32 v41, v184, v185
    v_cvt_pk_bf16_f32 v43, v186, v187
    v_lshrrev_b32 v252, 15, v255
    ds_write_b64 v252, v[32:33] offset:33536
    ds_write_b64 v252, v[34:35] offset:256
    ds_write_b64 v252, v[40:41] offset:2336
    ds_write_b64 v252, v[38:39] offset:4416
    ds_write_b64 v252, v[36:37] offset:6496
    ds_write_b64 v252, v[42:43] offset:35616
    s_waitcnt vmcnt(12)
    v_lshlrev_b32 v176, 16, v44
    v_and_b32 v177, s22, v44
    v_lshlrev_b32 v178, 16, v46
    v_and_b32 v179, s22, v46
    v_lshlrev_b32 v180, 16, v48
    v_and_b32 v181, s22, v48
    v_lshlrev_b32 v182, 16, v50
    v_and_b32 v183, s22, v50
    v_lshlrev_b32 v184, 16, v52
    v_and_b32 v185, s22, v52
    v_lshlrev_b32 v186, 16, v54
    v_and_b32 v187, s22, v54
    v_pk_add_f32 v[176:177], v[176:177], v[184:185]
    v_pk_add_f32 v[186:187], v[186:187], v[178:179]
    v_pk_fma_f32 v[176:177], v[180:181], s[22:23], v[176:177] op_sel:[0,1,0]
    v_pk_fma_f32 v[186:187], v[182:183], s[22:23], v[186:187] op_sel:[0,1,0]
    v_pk_fma_f32 v[188:189], v[180:181], s[24:25], v[184:185] op_sel_hi:[1,0,1]
    v_pk_fma_f32 v[184:185], v[180:181], s[24:25], v[184:185] op_sel:[0,1,0]
    v_pk_fma_f32 v[180:181], v[178:179], s[24:25], v[182:183] op_sel_hi:[1,0,1]
    v_pk_fma_f32 v[182:183], v[178:179], s[24:25], v[182:183] op_sel:[0,1,0]
    v_pk_fma_f32 v[178:179], v[182:183], s[26:27], v[184:185] op_sel_hi:[1,0,1]
    v_pk_fma_f32 v[184:185], v[182:183], s[26:27], v[184:185] op_sel:[0,1,0]
    v_pk_fma_f32 v[182:183], v[180:181], s[28:29], v[188:189] op_sel_hi:[1,0,1]
    v_pk_fma_f32 v[180:181], v[180:181], s[28:29], v[188:189] op_sel:[0,1,0]
    v_cvt_pk_bf16_f32 v44, v176, v177
    v_cvt_pk_bf16_f32 v46, v178, v179
    v_cvt_pk_bf16_f32 v48, v180, v181
    v_cvt_pk_bf16_f32 v50, v182, v183
    v_cvt_pk_bf16_f32 v52, v184, v185
    v_cvt_pk_bf16_f32 v54, v186, v187
    v_lshlrev_b32 v176, 16, v45
    v_and_b32 v177, s22, v45
    v_lshlrev_b32 v178, 16, v47
    v_and_b32 v179, s22, v47
    v_lshlrev_b32 v180, 16, v49
    v_and_b32 v181, s22, v49
    v_lshlrev_b32 v182, 16, v51
    v_and_b32 v183, s22, v51
    v_lshlrev_b32 v184, 16, v53
    v_and_b32 v185, s22, v53
    v_lshlrev_b32 v186, 16, v55
    v_and_b32 v187, s22, v55
    v_pk_add_f32 v[176:177], v[176:177], v[184:185]
    v_pk_add_f32 v[186:187], v[186:187], v[178:179]
    v_pk_fma_f32 v[176:177], v[180:181], s[22:23], v[176:177] op_sel:[0,1,0]
    v_pk_fma_f32 v[186:187], v[182:183], s[22:23], v[186:187] op_sel:[0,1,0]
    v_pk_fma_f32 v[188:189], v[180:181], s[24:25], v[184:185] op_sel_hi:[1,0,1]
    v_pk_fma_f32 v[184:185], v[180:181], s[24:25], v[184:185] op_sel:[0,1,0]
    v_pk_fma_f32 v[180:181], v[178:179], s[24:25], v[182:183] op_sel_hi:[1,0,1]
    v_pk_fma_f32 v[182:183], v[178:179], s[24:25], v[182:183] op_sel:[0,1,0]
    v_pk_fma_f32 v[178:179], v[182:183], s[26:27], v[184:185] op_sel_hi:[1,0,1]
    v_pk_fma_f32 v[184:185], v[182:183], s[26:27], v[184:185] op_sel:[0,1,0]
    v_pk_fma_f32 v[182:183], v[180:181], s[28:29], v[188:189] op_sel_hi:[1,0,1]
    v_pk_fma_f32 v[180:181], v[180:181], s[28:29], v[188:189] op_sel:[0,1,0]
    v_cvt_pk_bf16_f32 v45, v176, v177
    v_cvt_pk_bf16_f32 v47, v178, v179
    v_cvt_pk_bf16_f32 v49, v180, v181
    v_cvt_pk_bf16_f32 v51, v182, v183
    v_cvt_pk_bf16_f32 v53, v184, v185
    v_cvt_pk_bf16_f32 v55, v186, v187
    v_lshrrev_b32 v252, 15, v255
    ds_write_b64 v252, v[44:45] offset:33280
    ds_write_b64 v252, v[46:47] offset:0
    ds_write_b64 v252, v[52:53] offset:2080
    ds_write_b64 v252, v[50:51] offset:4160
    ds_write_b64 v252, v[48:49] offset:6240
    ds_write_b64 v252, v[54:55] offset:35360
    buffer_load_dword v97, v98, s[64:67], 0 offen offset:128 sc1
no_poll:
    s_cmp_lt_u32 s2, 54
    s_cbranch_scc1 warm_done
do_warm:
    s_mov_b64 vcc, -1
    s_cmp_eq_u32 s38, 0
    s_cbranch_scc1 pad0
    s_cmp_eq_u32 s38, 1
    s_cbranch_scc1 pad1
    s_cmp_eq_u32 s38, 2
    s_cbranch_scc1 pad2
    s_branch pad3
warm_ret:
    s_mov_b64 vcc, 0
    s_cmp_lt_u32 s2, 54
    s_cbranch_scc1 wt_ret
warm_done:
    s_mov_b32 s86, 0
    s_waitcnt vmcnt(0)
poll_loop:
    v_readfirstlane_b32 s87, v97
    s_add_u32 s86, s86, 1
    s_cmp_lg_u32 s87, 0
    s_cbranch_scc1 u_ready
    buffer_load_dword v97, v98, s[64:67], 0 offen offset:128 sc1
    s_cmp_lt_u32 s86, 512
    s_waitcnt vmcnt(0)
    s_cbranch_scc1 poll_loop
    s_mov_b32 s70, 0
    s_branch wt_loop
u_ready:
    s_add_u32 s42, s32, 0
    buffer_load_dwordx4 a[192:195], v254, s[8:11], s42 offen offset:0 sc1
    buffer_load_dwordx4 a[196:199], v254, s[8:11], s42 offen offset:1024 sc1
    buffer_load_dwordx4 a[200:203], v254, s[8:11], s42 offen offset:2048 sc1
    s_add_u32 s42, s32, 3072
    buffer_load_dwordx4 a[204:207], v254, s[8:11], s42 offen offset:0 sc1
    buffer_load_dwordx4 a[208:211], v254, s[8:11], s42 offen offset:1024 sc1
    buffer_load_dwordx4 a[212:215], v254, s[8:11], s42 offen offset:2048 sc1
    s_add_u32 s42, s32, 6144
    buffer_load_dwordx4 a[216:219], v254, s[8:11], s42 offen offset:0 sc1
    buffer_load_dwordx4 a[220:223], v254, s[8:11], s42 offen offset:1024 sc1
    buffer_load_dwordx4 a[224:227], v254, s[8:11], s42 offen offset:2048 sc1
    s_add_u32 s42, s32, 36864
    buffer_load_dwordx4 a[228:231], v254, s[8:11], s42 offen offset:0 sc1
    buffer_load_dwordx4 a[232:235], v254, s[8:11], s42 offen offset:1024 sc1
    buffer_load_dwordx4 a[236:239], v254, s[8:11], s42 offen offset:2048 sc1
    s_add_u32 s42, s32, 39936
    buffer_load_dwordx4 a[240:243], v254, s[8:11], s42 offen offset:0 sc1
u_done:
    s_cmp_eq_u32 s89, 1
    s_cselect_b32 s48, s33, 2130706432
    s_cselect_b32 s38, 2130706432, s33
    s_waitcnt lgkmcnt(0)
    s_barrier
    ds_read_b128 v[228:231], v253 offset:1040
    ds_read_b128 v[232:235], v253 offset:768
    ds_read_b128 v[236:239], v253 offset:512
    s_waitcnt vmcnt(4) lgkmcnt(0)
    s_branch blk_loop
.p2align 12
blk_loop:
sub0:
    v_mfma_f32_16x16x32_bf16 a[0:3], a[192:195], v[228:231], 0
pad0:
    s_cbranch_vccnz pad4
    s_waitcnt vmcnt(15) lgkmcnt(1)
    v_cvt_pk_bf16_f32 v164, v164, v165
    v_cvt_pk_bf16_f32 v165, v166, v167
    v_lshlrev_b32 v248, 16, v194
    v_mfma_f32_16x16x32_bf16 a[4:7], a[196:199], v[228:231], 0
    ds_write_b64 v5, v[164:165] offset:18624
    v_lshlrev_b32 v249, 16, v196
    v_mfma_f32_16x16x32_bf16 a[8:11], a[200:203], v[228:231], 0
    ds_read_b128 v[228:231], v253 offset:256
    v_cvt_pk_bf16_f32 v156, v156, v157
    v_lshlrev_b32 v250, 16, v198
    v_lshlrev_b32 v251, 16, v200
    v_mfma_f32_16x16x32_bf16 a[0:3], a[204:207], v[232:235], a[0:3]
    buffer_load_dwordx4 a[244:247], v254, s[8:11], s42 offen offset:1024 sc1
    v_and_b32 v194, s22, v194
    v_mfma_f32_16x16x32_bf16 a[4:7], a[208:211], v[232:235], a[4:7]
    v_cvt_pk_bf16_f32 v157, v158, v159
    v_cvt_pk_bf16_f32 v158, v160, v161
    v_and_b32 v196, s22, v196
    v_and_b32 v198, s22, v198
    v_mfma_f32_16x16x32_bf16 a[8:11], a[212:215], v[232:235], a[8:11]
    s_waitcnt lgkmcnt(2)
    v_cvt_pk_bf16_f32 v159, v162, v163
    v_and_b32 v200, s22, v200
    v_lshlrev_b32 v252, 16, v192
    v_mfma_f32_16x16x32_bf16 a[12:15], a[192:195], v[232:235], 0
    ds_write_b128 v4, v[156:159] offset:18560
    v_and_b32 v192, s22, v192
    v_add_f32 v252, v252, v251
    v_mfma_f32_16x16x32_bf16 a[12:15], a[204:207], v[236:239], a[12:15]
    buffer_load_dwordx4 a[248:251], v254, s[8:11], s42 offen offset:2048 sc1
    v_add_f32 v192, v192, v200
    v_mfma_f32_16x16x32_bf16 a[16:19], a[208:211], v[236:239], 0
    v_cvt_pk_bf16_f32 v176, v176, v177
    v_cvt_pk_bf16_f32 v177, v178, v179
    v_fmac_f32 v252, s23, v249
    v_fmac_f32 v192, s23, v196
    v_mfma_f32_16x16x32_bf16 a[16:19], a[196:199], v[232:235], a[16:19]
    s_add_u32 s42, s32, 43008
    v_cvt_pk_bf16_f32 v192, v252, v192
    v_lshlrev_b32 v252, 16, v202
    v_and_b32 v202, s22, v202
    v_mfma_f32_16x16x32_bf16 a[20:23], a[200:203], v[232:235], 0
    ds_read_b128 v[232:235], v253 offset:0
    v_add_f32 v252, v252, v248
    v_add_f32 v202, v202, v194
    v_mfma_f32_16x16x32_bf16 a[20:23], a[212:215], v[236:239], a[20:23]
    buffer_load_dwordx4 a[252:255], v254, s[8:11], s42 offen offset:0 sc1
    v_fmac_f32 v252, s23, v250
    v_fmac_f32 v202, s23, v198
    s_waitcnt vmcnt(15)
    v_mfma_f32_16x16x32_bf16 a[0:3], a[216:219], v[236:239], a[0:3]
    ds_write_b64 v5, v[176:177] offset:19008
    v_cvt_pk_bf16_f32 v202, v252, v202
    v_mfma_f32_16x16x32_bf16 a[4:7], a[220:223], v[236:239], a[4:7]
    v_cvt_pk_bf16_f32 v168, v168, v169
    v_cvt_pk_bf16_f32 v169, v170, v171
    v_fma_f32 v252, v249, s24, v251
    v_fmac_f32 v251, s25, v249
    v_mfma_f32_16x16x32_bf16 a[8:11], a[224:227], v[236:239], a[8:11]
    s_waitcnt lgkmcnt(3)
    v_cvt_pk_bf16_f32 v170, v172, v173
    v_cvt_pk_bf16_f32 v171, v174, v175
    v_fma_f32 v249, v248, s24, v250
    v_mfma_f32_16x16x32_bf16 a[24:27], a[192:195], v[236:239], 0
    buffer_load_dwordx4 v[240:243], v254, s[8:11], s42 offen offset:1024 sc1
    v_fmac_f32 v250, s25, v248
    v_fma_f32 v248, v250, s26, v251
    v_mfma_f32_16x16x32_bf16 a[24:27], a[204:207], v[228:231], a[24:27]
    ds_write_b128 v4, v[168:171] offset:18944
    v_fmac_f32 v251, s27, v250
    v_mfma_f32_16x16x32_bf16 a[28:31], a[208:211], v[228:231], 0
    v_cvt_pk_bf16_f32 v188, v188, v189
    v_cvt_pk_bf16_f32 v189, v190, v191
    v_fma_f32 v250, v249, s28, v252
    v_fmac_f32 v252, s29, v249
    v_mfma_f32_16x16x32_bf16 a[28:31], a[196:199], v[236:239], a[28:31]
    buffer_load_dwordx4 v[244:247], v254, s[8:11], s42 offen offset:2048 sc1
    v_fma_f32 v249, v196, s24, v200
    v_mfma_f32_16x16x32_bf16 a[32:35], a[200:203], v[236:239], 0
    ds_read_b128 v[236:239], v253 offset:1824
    v_and_b32 v227, 0x7fff, v255
    v_fmac_f32 v200, s25, v196
    v_fma_f32 v196, v194, s24, v198
    v_mfma_f32_16x16x32_bf16 a[32:35], a[212:215], v[228:231], a[32:35]
    ds_write_b64 v5, v[188:189] offset:19392
    v_fmac_f32 v198, s25, v194
    v_mfma_f32_16x16x32_bf16 a[12:15], a[216:219], v[228:231], a[12:15]
    buffer_load_dwordx2 v[216:217], v227, s[4:7], s16 offen offset:832
    v_fma_f32 v194, v198, s26, v200
    v_mfma_f32_16x16x32_bf16 a[16:19], a[220:223], v[228:231], a[16:19]
    v_cvt_pk_bf16_f32 v180, v180, v181
    v_cvt_pk_bf16_f32 v181, v182, v183
    v_fmac_f32 v200, s27, v198
    v_fma_f32 v198, v196, s28, v249
    v_mfma_f32_16x16x32_bf16 a[20:23], a[224:227], v[228:231], a[20:23]
    s_waitcnt lgkmcnt(4)
    v_cvt_pk_bf16_f32 v182, v184, v185
    v_cvt_pk_bf16_f32 v183, v186, v187
    v_fmac_f32 v249, s29, v196
    v_mfma_f32_16x16x32_bf16 a[36:39], a[192:195], v[228:231], 0
    buffer_load_dwordx2 v[218:219], v227, s[4:7], s17 offen offset:832
    v_cvt_pk_bf16_f32 v194, v248, v194
    v_cvt_pk_bf16_f32 v200, v251, v200
    v_mfma_f32_16x16x32_bf16 a[36:39], a[204:207], v[232:235], a[36:39]
    ds_write_b128 v4, v[180:183] offset:19328
    v_cvt_pk_bf16_f32 v198, v250, v198
    v_mfma_f32_16x16x32_bf16 a[40:43], a[208:211], v[232:235], 0
    v_cvt_pk_bf16_f32 v196, v252, v249
    v_lshlrev_b32 v248, 16, v195
    v_lshlrev_b32 v249, 16, v197
    v_lshlrev_b32 v250, 16, v199
    v_mfma_f32_16x16x32_bf16 a[40:43], a[196:199], v[228:231], a[40:43]
    buffer_load_dwordx2 v[220:221], v227, s[4:7], s18 offen offset:832
    v_lshlrev_b32 v251, 16, v201
    v_mfma_f32_16x16x32_bf16 a[44:47], a[200:203], v[228:231], 0
    ds_read_b128 v[228:231], v253 offset:1568
    v_and_b32 v195, s22, v195
    v_and_b32 v197, s22, v197
    v_and_b32 v199, s22, v199
    v_mfma_f32_16x16x32_bf16 a[44:47], a[212:215], v[232:235], a[44:47]
    s_waitcnt lgkmcnt(3)
    v_and_b32 v201, s22, v201
    v_lshlrev_b32 v252, 16, v193
    v_and_b32 v193, s22, v193
    v_mfma_f32_16x16x32_bf16 a[24:27], a[216:219], v[232:235], a[24:27]
    s_waitcnt lgkmcnt(0)
    v_add_f32 v252, v252, v251
    v_add_f32 v193, v193, v201
    v_fmac_f32 v252, s23, v249
    v_mfma_f32_16x16x32_bf16 a[28:31], a[220:223], v[232:235], a[28:31]
    s_barrier
    v_fmac_f32 v193, s23, v197
    v_cvt_pk_bf16_f32 v193, v252, v193
    v_mfma_f32_16x16x32_bf16 a[32:35], a[224:227], v[232:235], a[32:35]
    buffer_load_dwordx2 v[222:223], v227, s[4:7], s19 offen offset:832
    v_lshlrev_b32 v252, 16, v203
    v_mfma_f32_16x16x32_bf16 a[48:51], a[192:195], v[232:235], 0
    ds_read_b128 v[144:147], v6 offset:16640
    v_and_b32 v203, s22, v203
    v_add_f32 v252, v252, v248
    v_add_f32 v203, v203, v195
    v_mfma_f32_16x16x32_bf16 a[48:51], a[204:207], v[236:239], a[48:51]
    v_fmac_f32 v252, s23, v250
    v_fmac_f32 v203, s23, v199
    v_cvt_pk_bf16_f32 v203, v252, v203
    v_mfma_f32_16x16x32_bf16 a[52:55], a[208:211], v[236:239], 0
    buffer_load_dwordx2 v[224:225], v227, s[4:7], s20 offen offset:832
    v_fma_f32 v252, v249, s24, v251
    v_fmac_f32 v251, s25, v249
    v_mfma_f32_16x16x32_bf16 a[52:55], a[196:199], v[232:235], a[52:55]
    v_fma_f32 v249, v248, s24, v250
    v_fmac_f32 v250, s25, v248
    v_fma_f32 v248, v250, s26, v251
    v_mfma_f32_16x16x32_bf16 a[56:59], a[200:203], v[232:235], 0
    ds_read_b128 v[232:235], v253 offset:1312
    s_add_u32 s44, s41, 0
    v_fmac_f32 v251, s27, v250
    v_fma_f32 v250, v249, s28, v252
    v_mfma_f32_16x16x32_bf16 a[56:59], a[212:215], v[236:239], a[56:59]
    buffer_load_dwordx2 v[226:227], v227, s[4:7], s21 offen offset:832
    v_fmac_f32 v252, s29, v249
    v_mfma_f32_16x16x32_bf16 a[36:39], a[216:219], v[236:239], a[36:39]
    v_fma_f32 v249, v197, s24, v201
    v_fmac_f32 v201, s25, v197
    v_fma_f32 v197, v195, s24, v199
    v_fmac_f32 v199, s25, v195
    v_mfma_f32_16x16x32_bf16 a[40:43], a[220:223], v[236:239], a[40:43]
    ds_read_b128 v[148:151], v6 offset:17664
    v_fma_f32 v195, v199, s26, v201
    v_fmac_f32 v201, s27, v199
    v_mfma_f32_16x16x32_bf16 a[44:47], a[224:227], v[236:239], a[44:47]
    s_waitcnt lgkmcnt(2)
    v_fma_f32 v199, v197, s28, v249
    v_fmac_f32 v249, s29, v197
    v_cvt_pk_bf16_f32 v195, v248, v195
    v_mfma_f32_16x16x32_bf16 a[60:63], a[192:195], v[236:239], 0
    v_cvt_pk_bf16_f32 v201, v251, v201
    v_cvt_pk_bf16_f32 v199, v250, v199
    v_cvt_pk_bf16_f32 v197, v252, v249
    v_lshrrev_b32 v252, 15, v255
    v_mfma_f32_16x16x32_bf16 a[60:63], a[204:207], v[228:231], a[60:63]
    ds_write_b64 v252, v[194:195] offset:9088
    s_waitcnt vmcnt(17)
    v_mfma_f32_16x16x32_bf16 a[64:67], a[208:211], v[228:231], 0
    v_lshlrev_b32 v248, 16, v206
    v_lshlrev_b32 v249, 16, v208
    v_mfma_f32_16x16x32_bf16 a[64:67], a[196:199], v[236:239], a[64:67]
    ds_write_b64 v252, v[200:201] offset:11168
    v_lshlrev_b32 v250, 16, v210
    v_mfma_f32_16x16x32_bf16 a[68:71], a[200:203], v[236:239], 0
    ds_read_b128 v[236:239], v253 offset:1056
    v_lshlrev_b32 v251, 16, v212
    v_mfma_f32_16x16x32_bf16 a[68:71], a[212:215], v[228:231], a[68:71]
    buffer_store_dwordx4 v[144:147], v254, s[12:15], s44 offen sc1
    v_mfma_f32_16x16x32_bf16 a[48:51], a[216:219], v[228:231], a[48:51]
    ds_read_b128 v[152:155], v6 offset:18688
    v_mfma_f32_16x16x32_bf16 a[52:55], a[220:223], v[228:231], a[52:55]
    ds_write_b64 v252, v[198:199] offset:13248
    v_and_b32 v206, s22, v206
    v_mfma_f32_16x16x32_bf16 a[56:59], a[224:227], v[228:231], a[56:59]
    s_waitcnt lgkmcnt(6)
    v_and_b32 v208, s22, v208
    v_mfma_f32_16x16x32_bf16 a[72:75], a[192:195], v[228:231], 0
    s_add_u32 s44, s41, 1024
    v_mfma_f32_16x16x32_bf16 a[72:75], a[204:207], v[232:235], a[72:75]
    ds_write_b64 v252, v[192:193] offset:15328
    v_and_b32 v210, s22, v210
    v_mfma_f32_16x16x32_bf16 a[76:79], a[208:211], v[232:235], 0
    v_and_b32 v212, s22, v212
    v_mfma_f32_16x16x32_bf16 a[76:79], a[196:199], v[228:231], a[76:79]
    ds_write_b64 v252, v[202:203] offset:38208
    v_mfma_f32_16x16x32_bf16 a[80:83], a[200:203], v[228:231], 0
    ds_read_b128 v[228:231], v253 offset:784
    v_mfma_f32_16x16x32_bf16 a[80:83], a[212:215], v[232:235], a[80:83]
    s_waitcnt lgkmcnt(8)
    v_mfma_f32_16x16x32_bf16 a[60:63], a[216:219], v[232:235], a[60:63]
    ds_read_b128 v[156:159], v6 offset:19744
    v_mfma_f32_16x16x32_bf16 a[64:67], a[220:223], v[232:235], a[64:67]
    ds_write_b64 v252, v[196:197] offset:31968
    v_mfma_f32_16x16x32_bf16 a[68:71], a[224:227], v[232:235], a[68:71]
    s_add_u32 s42, s32, 73728
    v_mfma_f32_16x16x32_bf16 a[84:87], a[192:195], v[232:235], 0
    buffer_load_dwordx4 a[192:195], v254, s[8:11], s42 offen offset:0 sc1
    v_mfma_f32_16x16x32_bf16 a[88:91], a[196:199], v[232:235], 0
    v_lshlrev_b32 v252, 16, v204
    v_and_b32 v204, s22, v204
    v_mfma_f32_16x16x32_bf16 a[92:95], a[200:203], v[232:235], 0
    s_waitcnt lgkmcnt(7)
    v_add_f32 v252, v252, v251
    v_add_f32 v204, v204, v212
    v_fmac_f32 v252, s23, v249
    v_mfma_f32_16x16x32_bf16 a[84:87], a[204:207], v[236:239], a[84:87]
    ds_read_b128 v[232:235], v253 offset:3120
    v_fmac_f32 v204, s23, v208
    v_mfma_f32_16x16x32_bf16 a[88:91], a[208:211], v[236:239], a[88:91]
    buffer_load_dwordx4 a[196:199], v254, s[8:11], s42 offen offset:1024 sc1
    v_mfma_f32_16x16x32_bf16 a[92:95], a[212:215], v[236:239], a[92:95]
    ds_read_b128 v[160:163], v6 offset:20768
    v_cvt_pk_bf16_f32 v204, v252, v204
    v_lshlrev_b32 v252, 16, v214
    v_mfma_f32_16x16x32_bf16 a[72:75], a[216:219], v[236:239], a[72:75]
    s_waitcnt lgkmcnt(4)
    v_and_b32 v214, s22, v214
    v_add_f32 v252, v252, v248
    v_mfma_f32_16x16x32_bf16 a[76:79], a[220:223], v[236:239], a[76:79]
    buffer_load_dwordx4 a[200:203], v254, s[8:11], s42 offen offset:2048 sc1
    v_mfma_f32_16x16x32_bf16 a[80:83], a[224:227], v[236:239], a[80:83]
    ds_read_b128 v[236:239], v253 offset:2848
    v_add_f32 v214, v214, v206
    v_fmac_f32 v252, s23, v250
    v_mfma_f32_16x16x32_bf16 a[84:87], a[216:219], v[228:231], a[84:87]
    s_add_u32 s42, s32, 76800
    v_fmac_f32 v214, s23, v210
    v_cvt_pk_bf16_f32 v214, v252, v214
    v_mfma_f32_16x16x32_bf16 a[88:91], a[220:223], v[228:231], a[88:91]
    buffer_load_dwordx4 a[204:207], v254, s[8:11], s42 offen offset:0 sc1
    v_mfma_f32_16x16x32_bf16 a[92:95], a[224:227], v[228:231], a[92:95]
    ds_read_b128 v[228:231], v253 offset:2592
    v_fma_f32 v252, v249, s24, v251
    v_fmac_f32 v251, s25, v249
    s_waitcnt vmcnt(17)
    s_waitcnt lgkmcnt(3)
sub1:
    v_mfma_f32_16x16x32_bf16 a[96:99], a[228:231], v[232:235], 0
    s_waitcnt vmcnt(14) lgkmcnt(1)
    v_fma_f32 v249, v248, s24, v250
    v_fmac_f32 v250, s25, v248
    v_mfma_f32_16x16x32_bf16 a[100:103], a[232:235], v[232:235], 0
    ds_read_b128 v[164:167], v6 offset:21792
    v_fma_f32 v248, v250, s26, v251
    v_mfma_f32_16x16x32_bf16 a[104:107], a[236:239], v[232:235], 0
    ds_read_b128 v[232:235], v253 offset:2336
    v_fmac_f32 v251, s27, v250
    v_fma_f32 v250, v249, s28, v252
    v_mfma_f32_16x16x32_bf16 a[96:99], a[240:243], v[236:239], a[96:99]
    buffer_load_dwordx4 a[208:211], v254, s[8:11], s42 offen offset:1024 sc1
    v_mfma_f32_16x16x32_bf16 a[100:103], a[244:247], v[236:239], a[100:103]
    v_fmac_f32 v252, s29, v249
    v_fma_f32 v249, v208, s24, v212
    v_mfma_f32_16x16x32_bf16 a[104:107], a[248:251], v[236:239], a[104:107]
    v_fmac_f32 v212, s25, v208
    v_fma_f32 v208, v206, s24, v210
    v_fmac_f32 v210, s25, v206
    v_mfma_f32_16x16x32_bf16 a[108:111], a[228:231], v[236:239], 0
    s_waitcnt lgkmcnt(2)
    v_fma_f32 v206, v210, s26, v212
    v_fmac_f32 v212, s27, v210
    v_mfma_f32_16x16x32_bf16 a[108:111], a[240:243], v[228:231], a[108:111]
    buffer_load_dwordx4 a[212:215], v254, s[8:11], s42 offen offset:2048 sc1
    v_fma_f32 v210, v208, s28, v249
    v_mfma_f32_16x16x32_bf16 a[112:115], a[244:247], v[228:231], 0
    v_fmac_f32 v249, s29, v208
    v_cvt_pk_bf16_f32 v206, v248, v206
    v_mfma_f32_16x16x32_bf16 a[112:115], a[232:235], v[236:239], a[112:115]
    s_add_u32 s42, s32, 79872
    v_cvt_pk_bf16_f32 v212, v251, v212
    v_cvt_pk_bf16_f32 v210, v250, v210
    v_mfma_f32_16x16x32_bf16 a[116:119], a[236:239], v[236:239], 0
    ds_read_b128 v[236:239], v253 offset:2080
    v_cvt_pk_bf16_f32 v208, v252, v249
    v_lshlrev_b32 v248, 16, v207
    v_mfma_f32_16x16x32_bf16 a[116:119], a[248:251], v[228:231], a[116:119]
    buffer_load_dwordx4 a[216:219], v254, s[8:11], s42 offen offset:0 sc1
    s_waitcnt vmcnt(14)
    v_mfma_f32_16x16x32_bf16 a[96:99], a[252:255], v[228:231], a[96:99]
    ds_read_b128 v[168:171], v6 offset:22848
    v_lshlrev_b32 v249, 16, v209
    v_mfma_f32_16x16x32_bf16 a[100:103], v[240:243], v[228:231], a[100:103]
    v_lshlrev_b32 v250, 16, v211
    v_lshlrev_b32 v251, 16, v213
    v_and_b32 v207, s22, v207
    v_mfma_f32_16x16x32_bf16 a[104:107], v[244:247], v[228:231], a[104:107]
    s_waitcnt lgkmcnt(2)
    v_and_b32 v209, s22, v209
    v_and_b32 v211, s22, v211
    v_mfma_f32_16x16x32_bf16 a[120:123], a[228:231], v[228:231], 0
    buffer_load_dwordx4 a[220:223], v254, s[8:11], s42 offen offset:1024 sc1
    v_mfma_f32_16x16x32_bf16 a[120:123], a[240:243], v[232:235], a[120:123]
    v_and_b32 v213, s22, v213
    v_lshlrev_b32 v252, 16, v205
    v_and_b32 v205, s22, v205
    v_mfma_f32_16x16x32_bf16 a[124:127], a[244:247], v[232:235], 0
    v_add_f32 v252, v252, v251
    v_add_f32 v205, v205, v213
    v_mfma_f32_16x16x32_bf16 a[124:127], a[232:235], v[228:231], a[124:127]
    buffer_load_dwordx4 a[224:227], v254, s[8:11], s42 offen offset:2048 sc1
    v_mfma_f32_16x16x32_bf16 a[128:131], a[236:239], v[228:231], 0
    ds_read_b128 v[228:231], v253 offset:3904
    v_and_b32 v203, 0x7fff, v255
    v_fmac_f32 v252, s23, v249
    v_mfma_f32_16x16x32_bf16 a[128:131], a[248:251], v[232:235], a[128:131]
    ds_read_b128 v[172:175], v6 offset:23872
    v_fmac_f32 v205, s23, v209
    v_mfma_f32_16x16x32_bf16 a[108:111], a[252:255], v[232:235], a[108:111]
    buffer_load_dwordx2 v[192:193], v203, s[4:7], s16 offen offset:1216
    v_mfma_f32_16x16x32_bf16 a[112:115], v[240:243], v[232:235], a[112:115]
    v_cvt_pk_bf16_f32 v205, v252, v205
    v_lshlrev_b32 v252, 16, v215
    v_and_b32 v215, s22, v215
    v_mfma_f32_16x16x32_bf16 a[116:119], v[244:247], v[232:235], a[116:119]
    s_waitcnt lgkmcnt(3)
    v_add_f32 v252, v252, v248
    v_add_f32 v215, v215, v207
    v_mfma_f32_16x16x32_bf16 a[132:135], a[228:231], v[232:235], 0
    buffer_load_dwordx2 v[194:195], v203, s[4:7], s17 offen offset:1216
    v_mfma_f32_16x16x32_bf16 a[132:135], a[240:243], v[236:239], a[132:135]
    v_fmac_f32 v252, s23, v250
    v_fmac_f32 v215, s23, v211
    v_cvt_pk_bf16_f32 v215, v252, v215
    v_mfma_f32_16x16x32_bf16 a[136:139], a[244:247], v[236:239], 0
    ds_read_b128 v[176:179], v6 offset:24896
    v_fma_f32 v252, v249, s24, v251
    v_mfma_f32_16x16x32_bf16 a[136:139], a[232:235], v[232:235], a[136:139]
    buffer_load_dwordx2 v[196:197], v203, s[4:7], s18 offen offset:1216
    v_fmac_f32 v251, s25, v249
    v_mfma_f32_16x16x32_bf16 a[140:143], a[236:239], v[232:235], 0
    ds_read_b128 v[232:235], v253 offset:3648
    v_fma_f32 v249, v248, s24, v250
    v_mfma_f32_16x16x32_bf16 a[140:143], a[248:251], v[236:239], a[140:143]
    v_fmac_f32 v250, s25, v248
    v_fma_f32 v248, v250, s26, v251
    v_mfma_f32_16x16x32_bf16 a[120:123], a[252:255], v[236:239], a[120:123]
    buffer_load_dwordx2 v[198:199], v203, s[4:7], s19 offen offset:1216
    v_fmac_f32 v251, s27, v250
    v_mfma_f32_16x16x32_bf16 a[124:127], v[240:243], v[236:239], a[124:127]
    v_fma_f32 v250, v249, s28, v252
    v_fmac_f32 v252, s29, v249
    v_mfma_f32_16x16x32_bf16 a[128:131], v[244:247], v[236:239], a[128:131]
    s_waitcnt lgkmcnt(3)
    v_fma_f32 v249, v209, s24, v213
    v_fmac_f32 v213, s25, v209
    v_mfma_f32_16x16x32_bf16 a[144:147], a[228:231], v[236:239], 0
    buffer_load_dwordx2 v[200:201], v203, s[4:7], s20 offen offset:1216
    v_fma_f32 v209, v207, s24, v211
    v_mfma_f32_16x16x32_bf16 a[144:147], a[240:243], v[228:231], a[144:147]
    v_fmac_f32 v211, s25, v207
    v_fma_f32 v207, v211, s26, v213
    v_mfma_f32_16x16x32_bf16 a[148:151], a[244:247], v[228:231], 0
    ds_read_b128 v[180:183], v6 offset:25952
    v_fmac_f32 v213, s27, v211
    v_mfma_f32_16x16x32_bf16 a[148:151], a[232:235], v[236:239], a[148:151]
    buffer_load_dwordx2 v[202:203], v203, s[4:7], s21 offen offset:1216
    v_fma_f32 v211, v209, s28, v249
    v_mfma_f32_16x16x32_bf16 a[152:155], a[236:239], v[236:239], 0
    ds_read_b128 v[236:239], v253 offset:3392
    v_fmac_f32 v249, s29, v209
    v_mfma_f32_16x16x32_bf16 a[152:155], a[248:251], v[228:231], a[152:155]
    v_cvt_pk_bf16_f32 v207, v248, v207
    v_cvt_pk_bf16_f32 v213, v251, v213
    v_mfma_f32_16x16x32_bf16 a[132:135], a[252:255], v[228:231], a[132:135]
    buffer_store_dwordx4 v[148:151], v254, s[12:15], s44 offen sc1
    s_add_u32 s44, s41, 2048
    v_cvt_pk_bf16_f32 v211, v250, v211
    v_mfma_f32_16x16x32_bf16 a[136:139], v[240:243], v[228:231], a[136:139]
    s_waitcnt lgkmcnt(2)
    v_cvt_pk_bf16_f32 v209, v252, v249
    v_lshrrev_b32 v252, 15, v255
    v_mfma_f32_16x16x32_bf16 a[140:143], v[244:247], v[228:231], a[140:143]
    ds_write_b64 v252, v[206:207] offset:8832
    v_mfma_f32_16x16x32_bf16 a[156:159], a[228:231], v[228:231], 0
    buffer_store_dwordx4 v[152:155], v254, s[12:15], s44 offen sc1
    s_add_u32 s44, s41, 3072
    s_waitcnt vmcnt(18)
    v_mfma_f32_16x16x32_bf16 a[156:159], a[240:243], v[232:235], a[156:159]
    ds_read_b128 v[184:187], v6 offset:26976
    v_lshlrev_b32 v248, 16, v218
    v_mfma_f32_16x16x32_bf16 a[160:163], a[244:247], v[232:235], 0
    v_lshlrev_b32 v249, 16, v220
    v_mfma_f32_16x16x32_bf16 a[160:163], a[232:235], v[228:231], a[160:163]
    buffer_store_dwordx4 v[156:159], v254, s[12:15], s44 offen sc1
    s_add_u32 s44, s41, 4096
    v_mfma_f32_16x16x32_bf16 a[164:167], a[236:239], v[228:231], 0
    ds_read_b128 v[228:231], v253 offset:3136
    v_mfma_f32_16x16x32_bf16 a[164:167], a[248:251], v[232:235], a[164:167]
    ds_write_b64 v252, v[212:213] offset:10912
    v_lshlrev_b32 v250, 16, v222
    v_mfma_f32_16x16x32_bf16 a[144:147], a[252:255], v[232:235], a[144:147]
    buffer_store_dwordx4 v[160:163], v254, s[12:15], s44 offen sc1
    s_add_u32 s44, s41, 5120
    v_mfma_f32_16x16x32_bf16 a[148:151], v[240:243], v[232:235], a[148:151]
    s_waitcnt lgkmcnt(4)
    v_lshlrev_b32 v251, 16, v224
    v_mfma_f32_16x16x32_bf16 a[152:155], v[244:247], v[232:235], a[152:155]
    ds_write_b64 v252, v[210:211] offset:12992
    v_and_b32 v218, s22, v218
    v_mfma_f32_16x16x32_bf16 a[168:171], a[228:231], v[232:235], 0
    ds_read_b128 v[188:191], v6 offset:28000
    v_and_b32 v220, s22, v220
    v_mfma_f32_16x16x32_bf16 a[168:171], a[240:243], v[236:239], a[168:171]
    buffer_store_dwordx4 v[164:167], v254, s[12:15], s44 offen sc1
    s_add_u32 s44, s41, 6144
    v_mfma_f32_16x16x32_bf16 a[172:175], a[244:247], v[236:239], 0
    ds_write_b64 v252, v[204:205] offset:15072
    v_and_b32 v222, s22, v222
    v_mfma_f32_16x16x32_bf16 a[172:175], a[232:235], v[232:235], a[172:175]
    v_and_b32 v224, s22, v224
    v_mfma_f32_16x16x32_bf16 a[176:179], a[236:239], v[232:235], 0
    ds_read_b128 v[232:235], v253 offset:2864
    v_mfma_f32_16x16x32_bf16 a[176:179], a[248:251], v[236:239], a[176:179]
    ds_write_b64 v252, v[214:215] offset:37952
    v_mfma_f32_16x16x32_bf16 a[156:159], a[252:255], v[236:239], a[156:159]
    v_mfma_f32_16x16x32_bf16 a[160:163], v[240:243], v[236:239], a[160:163]
    ds_write_b64 v252, v[208:209] offset:31712
    v_mfma_f32_16x16x32_bf16 a[164:167], v[244:247], v[236:239], a[164:167]
    s_add_u32 s42, s32, 110592
    v_mfma_f32_16x16x32_bf16 a[180:183], a[228:231], v[236:239], 0
    buffer_load_dwordx4 a[228:231], v254, s[8:11], s42 offen offset:0 sc1
    v_mfma_f32_16x16x32_bf16 a[184:187], a[232:235], v[236:239], 0
    v_lshlrev_b32 v252, 16, v216
    v_and_b32 v216, s22, v216
    v_mfma_f32_16x16x32_bf16 a[188:191], a[236:239], v[236:239], 0
    s_waitcnt lgkmcnt(2)
    v_add_f32 v252, v252, v251
    v_add_f32 v216, v216, v224
    v_fmac_f32 v252, s23, v249
    v_mfma_f32_16x16x32_bf16 a[180:183], a[240:243], v[228:231], a[180:183]
    ds_read_b128 v[236:239], v253 offset:5200
    v_fmac_f32 v216, s23, v220
    v_mfma_f32_16x16x32_bf16 a[184:187], a[244:247], v[228:231], a[184:187]
    buffer_load_dwordx4 a[232:235], v254, s[8:11], s42 offen offset:1024 sc1
    v_mfma_f32_16x16x32_bf16 a[188:191], a[248:251], v[228:231], a[188:191]
    ds_read_b128 v[204:207], v253 offset:39712
    v_cvt_pk_bf16_f32 v216, v252, v216
    v_lshlrev_b32 v252, 16, v226
    v_mfma_f32_16x16x32_bf16 a[168:171], a[252:255], v[228:231], a[168:171]
    s_mov_b32 s45, 619910279
    v_and_b32 v226, s22, v226
    v_add_f32 v252, v252, v248
    v_mfma_f32_16x16x32_bf16 a[172:175], v[240:243], v[228:231], a[172:175]
    buffer_load_dwordx4 a[236:239], v254, s[8:11], s42 offen offset:2048 sc1
    v_add_f32 v226, v226, v218
    v_mfma_f32_16x16x32_bf16 a[176:179], v[244:247], v[228:231], a[176:179]
    ds_read_b128 v[228:231], v253 offset:4928
    v_fmac_f32 v252, s23, v250
    v_mfma_f32_16x16x32_bf16 a[180:183], a[252:255], v[232:235], a[180:183]
    s_add_u32 s42, s32, 113664
    v_bfe_u32 v208, v254, 5, 3
    v_fmac_f32 v226, s23, v222
    v_mfma_f32_16x16x32_bf16 a[184:187], v[240:243], v[232:235], a[184:187]
    buffer_load_dwordx4 a[240:243], v254, s[8:11], s42 offen offset:0 sc1
    v_cvt_pk_bf16_f32 v226, v252, v226
    v_mfma_f32_16x16x32_bf16 a[188:191], v[244:247], v[232:235], a[188:191]
    ds_read_b128 v[232:235], v253 offset:4672
    v_mul_u32_u24 v209, 5, v208
    s_waitcnt vmcnt(21)
    s_waitcnt lgkmcnt(3)
sub2:
    v_mfma_f32_16x16x32_bf16 v[0:3], a[192:195], v[236:239], 0
    v_fma_f32 v252, v249, s24, v251
    v_fmac_f32 v251, s25, v249
    v_mfma_f32_16x16x32_bf16 v[4:7], a[196:199], v[236:239], 0
    s_waitcnt vmcnt(18) lgkmcnt(1)
    v_fma_f32 v249, v248, s24, v250
    v_fmac_f32 v250, s25, v248
    v_fma_f32 v248, v250, s26, v251
    v_mfma_f32_16x16x32_bf16 v[8:11], a[200:203], v[236:239], 0
    ds_read_b128 v[236:239], v253 offset:4416
    v_bfe_u32 v209, s45, v209, 5
    v_mfma_f32_16x16x32_bf16 v[0:3], a[204:207], v[228:231], v[0:3]
    buffer_load_dwordx4 a[244:247], v254, s[8:11], s42 offen offset:1024 sc1
    v_mfma_f32_16x16x32_bf16 v[4:7], a[208:211], v[228:231], v[4:7]
    v_fmac_f32 v251, s27, v250
    v_fma_f32 v250, v249, s28, v252
    v_fmac_f32 v252, s29, v249
    v_mfma_f32_16x16x32_bf16 v[8:11], a[212:215], v[228:231], v[8:11]
    v_mul_u32_u24 v209, 65, v209
    v_fma_f32 v249, v220, s24, v224
    v_mfma_f32_16x16x32_bf16 v[12:15], a[192:195], v[228:231], 0
    s_waitcnt lgkmcnt(1)
    v_fmac_f32 v224, s25, v220
    v_fma_f32 v220, v218, s24, v222
    v_mfma_f32_16x16x32_bf16 v[12:15], a[204:207], v[232:235], v[12:15]
    buffer_load_dwordx4 a[248:251], v254, s[8:11], s42 offen offset:2048 sc1
    v_fmac_f32 v222, s25, v218
    v_mfma_f32_16x16x32_bf16 v[16:19], a[208:211], v[232:235], 0
    v_sub_u32 v209, v209, v208
    v_fma_f32 v218, v222, s26, v224
    v_mfma_f32_16x16x32_bf16 v[16:19], a[196:199], v[228:231], v[16:19]
    s_add_u32 s42, s32, 116736
    v_fmac_f32 v224, s27, v222
    v_fma_f32 v222, v220, s28, v249
    v_mfma_f32_16x16x32_bf16 v[20:23], a[200:203], v[228:231], 0
    ds_read_b128 v[228:231], v253 offset:4160
    v_lshl_add_u32 v208, v209, 5, v253
    v_fmac_f32 v249, s29, v220
    v_mfma_f32_16x16x32_bf16 v[20:23], a[212:215], v[232:235], v[20:23]
    buffer_load_dwordx4 a[252:255], v254, s[8:11], s42 offen offset:0 sc1
    s_waitcnt vmcnt(18)
    v_mfma_f32_16x16x32_bf16 v[0:3], a[216:219], v[232:235], v[0:3]
    v_cvt_pk_bf16_f32 v218, v248, v218
    v_cvt_pk_bf16_f32 v224, v251, v224
    v_mfma_f32_16x16x32_bf16 v[4:7], a[220:223], v[232:235], v[4:7]
    v_cvt_pk_bf16_f32 v222, v250, v222
    v_cvt_pk_bf16_f32 v220, v252, v249
    v_lshlrev_b32 v248, 16, v219
    v_mfma_f32_16x16x32_bf16 v[8:11], a[224:227], v[232:235], v[8:11]
    s_waitcnt lgkmcnt(1)
    v_lshlrev_b32 v249, 16, v221
    v_lshlrev_b32 v250, 16, v223
    v_mfma_f32_16x16x32_bf16 v[24:27], a[192:195], v[232:235], 0
    buffer_load_dwordx4 v[240:243], v254, s[8:11], s42 offen offset:1024 sc1
    v_lshlrev_b32 v251, 16, v225
    v_mfma_f32_16x16x32_bf16 v[24:27], a[204:207], v[236:239], v[24:27]
    s_mov_b64 exec, s[46:47]
    ds_write_b128 v208, v[204:207] offset:1024
    s_mov_b64 exec, -1
    v_mfma_f32_16x16x32_bf16 v[28:31], a[208:211], v[236:239], 0
    v_and_b32 v219, s22, v219
    v_and_b32 v221, s22, v221
    v_mfma_f32_16x16x32_bf16 v[28:31], a[196:199], v[232:235], v[28:31]
    buffer_load_dwordx4 v[244:247], v254, s[8:11], s42 offen offset:2048 sc1
    v_and_b32 v223, s22, v223
    v_mfma_f32_16x16x32_bf16 v[32:35], a[200:203], v[232:235], 0
    ds_read_b128 v[232:235], v253 offset:5984
    v_and_b32 v215, 0x7fff, v255
    v_mfma_f32_16x16x32_bf16 v[32:35], a[212:215], v[236:239], v[32:35]
    v_and_b32 v225, s22, v225
    v_lshlrev_b32 v252, 16, v217
    v_mfma_f32_16x16x32_bf16 v[12:15], a[216:219], v[236:239], v[12:15]
    buffer_load_dwordx2 v[204:205], v215, s[4:7], s16 offen offset:128
    v_and_b32 v217, s22, v217
    v_mfma_f32_16x16x32_bf16 v[16:19], a[220:223], v[236:239], v[16:19]
    v_add_f32 v252, v252, v251
    v_add_f32 v217, v217, v225
    v_mfma_f32_16x16x32_bf16 v[20:23], a[224:227], v[236:239], v[20:23]
    s_waitcnt lgkmcnt(2)
    v_fmac_f32 v252, s23, v249
    v_fmac_f32 v217, s23, v221
    v_mfma_f32_16x16x32_bf16 v[36:39], a[192:195], v[236:239], 0
    buffer_load_dwordx2 v[206:207], v215, s[4:7], s17 offen offset:128
    v_cvt_pk_bf16_f32 v217, v252, v217
    v_mfma_f32_16x16x32_bf16 v[36:39], a[204:207], v[228:231], v[36:39]
    v_lshlrev_b32 v252, 16, v227
    v_and_b32 v227, s22, v227
    v_mfma_f32_16x16x32_bf16 v[40:43], a[208:211], v[228:231], 0
    v_add_f32 v252, v252, v248
    v_add_f32 v227, v227, v219
    v_mfma_f32_16x16x32_bf16 v[40:43], a[196:199], v[236:239], v[40:43]
    buffer_load_dwordx2 v[208:209], v215, s[4:7], s18 offen offset:128
    v_fmac_f32 v252, s23, v250
    v_mfma_f32_16x16x32_bf16 v[44:47], a[200:203], v[236:239], 0
    ds_read_b128 v[236:239], v253 offset:5728
    v_fmac_f32 v227, s23, v223
    v_mfma_f32_16x16x32_bf16 v[44:47], a[212:215], v[228:231], v[44:47]
    v_cvt_pk_bf16_f32 v227, v252, v227
    v_fma_f32 v252, v249, s24, v251
    v_mfma_f32_16x16x32_bf16 v[24:27], a[216:219], v[228:231], v[24:27]
    buffer_load_dwordx2 v[210:211], v215, s[4:7], s19 offen offset:128
    v_fmac_f32 v251, s25, v249
    v_mfma_f32_16x16x32_bf16 v[28:31], a[220:223], v[228:231], v[28:31]
    v_fma_f32 v249, v248, s24, v250
    v_fmac_f32 v250, s25, v248
    v_mfma_f32_16x16x32_bf16 v[32:35], a[224:227], v[228:231], v[32:35]
    s_waitcnt lgkmcnt(1)
    v_fma_f32 v248, v250, s26, v251
    v_fmac_f32 v251, s27, v250
    v_mfma_f32_16x16x32_bf16 v[48:51], a[192:195], v[228:231], 0
    buffer_load_dwordx2 v[212:213], v215, s[4:7], s20 offen offset:128
    v_fma_f32 v250, v249, s28, v252
    v_mfma_f32_16x16x32_bf16 v[48:51], a[204:207], v[232:235], v[48:51]
    v_fmac_f32 v252, s29, v249
    v_fma_f32 v249, v221, s24, v225
    v_mfma_f32_16x16x32_bf16 v[52:55], a[208:211], v[232:235], 0
    v_fmac_f32 v225, s25, v221
    v_fma_f32 v221, v219, s24, v223
    v_mfma_f32_16x16x32_bf16 v[52:55], a[196:199], v[228:231], v[52:55]
    buffer_load_dwordx2 v[214:215], v215, s[4:7], s21 offen offset:128
    v_fmac_f32 v223, s25, v219
    v_mfma_f32_16x16x32_bf16 v[56:59], a[200:203], v[228:231], 0
    ds_read_b128 v[228:231], v253 offset:5472
    v_fma_f32 v219, v223, s26, v225
    v_mfma_f32_16x16x32_bf16 v[56:59], a[212:215], v[232:235], v[56:59]
    v_fmac_f32 v225, s27, v223
    v_fma_f32 v223, v221, s28, v249
    v_fmac_f32 v249, s29, v221
    v_mfma_f32_16x16x32_bf16 v[36:39], a[216:219], v[232:235], v[36:39]
pad1:
    s_cbranch_vccnz pad5
    buffer_store_dwordx4 v[168:171], v254, s[12:15], s44 offen sc1
    s_add_u32 s44, s41, 7168
    v_mfma_f32_16x16x32_bf16 v[40:43], a[220:223], v[232:235], v[40:43]
    v_cvt_pk_bf16_f32 v219, v248, v219
    v_cvt_pk_bf16_f32 v225, v251, v225
    v_mfma_f32_16x16x32_bf16 v[44:47], a[224:227], v[232:235], v[44:47]
    s_waitcnt lgkmcnt(1)
    v_cvt_pk_bf16_f32 v223, v250, v223
    v_cvt_pk_bf16_f32 v221, v252, v249
    v_lshrrev_b32 v252, 15, v255
    v_mfma_f32_16x16x32_bf16 v[60:63], a[192:195], v[232:235], 0
    buffer_store_dwordx4 v[172:175], v254, s[12:15], s44 offen sc1
    s_add_u32 s44, s41, 8192
    v_mfma_f32_16x16x32_bf16 v[60:63], a[204:207], v[236:239], v[60:63]
    ds_write_b64 v252, v[218:219] offset:8576
    v_mfma_f32_16x16x32_bf16 v[64:67], a[208:211], v[236:239], 0
    s_waitcnt vmcnt(22)
    v_lshlrev_b32 v248, 16, v194
    v_lshlrev_b32 v249, 16, v196
    v_mfma_f32_16x16x32_bf16 v[64:67], a[196:199], v[232:235], v[64:67]
    buffer_store_dwordx4 v[176:179], v254, s[12:15], s44 offen sc1
    s_add_u32 s44, s41, 9216
    v_mfma_f32_16x16x32_bf16 v[68:71], a[200:203], v[232:235], 0
    ds_read_b128 v[232:235], v253 offset:5216
    v_mfma_f32_16x16x32_bf16 v[68:71], a[212:215], v[236:239], v[68:71]
    ds_write_b64 v252, v[224:225] offset:10656
    v_lshlrev_b32 v250, 16, v198
    v_mfma_f32_16x16x32_bf16 v[48:51], a[216:219], v[236:239], v[48:51]
    buffer_store_dwordx4 v[180:183], v254, s[12:15], s44 offen sc1
    s_add_u32 s44, s41, 10240
    v_mfma_f32_16x16x32_bf16 v[52:55], a[220:223], v[236:239], v[52:55]
    s_waitcnt lgkmcnt(3)
    v_lshlrev_b32 v251, 16, v200
    v_mfma_f32_16x16x32_bf16 v[56:59], a[224:227], v[236:239], v[56:59]
    ds_write_b64 v252, v[222:223] offset:12736
    v_and_b32 v194, s22, v194
    v_mfma_f32_16x16x32_bf16 v[72:75], a[192:195], v[236:239], 0
    buffer_store_dwordx4 v[184:187], v254, s[12:15], s44 offen sc1
    v_and_b32 v196, s22, v196
    v_mfma_f32_16x16x32_bf16 v[72:75], a[204:207], v[228:231], v[72:75]
    ds_write_b64 v252, v[216:217] offset:14816
    v_mfma_f32_16x16x32_bf16 v[76:79], a[208:211], v[228:231], 0
    s_add_u32 s44, s41, 11264
    v_and_b32 v198, s22, v198
    v_and_b32 v200, s22, v200
    v_mfma_f32_16x16x32_bf16 v[76:79], a[196:199], v[236:239], v[76:79]
    ds_write_b64 v252, v[226:227] offset:37696
    v_mfma_f32_16x16x32_bf16 v[80:83], a[200:203], v[236:239], 0
    ds_read_b128 v[236:239], v253 offset:4944
    v_mfma_f32_16x16x32_bf16 v[80:83], a[212:215], v[228:231], v[80:83]
    ds_write_b64 v252, v[220:221] offset:31456
    v_mfma_f32_16x16x32_bf16 v[60:63], a[216:219], v[228:231], v[60:63]
    v_mfma_f32_16x16x32_bf16 v[64:67], a[220:223], v[228:231], v[64:67]
    v_mfma_f32_16x16x32_bf16 v[68:71], a[224:227], v[228:231], v[68:71]
    s_add_u32 s42, s32, 147456
    v_mfma_f32_16x16x32_bf16 v[84:87], a[192:195], v[228:231], 0
    buffer_load_dwordx4 a[192:195], v254, s[8:11], s42 offen offset:0 sc1
    v_mfma_f32_16x16x32_bf16 v[88:91], a[196:199], v[228:231], 0
    v_lshlrev_b32 v252, 16, v192
    v_and_b32 v192, s22, v192
    v_mfma_f32_16x16x32_bf16 v[92:95], a[200:203], v[228:231], 0
    s_waitcnt lgkmcnt(6)
    v_add_f32 v252, v252, v251
    v_add_f32 v192, v192, v200
    v_mfma_f32_16x16x32_bf16 v[84:87], a[204:207], v[232:235], v[84:87]
    ds_read_b128 v[228:231], v253 offset:7280
    v_fmac_f32 v252, s23, v249
    v_mfma_f32_16x16x32_bf16 v[88:91], a[208:211], v[232:235], v[88:91]
    buffer_load_dwordx4 a[196:199], v254, s[8:11], s42 offen offset:1024 sc1
    v_mfma_f32_16x16x32_bf16 v[92:95], a[212:215], v[232:235], v[92:95]
    v_fmac_f32 v192, s23, v196
    v_cvt_pk_bf16_f32 v192, v252, v192
    v_mfma_f32_16x16x32_bf16 v[72:75], a[216:219], v[232:235], v[72:75]
    s_waitcnt lgkmcnt(2)
    v_lshlrev_b32 v252, 16, v202
    v_and_b32 v202, s22, v202
    v_mfma_f32_16x16x32_bf16 v[76:79], a[220:223], v[232:235], v[76:79]
    buffer_load_dwordx4 a[200:203], v254, s[8:11], s42 offen offset:2048 sc1
    v_mfma_f32_16x16x32_bf16 v[80:83], a[224:227], v[232:235], v[80:83]
    ds_read_b128 v[232:235], v253 offset:7008
    v_add_f32 v252, v252, v248
    v_mfma_f32_16x16x32_bf16 v[84:87], a[216:219], v[236:239], v[84:87]
    s_add_u32 s42, s32, 150528
    v_add_f32 v202, v202, v194
    v_fmac_f32 v252, s23, v250
    v_mfma_f32_16x16x32_bf16 v[88:91], a[220:223], v[236:239], v[88:91]
    buffer_load_dwordx4 a[204:207], v254, s[8:11], s42 offen offset:0 sc1
    v_mfma_f32_16x16x32_bf16 v[92:95], a[224:227], v[236:239], v[92:95]
    ds_read_b128 v[236:239], v253 offset:6752
    v_fmac_f32 v202, s23, v198
    s_waitcnt vmcnt(21)
    s_waitcnt lgkmcnt(2)
sub3:
    v_mfma_f32_16x16x32_bf16 v[96:99], a[228:231], v[228:231], 0
    v_cvt_pk_bf16_f32 v202, v252, v202
    v_fma_f32 v252, v249, s24, v251
    v_mfma_f32_16x16x32_bf16 v[100:103], a[232:235], v[228:231], 0
    s_waitcnt vmcnt(18) lgkmcnt(1)
    v_fmac_f32 v251, s25, v249
    v_fma_f32 v249, v248, s24, v250
    v_mfma_f32_16x16x32_bf16 v[104:107], a[236:239], v[228:231], 0
    ds_read_b128 v[228:231], v253 offset:6496
    v_fmac_f32 v250, s25, v248
    v_mfma_f32_16x16x32_bf16 v[96:99], a[240:243], v[232:235], v[96:99]
    buffer_load_dwordx4 a[208:211], v254, s[8:11], s42 offen offset:1024 sc1
    v_mfma_f32_16x16x32_bf16 v[100:103], a[244:247], v[232:235], v[100:103]
    v_fma_f32 v248, v250, s26, v251
    v_fmac_f32 v251, s27, v250
    v_mfma_f32_16x16x32_bf16 v[104:107], a[248:251], v[232:235], v[104:107]
    v_fma_f32 v250, v249, s28, v252
    v_fmac_f32 v252, s29, v249
    v_mfma_f32_16x16x32_bf16 v[108:111], a[228:231], v[232:235], 0
    s_waitcnt lgkmcnt(1)
    v_fma_f32 v249, v196, s24, v200
    v_fmac_f32 v200, s25, v196
    v_mfma_f32_16x16x32_bf16 v[108:111], a[240:243], v[236:239], v[108:111]
    buffer_load_dwordx4 a[212:215], v254, s[8:11], s42 offen offset:2048 sc1
    v_mfma_f32_16x16x32_bf16 v[112:115], a[244:247], v[236:239], 0
    v_fma_f32 v196, v194, s24, v198
    v_fmac_f32 v198, s25, v194
    v_mfma_f32_16x16x32_bf16 v[112:115], a[232:235], v[232:235], v[112:115]
    s_add_u32 s42, s32, 153600
    v_fma_f32 v194, v198, s26, v200
    v_fmac_f32 v200, s27, v198
    v_mfma_f32_16x16x32_bf16 v[116:119], a[236:239], v[232:235], 0
    ds_read_b128 v[232:235], v253 offset:6240
    v_fma_f32 v198, v196, s28, v249
    v_mfma_f32_16x16x32_bf16 v[116:119], a[248:251], v[236:239], v[116:119]
    buffer_load_dwordx4 a[216:219], v254, s[8:11], s42 offen offset:0 sc1
    s_waitcnt vmcnt(18)
    v_mfma_f32_16x16x32_bf16 v[96:99], a[252:255], v[236:239], v[96:99]
    v_fmac_f32 v249, s29, v196
    v_cvt_pk_bf16_f32 v194, v248, v194
    v_mfma_f32_16x16x32_bf16 v[100:103], v[240:243], v[236:239], v[100:103]
    v_cvt_pk_bf16_f32 v200, v251, v200
    v_cvt_pk_bf16_f32 v198, v250, v198
    v_mfma_f32_16x16x32_bf16 v[104:107], v[244:247], v[236:239], v[104:107]
    s_waitcnt lgkmcnt(1)
    v_cvt_pk_bf16_f32 v196, v252, v249
    v_lshlrev_b32 v248, 16, v195
    v_mfma_f32_16x16x32_bf16 v[120:123], a[228:231], v[236:239], 0
    buffer_load_dwordx4 a[220:223], v254, s[8:11], s42 offen offset:1024 sc1
    v_mfma_f32_16x16x32_bf16 v[120:123], a[240:243], v[228:231], v[120:123]
    v_lshlrev_b32 v249, 16, v197
    v_lshlrev_b32 v250, 16, v199
    v_mfma_f32_16x16x32_bf16 v[124:127], a[244:247], v[228:231], 0
    v_lshlrev_b32 v251, 16, v201
    v_and_b32 v195, s22, v195
    v_mfma_f32_16x16x32_bf16 v[124:127], a[232:235], v[236:239], v[124:127]
    buffer_load_dwordx4 a[224:227], v254, s[8:11], s42 offen offset:2048 sc1
    v_mfma_f32_16x16x32_bf16 v[128:131], a[236:239], v[236:239], 0
    ds_read_b128 v[236:239], v253 offset:8064
    v_and_b32 v227, 0x7fff, v255
    v_mfma_f32_16x16x32_bf16 v[128:131], a[248:251], v[228:231], v[128:131]
    v_and_b32 v197, s22, v197
    v_and_b32 v199, s22, v199
    v_mfma_f32_16x16x32_bf16 v[108:111], a[252:255], v[228:231], v[108:111]
    buffer_load_dwordx2 v[216:217], v227, s[4:7], s16 offen offset:512
    v_mfma_f32_16x16x32_bf16 v[112:115], v[240:243], v[228:231], v[112:115]
    v_and_b32 v201, s22, v201
    v_lshlrev_b32 v252, 16, v193
    v_mfma_f32_16x16x32_bf16 v[116:119], v[244:247], v[228:231], v[116:119]
    s_waitcnt lgkmcnt(1)
    v_and_b32 v193, s22, v193
    v_add_f32 v252, v252, v251
    v_mfma_f32_16x16x32_bf16 v[132:135], a[228:231], v[228:231], 0
    buffer_load_dwordx2 v[218:219], v227, s[4:7], s17 offen offset:512
    v_mfma_f32_16x16x32_bf16 v[132:135], a[240:243], v[232:235], v[132:135]
    v_add_f32 v193, v193, v201
    v_fmac_f32 v252, s23, v249
    v_mfma_f32_16x16x32_bf16 v[136:139], a[244:247], v[232:235], 0
    v_fmac_f32 v193, s23, v197
    v_cvt_pk_bf16_f32 v193, v252, v193
    v_mfma_f32_16x16x32_bf16 v[136:139], a[232:235], v[228:231], v[136:139]
    buffer_load_dwordx2 v[220:221], v227, s[4:7], s18 offen offset:512
    v_mfma_f32_16x16x32_bf16 v[140:143], a[236:239], v[228:231], 0
    ds_read_b128 v[228:231], v253 offset:7808
    v_lshlrev_b32 v252, 16, v203
    v_mfma_f32_16x16x32_bf16 v[140:143], a[248:251], v[232:235], v[140:143]
    v_and_b32 v203, s22, v203
    v_add_f32 v252, v252, v248
    v_mfma_f32_16x16x32_bf16 v[120:123], a[252:255], v[232:235], v[120:123]
    buffer_load_dwordx2 v[222:223], v227, s[4:7], s19 offen offset:512
    v_mfma_f32_16x16x32_bf16 v[124:127], v[240:243], v[232:235], v[124:127]
    v_add_f32 v203, v203, v195
    v_fmac_f32 v252, s23, v250
    v_mfma_f32_16x16x32_bf16 v[128:131], v[244:247], v[232:235], v[128:131]
    s_waitcnt lgkmcnt(1)
    v_fmac_f32 v203, s23, v199
    v_cvt_pk_bf16_f32 v203, v252, v203
    v_mfma_f32_16x16x32_bf16 v[144:147], a[228:231], v[232:235], 0
    buffer_load_dwordx2 v[224:225], v227, s[4:7], s20 offen offset:512
    v_mfma_f32_16x16x32_bf16 v[144:147], a[240:243], v[236:239], v[144:147]
    v_fma_f32 v252, v249, s24, v251
    v_fmac_f32 v251, s25, v249
    v_mfma_f32_16x16x32_bf16 v[148:151], a[244:247], v[236:239], 0
    v_fma_f32 v249, v248, s24, v250
    v_fmac_f32 v250, s25, v248
    v_mfma_f32_16x16x32_bf16 v[148:151], a[232:235], v[232:235], v[148:151]
    buffer_load_dwordx2 v[226:227], v227, s[4:7], s21 offen offset:512
    v_mfma_f32_16x16x32_bf16 v[152:155], a[236:239], v[232:235], 0
    ds_read_b128 v[232:235], v253 offset:7552
    v_fma_f32 v248, v250, s26, v251
    v_mfma_f32_16x16x32_bf16 v[152:155], a[248:251], v[236:239], v[152:155]
    v_fmac_f32 v251, s27, v250
    v_fma_f32 v250, v249, s28, v252
    v_mfma_f32_16x16x32_bf16 v[132:135], a[252:255], v[236:239], v[132:135]
    buffer_store_dwordx4 v[188:191], v254, s[12:15], s44 offen sc1
    v_fmac_f32 v252, s29, v249
    v_fma_f32 v249, v197, s24, v201
    v_mfma_f32_16x16x32_bf16 v[136:139], v[240:243], v[236:239], v[136:139]
    v_fmac_f32 v201, s25, v197
    v_fma_f32 v197, v195, s24, v199
    v_mfma_f32_16x16x32_bf16 v[140:143], v[244:247], v[236:239], v[140:143]
    v_fmac_f32 v199, s25, v195
    v_fma_f32 v195, v199, s26, v201
    v_mfma_f32_16x16x32_bf16 v[156:159], a[228:231], v[236:239], 0
    s_waitcnt lgkmcnt(1)
    v_fmac_f32 v201, s27, v199
    v_fma_f32 v199, v197, s28, v249
    v_mfma_f32_16x16x32_bf16 v[156:159], a[240:243], v[228:231], v[156:159]
    v_fmac_f32 v249, s29, v197
    v_cvt_pk_bf16_f32 v195, v248, v195
    v_mfma_f32_16x16x32_bf16 v[160:163], a[244:247], v[228:231], 0
    v_cvt_pk_bf16_f32 v201, v251, v201
    v_cvt_pk_bf16_f32 v199, v250, v199
    v_mfma_f32_16x16x32_bf16 v[160:163], a[232:235], v[236:239], v[160:163]
    v_cvt_pk_bf16_f32 v197, v252, v249
    v_lshrrev_b32 v252, 15, v255
    v_mfma_f32_16x16x32_bf16 v[164:167], a[236:239], v[236:239], 0
    ds_read_b128 v[236:239], v253 offset:7296
    v_mfma_f32_16x16x32_bf16 v[164:167], a[248:251], v[228:231], v[164:167]
    ds_write_b64 v252, v[194:195] offset:8320
    v_mfma_f32_16x16x32_bf16 v[144:147], a[252:255], v[228:231], v[144:147]
    s_waitcnt vmcnt(21)
    v_lshlrev_b32 v248, 16, v206
    v_lshlrev_b32 v249, 16, v208
    v_mfma_f32_16x16x32_bf16 v[148:151], v[240:243], v[228:231], v[148:151]
    ds_write_b64 v252, v[200:201] offset:10400
    v_mfma_f32_16x16x32_bf16 v[152:155], v[244:247], v[228:231], v[152:155]
    s_waitcnt lgkmcnt(3)
    v_lshlrev_b32 v250, 16, v210
    v_lshlrev_b32 v251, 16, v212
    v_mfma_f32_16x16x32_bf16 v[168:171], a[228:231], v[228:231], 0
    ds_write_b64 v252, v[198:199] offset:12480
    v_mfma_f32_16x16x32_bf16 v[168:171], a[240:243], v[232:235], v[168:171]
    v_and_b32 v206, s22, v206
    v_and_b32 v208, s22, v208
    v_mfma_f32_16x16x32_bf16 v[172:175], a[244:247], v[232:235], 0
    ds_write_b64 v252, v[192:193] offset:14560
    v_mfma_f32_16x16x32_bf16 v[172:175], a[232:235], v[228:231], v[172:175]
    v_and_b32 v210, s22, v210
    v_and_b32 v212, s22, v212
    v_mfma_f32_16x16x32_bf16 v[176:179], a[236:239], v[228:231], 0
    ds_read_b128 v[228:231], v253 offset:7024
    v_mfma_f32_16x16x32_bf16 v[176:179], a[248:251], v[232:235], v[176:179]
    ds_write_b64 v252, v[202:203] offset:37440
    v_mfma_f32_16x16x32_bf16 v[156:159], a[252:255], v[232:235], v[156:159]
    s_waitcnt lgkmcnt(6)
    v_mfma_f32_16x16x32_bf16 v[160:163], v[240:243], v[232:235], v[160:163]
    ds_write_b64 v252, v[196:197] offset:31200
    v_mfma_f32_16x16x32_bf16 v[164:167], v[244:247], v[232:235], v[164:167]
    s_add_u32 s42, s32, 184320
    v_mfma_f32_16x16x32_bf16 v[180:183], a[228:231], v[232:235], 0
    buffer_load_dwordx4 a[228:231], v254, s[8:11], s42 offen offset:0 sc1
    v_mfma_f32_16x16x32_bf16 v[184:187], a[232:235], v[232:235], 0
    s_waitcnt lgkmcnt(0)
    v_lshlrev_b32 v252, 16, v204
    v_and_b32 v204, s22, v204
    v_mfma_f32_16x16x32_bf16 v[188:191], a[236:239], v[232:235], 0
    s_barrier
    v_mfma_f32_16x16x32_bf16 v[180:183], a[240:243], v[236:239], v[180:183]
    ds_read_b128 v[232:235], v253 offset:9360
    v_add_f32 v252, v252, v251
    v_add_f32 v204, v204, v212
    v_mfma_f32_16x16x32_bf16 v[184:187], a[244:247], v[236:239], v[184:187]
    buffer_load_dwordx4 a[232:235], v254, s[8:11], s42 offen offset:1024 sc1
    v_mfma_f32_16x16x32_bf16 v[188:191], a[248:251], v[236:239], v[188:191]
    v_fmac_f32 v252, s23, v249
    v_fmac_f32 v204, s23, v208
    v_mfma_f32_16x16x32_bf16 v[168:171], a[252:255], v[236:239], v[168:171]
    v_cvt_pk_bf16_f32 v204, v252, v204
    v_lshlrev_b32 v252, 16, v214
    v_mfma_f32_16x16x32_bf16 v[172:175], v[240:243], v[236:239], v[172:175]
    buffer_load_dwordx4 a[236:239], v254, s[8:11], s42 offen offset:2048 sc1
    v_mfma_f32_16x16x32_bf16 v[176:179], v[244:247], v[236:239], v[176:179]
    ds_read_b128 v[236:239], v253 offset:9088
    v_and_b32 v214, s22, v214
    v_mfma_f32_16x16x32_bf16 v[180:183], a[252:255], v[228:231], v[180:183]
    s_add_u32 s42, s32, 187392
    v_add_f32 v252, v252, v248
    v_add_f32 v214, v214, v206
    v_mfma_f32_16x16x32_bf16 v[184:187], v[240:243], v[228:231], v[184:187]
    buffer_load_dwordx4 a[240:243], v254, s[8:11], s42 offen offset:0 sc1
    v_mfma_f32_16x16x32_bf16 v[188:191], v[244:247], v[228:231], v[188:191]
    ds_read_b128 v[228:231], v253 offset:8832
    v_fmac_f32 v252, s23, v250
    s_waitcnt vmcnt(17)
    s_waitcnt lgkmcnt(2)
sub4:
    v_mfma_f32_16x16x32_bf16 a[0:3], a[192:195], v[232:235], a[0:3]
    v_fmac_f32 v214, s23, v210
    v_cvt_pk_bf16_f32 v214, v252, v214
    v_mfma_f32_16x16x32_bf16 a[4:7], a[196:199], v[232:235], a[4:7]
    s_waitcnt vmcnt(14) lgkmcnt(1)
    v_fma_f32 v252, v249, s24, v251
    v_fmac_f32 v251, s25, v249
    v_mfma_f32_16x16x32_bf16 a[8:11], a[200:203], v[232:235], a[8:11]
    ds_read_b128 v[232:235], v253 offset:8576
    v_fma_f32 v249, v248, s24, v250
    v_mfma_f32_16x16x32_bf16 a[0:3], a[204:207], v[236:239], a[0:3]
    buffer_load_dwordx4 a[244:247], v254, s[8:11], s42 offen offset:1024 sc1
    v_mfma_f32_16x16x32_bf16 a[4:7], a[208:211], v[236:239], a[4:7]
    v_fmac_f32 v250, s25, v248
    v_fma_f32 v248, v250, s26, v251
    v_mfma_f32_16x16x32_bf16 a[8:11], a[212:215], v[236:239], a[8:11]
    v_fmac_f32 v251, s27, v250
    v_fma_f32 v250, v249, s28, v252
    v_mfma_f32_16x16x32_bf16 a[12:15], a[192:195], v[236:239], a[12:15]
    s_waitcnt lgkmcnt(1)
    v_fmac_f32 v252, s29, v249
    v_fma_f32 v249, v208, s24, v212
    v_mfma_f32_16x16x32_bf16 a[12:15], a[204:207], v[228:231], a[12:15]
    buffer_load_dwordx4 a[248:251], v254, s[8:11], s42 offen offset:2048 sc1
    v_mfma_f32_16x16x32_bf16 a[16:19], a[208:211], v[228:231], a[16:19]
    v_fmac_f32 v212, s25, v208
    v_fma_f32 v208, v206, s24, v210
    v_mfma_f32_16x16x32_bf16 a[16:19], a[196:199], v[236:239], a[16:19]
    s_add_u32 s42, s32, 190464
    v_fmac_f32 v210, s25, v206
    v_fma_f32 v206, v210, s26, v212
    v_mfma_f32_16x16x32_bf16 a[20:23], a[200:203], v[236:239], a[20:23]
    ds_read_b128 v[236:239], v253 offset:8320
    v_fmac_f32 v212, s27, v210
    v_mfma_f32_16x16x32_bf16 a[20:23], a[212:215], v[228:231], a[20:23]
    buffer_load_dwordx4 a[252:255], v254, s[8:11], s42 offen offset:0 sc1
    v_fma_f32 v210, v208, s28, v249
    s_waitcnt vmcnt(14)
    v_mfma_f32_16x16x32_bf16 a[0:3], a[216:219], v[228:231], a[0:3]
    v_fmac_f32 v249, s29, v208
    v_cvt_pk_bf16_f32 v206, v248, v206
    v_mfma_f32_16x16x32_bf16 a[4:7], a[220:223], v[228:231], a[4:7]
    v_cvt_pk_bf16_f32 v212, v251, v212
    v_cvt_pk_bf16_f32 v210, v250, v210
    v_mfma_f32_16x16x32_bf16 a[8:11], a[224:227], v[228:231], a[8:11]
    s_waitcnt lgkmcnt(1)
    v_cvt_pk_bf16_f32 v208, v252, v249
    v_lshlrev_b32 v248, 16, v207
    v_mfma_f32_16x16x32_bf16 a[24:27], a[192:195], v[228:231], a[24:27]
    buffer_load_dwordx4 v[240:243], v254, s[8:11], s42 offen offset:1024 sc1
    v_mfma_f32_16x16x32_bf16 a[24:27], a[204:207], v[232:235], a[24:27]
    v_lshlrev_b32 v249, 16, v209
    v_lshlrev_b32 v250, 16, v211
    v_mfma_f32_16x16x32_bf16 a[28:31], a[208:211], v[232:235], a[28:31]
    v_lshlrev_b32 v251, 16, v213
    v_and_b32 v207, s22, v207
    v_mfma_f32_16x16x32_bf16 a[28:31], a[196:199], v[228:231], a[28:31]
    buffer_load_dwordx4 v[244:247], v254, s[8:11], s42 offen offset:2048 sc1
    v_mfma_f32_16x16x32_bf16 a[32:35], a[200:203], v[228:231], a[32:35]
    ds_read_b128 v[228:231], v253 offset:10144
    v_and_b32 v203, 0x7fff, v255
    v_mfma_f32_16x16x32_bf16 a[32:35], a[212:215], v[232:235], a[32:35]
    v_and_b32 v209, s22, v209
    v_and_b32 v211, s22, v211
    v_mfma_f32_16x16x32_bf16 a[12:15], a[216:219], v[232:235], a[12:15]
    buffer_load_dwordx2 v[192:193], v203, s[4:7], s16 offen offset:896
    v_mfma_f32_16x16x32_bf16 a[16:19], a[220:223], v[232:235], a[16:19]
    v_and_b32 v213, s22, v213
    v_lshlrev_b32 v252, 16, v205
    v_mfma_f32_16x16x32_bf16 a[20:23], a[224:227], v[232:235], a[20:23]
    s_waitcnt lgkmcnt(1)
    v_and_b32 v205, s22, v205
    v_add_f32 v252, v252, v251
    v_mfma_f32_16x16x32_bf16 a[36:39], a[192:195], v[232:235], a[36:39]
    buffer_load_dwordx2 v[194:195], v203, s[4:7], s17 offen offset:896
    v_mfma_f32_16x16x32_bf16 a[36:39], a[204:207], v[236:239], a[36:39]
    v_add_f32 v205, v205, v213
    v_fmac_f32 v252, s23, v249
    v_mfma_f32_16x16x32_bf16 a[40:43], a[208:211], v[236:239], a[40:43]
    v_fmac_f32 v205, s23, v209
    v_cvt_pk_bf16_f32 v205, v252, v205
    v_mfma_f32_16x16x32_bf16 a[40:43], a[196:199], v[232:235], a[40:43]
    buffer_load_dwordx2 v[196:197], v203, s[4:7], s18 offen offset:896
    v_mfma_f32_16x16x32_bf16 a[44:47], a[200:203], v[232:235], a[44:47]
    ds_read_b128 v[232:235], v253 offset:9888
    v_lshlrev_b32 v252, 16, v215
    v_mfma_f32_16x16x32_bf16 a[44:47], a[212:215], v[236:239], a[44:47]
    v_and_b32 v215, s22, v215
    v_add_f32 v252, v252, v248
    v_mfma_f32_16x16x32_bf16 a[24:27], a[216:219], v[236:239], a[24:27]
    buffer_load_dwordx2 v[198:199], v203, s[4:7], s19 offen offset:896
    v_mfma_f32_16x16x32_bf16 a[28:31], a[220:223], v[236:239], a[28:31]
    v_add_f32 v215, v215, v207
    v_fmac_f32 v252, s23, v250
    v_fmac_f32 v215, s23, v211
    v_mfma_f32_16x16x32_bf16 a[32:35], a[224:227], v[236:239], a[32:35]
    s_waitcnt lgkmcnt(1)
    v_cvt_pk_bf16_f32 v215, v252, v215
    v_fma_f32 v252, v249, s24, v251
    v_mfma_f32_16x16x32_bf16 a[48:51], a[192:195], v[236:239], a[48:51]
    buffer_load_dwordx2 v[200:201], v203, s[4:7], s20 offen offset:896
    v_mfma_f32_16x16x32_bf16 a[48:51], a[204:207], v[228:231], a[48:51]
    v_fmac_f32 v251, s25, v249
    v_fma_f32 v249, v248, s24, v250
    v_mfma_f32_16x16x32_bf16 a[52:55], a[208:211], v[228:231], a[52:55]
    v_fmac_f32 v250, s25, v248
    v_fma_f32 v248, v250, s26, v251
    v_mfma_f32_16x16x32_bf16 a[52:55], a[196:199], v[236:239], a[52:55]
    buffer_load_dwordx2 v[202:203], v203, s[4:7], s21 offen offset:896
    v_mfma_f32_16x16x32_bf16 a[56:59], a[200:203], v[236:239], a[56:59]
    ds_read_b128 v[236:239], v253 offset:9632
    v_fmac_f32 v251, s27, v250
    v_mfma_f32_16x16x32_bf16 a[56:59], a[212:215], v[228:231], a[56:59]
    v_fma_f32 v250, v249, s28, v252
    v_fmac_f32 v252, s29, v249
    v_mfma_f32_16x16x32_bf16 a[36:39], a[216:219], v[228:231], a[36:39]
    v_fma_f32 v249, v209, s24, v213
    v_fmac_f32 v213, s25, v209
    v_mfma_f32_16x16x32_bf16 a[40:43], a[220:223], v[228:231], a[40:43]
    v_fma_f32 v209, v207, s24, v211
    v_fmac_f32 v211, s25, v207
    v_mfma_f32_16x16x32_bf16 a[44:47], a[224:227], v[228:231], a[44:47]
    v_fma_f32 v207, v211, s26, v213
    v_fmac_f32 v213, s27, v211
    v_mfma_f32_16x16x32_bf16 a[60:63], a[192:195], v[228:231], a[60:63]
    s_waitcnt lgkmcnt(1)
    v_fma_f32 v211, v209, s28, v249
    v_fmac_f32 v249, s29, v209
    v_mfma_f32_16x16x32_bf16 a[60:63], a[204:207], v[232:235], a[60:63]
    v_cvt_pk_bf16_f32 v207, v248, v207
    v_cvt_pk_bf16_f32 v213, v251, v213
    v_mfma_f32_16x16x32_bf16 a[64:67], a[208:211], v[232:235], a[64:67]
    v_cvt_pk_bf16_f32 v211, v250, v211
    v_cvt_pk_bf16_f32 v209, v252, v249
    v_mfma_f32_16x16x32_bf16 a[64:67], a[196:199], v[228:231], a[64:67]
    v_lshrrev_b32 v252, 15, v255
    v_mfma_f32_16x16x32_bf16 a[68:71], a[200:203], v[228:231], a[68:71]
    ds_read_b128 v[228:231], v253 offset:9376
    v_mfma_f32_16x16x32_bf16 a[68:71], a[212:215], v[232:235], a[68:71]
    ds_write_b64 v252, v[206:207] offset:768
    v_mfma_f32_16x16x32_bf16 a[48:51], a[216:219], v[232:235], a[48:51]
    s_waitcnt vmcnt(16)
    v_lshlrev_b32 v248, 16, v218
    v_lshlrev_b32 v249, 16, v220
    v_mfma_f32_16x16x32_bf16 a[52:55], a[220:223], v[232:235], a[52:55]
    ds_write_b64 v252, v[212:213] offset:2848
    v_mfma_f32_16x16x32_bf16 a[56:59], a[224:227], v[232:235], a[56:59]
    s_waitcnt lgkmcnt(3)
    v_lshlrev_b32 v250, 16, v222
    v_lshlrev_b32 v251, 16, v224
    v_mfma_f32_16x16x32_bf16 a[72:75], a[192:195], v[232:235], a[72:75]
    ds_write_b64 v252, v[210:211] offset:4928
    v_and_b32 v218, s22, v218
    v_mfma_f32_16x16x32_bf16 a[72:75], a[204:207], v[236:239], a[72:75]
    v_and_b32 v220, s22, v220
    v_mfma_f32_16x16x32_bf16 a[76:79], a[208:211], v[236:239], a[76:79]
    ds_write_b64 v252, v[204:205] offset:17408
    v_mfma_f32_16x16x32_bf16 a[76:79], a[196:199], v[232:235], a[76:79]
    v_and_b32 v222, s22, v222
    v_and_b32 v224, s22, v224
    v_mfma_f32_16x16x32_bf16 a[80:83], a[200:203], v[232:235], a[80:83]
    ds_read_b128 v[232:235], v253 offset:9104
    v_mfma_f32_16x16x32_bf16 a[80:83], a[212:215], v[236:239], a[80:83]
    ds_write_b64 v252, v[214:215] offset:25728
    v_mfma_f32_16x16x32_bf16 a[60:63], a[216:219], v[236:239], a[60:63]
    v_mfma_f32_16x16x32_bf16 a[64:67], a[220:223], v[236:239], a[64:67]
    ds_write_b64 v252, v[208:209] offset:7008
    v_mfma_f32_16x16x32_bf16 a[68:71], a[224:227], v[236:239], a[68:71]
    s_add_u32 s42, s32, 221184
    v_mfma_f32_16x16x32_bf16 a[84:87], a[192:195], v[236:239], a[84:87]
    buffer_load_dwordx4 a[192:195], v254, s[8:11], s42 offen offset:0 sc1
    v_mfma_f32_16x16x32_bf16 a[88:91], a[196:199], v[236:239], a[88:91]
    v_lshlrev_b32 v252, 16, v216
    v_and_b32 v216, s22, v216
    v_mfma_f32_16x16x32_bf16 a[92:95], a[200:203], v[236:239], a[92:95]
    s_waitcnt lgkmcnt(7)
    v_add_f32 v252, v252, v251
    v_add_f32 v216, v216, v224
    v_mfma_f32_16x16x32_bf16 a[84:87], a[204:207], v[228:231], a[84:87]
    ds_read_b128 v[236:239], v253 offset:11440
    v_fmac_f32 v252, s23, v249
    v_mfma_f32_16x16x32_bf16 a[88:91], a[208:211], v[228:231], a[88:91]
    buffer_load_dwordx4 a[196:199], v254, s[8:11], s42 offen offset:1024 sc1
    v_mfma_f32_16x16x32_bf16 a[92:95], a[212:215], v[228:231], a[92:95]
    v_fmac_f32 v216, s23, v220
    v_cvt_pk_bf16_f32 v216, v252, v216
    v_mfma_f32_16x16x32_bf16 a[72:75], a[216:219], v[228:231], a[72:75]
    s_waitcnt lgkmcnt(3)
    v_lshlrev_b32 v252, 16, v226
    v_and_b32 v226, s22, v226
    v_mfma_f32_16x16x32_bf16 a[76:79], a[220:223], v[228:231], a[76:79]
    buffer_load_dwordx4 a[200:203], v254, s[8:11], s42 offen offset:2048 sc1
    v_mfma_f32_16x16x32_bf16 a[80:83], a[224:227], v[228:231], a[80:83]
    ds_read_b128 v[228:231], v253 offset:11168
    v_add_f32 v252, v252, v248
    v_mfma_f32_16x16x32_bf16 a[84:87], a[216:219], v[232:235], a[84:87]
    s_add_u32 s42, s32, 224256
    v_add_f32 v226, v226, v218
    v_fmac_f32 v252, s23, v250
    v_mfma_f32_16x16x32_bf16 a[88:91], a[220:223], v[232:235], a[88:91]
    buffer_load_dwordx4 a[204:207], v254, s[8:11], s42 offen offset:0 sc1
    v_mfma_f32_16x16x32_bf16 a[92:95], a[224:227], v[232:235], a[92:95]
    ds_read_b128 v[232:235], v253 offset:10912
    v_fmac_f32 v226, s23, v222
    s_waitcnt vmcnt(16)
    s_waitcnt lgkmcnt(2)
sub5:
    v_mfma_f32_16x16x32_bf16 a[96:99], a[228:231], v[236:239], a[96:99]
    v_cvt_pk_bf16_f32 v226, v252, v226
    v_fma_f32 v252, v249, s24, v251
    v_mfma_f32_16x16x32_bf16 a[100:103], a[232:235], v[236:239], a[100:103]
    s_waitcnt vmcnt(13) lgkmcnt(1)
    v_fmac_f32 v251, s25, v249
    v_fma_f32 v249, v248, s24, v250
    v_mfma_f32_16x16x32_bf16 a[104:107], a[236:239], v[236:239], a[104:107]
    ds_read_b128 v[236:239], v253 offset:10656
    v_fmac_f32 v250, s25, v248
    v_mfma_f32_16x16x32_bf16 a[96:99], a[240:243], v[228:231], a[96:99]
    buffer_load_dwordx4 a[208:211], v254, s[8:11], s42 offen offset:1024 sc1
    v_mfma_f32_16x16x32_bf16 a[100:103], a[244:247], v[228:231], a[100:103]
    v_fma_f32 v248, v250, s26, v251
    v_fmac_f32 v251, s27, v250
    v_mfma_f32_16x16x32_bf16 a[104:107], a[248:251], v[228:231], a[104:107]
    v_fma_f32 v250, v249, s28, v252
    v_fmac_f32 v252, s29, v249
    v_mfma_f32_16x16x32_bf16 a[108:111], a[228:231], v[228:231], a[108:111]
    s_waitcnt lgkmcnt(1)
    v_fma_f32 v249, v220, s24, v224
    v_fmac_f32 v224, s25, v220
    v_mfma_f32_16x16x32_bf16 a[108:111], a[240:243], v[232:235], a[108:111]
    buffer_load_dwordx4 a[212:215], v254, s[8:11], s42 offen offset:2048 sc1
    v_mfma_f32_16x16x32_bf16 a[112:115], a[244:247], v[232:235], a[112:115]
    v_fma_f32 v220, v218, s24, v222
    v_fmac_f32 v222, s25, v218
    v_mfma_f32_16x16x32_bf16 a[112:115], a[232:235], v[228:231], a[112:115]
    s_add_u32 s42, s32, 227328
    v_fma_f32 v218, v222, s26, v224
    v_fmac_f32 v224, s27, v222
    v_mfma_f32_16x16x32_bf16 a[116:119], a[236:239], v[228:231], a[116:119]
    ds_read_b128 v[228:231], v253 offset:10400
    v_fma_f32 v222, v220, s28, v249
    v_mfma_f32_16x16x32_bf16 a[116:119], a[248:251], v[232:235], a[116:119]
    buffer_load_dwordx4 a[216:219], v254, s[8:11], s42 offen offset:0 sc1
    s_waitcnt vmcnt(13)
    v_mfma_f32_16x16x32_bf16 a[96:99], a[252:255], v[232:235], a[96:99]
    v_fmac_f32 v249, s29, v220
    v_cvt_pk_bf16_f32 v218, v248, v218
    v_mfma_f32_16x16x32_bf16 a[100:103], v[240:243], v[232:235], a[100:103]
    v_cvt_pk_bf16_f32 v224, v251, v224
    v_cvt_pk_bf16_f32 v222, v250, v222
    v_mfma_f32_16x16x32_bf16 a[104:107], v[244:247], v[232:235], a[104:107]
    s_waitcnt lgkmcnt(1)
    v_cvt_pk_bf16_f32 v220, v252, v249
    v_lshlrev_b32 v248, 16, v219
    v_mfma_f32_16x16x32_bf16 a[120:123], a[228:231], v[232:235], a[120:123]
    buffer_load_dwordx4 a[220:223], v254, s[8:11], s42 offen offset:1024 sc1
    v_mfma_f32_16x16x32_bf16 a[120:123], a[240:243], v[236:239], a[120:123]
    v_lshlrev_b32 v249, 16, v221
    v_lshlrev_b32 v250, 16, v223
    v_mfma_f32_16x16x32_bf16 a[124:127], a[244:247], v[236:239], a[124:127]
    v_lshlrev_b32 v251, 16, v225
    v_and_b32 v219, s22, v219
    v_mfma_f32_16x16x32_bf16 a[124:127], a[232:235], v[232:235], a[124:127]
    buffer_load_dwordx4 a[224:227], v254, s[8:11], s42 offen offset:2048 sc1
    v_mfma_f32_16x16x32_bf16 a[128:131], a[236:239], v[232:235], a[128:131]
    ds_read_b128 v[232:235], v253 offset:12224
    v_and_b32 v215, 0x7fff, v255
    v_mfma_f32_16x16x32_bf16 a[128:131], a[248:251], v[236:239], a[128:131]
    v_and_b32 v221, s22, v221
    v_and_b32 v223, s22, v223
    v_mfma_f32_16x16x32_bf16 a[108:111], a[252:255], v[236:239], a[108:111]
    buffer_load_dwordx2 v[204:205], v215, s[4:7], s16 offen offset:1280
    v_mfma_f32_16x16x32_bf16 a[112:115], v[240:243], v[236:239], a[112:115]
    v_and_b32 v225, s22, v225
    v_lshlrev_b32 v252, 16, v217
    v_mfma_f32_16x16x32_bf16 a[116:119], v[244:247], v[236:239], a[116:119]
    s_waitcnt lgkmcnt(1)
    v_and_b32 v217, s22, v217
    v_add_f32 v252, v252, v251
    v_mfma_f32_16x16x32_bf16 a[132:135], a[228:231], v[236:239], a[132:135]
    buffer_load_dwordx2 v[206:207], v215, s[4:7], s17 offen offset:1280
    v_mfma_f32_16x16x32_bf16 a[132:135], a[240:243], v[228:231], a[132:135]
    v_add_f32 v217, v217, v225
    v_fmac_f32 v252, s23, v249
    v_mfma_f32_16x16x32_bf16 a[136:139], a[244:247], v[228:231], a[136:139]
    v_fmac_f32 v217, s23, v221
    v_cvt_pk_bf16_f32 v217, v252, v217
    v_mfma_f32_16x16x32_bf16 a[136:139], a[232:235], v[236:239], a[136:139]
    buffer_load_dwordx2 v[208:209], v215, s[4:7], s18 offen offset:1280
    v_mfma_f32_16x16x32_bf16 a[140:143], a[236:239], v[236:239], a[140:143]
    ds_read_b128 v[236:239], v253 offset:11968
    v_lshlrev_b32 v252, 16, v227
    v_mfma_f32_16x16x32_bf16 a[140:143], a[248:251], v[228:231], a[140:143]
    v_and_b32 v227, s22, v227
    v_add_f32 v252, v252, v248
    v_mfma_f32_16x16x32_bf16 a[120:123], a[252:255], v[228:231], a[120:123]
    buffer_load_dwordx2 v[210:211], v215, s[4:7], s19 offen offset:1280
    v_mfma_f32_16x16x32_bf16 a[124:127], v[240:243], v[228:231], a[124:127]
    v_add_f32 v227, v227, v219
    v_fmac_f32 v252, s23, v250
    v_mfma_f32_16x16x32_bf16 a[128:131], v[244:247], v[228:231], a[128:131]
    s_waitcnt lgkmcnt(1)
    v_fmac_f32 v227, s23, v223
    v_cvt_pk_bf16_f32 v227, v252, v227
    v_mfma_f32_16x16x32_bf16 a[144:147], a[228:231], v[228:231], a[144:147]
    buffer_load_dwordx2 v[212:213], v215, s[4:7], s20 offen offset:1280
    v_mfma_f32_16x16x32_bf16 a[144:147], a[240:243], v[232:235], a[144:147]
    v_fma_f32 v252, v249, s24, v251
    v_fmac_f32 v251, s25, v249
    v_mfma_f32_16x16x32_bf16 a[148:151], a[244:247], v[232:235], a[148:151]
    v_fma_f32 v249, v248, s24, v250
    v_fmac_f32 v250, s25, v248
    v_mfma_f32_16x16x32_bf16 a[148:151], a[232:235], v[228:231], a[148:151]
    buffer_load_dwordx2 v[214:215], v215, s[4:7], s21 offen offset:1280
    v_mfma_f32_16x16x32_bf16 a[152:155], a[236:239], v[228:231], a[152:155]
    ds_read_b128 v[228:231], v253 offset:11712
    v_fma_f32 v248, v250, s26, v251
    v_mfma_f32_16x16x32_bf16 a[152:155], a[248:251], v[232:235], a[152:155]
pad2:
    s_cbranch_vccnz pad6
    v_fmac_f32 v251, s27, v250
    v_fma_f32 v250, v249, s28, v252
    v_mfma_f32_16x16x32_bf16 a[132:135], a[252:255], v[232:235], a[132:135]
    v_fmac_f32 v252, s29, v249
    v_fma_f32 v249, v221, s24, v225
    v_mfma_f32_16x16x32_bf16 a[136:139], v[240:243], v[232:235], a[136:139]
    v_fmac_f32 v225, s25, v221
    v_fma_f32 v221, v219, s24, v223
    v_mfma_f32_16x16x32_bf16 a[140:143], v[244:247], v[232:235], a[140:143]
    v_fmac_f32 v223, s25, v219
    v_fma_f32 v219, v223, s26, v225
    v_mfma_f32_16x16x32_bf16 a[156:159], a[228:231], v[232:235], a[156:159]
    s_waitcnt lgkmcnt(1)
    v_fmac_f32 v225, s27, v223
    v_fma_f32 v223, v221, s28, v249
    v_mfma_f32_16x16x32_bf16 a[156:159], a[240:243], v[236:239], a[156:159]
    v_fmac_f32 v249, s29, v221
    v_cvt_pk_bf16_f32 v219, v248, v219
    v_mfma_f32_16x16x32_bf16 a[160:163], a[244:247], v[236:239], a[160:163]
    v_cvt_pk_bf16_f32 v225, v251, v225
    v_cvt_pk_bf16_f32 v223, v250, v223
    v_mfma_f32_16x16x32_bf16 a[160:163], a[232:235], v[232:235], a[160:163]
    v_cvt_pk_bf16_f32 v221, v252, v249
    v_lshrrev_b32 v252, 15, v255
    v_mfma_f32_16x16x32_bf16 a[164:167], a[236:239], v[232:235], a[164:167]
    ds_read_b128 v[232:235], v253 offset:11456
    v_mfma_f32_16x16x32_bf16 a[164:167], a[248:251], v[236:239], a[164:167]
    ds_write_b64 v252, v[218:219] offset:512
    v_mfma_f32_16x16x32_bf16 a[144:147], a[252:255], v[236:239], a[144:147]
    s_waitcnt vmcnt(15)
    v_lshlrev_b32 v248, 16, v194
    v_lshlrev_b32 v249, 16, v196
    v_mfma_f32_16x16x32_bf16 a[148:151], v[240:243], v[236:239], a[148:151]
    ds_write_b64 v252, v[224:225] offset:2592
    v_mfma_f32_16x16x32_bf16 a[152:155], v[244:247], v[236:239], a[152:155]
    s_waitcnt lgkmcnt(3)
    v_lshlrev_b32 v250, 16, v198
    v_lshlrev_b32 v251, 16, v200
    v_mfma_f32_16x16x32_bf16 a[168:171], a[228:231], v[236:239], a[168:171]
    ds_write_b64 v252, v[222:223] offset:4672
    v_mfma_f32_16x16x32_bf16 a[168:171], a[240:243], v[228:231], a[168:171]
    v_and_b32 v194, s22, v194
    v_and_b32 v196, s22, v196
    v_mfma_f32_16x16x32_bf16 a[172:175], a[244:247], v[228:231], a[172:175]
    ds_write_b64 v252, v[216:217] offset:17152
    v_mfma_f32_16x16x32_bf16 a[172:175], a[232:235], v[236:239], a[172:175]
    v_and_b32 v198, s22, v198
    v_and_b32 v200, s22, v200
    v_mfma_f32_16x16x32_bf16 a[176:179], a[236:239], v[236:239], a[176:179]
    ds_read_b128 v[236:239], v253 offset:11184
    v_mfma_f32_16x16x32_bf16 a[176:179], a[248:251], v[228:231], a[176:179]
    ds_write_b64 v252, v[226:227] offset:25472
    v_mfma_f32_16x16x32_bf16 a[156:159], a[252:255], v[228:231], a[156:159]
    v_mfma_f32_16x16x32_bf16 a[160:163], v[240:243], v[228:231], a[160:163]
    ds_write_b64 v252, v[220:221] offset:6752
    v_mfma_f32_16x16x32_bf16 a[164:167], v[244:247], v[228:231], a[164:167]
    s_add_u32 s42, s32, 258048
    v_mfma_f32_16x16x32_bf16 a[180:183], a[228:231], v[228:231], a[180:183]
    buffer_load_dwordx4 a[228:231], v254, s[8:11], s42 offen offset:0 sc1
    v_mfma_f32_16x16x32_bf16 a[184:187], a[232:235], v[228:231], a[184:187]
    v_lshlrev_b32 v252, 16, v192
    v_and_b32 v192, s22, v192
    v_mfma_f32_16x16x32_bf16 a[188:191], a[236:239], v[228:231], a[188:191]
    s_waitcnt lgkmcnt(2)
    v_add_f32 v252, v252, v251
    v_add_f32 v192, v192, v200
    v_mfma_f32_16x16x32_bf16 a[180:183], a[240:243], v[232:235], a[180:183]
    ds_read_b128 v[228:231], v253 offset:13520
    v_fmac_f32 v252, s23, v249
    v_mfma_f32_16x16x32_bf16 a[184:187], a[244:247], v[232:235], a[184:187]
    buffer_load_dwordx4 a[232:235], v254, s[8:11], s42 offen offset:1024 sc1
    v_mfma_f32_16x16x32_bf16 a[188:191], a[248:251], v[232:235], a[188:191]
    ds_read_b128 v[216:219], v253 offset:39904
    v_fmac_f32 v192, s23, v196
    v_mfma_f32_16x16x32_bf16 a[168:171], a[252:255], v[232:235], a[168:171]
    s_mov_b32 s45, 405865480
    v_cvt_pk_bf16_f32 v192, v252, v192
    v_lshlrev_b32 v252, 16, v202
    v_and_b32 v202, s22, v202
    v_mfma_f32_16x16x32_bf16 a[172:175], v[240:243], v[232:235], a[172:175]
    buffer_load_dwordx4 a[236:239], v254, s[8:11], s42 offen offset:2048 sc1
    v_mfma_f32_16x16x32_bf16 a[176:179], v[244:247], v[232:235], a[176:179]
    ds_read_b128 v[232:235], v253 offset:13248
    v_add_f32 v252, v252, v248
    v_mfma_f32_16x16x32_bf16 a[180:183], a[252:255], v[236:239], a[180:183]
    s_add_u32 s42, s32, 261120
    v_bfe_u32 v220, v254, 5, 3
    v_add_f32 v202, v202, v194
    v_mfma_f32_16x16x32_bf16 a[184:187], v[240:243], v[236:239], a[184:187]
    buffer_load_dwordx4 a[240:243], v254, s[8:11], s42 offen offset:0 sc1
    v_mfma_f32_16x16x32_bf16 a[188:191], v[244:247], v[236:239], a[188:191]
    ds_read_b128 v[236:239], v253 offset:12992
    v_mul_u32_u24 v221, 5, v220
    s_waitcnt vmcnt(16)
    s_waitcnt lgkmcnt(3)
sub6:
    v_mfma_f32_16x16x32_bf16 v[0:3], a[192:195], v[228:231], v[0:3]
    v_fmac_f32 v252, s23, v250
    v_fmac_f32 v202, s23, v198
    v_mfma_f32_16x16x32_bf16 v[4:7], a[196:199], v[228:231], v[4:7]
    s_waitcnt vmcnt(13) lgkmcnt(1)
    v_cvt_pk_bf16_f32 v202, v252, v202
    v_fma_f32 v252, v249, s24, v251
    v_fmac_f32 v251, s25, v249
    v_mfma_f32_16x16x32_bf16 v[8:11], a[200:203], v[228:231], v[8:11]
    ds_read_b128 v[228:231], v253 offset:12736
    v_bfe_u32 v221, s45, v221, 5
    v_mfma_f32_16x16x32_bf16 v[0:3], a[204:207], v[232:235], v[0:3]
    buffer_load_dwordx4 a[244:247], v254, s[8:11], s42 offen offset:1024 sc1
    v_mfma_f32_16x16x32_bf16 v[4:7], a[208:211], v[232:235], v[4:7]
    v_fma_f32 v249, v248, s24, v250
    v_fmac_f32 v250, s25, v248
    v_mfma_f32_16x16x32_bf16 v[8:11], a[212:215], v[232:235], v[8:11]
    v_mul_u32_u24 v221, 65, v221
    v_fma_f32 v248, v250, s26, v251
    v_mfma_f32_16x16x32_bf16 v[12:15], a[192:195], v[232:235], v[12:15]
    s_waitcnt lgkmcnt(1)
    v_fmac_f32 v251, s27, v250
    v_fma_f32 v250, v249, s28, v252
    v_mfma_f32_16x16x32_bf16 v[12:15], a[204:207], v[236:239], v[12:15]
    buffer_load_dwordx4 a[248:251], v254, s[8:11], s42 offen offset:2048 sc1
    v_fmac_f32 v252, s29, v249
    v_mfma_f32_16x16x32_bf16 v[16:19], a[208:211], v[236:239], v[16:19]
    v_sub_u32 v221, v221, v220
    v_fma_f32 v249, v196, s24, v200
    v_mfma_f32_16x16x32_bf16 v[16:19], a[196:199], v[232:235], v[16:19]
    s_add_u32 s42, s32, 264192
    v_fmac_f32 v200, s25, v196
    v_fma_f32 v196, v194, s24, v198
    v_mfma_f32_16x16x32_bf16 v[20:23], a[200:203], v[232:235], v[20:23]
    ds_read_b128 v[232:235], v253 offset:12480
    v_lshl_add_u32 v220, v221, 5, v253
    v_mfma_f32_16x16x32_bf16 v[20:23], a[212:215], v[236:239], v[20:23]
    buffer_load_dwordx4 a[252:255], v254, s[8:11], s42 offen offset:0 sc1
    s_waitcnt vmcnt(13)
    v_mfma_f32_16x16x32_bf16 v[0:3], a[216:219], v[236:239], v[0:3]
    v_fmac_f32 v198, s25, v194
    v_fma_f32 v194, v198, s26, v200
    v_mfma_f32_16x16x32_bf16 v[4:7], a[220:223], v[236:239], v[4:7]
    v_fmac_f32 v200, s27, v198
    v_fma_f32 v198, v196, s28, v249
    v_mfma_f32_16x16x32_bf16 v[8:11], a[224:227], v[236:239], v[8:11]
    s_waitcnt lgkmcnt(1)
    v_fmac_f32 v249, s29, v196
    v_cvt_pk_bf16_f32 v194, v248, v194
    v_cvt_pk_bf16_f32 v200, v251, v200
    v_mfma_f32_16x16x32_bf16 v[24:27], a[192:195], v[236:239], v[24:27]
    buffer_load_dwordx4 v[240:243], v254, s[8:11], s42 offen offset:1024 sc1
    v_mfma_f32_16x16x32_bf16 v[24:27], a[204:207], v[228:231], v[24:27]
    s_mov_b64 exec, s[46:47]
    ds_write_b128 v220, v[216:219] offset:1024
    s_mov_b64 exec, -1
    v_mfma_f32_16x16x32_bf16 v[28:31], a[208:211], v[228:231], v[28:31]
    v_cvt_pk_bf16_f32 v198, v250, v198
    v_cvt_pk_bf16_f32 v196, v252, v249
    v_mfma_f32_16x16x32_bf16 v[28:31], a[196:199], v[236:239], v[28:31]
    buffer_load_dwordx4 v[244:247], v254, s[8:11], s42 offen offset:2048 sc1
    v_mfma_f32_16x16x32_bf16 v[32:35], a[200:203], v[236:239], v[32:35]
    ds_read_b128 v[236:239], v253 offset:14304
    v_and_b32 v227, 0x7fff, v255
    v_mfma_f32_16x16x32_bf16 v[32:35], a[212:215], v[228:231], v[32:35]
    v_lshlrev_b32 v248, 16, v195
    v_lshlrev_b32 v249, 16, v197
    v_mfma_f32_16x16x32_bf16 v[12:15], a[216:219], v[228:231], v[12:15]
    buffer_load_dwordx2 v[216:217], v227, s[4:7], s16 offen offset:192
    v_lshlrev_b32 v250, 16, v199
    v_mfma_f32_16x16x32_bf16 v[16:19], a[220:223], v[228:231], v[16:19]
    v_lshlrev_b32 v251, 16, v201
    v_and_b32 v195, s22, v195
    v_mfma_f32_16x16x32_bf16 v[20:23], a[224:227], v[228:231], v[20:23]
    s_waitcnt lgkmcnt(2)
    v_and_b32 v197, s22, v197
    v_and_b32 v199, s22, v199
    v_mfma_f32_16x16x32_bf16 v[36:39], a[192:195], v[228:231], v[36:39]
    buffer_load_dwordx2 v[218:219], v227, s[4:7], s17 offen offset:192
    v_mfma_f32_16x16x32_bf16 v[36:39], a[204:207], v[232:235], v[36:39]
    v_and_b32 v201, s22, v201
    v_lshlrev_b32 v252, 16, v193
    v_mfma_f32_16x16x32_bf16 v[40:43], a[208:211], v[232:235], v[40:43]
    v_and_b32 v193, s22, v193
    v_add_f32 v252, v252, v251
    v_mfma_f32_16x16x32_bf16 v[40:43], a[196:199], v[228:231], v[40:43]
    buffer_load_dwordx2 v[220:221], v227, s[4:7], s18 offen offset:192
    v_add_f32 v193, v193, v201
    v_mfma_f32_16x16x32_bf16 v[44:47], a[200:203], v[228:231], v[44:47]
    ds_read_b128 v[228:231], v253 offset:14048
    v_fmac_f32 v252, s23, v249
    v_mfma_f32_16x16x32_bf16 v[44:47], a[212:215], v[232:235], v[44:47]
    v_fmac_f32 v193, s23, v197
    v_cvt_pk_bf16_f32 v193, v252, v193
    v_mfma_f32_16x16x32_bf16 v[24:27], a[216:219], v[232:235], v[24:27]
    buffer_load_dwordx2 v[222:223], v227, s[4:7], s19 offen offset:192
    v_mfma_f32_16x16x32_bf16 v[28:31], a[220:223], v[232:235], v[28:31]
    v_lshlrev_b32 v252, 16, v203
    v_and_b32 v203, s22, v203
    v_mfma_f32_16x16x32_bf16 v[32:35], a[224:227], v[232:235], v[32:35]
    s_waitcnt lgkmcnt(1)
    v_add_f32 v252, v252, v248
    v_add_f32 v203, v203, v195
    v_mfma_f32_16x16x32_bf16 v[48:51], a[192:195], v[232:235], v[48:51]
    buffer_load_dwordx2 v[224:225], v227, s[4:7], s20 offen offset:192
    v_mfma_f32_16x16x32_bf16 v[48:51], a[204:207], v[236:239], v[48:51]
    v_fmac_f32 v252, s23, v250
    v_fmac_f32 v203, s23, v199
    v_cvt_pk_bf16_f32 v203, v252, v203
    v_mfma_f32_16x16x32_bf16 v[52:55], a[208:211], v[236:239], v[52:55]
    v_fma_f32 v252, v249, s24, v251
    v_fmac_f32 v251, s25, v249
    v_mfma_f32_16x16x32_bf16 v[52:55], a[196:199], v[232:235], v[52:55]
    buffer_load_dwordx2 v[226:227], v227, s[4:7], s21 offen offset:192
    v_mfma_f32_16x16x32_bf16 v[56:59], a[200:203], v[232:235], v[56:59]
    ds_read_b128 v[232:235], v253 offset:13792
    v_fma_f32 v249, v248, s24, v250
    v_mfma_f32_16x16x32_bf16 v[56:59], a[212:215], v[236:239], v[56:59]
    v_fmac_f32 v250, s25, v248
    v_fma_f32 v248, v250, s26, v251
    v_mfma_f32_16x16x32_bf16 v[36:39], a[216:219], v[236:239], v[36:39]
    v_fmac_f32 v251, s27, v250
    v_fma_f32 v250, v249, s28, v252
    v_mfma_f32_16x16x32_bf16 v[40:43], a[220:223], v[236:239], v[40:43]
    v_fmac_f32 v252, s29, v249
    v_fma_f32 v249, v197, s24, v201
    v_mfma_f32_16x16x32_bf16 v[44:47], a[224:227], v[236:239], v[44:47]
    v_fmac_f32 v201, s25, v197
    v_fma_f32 v197, v195, s24, v199
    v_fmac_f32 v199, s25, v195
    v_mfma_f32_16x16x32_bf16 v[60:63], a[192:195], v[236:239], v[60:63]
    s_waitcnt lgkmcnt(1)
    v_fma_f32 v195, v199, s26, v201
    v_fmac_f32 v201, s27, v199
    v_mfma_f32_16x16x32_bf16 v[60:63], a[204:207], v[228:231], v[60:63]
    v_fma_f32 v199, v197, s28, v249
    v_fmac_f32 v249, s29, v197
    v_mfma_f32_16x16x32_bf16 v[64:67], a[208:211], v[228:231], v[64:67]
    v_cvt_pk_bf16_f32 v195, v248, v195
    v_cvt_pk_bf16_f32 v201, v251, v201
    v_mfma_f32_16x16x32_bf16 v[64:67], a[196:199], v[236:239], v[64:67]
    v_cvt_pk_bf16_f32 v199, v250, v199
    v_cvt_pk_bf16_f32 v197, v252, v249
    v_mfma_f32_16x16x32_bf16 v[68:71], a[200:203], v[236:239], v[68:71]
    ds_read_b128 v[236:239], v253 offset:13536
    v_lshrrev_b32 v252, 15, v255
    v_mfma_f32_16x16x32_bf16 v[68:71], a[212:215], v[228:231], v[68:71]
    ds_write_b64 v252, v[194:195] offset:256
    s_waitcnt vmcnt(15)
    v_mfma_f32_16x16x32_bf16 v[48:51], a[216:219], v[228:231], v[48:51]
    v_lshlrev_b32 v248, 16, v206
    v_lshlrev_b32 v249, 16, v208
    v_mfma_f32_16x16x32_bf16 v[52:55], a[220:223], v[228:231], v[52:55]
    ds_write_b64 v252, v[200:201] offset:2336
    v_mfma_f32_16x16x32_bf16 v[56:59], a[224:227], v[228:231], v[56:59]
    s_waitcnt lgkmcnt(3)
    v_lshlrev_b32 v250, 16, v210
    v_lshlrev_b32 v251, 16, v212
    v_mfma_f32_16x16x32_bf16 v[72:75], a[192:195], v[228:231], v[72:75]
    ds_write_b64 v252, v[198:199] offset:4416
    v_mfma_f32_16x16x32_bf16 v[72:75], a[204:207], v[232:235], v[72:75]
    v_and_b32 v206, s22, v206
    v_and_b32 v208, s22, v208
    v_mfma_f32_16x16x32_bf16 v[76:79], a[208:211], v[232:235], v[76:79]
    ds_write_b64 v252, v[192:193] offset:16896
    v_mfma_f32_16x16x32_bf16 v[76:79], a[196:199], v[228:231], v[76:79]
    v_and_b32 v210, s22, v210
    v_and_b32 v212, s22, v212
    v_mfma_f32_16x16x32_bf16 v[80:83], a[200:203], v[228:231], v[80:83]
    ds_read_b128 v[228:231], v253 offset:13264
    v_mfma_f32_16x16x32_bf16 v[80:83], a[212:215], v[232:235], v[80:83]
    ds_write_b64 v252, v[202:203] offset:25216
    v_mfma_f32_16x16x32_bf16 v[60:63], a[216:219], v[232:235], v[60:63]
    v_mfma_f32_16x16x32_bf16 v[64:67], a[220:223], v[232:235], v[64:67]
    ds_write_b64 v252, v[196:197] offset:6496
    v_mfma_f32_16x16x32_bf16 v[68:71], a[224:227], v[232:235], v[68:71]
    s_add_u32 s42, s32, 294912
    v_mfma_f32_16x16x32_bf16 v[84:87], a[192:195], v[232:235], v[84:87]
    buffer_load_dwordx4 a[192:195], v254, s[8:11], s42 offen offset:0 sc1
    v_mfma_f32_16x16x32_bf16 v[88:91], a[196:199], v[232:235], v[88:91]
    v_lshlrev_b32 v252, 16, v204
    v_and_b32 v204, s22, v204
    v_mfma_f32_16x16x32_bf16 v[92:95], a[200:203], v[232:235], v[92:95]
    s_waitcnt lgkmcnt(7)
    v_add_f32 v252, v252, v251
    v_add_f32 v204, v204, v212
    v_mfma_f32_16x16x32_bf16 v[84:87], a[204:207], v[236:239], v[84:87]
    ds_read_b128 v[232:235], v253 offset:32240
    v_fmac_f32 v252, s23, v249
    v_mfma_f32_16x16x32_bf16 v[88:91], a[208:211], v[236:239], v[88:91]
    buffer_load_dwordx4 a[196:199], v254, s[8:11], s42 offen offset:1024 sc1
    v_mfma_f32_16x16x32_bf16 v[92:95], a[212:215], v[236:239], v[92:95]
    v_fmac_f32 v204, s23, v208
    v_cvt_pk_bf16_f32 v204, v252, v204
    v_mfma_f32_16x16x32_bf16 v[72:75], a[216:219], v[236:239], v[72:75]
    s_waitcnt lgkmcnt(3)
    v_lshlrev_b32 v252, 16, v214
    v_and_b32 v214, s22, v214
    v_mfma_f32_16x16x32_bf16 v[76:79], a[220:223], v[236:239], v[76:79]
    buffer_load_dwordx4 a[200:203], v254, s[8:11], s42 offen offset:2048 sc1
    v_mfma_f32_16x16x32_bf16 v[80:83], a[224:227], v[236:239], v[80:83]
    ds_read_b128 v[236:239], v253 offset:31968
    v_add_f32 v252, v252, v248
    v_mfma_f32_16x16x32_bf16 v[84:87], a[216:219], v[228:231], v[84:87]
    s_add_u32 s42, s32, 297984
    v_add_f32 v214, v214, v206
    v_fmac_f32 v252, s23, v250
    v_mfma_f32_16x16x32_bf16 v[88:91], a[220:223], v[228:231], v[88:91]
    buffer_load_dwordx4 a[204:207], v254, s[8:11], s42 offen offset:0 sc1
    v_mfma_f32_16x16x32_bf16 v[92:95], a[224:227], v[228:231], v[92:95]
    ds_read_b128 v[228:231], v253 offset:31712
    v_fmac_f32 v214, s23, v210
    s_waitcnt vmcnt(16)
    s_waitcnt lgkmcnt(2)
sub7:
    v_mfma_f32_16x16x32_bf16 v[96:99], a[228:231], v[232:235], v[96:99]
    v_cvt_pk_bf16_f32 v214, v252, v214
    v_fma_f32 v252, v249, s24, v251
    v_mfma_f32_16x16x32_bf16 v[100:103], a[232:235], v[232:235], v[100:103]
    s_waitcnt vmcnt(13) lgkmcnt(1)
    v_fmac_f32 v251, s25, v249
    v_fma_f32 v249, v248, s24, v250
    v_mfma_f32_16x16x32_bf16 v[104:107], a[236:239], v[232:235], v[104:107]
    ds_read_b128 v[232:235], v253 offset:31456
    v_fmac_f32 v250, s25, v248
    v_mfma_f32_16x16x32_bf16 v[96:99], a[240:243], v[236:239], v[96:99]
    buffer_load_dwordx4 a[208:211], v254, s[8:11], s42 offen offset:1024 sc1
    v_mfma_f32_16x16x32_bf16 v[100:103], a[244:247], v[236:239], v[100:103]
    v_fma_f32 v248, v250, s26, v251
    v_fmac_f32 v251, s27, v250
    v_mfma_f32_16x16x32_bf16 v[104:107], a[248:251], v[236:239], v[104:107]
    v_fma_f32 v250, v249, s28, v252
    v_fmac_f32 v252, s29, v249
    v_mfma_f32_16x16x32_bf16 v[108:111], a[228:231], v[236:239], v[108:111]
    s_waitcnt lgkmcnt(1)
    v_fma_f32 v249, v208, s24, v212
    v_fmac_f32 v212, s25, v208
    v_mfma_f32_16x16x32_bf16 v[108:111], a[240:243], v[228:231], v[108:111]
    buffer_load_dwordx4 a[212:215], v254, s[8:11], s42 offen offset:2048 sc1
    v_mfma_f32_16x16x32_bf16 v[112:115], a[244:247], v[228:231], v[112:115]
    v_fma_f32 v208, v206, s24, v210
    v_fmac_f32 v210, s25, v206
    v_mfma_f32_16x16x32_bf16 v[112:115], a[232:235], v[236:239], v[112:115]
    s_add_u32 s42, s32, 301056
    v_fma_f32 v206, v210, s26, v212
    v_fmac_f32 v212, s27, v210
    v_mfma_f32_16x16x32_bf16 v[116:119], a[236:239], v[236:239], v[116:119]
    ds_read_b128 v[236:239], v253 offset:31200
    v_fma_f32 v210, v208, s28, v249
    v_mfma_f32_16x16x32_bf16 v[116:119], a[248:251], v[228:231], v[116:119]
    buffer_load_dwordx4 a[216:219], v254, s[8:11], s42 offen offset:0 sc1
    s_waitcnt vmcnt(13)
    v_mfma_f32_16x16x32_bf16 v[96:99], a[252:255], v[228:231], v[96:99]
    v_fmac_f32 v249, s29, v208
    v_cvt_pk_bf16_f32 v206, v248, v206
    v_mfma_f32_16x16x32_bf16 v[100:103], v[240:243], v[228:231], v[100:103]
    v_cvt_pk_bf16_f32 v212, v251, v212
    v_cvt_pk_bf16_f32 v210, v250, v210
    v_mfma_f32_16x16x32_bf16 v[104:107], v[244:247], v[228:231], v[104:107]
    s_waitcnt lgkmcnt(1)
    v_cvt_pk_bf16_f32 v208, v252, v249
    v_lshlrev_b32 v248, 16, v207
    v_mfma_f32_16x16x32_bf16 v[120:123], a[228:231], v[228:231], v[120:123]
    buffer_load_dwordx4 a[220:223], v254, s[8:11], s42 offen offset:1024 sc1
    v_mfma_f32_16x16x32_bf16 v[120:123], a[240:243], v[232:235], v[120:123]
    v_lshlrev_b32 v249, 16, v209
    v_lshlrev_b32 v250, 16, v211
    v_mfma_f32_16x16x32_bf16 v[124:127], a[244:247], v[232:235], v[124:127]
    v_lshlrev_b32 v251, 16, v213
    v_and_b32 v207, s22, v207
    v_mfma_f32_16x16x32_bf16 v[124:127], a[232:235], v[228:231], v[124:127]
    buffer_load_dwordx4 a[224:227], v254, s[8:11], s42 offen offset:2048 sc1
    v_mfma_f32_16x16x32_bf16 v[128:131], a[236:239], v[228:231], v[128:131]
    ds_read_b128 v[228:231], v253 offset:33024
    v_and_b32 v203, 0x7fff, v255
    v_mfma_f32_16x16x32_bf16 v[128:131], a[248:251], v[232:235], v[128:131]
    v_and_b32 v209, s22, v209
    v_and_b32 v211, s22, v211
    v_mfma_f32_16x16x32_bf16 v[108:111], a[252:255], v[232:235], v[108:111]
    buffer_load_dwordx2 v[192:193], v203, s[4:7], s16 offen offset:576
    v_mfma_f32_16x16x32_bf16 v[112:115], v[240:243], v[232:235], v[112:115]
    v_and_b32 v213, s22, v213
    v_lshlrev_b32 v252, 16, v205
    v_mfma_f32_16x16x32_bf16 v[116:119], v[244:247], v[232:235], v[116:119]
    s_waitcnt lgkmcnt(1)
    v_and_b32 v205, s22, v205
    v_add_f32 v252, v252, v251
    v_mfma_f32_16x16x32_bf16 v[132:135], a[228:231], v[232:235], v[132:135]
    buffer_load_dwordx2 v[194:195], v203, s[4:7], s17 offen offset:576
    v_mfma_f32_16x16x32_bf16 v[132:135], a[240:243], v[236:239], v[132:135]
    v_add_f32 v205, v205, v213
    v_fmac_f32 v252, s23, v249
    v_mfma_f32_16x16x32_bf16 v[136:139], a[244:247], v[236:239], v[136:139]
    v_fmac_f32 v205, s23, v209
    v_cvt_pk_bf16_f32 v205, v252, v205
    v_mfma_f32_16x16x32_bf16 v[136:139], a[232:235], v[232:235], v[136:139]
    buffer_load_dwordx2 v[196:197], v203, s[4:7], s18 offen offset:576
    v_mfma_f32_16x16x32_bf16 v[140:143], a[236:239], v[232:235], v[140:143]
    ds_read_b128 v[232:235], v253 offset:32768
    v_lshlrev_b32 v252, 16, v215
    v_mfma_f32_16x16x32_bf16 v[140:143], a[248:251], v[236:239], v[140:143]
    v_and_b32 v215, s22, v215
    v_add_f32 v252, v252, v248
    v_mfma_f32_16x16x32_bf16 v[120:123], a[252:255], v[236:239], v[120:123]
    buffer_load_dwordx2 v[198:199], v203, s[4:7], s19 offen offset:576
    v_mfma_f32_16x16x32_bf16 v[124:127], v[240:243], v[236:239], v[124:127]
    v_add_f32 v215, v215, v207
    v_fmac_f32 v252, s23, v250
    v_mfma_f32_16x16x32_bf16 v[128:131], v[244:247], v[236:239], v[128:131]
    s_waitcnt lgkmcnt(1)
    v_fmac_f32 v215, s23, v211
    v_cvt_pk_bf16_f32 v215, v252, v215
    v_mfma_f32_16x16x32_bf16 v[144:147], a[228:231], v[236:239], v[144:147]
    buffer_load_dwordx2 v[200:201], v203, s[4:7], s20 offen offset:576
    v_mfma_f32_16x16x32_bf16 v[144:147], a[240:243], v[228:231], v[144:147]
    v_fma_f32 v252, v249, s24, v251
    v_fmac_f32 v251, s25, v249
    v_mfma_f32_16x16x32_bf16 v[148:151], a[244:247], v[228:231], v[148:151]
    v_fma_f32 v249, v248, s24, v250
    v_fmac_f32 v250, s25, v248
    v_mfma_f32_16x16x32_bf16 v[148:151], a[232:235], v[236:239], v[148:151]
    buffer_load_dwordx2 v[202:203], v203, s[4:7], s21 offen offset:576
    v_mfma_f32_16x16x32_bf16 v[152:155], a[236:239], v[236:239], v[152:155]
    ds_read_b128 v[236:239], v253 offset:32512
    v_fma_f32 v248, v250, s26, v251
    v_mfma_f32_16x16x32_bf16 v[152:155], a[248:251], v[228:231], v[152:155]
    v_fmac_f32 v251, s27, v250
    v_fma_f32 v250, v249, s28, v252
    v_mfma_f32_16x16x32_bf16 v[132:135], a[252:255], v[228:231], v[132:135]
    v_fmac_f32 v252, s29, v249
    v_fma_f32 v249, v209, s24, v213
    v_mfma_f32_16x16x32_bf16 v[136:139], v[240:243], v[228:231], v[136:139]
    v_fmac_f32 v213, s25, v209
    v_fma_f32 v209, v207, s24, v211
    v_mfma_f32_16x16x32_bf16 v[140:143], v[244:247], v[228:231], v[140:143]
    v_fmac_f32 v211, s25, v207
    v_fma_f32 v207, v211, s26, v213
    v_mfma_f32_16x16x32_bf16 v[156:159], a[228:231], v[228:231], v[156:159]
    s_waitcnt lgkmcnt(1)
    v_fmac_f32 v213, s27, v211
    v_fma_f32 v211, v209, s28, v249
    v_mfma_f32_16x16x32_bf16 v[156:159], a[240:243], v[232:235], v[156:159]
    v_fmac_f32 v249, s29, v209
    v_cvt_pk_bf16_f32 v207, v248, v207
    v_mfma_f32_16x16x32_bf16 v[160:163], a[244:247], v[232:235], v[160:163]
    v_cvt_pk_bf16_f32 v213, v251, v213
    v_cvt_pk_bf16_f32 v211, v250, v211
    v_mfma_f32_16x16x32_bf16 v[160:163], a[232:235], v[228:231], v[160:163]
    v_cvt_pk_bf16_f32 v209, v252, v249
    v_lshrrev_b32 v252, 15, v255
    v_mfma_f32_16x16x32_bf16 v[164:167], a[236:239], v[228:231], v[164:167]
    ds_read_b128 v[228:231], v253 offset:32256
    v_mfma_f32_16x16x32_bf16 v[164:167], a[248:251], v[232:235], v[164:167]
    ds_write_b64 v252, v[206:207] offset:0
    v_mfma_f32_16x16x32_bf16 v[144:147], a[252:255], v[232:235], v[144:147]
    s_waitcnt vmcnt(15)
    v_lshlrev_b32 v248, 16, v218
    v_lshlrev_b32 v249, 16, v220
    v_mfma_f32_16x16x32_bf16 v[148:151], v[240:243], v[232:235], v[148:151]
    ds_write_b64 v252, v[212:213] offset:2080
    v_mfma_f32_16x16x32_bf16 v[152:155], v[244:247], v[232:235], v[152:155]
    s_waitcnt lgkmcnt(3)
    v_lshlrev_b32 v250, 16, v222
    v_lshlrev_b32 v251, 16, v224
    v_mfma_f32_16x16x32_bf16 v[168:171], a[228:231], v[232:235], v[168:171]
    ds_write_b64 v252, v[210:211] offset:4160
    v_mfma_f32_16x16x32_bf16 v[168:171], a[240:243], v[236:239], v[168:171]
    v_and_b32 v218, s22, v218
    v_and_b32 v220, s22, v220
    v_mfma_f32_16x16x32_bf16 v[172:175], a[244:247], v[236:239], v[172:175]
    ds_write_b64 v252, v[204:205] offset:16640
    v_mfma_f32_16x16x32_bf16 v[172:175], a[232:235], v[232:235], v[172:175]
    v_and_b32 v222, s22, v222
    v_and_b32 v224, s22, v224
    v_mfma_f32_16x16x32_bf16 v[176:179], a[236:239], v[232:235], v[176:179]
    ds_read_b128 v[232:235], v253 offset:31984
    v_mfma_f32_16x16x32_bf16 v[176:179], a[248:251], v[236:239], v[176:179]
    ds_write_b64 v252, v[214:215] offset:24960
    v_mfma_f32_16x16x32_bf16 v[156:159], a[252:255], v[236:239], v[156:159]
    s_waitcnt lgkmcnt(6)
    v_mfma_f32_16x16x32_bf16 v[160:163], v[240:243], v[236:239], v[160:163]
    ds_write_b64 v252, v[208:209] offset:6240
    v_mfma_f32_16x16x32_bf16 v[164:167], v[244:247], v[236:239], v[164:167]
    s_add_u32 s42, s32, 331776
    v_mfma_f32_16x16x32_bf16 v[180:183], a[228:231], v[236:239], v[180:183]
    buffer_load_dwordx4 a[228:231], v254, s[8:11], s42 offen offset:0 sc1
    v_mfma_f32_16x16x32_bf16 v[184:187], a[232:235], v[236:239], v[184:187]
    s_waitcnt lgkmcnt(0)
    v_lshlrev_b32 v252, 16, v216
    v_and_b32 v216, s22, v216
    v_mfma_f32_16x16x32_bf16 v[188:191], a[236:239], v[236:239], v[188:191]
    s_barrier
    v_mfma_f32_16x16x32_bf16 v[180:183], a[240:243], v[228:231], v[180:183]
    ds_read_b128 v[236:239], v253 offset:1040
    v_add_f32 v252, v252, v251
    v_mfma_f32_16x16x32_bf16 v[184:187], a[244:247], v[228:231], v[184:187]
    buffer_load_dwordx4 a[232:235], v254, s[8:11], s42 offen offset:1024 sc1
    v_mfma_f32_16x16x32_bf16 v[188:191], a[248:251], v[228:231], v[188:191]
    v_add_f32 v216, v216, v224
    v_fmac_f32 v252, s23, v249
    v_mfma_f32_16x16x32_bf16 v[168:171], a[252:255], v[228:231], v[168:171]
    v_fmac_f32 v216, s23, v220
    v_cvt_pk_bf16_f32 v216, v252, v216
    v_mfma_f32_16x16x32_bf16 v[172:175], v[240:243], v[228:231], v[172:175]
    buffer_load_dwordx4 a[236:239], v254, s[8:11], s42 offen offset:2048 sc1
    v_mfma_f32_16x16x32_bf16 v[176:179], v[244:247], v[228:231], v[176:179]
    ds_read_b128 v[228:231], v253 offset:768
    v_lshlrev_b32 v252, 16, v226
    v_mfma_f32_16x16x32_bf16 v[180:183], a[252:255], v[232:235], v[180:183]
    s_add_u32 s42, s32, 334848
    v_and_b32 v226, s22, v226
    v_add_f32 v252, v252, v248
    v_mfma_f32_16x16x32_bf16 v[184:187], v[240:243], v[232:235], v[184:187]
    buffer_load_dwordx4 a[240:243], v254, s[8:11], s42 offen offset:0 sc1
    v_mfma_f32_16x16x32_bf16 v[188:191], v[244:247], v[232:235], v[188:191]
    ds_read_b128 v[232:235], v253 offset:512
    v_add_f32 v226, v226, v218
    s_waitcnt vmcnt(16)
    s_waitcnt lgkmcnt(2)
sub8:
    v_mfma_f32_16x16x32_bf16 a[0:3], a[192:195], v[236:239], a[0:3]
    v_fmac_f32 v252, s23, v250
    v_fmac_f32 v226, s23, v222
    v_mfma_f32_16x16x32_bf16 a[4:7], a[196:199], v[236:239], a[4:7]
    s_waitcnt vmcnt(13) lgkmcnt(1)
    v_cvt_pk_bf16_f32 v226, v252, v226
    v_fma_f32 v252, v249, s24, v251
    v_mfma_f32_16x16x32_bf16 a[8:11], a[200:203], v[236:239], a[8:11]
    ds_read_b128 v[236:239], v253 offset:256
    v_fmac_f32 v251, s25, v249
    v_mfma_f32_16x16x32_bf16 a[0:3], a[204:207], v[228:231], a[0:3]
    buffer_load_dwordx4 a[244:247], v254, s[8:11], s42 offen offset:1024 sc1
    v_fma_f32 v249, v248, s24, v250
    v_mfma_f32_16x16x32_bf16 a[4:7], a[208:211], v[228:231], a[4:7]
    v_fmac_f32 v250, s25, v248
    v_fma_f32 v248, v250, s26, v251
    v_mfma_f32_16x16x32_bf16 a[8:11], a[212:215], v[228:231], a[8:11]
    v_fmac_f32 v251, s27, v250
    v_fma_f32 v250, v249, s28, v252
    v_mfma_f32_16x16x32_bf16 a[12:15], a[192:195], v[228:231], a[12:15]
    s_waitcnt lgkmcnt(1)
    v_fmac_f32 v252, s29, v249
    v_fma_f32 v249, v220, s24, v224
    v_mfma_f32_16x16x32_bf16 a[12:15], a[204:207], v[232:235], a[12:15]
    buffer_load_dwordx4 a[248:251], v254, s[8:11], s42 offen offset:2048 sc1
    v_mfma_f32_16x16x32_bf16 a[16:19], a[208:211], v[232:235], a[16:19]
    v_fmac_f32 v224, s25, v220
    v_fma_f32 v220, v218, s24, v222
    v_mfma_f32_16x16x32_bf16 a[16:19], a[196:199], v[228:231], a[16:19]
    s_add_u32 s42, s32, 337920
    v_fmac_f32 v222, s25, v218
    v_fma_f32 v218, v222, s26, v224
    v_mfma_f32_16x16x32_bf16 a[20:23], a[200:203], v[228:231], a[20:23]
    ds_read_b128 v[228:231], v253 offset:0
    v_fmac_f32 v224, s27, v222
    v_mfma_f32_16x16x32_bf16 a[20:23], a[212:215], v[232:235], a[20:23]
    buffer_load_dwordx4 a[252:255], v254, s[8:11], s42 offen offset:0 sc1
    s_waitcnt vmcnt(13)
    v_mfma_f32_16x16x32_bf16 a[0:3], a[216:219], v[232:235], a[0:3]
    v_fma_f32 v222, v220, s28, v249
    v_fmac_f32 v249, s29, v220
    v_mfma_f32_16x16x32_bf16 a[4:7], a[220:223], v[232:235], a[4:7]
    v_cvt_pk_bf16_f32 v218, v248, v218
    v_cvt_pk_bf16_f32 v224, v251, v224
    v_mfma_f32_16x16x32_bf16 a[8:11], a[224:227], v[232:235], a[8:11]
    s_waitcnt lgkmcnt(1)
    v_cvt_pk_bf16_f32 v222, v250, v222
    v_cvt_pk_bf16_f32 v220, v252, v249
    v_mfma_f32_16x16x32_bf16 a[24:27], a[192:195], v[232:235], a[24:27]
    buffer_load_dwordx4 v[240:243], v254, s[8:11], s42 offen offset:1024 sc1
    v_mfma_f32_16x16x32_bf16 a[24:27], a[204:207], v[236:239], a[24:27]
    v_lshlrev_b32 v248, 16, v219
    v_lshlrev_b32 v249, 16, v221
    v_mfma_f32_16x16x32_bf16 a[28:31], a[208:211], v[236:239], a[28:31]
    v_lshlrev_b32 v250, 16, v223
    v_lshlrev_b32 v251, 16, v225
    v_mfma_f32_16x16x32_bf16 a[28:31], a[196:199], v[232:235], a[28:31]
    buffer_load_dwordx4 v[244:247], v254, s[8:11], s42 offen offset:2048 sc1
    v_mfma_f32_16x16x32_bf16 a[32:35], a[200:203], v[232:235], a[32:35]
    ds_read_b128 v[232:235], v253 offset:1824
    v_and_b32 v215, 0x7fff, v255
    v_mfma_f32_16x16x32_bf16 a[32:35], a[212:215], v[236:239], a[32:35]
    v_and_b32 v219, s22, v219
    v_and_b32 v221, s22, v221
    v_mfma_f32_16x16x32_bf16 a[12:15], a[216:219], v[236:239], a[12:15]
    buffer_load_dwordx2 v[204:205], v215, s[4:7], s16 offen offset:960
    v_mfma_f32_16x16x32_bf16 a[16:19], a[220:223], v[236:239], a[16:19]
    v_and_b32 v223, s22, v223
    v_and_b32 v225, s22, v225
    v_mfma_f32_16x16x32_bf16 a[20:23], a[224:227], v[236:239], a[20:23]
    s_waitcnt lgkmcnt(1)
    v_lshlrev_b32 v252, 16, v217
    v_and_b32 v217, s22, v217
    v_add_f32 v252, v252, v251
    v_mfma_f32_16x16x32_bf16 a[36:39], a[192:195], v[236:239], a[36:39]
    buffer_load_dwordx2 v[206:207], v215, s[4:7], s17 offen offset:960
    v_mfma_f32_16x16x32_bf16 a[36:39], a[204:207], v[228:231], a[36:39]
    v_add_f32 v217, v217, v225
    v_fmac_f32 v252, s23, v249
    v_mfma_f32_16x16x32_bf16 a[40:43], a[208:211], v[228:231], a[40:43]
    v_fmac_f32 v217, s23, v221
    v_cvt_pk_bf16_f32 v217, v252, v217
    v_mfma_f32_16x16x32_bf16 a[40:43], a[196:199], v[236:239], a[40:43]
    buffer_load_dwordx2 v[208:209], v215, s[4:7], s18 offen offset:960
    v_mfma_f32_16x16x32_bf16 a[44:47], a[200:203], v[236:239], a[44:47]
    ds_read_b128 v[236:239], v253 offset:1568
    v_lshlrev_b32 v252, 16, v227
    v_mfma_f32_16x16x32_bf16 a[44:47], a[212:215], v[228:231], a[44:47]
    v_and_b32 v227, s22, v227
    v_add_f32 v252, v252, v248
    v_mfma_f32_16x16x32_bf16 a[24:27], a[216:219], v[228:231], a[24:27]
    buffer_load_dwordx2 v[210:211], v215, s[4:7], s19 offen offset:960
    v_mfma_f32_16x16x32_bf16 a[28:31], a[220:223], v[228:231], a[28:31]
    v_add_f32 v227, v227, v219
    v_fmac_f32 v252, s23, v250
    v_mfma_f32_16x16x32_bf16 a[32:35], a[224:227], v[228:231], a[32:35]
    s_waitcnt lgkmcnt(1)
    v_fmac_f32 v227, s23, v223
    v_cvt_pk_bf16_f32 v227, v252, v227
    v_mfma_f32_16x16x32_bf16 a[48:51], a[192:195], v[228:231], a[48:51]
    buffer_load_dwordx2 v[212:213], v215, s[4:7], s20 offen offset:960
    v_mfma_f32_16x16x32_bf16 a[48:51], a[204:207], v[232:235], a[48:51]
    v_fma_f32 v252, v249, s24, v251
    v_fmac_f32 v251, s25, v249
    v_mfma_f32_16x16x32_bf16 a[52:55], a[208:211], v[232:235], a[52:55]
pad3:
    s_cbranch_vccnz pad7
    v_fma_f32 v249, v248, s24, v250
    v_fmac_f32 v250, s25, v248
    v_mfma_f32_16x16x32_bf16 a[52:55], a[196:199], v[228:231], a[52:55]
    buffer_load_dwordx2 v[214:215], v215, s[4:7], s21 offen offset:960
    v_mfma_f32_16x16x32_bf16 a[56:59], a[200:203], v[228:231], a[56:59]
    ds_read_b128 v[228:231], v253 offset:1312
    v_fma_f32 v248, v250, s26, v251
    v_mfma_f32_16x16x32_bf16 a[56:59], a[212:215], v[232:235], a[56:59]
    v_fmac_f32 v251, s27, v250
    v_fma_f32 v250, v249, s28, v252
    v_mfma_f32_16x16x32_bf16 a[36:39], a[216:219], v[232:235], a[36:39]
    v_fmac_f32 v252, s29, v249
    v_fma_f32 v249, v221, s24, v225
    v_mfma_f32_16x16x32_bf16 a[40:43], a[220:223], v[232:235], a[40:43]
    v_fmac_f32 v225, s25, v221
    v_fma_f32 v221, v219, s24, v223
    v_mfma_f32_16x16x32_bf16 a[44:47], a[224:227], v[232:235], a[44:47]
    v_fmac_f32 v223, s25, v219
    v_fma_f32 v219, v223, s26, v225
    v_mfma_f32_16x16x32_bf16 a[60:63], a[192:195], v[232:235], a[60:63]
    s_waitcnt lgkmcnt(1)
    v_fmac_f32 v225, s27, v223
    v_fma_f32 v223, v221, s28, v249
    v_mfma_f32_16x16x32_bf16 a[60:63], a[204:207], v[236:239], a[60:63]
    v_fmac_f32 v249, s29, v221
    v_cvt_pk_bf16_f32 v219, v248, v219
    v_cvt_pk_bf16_f32 v225, v251, v225
    v_mfma_f32_16x16x32_bf16 a[64:67], a[208:211], v[236:239], a[64:67]
    v_cvt_pk_bf16_f32 v223, v250, v223
    v_cvt_pk_bf16_f32 v221, v252, v249
    v_mfma_f32_16x16x32_bf16 a[64:67], a[196:199], v[232:235], a[64:67]
    v_lshrrev_b32 v252, 15, v255
    v_mfma_f32_16x16x32_bf16 a[68:71], a[200:203], v[232:235], a[68:71]
    ds_read_b128 v[232:235], v253 offset:1056
    v_mfma_f32_16x16x32_bf16 a[68:71], a[212:215], v[236:239], a[68:71]
    ds_write_b64 v252, v[218:219] offset:9088
    v_mfma_f32_16x16x32_bf16 a[48:51], a[216:219], v[236:239], a[48:51]
    s_waitcnt vmcnt(15)
    v_lshlrev_b32 v248, 16, v194
    v_lshlrev_b32 v249, 16, v196
    v_mfma_f32_16x16x32_bf16 a[52:55], a[220:223], v[236:239], a[52:55]
    ds_write_b64 v252, v[224:225] offset:11168
    v_mfma_f32_16x16x32_bf16 a[56:59], a[224:227], v[236:239], a[56:59]
    s_waitcnt lgkmcnt(3)
    v_lshlrev_b32 v250, 16, v198
    v_lshlrev_b32 v251, 16, v200
    v_mfma_f32_16x16x32_bf16 a[72:75], a[192:195], v[236:239], a[72:75]
    ds_write_b64 v252, v[222:223] offset:13248
    v_mfma_f32_16x16x32_bf16 a[72:75], a[204:207], v[228:231], a[72:75]
    v_and_b32 v194, s22, v194
    v_and_b32 v196, s22, v196
    v_mfma_f32_16x16x32_bf16 a[76:79], a[208:211], v[228:231], a[76:79]
    ds_write_b64 v252, v[216:217] offset:19488
    v_mfma_f32_16x16x32_bf16 a[76:79], a[196:199], v[236:239], a[76:79]
    v_and_b32 v198, s22, v198
    v_and_b32 v200, s22, v200
    v_mfma_f32_16x16x32_bf16 a[80:83], a[200:203], v[236:239], a[80:83]
    ds_read_b128 v[236:239], v253 offset:784
    v_mfma_f32_16x16x32_bf16 a[80:83], a[212:215], v[228:231], a[80:83]
    ds_write_b64 v252, v[226:227] offset:27808
    v_mfma_f32_16x16x32_bf16 a[60:63], a[216:219], v[228:231], a[60:63]
    v_mfma_f32_16x16x32_bf16 a[64:67], a[220:223], v[228:231], a[64:67]
    ds_write_b64 v252, v[220:221] offset:31968
    v_mfma_f32_16x16x32_bf16 a[68:71], a[224:227], v[228:231], a[68:71]
    s_add_u32 s42, s32, 368640
    v_mfma_f32_16x16x32_bf16 a[84:87], a[192:195], v[228:231], a[84:87]
    buffer_load_dwordx4 a[192:195], v254, s[8:11], s42 offen offset:0 sc1
    v_mfma_f32_16x16x32_bf16 a[88:91], a[196:199], v[228:231], a[88:91]
    v_lshlrev_b32 v252, 16, v192
    v_and_b32 v192, s22, v192
    v_mfma_f32_16x16x32_bf16 a[92:95], a[200:203], v[228:231], a[92:95]
    s_waitcnt lgkmcnt(7)
    v_add_f32 v252, v252, v251
    v_add_f32 v192, v192, v200
    v_mfma_f32_16x16x32_bf16 a[84:87], a[204:207], v[232:235], a[84:87]
    ds_read_b128 v[228:231], v253 offset:3120
    v_fmac_f32 v252, s23, v249
    v_mfma_f32_16x16x32_bf16 a[88:91], a[208:211], v[232:235], a[88:91]
    buffer_load_dwordx4 a[196:199], v254, s[8:11], s42 offen offset:1024 sc1
    v_mfma_f32_16x16x32_bf16 a[92:95], a[212:215], v[232:235], a[92:95]
    v_fmac_f32 v192, s23, v196
    v_cvt_pk_bf16_f32 v192, v252, v192
    v_mfma_f32_16x16x32_bf16 a[72:75], a[216:219], v[232:235], a[72:75]
    s_waitcnt lgkmcnt(3)
    v_lshlrev_b32 v252, 16, v202
    v_and_b32 v202, s22, v202
    v_mfma_f32_16x16x32_bf16 a[76:79], a[220:223], v[232:235], a[76:79]
    buffer_load_dwordx4 a[200:203], v254, s[8:11], s42 offen offset:2048 sc1
    v_mfma_f32_16x16x32_bf16 a[80:83], a[224:227], v[232:235], a[80:83]
    ds_read_b128 v[232:235], v253 offset:2848
    v_add_f32 v252, v252, v248
    v_mfma_f32_16x16x32_bf16 a[84:87], a[216:219], v[236:239], a[84:87]
    s_add_u32 s42, s32, 371712
    v_add_f32 v202, v202, v194
    v_fmac_f32 v252, s23, v250
    v_mfma_f32_16x16x32_bf16 a[88:91], a[220:223], v[236:239], a[88:91]
    buffer_load_dwordx4 a[204:207], v254, s[8:11], s42 offen offset:0 sc1
    v_mfma_f32_16x16x32_bf16 a[92:95], a[224:227], v[236:239], a[92:95]
    ds_read_b128 v[236:239], v253 offset:2592
    v_fmac_f32 v202, s23, v198
    s_waitcnt vmcnt(16)
    s_waitcnt lgkmcnt(2)
sub9:
    v_mfma_f32_16x16x32_bf16 a[96:99], a[228:231], v[228:231], a[96:99]
    v_cvt_pk_bf16_f32 v202, v252, v202
    v_fma_f32 v252, v249, s24, v251
    v_mfma_f32_16x16x32_bf16 a[100:103], a[232:235], v[228:231], a[100:103]
    s_waitcnt vmcnt(13) lgkmcnt(1)
    v_fmac_f32 v251, s25, v249
    v_fma_f32 v249, v248, s24, v250
    v_mfma_f32_16x16x32_bf16 a[104:107], a[236:239], v[228:231], a[104:107]
    ds_read_b128 v[228:231], v253 offset:2336
    v_fmac_f32 v250, s25, v248
    v_mfma_f32_16x16x32_bf16 a[96:99], a[240:243], v[232:235], a[96:99]
    buffer_load_dwordx4 a[208:211], v254, s[8:11], s42 offen offset:1024 sc1
    v_mfma_f32_16x16x32_bf16 a[100:103], a[244:247], v[232:235], a[100:103]
    v_fma_f32 v248, v250, s26, v251
    v_fmac_f32 v251, s27, v250
    v_mfma_f32_16x16x32_bf16 a[104:107], a[248:251], v[232:235], a[104:107]
    v_fma_f32 v250, v249, s28, v252
    v_fmac_f32 v252, s29, v249
    v_mfma_f32_16x16x32_bf16 a[108:111], a[228:231], v[232:235], a[108:111]
    s_waitcnt lgkmcnt(1)
    v_fma_f32 v249, v196, s24, v200
    v_fmac_f32 v200, s25, v196
    v_mfma_f32_16x16x32_bf16 a[108:111], a[240:243], v[236:239], a[108:111]
    buffer_load_dwordx4 a[212:215], v254, s[8:11], s42 offen offset:2048 sc1
    v_mfma_f32_16x16x32_bf16 a[112:115], a[244:247], v[236:239], a[112:115]
    v_fma_f32 v196, v194, s24, v198
    v_fmac_f32 v198, s25, v194
    v_mfma_f32_16x16x32_bf16 a[112:115], a[232:235], v[232:235], a[112:115]
    s_add_u32 s42, s32, 374784
    v_fma_f32 v194, v198, s26, v200
    v_fmac_f32 v200, s27, v198
    v_mfma_f32_16x16x32_bf16 a[116:119], a[236:239], v[232:235], a[116:119]
    ds_read_b128 v[232:235], v253 offset:2080
    v_fma_f32 v198, v196, s28, v249
    v_mfma_f32_16x16x32_bf16 a[116:119], a[248:251], v[236:239], a[116:119]
    buffer_load_dwordx4 a[216:219], v254, s[8:11], s42 offen offset:0 sc1
    s_waitcnt vmcnt(13)
    v_mfma_f32_16x16x32_bf16 a[96:99], a[252:255], v[236:239], a[96:99]
    v_fmac_f32 v249, s29, v196
    v_cvt_pk_bf16_f32 v194, v248, v194
    v_mfma_f32_16x16x32_bf16 a[100:103], v[240:243], v[236:239], a[100:103]
    v_cvt_pk_bf16_f32 v200, v251, v200
    v_cvt_pk_bf16_f32 v198, v250, v198
    v_mfma_f32_16x16x32_bf16 a[104:107], v[244:247], v[236:239], a[104:107]
    s_waitcnt lgkmcnt(1)
    v_cvt_pk_bf16_f32 v196, v252, v249
    v_lshlrev_b32 v248, 16, v195
    v_mfma_f32_16x16x32_bf16 a[120:123], a[228:231], v[236:239], a[120:123]
    buffer_load_dwordx4 a[220:223], v254, s[8:11], s42 offen offset:1024 sc1
    v_mfma_f32_16x16x32_bf16 a[120:123], a[240:243], v[228:231], a[120:123]
    v_lshlrev_b32 v249, 16, v197
    v_lshlrev_b32 v250, 16, v199
    v_mfma_f32_16x16x32_bf16 a[124:127], a[244:247], v[228:231], a[124:127]
    v_lshlrev_b32 v251, 16, v201
    v_and_b32 v195, s22, v195
    v_mfma_f32_16x16x32_bf16 a[124:127], a[232:235], v[236:239], a[124:127]
    buffer_load_dwordx4 a[224:227], v254, s[8:11], s42 offen offset:2048 sc1
    v_mfma_f32_16x16x32_bf16 a[128:131], a[236:239], v[236:239], a[128:131]
    ds_read_b128 v[236:239], v253 offset:3904
    v_and_b32 v227, 0x7fff, v255
    v_mfma_f32_16x16x32_bf16 a[128:131], a[248:251], v[228:231], a[128:131]
    v_and_b32 v197, s22, v197
    v_and_b32 v199, s22, v199
    v_mfma_f32_16x16x32_bf16 a[108:111], a[252:255], v[228:231], a[108:111]
    buffer_load_dwordx2 v[216:217], v227, s[4:7], s16 offen offset:1344
    v_mfma_f32_16x16x32_bf16 a[112:115], v[240:243], v[228:231], a[112:115]
    v_and_b32 v201, s22, v201
    v_lshlrev_b32 v252, 16, v193
    v_mfma_f32_16x16x32_bf16 a[116:119], v[244:247], v[228:231], a[116:119]
    s_waitcnt lgkmcnt(1)
    v_and_b32 v193, s22, v193
    v_add_f32 v252, v252, v251
    v_mfma_f32_16x16x32_bf16 a[132:135], a[228:231], v[228:231], a[132:135]
    buffer_load_dwordx2 v[218:219], v227, s[4:7], s17 offen offset:1344
    v_mfma_f32_16x16x32_bf16 a[132:135], a[240:243], v[232:235], a[132:135]
    v_add_f32 v193, v193, v201
    v_fmac_f32 v252, s23, v249
    v_mfma_f32_16x16x32_bf16 a[136:139], a[244:247], v[232:235], a[136:139]
    v_fmac_f32 v193, s23, v197
    v_cvt_pk_bf16_f32 v193, v252, v193
    v_mfma_f32_16x16x32_bf16 a[136:139], a[232:235], v[228:231], a[136:139]
    buffer_load_dwordx2 v[220:221], v227, s[4:7], s18 offen offset:1344
    v_mfma_f32_16x16x32_bf16 a[140:143], a[236:239], v[228:231], a[140:143]
    ds_read_b128 v[228:231], v253 offset:3648
    v_lshlrev_b32 v252, 16, v203
    v_mfma_f32_16x16x32_bf16 a[140:143], a[248:251], v[232:235], a[140:143]
    v_and_b32 v203, s22, v203
    v_add_f32 v252, v252, v248
    v_mfma_f32_16x16x32_bf16 a[120:123], a[252:255], v[232:235], a[120:123]
    buffer_load_dwordx2 v[222:223], v227, s[4:7], s19 offen offset:1344
    v_mfma_f32_16x16x32_bf16 a[124:127], v[240:243], v[232:235], a[124:127]
    v_add_f32 v203, v203, v195
    v_fmac_f32 v252, s23, v250
    v_mfma_f32_16x16x32_bf16 a[128:131], v[244:247], v[232:235], a[128:131]
    s_waitcnt lgkmcnt(1)
    v_fmac_f32 v203, s23, v199
    v_cvt_pk_bf16_f32 v203, v252, v203
    v_mfma_f32_16x16x32_bf16 a[144:147], a[228:231], v[232:235], a[144:147]
    buffer_load_dwordx2 v[224:225], v227, s[4:7], s20 offen offset:1344
    v_mfma_f32_16x16x32_bf16 a[144:147], a[240:243], v[236:239], a[144:147]
    v_fma_f32 v252, v249, s24, v251
    v_fmac_f32 v251, s25, v249
    v_mfma_f32_16x16x32_bf16 a[148:151], a[244:247], v[236:239], a[148:151]
    v_fma_f32 v249, v248, s24, v250
    v_fmac_f32 v250, s25, v248
    v_mfma_f32_16x16x32_bf16 a[148:151], a[232:235], v[232:235], a[148:151]
    buffer_load_dwordx2 v[226:227], v227, s[4:7], s21 offen offset:1344
    v_mfma_f32_16x16x32_bf16 a[152:155], a[236:239], v[232:235], a[152:155]
    ds_read_b128 v[232:235], v253 offset:3392
    v_fma_f32 v248, v250, s26, v251
    v_mfma_f32_16x16x32_bf16 a[152:155], a[248:251], v[236:239], a[152:155]
    v_fmac_f32 v251, s27, v250
    v_fma_f32 v250, v249, s28, v252
    v_mfma_f32_16x16x32_bf16 a[132:135], a[252:255], v[236:239], a[132:135]
    v_fmac_f32 v252, s29, v249
    v_fma_f32 v249, v197, s24, v201
    v_mfma_f32_16x16x32_bf16 a[136:139], v[240:243], v[236:239], a[136:139]
    v_fmac_f32 v201, s25, v197
    v_fma_f32 v197, v195, s24, v199
    v_mfma_f32_16x16x32_bf16 a[140:143], v[244:247], v[236:239], a[140:143]
    v_fmac_f32 v199, s25, v195
    v_fma_f32 v195, v199, s26, v201
    v_mfma_f32_16x16x32_bf16 a[156:159], a[228:231], v[236:239], a[156:159]
    s_waitcnt lgkmcnt(1)
    v_fmac_f32 v201, s27, v199
    v_fma_f32 v199, v197, s28, v249
    v_mfma_f32_16x16x32_bf16 a[156:159], a[240:243], v[228:231], a[156:159]
    v_fmac_f32 v249, s29, v197
    v_cvt_pk_bf16_f32 v195, v248, v195
    v_mfma_f32_16x16x32_bf16 a[160:163], a[244:247], v[228:231], a[160:163]
    v_cvt_pk_bf16_f32 v201, v251, v201
    v_cvt_pk_bf16_f32 v199, v250, v199
    v_mfma_f32_16x16x32_bf16 a[160:163], a[232:235], v[236:239], a[160:163]
    v_cvt_pk_bf16_f32 v197, v252, v249
    v_lshrrev_b32 v252, 15, v255
    v_mfma_f32_16x16x32_bf16 a[164:167], a[236:239], v[236:239], a[164:167]
    ds_read_b128 v[236:239], v253 offset:3136
    v_mfma_f32_16x16x32_bf16 a[164:167], a[248:251], v[228:231], a[164:167]
    ds_write_b64 v252, v[194:195] offset:8832
    v_mfma_f32_16x16x32_bf16 a[144:147], a[252:255], v[228:231], a[144:147]
    s_waitcnt vmcnt(15)
    v_lshlrev_b32 v248, 16, v206
    v_lshlrev_b32 v249, 16, v208
    v_mfma_f32_16x16x32_bf16 a[148:151], v[240:243], v[228:231], a[148:151]
    ds_write_b64 v252, v[200:201] offset:10912
    v_mfma_f32_16x16x32_bf16 a[152:155], v[244:247], v[228:231], a[152:155]
    s_waitcnt lgkmcnt(3)
    v_lshlrev_b32 v250, 16, v210
    v_lshlrev_b32 v251, 16, v212
    v_mfma_f32_16x16x32_bf16 a[168:171], a[228:231], v[228:231], a[168:171]
    ds_write_b64 v252, v[198:199] offset:12992
    v_mfma_f32_16x16x32_bf16 a[168:171], a[240:243], v[232:235], a[168:171]
    v_and_b32 v206, s22, v206
    v_and_b32 v208, s22, v208
    v_mfma_f32_16x16x32_bf16 a[172:175], a[244:247], v[232:235], a[172:175]
    ds_write_b64 v252, v[192:193] offset:19232
    v_mfma_f32_16x16x32_bf16 a[172:175], a[232:235], v[228:231], a[172:175]
    v_and_b32 v210, s22, v210
    v_and_b32 v212, s22, v212
    v_mfma_f32_16x16x32_bf16 a[176:179], a[236:239], v[228:231], a[176:179]
    ds_read_b128 v[228:231], v253 offset:2864
    v_mfma_f32_16x16x32_bf16 a[176:179], a[248:251], v[232:235], a[176:179]
    ds_write_b64 v252, v[202:203] offset:27552
    v_mfma_f32_16x16x32_bf16 a[156:159], a[252:255], v[232:235], a[156:159]
    v_mfma_f32_16x16x32_bf16 a[160:163], v[240:243], v[232:235], a[160:163]
    ds_write_b64 v252, v[196:197] offset:31712
    v_mfma_f32_16x16x32_bf16 a[164:167], v[244:247], v[232:235], a[164:167]
    s_add_u32 s42, s32, 405504
    v_mfma_f32_16x16x32_bf16 a[180:183], a[228:231], v[232:235], a[180:183]
    buffer_load_dwordx4 a[228:231], v254, s[8:11], s42 offen offset:0 sc1
    v_mfma_f32_16x16x32_bf16 a[184:187], a[232:235], v[232:235], a[184:187]
    v_lshlrev_b32 v252, 16, v204
    v_and_b32 v204, s22, v204
    v_mfma_f32_16x16x32_bf16 a[188:191], a[236:239], v[232:235], a[188:191]
    s_waitcnt lgkmcnt(2)
    v_add_f32 v252, v252, v251
    v_add_f32 v204, v204, v212
    v_mfma_f32_16x16x32_bf16 a[180:183], a[240:243], v[236:239], a[180:183]
    ds_read_b128 v[232:235], v253 offset:5200
    v_fmac_f32 v252, s23, v249
    v_mfma_f32_16x16x32_bf16 a[184:187], a[244:247], v[236:239], a[184:187]
    buffer_load_dwordx4 a[232:235], v254, s[8:11], s42 offen offset:1024 sc1
    v_mfma_f32_16x16x32_bf16 a[188:191], a[248:251], v[236:239], a[188:191]
    ds_read_b128 v[192:195], v253 offset:40096
    v_fmac_f32 v204, s23, v208
    v_cvt_pk_bf16_f32 v204, v252, v204
    v_mfma_f32_16x16x32_bf16 a[168:171], a[252:255], v[236:239], a[168:171]
    s_mov_b32 s45, 452138121
    v_lshlrev_b32 v252, 16, v214
    v_and_b32 v214, s22, v214
    v_mfma_f32_16x16x32_bf16 a[172:175], v[240:243], v[236:239], a[172:175]
    buffer_load_dwordx4 a[236:239], v254, s[8:11], s42 offen offset:2048 sc1
    v_mfma_f32_16x16x32_bf16 a[176:179], v[244:247], v[236:239], a[176:179]
    ds_read_b128 v[236:239], v253 offset:4928
    v_add_f32 v252, v252, v248
    v_mfma_f32_16x16x32_bf16 a[180:183], a[252:255], v[228:231], a[180:183]
    s_add_u32 s42, s32, 408576
    v_bfe_u32 v196, v254, 5, 3
    v_add_f32 v214, v214, v206
    v_mfma_f32_16x16x32_bf16 a[184:187], v[240:243], v[228:231], a[184:187]
    buffer_load_dwordx4 a[240:243], v254, s[8:11], s42 offen offset:0 sc1
    v_mfma_f32_16x16x32_bf16 a[188:191], v[244:247], v[228:231], a[188:191]
    ds_read_b128 v[228:231], v253 offset:4672
    v_mul_u32_u24 v197, 5, v196
    v_fmac_f32 v252, s23, v250
    s_waitcnt vmcnt(16)
    s_waitcnt lgkmcnt(3)
sub10:
    v_mfma_f32_16x16x32_bf16 v[0:3], a[192:195], v[232:235], v[0:3]
    v_fmac_f32 v214, s23, v210
    v_cvt_pk_bf16_f32 v214, v252, v214
    v_mfma_f32_16x16x32_bf16 v[4:7], a[196:199], v[232:235], v[4:7]
    s_waitcnt vmcnt(13) lgkmcnt(1)
    v_fma_f32 v252, v249, s24, v251
    v_fmac_f32 v251, s25, v249
    v_mfma_f32_16x16x32_bf16 v[8:11], a[200:203], v[232:235], v[8:11]
    ds_read_b128 v[232:235], v253 offset:4416
    v_bfe_u32 v197, s45, v197, 5
    v_mfma_f32_16x16x32_bf16 v[0:3], a[204:207], v[236:239], v[0:3]
    buffer_load_dwordx4 a[244:247], v254, s[8:11], s42 offen offset:1024 sc1
    v_mfma_f32_16x16x32_bf16 v[4:7], a[208:211], v[236:239], v[4:7]
    v_fma_f32 v249, v248, s24, v250
    v_fmac_f32 v250, s25, v248
    v_mfma_f32_16x16x32_bf16 v[8:11], a[212:215], v[236:239], v[8:11]
    v_mul_u32_u24 v197, 65, v197
    v_fma_f32 v248, v250, s26, v251
    v_mfma_f32_16x16x32_bf16 v[12:15], a[192:195], v[236:239], v[12:15]
    s_waitcnt lgkmcnt(1)
    v_fmac_f32 v251, s27, v250
    v_fma_f32 v250, v249, s28, v252
    v_fmac_f32 v252, s29, v249
    v_mfma_f32_16x16x32_bf16 v[12:15], a[204:207], v[228:231], v[12:15]
    buffer_load_dwordx4 a[248:251], v254, s[8:11], s42 offen offset:2048 sc1
    v_mfma_f32_16x16x32_bf16 v[16:19], a[208:211], v[228:231], v[16:19]
    v_sub_u32 v197, v197, v196
    v_fma_f32 v249, v208, s24, v212
    v_mfma_f32_16x16x32_bf16 v[16:19], a[196:199], v[236:239], v[16:19]
    s_add_u32 s42, s32, 411648
    v_fmac_f32 v212, s25, v208
    v_fma_f32 v208, v206, s24, v210
    v_mfma_f32_16x16x32_bf16 v[20:23], a[200:203], v[236:239], v[20:23]
    ds_read_b128 v[236:239], v253 offset:4160
    v_lshl_add_u32 v196, v197, 5, v253
    v_mfma_f32_16x16x32_bf16 v[20:23], a[212:215], v[228:231], v[20:23]
    buffer_load_dwordx4 a[252:255], v254, s[8:11], s42 offen offset:0 sc1
    s_waitcnt vmcnt(13)
    v_mfma_f32_16x16x32_bf16 v[0:3], a[216:219], v[228:231], v[0:3]
    v_fmac_f32 v210, s25, v206
    v_fma_f32 v206, v210, s26, v212
    v_mfma_f32_16x16x32_bf16 v[4:7], a[220:223], v[228:231], v[4:7]
    v_fmac_f32 v212, s27, v210
    v_fma_f32 v210, v208, s28, v249
    v_fmac_f32 v249, s29, v208
    v_mfma_f32_16x16x32_bf16 v[8:11], a[224:227], v[228:231], v[8:11]
    s_waitcnt lgkmcnt(1)
    v_cvt_pk_bf16_f32 v206, v248, v206
    v_cvt_pk_bf16_f32 v212, v251, v212
    v_mfma_f32_16x16x32_bf16 v[24:27], a[192:195], v[228:231], v[24:27]
    buffer_load_dwordx4 v[240:243], v254, s[8:11], s42 offen offset:1024 sc1
    v_mfma_f32_16x16x32_bf16 v[24:27], a[204:207], v[232:235], v[24:27]
    s_mov_b64 exec, s[46:47]
    ds_write_b128 v196, v[192:195] offset:1024
    s_mov_b64 exec, -1
    v_mfma_f32_16x16x32_bf16 v[28:31], a[208:211], v[232:235], v[28:31]
    v_cvt_pk_bf16_f32 v210, v250, v210
    v_cvt_pk_bf16_f32 v208, v252, v249
    v_mfma_f32_16x16x32_bf16 v[28:31], a[196:199], v[228:231], v[28:31]
    buffer_load_dwordx4 v[244:247], v254, s[8:11], s42 offen offset:2048 sc1
    v_mfma_f32_16x16x32_bf16 v[32:35], a[200:203], v[228:231], v[32:35]
    ds_read_b128 v[228:231], v253 offset:5984
    v_and_b32 v203, 0x7fff, v255
    v_lshlrev_b32 v248, 16, v207
    v_mfma_f32_16x16x32_bf16 v[32:35], a[212:215], v[232:235], v[32:35]
    v_lshlrev_b32 v249, 16, v209
    v_lshlrev_b32 v250, 16, v211
    v_mfma_f32_16x16x32_bf16 v[12:15], a[216:219], v[232:235], v[12:15]
    buffer_load_dwordx2 v[192:193], v203, s[4:7], s16 offen offset:256
    v_mfma_f32_16x16x32_bf16 v[16:19], a[220:223], v[232:235], v[16:19]
    v_lshlrev_b32 v251, 16, v213
    v_and_b32 v207, s22, v207
    v_mfma_f32_16x16x32_bf16 v[20:23], a[224:227], v[232:235], v[20:23]
    s_waitcnt lgkmcnt(2)
    v_and_b32 v209, s22, v209
    v_and_b32 v211, s22, v211
    v_mfma_f32_16x16x32_bf16 v[36:39], a[192:195], v[232:235], v[36:39]
    buffer_load_dwordx2 v[194:195], v203, s[4:7], s17 offen offset:256
    v_mfma_f32_16x16x32_bf16 v[36:39], a[204:207], v[236:239], v[36:39]
    v_and_b32 v213, s22, v213
    v_lshlrev_b32 v252, 16, v205
    v_mfma_f32_16x16x32_bf16 v[40:43], a[208:211], v[236:239], v[40:43]
    v_and_b32 v205, s22, v205
    v_add_f32 v252, v252, v251
    v_add_f32 v205, v205, v213
    v_mfma_f32_16x16x32_bf16 v[40:43], a[196:199], v[232:235], v[40:43]
    buffer_load_dwordx2 v[196:197], v203, s[4:7], s18 offen offset:256
    v_mfma_f32_16x16x32_bf16 v[44:47], a[200:203], v[232:235], v[44:47]
    ds_read_b128 v[232:235], v253 offset:5728
    v_fmac_f32 v252, s23, v249
    v_mfma_f32_16x16x32_bf16 v[44:47], a[212:215], v[236:239], v[44:47]
    v_fmac_f32 v205, s23, v209
    v_cvt_pk_bf16_f32 v205, v252, v205
    v_mfma_f32_16x16x32_bf16 v[24:27], a[216:219], v[236:239], v[24:27]
    buffer_load_dwordx2 v[198:199], v203, s[4:7], s19 offen offset:256
    v_mfma_f32_16x16x32_bf16 v[28:31], a[220:223], v[236:239], v[28:31]
    v_lshlrev_b32 v252, 16, v215
    v_and_b32 v215, s22, v215
    v_mfma_f32_16x16x32_bf16 v[32:35], a[224:227], v[236:239], v[32:35]
    s_waitcnt lgkmcnt(1)
    v_add_f32 v252, v252, v248
    v_add_f32 v215, v215, v207
    v_mfma_f32_16x16x32_bf16 v[48:51], a[192:195], v[236:239], v[48:51]
    buffer_load_dwordx2 v[200:201], v203, s[4:7], s20 offen offset:256
    v_fmac_f32 v252, s23, v250
    v_mfma_f32_16x16x32_bf16 v[48:51], a[204:207], v[228:231], v[48:51]
    v_fmac_f32 v215, s23, v211
    v_cvt_pk_bf16_f32 v215, v252, v215
    v_mfma_f32_16x16x32_bf16 v[52:55], a[208:211], v[228:231], v[52:55]
    v_fma_f32 v252, v249, s24, v251
    v_fmac_f32 v251, s25, v249
    v_mfma_f32_16x16x32_bf16 v[52:55], a[196:199], v[236:239], v[52:55]
    buffer_load_dwordx2 v[202:203], v203, s[4:7], s21 offen offset:256
    v_mfma_f32_16x16x32_bf16 v[56:59], a[200:203], v[236:239], v[56:59]
    ds_read_b128 v[236:239], v253 offset:5472
    v_fma_f32 v249, v248, s24, v250
    v_mfma_f32_16x16x32_bf16 v[56:59], a[212:215], v[228:231], v[56:59]
    v_fmac_f32 v250, s25, v248
    v_fma_f32 v248, v250, s26, v251
    v_mfma_f32_16x16x32_bf16 v[36:39], a[216:219], v[228:231], v[36:39]
    v_fmac_f32 v251, s27, v250
    v_fma_f32 v250, v249, s28, v252
    v_fmac_f32 v252, s29, v249
    v_mfma_f32_16x16x32_bf16 v[40:43], a[220:223], v[228:231], v[40:43]
    v_fma_f32 v249, v209, s24, v213
    v_fmac_f32 v213, s25, v209
    v_mfma_f32_16x16x32_bf16 v[44:47], a[224:227], v[228:231], v[44:47]
    v_fma_f32 v209, v207, s24, v211
    v_fmac_f32 v211, s25, v207
    v_mfma_f32_16x16x32_bf16 v[60:63], a[192:195], v[228:231], v[60:63]
    s_waitcnt lgkmcnt(1)
    v_fma_f32 v207, v211, s26, v213
    v_fmac_f32 v213, s27, v211
    v_mfma_f32_16x16x32_bf16 v[60:63], a[204:207], v[232:235], v[60:63]
    v_fma_f32 v211, v209, s28, v249
    v_fmac_f32 v249, s29, v209
    v_mfma_f32_16x16x32_bf16 v[64:67], a[208:211], v[232:235], v[64:67]
    v_cvt_pk_bf16_f32 v207, v248, v207
    v_cvt_pk_bf16_f32 v213, v251, v213
    v_mfma_f32_16x16x32_bf16 v[64:67], a[196:199], v[228:231], v[64:67]
    v_cvt_pk_bf16_f32 v211, v250, v211
    v_cvt_pk_bf16_f32 v209, v252, v249
    v_mfma_f32_16x16x32_bf16 v[68:71], a[200:203], v[228:231], v[68:71]
    ds_read_b128 v[228:231], v253 offset:5216
    v_lshrrev_b32 v252, 15, v255
    v_mfma_f32_16x16x32_bf16 v[68:71], a[212:215], v[232:235], v[68:71]
    ds_write_b64 v252, v[206:207] offset:8576
    v_mfma_f32_16x16x32_bf16 v[48:51], a[216:219], v[232:235], v[48:51]
    s_waitcnt vmcnt(15)
    v_lshlrev_b32 v248, 16, v218
    v_lshlrev_b32 v249, 16, v220
    v_mfma_f32_16x16x32_bf16 v[52:55], a[220:223], v[232:235], v[52:55]
    ds_write_b64 v252, v[212:213] offset:10656
    v_mfma_f32_16x16x32_bf16 v[56:59], a[224:227], v[232:235], v[56:59]
    s_waitcnt lgkmcnt(3)
    v_lshlrev_b32 v250, 16, v222
    v_lshlrev_b32 v251, 16, v224
    v_mfma_f32_16x16x32_bf16 v[72:75], a[192:195], v[232:235], v[72:75]
    ds_write_b64 v252, v[210:211] offset:12736
    v_mfma_f32_16x16x32_bf16 v[72:75], a[204:207], v[236:239], v[72:75]
    v_and_b32 v218, s22, v218
    v_and_b32 v220, s22, v220
    v_mfma_f32_16x16x32_bf16 v[76:79], a[208:211], v[236:239], v[76:79]
    ds_write_b64 v252, v[204:205] offset:18976
    v_and_b32 v222, s22, v222
    v_mfma_f32_16x16x32_bf16 v[76:79], a[196:199], v[232:235], v[76:79]
    v_and_b32 v224, s22, v224
    v_mfma_f32_16x16x32_bf16 v[80:83], a[200:203], v[232:235], v[80:83]
    ds_read_b128 v[232:235], v253 offset:4944
    v_mfma_f32_16x16x32_bf16 v[80:83], a[212:215], v[236:239], v[80:83]
    ds_write_b64 v252, v[214:215] offset:27296
    v_mfma_f32_16x16x32_bf16 v[60:63], a[216:219], v[236:239], v[60:63]
    v_mfma_f32_16x16x32_bf16 v[64:67], a[220:223], v[236:239], v[64:67]
    ds_write_b64 v252, v[208:209] offset:31456
    v_mfma_f32_16x16x32_bf16 v[68:71], a[224:227], v[236:239], v[68:71]
    s_add_u32 s42, s32, 442368
    v_mfma_f32_16x16x32_bf16 v[84:87], a[192:195], v[236:239], v[84:87]
    buffer_load_dwordx4 a[192:195], v254, s[8:11], s42 offen offset:0 sc1
    v_mfma_f32_16x16x32_bf16 v[88:91], a[196:199], v[236:239], v[88:91]
    v_lshlrev_b32 v252, 16, v216
    v_and_b32 v216, s22, v216
    v_mfma_f32_16x16x32_bf16 v[92:95], a[200:203], v[236:239], v[92:95]
    s_waitcnt lgkmcnt(7)
    v_add_f32 v252, v252, v251
    v_add_f32 v216, v216, v224
    v_mfma_f32_16x16x32_bf16 v[84:87], a[204:207], v[228:231], v[84:87]
    ds_read_b128 v[236:239], v253 offset:7280
    v_fmac_f32 v252, s23, v249
    v_mfma_f32_16x16x32_bf16 v[88:91], a[208:211], v[228:231], v[88:91]
    buffer_load_dwordx4 a[196:199], v254, s[8:11], s42 offen offset:1024 sc1
    v_mfma_f32_16x16x32_bf16 v[92:95], a[212:215], v[228:231], v[92:95]
    v_fmac_f32 v216, s23, v220
    v_cvt_pk_bf16_f32 v216, v252, v216
    v_mfma_f32_16x16x32_bf16 v[72:75], a[216:219], v[228:231], v[72:75]
    s_waitcnt lgkmcnt(3)
    v_lshlrev_b32 v252, 16, v226
    v_and_b32 v226, s22, v226
    v_mfma_f32_16x16x32_bf16 v[76:79], a[220:223], v[228:231], v[76:79]
    buffer_load_dwordx4 a[200:203], v254, s[8:11], s42 offen offset:2048 sc1
    v_mfma_f32_16x16x32_bf16 v[80:83], a[224:227], v[228:231], v[80:83]
    ds_read_b128 v[228:231], v253 offset:7008
    v_add_f32 v252, v252, v248
    v_mfma_f32_16x16x32_bf16 v[84:87], a[216:219], v[232:235], v[84:87]
    s_add_u32 s42, s32, 445440
    v_add_f32 v226, v226, v218
    v_fmac_f32 v252, s23, v250
    v_mfma_f32_16x16x32_bf16 v[88:91], a[220:223], v[232:235], v[88:91]
    buffer_load_dwordx4 a[204:207], v254, s[8:11], s42 offen offset:0 sc1
    v_mfma_f32_16x16x32_bf16 v[92:95], a[224:227], v[232:235], v[92:95]
    ds_read_b128 v[232:235], v253 offset:6752
    v_fmac_f32 v226, s23, v222
    s_waitcnt vmcnt(16)
    s_waitcnt lgkmcnt(2)
sub11:
    v_mfma_f32_16x16x32_bf16 v[96:99], a[228:231], v[236:239], v[96:99]
    v_cvt_pk_bf16_f32 v226, v252, v226
    v_fma_f32 v252, v249, s24, v251
    v_mfma_f32_16x16x32_bf16 v[100:103], a[232:235], v[236:239], v[100:103]
    s_waitcnt vmcnt(13) lgkmcnt(1)
    v_fmac_f32 v251, s25, v249
    v_fma_f32 v249, v248, s24, v250
    v_mfma_f32_16x16x32_bf16 v[104:107], a[236:239], v[236:239], v[104:107]
    ds_read_b128 v[236:239], v253 offset:6496
    v_fmac_f32 v250, s25, v248
    v_mfma_f32_16x16x32_bf16 v[96:99], a[240:243], v[228:231], v[96:99]
    buffer_load_dwordx4 a[208:211], v254, s[8:11], s42 offen offset:1024 sc1
    v_mfma_f32_16x16x32_bf16 v[100:103], a[244:247], v[228:231], v[100:103]
    v_fma_f32 v248, v250, s26, v251
    v_fmac_f32 v251, s27, v250
    v_mfma_f32_16x16x32_bf16 v[104:107], a[248:251], v[228:231], v[104:107]
    v_fma_f32 v250, v249, s28, v252
    v_fmac_f32 v252, s29, v249
    v_mfma_f32_16x16x32_bf16 v[108:111], a[228:231], v[228:231], v[108:111]
    s_waitcnt lgkmcnt(1)
    v_fma_f32 v249, v220, s24, v224
    v_fmac_f32 v224, s25, v220
    v_mfma_f32_16x16x32_bf16 v[108:111], a[240:243], v[232:235], v[108:111]
    buffer_load_dwordx4 a[212:215], v254, s[8:11], s42 offen offset:2048 sc1
    v_mfma_f32_16x16x32_bf16 v[112:115], a[244:247], v[232:235], v[112:115]
    v_fma_f32 v220, v218, s24, v222
    v_fmac_f32 v222, s25, v218
    v_mfma_f32_16x16x32_bf16 v[112:115], a[232:235], v[228:231], v[112:115]
    s_add_u32 s42, s32, 448512
    v_fma_f32 v218, v222, s26, v224
    v_fmac_f32 v224, s27, v222
    v_mfma_f32_16x16x32_bf16 v[116:119], a[236:239], v[228:231], v[116:119]
    ds_read_b128 v[228:231], v253 offset:6240
    v_fma_f32 v222, v220, s28, v249
    v_mfma_f32_16x16x32_bf16 v[116:119], a[248:251], v[232:235], v[116:119]
    buffer_load_dwordx4 a[216:219], v254, s[8:11], s42 offen offset:0 sc1
    s_waitcnt vmcnt(13)
    v_mfma_f32_16x16x32_bf16 v[96:99], a[252:255], v[232:235], v[96:99]
    v_fmac_f32 v249, s29, v220
    v_cvt_pk_bf16_f32 v218, v248, v218
    v_mfma_f32_16x16x32_bf16 v[100:103], v[240:243], v[232:235], v[100:103]
    v_cvt_pk_bf16_f32 v224, v251, v224
    v_cvt_pk_bf16_f32 v222, v250, v222
    v_mfma_f32_16x16x32_bf16 v[104:107], v[244:247], v[232:235], v[104:107]
    s_waitcnt lgkmcnt(1)
    v_cvt_pk_bf16_f32 v220, v252, v249
    v_lshlrev_b32 v248, 16, v219
    v_mfma_f32_16x16x32_bf16 v[120:123], a[228:231], v[232:235], v[120:123]
    buffer_load_dwordx4 a[220:223], v254, s[8:11], s42 offen offset:1024 sc1
    v_mfma_f32_16x16x32_bf16 v[120:123], a[240:243], v[236:239], v[120:123]
    v_lshlrev_b32 v249, 16, v221
    v_lshlrev_b32 v250, 16, v223
    v_mfma_f32_16x16x32_bf16 v[124:127], a[244:247], v[236:239], v[124:127]
    v_lshlrev_b32 v251, 16, v225
    v_and_b32 v219, s22, v219
    v_mfma_f32_16x16x32_bf16 v[124:127], a[232:235], v[232:235], v[124:127]
    buffer_load_dwordx4 a[224:227], v254, s[8:11], s42 offen offset:2048 sc1
    v_mfma_f32_16x16x32_bf16 v[128:131], a[236:239], v[232:235], v[128:131]
    ds_read_b128 v[232:235], v253 offset:8064
    v_and_b32 v215, 0x7fff, v255
    v_mfma_f32_16x16x32_bf16 v[128:131], a[248:251], v[236:239], v[128:131]
    v_and_b32 v221, s22, v221
    v_and_b32 v223, s22, v223
    v_mfma_f32_16x16x32_bf16 v[108:111], a[252:255], v[236:239], v[108:111]
    buffer_load_dwordx2 v[204:205], v215, s[4:7], s16 offen offset:640
    v_mfma_f32_16x16x32_bf16 v[112:115], v[240:243], v[236:239], v[112:115]
    v_and_b32 v225, s22, v225
    v_lshlrev_b32 v252, 16, v217
    v_mfma_f32_16x16x32_bf16 v[116:119], v[244:247], v[236:239], v[116:119]
    s_waitcnt lgkmcnt(1)
    v_and_b32 v217, s22, v217
    v_add_f32 v252, v252, v251
    v_mfma_f32_16x16x32_bf16 v[132:135], a[228:231], v[236:239], v[132:135]
    buffer_load_dwordx2 v[206:207], v215, s[4:7], s17 offen offset:640
    v_mfma_f32_16x16x32_bf16 v[132:135], a[240:243], v[228:231], v[132:135]
    v_add_f32 v217, v217, v225
    v_fmac_f32 v252, s23, v249
    v_mfma_f32_16x16x32_bf16 v[136:139], a[244:247], v[228:231], v[136:139]
    v_fmac_f32 v217, s23, v221
    v_cvt_pk_bf16_f32 v217, v252, v217
    v_mfma_f32_16x16x32_bf16 v[136:139], a[232:235], v[236:239], v[136:139]
    buffer_load_dwordx2 v[208:209], v215, s[4:7], s18 offen offset:640
    v_mfma_f32_16x16x32_bf16 v[140:143], a[236:239], v[236:239], v[140:143]
    ds_read_b128 v[236:239], v253 offset:7808
    v_lshlrev_b32 v252, 16, v227
    v_mfma_f32_16x16x32_bf16 v[140:143], a[248:251], v[228:231], v[140:143]
    v_and_b32 v227, s22, v227
    v_add_f32 v252, v252, v248
    v_mfma_f32_16x16x32_bf16 v[120:123], a[252:255], v[228:231], v[120:123]
    buffer_load_dwordx2 v[210:211], v215, s[4:7], s19 offen offset:640
    v_mfma_f32_16x16x32_bf16 v[124:127], v[240:243], v[228:231], v[124:127]
    v_add_f32 v227, v227, v219
    v_fmac_f32 v252, s23, v250
    v_mfma_f32_16x16x32_bf16 v[128:131], v[244:247], v[228:231], v[128:131]
pad4:
    s_cbranch_vccnz pad8
    s_waitcnt lgkmcnt(1)
    v_fmac_f32 v227, s23, v223
    v_cvt_pk_bf16_f32 v227, v252, v227
    v_mfma_f32_16x16x32_bf16 v[144:147], a[228:231], v[228:231], v[144:147]
    buffer_load_dwordx2 v[212:213], v215, s[4:7], s20 offen offset:640
    v_mfma_f32_16x16x32_bf16 v[144:147], a[240:243], v[232:235], v[144:147]
    v_fma_f32 v252, v249, s24, v251
    v_fmac_f32 v251, s25, v249
    v_mfma_f32_16x16x32_bf16 v[148:151], a[244:247], v[232:235], v[148:151]
    v_fma_f32 v249, v248, s24, v250
    v_fmac_f32 v250, s25, v248
    v_mfma_f32_16x16x32_bf16 v[148:151], a[232:235], v[228:231], v[148:151]
    buffer_load_dwordx2 v[214:215], v215, s[4:7], s21 offen offset:640
    v_mfma_f32_16x16x32_bf16 v[152:155], a[236:239], v[228:231], v[152:155]
    ds_read_b128 v[228:231], v253 offset:7552
    v_fma_f32 v248, v250, s26, v251
    v_mfma_f32_16x16x32_bf16 v[152:155], a[248:251], v[232:235], v[152:155]
    v_fmac_f32 v251, s27, v250
    v_fma_f32 v250, v249, s28, v252
    v_mfma_f32_16x16x32_bf16 v[132:135], a[252:255], v[232:235], v[132:135]
    v_fmac_f32 v252, s29, v249
    v_fma_f32 v249, v221, s24, v225
    v_mfma_f32_16x16x32_bf16 v[136:139], v[240:243], v[232:235], v[136:139]
    v_fmac_f32 v225, s25, v221
    v_fma_f32 v221, v219, s24, v223
    v_mfma_f32_16x16x32_bf16 v[140:143], v[244:247], v[232:235], v[140:143]
    v_fmac_f32 v223, s25, v219
    v_fma_f32 v219, v223, s26, v225
    v_mfma_f32_16x16x32_bf16 v[156:159], a[228:231], v[232:235], v[156:159]
    s_waitcnt lgkmcnt(1)
    v_fmac_f32 v225, s27, v223
    v_fma_f32 v223, v221, s28, v249
    v_mfma_f32_16x16x32_bf16 v[156:159], a[240:243], v[236:239], v[156:159]
    v_fmac_f32 v249, s29, v221
    v_cvt_pk_bf16_f32 v219, v248, v219
    v_mfma_f32_16x16x32_bf16 v[160:163], a[244:247], v[236:239], v[160:163]
    v_cvt_pk_bf16_f32 v225, v251, v225
    v_cvt_pk_bf16_f32 v223, v250, v223
    v_mfma_f32_16x16x32_bf16 v[160:163], a[232:235], v[232:235], v[160:163]
    v_cvt_pk_bf16_f32 v221, v252, v249
    v_lshrrev_b32 v252, 15, v255
    v_mfma_f32_16x16x32_bf16 v[164:167], a[236:239], v[232:235], v[164:167]
    ds_read_b128 v[232:235], v253 offset:7296
    v_mfma_f32_16x16x32_bf16 v[164:167], a[248:251], v[236:239], v[164:167]
    ds_write_b64 v252, v[218:219] offset:8320
    v_mfma_f32_16x16x32_bf16 v[144:147], a[252:255], v[236:239], v[144:147]
    s_waitcnt vmcnt(15)
    v_lshlrev_b32 v248, 16, v194
    v_lshlrev_b32 v249, 16, v196
    v_mfma_f32_16x16x32_bf16 v[148:151], v[240:243], v[236:239], v[148:151]
    ds_write_b64 v252, v[224:225] offset:10400
    v_mfma_f32_16x16x32_bf16 v[152:155], v[244:247], v[236:239], v[152:155]
    s_waitcnt lgkmcnt(3)
    v_lshlrev_b32 v250, 16, v198
    v_lshlrev_b32 v251, 16, v200
    v_mfma_f32_16x16x32_bf16 v[168:171], a[228:231], v[236:239], v[168:171]
    ds_write_b64 v252, v[222:223] offset:12480
    v_mfma_f32_16x16x32_bf16 v[168:171], a[240:243], v[228:231], v[168:171]
    v_and_b32 v194, s22, v194
    v_and_b32 v196, s22, v196
    v_mfma_f32_16x16x32_bf16 v[172:175], a[244:247], v[228:231], v[172:175]
    ds_write_b64 v252, v[216:217] offset:18720
    v_mfma_f32_16x16x32_bf16 v[172:175], a[232:235], v[236:239], v[172:175]
    v_and_b32 v198, s22, v198
    v_and_b32 v200, s22, v200
    v_mfma_f32_16x16x32_bf16 v[176:179], a[236:239], v[236:239], v[176:179]
    ds_read_b128 v[236:239], v253 offset:7024
    v_mfma_f32_16x16x32_bf16 v[176:179], a[248:251], v[228:231], v[176:179]
    ds_write_b64 v252, v[226:227] offset:27040
    v_mfma_f32_16x16x32_bf16 v[156:159], a[252:255], v[228:231], v[156:159]
    s_waitcnt lgkmcnt(6)
    v_mfma_f32_16x16x32_bf16 v[160:163], v[240:243], v[228:231], v[160:163]
    ds_write_b64 v252, v[220:221] offset:31200
    v_mfma_f32_16x16x32_bf16 v[164:167], v[244:247], v[228:231], v[164:167]
    s_add_u32 s42, s32, 479232
    v_mfma_f32_16x16x32_bf16 v[180:183], a[228:231], v[228:231], v[180:183]
    buffer_load_dwordx4 a[228:231], v254, s[8:11], s42 offen offset:0 sc1
    v_mfma_f32_16x16x32_bf16 v[184:187], a[232:235], v[228:231], v[184:187]
    s_waitcnt lgkmcnt(0)
    v_lshlrev_b32 v252, 16, v192
    v_and_b32 v192, s22, v192
    v_mfma_f32_16x16x32_bf16 v[188:191], a[236:239], v[228:231], v[188:191]
    s_barrier
    v_mfma_f32_16x16x32_bf16 v[180:183], a[240:243], v[232:235], v[180:183]
    ds_read_b128 v[228:231], v253 offset:9360
    v_add_f32 v252, v252, v251
    v_mfma_f32_16x16x32_bf16 v[184:187], a[244:247], v[232:235], v[184:187]
    buffer_load_dwordx4 a[232:235], v254, s[8:11], s42 offen offset:1024 sc1
    v_mfma_f32_16x16x32_bf16 v[188:191], a[248:251], v[232:235], v[188:191]
    v_add_f32 v192, v192, v200
    v_fmac_f32 v252, s23, v249
    v_mfma_f32_16x16x32_bf16 v[168:171], a[252:255], v[232:235], v[168:171]
    v_fmac_f32 v192, s23, v196
    v_cvt_pk_bf16_f32 v192, v252, v192
    v_mfma_f32_16x16x32_bf16 v[172:175], v[240:243], v[232:235], v[172:175]
    buffer_load_dwordx4 a[236:239], v254, s[8:11], s42 offen offset:2048 sc1
    v_lshlrev_b32 v252, 16, v202
    v_mfma_f32_16x16x32_bf16 v[176:179], v[244:247], v[232:235], v[176:179]
    ds_read_b128 v[232:235], v253 offset:9088
    v_and_b32 v202, s22, v202
    v_mfma_f32_16x16x32_bf16 v[180:183], a[252:255], v[236:239], v[180:183]
    s_add_u32 s42, s32, 482304
    v_add_f32 v252, v252, v248
    v_add_f32 v202, v202, v194
    v_mfma_f32_16x16x32_bf16 v[184:187], v[240:243], v[236:239], v[184:187]
    buffer_load_dwordx4 a[240:243], v254, s[8:11], s42 offen offset:0 sc1
    v_mfma_f32_16x16x32_bf16 v[188:191], v[244:247], v[236:239], v[188:191]
    ds_read_b128 v[236:239], v253 offset:8832
    v_fmac_f32 v252, s23, v250
    s_waitcnt vmcnt(16)
    s_waitcnt lgkmcnt(2)
sub12:
    v_mfma_f32_16x16x32_bf16 a[0:3], a[192:195], v[228:231], a[0:3]
    v_fmac_f32 v202, s23, v198
    v_cvt_pk_bf16_f32 v202, v252, v202
    v_mfma_f32_16x16x32_bf16 a[4:7], a[196:199], v[228:231], a[4:7]
    s_waitcnt vmcnt(13) lgkmcnt(1)
    v_fma_f32 v252, v249, s24, v251
    v_fmac_f32 v251, s25, v249
    v_mfma_f32_16x16x32_bf16 a[8:11], a[200:203], v[228:231], a[8:11]
    ds_read_b128 v[228:231], v253 offset:8576
    v_fma_f32 v249, v248, s24, v250
    v_mfma_f32_16x16x32_bf16 a[0:3], a[204:207], v[232:235], a[0:3]
    buffer_load_dwordx4 a[244:247], v254, s[8:11], s42 offen offset:1024 sc1
    v_mfma_f32_16x16x32_bf16 a[4:7], a[208:211], v[232:235], a[4:7]
    v_fmac_f32 v250, s25, v248
    v_fma_f32 v248, v250, s26, v251
    v_mfma_f32_16x16x32_bf16 a[8:11], a[212:215], v[232:235], a[8:11]
    v_fmac_f32 v251, s27, v250
    v_fma_f32 v250, v249, s28, v252
    v_mfma_f32_16x16x32_bf16 a[12:15], a[192:195], v[232:235], a[12:15]
    s_waitcnt lgkmcnt(1)
    v_fmac_f32 v252, s29, v249
    v_fma_f32 v249, v196, s24, v200
    v_mfma_f32_16x16x32_bf16 a[12:15], a[204:207], v[236:239], a[12:15]
    buffer_load_dwordx4 a[248:251], v254, s[8:11], s42 offen offset:2048 sc1
    v_mfma_f32_16x16x32_bf16 a[16:19], a[208:211], v[236:239], a[16:19]
    v_fmac_f32 v200, s25, v196
    v_fma_f32 v196, v194, s24, v198
    v_mfma_f32_16x16x32_bf16 a[16:19], a[196:199], v[232:235], a[16:19]
    s_add_u32 s42, s32, 485376
    v_fmac_f32 v198, s25, v194
    v_fma_f32 v194, v198, s26, v200
    v_mfma_f32_16x16x32_bf16 a[20:23], a[200:203], v[232:235], a[20:23]
    ds_read_b128 v[232:235], v253 offset:8320
    v_fmac_f32 v200, s27, v198
    v_mfma_f32_16x16x32_bf16 a[20:23], a[212:215], v[236:239], a[20:23]
    buffer_load_dwordx4 a[252:255], v254, s[8:11], s42 offen offset:0 sc1
    s_waitcnt vmcnt(13)
    v_mfma_f32_16x16x32_bf16 a[0:3], a[216:219], v[236:239], a[0:3]
    v_fma_f32 v198, v196, s28, v249
    v_fmac_f32 v249, s29, v196
    v_mfma_f32_16x16x32_bf16 a[4:7], a[220:223], v[236:239], a[4:7]
    v_cvt_pk_bf16_f32 v194, v248, v194
    v_cvt_pk_bf16_f32 v200, v251, v200
    v_mfma_f32_16x16x32_bf16 a[8:11], a[224:227], v[236:239], a[8:11]
    s_waitcnt lgkmcnt(1)
    v_cvt_pk_bf16_f32 v198, v250, v198
    v_cvt_pk_bf16_f32 v196, v252, v249
    v_mfma_f32_16x16x32_bf16 a[24:27], a[192:195], v[236:239], a[24:27]
    buffer_load_dwordx4 v[240:243], v254, s[8:11], s42 offen offset:1024 sc1
    v_lshlrev_b32 v248, 16, v195
    v_mfma_f32_16x16x32_bf16 a[24:27], a[204:207], v[228:231], a[24:27]
    v_lshlrev_b32 v249, 16, v197
    v_lshlrev_b32 v250, 16, v199
    v_mfma_f32_16x16x32_bf16 a[28:31], a[208:211], v[228:231], a[28:31]
    v_lshlrev_b32 v251, 16, v201
    v_and_b32 v195, s22, v195
    v_mfma_f32_16x16x32_bf16 a[28:31], a[196:199], v[236:239], a[28:31]
    buffer_load_dwordx4 v[244:247], v254, s[8:11], s42 offen offset:2048 sc1
    v_mfma_f32_16x16x32_bf16 a[32:35], a[200:203], v[236:239], a[32:35]
    ds_read_b128 v[236:239], v253 offset:10144
    v_and_b32 v227, 0x7fff, v255
    v_mfma_f32_16x16x32_bf16 a[32:35], a[212:215], v[228:231], a[32:35]
    v_and_b32 v197, s22, v197
    v_and_b32 v199, s22, v199
    v_mfma_f32_16x16x32_bf16 a[12:15], a[216:219], v[228:231], a[12:15]
    buffer_load_dwordx2 v[216:217], v227, s[4:7], s16 offen offset:1024
    v_mfma_f32_16x16x32_bf16 a[16:19], a[220:223], v[228:231], a[16:19]
    v_and_b32 v201, s22, v201
    v_lshlrev_b32 v252, 16, v193
    v_mfma_f32_16x16x32_bf16 a[20:23], a[224:227], v[228:231], a[20:23]
    s_waitcnt lgkmcnt(1)
    v_and_b32 v193, s22, v193
    v_add_f32 v252, v252, v251
    v_mfma_f32_16x16x32_bf16 a[36:39], a[192:195], v[228:231], a[36:39]
    buffer_load_dwordx2 v[218:219], v227, s[4:7], s17 offen offset:1024
    v_mfma_f32_16x16x32_bf16 a[36:39], a[204:207], v[232:235], a[36:39]
    v_add_f32 v193, v193, v201
    v_fmac_f32 v252, s23, v249
    v_mfma_f32_16x16x32_bf16 a[40:43], a[208:211], v[232:235], a[40:43]
    v_fmac_f32 v193, s23, v197
    v_cvt_pk_bf16_f32 v193, v252, v193
    v_mfma_f32_16x16x32_bf16 a[40:43], a[196:199], v[228:231], a[40:43]
    buffer_load_dwordx2 v[220:221], v227, s[4:7], s18 offen offset:1024
    v_mfma_f32_16x16x32_bf16 a[44:47], a[200:203], v[228:231], a[44:47]
    ds_read_b128 v[228:231], v253 offset:9888
    v_lshlrev_b32 v252, 16, v203
    v_mfma_f32_16x16x32_bf16 a[44:47], a[212:215], v[232:235], a[44:47]
    v_and_b32 v203, s22, v203
    v_add_f32 v252, v252, v248
    v_mfma_f32_16x16x32_bf16 a[24:27], a[216:219], v[232:235], a[24:27]
    buffer_load_dwordx2 v[222:223], v227, s[4:7], s19 offen offset:1024
    v_mfma_f32_16x16x32_bf16 a[28:31], a[220:223], v[232:235], a[28:31]
    v_add_f32 v203, v203, v195
    v_fmac_f32 v252, s23, v250
    v_mfma_f32_16x16x32_bf16 a[32:35], a[224:227], v[232:235], a[32:35]
    s_waitcnt lgkmcnt(1)
    v_fmac_f32 v203, s23, v199
    v_cvt_pk_bf16_f32 v203, v252, v203
    v_mfma_f32_16x16x32_bf16 a[48:51], a[192:195], v[232:235], a[48:51]
    buffer_load_dwordx2 v[224:225], v227, s[4:7], s20 offen offset:1024
    v_mfma_f32_16x16x32_bf16 a[48:51], a[204:207], v[236:239], a[48:51]
    v_fma_f32 v252, v249, s24, v251
    v_fmac_f32 v251, s25, v249
    v_mfma_f32_16x16x32_bf16 a[52:55], a[208:211], v[236:239], a[52:55]
    v_fma_f32 v249, v248, s24, v250
    v_fmac_f32 v250, s25, v248
    v_fma_f32 v248, v250, s26, v251
    v_mfma_f32_16x16x32_bf16 a[52:55], a[196:199], v[232:235], a[52:55]
    buffer_load_dwordx2 v[226:227], v227, s[4:7], s21 offen offset:1024
    v_mfma_f32_16x16x32_bf16 a[56:59], a[200:203], v[232:235], a[56:59]
    ds_read_b128 v[232:235], v253 offset:9632
    v_fmac_f32 v251, s27, v250
    v_mfma_f32_16x16x32_bf16 a[56:59], a[212:215], v[236:239], a[56:59]
    v_fma_f32 v250, v249, s28, v252
    v_fmac_f32 v252, s29, v249
    v_mfma_f32_16x16x32_bf16 a[36:39], a[216:219], v[236:239], a[36:39]
    v_fma_f32 v249, v197, s24, v201
    v_fmac_f32 v201, s25, v197
    v_mfma_f32_16x16x32_bf16 a[40:43], a[220:223], v[236:239], a[40:43]
    v_fma_f32 v197, v195, s24, v199
    v_fmac_f32 v199, s25, v195
    v_mfma_f32_16x16x32_bf16 a[44:47], a[224:227], v[236:239], a[44:47]
    v_fma_f32 v195, v199, s26, v201
    v_fmac_f32 v201, s27, v199
    v_mfma_f32_16x16x32_bf16 a[60:63], a[192:195], v[236:239], a[60:63]
    s_waitcnt lgkmcnt(1)
    v_fma_f32 v199, v197, s28, v249
    v_fmac_f32 v249, s29, v197
    v_mfma_f32_16x16x32_bf16 a[60:63], a[204:207], v[228:231], a[60:63]
    v_cvt_pk_bf16_f32 v195, v248, v195
    v_cvt_pk_bf16_f32 v201, v251, v201
    v_mfma_f32_16x16x32_bf16 a[64:67], a[208:211], v[228:231], a[64:67]
    v_cvt_pk_bf16_f32 v199, v250, v199
    v_cvt_pk_bf16_f32 v197, v252, v249
    v_mfma_f32_16x16x32_bf16 a[64:67], a[196:199], v[236:239], a[64:67]
    v_lshrrev_b32 v252, 15, v255
    v_mfma_f32_16x16x32_bf16 a[68:71], a[200:203], v[236:239], a[68:71]
    ds_read_b128 v[236:239], v253 offset:9376
    v_mfma_f32_16x16x32_bf16 a[68:71], a[212:215], v[228:231], a[68:71]
    ds_write_b64 v252, v[194:195] offset:768
    v_mfma_f32_16x16x32_bf16 a[48:51], a[216:219], v[228:231], a[48:51]
    s_waitcnt vmcnt(15)
    v_lshlrev_b32 v248, 16, v206
    v_lshlrev_b32 v249, 16, v208
    v_mfma_f32_16x16x32_bf16 a[52:55], a[220:223], v[228:231], a[52:55]
    ds_write_b64 v252, v[200:201] offset:2848
    v_mfma_f32_16x16x32_bf16 a[56:59], a[224:227], v[228:231], a[56:59]
    s_waitcnt lgkmcnt(3)
    v_lshlrev_b32 v250, 16, v210
    v_lshlrev_b32 v251, 16, v212
    v_mfma_f32_16x16x32_bf16 a[72:75], a[192:195], v[228:231], a[72:75]
    ds_write_b64 v252, v[198:199] offset:4928
    v_mfma_f32_16x16x32_bf16 a[72:75], a[204:207], v[232:235], a[72:75]
    v_and_b32 v206, s22, v206
    v_and_b32 v208, s22, v208
    v_mfma_f32_16x16x32_bf16 a[76:79], a[208:211], v[232:235], a[76:79]
    ds_write_b64 v252, v[192:193] offset:21568
    v_mfma_f32_16x16x32_bf16 a[76:79], a[196:199], v[228:231], a[76:79]
    v_and_b32 v210, s22, v210
    v_and_b32 v212, s22, v212
    v_mfma_f32_16x16x32_bf16 a[80:83], a[200:203], v[228:231], a[80:83]
    ds_read_b128 v[228:231], v253 offset:9104
    v_mfma_f32_16x16x32_bf16 a[80:83], a[212:215], v[232:235], a[80:83]
    ds_write_b64 v252, v[202:203] offset:29888
    v_mfma_f32_16x16x32_bf16 a[60:63], a[216:219], v[232:235], a[60:63]
    v_mfma_f32_16x16x32_bf16 a[64:67], a[220:223], v[232:235], a[64:67]
    ds_write_b64 v252, v[196:197] offset:7008
    v_mfma_f32_16x16x32_bf16 a[68:71], a[224:227], v[232:235], a[68:71]
    s_add_u32 s42, s32, 516096
    v_mfma_f32_16x16x32_bf16 a[84:87], a[192:195], v[232:235], a[84:87]
    buffer_load_dwordx4 a[192:195], v254, s[8:11], s42 offen offset:0 sc1
    v_mfma_f32_16x16x32_bf16 a[88:91], a[196:199], v[232:235], a[88:91]
    v_lshlrev_b32 v252, 16, v204
    v_and_b32 v204, s22, v204
    v_mfma_f32_16x16x32_bf16 a[92:95], a[200:203], v[232:235], a[92:95]
    s_waitcnt lgkmcnt(7)
    v_add_f32 v252, v252, v251
    v_add_f32 v204, v204, v212
    v_mfma_f32_16x16x32_bf16 a[84:87], a[204:207], v[236:239], a[84:87]
    ds_read_b128 v[232:235], v253 offset:11440
    v_fmac_f32 v252, s23, v249
    v_mfma_f32_16x16x32_bf16 a[88:91], a[208:211], v[236:239], a[88:91]
    buffer_load_dwordx4 a[196:199], v254, s[8:11], s42 offen offset:1024 sc1
    v_mfma_f32_16x16x32_bf16 a[92:95], a[212:215], v[236:239], a[92:95]
    v_fmac_f32 v204, s23, v208
    v_cvt_pk_bf16_f32 v204, v252, v204
    v_mfma_f32_16x16x32_bf16 a[72:75], a[216:219], v[236:239], a[72:75]
    s_waitcnt lgkmcnt(3)
    v_lshlrev_b32 v252, 16, v214
    v_and_b32 v214, s22, v214
    v_mfma_f32_16x16x32_bf16 a[76:79], a[220:223], v[236:239], a[76:79]
    buffer_load_dwordx4 a[200:203], v254, s[8:11], s42 offen offset:2048 sc1
    v_mfma_f32_16x16x32_bf16 a[80:83], a[224:227], v[236:239], a[80:83]
    ds_read_b128 v[236:239], v253 offset:11168
    v_add_f32 v252, v252, v248
    v_mfma_f32_16x16x32_bf16 a[84:87], a[216:219], v[228:231], a[84:87]
    s_add_u32 s42, s32, 519168
    v_add_f32 v214, v214, v206
    v_fmac_f32 v252, s23, v250
    v_mfma_f32_16x16x32_bf16 a[88:91], a[220:223], v[228:231], a[88:91]
    buffer_load_dwordx4 a[204:207], v254, s[8:11], s42 offen offset:0 sc1
    v_mfma_f32_16x16x32_bf16 a[92:95], a[224:227], v[228:231], a[92:95]
    ds_read_b128 v[228:231], v253 offset:10912
    v_fmac_f32 v214, s23, v210
    s_waitcnt vmcnt(16)
    s_waitcnt lgkmcnt(2)
sub13:
    v_mfma_f32_16x16x32_bf16 a[96:99], a[228:231], v[232:235], a[96:99]
    v_cvt_pk_bf16_f32 v214, v252, v214
    v_fma_f32 v252, v249, s24, v251
    v_mfma_f32_16x16x32_bf16 a[100:103], a[232:235], v[232:235], a[100:103]
    s_waitcnt vmcnt(13) lgkmcnt(1)
    v_fmac_f32 v251, s25, v249
    v_fma_f32 v249, v248, s24, v250
    v_mfma_f32_16x16x32_bf16 a[104:107], a[236:239], v[232:235], a[104:107]
    ds_read_b128 v[232:235], v253 offset:10656
    v_fmac_f32 v250, s25, v248
    v_mfma_f32_16x16x32_bf16 a[96:99], a[240:243], v[236:239], a[96:99]
    buffer_load_dwordx4 a[208:211], v254, s[8:11], s42 offen offset:1024 sc1
    v_mfma_f32_16x16x32_bf16 a[100:103], a[244:247], v[236:239], a[100:103]
    v_fma_f32 v248, v250, s26, v251
    v_fmac_f32 v251, s27, v250
    v_mfma_f32_16x16x32_bf16 a[104:107], a[248:251], v[236:239], a[104:107]
    v_fma_f32 v250, v249, s28, v252
    v_fmac_f32 v252, s29, v249
    v_mfma_f32_16x16x32_bf16 a[108:111], a[228:231], v[236:239], a[108:111]
    s_waitcnt lgkmcnt(1)
    v_fma_f32 v249, v208, s24, v212
    v_fmac_f32 v212, s25, v208
    v_mfma_f32_16x16x32_bf16 a[108:111], a[240:243], v[228:231], a[108:111]
    buffer_load_dwordx4 a[212:215], v254, s[8:11], s42 offen offset:2048 sc1
    v_mfma_f32_16x16x32_bf16 a[112:115], a[244:247], v[228:231], a[112:115]
    v_fma_f32 v208, v206, s24, v210
    v_fmac_f32 v210, s25, v206
    v_mfma_f32_16x16x32_bf16 a[112:115], a[232:235], v[236:239], a[112:115]
    s_add_u32 s42, s32, 522240
    v_fma_f32 v206, v210, s26, v212
    v_fmac_f32 v212, s27, v210
    v_mfma_f32_16x16x32_bf16 a[116:119], a[236:239], v[236:239], a[116:119]
    ds_read_b128 v[236:239], v253 offset:10400
    v_fma_f32 v210, v208, s28, v249
    v_mfma_f32_16x16x32_bf16 a[116:119], a[248:251], v[228:231], a[116:119]
    buffer_load_dwordx4 a[216:219], v254, s[8:11], s42 offen offset:0 sc1
    s_waitcnt vmcnt(13)
    v_mfma_f32_16x16x32_bf16 a[96:99], a[252:255], v[228:231], a[96:99]
    v_fmac_f32 v249, s29, v208
    v_cvt_pk_bf16_f32 v206, v248, v206
    v_mfma_f32_16x16x32_bf16 a[100:103], v[240:243], v[228:231], a[100:103]
    v_cvt_pk_bf16_f32 v212, v251, v212
    v_cvt_pk_bf16_f32 v210, v250, v210
    v_mfma_f32_16x16x32_bf16 a[104:107], v[244:247], v[228:231], a[104:107]
    s_waitcnt lgkmcnt(1)
    v_cvt_pk_bf16_f32 v208, v252, v249
    v_lshlrev_b32 v248, 16, v207
    v_mfma_f32_16x16x32_bf16 a[120:123], a[228:231], v[228:231], a[120:123]
    buffer_load_dwordx4 a[220:223], v254, s[8:11], s42 offen offset:1024 sc1
    v_mfma_f32_16x16x32_bf16 a[120:123], a[240:243], v[232:235], a[120:123]
    v_lshlrev_b32 v249, 16, v209
    v_lshlrev_b32 v250, 16, v211
    v_mfma_f32_16x16x32_bf16 a[124:127], a[244:247], v[232:235], a[124:127]
    v_lshlrev_b32 v251, 16, v213
    v_and_b32 v207, s22, v207
    v_mfma_f32_16x16x32_bf16 a[124:127], a[232:235], v[228:231], a[124:127]
    buffer_load_dwordx4 a[224:227], v254, s[8:11], s42 offen offset:2048 sc1
    v_mfma_f32_16x16x32_bf16 a[128:131], a[236:239], v[228:231], a[128:131]
    ds_read_b128 v[228:231], v253 offset:12224
    v_and_b32 v203, 0x7fff, v255
    v_mfma_f32_16x16x32_bf16 a[128:131], a[248:251], v[232:235], a[128:131]
    v_and_b32 v209, s22, v209
    v_and_b32 v211, s22, v211
    v_mfma_f32_16x16x32_bf16 a[108:111], a[252:255], v[232:235], a[108:111]
    buffer_load_dwordx2 v[192:193], v203, s[4:7], s16 offen offset:1408
    v_mfma_f32_16x16x32_bf16 a[112:115], v[240:243], v[232:235], a[112:115]
    v_and_b32 v213, s22, v213
    v_lshlrev_b32 v252, 16, v205
    v_mfma_f32_16x16x32_bf16 a[116:119], v[244:247], v[232:235], a[116:119]
    s_waitcnt lgkmcnt(1)
    v_and_b32 v205, s22, v205
    v_add_f32 v252, v252, v251
    v_mfma_f32_16x16x32_bf16 a[132:135], a[228:231], v[232:235], a[132:135]
    buffer_load_dwordx2 v[194:195], v203, s[4:7], s17 offen offset:1408
    v_mfma_f32_16x16x32_bf16 a[132:135], a[240:243], v[236:239], a[132:135]
    v_add_f32 v205, v205, v213
    v_fmac_f32 v252, s23, v249
    v_mfma_f32_16x16x32_bf16 a[136:139], a[244:247], v[236:239], a[136:139]
    v_fmac_f32 v205, s23, v209
    v_cvt_pk_bf16_f32 v205, v252, v205
    v_mfma_f32_16x16x32_bf16 a[136:139], a[232:235], v[232:235], a[136:139]
    buffer_load_dwordx2 v[196:197], v203, s[4:7], s18 offen offset:1408
    v_mfma_f32_16x16x32_bf16 a[140:143], a[236:239], v[232:235], a[140:143]
    ds_read_b128 v[232:235], v253 offset:11968
    v_lshlrev_b32 v252, 16, v215
    v_mfma_f32_16x16x32_bf16 a[140:143], a[248:251], v[236:239], a[140:143]
    v_and_b32 v215, s22, v215
    v_add_f32 v252, v252, v248
    v_mfma_f32_16x16x32_bf16 a[120:123], a[252:255], v[236:239], a[120:123]
    buffer_load_dwordx2 v[198:199], v203, s[4:7], s19 offen offset:1408
    v_mfma_f32_16x16x32_bf16 a[124:127], v[240:243], v[236:239], a[124:127]
    v_add_f32 v215, v215, v207
    v_fmac_f32 v252, s23, v250
    v_mfma_f32_16x16x32_bf16 a[128:131], v[244:247], v[236:239], a[128:131]
    s_waitcnt lgkmcnt(1)
    v_fmac_f32 v215, s23, v211
    v_cvt_pk_bf16_f32 v215, v252, v215
    v_mfma_f32_16x16x32_bf16 a[144:147], a[228:231], v[236:239], a[144:147]
    buffer_load_dwordx2 v[200:201], v203, s[4:7], s20 offen offset:1408
    v_mfma_f32_16x16x32_bf16 a[144:147], a[240:243], v[228:231], a[144:147]
    v_fma_f32 v252, v249, s24, v251
    v_fmac_f32 v251, s25, v249
    v_mfma_f32_16x16x32_bf16 a[148:151], a[244:247], v[228:231], a[148:151]
    v_fma_f32 v249, v248, s24, v250
    v_fmac_f32 v250, s25, v248
    v_mfma_f32_16x16x32_bf16 a[148:151], a[232:235], v[236:239], a[148:151]
    buffer_load_dwordx2 v[202:203], v203, s[4:7], s21 offen offset:1408
    v_mfma_f32_16x16x32_bf16 a[152:155], a[236:239], v[236:239], a[152:155]
    ds_read_b128 v[236:239], v253 offset:11712
    v_fma_f32 v248, v250, s26, v251
    v_mfma_f32_16x16x32_bf16 a[152:155], a[248:251], v[228:231], a[152:155]
    v_fmac_f32 v251, s27, v250
    v_fma_f32 v250, v249, s28, v252
    v_mfma_f32_16x16x32_bf16 a[132:135], a[252:255], v[228:231], a[132:135]
    v_fmac_f32 v252, s29, v249
    v_fma_f32 v249, v209, s24, v213
    v_mfma_f32_16x16x32_bf16 a[136:139], v[240:243], v[228:231], a[136:139]
    v_fmac_f32 v213, s25, v209
    v_fma_f32 v209, v207, s24, v211
    v_mfma_f32_16x16x32_bf16 a[140:143], v[244:247], v[228:231], a[140:143]
    v_fmac_f32 v211, s25, v207
    v_fma_f32 v207, v211, s26, v213
    v_mfma_f32_16x16x32_bf16 a[156:159], a[228:231], v[228:231], a[156:159]
    s_waitcnt lgkmcnt(1)
    v_fmac_f32 v213, s27, v211
    v_fma_f32 v211, v209, s28, v249
    v_mfma_f32_16x16x32_bf16 a[156:159], a[240:243], v[232:235], a[156:159]
    v_fmac_f32 v249, s29, v209
    v_cvt_pk_bf16_f32 v207, v248, v207
    v_mfma_f32_16x16x32_bf16 a[160:163], a[244:247], v[232:235], a[160:163]
    v_cvt_pk_bf16_f32 v213, v251, v213
    v_cvt_pk_bf16_f32 v211, v250, v211
    v_mfma_f32_16x16x32_bf16 a[160:163], a[232:235], v[228:231], a[160:163]
    v_cvt_pk_bf16_f32 v209, v252, v249
    v_lshrrev_b32 v252, 15, v255
    v_mfma_f32_16x16x32_bf16 a[164:167], a[236:239], v[228:231], a[164:167]
    ds_read_b128 v[228:231], v253 offset:11456
    v_mfma_f32_16x16x32_bf16 a[164:167], a[248:251], v[232:235], a[164:167]
    ds_write_b64 v252, v[206:207] offset:512
    v_mfma_f32_16x16x32_bf16 a[144:147], a[252:255], v[232:235], a[144:147]
    s_waitcnt vmcnt(15)
    v_lshlrev_b32 v248, 16, v218
    v_lshlrev_b32 v249, 16, v220
    v_mfma_f32_16x16x32_bf16 a[148:151], v[240:243], v[232:235], a[148:151]
    ds_write_b64 v252, v[212:213] offset:2592
    v_mfma_f32_16x16x32_bf16 a[152:155], v[244:247], v[232:235], a[152:155]
    s_waitcnt lgkmcnt(3)
    v_lshlrev_b32 v250, 16, v222
    v_lshlrev_b32 v251, 16, v224
    v_mfma_f32_16x16x32_bf16 a[168:171], a[228:231], v[232:235], a[168:171]
    ds_write_b64 v252, v[210:211] offset:4672
    v_mfma_f32_16x16x32_bf16 a[168:171], a[240:243], v[236:239], a[168:171]
    v_and_b32 v218, s22, v218
    v_and_b32 v220, s22, v220
    v_mfma_f32_16x16x32_bf16 a[172:175], a[244:247], v[236:239], a[172:175]
    ds_write_b64 v252, v[204:205] offset:21312
    v_mfma_f32_16x16x32_bf16 a[172:175], a[232:235], v[232:235], a[172:175]
    v_and_b32 v222, s22, v222
    v_and_b32 v224, s22, v224
    v_mfma_f32_16x16x32_bf16 a[176:179], a[236:239], v[232:235], a[176:179]
    ds_read_b128 v[232:235], v253 offset:11184
    v_mfma_f32_16x16x32_bf16 a[176:179], a[248:251], v[236:239], a[176:179]
    ds_write_b64 v252, v[214:215] offset:29632
    v_mfma_f32_16x16x32_bf16 a[156:159], a[252:255], v[236:239], a[156:159]
    s_sub_u32 s16, s16, s3
    v_mfma_f32_16x16x32_bf16 a[160:163], v[240:243], v[236:239], a[160:163]
    ds_write_b64 v252, v[208:209] offset:6752
    v_mfma_f32_16x16x32_bf16 a[164:167], v[244:247], v[236:239], a[164:167]
    s_add_u32 s42, s32, 552960
    v_mfma_f32_16x16x32_bf16 a[180:183], a[228:231], v[236:239], a[180:183]
    buffer_load_dwordx4 a[228:231], v254, s[8:11], s42 offen offset:0 sc1
    v_mfma_f32_16x16x32_bf16 a[184:187], a[232:235], v[236:239], a[184:187]
    s_waitcnt lgkmcnt(7)
    v_lshlrev_b32 v252, 16, v216
    v_and_b32 v216, s22, v216
    v_mfma_f32_16x16x32_bf16 a[188:191], a[236:239], v[236:239], a[188:191]
    s_sub_u32 s17, s17, s3
    v_add_f32 v252, v252, v251
    v_add_f32 v216, v216, v224
    v_mfma_f32_16x16x32_bf16 a[180:183], a[240:243], v[228:231], a[180:183]
    ds_read_b128 v[236:239], v253 offset:13520
    v_fmac_f32 v252, s23, v249
    v_fmac_f32 v216, s23, v220
    v_mfma_f32_16x16x32_bf16 a[184:187], a[244:247], v[228:231], a[184:187]
    buffer_load_dwordx4 a[232:235], v254, s[8:11], s42 offen offset:1024 sc1
    v_mfma_f32_16x16x32_bf16 a[188:191], a[248:251], v[228:231], a[188:191]
    ds_read_b128 v[204:207], v253 offset:40288
    v_cvt_pk_bf16_f32 v216, v252, v216
    v_mfma_f32_16x16x32_bf16 a[168:171], a[252:255], v[228:231], a[168:171]
    s_mov_b32 s45, 472974346
    v_lshlrev_b32 v252, 16, v226
    v_and_b32 v226, s22, v226
    v_mfma_f32_16x16x32_bf16 a[172:175], v[240:243], v[228:231], a[172:175]
    buffer_load_dwordx4 a[236:239], v254, s[8:11], s42 offen offset:2048 sc1
    v_mfma_f32_16x16x32_bf16 a[176:179], v[244:247], v[228:231], a[176:179]
    ds_read_b128 v[228:231], v253 offset:13248
    s_sub_u32 s18, s18, s3
    v_add_f32 v252, v252, v248
    s_waitcnt lgkmcnt(5)
    v_mfma_f32_16x16x32_bf16 a[180:183], a[252:255], v[232:235], a[180:183]
    s_add_u32 s42, s32, 556032
    v_bfe_u32 v208, v254, 5, 3
    v_add_f32 v226, v226, v218
    v_mfma_f32_16x16x32_bf16 a[184:187], v[240:243], v[232:235], a[184:187]
    buffer_load_dwordx4 a[240:243], v254, s[8:11], s42 offen offset:0 sc1
    v_mfma_f32_16x16x32_bf16 a[188:191], v[244:247], v[232:235], a[188:191]
    ds_read_b128 v[232:235], v253 offset:12992
    v_mul_u32_u24 v209, 5, v208
    s_waitcnt vmcnt(16)
    s_waitcnt lgkmcnt(3)
sub14:
    v_mfma_f32_16x16x32_bf16 v[0:3], a[192:195], v[236:239], v[0:3]
    s_waitcnt vmcnt(13) lgkmcnt(1)
    v_fmac_f32 v252, s23, v250
    v_fmac_f32 v226, s23, v222
    v_mfma_f32_16x16x32_bf16 v[4:7], a[196:199], v[236:239], v[4:7]
    s_sub_u32 s19, s19, s3
    v_cvt_pk_bf16_f32 v226, v252, v226
    v_fma_f32 v252, v249, s24, v251
    v_fmac_f32 v251, s25, v249
    v_mfma_f32_16x16x32_bf16 v[8:11], a[200:203], v[236:239], v[8:11]
    ds_read_b128 v[236:239], v253 offset:12736
    v_bfe_u32 v209, s45, v209, 5
    v_mfma_f32_16x16x32_bf16 v[0:3], a[204:207], v[228:231], v[0:3]
    buffer_load_dwordx4 a[244:247], v254, s[8:11], s42 offen offset:1024 sc1
    v_mfma_f32_16x16x32_bf16 v[4:7], a[208:211], v[228:231], v[4:7]
    v_fma_f32 v249, v248, s24, v250
    v_fmac_f32 v250, s25, v248
    v_mfma_f32_16x16x32_bf16 v[8:11], a[212:215], v[228:231], v[8:11]
    v_mul_u32_u24 v209, 65, v209
    v_fma_f32 v248, v250, s26, v251
    v_mfma_f32_16x16x32_bf16 v[12:15], a[192:195], v[228:231], v[12:15]
    s_waitcnt lgkmcnt(1)
    v_fmac_f32 v251, s27, v250
    v_fma_f32 v250, v249, s28, v252
    v_fmac_f32 v252, s29, v249
    v_mfma_f32_16x16x32_bf16 v[12:15], a[204:207], v[232:235], v[12:15]
    buffer_load_dwordx4 a[248:251], v254, s[8:11], s42 offen offset:2048 sc1
    v_mfma_f32_16x16x32_bf16 v[16:19], a[208:211], v[232:235], v[16:19]
    s_sub_u32 s20, s20, s3
    v_sub_u32 v209, v209, v208
    v_fma_f32 v249, v220, s24, v224
    v_mfma_f32_16x16x32_bf16 v[16:19], a[196:199], v[228:231], v[16:19]
    s_add_u32 s42, s32, 559104
    v_fmac_f32 v224, s25, v220
    v_fma_f32 v220, v218, s24, v222
    v_mfma_f32_16x16x32_bf16 v[20:23], a[200:203], v[228:231], v[20:23]
    ds_read_b128 v[228:231], v253 offset:12480
    v_lshl_add_u32 v208, v209, 5, v253
    v_mfma_f32_16x16x32_bf16 v[20:23], a[212:215], v[232:235], v[20:23]
    buffer_load_dwordx4 a[252:255], v254, s[8:11], s42 offen offset:0 sc1
    v_fmac_f32 v222, s25, v218
    s_waitcnt vmcnt(13)
    v_mfma_f32_16x16x32_bf16 v[0:3], a[216:219], v[232:235], v[0:3]
    s_sub_u32 s21, s21, s3
    v_fma_f32 v218, v222, s26, v224
    v_mfma_f32_16x16x32_bf16 v[4:7], a[220:223], v[232:235], v[4:7]
    v_fmac_f32 v224, s27, v222
    v_fma_f32 v222, v220, s28, v249
    v_mfma_f32_16x16x32_bf16 v[8:11], a[224:227], v[232:235], v[8:11]
    s_waitcnt lgkmcnt(1)
    v_fmac_f32 v249, s29, v220
    v_cvt_pk_bf16_f32 v218, v248, v218
    v_mfma_f32_16x16x32_bf16 v[24:27], a[192:195], v[232:235], v[24:27]
    buffer_load_dwordx4 v[240:243], v254, s[8:11], s42 offen offset:1024 sc1
    v_mfma_f32_16x16x32_bf16 v[24:27], a[204:207], v[236:239], v[24:27]
    s_mov_b64 exec, s[46:47]
    ds_write_b128 v208, v[204:207] offset:1024
    s_mov_b64 exec, -1
    v_cvt_pk_bf16_f32 v224, v251, v224
    v_mfma_f32_16x16x32_bf16 v[28:31], a[208:211], v[236:239], v[28:31]
    v_cvt_pk_bf16_f32 v222, v250, v222
    v_cvt_pk_bf16_f32 v220, v252, v249
    v_mfma_f32_16x16x32_bf16 v[28:31], a[196:199], v[232:235], v[28:31]
    buffer_load_dwordx4 v[244:247], v254, s[8:11], s42 offen offset:2048 sc1
    v_mfma_f32_16x16x32_bf16 v[32:35], a[200:203], v[232:235], v[32:35]
    ds_read_b128 v[232:235], v253 offset:14304
    v_and_b32 v215, 0x7fff, v255
    v_mfma_f32_16x16x32_bf16 v[32:35], a[212:215], v[236:239], v[32:35]
    v_lshlrev_b32 v248, 16, v219
    v_lshlrev_b32 v249, 16, v221
    v_mfma_f32_16x16x32_bf16 v[12:15], a[216:219], v[236:239], v[12:15]
    buffer_load_dwordx2 v[204:205], v215, s[4:7], s16 offen offset:320
    v_lshlrev_b32 v250, 16, v223
    v_mfma_f32_16x16x32_bf16 v[16:19], a[220:223], v[236:239], v[16:19]
    v_lshlrev_b32 v251, 16, v225
    v_and_b32 v219, s22, v219
    v_mfma_f32_16x16x32_bf16 v[20:23], a[224:227], v[236:239], v[20:23]
    s_waitcnt lgkmcnt(2)
    v_and_b32 v221, s22, v221
    v_and_b32 v223, s22, v223
    v_mfma_f32_16x16x32_bf16 v[36:39], a[192:195], v[236:239], v[36:39]
    buffer_load_dwordx2 v[206:207], v215, s[4:7], s17 offen offset:320
    v_mfma_f32_16x16x32_bf16 v[36:39], a[204:207], v[228:231], v[36:39]
    v_and_b32 v225, s22, v225
    v_lshlrev_b32 v252, 16, v217
    v_mfma_f32_16x16x32_bf16 v[40:43], a[208:211], v[228:231], v[40:43]
    v_and_b32 v217, s22, v217
    v_add_f32 v252, v252, v251
    v_add_f32 v217, v217, v225
    v_mfma_f32_16x16x32_bf16 v[40:43], a[196:199], v[236:239], v[40:43]
    buffer_load_dwordx2 v[208:209], v215, s[4:7], s18 offen offset:320
    v_mfma_f32_16x16x32_bf16 v[44:47], a[200:203], v[236:239], v[44:47]
pad5:
    s_cbranch_vccnz pad9
    ds_read_b128 v[236:239], v253 offset:14048
    v_fmac_f32 v252, s23, v249
    v_mfma_f32_16x16x32_bf16 v[44:47], a[212:215], v[228:231], v[44:47]
    v_fmac_f32 v217, s23, v221
    v_cvt_pk_bf16_f32 v217, v252, v217
    v_mfma_f32_16x16x32_bf16 v[24:27], a[216:219], v[228:231], v[24:27]
    buffer_load_dwordx2 v[210:211], v215, s[4:7], s19 offen offset:320
    v_mfma_f32_16x16x32_bf16 v[28:31], a[220:223], v[228:231], v[28:31]
    v_lshlrev_b32 v252, 16, v227
    v_and_b32 v227, s22, v227
    v_add_f32 v252, v252, v248
    v_mfma_f32_16x16x32_bf16 v[32:35], a[224:227], v[228:231], v[32:35]
    s_waitcnt lgkmcnt(1)
    v_add_f32 v227, v227, v219
    v_fmac_f32 v252, s23, v250
    v_mfma_f32_16x16x32_bf16 v[48:51], a[192:195], v[228:231], v[48:51]
    buffer_load_dwordx2 v[212:213], v215, s[4:7], s20 offen offset:320
    v_mfma_f32_16x16x32_bf16 v[48:51], a[204:207], v[232:235], v[48:51]
    v_fmac_f32 v227, s23, v223
    v_cvt_pk_bf16_f32 v227, v252, v227
    v_mfma_f32_16x16x32_bf16 v[52:55], a[208:211], v[232:235], v[52:55]
    v_fma_f32 v252, v249, s24, v251
    v_fmac_f32 v251, s25, v249
    v_mfma_f32_16x16x32_bf16 v[52:55], a[196:199], v[228:231], v[52:55]
    buffer_load_dwordx2 v[214:215], v215, s[4:7], s21 offen offset:320
    v_fma_f32 v249, v248, s24, v250
    v_mfma_f32_16x16x32_bf16 v[56:59], a[200:203], v[228:231], v[56:59]
    ds_read_b128 v[228:231], v253 offset:13792
    v_fmac_f32 v250, s25, v248
    v_mfma_f32_16x16x32_bf16 v[56:59], a[212:215], v[232:235], v[56:59]
    v_fma_f32 v248, v250, s26, v251
    v_fmac_f32 v251, s27, v250
    v_mfma_f32_16x16x32_bf16 v[36:39], a[216:219], v[232:235], v[36:39]
    v_fma_f32 v250, v249, s28, v252
    v_fmac_f32 v252, s29, v249
    v_mfma_f32_16x16x32_bf16 v[40:43], a[220:223], v[232:235], v[40:43]
    v_fma_f32 v249, v221, s24, v225
    v_fmac_f32 v225, s25, v221
    v_mfma_f32_16x16x32_bf16 v[44:47], a[224:227], v[232:235], v[44:47]
    v_fma_f32 v221, v219, s24, v223
    v_fmac_f32 v223, s25, v219
    v_fma_f32 v219, v223, s26, v225
    v_mfma_f32_16x16x32_bf16 v[60:63], a[192:195], v[232:235], v[60:63]
    s_waitcnt lgkmcnt(1)
    v_fmac_f32 v225, s27, v223
    v_fma_f32 v223, v221, s28, v249
    v_mfma_f32_16x16x32_bf16 v[60:63], a[204:207], v[236:239], v[60:63]
    v_fmac_f32 v249, s29, v221
    v_cvt_pk_bf16_f32 v219, v248, v219
    v_mfma_f32_16x16x32_bf16 v[64:67], a[208:211], v[236:239], v[64:67]
    v_cvt_pk_bf16_f32 v225, v251, v225
    v_cvt_pk_bf16_f32 v223, v250, v223
    v_mfma_f32_16x16x32_bf16 v[64:67], a[196:199], v[232:235], v[64:67]
    v_cvt_pk_bf16_f32 v221, v252, v249
    v_lshrrev_b32 v252, 15, v255
    v_mfma_f32_16x16x32_bf16 v[68:71], a[200:203], v[232:235], v[68:71]
    ds_read_b128 v[232:235], v253 offset:13536
    v_mfma_f32_16x16x32_bf16 v[68:71], a[212:215], v[236:239], v[68:71]
    ds_write_b64 v252, v[218:219] offset:256
    v_mfma_f32_16x16x32_bf16 v[48:51], a[216:219], v[236:239], v[48:51]
    s_waitcnt vmcnt(15)
    v_lshlrev_b32 v248, 16, v194
    v_lshlrev_b32 v249, 16, v196
    v_mfma_f32_16x16x32_bf16 v[52:55], a[220:223], v[236:239], v[52:55]
    ds_write_b64 v252, v[224:225] offset:2336
    v_mfma_f32_16x16x32_bf16 v[56:59], a[224:227], v[236:239], v[56:59]
    s_waitcnt lgkmcnt(3)
    v_lshlrev_b32 v250, 16, v198
    v_lshlrev_b32 v251, 16, v200
    v_mfma_f32_16x16x32_bf16 v[72:75], a[192:195], v[236:239], v[72:75]
    ds_write_b64 v252, v[222:223] offset:4416
    v_and_b32 v194, s22, v194
    v_mfma_f32_16x16x32_bf16 v[72:75], a[204:207], v[228:231], v[72:75]
    v_and_b32 v196, s22, v196
    v_mfma_f32_16x16x32_bf16 v[76:79], a[208:211], v[228:231], v[76:79]
    ds_write_b64 v252, v[216:217] offset:21056
    v_mfma_f32_16x16x32_bf16 v[76:79], a[196:199], v[236:239], v[76:79]
    v_and_b32 v198, s22, v198
    v_and_b32 v200, s22, v200
    v_mfma_f32_16x16x32_bf16 v[80:83], a[200:203], v[236:239], v[80:83]
    ds_read_b128 v[236:239], v253 offset:13264
    v_mfma_f32_16x16x32_bf16 v[80:83], a[212:215], v[228:231], v[80:83]
    ds_write_b64 v252, v[226:227] offset:29376
    v_mfma_f32_16x16x32_bf16 v[60:63], a[216:219], v[228:231], v[60:63]
    v_mfma_f32_16x16x32_bf16 v[64:67], a[220:223], v[228:231], v[64:67]
    ds_write_b64 v252, v[220:221] offset:6496
    v_mfma_f32_16x16x32_bf16 v[68:71], a[224:227], v[228:231], v[68:71]
    s_add_u32 s42, s32, 589824
    v_mfma_f32_16x16x32_bf16 v[84:87], a[192:195], v[228:231], v[84:87]
    buffer_load_dwordx4 a[192:195], v254, s[8:11], s42 offen offset:0 sc1
    v_mfma_f32_16x16x32_bf16 v[88:91], a[196:199], v[228:231], v[88:91]
    v_lshlrev_b32 v252, 16, v192
    v_and_b32 v192, s22, v192
    v_mfma_f32_16x16x32_bf16 v[92:95], a[200:203], v[228:231], v[92:95]
    s_waitcnt lgkmcnt(7)
    v_add_f32 v252, v252, v251
    v_add_f32 v192, v192, v200
    v_mfma_f32_16x16x32_bf16 v[84:87], a[204:207], v[232:235], v[84:87]
    ds_read_b128 v[228:231], v253 offset:32240
    v_fmac_f32 v252, s23, v249
    v_mfma_f32_16x16x32_bf16 v[88:91], a[208:211], v[232:235], v[88:91]
    buffer_load_dwordx4 a[196:199], v254, s[8:11], s42 offen offset:1024 sc1
    v_mfma_f32_16x16x32_bf16 v[92:95], a[212:215], v[232:235], v[92:95]
    v_fmac_f32 v192, s23, v196
    v_cvt_pk_bf16_f32 v192, v252, v192
    v_mfma_f32_16x16x32_bf16 v[72:75], a[216:219], v[232:235], v[72:75]
    s_waitcnt lgkmcnt(3)
    v_lshlrev_b32 v252, 16, v202
    v_and_b32 v202, s22, v202
    v_mfma_f32_16x16x32_bf16 v[76:79], a[220:223], v[232:235], v[76:79]
    buffer_load_dwordx4 a[200:203], v254, s[8:11], s42 offen offset:2048 sc1
    v_mfma_f32_16x16x32_bf16 v[80:83], a[224:227], v[232:235], v[80:83]
    ds_read_b128 v[232:235], v253 offset:31968
    v_add_f32 v252, v252, v248
    v_mfma_f32_16x16x32_bf16 v[84:87], a[216:219], v[236:239], v[84:87]
    s_add_u32 s42, s32, 592896
    v_add_f32 v202, v202, v194
    v_fmac_f32 v252, s23, v250
    v_mfma_f32_16x16x32_bf16 v[88:91], a[220:223], v[236:239], v[88:91]
    buffer_load_dwordx4 a[204:207], v254, s[8:11], s42 offen offset:0 sc1
    v_mfma_f32_16x16x32_bf16 v[92:95], a[224:227], v[236:239], v[92:95]
    ds_read_b128 v[236:239], v253 offset:31712
    v_fmac_f32 v202, s23, v198
    s_waitcnt vmcnt(16)
    s_waitcnt lgkmcnt(2)
sub15:
    v_mfma_f32_16x16x32_bf16 v[96:99], a[228:231], v[228:231], v[96:99]
    v_cvt_pk_bf16_f32 v202, v252, v202
    v_fma_f32 v252, v249, s24, v251
    v_mfma_f32_16x16x32_bf16 v[100:103], a[232:235], v[228:231], v[100:103]
    s_waitcnt vmcnt(13) lgkmcnt(1)
    v_fmac_f32 v251, s25, v249
    v_fma_f32 v249, v248, s24, v250
    v_mfma_f32_16x16x32_bf16 v[104:107], a[236:239], v[228:231], v[104:107]
    ds_read_b128 v[228:231], v253 offset:31456
    v_fmac_f32 v250, s25, v248
    v_mfma_f32_16x16x32_bf16 v[96:99], a[240:243], v[232:235], v[96:99]
    buffer_load_dwordx4 a[208:211], v254, s[8:11], s42 offen offset:1024 sc1
    v_mfma_f32_16x16x32_bf16 v[100:103], a[244:247], v[232:235], v[100:103]
    v_fma_f32 v248, v250, s26, v251
    v_fmac_f32 v251, s27, v250
    v_mfma_f32_16x16x32_bf16 v[104:107], a[248:251], v[232:235], v[104:107]
    v_fma_f32 v250, v249, s28, v252
    v_fmac_f32 v252, s29, v249
    v_mfma_f32_16x16x32_bf16 v[108:111], a[228:231], v[232:235], v[108:111]
    s_waitcnt lgkmcnt(1)
    v_fma_f32 v249, v196, s24, v200
    v_fmac_f32 v200, s25, v196
    v_mfma_f32_16x16x32_bf16 v[108:111], a[240:243], v[236:239], v[108:111]
    buffer_load_dwordx4 a[212:215], v254, s[8:11], s42 offen offset:2048 sc1
    v_mfma_f32_16x16x32_bf16 v[112:115], a[244:247], v[236:239], v[112:115]
    v_fma_f32 v196, v194, s24, v198
    v_fmac_f32 v198, s25, v194
    v_mfma_f32_16x16x32_bf16 v[112:115], a[232:235], v[232:235], v[112:115]
    s_add_u32 s42, s32, 595968
    v_fma_f32 v194, v198, s26, v200
    v_fmac_f32 v200, s27, v198
    v_mfma_f32_16x16x32_bf16 v[116:119], a[236:239], v[232:235], v[116:119]
    ds_read_b128 v[232:235], v253 offset:31200
    v_fma_f32 v198, v196, s28, v249
    v_mfma_f32_16x16x32_bf16 v[116:119], a[248:251], v[236:239], v[116:119]
    buffer_load_dwordx4 a[216:219], v254, s[8:11], s42 offen offset:0 sc1
    s_waitcnt vmcnt(13)
    v_mfma_f32_16x16x32_bf16 v[96:99], a[252:255], v[236:239], v[96:99]
    v_fmac_f32 v249, s29, v196
    v_cvt_pk_bf16_f32 v194, v248, v194
    v_mfma_f32_16x16x32_bf16 v[100:103], v[240:243], v[236:239], v[100:103]
    v_cvt_pk_bf16_f32 v200, v251, v200
    v_cvt_pk_bf16_f32 v198, v250, v198
    v_mfma_f32_16x16x32_bf16 v[104:107], v[244:247], v[236:239], v[104:107]
    s_waitcnt lgkmcnt(1)
    v_cvt_pk_bf16_f32 v196, v252, v249
    v_lshlrev_b32 v248, 16, v195
    v_mfma_f32_16x16x32_bf16 v[120:123], a[228:231], v[236:239], v[120:123]
    buffer_load_dwordx4 a[220:223], v254, s[8:11], s42 offen offset:1024 sc1
    v_mfma_f32_16x16x32_bf16 v[120:123], a[240:243], v[228:231], v[120:123]
    v_lshlrev_b32 v249, 16, v197
    v_lshlrev_b32 v250, 16, v199
    v_mfma_f32_16x16x32_bf16 v[124:127], a[244:247], v[228:231], v[124:127]
    v_lshlrev_b32 v251, 16, v201
    v_and_b32 v195, s22, v195
    v_mfma_f32_16x16x32_bf16 v[124:127], a[232:235], v[236:239], v[124:127]
    buffer_load_dwordx4 a[224:227], v254, s[8:11], s42 offen offset:2048 sc1
    v_mfma_f32_16x16x32_bf16 v[128:131], a[236:239], v[236:239], v[128:131]
    ds_read_b128 v[236:239], v253 offset:33024
    v_and_b32 v227, 0x7fff, v255
    v_mfma_f32_16x16x32_bf16 v[128:131], a[248:251], v[228:231], v[128:131]
    v_and_b32 v197, s22, v197
    v_and_b32 v199, s22, v199
    v_mfma_f32_16x16x32_bf16 v[108:111], a[252:255], v[228:231], v[108:111]
    buffer_load_dwordx2 v[216:217], v227, s[4:7], s16 offen offset:704
    v_mfma_f32_16x16x32_bf16 v[112:115], v[240:243], v[228:231], v[112:115]
    v_and_b32 v201, s22, v201
    v_lshlrev_b32 v252, 16, v193
    v_mfma_f32_16x16x32_bf16 v[116:119], v[244:247], v[228:231], v[116:119]
    s_waitcnt lgkmcnt(1)
    v_and_b32 v193, s22, v193
    v_add_f32 v252, v252, v251
    v_mfma_f32_16x16x32_bf16 v[132:135], a[228:231], v[228:231], v[132:135]
    buffer_load_dwordx2 v[218:219], v227, s[4:7], s17 offen offset:704
    v_mfma_f32_16x16x32_bf16 v[132:135], a[240:243], v[232:235], v[132:135]
    v_add_f32 v193, v193, v201
    v_fmac_f32 v252, s23, v249
    v_mfma_f32_16x16x32_bf16 v[136:139], a[244:247], v[232:235], v[136:139]
    v_fmac_f32 v193, s23, v197
    v_cvt_pk_bf16_f32 v193, v252, v193
    v_mfma_f32_16x16x32_bf16 v[136:139], a[232:235], v[228:231], v[136:139]
    buffer_load_dwordx2 v[220:221], v227, s[4:7], s18 offen offset:704
    v_mfma_f32_16x16x32_bf16 v[140:143], a[236:239], v[228:231], v[140:143]
    ds_read_b128 v[228:231], v253 offset:32768
    v_lshlrev_b32 v252, 16, v203
    v_mfma_f32_16x16x32_bf16 v[140:143], a[248:251], v[232:235], v[140:143]
    v_and_b32 v203, s22, v203
    v_add_f32 v252, v252, v248
    v_mfma_f32_16x16x32_bf16 v[120:123], a[252:255], v[232:235], v[120:123]
    buffer_load_dwordx2 v[222:223], v227, s[4:7], s19 offen offset:704
    v_mfma_f32_16x16x32_bf16 v[124:127], v[240:243], v[232:235], v[124:127]
    v_add_f32 v203, v203, v195
    v_fmac_f32 v252, s23, v250
    v_mfma_f32_16x16x32_bf16 v[128:131], v[244:247], v[232:235], v[128:131]
    s_waitcnt lgkmcnt(1)
    v_fmac_f32 v203, s23, v199
    v_cvt_pk_bf16_f32 v203, v252, v203
    v_mfma_f32_16x16x32_bf16 v[144:147], a[228:231], v[232:235], v[144:147]
    buffer_load_dwordx2 v[224:225], v227, s[4:7], s20 offen offset:704
    v_mfma_f32_16x16x32_bf16 v[144:147], a[240:243], v[236:239], v[144:147]
    v_fma_f32 v252, v249, s24, v251
    v_fmac_f32 v251, s25, v249
    v_mfma_f32_16x16x32_bf16 v[148:151], a[244:247], v[236:239], v[148:151]
    v_fma_f32 v249, v248, s24, v250
    v_fmac_f32 v250, s25, v248
    v_mfma_f32_16x16x32_bf16 v[148:151], a[232:235], v[232:235], v[148:151]
    buffer_load_dwordx2 v[226:227], v227, s[4:7], s21 offen offset:704
    v_mfma_f32_16x16x32_bf16 v[152:155], a[236:239], v[232:235], v[152:155]
    ds_read_b128 v[232:235], v253 offset:32512
    v_fma_f32 v248, v250, s26, v251
    v_mfma_f32_16x16x32_bf16 v[152:155], a[248:251], v[236:239], v[152:155]
    v_fmac_f32 v251, s27, v250
    v_fma_f32 v250, v249, s28, v252
    v_mfma_f32_16x16x32_bf16 v[132:135], a[252:255], v[236:239], v[132:135]
    v_fmac_f32 v252, s29, v249
    v_fma_f32 v249, v197, s24, v201
    v_mfma_f32_16x16x32_bf16 v[136:139], v[240:243], v[236:239], v[136:139]
    v_fmac_f32 v201, s25, v197
    v_fma_f32 v197, v195, s24, v199
    v_mfma_f32_16x16x32_bf16 v[140:143], v[244:247], v[236:239], v[140:143]
    v_fmac_f32 v199, s25, v195
    v_fma_f32 v195, v199, s26, v201
    v_mfma_f32_16x16x32_bf16 v[156:159], a[228:231], v[236:239], v[156:159]
    s_waitcnt lgkmcnt(1)
    v_fmac_f32 v201, s27, v199
    v_fma_f32 v199, v197, s28, v249
    v_mfma_f32_16x16x32_bf16 v[156:159], a[240:243], v[228:231], v[156:159]
    v_fmac_f32 v249, s29, v197
    v_cvt_pk_bf16_f32 v195, v248, v195
    v_mfma_f32_16x16x32_bf16 v[160:163], a[244:247], v[228:231], v[160:163]
    v_cvt_pk_bf16_f32 v201, v251, v201
    v_cvt_pk_bf16_f32 v199, v250, v199
    v_mfma_f32_16x16x32_bf16 v[160:163], a[232:235], v[236:239], v[160:163]
    v_cvt_pk_bf16_f32 v197, v252, v249
    v_lshrrev_b32 v252, 15, v255
    v_mfma_f32_16x16x32_bf16 v[164:167], a[236:239], v[236:239], v[164:167]
    ds_read_b128 v[236:239], v253 offset:32256
    v_mfma_f32_16x16x32_bf16 v[164:167], a[248:251], v[228:231], v[164:167]
    ds_write_b64 v252, v[194:195] offset:0
    v_mfma_f32_16x16x32_bf16 v[144:147], a[252:255], v[228:231], v[144:147]
    s_waitcnt vmcnt(15)
    v_lshlrev_b32 v248, 16, v206
    v_lshlrev_b32 v249, 16, v208
    v_mfma_f32_16x16x32_bf16 v[148:151], v[240:243], v[228:231], v[148:151]
    ds_write_b64 v252, v[200:201] offset:2080
    v_mfma_f32_16x16x32_bf16 v[152:155], v[244:247], v[228:231], v[152:155]
    s_waitcnt lgkmcnt(3)
    v_lshlrev_b32 v250, 16, v210
    v_lshlrev_b32 v251, 16, v212
    v_mfma_f32_16x16x32_bf16 v[168:171], a[228:231], v[228:231], v[168:171]
    ds_write_b64 v252, v[198:199] offset:4160
    v_mfma_f32_16x16x32_bf16 v[168:171], a[240:243], v[232:235], v[168:171]
    v_and_b32 v206, s22, v206
    v_and_b32 v208, s22, v208
    v_mfma_f32_16x16x32_bf16 v[172:175], a[244:247], v[232:235], v[172:175]
    ds_write_b64 v252, v[192:193] offset:20800
    v_mfma_f32_16x16x32_bf16 v[172:175], a[232:235], v[228:231], v[172:175]
    v_and_b32 v210, s22, v210
    v_and_b32 v212, s22, v212
    v_mfma_f32_16x16x32_bf16 v[176:179], a[236:239], v[228:231], v[176:179]
    ds_read_b128 v[228:231], v253 offset:31984
    v_mfma_f32_16x16x32_bf16 v[176:179], a[248:251], v[232:235], v[176:179]
    ds_write_b64 v252, v[202:203] offset:29120
    v_mfma_f32_16x16x32_bf16 v[156:159], a[252:255], v[232:235], v[156:159]
    s_waitcnt lgkmcnt(6)
    v_mfma_f32_16x16x32_bf16 v[160:163], v[240:243], v[232:235], v[160:163]
    ds_write_b64 v252, v[196:197] offset:6240
    v_mfma_f32_16x16x32_bf16 v[164:167], v[244:247], v[232:235], v[164:167]
    s_add_u32 s42, s32, 626688
    v_mfma_f32_16x16x32_bf16 v[180:183], a[228:231], v[232:235], v[180:183]
    buffer_load_dwordx4 a[228:231], v254, s[8:11], s42 offen offset:0 sc1
    v_mfma_f32_16x16x32_bf16 v[184:187], a[232:235], v[232:235], v[184:187]
    s_waitcnt lgkmcnt(0)
    v_lshlrev_b32 v252, 16, v204
    v_and_b32 v204, s22, v204
    v_mfma_f32_16x16x32_bf16 v[188:191], a[236:239], v[232:235], v[188:191]
    s_barrier
    v_mfma_f32_16x16x32_bf16 v[180:183], a[240:243], v[236:239], v[180:183]
    ds_read_b128 v[232:235], v253 offset:1040
    v_add_f32 v252, v252, v251
    v_mfma_f32_16x16x32_bf16 v[184:187], a[244:247], v[236:239], v[184:187]
    buffer_load_dwordx4 a[232:235], v254, s[8:11], s42 offen offset:1024 sc1
    v_mfma_f32_16x16x32_bf16 v[188:191], a[248:251], v[236:239], v[188:191]
    v_add_f32 v204, v204, v212
    v_fmac_f32 v252, s23, v249
    v_mfma_f32_16x16x32_bf16 v[168:171], a[252:255], v[236:239], v[168:171]
    v_fmac_f32 v204, s23, v208
    v_cvt_pk_bf16_f32 v204, v252, v204
    v_mfma_f32_16x16x32_bf16 v[172:175], v[240:243], v[236:239], v[172:175]
    buffer_load_dwordx4 a[236:239], v254, s[8:11], s42 offen offset:2048 sc1
    v_mfma_f32_16x16x32_bf16 v[176:179], v[244:247], v[236:239], v[176:179]
    ds_read_b128 v[236:239], v253 offset:768
    v_lshlrev_b32 v252, 16, v214
    v_mfma_f32_16x16x32_bf16 v[180:183], a[252:255], v[228:231], v[180:183]
    s_add_u32 s42, s32, 629760
    v_and_b32 v214, s22, v214
    v_add_f32 v252, v252, v248
    v_mfma_f32_16x16x32_bf16 v[184:187], v[240:243], v[228:231], v[184:187]
    buffer_load_dwordx4 a[240:243], v254, s[8:11], s42 offen offset:0 sc1
    v_mfma_f32_16x16x32_bf16 v[188:191], v[244:247], v[228:231], v[188:191]
    ds_read_b128 v[228:231], v253 offset:512
    v_add_f32 v214, v214, v206
    s_waitcnt vmcnt(16)
    s_waitcnt lgkmcnt(2)
sub16:
    v_mfma_f32_16x16x32_bf16 a[0:3], a[192:195], v[232:235], a[0:3]
    v_fmac_f32 v252, s23, v250
    v_fmac_f32 v214, s23, v210
    v_mfma_f32_16x16x32_bf16 a[4:7], a[196:199], v[232:235], a[4:7]
    s_waitcnt vmcnt(13) lgkmcnt(1)
    v_cvt_pk_bf16_f32 v214, v252, v214
    v_fma_f32 v252, v249, s24, v251
    v_mfma_f32_16x16x32_bf16 a[8:11], a[200:203], v[232:235], a[8:11]
    ds_read_b128 v[232:235], v253 offset:256
    v_fmac_f32 v251, s25, v249
    v_mfma_f32_16x16x32_bf16 a[0:3], a[204:207], v[236:239], a[0:3]
    buffer_load_dwordx4 a[244:247], v254, s[8:11], s42 offen offset:1024 sc1
    v_mfma_f32_16x16x32_bf16 a[4:7], a[208:211], v[236:239], a[4:7]
    v_fma_f32 v249, v248, s24, v250
    v_fmac_f32 v250, s25, v248
    v_mfma_f32_16x16x32_bf16 a[8:11], a[212:215], v[236:239], a[8:11]
    v_fma_f32 v248, v250, s26, v251
    v_fmac_f32 v251, s27, v250
    v_mfma_f32_16x16x32_bf16 a[12:15], a[192:195], v[236:239], a[12:15]
    s_waitcnt lgkmcnt(1)
    v_fma_f32 v250, v249, s28, v252
    v_fmac_f32 v252, s29, v249
    v_mfma_f32_16x16x32_bf16 a[12:15], a[204:207], v[228:231], a[12:15]
    buffer_load_dwordx4 a[248:251], v254, s[8:11], s42 offen offset:2048 sc1
    v_mfma_f32_16x16x32_bf16 a[16:19], a[208:211], v[228:231], a[16:19]
    v_fma_f32 v249, v208, s24, v212
    v_fmac_f32 v212, s25, v208
    v_mfma_f32_16x16x32_bf16 a[16:19], a[196:199], v[236:239], a[16:19]
    s_add_u32 s42, s32, 632832
    v_fma_f32 v208, v206, s24, v210
    v_fmac_f32 v210, s25, v206
    v_mfma_f32_16x16x32_bf16 a[20:23], a[200:203], v[236:239], a[20:23]
    ds_read_b128 v[236:239], v253 offset:0
    v_fma_f32 v206, v210, s26, v212
    v_mfma_f32_16x16x32_bf16 a[20:23], a[212:215], v[228:231], a[20:23]
    buffer_load_dwordx4 a[252:255], v254, s[8:11], s42 offen offset:0 sc1
    s_waitcnt vmcnt(13)
    v_mfma_f32_16x16x32_bf16 a[0:3], a[216:219], v[228:231], a[0:3]
    v_fmac_f32 v212, s27, v210
    v_fma_f32 v210, v208, s28, v249
    v_mfma_f32_16x16x32_bf16 a[4:7], a[220:223], v[228:231], a[4:7]
    v_fmac_f32 v249, s29, v208
    v_cvt_pk_bf16_f32 v206, v248, v206
    v_mfma_f32_16x16x32_bf16 a[8:11], a[224:227], v[228:231], a[8:11]
    s_waitcnt lgkmcnt(1)
    v_cvt_pk_bf16_f32 v212, v251, v212
    v_cvt_pk_bf16_f32 v210, v250, v210
    v_mfma_f32_16x16x32_bf16 a[24:27], a[192:195], v[228:231], a[24:27]
    buffer_load_dwordx4 v[240:243], v254, s[8:11], s42 offen offset:1024 sc1
    v_mfma_f32_16x16x32_bf16 a[24:27], a[204:207], v[232:235], a[24:27]
    v_cvt_pk_bf16_f32 v208, v252, v249
    v_lshlrev_b32 v248, 16, v207
    v_mfma_f32_16x16x32_bf16 a[28:31], a[208:211], v[232:235], a[28:31]
    v_lshlrev_b32 v249, 16, v209
    v_lshlrev_b32 v250, 16, v211
    v_mfma_f32_16x16x32_bf16 a[28:31], a[196:199], v[228:231], a[28:31]
    buffer_load_dwordx4 v[244:247], v254, s[8:11], s42 offen offset:2048 sc1
    v_mfma_f32_16x16x32_bf16 a[32:35], a[200:203], v[228:231], a[32:35]
    ds_read_b128 v[228:231], v253 offset:1824
    v_and_b32 v203, 0x7fff, v255
    v_mfma_f32_16x16x32_bf16 a[32:35], a[212:215], v[232:235], a[32:35]
    v_lshlrev_b32 v251, 16, v213
    v_and_b32 v207, s22, v207
    v_mfma_f32_16x16x32_bf16 a[12:15], a[216:219], v[232:235], a[12:15]
    buffer_load_dwordx2 v[192:193], v203, s[4:7], s16 offen offset:1088
    v_mfma_f32_16x16x32_bf16 a[16:19], a[220:223], v[232:235], a[16:19]
    v_and_b32 v209, s22, v209
    v_and_b32 v211, s22, v211
    v_mfma_f32_16x16x32_bf16 a[20:23], a[224:227], v[232:235], a[20:23]
    s_waitcnt lgkmcnt(1)
    v_and_b32 v213, s22, v213
    v_lshlrev_b32 v252, 16, v205
    v_mfma_f32_16x16x32_bf16 a[36:39], a[192:195], v[232:235], a[36:39]
    buffer_load_dwordx2 v[194:195], v203, s[4:7], s17 offen offset:1088
    v_mfma_f32_16x16x32_bf16 a[36:39], a[204:207], v[236:239], a[36:39]
    v_and_b32 v205, s22, v205
    v_add_f32 v252, v252, v251
    v_mfma_f32_16x16x32_bf16 a[40:43], a[208:211], v[236:239], a[40:43]
    v_add_f32 v205, v205, v213
    v_fmac_f32 v252, s23, v249
    v_mfma_f32_16x16x32_bf16 a[40:43], a[196:199], v[232:235], a[40:43]
    buffer_load_dwordx2 v[196:197], v203, s[4:7], s18 offen offset:1088
    v_mfma_f32_16x16x32_bf16 a[44:47], a[200:203], v[232:235], a[44:47]
    ds_read_b128 v[232:235], v253 offset:1568
    v_fmac_f32 v205, s23, v209
    v_mfma_f32_16x16x32_bf16 a[44:47], a[212:215], v[236:239], a[44:47]
    v_cvt_pk_bf16_f32 v205, v252, v205
    v_lshlrev_b32 v252, 16, v215
    v_mfma_f32_16x16x32_bf16 a[24:27], a[216:219], v[236:239], a[24:27]
    buffer_load_dwordx2 v[198:199], v203, s[4:7], s19 offen offset:1088
    v_mfma_f32_16x16x32_bf16 a[28:31], a[220:223], v[236:239], a[28:31]
    v_and_b32 v215, s22, v215
    v_add_f32 v252, v252, v248
    v_mfma_f32_16x16x32_bf16 a[32:35], a[224:227], v[236:239], a[32:35]
    s_waitcnt lgkmcnt(1)
    v_add_f32 v215, v215, v207
    v_fmac_f32 v252, s23, v250
    v_mfma_f32_16x16x32_bf16 a[48:51], a[192:195], v[236:239], a[48:51]
    buffer_load_dwordx2 v[200:201], v203, s[4:7], s20 offen offset:1088
    v_mfma_f32_16x16x32_bf16 a[48:51], a[204:207], v[228:231], a[48:51]
    v_fmac_f32 v215, s23, v211
    v_cvt_pk_bf16_f32 v215, v252, v215
    v_mfma_f32_16x16x32_bf16 a[52:55], a[208:211], v[228:231], a[52:55]
    v_fma_f32 v252, v249, s24, v251
    v_fmac_f32 v251, s25, v249
    v_mfma_f32_16x16x32_bf16 a[52:55], a[196:199], v[236:239], a[52:55]
    buffer_load_dwordx2 v[202:203], v203, s[4:7], s21 offen offset:1088
    v_mfma_f32_16x16x32_bf16 a[56:59], a[200:203], v[236:239], a[56:59]
    ds_read_b128 v[236:239], v253 offset:1312
    v_fma_f32 v249, v248, s24, v250
    v_mfma_f32_16x16x32_bf16 a[56:59], a[212:215], v[228:231], a[56:59]
    v_fmac_f32 v250, s25, v248
    v_fma_f32 v248, v250, s26, v251
    v_mfma_f32_16x16x32_bf16 a[36:39], a[216:219], v[228:231], a[36:39]
    v_fmac_f32 v251, s27, v250
    v_fma_f32 v250, v249, s28, v252
    v_mfma_f32_16x16x32_bf16 a[40:43], a[220:223], v[228:231], a[40:43]
    v_fmac_f32 v252, s29, v249
    v_fma_f32 v249, v209, s24, v213
    v_mfma_f32_16x16x32_bf16 a[44:47], a[224:227], v[228:231], a[44:47]
    v_fmac_f32 v213, s25, v209
    v_fma_f32 v209, v207, s24, v211
    v_mfma_f32_16x16x32_bf16 a[60:63], a[192:195], v[228:231], a[60:63]
    s_waitcnt lgkmcnt(1)
    v_fmac_f32 v211, s25, v207
    v_fma_f32 v207, v211, s26, v213
    v_mfma_f32_16x16x32_bf16 a[60:63], a[204:207], v[232:235], a[60:63]
    v_fmac_f32 v213, s27, v211
    v_fma_f32 v211, v209, s28, v249
    v_mfma_f32_16x16x32_bf16 a[64:67], a[208:211], v[232:235], a[64:67]
    v_fmac_f32 v249, s29, v209
    v_cvt_pk_bf16_f32 v207, v248, v207
    v_mfma_f32_16x16x32_bf16 a[64:67], a[196:199], v[228:231], a[64:67]
    v_cvt_pk_bf16_f32 v213, v251, v213
    v_cvt_pk_bf16_f32 v211, v250, v211
    v_mfma_f32_16x16x32_bf16 a[68:71], a[200:203], v[228:231], a[68:71]
    ds_read_b128 v[228:231], v253 offset:1056
    v_cvt_pk_bf16_f32 v209, v252, v249
    v_mfma_f32_16x16x32_bf16 a[68:71], a[212:215], v[232:235], a[68:71]
    v_lshrrev_b32 v252, 15, v255
    v_mfma_f32_16x16x32_bf16 a[48:51], a[216:219], v[232:235], a[48:51]
    ds_write_b64 v252, v[206:207] offset:9088
    v_mfma_f32_16x16x32_bf16 a[52:55], a[220:223], v[232:235], a[52:55]
    s_waitcnt vmcnt(15)
    v_lshlrev_b32 v248, 16, v218
    v_mfma_f32_16x16x32_bf16 a[56:59], a[224:227], v[232:235], a[56:59]
    s_waitcnt lgkmcnt(2)
    v_lshlrev_b32 v249, 16, v220
    v_mfma_f32_16x16x32_bf16 a[72:75], a[192:195], v[232:235], a[72:75]
    ds_write_b64 v252, v[212:213] offset:11168
    v_mfma_f32_16x16x32_bf16 a[72:75], a[204:207], v[236:239], a[72:75]
    v_lshlrev_b32 v250, 16, v222
    v_lshlrev_b32 v251, 16, v224
    v_mfma_f32_16x16x32_bf16 a[76:79], a[208:211], v[236:239], a[76:79]
    ds_write_b64 v252, v[210:211] offset:13248
    v_mfma_f32_16x16x32_bf16 a[76:79], a[196:199], v[232:235], a[76:79]
    v_and_b32 v218, s22, v218
    v_mfma_f32_16x16x32_bf16 a[80:83], a[200:203], v[232:235], a[80:83]
    ds_read_b128 v[232:235], v253 offset:784
    v_and_b32 v220, s22, v220
    v_mfma_f32_16x16x32_bf16 a[80:83], a[212:215], v[236:239], a[80:83]
    ds_write_b64 v252, v[204:205] offset:23648
    v_mfma_f32_16x16x32_bf16 a[60:63], a[216:219], v[236:239], a[60:63]
    s_waitcnt lgkmcnt(5)
    v_and_b32 v222, s22, v222
    v_and_b32 v224, s22, v224
    v_mfma_f32_16x16x32_bf16 a[64:67], a[220:223], v[236:239], a[64:67]
    ds_write_b64 v252, v[214:215] offset:31968
    v_mfma_f32_16x16x32_bf16 a[68:71], a[224:227], v[236:239], a[68:71]
    s_add_u32 s42, s32, 663552
    v_mfma_f32_16x16x32_bf16 a[84:87], a[192:195], v[236:239], a[84:87]
    buffer_load_dwordx4 a[192:195], v254, s[8:11], s42 offen offset:0 sc1
    v_mfma_f32_16x16x32_bf16 a[88:91], a[196:199], v[236:239], a[88:91]
    s_waitcnt lgkmcnt(0)
    v_mfma_f32_16x16x32_bf16 a[92:95], a[200:203], v[236:239], a[92:95]
    s_barrier
    v_mfma_f32_16x16x32_bf16 a[84:87], a[204:207], v[228:231], a[84:87]
    ds_read_b128 v[236:239], v253 offset:3120
    v_mfma_f32_16x16x32_bf16 a[88:91], a[208:211], v[228:231], a[88:91]
    buffer_load_dwordx4 a[196:199], v254, s[8:11], s42 offen offset:1024 sc1
    v_mfma_f32_16x16x32_bf16 a[92:95], a[212:215], v[228:231], a[92:95]
    ds_write_b64 v252, v[208:209] offset:768
    v_mfma_f32_16x16x32_bf16 a[72:75], a[216:219], v[228:231], a[72:75]
    v_lshlrev_b32 v252, 16, v216
    v_and_b32 v216, s22, v216
    v_mfma_f32_16x16x32_bf16 a[76:79], a[220:223], v[228:231], a[76:79]
    buffer_load_dwordx4 a[200:203], v254, s[8:11], s42 offen offset:2048 sc1
    v_add_f32 v252, v252, v251
    v_mfma_f32_16x16x32_bf16 a[80:83], a[224:227], v[228:231], a[80:83]
    ds_read_b128 v[228:231], v253 offset:2848
    v_add_f32 v216, v216, v224
    v_mfma_f32_16x16x32_bf16 a[84:87], a[216:219], v[232:235], a[84:87]
    s_add_u32 s42, s32, 666624
    v_fmac_f32 v252, s23, v249
    v_fmac_f32 v216, s23, v220
    v_mfma_f32_16x16x32_bf16 a[88:91], a[220:223], v[232:235], a[88:91]
    buffer_load_dwordx4 a[204:207], v254, s[8:11], s42 offen offset:0 sc1
    v_mfma_f32_16x16x32_bf16 a[92:95], a[224:227], v[232:235], a[92:95]
    ds_read_b128 v[232:235], v253 offset:2592
    v_cvt_pk_bf16_f32 v216, v252, v216
    s_waitcnt vmcnt(16)
    s_waitcnt lgkmcnt(3)
sub17:
    v_mfma_f32_16x16x32_bf16 a[96:99], a[228:231], v[236:239], a[96:99]
    v_lshlrev_b32 v252, 16, v226
    v_and_b32 v226, s22, v226
    v_mfma_f32_16x16x32_bf16 a[100:103], a[232:235], v[236:239], a[100:103]
    s_waitcnt vmcnt(13) lgkmcnt(1)
    v_add_f32 v252, v252, v248
    v_add_f32 v226, v226, v218
    v_mfma_f32_16x16x32_bf16 a[104:107], a[236:239], v[236:239], a[104:107]
    ds_read_b128 v[236:239], v253 offset:2336
    v_fmac_f32 v252, s23, v250
    v_mfma_f32_16x16x32_bf16 a[96:99], a[240:243], v[228:231], a[96:99]
    buffer_load_dwordx4 a[208:211], v254, s[8:11], s42 offen offset:1024 sc1
    v_mfma_f32_16x16x32_bf16 a[100:103], a[244:247], v[228:231], a[100:103]
    v_fmac_f32 v226, s23, v222
    v_cvt_pk_bf16_f32 v226, v252, v226
    v_mfma_f32_16x16x32_bf16 a[104:107], a[248:251], v[228:231], a[104:107]
    v_fma_f32 v252, v249, s24, v251
    v_fmac_f32 v251, s25, v249
    v_fma_f32 v249, v248, s24, v250
    v_mfma_f32_16x16x32_bf16 a[108:111], a[228:231], v[228:231], a[108:111]
    s_waitcnt lgkmcnt(1)
    v_fmac_f32 v250, s25, v248
    v_fma_f32 v248, v250, s26, v251
    v_mfma_f32_16x16x32_bf16 a[108:111], a[240:243], v[232:235], a[108:111]
    buffer_load_dwordx4 a[212:215], v254, s[8:11], s42 offen offset:2048 sc1
    v_mfma_f32_16x16x32_bf16 a[112:115], a[244:247], v[232:235], a[112:115]
    v_fmac_f32 v251, s27, v250
    v_fma_f32 v250, v249, s28, v252
    v_mfma_f32_16x16x32_bf16 a[112:115], a[232:235], v[228:231], a[112:115]
    s_add_u32 s42, s32, 669696
    v_fmac_f32 v252, s29, v249
    v_fma_f32 v249, v220, s24, v224
    v_mfma_f32_16x16x32_bf16 a[116:119], a[236:239], v[228:231], a[116:119]
    ds_read_b128 v[228:231], v253 offset:2080
    v_fmac_f32 v224, s25, v220
    v_mfma_f32_16x16x32_bf16 a[116:119], a[248:251], v[232:235], a[116:119]
    buffer_load_dwordx4 a[216:219], v254, s[8:11], s42 offen offset:0 sc1
    s_waitcnt vmcnt(13)
    v_mfma_f32_16x16x32_bf16 a[96:99], a[252:255], v[232:235], a[96:99]
    v_fma_f32 v220, v218, s24, v222
    v_fmac_f32 v222, s25, v218
    v_mfma_f32_16x16x32_bf16 a[100:103], v[240:243], v[232:235], a[100:103]
    v_fma_f32 v218, v222, s26, v224
    v_fmac_f32 v224, s27, v222
    v_mfma_f32_16x16x32_bf16 a[104:107], v[244:247], v[232:235], a[104:107]
    s_waitcnt lgkmcnt(1)
    v_fma_f32 v222, v220, s28, v249
    v_fmac_f32 v249, s29, v220
    v_mfma_f32_16x16x32_bf16 a[120:123], a[228:231], v[232:235], a[120:123]
    buffer_load_dwordx4 a[220:223], v254, s[8:11], s42 offen offset:1024 sc1
    v_cvt_pk_bf16_f32 v218, v248, v218
    v_mfma_f32_16x16x32_bf16 a[120:123], a[240:243], v[236:239], a[120:123]
    v_cvt_pk_bf16_f32 v224, v251, v224
    v_cvt_pk_bf16_f32 v222, v250, v222
    v_mfma_f32_16x16x32_bf16 a[124:127], a[244:247], v[236:239], a[124:127]
    v_cvt_pk_bf16_f32 v220, v252, v249
    v_lshlrev_b32 v248, 16, v219
    v_mfma_f32_16x16x32_bf16 a[124:127], a[232:235], v[232:235], a[124:127]
    buffer_load_dwordx4 a[224:227], v254, s[8:11], s42 offen offset:2048 sc1
    v_mfma_f32_16x16x32_bf16 a[128:131], a[236:239], v[232:235], a[128:131]
    ds_read_b128 v[232:235], v253 offset:3904
    v_and_b32 v215, 0x7fff, v255
    v_mfma_f32_16x16x32_bf16 a[128:131], a[248:251], v[236:239], a[128:131]
    v_lshlrev_b32 v249, 16, v221
    v_lshlrev_b32 v250, 16, v223
    v_mfma_f32_16x16x32_bf16 a[108:111], a[252:255], v[236:239], a[108:111]
    buffer_load_dwordx2 v[204:205], v215, s[4:7], s16 offen offset:1472
    v_mfma_f32_16x16x32_bf16 a[112:115], v[240:243], v[236:239], a[112:115]
    v_lshlrev_b32 v251, 16, v225
    v_and_b32 v219, s22, v219
    v_mfma_f32_16x16x32_bf16 a[116:119], v[244:247], v[236:239], a[116:119]
    s_waitcnt lgkmcnt(1)
    v_and_b32 v221, s22, v221
    v_and_b32 v223, s22, v223
    v_mfma_f32_16x16x32_bf16 a[132:135], a[228:231], v[236:239], a[132:135]
    buffer_load_dwordx2 v[206:207], v215, s[4:7], s17 offen offset:1472
    v_mfma_f32_16x16x32_bf16 a[132:135], a[240:243], v[228:231], a[132:135]
    v_and_b32 v225, s22, v225
    v_lshlrev_b32 v252, 16, v217
    v_and_b32 v217, s22, v217
    v_mfma_f32_16x16x32_bf16 a[136:139], a[244:247], v[228:231], a[136:139]
    v_add_f32 v252, v252, v251
    v_add_f32 v217, v217, v225
    v_mfma_f32_16x16x32_bf16 a[136:139], a[232:235], v[236:239], a[136:139]
    buffer_load_dwordx2 v[208:209], v215, s[4:7], s18 offen offset:1472
    v_mfma_f32_16x16x32_bf16 a[140:143], a[236:239], v[236:239], a[140:143]
pad6:
    s_cbranch_vccnz pad10
    ds_read_b128 v[236:239], v253 offset:3648
    v_fmac_f32 v252, s23, v249
    v_mfma_f32_16x16x32_bf16 a[140:143], a[248:251], v[228:231], a[140:143]
    v_fmac_f32 v217, s23, v221
    v_cvt_pk_bf16_f32 v217, v252, v217
    v_mfma_f32_16x16x32_bf16 a[120:123], a[252:255], v[228:231], a[120:123]
    buffer_load_dwordx2 v[210:211], v215, s[4:7], s19 offen offset:1472
    v_mfma_f32_16x16x32_bf16 a[124:127], v[240:243], v[228:231], a[124:127]
    v_lshlrev_b32 v252, 16, v227
    v_and_b32 v227, s22, v227
    v_mfma_f32_16x16x32_bf16 a[128:131], v[244:247], v[228:231], a[128:131]
    s_waitcnt lgkmcnt(1)
    v_add_f32 v252, v252, v248
    v_add_f32 v227, v227, v219
    v_mfma_f32_16x16x32_bf16 a[144:147], a[228:231], v[228:231], a[144:147]
    buffer_load_dwordx2 v[212:213], v215, s[4:7], s20 offen offset:1472
    v_mfma_f32_16x16x32_bf16 a[144:147], a[240:243], v[232:235], a[144:147]
    v_fmac_f32 v252, s23, v250
    v_fmac_f32 v227, s23, v223
    v_mfma_f32_16x16x32_bf16 a[148:151], a[244:247], v[232:235], a[148:151]
    v_cvt_pk_bf16_f32 v227, v252, v227
    v_fma_f32 v252, v249, s24, v251
    v_fmac_f32 v251, s25, v249
    v_mfma_f32_16x16x32_bf16 a[148:151], a[232:235], v[228:231], a[148:151]
    buffer_load_dwordx2 v[214:215], v215, s[4:7], s21 offen offset:1472
    v_mfma_f32_16x16x32_bf16 a[152:155], a[236:239], v[228:231], a[152:155]
    ds_read_b128 v[228:231], v253 offset:3392
    v_fma_f32 v249, v248, s24, v250
    v_mfma_f32_16x16x32_bf16 a[152:155], a[248:251], v[232:235], a[152:155]
    v_fmac_f32 v250, s25, v248
    v_fma_f32 v248, v250, s26, v251
    v_mfma_f32_16x16x32_bf16 a[132:135], a[252:255], v[232:235], a[132:135]
    v_fmac_f32 v251, s27, v250
    v_fma_f32 v250, v249, s28, v252
    v_mfma_f32_16x16x32_bf16 a[136:139], v[240:243], v[232:235], a[136:139]
    v_fmac_f32 v252, s29, v249
    v_fma_f32 v249, v221, s24, v225
    v_mfma_f32_16x16x32_bf16 a[140:143], v[244:247], v[232:235], a[140:143]
    v_fmac_f32 v225, s25, v221
    v_fma_f32 v221, v219, s24, v223
    v_mfma_f32_16x16x32_bf16 a[156:159], a[228:231], v[232:235], a[156:159]
    s_waitcnt lgkmcnt(1)
    v_fmac_f32 v223, s25, v219
    v_fma_f32 v219, v223, s26, v225
    v_mfma_f32_16x16x32_bf16 a[156:159], a[240:243], v[236:239], a[156:159]
    v_fmac_f32 v225, s27, v223
    v_fma_f32 v223, v221, s28, v249
    v_mfma_f32_16x16x32_bf16 a[160:163], a[244:247], v[236:239], a[160:163]
    v_fmac_f32 v249, s29, v221
    v_cvt_pk_bf16_f32 v219, v248, v219
    v_mfma_f32_16x16x32_bf16 a[160:163], a[232:235], v[232:235], a[160:163]
    v_cvt_pk_bf16_f32 v225, v251, v225
    v_cvt_pk_bf16_f32 v223, v250, v223
    v_cvt_pk_bf16_f32 v221, v252, v249
    v_mfma_f32_16x16x32_bf16 a[164:167], a[236:239], v[232:235], a[164:167]
    ds_read_b128 v[232:235], v253 offset:3136
    v_lshrrev_b32 v252, 15, v255
    v_mfma_f32_16x16x32_bf16 a[164:167], a[248:251], v[236:239], a[164:167]
    ds_write_b64 v252, v[218:219] offset:8832
    v_mfma_f32_16x16x32_bf16 a[144:147], a[252:255], v[236:239], a[144:147]
    s_waitcnt vmcnt(15)
    v_lshlrev_b32 v248, 16, v194
    v_lshlrev_b32 v249, 16, v196
    v_mfma_f32_16x16x32_bf16 a[148:151], v[240:243], v[236:239], a[148:151]
    ds_write_b64 v252, v[224:225] offset:10912
    v_mfma_f32_16x16x32_bf16 a[152:155], v[244:247], v[236:239], a[152:155]
    s_waitcnt lgkmcnt(3)
    v_lshlrev_b32 v250, 16, v198
    v_lshlrev_b32 v251, 16, v200
    v_mfma_f32_16x16x32_bf16 a[168:171], a[228:231], v[236:239], a[168:171]
    ds_write_b64 v252, v[222:223] offset:12992
    v_mfma_f32_16x16x32_bf16 a[168:171], a[240:243], v[228:231], a[168:171]
    v_and_b32 v194, s22, v194
    v_and_b32 v196, s22, v196
    v_mfma_f32_16x16x32_bf16 a[172:175], a[244:247], v[228:231], a[172:175]
    ds_write_b64 v252, v[216:217] offset:23392
    v_mfma_f32_16x16x32_bf16 a[172:175], a[232:235], v[236:239], a[172:175]
    v_and_b32 v198, s22, v198
    v_and_b32 v200, s22, v200
    v_mfma_f32_16x16x32_bf16 a[176:179], a[236:239], v[236:239], a[176:179]
    ds_read_b128 v[236:239], v253 offset:2864
    v_mfma_f32_16x16x32_bf16 a[176:179], a[248:251], v[228:231], a[176:179]
    ds_write_b64 v252, v[226:227] offset:31712
    v_mfma_f32_16x16x32_bf16 a[156:159], a[252:255], v[228:231], a[156:159]
    v_mfma_f32_16x16x32_bf16 a[160:163], v[240:243], v[228:231], a[160:163]
    ds_write_b64 v252, v[220:221] offset:512
    v_mfma_f32_16x16x32_bf16 a[164:167], v[244:247], v[228:231], a[164:167]
    s_add_u32 s42, s32, 700416
    v_mfma_f32_16x16x32_bf16 a[180:183], a[228:231], v[228:231], a[180:183]
    buffer_load_dwordx4 a[228:231], v254, s[8:11], s42 offen offset:0 sc1
    v_lshlrev_b32 v252, 16, v192
    v_mfma_f32_16x16x32_bf16 a[184:187], a[232:235], v[228:231], a[184:187]
    v_and_b32 v192, s22, v192
    v_add_f32 v252, v252, v251
    v_mfma_f32_16x16x32_bf16 a[188:191], a[236:239], v[228:231], a[188:191]
    s_waitcnt lgkmcnt(2)
    v_add_f32 v192, v192, v200
    v_fmac_f32 v252, s23, v249
    v_mfma_f32_16x16x32_bf16 a[180:183], a[240:243], v[232:235], a[180:183]
    ds_read_b128 v[228:231], v253 offset:5200
    v_fmac_f32 v192, s23, v196
    v_mfma_f32_16x16x32_bf16 a[184:187], a[244:247], v[232:235], a[184:187]
    buffer_load_dwordx4 a[232:235], v254, s[8:11], s42 offen offset:1024 sc1
    v_mfma_f32_16x16x32_bf16 a[188:191], a[248:251], v[232:235], a[188:191]
    ds_read_b128 v[216:219], v253 offset:40480
    v_cvt_pk_bf16_f32 v192, v252, v192
    v_lshlrev_b32 v252, 16, v202
    v_mfma_f32_16x16x32_bf16 a[168:171], a[252:255], v[232:235], a[168:171]
    s_mov_b32 s45, 503518347
    v_and_b32 v202, s22, v202
    v_add_f32 v252, v252, v248
    v_mfma_f32_16x16x32_bf16 a[172:175], v[240:243], v[232:235], a[172:175]
    buffer_load_dwordx4 a[236:239], v254, s[8:11], s42 offen offset:2048 sc1
    v_mfma_f32_16x16x32_bf16 a[176:179], v[244:247], v[232:235], a[176:179]
    ds_read_b128 v[232:235], v253 offset:4928
    v_add_f32 v202, v202, v194
    v_mfma_f32_16x16x32_bf16 a[180:183], a[252:255], v[236:239], a[180:183]
    s_add_u32 s42, s32, 703488
    v_bfe_u32 v220, v254, 5, 3
    v_fmac_f32 v252, s23, v250
    v_mfma_f32_16x16x32_bf16 a[184:187], v[240:243], v[236:239], a[184:187]
    buffer_load_dwordx4 a[240:243], v254, s[8:11], s42 offen offset:0 sc1
    v_fmac_f32 v202, s23, v198
    v_mfma_f32_16x16x32_bf16 a[188:191], v[244:247], v[236:239], a[188:191]
    ds_read_b128 v[236:239], v253 offset:4672
    v_mul_u32_u24 v221, 5, v220
    s_waitcnt vmcnt(16)
    s_waitcnt lgkmcnt(3)
sub18:
    v_mfma_f32_16x16x32_bf16 v[0:3], a[192:195], v[228:231], v[0:3]
    v_cvt_pk_bf16_f32 v202, v252, v202
    v_fma_f32 v252, v249, s24, v251
    v_mfma_f32_16x16x32_bf16 v[4:7], a[196:199], v[228:231], v[4:7]
    s_waitcnt vmcnt(13) lgkmcnt(1)
    v_fmac_f32 v251, s25, v249
    v_fma_f32 v249, v248, s24, v250
    v_mfma_f32_16x16x32_bf16 v[8:11], a[200:203], v[228:231], v[8:11]
    ds_read_b128 v[228:231], v253 offset:4416
    v_bfe_u32 v221, s45, v221, 5
    v_mfma_f32_16x16x32_bf16 v[0:3], a[204:207], v[232:235], v[0:3]
    buffer_load_dwordx4 a[244:247], v254, s[8:11], s42 offen offset:1024 sc1
    v_fmac_f32 v250, s25, v248
    v_mfma_f32_16x16x32_bf16 v[4:7], a[208:211], v[232:235], v[4:7]
    v_fma_f32 v248, v250, s26, v251
    v_fmac_f32 v251, s27, v250
    v_mfma_f32_16x16x32_bf16 v[8:11], a[212:215], v[232:235], v[8:11]
    v_mul_u32_u24 v221, 65, v221
    v_fma_f32 v250, v249, s28, v252
    v_mfma_f32_16x16x32_bf16 v[12:15], a[192:195], v[232:235], v[12:15]
    s_waitcnt lgkmcnt(1)
    v_fmac_f32 v252, s29, v249
    v_fma_f32 v249, v196, s24, v200
    v_mfma_f32_16x16x32_bf16 v[12:15], a[204:207], v[236:239], v[12:15]
    buffer_load_dwordx4 a[248:251], v254, s[8:11], s42 offen offset:2048 sc1
    v_mfma_f32_16x16x32_bf16 v[16:19], a[208:211], v[236:239], v[16:19]
    v_sub_u32 v221, v221, v220
    v_fmac_f32 v200, s25, v196
    v_fma_f32 v196, v194, s24, v198
    v_mfma_f32_16x16x32_bf16 v[16:19], a[196:199], v[232:235], v[16:19]
    s_add_u32 s42, s32, 706560
    v_fmac_f32 v198, s25, v194
    v_fma_f32 v194, v198, s26, v200
    v_mfma_f32_16x16x32_bf16 v[20:23], a[200:203], v[232:235], v[20:23]
    ds_read_b128 v[232:235], v253 offset:4160
    v_lshl_add_u32 v220, v221, 5, v253
    v_mfma_f32_16x16x32_bf16 v[20:23], a[212:215], v[236:239], v[20:23]
    buffer_load_dwordx4 a[252:255], v254, s[8:11], s42 offen offset:0 sc1
    s_waitcnt vmcnt(13)
    v_mfma_f32_16x16x32_bf16 v[0:3], a[216:219], v[236:239], v[0:3]
    v_fmac_f32 v200, s27, v198
    v_fma_f32 v198, v196, s28, v249
    v_mfma_f32_16x16x32_bf16 v[4:7], a[220:223], v[236:239], v[4:7]
    v_fmac_f32 v249, s29, v196
    v_cvt_pk_bf16_f32 v194, v248, v194
    v_cvt_pk_bf16_f32 v200, v251, v200
    v_mfma_f32_16x16x32_bf16 v[8:11], a[224:227], v[236:239], v[8:11]
    s_waitcnt lgkmcnt(1)
    v_cvt_pk_bf16_f32 v198, v250, v198
    v_cvt_pk_bf16_f32 v196, v252, v249
    v_mfma_f32_16x16x32_bf16 v[24:27], a[192:195], v[236:239], v[24:27]
    buffer_load_dwordx4 v[240:243], v254, s[8:11], s42 offen offset:1024 sc1
    v_mfma_f32_16x16x32_bf16 v[24:27], a[204:207], v[228:231], v[24:27]
    s_mov_b64 exec, s[46:47]
    ds_write_b128 v220, v[216:219] offset:1024
    s_mov_b64 exec, -1
    v_mfma_f32_16x16x32_bf16 v[28:31], a[208:211], v[228:231], v[28:31]
    v_lshlrev_b32 v248, 16, v195
    v_lshlrev_b32 v249, 16, v197
    v_mfma_f32_16x16x32_bf16 v[28:31], a[196:199], v[236:239], v[28:31]
    buffer_load_dwordx4 v[244:247], v254, s[8:11], s42 offen offset:2048 sc1
    v_lshlrev_b32 v250, 16, v199
    v_mfma_f32_16x16x32_bf16 v[32:35], a[200:203], v[236:239], v[32:35]
    ds_read_b128 v[236:239], v253 offset:5984
    v_and_b32 v222, 0x1f0, v254
    v_mfma_f32_16x16x32_bf16 v[32:35], a[212:215], v[228:231], v[32:35]
    s_add_u32 s49, s49, 8
    v_mul_u32_u24 v222, 96, v222
    v_lshlrev_b32 v251, 16, v201
    v_mfma_f32_16x16x32_bf16 v[12:15], a[216:219], v[228:231], v[12:15]
    buffer_load_dword v222, v222, s[4:7], s33 offen offset:0
    v_mfma_f32_16x16x32_bf16 v[16:19], a[220:223], v[228:231], v[16:19]
    s_cmp_eq_u32 s39, 1
    s_cselect_b32 s49, 128, s49
    v_and_b32 v195, s22, v195
    v_mfma_f32_16x16x32_bf16 v[20:23], a[224:227], v[228:231], v[20:23]
    v_and_b32 v197, s22, v197
    v_and_b32 v199, s22, v199
    v_and_b32 v201, s22, v201
    v_mfma_f32_16x16x32_bf16 v[36:39], a[192:195], v[228:231], v[36:39]
    s_waitcnt lgkmcnt(2)
    v_lshlrev_b32 v252, 16, v193
    v_and_b32 v193, s22, v193
    v_mfma_f32_16x16x32_bf16 v[36:39], a[204:207], v[232:235], v[36:39]
    s_mul_i32 s43, s49, 786432
    v_add_f32 v252, v252, v251
    v_add_f32 v193, v193, v201
    v_mfma_f32_16x16x32_bf16 v[40:43], a[208:211], v[232:235], v[40:43]
    v_fmac_f32 v252, s23, v249
    v_fmac_f32 v193, s23, v197
    v_mfma_f32_16x16x32_bf16 v[40:43], a[196:199], v[228:231], v[40:43]
    v_cvt_pk_bf16_f32 v193, v252, v193
    v_lshlrev_b32 v252, 16, v203
    v_mfma_f32_16x16x32_bf16 v[44:47], a[200:203], v[228:231], v[44:47]
    ds_read_b128 v[228:231], v253 offset:5728
    s_add_u32 s43, s43, s53
    v_and_b32 v203, s22, v203
    v_mfma_f32_16x16x32_bf16 v[44:47], a[212:215], v[232:235], v[44:47]
    v_add_f32 v252, v252, v248
    v_add_f32 v203, v203, v195
    v_mfma_f32_16x16x32_bf16 v[24:27], a[216:219], v[232:235], v[24:27]
    v_fmac_f32 v252, s23, v250
    v_fmac_f32 v203, s23, v199
    v_mfma_f32_16x16x32_bf16 v[28:31], a[220:223], v[232:235], v[28:31]
    s_cmp_ge_u32 s49, 128
    s_cselect_b32 s43, 2130706432, s43
    v_cvt_pk_bf16_f32 v203, v252, v203
    v_mfma_f32_16x16x32_bf16 v[32:35], a[224:227], v[232:235], v[32:35]
    s_waitcnt lgkmcnt(1)
    v_fma_f32 v252, v249, s24, v251
    v_fmac_f32 v251, s25, v249
    v_mfma_f32_16x16x32_bf16 v[48:51], a[192:195], v[232:235], v[48:51]
    s_sub_u32 s16, s43, 196608
    v_fma_f32 v249, v248, s24, v250
    v_fmac_f32 v250, s25, v248
    v_fma_f32 v248, v250, s26, v251
    v_mfma_f32_16x16x32_bf16 v[48:51], a[204:207], v[236:239], v[48:51]
    v_fmac_f32 v251, s27, v250
    v_fma_f32 v250, v249, s28, v252
    v_mfma_f32_16x16x32_bf16 v[52:55], a[208:211], v[236:239], v[52:55]
    v_fmac_f32 v252, s29, v249
    v_fma_f32 v249, v197, s24, v201
    v_mfma_f32_16x16x32_bf16 v[52:55], a[196:199], v[232:235], v[52:55]
    s_cmp_eq_u32 s49, 0
    s_cselect_b32 s16, 2130706432, s16
    v_fmac_f32 v201, s25, v197
    v_mfma_f32_16x16x32_bf16 v[56:59], a[200:203], v[232:235], v[56:59]
    ds_read_b128 v[232:235], v253 offset:5472
    v_fma_f32 v197, v195, s24, v199
    v_mfma_f32_16x16x32_bf16 v[56:59], a[212:215], v[236:239], v[56:59]
    v_fmac_f32 v199, s25, v195
    v_fma_f32 v195, v199, s26, v201
    v_fmac_f32 v201, s27, v199
    v_mfma_f32_16x16x32_bf16 v[36:39], a[216:219], v[236:239], v[36:39]
    s_mov_b32 s17, s43
    v_fma_f32 v199, v197, s28, v249
    v_fmac_f32 v249, s29, v197
    v_mfma_f32_16x16x32_bf16 v[40:43], a[220:223], v[236:239], v[40:43]
    v_cvt_pk_bf16_f32 v195, v248, v195
    v_cvt_pk_bf16_f32 v201, v251, v201
    v_mfma_f32_16x16x32_bf16 v[44:47], a[224:227], v[236:239], v[44:47]
    s_waitcnt lgkmcnt(1)
    v_cvt_pk_bf16_f32 v199, v250, v199
    v_cvt_pk_bf16_f32 v197, v252, v249
    v_mfma_f32_16x16x32_bf16 v[60:63], a[192:195], v[236:239], v[60:63]
    s_add_u32 s18, s43, 196608
    v_lshrrev_b32 v252, 15, v255
    v_mfma_f32_16x16x32_bf16 v[60:63], a[204:207], v[228:231], v[60:63]
    ds_write_b64 v252, v[194:195] offset:8576
    s_waitcnt vmcnt(10)
    v_mfma_f32_16x16x32_bf16 v[64:67], a[208:211], v[228:231], v[64:67]
    s_add_u32 s19, s43, 393216
    v_lshlrev_b32 v248, 16, v206
    v_lshlrev_b32 v249, 16, v208
    v_mfma_f32_16x16x32_bf16 v[64:67], a[196:199], v[236:239], v[64:67]
    ds_write_b64 v252, v[200:201] offset:10656
    v_mfma_f32_16x16x32_bf16 v[68:71], a[200:203], v[236:239], v[68:71]
    ds_read_b128 v[236:239], v253 offset:5216
    v_lshlrev_b32 v250, 16, v210
    v_mfma_f32_16x16x32_bf16 v[68:71], a[212:215], v[228:231], v[68:71]
    s_add_u32 s20, s43, 589824
    v_lshlrev_b32 v251, 16, v212
    v_mfma_f32_16x16x32_bf16 v[48:51], a[216:219], v[228:231], v[48:51]
    ds_write_b64 v252, v[198:199] offset:12736
    v_and_b32 v206, s22, v206
    v_mfma_f32_16x16x32_bf16 v[52:55], a[220:223], v[228:231], v[52:55]
    s_waitcnt lgkmcnt(4)
    v_and_b32 v208, s22, v208
    v_mfma_f32_16x16x32_bf16 v[56:59], a[224:227], v[228:231], v[56:59]
    s_add_u32 s21, s43, 786432
    v_mfma_f32_16x16x32_bf16 v[72:75], a[192:195], v[228:231], v[72:75]
    ds_write_b64 v252, v[192:193] offset:23136
    v_mfma_f32_16x16x32_bf16 v[72:75], a[204:207], v[232:235], v[72:75]
    v_and_b32 v210, s22, v210
    v_and_b32 v212, s22, v212
    v_mfma_f32_16x16x32_bf16 v[76:79], a[208:211], v[232:235], v[76:79]
    s_add_u32 s100, s43, s101
    v_mfma_f32_16x16x32_bf16 v[76:79], a[196:199], v[228:231], v[76:79]
    ds_write_b64 v252, v[202:203] offset:31456
    v_mfma_f32_16x16x32_bf16 v[80:83], a[200:203], v[228:231], v[80:83]
    ds_read_b128 v[228:231], v253 offset:4944
    v_mfma_f32_16x16x32_bf16 v[80:83], a[212:215], v[232:235], v[80:83]
    ds_write_b64 v252, v[196:197] offset:256
    v_mfma_f32_16x16x32_bf16 v[60:63], a[216:219], v[232:235], v[60:63]
    v_mfma_f32_16x16x32_bf16 v[64:67], a[220:223], v[232:235], v[64:67]
    v_mfma_f32_16x16x32_bf16 v[68:71], a[224:227], v[232:235], v[68:71]
    s_add_u32 s42, s35, 737280
    v_mfma_f32_16x16x32_bf16 v[84:87], a[192:195], v[232:235], v[84:87]
    buffer_load_dwordx4 a[192:195], v254, s[8:11], s42 offen offset:0 sc1
    v_mfma_f32_16x16x32_bf16 v[88:91], a[196:199], v[232:235], v[88:91]
    v_lshlrev_b32 v252, 16, v204
    v_and_b32 v204, s22, v204
    v_mfma_f32_16x16x32_bf16 v[92:95], a[200:203], v[232:235], v[92:95]
    s_waitcnt lgkmcnt(5)
    v_add_f32 v252, v252, v251
    v_add_f32 v204, v204, v212
    v_mfma_f32_16x16x32_bf16 v[84:87], a[204:207], v[236:239], v[84:87]
    ds_read_b128 v[232:235], v253 offset:7280
    v_fmac_f32 v252, s23, v249
    v_fmac_f32 v204, s23, v208
    v_mfma_f32_16x16x32_bf16 v[88:91], a[208:211], v[236:239], v[88:91]
    buffer_load_dwordx4 a[196:199], v254, s[8:11], s42 offen offset:1024 sc1
    v_mfma_f32_16x16x32_bf16 v[92:95], a[212:215], v[236:239], v[92:95]
    v_cvt_pk_bf16_f32 v204, v252, v204
    v_lshlrev_b32 v252, 16, v214
    v_mfma_f32_16x16x32_bf16 v[72:75], a[216:219], v[236:239], v[72:75]
    s_waitcnt lgkmcnt(2)
    v_and_b32 v214, s22, v214
    v_add_f32 v252, v252, v248
    v_mfma_f32_16x16x32_bf16 v[76:79], a[220:223], v[236:239], v[76:79]
    buffer_load_dwordx4 a[200:203], v254, s[8:11], s42 offen offset:2048 sc1
    v_mfma_f32_16x16x32_bf16 v[80:83], a[224:227], v[236:239], v[80:83]
    ds_read_b128 v[236:239], v253 offset:7008
    v_add_f32 v214, v214, v206
    v_mfma_f32_16x16x32_bf16 v[84:87], a[216:219], v[228:231], v[84:87]
    s_add_u32 s42, s35, 740352
    v_fmac_f32 v252, s23, v250
    v_fmac_f32 v214, s23, v210
    v_mfma_f32_16x16x32_bf16 v[88:91], a[220:223], v[228:231], v[88:91]
    buffer_load_dwordx4 a[204:207], v254, s[8:11], s42 offen offset:0 sc1
    v_mfma_f32_16x16x32_bf16 v[92:95], a[224:227], v[228:231], v[92:95]
    ds_read_b128 v[228:231], v253 offset:6752
    v_cvt_pk_bf16_f32 v214, v252, v214
    s_waitcnt vmcnt(11)
    s_waitcnt lgkmcnt(2)
sub19:
    v_mfma_f32_16x16x32_bf16 v[96:99], a[228:231], v[232:235], v[96:99]
    v_fma_f32 v252, v249, s24, v251
    v_fmac_f32 v251, s25, v249
    v_mfma_f32_16x16x32_bf16 v[100:103], a[232:235], v[232:235], v[100:103]
    s_waitcnt vmcnt(8) lgkmcnt(1)
    v_fma_f32 v249, v248, s24, v250
    v_fmac_f32 v250, s25, v248
    v_fma_f32 v248, v250, s26, v251
    v_mfma_f32_16x16x32_bf16 v[104:107], a[236:239], v[232:235], v[104:107]
    ds_read_b128 v[232:235], v253 offset:6496
    v_fmac_f32 v251, s27, v250
    v_mfma_f32_16x16x32_bf16 v[96:99], a[240:243], v[236:239], v[96:99]
    buffer_load_dwordx4 a[208:211], v254, s[8:11], s42 offen offset:1024 sc1
    v_mfma_f32_16x16x32_bf16 v[100:103], a[244:247], v[236:239], v[100:103]
    v_fma_f32 v250, v249, s28, v252
    v_fmac_f32 v252, s29, v249
    v_mfma_f32_16x16x32_bf16 v[104:107], a[248:251], v[236:239], v[104:107]
    v_fma_f32 v249, v208, s24, v212
    v_fmac_f32 v212, s25, v208
    v_mfma_f32_16x16x32_bf16 v[108:111], a[228:231], v[236:239], v[108:111]
    s_waitcnt lgkmcnt(1)
    v_fma_f32 v208, v206, s24, v210
    v_fmac_f32 v210, s25, v206
    v_mfma_f32_16x16x32_bf16 v[108:111], a[240:243], v[228:231], v[108:111]
    buffer_load_dwordx4 a[212:215], v254, s[8:11], s42 offen offset:2048 sc1
    v_mfma_f32_16x16x32_bf16 v[112:115], a[244:247], v[228:231], v[112:115]
    v_and_b32 v203, 0xf0, v254
    v_lshrrev_b32 v203, 1, v203
    v_mfma_f32_16x16x32_bf16 v[112:115], a[232:235], v[236:239], v[112:115]
    s_add_u32 s42, s35, 743424
    v_add_u32 v203, s52, v203
    v_mov_b32 v202, s54
    v_mfma_f32_16x16x32_bf16 v[116:119], a[236:239], v[236:239], v[116:119]
    ds_read_b128 v[236:239], v253 offset:6240
    v_mov_b32 v201, s55
    v_mfma_f32_16x16x32_bf16 v[116:119], a[248:251], v[228:231], v[116:119]
    buffer_load_dwordx4 a[216:219], v254, s[8:11], s42 offen offset:0 sc1
    v_fma_f32 v206, v210, s26, v212
    s_waitcnt vmcnt(8)
    v_mfma_f32_16x16x32_bf16 v[96:99], a[252:255], v[228:231], v[96:99]
    v_cndmask_b32 v202, v202, v201, s[56:57]
    v_add_u32 v203, v203, v202
    v_mfma_f32_16x16x32_bf16 v[100:103], v[240:243], v[228:231], v[100:103]
    s_sub_u32 s45, s16, s50
    v_fmac_f32 v212, s27, v210
    v_fma_f32 v210, v208, s28, v249
    v_mfma_f32_16x16x32_bf16 v[104:107], v[244:247], v[228:231], v[104:107]
    s_waitcnt lgkmcnt(1)
    v_fmac_f32 v249, s29, v208
    v_cvt_pk_bf16_f32 v206, v248, v206
    v_mfma_f32_16x16x32_bf16 v[120:123], a[228:231], v[228:231], v[120:123]
    buffer_load_dwordx4 a[220:223], v254, s[8:11], s42 offen offset:1024 sc1
    v_mfma_f32_16x16x32_bf16 v[120:123], a[240:243], v[232:235], v[120:123]
    v_cvt_pk_bf16_f32 v212, v251, v212
    v_cvt_pk_bf16_f32 v210, v250, v210
    v_mfma_f32_16x16x32_bf16 v[124:127], a[244:247], v[232:235], v[124:127]
    v_cvt_pk_bf16_f32 v208, v252, v249
    v_lshlrev_b32 v248, 16, v207
    v_mfma_f32_16x16x32_bf16 v[124:127], a[232:235], v[228:231], v[124:127]
    buffer_load_dwordx4 a[224:227], v254, s[8:11], s42 offen offset:2048 sc1
    v_mfma_f32_16x16x32_bf16 v[128:131], a[236:239], v[228:231], v[128:131]
    ds_read_b128 v[228:231], v253 offset:8064
    v_lshlrev_b32 v249, 16, v209
    v_mfma_f32_16x16x32_bf16 v[128:131], a[248:251], v[232:235], v[128:131]
    v_lshlrev_b32 v250, 16, v211
    v_lshlrev_b32 v251, 16, v213
    v_mfma_f32_16x16x32_bf16 v[108:111], a[252:255], v[232:235], v[108:111]
    buffer_load_dwordx2 v[192:193], v203, s[4:7], s45 offen
    v_and_b32 v207, s22, v207
    v_mfma_f32_16x16x32_bf16 v[112:115], v[240:243], v[232:235], v[112:115]
    s_sub_u32 s45, s17, s50
    v_and_b32 v209, s22, v209
    v_and_b32 v211, s22, v211
    v_mfma_f32_16x16x32_bf16 v[116:119], v[244:247], v[232:235], v[116:119]
    s_waitcnt lgkmcnt(1)
    v_and_b32 v213, s22, v213
    v_lshlrev_b32 v252, 16, v205
    v_mfma_f32_16x16x32_bf16 v[132:135], a[228:231], v[232:235], v[132:135]
    buffer_load_dwordx2 v[194:195], v203, s[4:7], s45 offen
    v_mfma_f32_16x16x32_bf16 v[132:135], a[240:243], v[236:239], v[132:135]
    s_sub_u32 s45, s18, s50
    v_and_b32 v205, s22, v205
    v_add_f32 v252, v252, v251
    v_mfma_f32_16x16x32_bf16 v[136:139], a[244:247], v[236:239], v[136:139]
    v_add_f32 v205, v205, v213
    v_fmac_f32 v252, s23, v249
    v_mfma_f32_16x16x32_bf16 v[136:139], a[232:235], v[232:235], v[136:139]
    buffer_load_dwordx2 v[196:197], v203, s[4:7], s45 offen
    v_mfma_f32_16x16x32_bf16 v[140:143], a[236:239], v[232:235], v[140:143]
    ds_read_b128 v[232:235], v253 offset:7808
    s_sub_u32 s45, s19, s50
    v_mfma_f32_16x16x32_bf16 v[140:143], a[248:251], v[236:239], v[140:143]
    v_fmac_f32 v205, s23, v209
    v_cvt_pk_bf16_f32 v205, v252, v205
    v_mfma_f32_16x16x32_bf16 v[120:123], a[252:255], v[236:239], v[120:123]
    buffer_load_dwordx2 v[198:199], v203, s[4:7], s45 offen
    v_mfma_f32_16x16x32_bf16 v[124:127], v[240:243], v[236:239], v[124:127]
    s_sub_u32 s45, s20, s50
    v_lshlrev_b32 v252, 16, v215
    v_and_b32 v215, s22, v215
    v_add_f32 v252, v252, v248
    v_mfma_f32_16x16x32_bf16 v[128:131], v[244:247], v[236:239], v[128:131]
    s_waitcnt lgkmcnt(1)
    v_add_f32 v215, v215, v207
    v_fmac_f32 v252, s23, v250
    v_mfma_f32_16x16x32_bf16 v[144:147], a[228:231], v[236:239], v[144:147]
    buffer_load_dwordx2 v[200:201], v203, s[4:7], s45 offen
    v_mfma_f32_16x16x32_bf16 v[144:147], a[240:243], v[228:231], v[144:147]
    s_sub_u32 s45, s21, s50
    v_fmac_f32 v215, s23, v211
    v_cvt_pk_bf16_f32 v215, v252, v215
    v_mfma_f32_16x16x32_bf16 v[148:151], a[244:247], v[228:231], v[148:151]
    v_fma_f32 v252, v249, s24, v251
    v_fmac_f32 v251, s25, v249
    v_mfma_f32_16x16x32_bf16 v[148:151], a[232:235], v[236:239], v[148:151]
    buffer_load_dwordx2 v[202:203], v203, s[4:7], s45 offen
    v_mfma_f32_16x16x32_bf16 v[152:155], a[236:239], v[236:239], v[152:155]
    ds_read_b128 v[236:239], v253 offset:7552
    v_fma_f32 v249, v248, s24, v250
    v_mfma_f32_16x16x32_bf16 v[152:155], a[248:251], v[228:231], v[152:155]
    v_fmac_f32 v250, s25, v248
    v_fma_f32 v248, v250, s26, v251
    v_mfma_f32_16x16x32_bf16 v[132:135], a[252:255], v[228:231], v[132:135]
    v_fmac_f32 v251, s27, v250
    v_fma_f32 v250, v249, s28, v252
    v_mfma_f32_16x16x32_bf16 v[136:139], v[240:243], v[228:231], v[136:139]
    v_fmac_f32 v252, s29, v249
    v_fma_f32 v249, v209, s24, v213
    v_mfma_f32_16x16x32_bf16 v[140:143], v[244:247], v[228:231], v[140:143]
    v_fmac_f32 v213, s25, v209
    v_fma_f32 v209, v207, s24, v211
    v_fmac_f32 v211, s25, v207
    v_mfma_f32_16x16x32_bf16 v[156:159], a[228:231], v[228:231], v[156:159]
    s_waitcnt lgkmcnt(1)
    v_fma_f32 v207, v211, s26, v213
    v_fmac_f32 v213, s27, v211
    v_mfma_f32_16x16x32_bf16 v[156:159], a[240:243], v[232:235], v[156:159]
    v_fma_f32 v211, v209, s28, v249
    v_fmac_f32 v249, s29, v209
    v_mfma_f32_16x16x32_bf16 v[160:163], a[244:247], v[232:235], v[160:163]
    v_cvt_pk_bf16_f32 v207, v248, v207
    v_cvt_pk_bf16_f32 v213, v251, v213
    v_mfma_f32_16x16x32_bf16 v[160:163], a[232:235], v[228:231], v[160:163]
    v_cvt_pk_bf16_f32 v211, v250, v211
    v_cvt_pk_bf16_f32 v209, v252, v249
    v_mfma_f32_16x16x32_bf16 v[164:167], a[236:239], v[228:231], v[164:167]
    ds_read_b128 v[228:231], v253 offset:7296
    v_lshrrev_b32 v252, 15, v255
    v_mfma_f32_16x16x32_bf16 v[164:167], a[248:251], v[232:235], v[164:167]
    ds_write_b64 v252, v[206:207] offset:8320
    v_mfma_f32_16x16x32_bf16 v[144:147], a[252:255], v[232:235], v[144:147]
    v_mfma_f32_16x16x32_bf16 v[148:151], v[240:243], v[232:235], v[148:151]
    ds_write_b64 v252, v[212:213] offset:10400
    v_mfma_f32_16x16x32_bf16 v[152:155], v[244:247], v[232:235], v[152:155]
    s_waitcnt lgkmcnt(3)
    v_mfma_f32_16x16x32_bf16 v[168:171], a[228:231], v[232:235], v[168:171]
    ds_write_b64 v252, v[210:211] offset:12480
    v_mfma_f32_16x16x32_bf16 v[168:171], a[240:243], v[236:239], v[168:171]
    v_mfma_f32_16x16x32_bf16 v[172:175], a[244:247], v[236:239], v[172:175]
    ds_write_b64 v252, v[204:205] offset:22880
    v_mfma_f32_16x16x32_bf16 v[172:175], a[232:235], v[232:235], v[172:175]
    v_mfma_f32_16x16x32_bf16 v[176:179], a[236:239], v[232:235], v[176:179]
    ds_read_b128 v[232:235], v253 offset:7024
    v_mfma_f32_16x16x32_bf16 v[176:179], a[248:251], v[236:239], v[176:179]
    ds_write_b64 v252, v[214:215] offset:31200
    v_mfma_f32_16x16x32_bf16 v[156:159], a[252:255], v[236:239], v[156:159]
    s_waitcnt lgkmcnt(6)
    v_mfma_f32_16x16x32_bf16 v[160:163], v[240:243], v[236:239], v[160:163]
    ds_write_b64 v252, v[208:209] offset:0
    v_mfma_f32_16x16x32_bf16 v[164:167], v[244:247], v[236:239], v[164:167]
    s_add_u32 s42, s35, 774144
    v_mfma_f32_16x16x32_bf16 v[180:183], a[228:231], v[236:239], v[180:183]
    buffer_load_dwordx4 a[228:231], v254, s[8:11], s42 offen offset:0 sc1
    v_mfma_f32_16x16x32_bf16 v[184:187], a[232:235], v[236:239], v[184:187]
    s_waitcnt lgkmcnt(0)
    v_mfma_f32_16x16x32_bf16 v[188:191], a[236:239], v[236:239], v[188:191]
    s_barrier
    v_mfma_f32_16x16x32_bf16 v[180:183], a[240:243], v[228:231], v[180:183]
    ds_read_b128 v[236:239], v253 offset:9360
    v_mfma_f32_16x16x32_bf16 v[184:187], a[244:247], v[228:231], v[184:187]
    buffer_load_dwordx4 a[232:235], v254, s[8:11], s42 offen offset:1024 sc1
    v_mfma_f32_16x16x32_bf16 v[188:191], a[248:251], v[228:231], v[188:191]
    v_mfma_f32_16x16x32_bf16 v[168:171], a[252:255], v[228:231], v[168:171]
    v_mfma_f32_16x16x32_bf16 v[172:175], v[240:243], v[228:231], v[172:175]
    buffer_load_dwordx4 a[236:239], v254, s[8:11], s42 offen offset:2048 sc1
    v_mfma_f32_16x16x32_bf16 v[176:179], v[244:247], v[228:231], v[176:179]
    ds_read_b128 v[228:231], v253 offset:9088
    v_mfma_f32_16x16x32_bf16 v[180:183], a[252:255], v[232:235], v[180:183]
    s_add_u32 s42, s35, 777216
    v_mfma_f32_16x16x32_bf16 v[184:187], v[240:243], v[232:235], v[184:187]
    buffer_load_dwordx4 a[240:243], v254, s[8:11], s42 offen offset:0 sc1
    v_mfma_f32_16x16x32_bf16 v[188:191], v[244:247], v[232:235], v[188:191]
    ds_read_b128 v[232:235], v253 offset:8832
    s_waitcnt vmcnt(16)
    s_waitcnt lgkmcnt(2)
sub20:
    v_mfma_f32_16x16x32_bf16 a[0:3], a[192:195], v[236:239], a[0:3]
    v_mfma_f32_16x16x32_bf16 a[4:7], a[196:199], v[236:239], a[4:7]
    s_waitcnt vmcnt(13) lgkmcnt(1)
    v_mfma_f32_16x16x32_bf16 a[8:11], a[200:203], v[236:239], a[8:11]
    ds_read_b128 v[236:239], v253 offset:8576
    v_mfma_f32_16x16x32_bf16 a[0:3], a[204:207], v[228:231], a[0:3]
    buffer_load_dwordx4 a[244:247], v254, s[8:11], s42 offen offset:1024 sc1
    v_mfma_f32_16x16x32_bf16 a[4:7], a[208:211], v[228:231], a[4:7]
    v_mfma_f32_16x16x32_bf16 a[8:11], a[212:215], v[228:231], a[8:11]
    v_mfma_f32_16x16x32_bf16 a[12:15], a[192:195], v[228:231], a[12:15]
    s_waitcnt lgkmcnt(1)
    v_mfma_f32_16x16x32_bf16 a[12:15], a[204:207], v[232:235], a[12:15]
    buffer_load_dwordx4 a[248:251], v254, s[8:11], s42 offen offset:2048 sc1
    v_mfma_f32_16x16x32_bf16 a[16:19], a[208:211], v[232:235], a[16:19]
    v_mfma_f32_16x16x32_bf16 a[16:19], a[196:199], v[228:231], a[16:19]
    s_add_u32 s42, s35, 780288
    v_mfma_f32_16x16x32_bf16 a[20:23], a[200:203], v[228:231], a[20:23]
    ds_read_b128 v[228:231], v253 offset:8320
    v_mfma_f32_16x16x32_bf16 a[20:23], a[212:215], v[232:235], a[20:23]
    buffer_load_dwordx4 a[252:255], v254, s[8:11], s42 offen offset:0 sc1
    s_waitcnt vmcnt(13)
    v_mfma_f32_16x16x32_bf16 a[0:3], a[216:219], v[232:235], a[0:3]
    v_mfma_f32_16x16x32_bf16 a[4:7], a[220:223], v[232:235], a[4:7]
    v_mfma_f32_16x16x32_bf16 a[8:11], a[224:227], v[232:235], a[8:11]
    s_waitcnt lgkmcnt(1)
    v_mfma_f32_16x16x32_bf16 a[24:27], a[192:195], v[232:235], a[24:27]
    buffer_load_dwordx4 v[240:243], v254, s[8:11], s42 offen offset:1024 sc1
    v_mfma_f32_16x16x32_bf16 a[24:27], a[204:207], v[236:239], a[24:27]
    v_mfma_f32_16x16x32_bf16 a[28:31], a[208:211], v[236:239], a[28:31]
    v_mfma_f32_16x16x32_bf16 a[28:31], a[196:199], v[232:235], a[28:31]
    buffer_load_dwordx4 v[244:247], v254, s[8:11], s42 offen offset:2048 sc1
    v_mfma_f32_16x16x32_bf16 a[32:35], a[200:203], v[232:235], a[32:35]
    ds_read_b128 v[232:235], v253 offset:10144
    v_and_b32 v226, 0x1f0, v254
    v_mfma_f32_16x16x32_bf16 a[32:35], a[212:215], v[236:239], a[32:35]
    v_mul_u32_u24 v226, 96, v226
    v_mfma_f32_16x16x32_bf16 a[12:15], a[216:219], v[236:239], a[12:15]
    buffer_load_dword v226, v226, s[4:7], s33 offen offset:384
    v_mfma_f32_16x16x32_bf16 a[16:19], a[220:223], v[236:239], a[16:19]
    v_mfma_f32_16x16x32_bf16 a[20:23], a[224:227], v[236:239], a[20:23]
    v_mfma_f32_16x16x32_bf16 a[36:39], a[192:195], v[236:239], a[36:39]
    s_waitcnt lgkmcnt(1)
    v_mfma_f32_16x16x32_bf16 a[36:39], a[204:207], v[228:231], a[36:39]
    v_mfma_f32_16x16x32_bf16 a[40:43], a[208:211], v[228:231], a[40:43]
    v_mfma_f32_16x16x32_bf16 a[40:43], a[196:199], v[236:239], a[40:43]
    v_mfma_f32_16x16x32_bf16 a[44:47], a[200:203], v[236:239], a[44:47]
    ds_read_b128 v[236:239], v253 offset:9888
    v_mfma_f32_16x16x32_bf16 a[44:47], a[212:215], v[228:231], a[44:47]
    v_mfma_f32_16x16x32_bf16 a[24:27], a[216:219], v[228:231], a[24:27]
    v_mfma_f32_16x16x32_bf16 a[28:31], a[220:223], v[228:231], a[28:31]
    v_mfma_f32_16x16x32_bf16 a[32:35], a[224:227], v[228:231], a[32:35]
    v_mfma_f32_16x16x32_bf16 a[48:51], a[192:195], v[228:231], a[48:51]
    s_waitcnt lgkmcnt(1)
    v_mfma_f32_16x16x32_bf16 a[48:51], a[204:207], v[232:235], a[48:51]
    v_mfma_f32_16x16x32_bf16 a[52:55], a[208:211], v[232:235], a[52:55]
    v_mfma_f32_16x16x32_bf16 a[52:55], a[196:199], v[228:231], a[52:55]
    v_mfma_f32_16x16x32_bf16 a[56:59], a[200:203], v[228:231], a[56:59]
    ds_read_b128 v[228:231], v253 offset:9632
    v_mfma_f32_16x16x32_bf16 a[56:59], a[212:215], v[232:235], a[56:59]
pad7:
    s_cbranch_vccnz pad11
    v_mfma_f32_16x16x32_bf16 a[36:39], a[216:219], v[232:235], a[36:39]
    v_mfma_f32_16x16x32_bf16 a[40:43], a[220:223], v[232:235], a[40:43]
    v_mfma_f32_16x16x32_bf16 a[44:47], a[224:227], v[232:235], a[44:47]
    v_mfma_f32_16x16x32_bf16 a[60:63], a[192:195], v[232:235], a[60:63]
    s_waitcnt lgkmcnt(1)
    v_mfma_f32_16x16x32_bf16 a[60:63], a[204:207], v[236:239], a[60:63]
    v_mfma_f32_16x16x32_bf16 a[64:67], a[208:211], v[236:239], a[64:67]
    v_mfma_f32_16x16x32_bf16 a[64:67], a[196:199], v[232:235], a[64:67]
    v_mfma_f32_16x16x32_bf16 a[68:71], a[200:203], v[232:235], a[68:71]
    ds_read_b128 v[232:235], v253 offset:9376
    v_mfma_f32_16x16x32_bf16 a[68:71], a[212:215], v[236:239], a[68:71]
    v_mfma_f32_16x16x32_bf16 a[48:51], a[216:219], v[236:239], a[48:51]
    v_mfma_f32_16x16x32_bf16 a[52:55], a[220:223], v[236:239], a[52:55]
    v_mfma_f32_16x16x32_bf16 a[56:59], a[224:227], v[236:239], a[56:59]
    v_mfma_f32_16x16x32_bf16 a[72:75], a[192:195], v[236:239], a[72:75]
    s_waitcnt lgkmcnt(1)
    v_mfma_f32_16x16x32_bf16 a[72:75], a[204:207], v[228:231], a[72:75]
    v_mfma_f32_16x16x32_bf16 a[76:79], a[208:211], v[228:231], a[76:79]
    v_mfma_f32_16x16x32_bf16 a[76:79], a[196:199], v[236:239], a[76:79]
    v_mfma_f32_16x16x32_bf16 a[80:83], a[200:203], v[236:239], a[80:83]
    ds_read_b128 v[236:239], v253 offset:9104
    v_mfma_f32_16x16x32_bf16 a[80:83], a[212:215], v[228:231], a[80:83]
    v_mfma_f32_16x16x32_bf16 a[60:63], a[216:219], v[228:231], a[60:63]
    v_mfma_f32_16x16x32_bf16 a[64:67], a[220:223], v[228:231], a[64:67]
    v_mfma_f32_16x16x32_bf16 a[68:71], a[224:227], v[228:231], a[68:71]
    s_add_u32 s42, s35, 811008
    v_mfma_f32_16x16x32_bf16 a[84:87], a[192:195], v[228:231], a[84:87]
    buffer_load_dwordx4 a[192:195], v254, s[8:11], s42 offen offset:0 sc1
    v_mfma_f32_16x16x32_bf16 a[88:91], a[196:199], v[228:231], a[88:91]
    v_mfma_f32_16x16x32_bf16 a[92:95], a[200:203], v[228:231], a[92:95]
    s_waitcnt lgkmcnt(1)
    v_mfma_f32_16x16x32_bf16 a[84:87], a[204:207], v[232:235], a[84:87]
    ds_read_b128 v[228:231], v253 offset:11440
    s_waitcnt vmcnt(11)
    v_mfma_f32_16x16x32_bf16 a[88:91], a[208:211], v[232:235], a[88:91]
    buffer_load_dwordx4 a[196:199], v254, s[8:11], s42 offen offset:1024 sc1
    v_mfma_f32_16x16x32_bf16 a[92:95], a[212:215], v[232:235], a[92:95]
    v_lshlrev_b32 v248, 16, v194
    v_lshlrev_b32 v249, 16, v196
    v_mfma_f32_16x16x32_bf16 a[72:75], a[216:219], v[232:235], a[72:75]
    s_waitcnt lgkmcnt(1)
    v_lshlrev_b32 v250, 16, v198
    v_lshlrev_b32 v251, 16, v200
    v_mfma_f32_16x16x32_bf16 a[76:79], a[220:223], v[232:235], a[76:79]
    buffer_load_dwordx4 a[200:203], v254, s[8:11], s42 offen offset:2048 sc1
    v_mfma_f32_16x16x32_bf16 a[80:83], a[224:227], v[232:235], a[80:83]
    ds_read_b128 v[232:235], v253 offset:11168
    v_and_b32 v194, s22, v194
    v_mfma_f32_16x16x32_bf16 a[84:87], a[216:219], v[236:239], a[84:87]
    s_add_u32 s42, s35, 814080
    v_and_b32 v196, s22, v196
    v_and_b32 v198, s22, v198
    v_mfma_f32_16x16x32_bf16 a[88:91], a[220:223], v[236:239], a[88:91]
    buffer_load_dwordx4 a[204:207], v254, s[8:11], s42 offen offset:0 sc1
    v_mfma_f32_16x16x32_bf16 a[92:95], a[224:227], v[236:239], a[92:95]
    ds_read_b128 v[236:239], v253 offset:10912
    v_and_b32 v200, s22, v200
    s_waitcnt vmcnt(11)
    s_waitcnt lgkmcnt(2)
sub21:
    v_mfma_f32_16x16x32_bf16 a[96:99], a[228:231], v[228:231], a[96:99]
    v_lshlrev_b32 v252, 16, v192
    v_and_b32 v192, s22, v192
    v_mfma_f32_16x16x32_bf16 a[100:103], a[232:235], v[228:231], a[100:103]
    s_waitcnt vmcnt(8) lgkmcnt(1)
    v_add_f32 v252, v252, v251
    v_add_f32 v192, v192, v200
    v_mfma_f32_16x16x32_bf16 a[104:107], a[236:239], v[228:231], a[104:107]
    ds_read_b128 v[228:231], v253 offset:10656
    v_fmac_f32 v252, s23, v249
    v_mfma_f32_16x16x32_bf16 a[96:99], a[240:243], v[232:235], a[96:99]
    buffer_load_dwordx4 a[208:211], v254, s[8:11], s42 offen offset:1024 sc1
    v_mfma_f32_16x16x32_bf16 a[100:103], a[244:247], v[232:235], a[100:103]
    v_fmac_f32 v192, s23, v196
    v_cvt_pk_bf16_f32 v192, v252, v192
    v_mfma_f32_16x16x32_bf16 a[104:107], a[248:251], v[232:235], a[104:107]
    v_lshlrev_b32 v252, 16, v202
    v_and_b32 v202, s22, v202
    v_mfma_f32_16x16x32_bf16 a[108:111], a[228:231], v[232:235], a[108:111]
    s_waitcnt lgkmcnt(1)
    v_add_f32 v252, v252, v248
    v_add_f32 v202, v202, v194
    v_mfma_f32_16x16x32_bf16 a[108:111], a[240:243], v[236:239], a[108:111]
    buffer_load_dwordx4 a[212:215], v254, s[8:11], s42 offen offset:2048 sc1
    v_mfma_f32_16x16x32_bf16 a[112:115], a[244:247], v[236:239], a[112:115]
    v_fmac_f32 v252, s23, v250
    v_fmac_f32 v202, s23, v198
    v_mfma_f32_16x16x32_bf16 a[112:115], a[232:235], v[232:235], a[112:115]
    s_add_u32 s42, s35, 817152
    v_cvt_pk_bf16_f32 v202, v252, v202
    v_fma_f32 v252, v249, s24, v251
    v_mfma_f32_16x16x32_bf16 a[116:119], a[236:239], v[232:235], a[116:119]
    ds_read_b128 v[232:235], v253 offset:10400
    v_fmac_f32 v251, s25, v249
    v_mfma_f32_16x16x32_bf16 a[116:119], a[248:251], v[236:239], a[116:119]
    buffer_load_dwordx4 a[216:219], v254, s[8:11], s42 offen offset:0 sc1
    s_waitcnt vmcnt(8)
    v_mfma_f32_16x16x32_bf16 a[96:99], a[252:255], v[236:239], a[96:99]
    v_fma_f32 v249, v248, s24, v250
    v_fmac_f32 v250, s25, v248
    v_mfma_f32_16x16x32_bf16 a[100:103], v[240:243], v[236:239], a[100:103]
    v_fma_f32 v248, v250, s26, v251
    v_fmac_f32 v251, s27, v250
    v_mfma_f32_16x16x32_bf16 a[104:107], v[244:247], v[236:239], a[104:107]
    s_waitcnt lgkmcnt(1)
    v_fma_f32 v250, v249, s28, v252
    v_fmac_f32 v252, s29, v249
    v_mfma_f32_16x16x32_bf16 a[120:123], a[228:231], v[236:239], a[120:123]
    buffer_load_dwordx4 a[220:223], v254, s[8:11], s42 offen offset:1024 sc1
    v_mfma_f32_16x16x32_bf16 a[120:123], a[240:243], v[228:231], a[120:123]
    v_fma_f32 v249, v196, s24, v200
    v_fmac_f32 v200, s25, v196
    v_mfma_f32_16x16x32_bf16 a[124:127], a[244:247], v[228:231], a[124:127]
    v_fma_f32 v196, v194, s24, v198
    v_fmac_f32 v198, s25, v194
    v_mfma_f32_16x16x32_bf16 a[124:127], a[232:235], v[236:239], a[124:127]
    buffer_load_dwordx4 a[224:227], v254, s[8:11], s42 offen offset:2048 sc1
    v_mfma_f32_16x16x32_bf16 a[128:131], a[236:239], v[236:239], a[128:131]
    ds_read_b128 v[236:239], v253 offset:12224
    v_and_b32 v222, 0x1f0, v254
    v_mfma_f32_16x16x32_bf16 a[128:131], a[248:251], v[228:231], a[128:131]
    v_mul_u32_u24 v222, 96, v222
    v_fma_f32 v194, v198, s26, v200
    v_mfma_f32_16x16x32_bf16 a[108:111], a[252:255], v[228:231], a[108:111]
    buffer_load_dword v222, v222, s[4:7], s33 offen offset:768
    v_mfma_f32_16x16x32_bf16 a[112:115], v[240:243], v[228:231], a[112:115]
    v_fmac_f32 v200, s27, v198
    v_fma_f32 v198, v196, s28, v249
    v_mfma_f32_16x16x32_bf16 a[116:119], v[244:247], v[228:231], a[116:119]
    v_fmac_f32 v249, s29, v196
    v_cvt_pk_bf16_f32 v194, v248, v194
    v_mfma_f32_16x16x32_bf16 a[132:135], a[228:231], v[228:231], a[132:135]
    s_waitcnt lgkmcnt(1)
    v_cvt_pk_bf16_f32 v200, v251, v200
    v_cvt_pk_bf16_f32 v198, v250, v198
    v_mfma_f32_16x16x32_bf16 a[132:135], a[240:243], v[232:235], a[132:135]
    v_cvt_pk_bf16_f32 v196, v252, v249
    v_lshlrev_b32 v248, 16, v195
    v_mfma_f32_16x16x32_bf16 a[136:139], a[244:247], v[232:235], a[136:139]
    v_lshlrev_b32 v249, 16, v197
    v_lshlrev_b32 v250, 16, v199
    v_mfma_f32_16x16x32_bf16 a[136:139], a[232:235], v[228:231], a[136:139]
    v_lshlrev_b32 v251, 16, v201
    v_and_b32 v195, s22, v195
    v_mfma_f32_16x16x32_bf16 a[140:143], a[236:239], v[228:231], a[140:143]
    ds_read_b128 v[228:231], v253 offset:11968
    v_and_b32 v197, s22, v197
    v_mfma_f32_16x16x32_bf16 a[140:143], a[248:251], v[232:235], a[140:143]
    v_and_b32 v199, s22, v199
    v_and_b32 v201, s22, v201
    v_mfma_f32_16x16x32_bf16 a[120:123], a[252:255], v[232:235], a[120:123]
    v_lshlrev_b32 v252, 16, v193
    v_and_b32 v193, s22, v193
    v_mfma_f32_16x16x32_bf16 a[124:127], v[240:243], v[232:235], a[124:127]
    v_add_f32 v252, v252, v251
    v_add_f32 v193, v193, v201
    v_mfma_f32_16x16x32_bf16 a[128:131], v[244:247], v[232:235], a[128:131]
    v_fmac_f32 v252, s23, v249
    v_fmac_f32 v193, s23, v197
    v_mfma_f32_16x16x32_bf16 a[144:147], a[228:231], v[232:235], a[144:147]
    s_waitcnt lgkmcnt(1)
    v_cvt_pk_bf16_f32 v193, v252, v193
    v_lshlrev_b32 v252, 16, v203
    v_mfma_f32_16x16x32_bf16 a[144:147], a[240:243], v[236:239], a[144:147]
    v_and_b32 v203, s22, v203
    v_add_f32 v252, v252, v248
    v_mfma_f32_16x16x32_bf16 a[148:151], a[244:247], v[236:239], a[148:151]
    v_add_f32 v203, v203, v195
    v_fmac_f32 v252, s23, v250
    v_mfma_f32_16x16x32_bf16 a[148:151], a[232:235], v[232:235], a[148:151]
    v_fmac_f32 v203, s23, v199
    v_cvt_pk_bf16_f32 v203, v252, v203
    v_mfma_f32_16x16x32_bf16 a[152:155], a[236:239], v[232:235], a[152:155]
    ds_read_b128 v[232:235], v253 offset:11712
    v_fma_f32 v252, v249, s24, v251
    v_mfma_f32_16x16x32_bf16 a[152:155], a[248:251], v[236:239], a[152:155]
    v_fmac_f32 v251, s25, v249
    v_fma_f32 v249, v248, s24, v250
    v_mfma_f32_16x16x32_bf16 a[132:135], a[252:255], v[236:239], a[132:135]
    v_fmac_f32 v250, s25, v248
    v_fma_f32 v248, v250, s26, v251
    v_mfma_f32_16x16x32_bf16 a[136:139], v[240:243], v[236:239], a[136:139]
    v_fmac_f32 v251, s27, v250
    v_fma_f32 v250, v249, s28, v252
    v_mfma_f32_16x16x32_bf16 a[140:143], v[244:247], v[236:239], a[140:143]
    v_fmac_f32 v252, s29, v249
    v_fma_f32 v249, v197, s24, v201
    v_mfma_f32_16x16x32_bf16 a[156:159], a[228:231], v[236:239], a[156:159]
    s_waitcnt lgkmcnt(1)
    v_fmac_f32 v201, s25, v197
    v_fma_f32 v197, v195, s24, v199
    v_mfma_f32_16x16x32_bf16 a[156:159], a[240:243], v[228:231], a[156:159]
    v_fmac_f32 v199, s25, v195
    v_fma_f32 v195, v199, s26, v201
    v_mfma_f32_16x16x32_bf16 a[160:163], a[244:247], v[228:231], a[160:163]
    v_fmac_f32 v201, s27, v199
    v_fma_f32 v199, v197, s28, v249
    v_mfma_f32_16x16x32_bf16 a[160:163], a[232:235], v[236:239], a[160:163]
    v_fmac_f32 v249, s29, v197
    v_cvt_pk_bf16_f32 v195, v248, v195
    v_mfma_f32_16x16x32_bf16 a[164:167], a[236:239], v[236:239], a[164:167]
    ds_read_b128 v[236:239], v253 offset:11456
    v_cvt_pk_bf16_f32 v201, v251, v201
    v_mfma_f32_16x16x32_bf16 a[164:167], a[248:251], v[228:231], a[164:167]
    v_cvt_pk_bf16_f32 v199, v250, v199
    v_cvt_pk_bf16_f32 v197, v252, v249
    v_mfma_f32_16x16x32_bf16 a[144:147], a[252:255], v[228:231], a[144:147]
    v_and_b32 v248, 0xf0, v254
    v_lshrrev_b32 v248, 1, v248
    v_mfma_f32_16x16x32_bf16 a[148:151], v[240:243], v[228:231], a[148:151]
    v_add_u32 v248, s52, v248
    v_and_b32 v252, 8, v248
    v_mfma_f32_16x16x32_bf16 a[152:155], v[244:247], v[228:231], a[152:155]
    v_lshrrev_b32 v249, 6, v248
    v_mul_u32_u24 v249, 384, v249
    v_mfma_f32_16x16x32_bf16 a[168:171], a[228:231], v[228:231], a[168:171]
    s_waitcnt lgkmcnt(1)
    v_subrev_u32 v249, s3, v249
    v_min_u32 v249, 1920, v249
    v_mfma_f32_16x16x32_bf16 a[168:171], a[240:243], v[232:235], a[168:171]
    v_lshrrev_b32 v249, 1, v249
    v_mfma_f32_16x16x32_bf16 a[172:175], a[244:247], v[232:235], a[172:175]
    v_add_u32 v252, v252, v249
    v_bfe_u32 v249, v248, 4, 2
    v_mfma_f32_16x16x32_bf16 a[172:175], a[232:235], v[228:231], a[172:175]
    v_mul_u32_u24 v249, 40704, v249
    v_mfma_f32_16x16x32_bf16 a[176:179], a[236:239], v[228:231], a[176:179]
    ds_read_b128 v[228:231], v253 offset:11184
    v_add_u32 v252, v252, v249
    v_mfma_f32_16x16x32_bf16 a[176:179], a[248:251], v[232:235], a[176:179]
    v_and_b32 v249, 32, v248
    v_lshl_add_u32 v252, v249, 1, v252
    v_mfma_f32_16x16x32_bf16 a[156:159], a[252:255], v[232:235], a[156:159]
    v_bfe_u32 v249, v254, 8, 1
    v_lshl_add_u32 v252, v249, 4, v252
    v_mfma_f32_16x16x32_bf16 a[160:163], v[240:243], v[232:235], a[160:163]
    v_mov_b32 v249, 123328
    v_mfma_f32_16x16x32_bf16 a[164:167], v[244:247], v[232:235], a[164:167]
    s_add_u32 s42, s35, 847872
    v_cndmask_b32 v252, v249, v252, s[58:59]
    v_mfma_f32_16x16x32_bf16 a[180:183], a[228:231], v[232:235], a[180:183]
    buffer_load_dwordx4 a[228:231], v254, s[8:11], s42 offen offset:0 sc1
    v_mfma_f32_16x16x32_bf16 a[184:187], a[232:235], v[232:235], a[184:187]
    ds_write_b64 v252, v[192:193] offset:39520
    v_mfma_f32_16x16x32_bf16 a[188:191], a[236:239], v[232:235], a[188:191]
    s_waitcnt lgkmcnt(2)
    v_mfma_f32_16x16x32_bf16 a[180:183], a[240:243], v[236:239], a[180:183]
    ds_read_b128 v[232:235], v253 offset:13520
    v_mfma_f32_16x16x32_bf16 a[184:187], a[244:247], v[236:239], a[184:187]
    buffer_load_dwordx4 a[232:235], v254, s[8:11], s42 offen offset:1024 sc1
    v_mfma_f32_16x16x32_bf16 a[188:191], a[248:251], v[236:239], a[188:191]
    ds_write_b64 v252, v[194:195] offset:39552
    v_mfma_f32_16x16x32_bf16 a[168:171], a[252:255], v[236:239], a[168:171]
    s_waitcnt lgkmcnt(3)
    v_mfma_f32_16x16x32_bf16 a[172:175], v[240:243], v[236:239], a[172:175]
    buffer_load_dwordx4 a[236:239], v254, s[8:11], s42 offen offset:2048 sc1
    v_mfma_f32_16x16x32_bf16 a[176:179], v[244:247], v[236:239], a[176:179]
    ds_read_b128 v[236:239], v253 offset:13248
    v_mfma_f32_16x16x32_bf16 a[180:183], a[252:255], v[228:231], a[180:183]
    s_add_u32 s42, s35, 850944
    v_mfma_f32_16x16x32_bf16 a[184:187], v[240:243], v[228:231], a[184:187]
    buffer_load_dwordx4 a[240:243], v254, s[8:11], s42 offen offset:0 sc1
    v_mfma_f32_16x16x32_bf16 a[188:191], v[244:247], v[228:231], a[188:191]
    ds_read_b128 v[228:231], v253 offset:12992
    s_waitcnt vmcnt(11)
    s_waitcnt lgkmcnt(3)
sub22:
    v_mfma_f32_16x16x32_bf16 v[0:3], a[192:195], v[232:235], v[0:3]
    ds_write_b64 v252, v[200:201] offset:39584
    v_mfma_f32_16x16x32_bf16 v[4:7], a[196:199], v[232:235], v[4:7]
    s_waitcnt vmcnt(8) lgkmcnt(2)
    v_mfma_f32_16x16x32_bf16 v[8:11], a[200:203], v[232:235], v[8:11]
    ds_read_b128 v[232:235], v253 offset:12736
    v_mfma_f32_16x16x32_bf16 v[0:3], a[204:207], v[236:239], v[0:3]
    buffer_load_dwordx4 a[244:247], v254, s[8:11], s42 offen offset:1024 sc1
    v_mfma_f32_16x16x32_bf16 v[4:7], a[208:211], v[236:239], v[4:7]
    ds_write_b64 v252, v[198:199] offset:39616
    v_mfma_f32_16x16x32_bf16 v[8:11], a[212:215], v[236:239], v[8:11]
    s_waitcnt lgkmcnt(3)
    v_mfma_f32_16x16x32_bf16 v[12:15], a[192:195], v[236:239], v[12:15]
    ds_write_b64 v252, v[196:197] offset:39648
    v_mfma_f32_16x16x32_bf16 v[12:15], a[204:207], v[228:231], v[12:15]
    buffer_load_dwordx4 a[248:251], v254, s[8:11], s42 offen offset:2048 sc1
    v_mfma_f32_16x16x32_bf16 v[16:19], a[208:211], v[228:231], v[16:19]
    ds_write_b64 v252, v[202:203] offset:39680
    v_mfma_f32_16x16x32_bf16 v[16:19], a[196:199], v[236:239], v[16:19]
    s_add_u32 s42, s35, 854016
    v_mfma_f32_16x16x32_bf16 v[20:23], a[200:203], v[236:239], v[20:23]
    ds_read_b128 v[236:239], v253 offset:12480
    v_mfma_f32_16x16x32_bf16 v[20:23], a[212:215], v[228:231], v[20:23]
    buffer_load_dwordx4 a[252:255], v254, s[8:11], s42 offen offset:0 sc1
    s_waitcnt vmcnt(8)
    v_mfma_f32_16x16x32_bf16 v[0:3], a[216:219], v[228:231], v[0:3]
    v_mfma_f32_16x16x32_bf16 v[4:7], a[220:223], v[228:231], v[4:7]
    v_mfma_f32_16x16x32_bf16 v[8:11], a[224:227], v[228:231], v[8:11]
    s_waitcnt lgkmcnt(4)
    v_mfma_f32_16x16x32_bf16 v[24:27], a[192:195], v[228:231], v[24:27]
    buffer_load_dwordx4 v[240:243], v254, s[8:11], s42 offen offset:1024 sc1
    v_mfma_f32_16x16x32_bf16 v[24:27], a[204:207], v[232:235], v[24:27]
    v_mfma_f32_16x16x32_bf16 v[28:31], a[208:211], v[232:235], v[28:31]
    v_mfma_f32_16x16x32_bf16 v[28:31], a[196:199], v[228:231], v[28:31]
    buffer_load_dwordx4 v[244:247], v254, s[8:11], s42 offen offset:2048 sc1
    v_mfma_f32_16x16x32_bf16 v[32:35], a[200:203], v[228:231], v[32:35]
    ds_read_b128 v[228:231], v253 offset:14304
    v_mfma_f32_16x16x32_bf16 v[32:35], a[212:215], v[232:235], v[32:35]
    v_mfma_f32_16x16x32_bf16 v[12:15], a[216:219], v[232:235], v[12:15]
    v_mfma_f32_16x16x32_bf16 v[16:19], a[220:223], v[232:235], v[16:19]
    v_mfma_f32_16x16x32_bf16 v[20:23], a[224:227], v[232:235], v[20:23]
    v_mfma_f32_16x16x32_bf16 v[36:39], a[192:195], v[232:235], v[36:39]
    s_waitcnt lgkmcnt(1)
    v_mfma_f32_16x16x32_bf16 v[36:39], a[204:207], v[236:239], v[36:39]
    v_mfma_f32_16x16x32_bf16 v[40:43], a[208:211], v[236:239], v[40:43]
    v_mfma_f32_16x16x32_bf16 v[40:43], a[196:199], v[232:235], v[40:43]
    v_mfma_f32_16x16x32_bf16 v[44:47], a[200:203], v[232:235], v[44:47]
    ds_read_b128 v[232:235], v253 offset:14048
    v_mfma_f32_16x16x32_bf16 v[44:47], a[212:215], v[236:239], v[44:47]
    v_mfma_f32_16x16x32_bf16 v[24:27], a[216:219], v[236:239], v[24:27]
    v_mfma_f32_16x16x32_bf16 v[28:31], a[220:223], v[236:239], v[28:31]
    v_mfma_f32_16x16x32_bf16 v[32:35], a[224:227], v[236:239], v[32:35]
    v_mfma_f32_16x16x32_bf16 v[48:51], a[192:195], v[236:239], v[48:51]
    s_waitcnt lgkmcnt(1)
    v_mfma_f32_16x16x32_bf16 v[48:51], a[204:207], v[228:231], v[48:51]
    v_mfma_f32_16x16x32_bf16 v[52:55], a[208:211], v[228:231], v[52:55]
    v_mfma_f32_16x16x32_bf16 v[52:55], a[196:199], v[236:239], v[52:55]
    v_mfma_f32_16x16x32_bf16 v[56:59], a[200:203], v[236:239], v[56:59]
    ds_read_b128 v[236:239], v253 offset:13792
    v_mfma_f32_16x16x32_bf16 v[56:59], a[212:215], v[228:231], v[56:59]
    v_mfma_f32_16x16x32_bf16 v[36:39], a[216:219], v[228:231], v[36:39]
    v_mfma_f32_16x16x32_bf16 v[40:43], a[220:223], v[228:231], v[40:43]
    v_mfma_f32_16x16x32_bf16 v[44:47], a[224:227], v[228:231], v[44:47]
    v_mfma_f32_16x16x32_bf16 v[60:63], a[192:195], v[228:231], v[60:63]
    s_waitcnt lgkmcnt(1)
    v_mfma_f32_16x16x32_bf16 v[60:63], a[204:207], v[232:235], v[60:63]
    v_mfma_f32_16x16x32_bf16 v[64:67], a[208:211], v[232:235], v[64:67]
    v_mfma_f32_16x16x32_bf16 v[64:67], a[196:199], v[228:231], v[64:67]
    v_mfma_f32_16x16x32_bf16 v[68:71], a[200:203], v[228:231], v[68:71]
    ds_read_b128 v[228:231], v253 offset:13536
    v_mfma_f32_16x16x32_bf16 v[68:71], a[212:215], v[232:235], v[68:71]
    v_mfma_f32_16x16x32_bf16 v[48:51], a[216:219], v[232:235], v[48:51]
    v_mfma_f32_16x16x32_bf16 v[52:55], a[220:223], v[232:235], v[52:55]
    v_mfma_f32_16x16x32_bf16 v[56:59], a[224:227], v[232:235], v[56:59]
    v_mfma_f32_16x16x32_bf16 v[72:75], a[192:195], v[232:235], v[72:75]
    s_waitcnt lgkmcnt(1)
    v_mfma_f32_16x16x32_bf16 v[72:75], a[204:207], v[236:239], v[72:75]
    v_mfma_f32_16x16x32_bf16 v[76:79], a[208:211], v[236:239], v[76:79]
    v_mfma_f32_16x16x32_bf16 v[76:79], a[196:199], v[232:235], v[76:79]
    v_mfma_f32_16x16x32_bf16 v[80:83], a[200:203], v[232:235], v[80:83]
    ds_read_b128 v[232:235], v253 offset:13264
    v_mfma_f32_16x16x32_bf16 v[80:83], a[212:215], v[236:239], v[80:83]
    v_mfma_f32_16x16x32_bf16 v[60:63], a[216:219], v[236:239], v[60:63]
    v_mfma_f32_16x16x32_bf16 v[64:67], a[220:223], v[236:239], v[64:67]
    v_mfma_f32_16x16x32_bf16 v[68:71], a[224:227], v[236:239], v[68:71]
    s_add_u32 s42, s36, 884736
    v_mfma_f32_16x16x32_bf16 v[84:87], a[192:195], v[236:239], v[84:87]
    buffer_load_dwordx4 a[192:195], v254, s[8:11], s42 offen offset:0 sc1
    v_mfma_f32_16x16x32_bf16 v[88:91], a[196:199], v[236:239], v[88:91]
    v_mfma_f32_16x16x32_bf16 v[92:95], a[200:203], v[236:239], v[92:95]
    s_waitcnt lgkmcnt(1)
    v_mfma_f32_16x16x32_bf16 v[84:87], a[204:207], v[228:231], v[84:87]
    ds_read_b128 v[236:239], v253 offset:1040
    v_mfma_f32_16x16x32_bf16 v[88:91], a[208:211], v[228:231], v[88:91]
    buffer_load_dwordx4 a[196:199], v254, s[8:11], s42 offen offset:1024 sc1
    v_mfma_f32_16x16x32_bf16 v[92:95], a[212:215], v[228:231], v[92:95]
    v_mfma_f32_16x16x32_bf16 v[72:75], a[216:219], v[228:231], v[72:75]
    s_waitcnt lgkmcnt(1)
    v_mfma_f32_16x16x32_bf16 v[76:79], a[220:223], v[228:231], v[76:79]
    buffer_load_dwordx4 a[200:203], v254, s[8:11], s42 offen offset:2048 sc1
    v_mfma_f32_16x16x32_bf16 v[80:83], a[224:227], v[228:231], v[80:83]
    ds_read_b128 v[228:231], v253 offset:768
    v_mfma_f32_16x16x32_bf16 v[84:87], a[216:219], v[232:235], v[84:87]
    s_add_u32 s42, s36, 887808
    v_mfma_f32_16x16x32_bf16 v[88:91], a[220:223], v[232:235], v[88:91]
    buffer_load_dwordx4 a[204:207], v254, s[8:11], s42 offen offset:0 sc1
    v_mfma_f32_16x16x32_bf16 v[92:95], a[224:227], v[232:235], v[92:95]
    ds_read_b128 v[232:235], v253 offset:512
    s_waitcnt vmcnt(10)
    s_waitcnt lgkmcnt(2)
sub23:
    v_mfma_f32_16x16x32_bf16 v[96:99], a[228:231], v[236:239], v[96:99]
    v_mfma_f32_16x16x32_bf16 v[100:103], a[232:235], v[236:239], v[100:103]
    s_waitcnt vmcnt(7) lgkmcnt(1)
    v_mfma_f32_16x16x32_bf16 v[104:107], a[236:239], v[236:239], v[104:107]
    ds_read_b128 v[236:239], v253 offset:256
    v_mfma_f32_16x16x32_bf16 v[96:99], a[240:243], v[228:231], v[96:99]
    buffer_load_dwordx4 a[208:211], v254, s[8:11], s42 offen offset:1024 sc1
    v_mfma_f32_16x16x32_bf16 v[100:103], a[244:247], v[228:231], v[100:103]
    v_mfma_f32_16x16x32_bf16 v[104:107], a[248:251], v[228:231], v[104:107]
    v_mfma_f32_16x16x32_bf16 v[108:111], a[228:231], v[228:231], v[108:111]
    s_waitcnt lgkmcnt(1)
    v_mfma_f32_16x16x32_bf16 v[108:111], a[240:243], v[232:235], v[108:111]
    buffer_load_dwordx4 a[212:215], v254, s[8:11], s42 offen offset:2048 sc1
    v_mfma_f32_16x16x32_bf16 v[112:115], a[244:247], v[232:235], v[112:115]
    v_mfma_f32_16x16x32_bf16 v[112:115], a[232:235], v[228:231], v[112:115]
    s_add_u32 s42, s36, 890880
    v_mfma_f32_16x16x32_bf16 v[116:119], a[236:239], v[228:231], v[116:119]
    ds_read_b128 v[228:231], v253 offset:0
    v_bfe_u32 v251, v254, 6, 2
    v_mfma_f32_16x16x32_bf16 v[116:119], a[248:251], v[232:235], v[116:119]
    buffer_load_dwordx4 a[216:219], v254, s[8:11], s42 offen offset:0 sc1
    s_waitcnt vmcnt(7)
    v_mfma_f32_16x16x32_bf16 v[96:99], a[252:255], v[232:235], v[96:99]
    v_mfma_f32_16x16x32_bf16 v[100:103], v[240:243], v[232:235], v[100:103]
    v_mul_u32_u24 v248, 40704, v251
    v_mfma_f32_16x16x32_bf16 v[104:107], v[244:247], v[232:235], v[104:107]
    s_waitcnt lgkmcnt(1)
    v_mfma_f32_16x16x32_bf16 v[120:123], a[228:231], v[232:235], v[120:123]
    buffer_load_dwordx4 a[220:223], v254, s[8:11], s42 offen offset:1024 sc1
    v_mfma_f32_16x16x32_bf16 v[120:123], a[240:243], v[236:239], v[120:123]
    v_and_b32 v251, 0x80, v254
    v_mfma_f32_16x16x32_bf16 v[124:127], a[244:247], v[236:239], v[124:127]
    v_mfma_f32_16x16x32_bf16 v[124:127], a[232:235], v[232:235], v[124:127]
    buffer_load_dwordx4 a[224:227], v254, s[8:11], s42 offen offset:2048 sc1
    v_mfma_f32_16x16x32_bf16 v[128:131], a[236:239], v[232:235], v[128:131]
    ds_read_b128 v[232:235], v253 offset:1824
    v_and_b32 v252, 0x1f0, v254
    v_mfma_f32_16x16x32_bf16 v[128:131], a[248:251], v[236:239], v[128:131]
    v_mul_u32_u24 v252, 96, v252
    v_lshrrev_b32 v251, 1, v251
    v_mfma_f32_16x16x32_bf16 v[108:111], a[252:255], v[236:239], v[108:111]
    buffer_load_dword v252, v252, s[4:7], s33 offen offset:1152
    v_mfma_f32_16x16x32_bf16 v[112:115], v[240:243], v[236:239], v[112:115]
    v_mfma_f32_16x16x32_bf16 v[116:119], v[244:247], v[236:239], v[116:119]
    v_add_u32 v248, v248, v251
    v_mfma_f32_16x16x32_bf16 v[132:135], a[228:231], v[236:239], v[132:135]
    s_waitcnt lgkmcnt(1)
    v_mfma_f32_16x16x32_bf16 v[132:135], a[240:243], v[228:231], v[132:135]
    v_mfma_f32_16x16x32_bf16 v[136:139], a[244:247], v[228:231], v[136:139]
    v_and_b32 v251, 0x40, v254
    v_mfma_f32_16x16x32_bf16 v[136:139], a[232:235], v[236:239], v[136:139]
    v_mfma_f32_16x16x32_bf16 v[140:143], a[236:239], v[236:239], v[140:143]
    ds_read_b128 v[236:239], v253 offset:1568
    v_mfma_f32_16x16x32_bf16 v[140:143], a[248:251], v[228:231], v[140:143]
    v_mfma_f32_16x16x32_bf16 v[120:123], a[252:255], v[228:231], v[120:123]
    v_lshrrev_b32 v251, 2, v251
    v_mfma_f32_16x16x32_bf16 v[124:127], v[240:243], v[228:231], v[124:127]
    v_mfma_f32_16x16x32_bf16 v[128:131], v[244:247], v[228:231], v[128:131]
    v_mfma_f32_16x16x32_bf16 v[144:147], a[228:231], v[228:231], v[144:147]
    s_waitcnt lgkmcnt(1)
    v_add_u32 v248, v248, v251
    v_mfma_f32_16x16x32_bf16 v[144:147], a[240:243], v[232:235], v[144:147]
    v_mfma_f32_16x16x32_bf16 v[148:151], a[244:247], v[232:235], v[148:151]
    v_mfma_f32_16x16x32_bf16 v[148:151], a[232:235], v[228:231], v[148:151]
    v_bfe_u32 v251, v254, 4, 2
    v_mfma_f32_16x16x32_bf16 v[152:155], a[236:239], v[228:231], v[152:155]
    ds_read_b128 v[228:231], v253 offset:1312
    v_mfma_f32_16x16x32_bf16 v[152:155], a[248:251], v[232:235], v[152:155]
    v_mfma_f32_16x16x32_bf16 v[132:135], a[252:255], v[232:235], v[132:135]
    v_mfma_f32_16x16x32_bf16 v[136:139], v[240:243], v[232:235], v[136:139]
    v_mul_u32_u24 v251, 3104, v251
    v_mfma_f32_16x16x32_bf16 v[140:143], v[244:247], v[232:235], v[140:143]
    v_mfma_f32_16x16x32_bf16 v[156:159], a[228:231], v[232:235], v[156:159]
    s_waitcnt lgkmcnt(1)
    v_mfma_f32_16x16x32_bf16 v[156:159], a[240:243], v[236:239], v[156:159]
    v_add_u32 v248, v248, v251
    v_mfma_f32_16x16x32_bf16 v[160:163], a[244:247], v[236:239], v[160:163]
    v_mfma_f32_16x16x32_bf16 v[160:163], a[232:235], v[232:235], v[160:163]
    v_mfma_f32_16x16x32_bf16 v[164:167], a[236:239], v[232:235], v[164:167]
    ds_read_b128 v[232:235], v253 offset:1056
    v_add_u32 v248, s52, v248
    v_mfma_f32_16x16x32_bf16 v[164:167], a[248:251], v[236:239], v[164:167]
    v_mfma_f32_16x16x32_bf16 v[144:147], a[252:255], v[236:239], v[144:147]
    v_mfma_f32_16x16x32_bf16 v[148:151], v[240:243], v[236:239], v[148:151]
    v_mfma_f32_16x16x32_bf16 v[152:155], v[244:247], v[236:239], v[152:155]
    v_lshrrev_b32 v251, 8, v254
    v_mfma_f32_16x16x32_bf16 v[168:171], a[228:231], v[236:239], v[168:171]
    s_waitcnt lgkmcnt(1)
    v_mfma_f32_16x16x32_bf16 v[168:171], a[240:243], v[228:231], v[168:171]
    v_mfma_f32_16x16x32_bf16 v[172:175], a[244:247], v[228:231], v[172:175]
    v_lshl_add_u32 v249, v251, 3, v248
    v_mfma_f32_16x16x32_bf16 v[172:175], a[232:235], v[236:239], v[172:175]
    v_mfma_f32_16x16x32_bf16 v[176:179], a[236:239], v[236:239], v[176:179]
    ds_read_b128 v[236:239], v253 offset:784
    v_mfma_f32_16x16x32_bf16 v[176:179], a[248:251], v[228:231], v[176:179]
    v_lshl_add_u32 v248, v251, 4, v248
    v_mfma_f32_16x16x32_bf16 v[156:159], a[252:255], v[228:231], v[156:159]
    v_mfma_f32_16x16x32_bf16 v[160:163], v[240:243], v[228:231], v[160:163]
    s_waitcnt lgkmcnt(1)
    v_mfma_f32_16x16x32_bf16 v[164:167], v[244:247], v[228:231], v[164:167]
    s_add_u32 s42, s36, 921600
    v_mfma_f32_16x16x32_bf16 v[180:183], a[228:231], v[228:231], v[180:183]
    buffer_load_dwordx4 a[228:231], v254, s[8:11], s42 offen offset:0 sc1
    v_mfma_f32_16x16x32_bf16 v[184:187], a[232:235], v[228:231], v[184:187]
    s_waitcnt lgkmcnt(0)
    v_mfma_f32_16x16x32_bf16 v[188:191], a[236:239], v[228:231], v[188:191]
    s_barrier
    v_mfma_f32_16x16x32_bf16 v[180:183], a[240:243], v[232:235], v[180:183]
    ds_read_b128 v[228:231], v253 offset:34320
    v_mfma_f32_16x16x32_bf16 v[184:187], a[244:247], v[232:235], v[184:187]
    buffer_load_dwordx4 a[232:235], v254, s[8:11], s42 offen offset:1024 sc1
    v_mfma_f32_16x16x32_bf16 v[188:191], a[248:251], v[232:235], v[188:191]
    v_mfma_f32_16x16x32_bf16 v[168:171], a[252:255], v[232:235], v[168:171]
    v_mfma_f32_16x16x32_bf16 v[172:175], v[240:243], v[232:235], v[172:175]
    buffer_load_dwordx4 a[236:239], v254, s[8:11], s42 offen offset:2048 sc1
    v_mfma_f32_16x16x32_bf16 v[176:179], v[244:247], v[232:235], v[176:179]
    ds_read_b128 v[232:235], v253 offset:34048
    v_mfma_f32_16x16x32_bf16 v[180:183], a[252:255], v[236:239], v[180:183]
    s_add_u32 s42, s36, 924672
    v_mfma_f32_16x16x32_bf16 v[184:187], v[240:243], v[236:239], v[184:187]
    buffer_load_dwordx4 a[240:243], v254, s[8:11], s42 offen offset:0 sc1
    v_mfma_f32_16x16x32_bf16 v[188:191], v[244:247], v[236:239], v[188:191]
    ds_read_b128 v[236:239], v253 offset:33792
    s_waitcnt vmcnt(11)
    s_waitcnt lgkmcnt(2)
    s_nop 7
    v_accvgpr_read_b32 v192, a0
    v_accvgpr_read_b32 v193, a1
    v_accvgpr_read_b32 v194, a2
    v_accvgpr_read_b32 v195, a3
    v_accvgpr_read_b32 v196, a96
    v_accvgpr_read_b32 v197, a97
    v_accvgpr_read_b32 v198, a98
    v_accvgpr_read_b32 v199, a99
    v_pk_add_f32 v[192:193], v[192:193], v[196:197]
    v_pk_add_f32 v[194:195], v[194:195], v[198:199]
    v_pk_add_f32 v[196:197], v[0:1], v[96:97]
    v_pk_add_f32 v[198:199], v[2:3], v[98:99]
    v_pk_add_f32 v[96:97], v[0:1], v[96:97] neg_lo:[0,1] neg_hi:[0,1]
    v_pk_add_f32 v[98:99], v[2:3], v[98:99] neg_lo:[0,1] neg_hi:[0,1]
    v_pk_fma_f32 v[0:1], v[196:197], s[30:31], v[192:193]
    v_pk_fma_f32 v[2:3], v[198:199], s[30:31], v[194:195]
    v_pk_fma_f32 v[192:193], v[192:193], s[30:31], v[196:197]
    v_pk_fma_f32 v[194:195], v[194:195], s[30:31], v[198:199]
    v_cvt_pk_bf16_f32 v208, v192, v193
    v_cvt_pk_bf16_f32 v209, v194, v195
    v_accvgpr_read_b32 v200, a4
    v_accvgpr_read_b32 v201, a5
    v_accvgpr_read_b32 v202, a6
    v_accvgpr_read_b32 v203, a7
    v_accvgpr_read_b32 v204, a100
    v_accvgpr_read_b32 v205, a101
    v_accvgpr_read_b32 v206, a102
    v_accvgpr_read_b32 v207, a103
    v_pk_add_f32 v[200:201], v[200:201], v[204:205]
    v_pk_add_f32 v[202:203], v[202:203], v[206:207]
    v_pk_add_f32 v[204:205], v[4:5], v[100:101]
    v_pk_add_f32 v[206:207], v[6:7], v[102:103]
    v_pk_add_f32 v[100:101], v[4:5], v[100:101] neg_lo:[0,1] neg_hi:[0,1]
    v_pk_add_f32 v[102:103], v[6:7], v[102:103] neg_lo:[0,1] neg_hi:[0,1]
    v_pk_fma_f32 v[4:5], v[204:205], s[30:31], v[200:201]
    v_pk_fma_f32 v[6:7], v[206:207], s[30:31], v[202:203]
    v_pk_fma_f32 v[200:201], v[200:201], s[30:31], v[204:205]
    v_pk_fma_f32 v[202:203], v[202:203], s[30:31], v[206:207]
    v_cvt_pk_bf16_f32 v210, v200, v201
    v_cvt_pk_bf16_f32 v211, v202, v203
    ds_write_b128 v248, v[208:211] offset:0
    v_accvgpr_read_b32 v192, a8
    v_accvgpr_read_b32 v193, a9
    v_accvgpr_read_b32 v194, a10
    v_accvgpr_read_b32 v195, a11
    v_accvgpr_read_b32 v196, a104
    v_accvgpr_read_b32 v197, a105
    v_accvgpr_read_b32 v198, a106
    v_accvgpr_read_b32 v199, a107
    v_pk_add_f32 v[192:193], v[192:193], v[196:197]
    v_pk_add_f32 v[194:195], v[194:195], v[198:199]
    v_pk_add_f32 v[196:197], v[8:9], v[104:105]
    v_pk_add_f32 v[198:199], v[10:11], v[106:107]
    v_pk_add_f32 v[104:105], v[8:9], v[104:105] neg_lo:[0,1] neg_hi:[0,1]
    v_pk_add_f32 v[106:107], v[10:11], v[106:107] neg_lo:[0,1] neg_hi:[0,1]
    v_pk_fma_f32 v[8:9], v[196:197], s[30:31], v[192:193]
    v_pk_fma_f32 v[10:11], v[198:199], s[30:31], v[194:195]
    v_pk_fma_f32 v[192:193], v[192:193], s[30:31], v[196:197]
    v_pk_fma_f32 v[194:195], v[194:195], s[30:31], v[198:199]
    v_cvt_pk_bf16_f32 v212, v192, v193
    v_cvt_pk_bf16_f32 v213, v194, v195
    v_accvgpr_read_b32 v192, a12
    v_accvgpr_read_b32 v193, a13
    v_accvgpr_read_b32 v194, a14
    v_accvgpr_read_b32 v195, a15
    v_accvgpr_read_b32 v196, a108
    v_accvgpr_read_b32 v197, a109
    v_accvgpr_read_b32 v198, a110
    v_accvgpr_read_b32 v199, a111
pad8:
    s_cbranch_vccnz pad12
    s_nop 0
    v_pk_add_f32 v[192:193], v[192:193], v[196:197]
    v_pk_add_f32 v[194:195], v[194:195], v[198:199]
    v_pk_add_f32 v[196:197], v[12:13], v[108:109]
    v_pk_add_f32 v[198:199], v[14:15], v[110:111]
    v_pk_add_f32 v[108:109], v[12:13], v[108:109] neg_lo:[0,1] neg_hi:[0,1]
    v_pk_add_f32 v[110:111], v[14:15], v[110:111] neg_lo:[0,1] neg_hi:[0,1]
    v_pk_fma_f32 v[12:13], v[196:197], s[30:31], v[192:193]
    v_pk_fma_f32 v[14:15], v[198:199], s[30:31], v[194:195]
    v_pk_fma_f32 v[192:193], v[192:193], s[30:31], v[196:197]
    v_pk_fma_f32 v[194:195], v[194:195], s[30:31], v[198:199]
    v_cvt_pk_bf16_f32 v214, v192, v193
    v_cvt_pk_bf16_f32 v215, v194, v195
    ds_write_b64 v249, v[212:213] offset:64
    v_accvgpr_read_b32 v200, a16
    v_accvgpr_read_b32 v201, a17
    v_accvgpr_read_b32 v202, a18
    v_accvgpr_read_b32 v203, a19
    v_accvgpr_read_b32 v204, a112
    v_accvgpr_read_b32 v205, a113
    v_accvgpr_read_b32 v206, a114
    v_accvgpr_read_b32 v207, a115
    v_pk_add_f32 v[200:201], v[200:201], v[204:205]
    v_pk_add_f32 v[202:203], v[202:203], v[206:207]
    v_pk_add_f32 v[204:205], v[16:17], v[112:113]
    v_pk_add_f32 v[206:207], v[18:19], v[114:115]
    v_pk_add_f32 v[112:113], v[16:17], v[112:113] neg_lo:[0,1] neg_hi:[0,1]
    v_pk_add_f32 v[114:115], v[18:19], v[114:115] neg_lo:[0,1] neg_hi:[0,1]
    v_pk_fma_f32 v[16:17], v[204:205], s[30:31], v[200:201]
    v_pk_fma_f32 v[18:19], v[206:207], s[30:31], v[202:203]
    v_pk_fma_f32 v[200:201], v[200:201], s[30:31], v[204:205]
    v_pk_fma_f32 v[202:203], v[202:203], s[30:31], v[206:207]
    v_cvt_pk_bf16_f32 v216, v200, v201
    v_cvt_pk_bf16_f32 v217, v202, v203
    ds_write_b128 v248, v[214:217] offset:384
    v_accvgpr_read_b32 v192, a20
    v_accvgpr_read_b32 v193, a21
    v_accvgpr_read_b32 v194, a22
    v_accvgpr_read_b32 v195, a23
    v_accvgpr_read_b32 v196, a116
    v_accvgpr_read_b32 v197, a117
    v_accvgpr_read_b32 v198, a118
    v_accvgpr_read_b32 v199, a119
    v_pk_add_f32 v[192:193], v[192:193], v[196:197]
    v_pk_add_f32 v[194:195], v[194:195], v[198:199]
    v_pk_add_f32 v[196:197], v[20:21], v[116:117]
    v_pk_add_f32 v[198:199], v[22:23], v[118:119]
    v_pk_add_f32 v[116:117], v[20:21], v[116:117] neg_lo:[0,1] neg_hi:[0,1]
    v_pk_add_f32 v[118:119], v[22:23], v[118:119] neg_lo:[0,1] neg_hi:[0,1]
    v_pk_fma_f32 v[20:21], v[196:197], s[30:31], v[192:193]
    v_pk_fma_f32 v[22:23], v[198:199], s[30:31], v[194:195]
    v_pk_fma_f32 v[192:193], v[192:193], s[30:31], v[196:197]
    v_pk_fma_f32 v[194:195], v[194:195], s[30:31], v[198:199]
    v_cvt_pk_bf16_f32 v218, v192, v193
    v_cvt_pk_bf16_f32 v219, v194, v195
    v_accvgpr_read_b32 v192, a24
    v_accvgpr_read_b32 v193, a25
    v_accvgpr_read_b32 v194, a26
    v_accvgpr_read_b32 v195, a27
    v_accvgpr_read_b32 v196, a120
    v_accvgpr_read_b32 v197, a121
    v_accvgpr_read_b32 v198, a122
    v_accvgpr_read_b32 v199, a123
    v_pk_add_f32 v[192:193], v[192:193], v[196:197]
    v_pk_add_f32 v[194:195], v[194:195], v[198:199]
    v_pk_add_f32 v[196:197], v[24:25], v[120:121]
    v_pk_add_f32 v[198:199], v[26:27], v[122:123]
    v_pk_add_f32 v[120:121], v[24:25], v[120:121] neg_lo:[0,1] neg_hi:[0,1]
    v_pk_add_f32 v[122:123], v[26:27], v[122:123] neg_lo:[0,1] neg_hi:[0,1]
    v_pk_fma_f32 v[24:25], v[196:197], s[30:31], v[192:193]
    v_pk_fma_f32 v[26:27], v[198:199], s[30:31], v[194:195]
    v_pk_fma_f32 v[192:193], v[192:193], s[30:31], v[196:197]
    v_pk_fma_f32 v[194:195], v[194:195], s[30:31], v[198:199]
    v_cvt_pk_bf16_f32 v208, v192, v193
    v_cvt_pk_bf16_f32 v209, v194, v195
    ds_write_b64 v249, v[218:219] offset:448
    v_accvgpr_read_b32 v200, a28
    v_accvgpr_read_b32 v201, a29
    v_accvgpr_read_b32 v202, a30
    v_accvgpr_read_b32 v203, a31
    v_accvgpr_read_b32 v204, a124
    v_accvgpr_read_b32 v205, a125
    v_accvgpr_read_b32 v206, a126
    v_accvgpr_read_b32 v207, a127
    v_pk_add_f32 v[200:201], v[200:201], v[204:205]
    v_pk_add_f32 v[202:203], v[202:203], v[206:207]
    v_pk_add_f32 v[204:205], v[28:29], v[124:125]
    v_pk_add_f32 v[206:207], v[30:31], v[126:127]
    v_pk_add_f32 v[124:125], v[28:29], v[124:125] neg_lo:[0,1] neg_hi:[0,1]
    v_pk_add_f32 v[126:127], v[30:31], v[126:127] neg_lo:[0,1] neg_hi:[0,1]
    v_pk_fma_f32 v[28:29], v[204:205], s[30:31], v[200:201]
    v_pk_fma_f32 v[30:31], v[206:207], s[30:31], v[202:203]
    v_pk_fma_f32 v[200:201], v[200:201], s[30:31], v[204:205]
    v_pk_fma_f32 v[202:203], v[202:203], s[30:31], v[206:207]
    v_cvt_pk_bf16_f32 v210, v200, v201
    v_cvt_pk_bf16_f32 v211, v202, v203
    ds_write_b128 v248, v[208:211] offset:768
    v_accvgpr_read_b32 v192, a32
    v_accvgpr_read_b32 v193, a33
    v_accvgpr_read_b32 v194, a34
    v_accvgpr_read_b32 v195, a35
    v_accvgpr_read_b32 v196, a128
    v_accvgpr_read_b32 v197, a129
    v_accvgpr_read_b32 v198, a130
    v_accvgpr_read_b32 v199, a131
    v_pk_add_f32 v[192:193], v[192:193], v[196:197]
    v_pk_add_f32 v[194:195], v[194:195], v[198:199]
    v_pk_add_f32 v[196:197], v[32:33], v[128:129]
    v_pk_add_f32 v[198:199], v[34:35], v[130:131]
    v_pk_add_f32 v[128:129], v[32:33], v[128:129] neg_lo:[0,1] neg_hi:[0,1]
    v_pk_add_f32 v[130:131], v[34:35], v[130:131] neg_lo:[0,1] neg_hi:[0,1]
    v_pk_fma_f32 v[32:33], v[196:197], s[30:31], v[192:193]
    v_pk_fma_f32 v[34:35], v[198:199], s[30:31], v[194:195]
    v_pk_fma_f32 v[192:193], v[192:193], s[30:31], v[196:197]
    v_pk_fma_f32 v[194:195], v[194:195], s[30:31], v[198:199]
    v_cvt_pk_bf16_f32 v212, v192, v193
    v_cvt_pk_bf16_f32 v213, v194, v195
    v_accvgpr_read_b32 v192, a36
    v_accvgpr_read_b32 v193, a37
    v_accvgpr_read_b32 v194, a38
    v_accvgpr_read_b32 v195, a39
    v_accvgpr_read_b32 v196, a132
    v_accvgpr_read_b32 v197, a133
    v_accvgpr_read_b32 v198, a134
    v_accvgpr_read_b32 v199, a135
    v_pk_add_f32 v[192:193], v[192:193], v[196:197]
    v_pk_add_f32 v[194:195], v[194:195], v[198:199]
    v_pk_add_f32 v[196:197], v[36:37], v[132:133]
    v_pk_add_f32 v[198:199], v[38:39], v[134:135]
    v_pk_add_f32 v[132:133], v[36:37], v[132:133] neg_lo:[0,1] neg_hi:[0,1]
    v_pk_add_f32 v[134:135], v[38:39], v[134:135] neg_lo:[0,1] neg_hi:[0,1]
    v_pk_fma_f32 v[36:37], v[196:197], s[30:31], v[192:193]
    v_pk_fma_f32 v[38:39], v[198:199], s[30:31], v[194:195]
    v_pk_fma_f32 v[192:193], v[192:193], s[30:31], v[196:197]
    v_pk_fma_f32 v[194:195], v[194:195], s[30:31], v[198:199]
    v_cvt_pk_bf16_f32 v214, v192, v193
    v_cvt_pk_bf16_f32 v215, v194, v195
    ds_write_b64 v249, v[212:213] offset:832
    v_accvgpr_read_b32 v200, a40
    v_accvgpr_read_b32 v201, a41
    v_accvgpr_read_b32 v202, a42
    v_accvgpr_read_b32 v203, a43
    v_accvgpr_read_b32 v204, a136
    v_accvgpr_read_b32 v205, a137
    v_accvgpr_read_b32 v206, a138
    v_accvgpr_read_b32 v207, a139
    v_pk_add_f32 v[200:201], v[200:201], v[204:205]
    v_pk_add_f32 v[202:203], v[202:203], v[206:207]
    v_pk_add_f32 v[204:205], v[40:41], v[136:137]
    v_pk_add_f32 v[206:207], v[42:43], v[138:139]
    v_pk_add_f32 v[136:137], v[40:41], v[136:137] neg_lo:[0,1] neg_hi:[0,1]
    v_pk_add_f32 v[138:139], v[42:43], v[138:139] neg_lo:[0,1] neg_hi:[0,1]
    v_pk_fma_f32 v[40:41], v[204:205], s[30:31], v[200:201]
    v_pk_fma_f32 v[42:43], v[206:207], s[30:31], v[202:203]
    v_pk_fma_f32 v[200:201], v[200:201], s[30:31], v[204:205]
    v_pk_fma_f32 v[202:203], v[202:203], s[30:31], v[206:207]
    v_cvt_pk_bf16_f32 v216, v200, v201
    v_cvt_pk_bf16_f32 v217, v202, v203
    ds_write_b128 v248, v[214:217] offset:1152
    v_accvgpr_read_b32 v192, a44
    v_accvgpr_read_b32 v193, a45
    v_accvgpr_read_b32 v194, a46
    v_accvgpr_read_b32 v195, a47
    v_accvgpr_read_b32 v196, a140
    v_accvgpr_read_b32 v197, a141
    v_accvgpr_read_b32 v198, a142
    v_accvgpr_read_b32 v199, a143
    v_pk_add_f32 v[192:193], v[192:193], v[196:197]
    v_pk_add_f32 v[194:195], v[194:195], v[198:199]
    v_pk_add_f32 v[196:197], v[44:45], v[140:141]
    v_pk_add_f32 v[198:199], v[46:47], v[142:143]
    v_pk_add_f32 v[140:141], v[44:45], v[140:141] neg_lo:[0,1] neg_hi:[0,1]
    v_pk_add_f32 v[142:143], v[46:47], v[142:143] neg_lo:[0,1] neg_hi:[0,1]
    v_pk_fma_f32 v[44:45], v[196:197], s[30:31], v[192:193]
    v_pk_fma_f32 v[46:47], v[198:199], s[30:31], v[194:195]
    v_pk_fma_f32 v[192:193], v[192:193], s[30:31], v[196:197]
    v_pk_fma_f32 v[194:195], v[194:195], s[30:31], v[198:199]
    v_cvt_pk_bf16_f32 v218, v192, v193
    v_cvt_pk_bf16_f32 v219, v194, v195
    v_accvgpr_read_b32 v192, a48
    v_accvgpr_read_b32 v193, a49
    v_accvgpr_read_b32 v194, a50
    v_accvgpr_read_b32 v195, a51
    v_accvgpr_read_b32 v196, a144
    v_accvgpr_read_b32 v197, a145
    v_accvgpr_read_b32 v198, a146
    v_accvgpr_read_b32 v199, a147
    v_pk_add_f32 v[192:193], v[192:193], v[196:197]
    v_pk_add_f32 v[194:195], v[194:195], v[198:199]
    v_pk_add_f32 v[196:197], v[48:49], v[144:145]
    v_pk_add_f32 v[198:199], v[50:51], v[146:147]
    v_pk_add_f32 v[144:145], v[48:49], v[144:145] neg_lo:[0,1] neg_hi:[0,1]
    v_pk_add_f32 v[146:147], v[50:51], v[146:147] neg_lo:[0,1] neg_hi:[0,1]
    v_pk_fma_f32 v[48:49], v[196:197], s[30:31], v[192:193]
    v_pk_fma_f32 v[50:51], v[198:199], s[30:31], v[194:195]
    v_pk_fma_f32 v[192:193], v[192:193], s[30:31], v[196:197]
    v_pk_fma_f32 v[194:195], v[194:195], s[30:31], v[198:199]
    v_cvt_pk_bf16_f32 v208, v192, v193
    v_cvt_pk_bf16_f32 v209, v194, v195
    ds_write_b64 v249, v[218:219] offset:1216
    v_accvgpr_read_b32 v200, a52
    v_accvgpr_read_b32 v201, a53
    v_accvgpr_read_b32 v202, a54
    v_accvgpr_read_b32 v203, a55
    v_accvgpr_read_b32 v204, a148
    v_accvgpr_read_b32 v205, a149
    v_accvgpr_read_b32 v206, a150
    v_accvgpr_read_b32 v207, a151
    v_pk_add_f32 v[200:201], v[200:201], v[204:205]
    v_pk_add_f32 v[202:203], v[202:203], v[206:207]
    v_pk_add_f32 v[204:205], v[52:53], v[148:149]
    v_pk_add_f32 v[206:207], v[54:55], v[150:151]
    v_pk_add_f32 v[148:149], v[52:53], v[148:149] neg_lo:[0,1] neg_hi:[0,1]
    v_pk_add_f32 v[150:151], v[54:55], v[150:151] neg_lo:[0,1] neg_hi:[0,1]
    v_pk_fma_f32 v[52:53], v[204:205], s[30:31], v[200:201]
    v_pk_fma_f32 v[54:55], v[206:207], s[30:31], v[202:203]
    v_pk_fma_f32 v[200:201], v[200:201], s[30:31], v[204:205]
    v_pk_fma_f32 v[202:203], v[202:203], s[30:31], v[206:207]
    v_cvt_pk_bf16_f32 v210, v200, v201
    v_cvt_pk_bf16_f32 v211, v202, v203
    ds_write_b128 v248, v[208:211] offset:1536
    v_accvgpr_read_b32 v192, a56
    v_accvgpr_read_b32 v193, a57
    v_accvgpr_read_b32 v194, a58
    v_accvgpr_read_b32 v195, a59
    v_accvgpr_read_b32 v196, a152
    v_accvgpr_read_b32 v197, a153
    v_accvgpr_read_b32 v198, a154
    v_accvgpr_read_b32 v199, a155
    v_pk_add_f32 v[192:193], v[192:193], v[196:197]
    v_pk_add_f32 v[194:195], v[194:195], v[198:199]
    v_pk_add_f32 v[196:197], v[56:57], v[152:153]
    v_pk_add_f32 v[198:199], v[58:59], v[154:155]
    v_pk_add_f32 v[152:153], v[56:57], v[152:153] neg_lo:[0,1] neg_hi:[0,1]
    v_pk_add_f32 v[154:155], v[58:59], v[154:155] neg_lo:[0,1] neg_hi:[0,1]
    v_pk_fma_f32 v[56:57], v[196:197], s[30:31], v[192:193]
    v_pk_fma_f32 v[58:59], v[198:199], s[30:31], v[194:195]
    v_pk_fma_f32 v[192:193], v[192:193], s[30:31], v[196:197]
    v_pk_fma_f32 v[194:195], v[194:195], s[30:31], v[198:199]
    v_cvt_pk_bf16_f32 v212, v192, v193
    v_cvt_pk_bf16_f32 v213, v194, v195
    v_accvgpr_read_b32 v192, a60
    v_accvgpr_read_b32 v193, a61
    v_accvgpr_read_b32 v194, a62
    v_accvgpr_read_b32 v195, a63
    v_accvgpr_read_b32 v196, a156
    v_accvgpr_read_b32 v197, a157
    v_accvgpr_read_b32 v198, a158
    v_accvgpr_read_b32 v199, a159
    v_pk_add_f32 v[192:193], v[192:193], v[196:197]
    v_pk_add_f32 v[194:195], v[194:195], v[198:199]
    v_pk_add_f32 v[196:197], v[60:61], v[156:157]
    v_pk_add_f32 v[198:199], v[62:63], v[158:159]
    v_pk_add_f32 v[156:157], v[60:61], v[156:157] neg_lo:[0,1] neg_hi:[0,1]
    v_pk_add_f32 v[158:159], v[62:63], v[158:159] neg_lo:[0,1] neg_hi:[0,1]
    v_pk_fma_f32 v[60:61], v[196:197], s[30:31], v[192:193]
    v_pk_fma_f32 v[62:63], v[198:199], s[30:31], v[194:195]
    v_pk_fma_f32 v[192:193], v[192:193], s[30:31], v[196:197]
    v_pk_fma_f32 v[194:195], v[194:195], s[30:31], v[198:199]
    v_cvt_pk_bf16_f32 v214, v192, v193
    v_cvt_pk_bf16_f32 v215, v194, v195
    ds_write_b64 v249, v[212:213] offset:1600
    v_accvgpr_read_b32 v200, a64
    v_accvgpr_read_b32 v201, a65
    v_accvgpr_read_b32 v202, a66
    v_accvgpr_read_b32 v203, a67
    v_accvgpr_read_b32 v204, a160
    v_accvgpr_read_b32 v205, a161
    v_accvgpr_read_b32 v206, a162
    v_accvgpr_read_b32 v207, a163
    v_pk_add_f32 v[200:201], v[200:201], v[204:205]
    v_pk_add_f32 v[202:203], v[202:203], v[206:207]
    v_pk_add_f32 v[204:205], v[64:65], v[160:161]
    v_pk_add_f32 v[206:207], v[66:67], v[162:163]
    v_pk_add_f32 v[160:161], v[64:65], v[160:161] neg_lo:[0,1] neg_hi:[0,1]
    v_pk_add_f32 v[162:163], v[66:67], v[162:163] neg_lo:[0,1] neg_hi:[0,1]
    v_pk_fma_f32 v[64:65], v[204:205], s[30:31], v[200:201]
    v_pk_fma_f32 v[66:67], v[206:207], s[30:31], v[202:203]
    v_pk_fma_f32 v[200:201], v[200:201], s[30:31], v[204:205]
    v_pk_fma_f32 v[202:203], v[202:203], s[30:31], v[206:207]
    v_cvt_pk_bf16_f32 v216, v200, v201
    v_cvt_pk_bf16_f32 v217, v202, v203
    ds_write_b128 v248, v[214:217] offset:1920
    v_accvgpr_read_b32 v192, a68
    v_accvgpr_read_b32 v193, a69
    v_accvgpr_read_b32 v194, a70
    v_accvgpr_read_b32 v195, a71
    v_accvgpr_read_b32 v196, a164
    v_accvgpr_read_b32 v197, a165
    v_accvgpr_read_b32 v198, a166
    v_accvgpr_read_b32 v199, a167
    v_pk_add_f32 v[192:193], v[192:193], v[196:197]
    v_pk_add_f32 v[194:195], v[194:195], v[198:199]
    v_pk_add_f32 v[196:197], v[68:69], v[164:165]
    v_pk_add_f32 v[198:199], v[70:71], v[166:167]
    v_pk_add_f32 v[164:165], v[68:69], v[164:165] neg_lo:[0,1] neg_hi:[0,1]
    v_pk_add_f32 v[166:167], v[70:71], v[166:167] neg_lo:[0,1] neg_hi:[0,1]
    v_pk_fma_f32 v[68:69], v[196:197], s[30:31], v[192:193]
    v_pk_fma_f32 v[70:71], v[198:199], s[30:31], v[194:195]
    v_pk_fma_f32 v[192:193], v[192:193], s[30:31], v[196:197]
    v_pk_fma_f32 v[194:195], v[194:195], s[30:31], v[198:199]
    v_cvt_pk_bf16_f32 v218, v192, v193
    v_cvt_pk_bf16_f32 v219, v194, v195
    v_accvgpr_read_b32 v192, a72
    v_accvgpr_read_b32 v193, a73
    v_accvgpr_read_b32 v194, a74
    v_accvgpr_read_b32 v195, a75
    v_accvgpr_read_b32 v196, a168
    v_accvgpr_read_b32 v197, a169
    v_accvgpr_read_b32 v198, a170
    v_accvgpr_read_b32 v199, a171
    v_pk_add_f32 v[192:193], v[192:193], v[196:197]
    v_pk_add_f32 v[194:195], v[194:195], v[198:199]
    v_pk_add_f32 v[196:197], v[72:73], v[168:169]
    v_pk_add_f32 v[198:199], v[74:75], v[170:171]
    v_pk_add_f32 v[168:169], v[72:73], v[168:169] neg_lo:[0,1] neg_hi:[0,1]
    v_pk_add_f32 v[170:171], v[74:75], v[170:171] neg_lo:[0,1] neg_hi:[0,1]
    v_pk_fma_f32 v[72:73], v[196:197], s[30:31], v[192:193]
    v_pk_fma_f32 v[74:75], v[198:199], s[30:31], v[194:195]
    v_pk_fma_f32 v[192:193], v[192:193], s[30:31], v[196:197]
    v_pk_fma_f32 v[194:195], v[194:195], s[30:31], v[198:199]
    v_cvt_pk_bf16_f32 v208, v192, v193
    v_cvt_pk_bf16_f32 v209, v194, v195
    ds_write_b64 v249, v[218:219] offset:1984
    v_accvgpr_read_b32 v200, a76
    v_accvgpr_read_b32 v201, a77
    v_accvgpr_read_b32 v202, a78
    v_accvgpr_read_b32 v203, a79
    v_accvgpr_read_b32 v204, a172
    v_accvgpr_read_b32 v205, a173
    v_accvgpr_read_b32 v206, a174
    v_accvgpr_read_b32 v207, a175
    v_pk_add_f32 v[200:201], v[200:201], v[204:205]
    v_pk_add_f32 v[202:203], v[202:203], v[206:207]
    v_pk_add_f32 v[204:205], v[76:77], v[172:173]
    v_pk_add_f32 v[206:207], v[78:79], v[174:175]
    v_pk_add_f32 v[172:173], v[76:77], v[172:173] neg_lo:[0,1] neg_hi:[0,1]
    v_pk_add_f32 v[174:175], v[78:79], v[174:175] neg_lo:[0,1] neg_hi:[0,1]
    v_pk_fma_f32 v[76:77], v[204:205], s[30:31], v[200:201]
    v_pk_fma_f32 v[78:79], v[206:207], s[30:31], v[202:203]
    v_pk_fma_f32 v[200:201], v[200:201], s[30:31], v[204:205]
    v_pk_fma_f32 v[202:203], v[202:203], s[30:31], v[206:207]
    v_cvt_pk_bf16_f32 v210, v200, v201
    v_cvt_pk_bf16_f32 v211, v202, v203
    ds_write_b128 v248, v[208:211] offset:2304
    v_accvgpr_read_b32 v192, a80
    v_accvgpr_read_b32 v193, a81
    v_accvgpr_read_b32 v194, a82
    v_accvgpr_read_b32 v195, a83
    v_accvgpr_read_b32 v196, a176
    v_accvgpr_read_b32 v197, a177
    v_accvgpr_read_b32 v198, a178
    v_accvgpr_read_b32 v199, a179
    v_pk_add_f32 v[192:193], v[192:193], v[196:197]
    v_pk_add_f32 v[194:195], v[194:195], v[198:199]
    v_pk_add_f32 v[196:197], v[80:81], v[176:177]
    v_pk_add_f32 v[198:199], v[82:83], v[178:179]
    v_pk_add_f32 v[176:177], v[80:81], v[176:177] neg_lo:[0,1] neg_hi:[0,1]
    v_pk_add_f32 v[178:179], v[82:83], v[178:179] neg_lo:[0,1] neg_hi:[0,1]
    v_pk_fma_f32 v[80:81], v[196:197], s[30:31], v[192:193]
    v_pk_fma_f32 v[82:83], v[198:199], s[30:31], v[194:195]
    v_pk_fma_f32 v[192:193], v[192:193], s[30:31], v[196:197]
    v_pk_fma_f32 v[194:195], v[194:195], s[30:31], v[198:199]
    v_cvt_pk_bf16_f32 v212, v192, v193
    v_cvt_pk_bf16_f32 v213, v194, v195
    v_accvgpr_read_b32 v192, a84
    v_accvgpr_read_b32 v193, a85
    v_accvgpr_read_b32 v194, a86
    v_accvgpr_read_b32 v195, a87
    v_accvgpr_read_b32 v196, a180
    v_accvgpr_read_b32 v197, a181
    v_accvgpr_read_b32 v198, a182
    v_accvgpr_read_b32 v199, a183
    v_pk_add_f32 v[192:193], v[192:193], v[196:197]
    v_pk_add_f32 v[194:195], v[194:195], v[198:199]
    v_pk_add_f32 v[196:197], v[84:85], v[180:181]
    v_pk_add_f32 v[198:199], v[86:87], v[182:183]
    v_pk_add_f32 v[180:181], v[84:85], v[180:181] neg_lo:[0,1] neg_hi:[0,1]
    v_pk_add_f32 v[182:183], v[86:87], v[182:183] neg_lo:[0,1] neg_hi:[0,1]
    v_pk_fma_f32 v[84:85], v[196:197], s[30:31], v[192:193]
    v_pk_fma_f32 v[86:87], v[198:199], s[30:31], v[194:195]
    v_pk_fma_f32 v[192:193], v[192:193], s[30:31], v[196:197]
    v_pk_fma_f32 v[194:195], v[194:195], s[30:31], v[198:199]
    v_cvt_pk_bf16_f32 v214, v192, v193
    v_cvt_pk_bf16_f32 v215, v194, v195
    ds_write_b64 v249, v[212:213] offset:2368
    v_accvgpr_read_b32 v200, a88
    v_accvgpr_read_b32 v201, a89
    v_accvgpr_read_b32 v202, a90
    v_accvgpr_read_b32 v203, a91
    v_accvgpr_read_b32 v204, a184
    v_accvgpr_read_b32 v205, a185
    v_accvgpr_read_b32 v206, a186
    v_accvgpr_read_b32 v207, a187
    v_pk_add_f32 v[200:201], v[200:201], v[204:205]
    v_pk_add_f32 v[202:203], v[202:203], v[206:207]
    v_pk_add_f32 v[204:205], v[88:89], v[184:185]
    v_pk_add_f32 v[206:207], v[90:91], v[186:187]
    v_pk_add_f32 v[184:185], v[88:89], v[184:185] neg_lo:[0,1] neg_hi:[0,1]
    v_pk_add_f32 v[186:187], v[90:91], v[186:187] neg_lo:[0,1] neg_hi:[0,1]
    v_pk_fma_f32 v[88:89], v[204:205], s[30:31], v[200:201]
    v_pk_fma_f32 v[90:91], v[206:207], s[30:31], v[202:203]
    v_pk_fma_f32 v[200:201], v[200:201], s[30:31], v[204:205]
    v_pk_fma_f32 v[202:203], v[202:203], s[30:31], v[206:207]
    v_cvt_pk_bf16_f32 v216, v200, v201
    v_cvt_pk_bf16_f32 v217, v202, v203
    ds_write_b128 v248, v[214:217] offset:2688
    v_accvgpr_read_b32 v192, a92
    v_accvgpr_read_b32 v193, a93
    v_accvgpr_read_b32 v194, a94
    v_accvgpr_read_b32 v195, a95
    v_accvgpr_read_b32 v196, a188
    v_accvgpr_read_b32 v197, a189
    v_accvgpr_read_b32 v198, a190
    v_accvgpr_read_b32 v199, a191
    v_pk_add_f32 v[192:193], v[192:193], v[196:197]
    v_pk_add_f32 v[194:195], v[194:195], v[198:199]
    v_pk_add_f32 v[196:197], v[92:93], v[188:189]
    v_pk_add_f32 v[198:199], v[94:95], v[190:191]
    v_pk_add_f32 v[188:189], v[92:93], v[188:189] neg_lo:[0,1] neg_hi:[0,1]
    v_pk_add_f32 v[190:191], v[94:95], v[190:191] neg_lo:[0,1] neg_hi:[0,1]
    v_pk_fma_f32 v[92:93], v[196:197], s[30:31], v[192:193]
    v_pk_fma_f32 v[94:95], v[198:199], s[30:31], v[194:195]
    v_pk_fma_f32 v[192:193], v[192:193], s[30:31], v[196:197]
    v_pk_fma_f32 v[194:195], v[194:195], s[30:31], v[198:199]
    v_cvt_pk_bf16_f32 v218, v192, v193
    v_cvt_pk_bf16_f32 v219, v194, v195
    ds_write_b64 v249, v[218:219] offset:2752
    s_waitcnt lgkmcnt(0)
    s_barrier
sub24:
    v_mfma_f32_16x16x32_bf16 v[0:3], a[192:195], v[228:231], v[0:3]
    s_waitcnt vmcnt(8)
    v_add_u32 v250, s51, v254
    v_accvgpr_read_b32 v220, a0
    v_accvgpr_read_b32 v221, a1
    v_mfma_f32_16x16x32_bf16 v[4:7], a[196:199], v[228:231], v[4:7]
    ds_read_b128 v[204:207], v250 offset:0
    v_accvgpr_read_b32 v222, a2
    v_mfma_f32_16x16x32_bf16 v[8:11], a[200:203], v[228:231], v[8:11]
    ds_read_b128 v[228:231], v253 offset:33536
    v_accvgpr_read_b32 v223, a3
    v_mfma_f32_16x16x32_bf16 v[0:3], a[204:207], v[232:235], v[0:3]
    buffer_load_dwordx4 a[244:247], v254, s[8:11], s42 offen offset:1024 sc1
    v_accvgpr_read_b32 v224, a96
    v_mfma_f32_16x16x32_bf16 v[4:7], a[208:211], v[232:235], v[4:7]
    ds_read_b128 v[208:211], v250 offset:1024
    v_accvgpr_read_b32 v225, a97
    v_mfma_f32_16x16x32_bf16 v[8:11], a[212:215], v[232:235], v[8:11]
    ds_read_b128 v[212:215], v250 offset:2048
    v_accvgpr_read_b32 v226, a98
    v_accvgpr_read_b32 v227, a99
    v_mfma_f32_16x16x32_bf16 v[12:15], a[192:195], v[232:235], v[12:15]
    ds_read_b128 v[216:219], v250 offset:3104
    v_sub_f32 v220, v220, v224
    v_mfma_f32_16x16x32_bf16 v[12:15], a[204:207], v[236:239], v[12:15]
    buffer_load_dwordx4 a[248:251], v254, s[8:11], s42 offen offset:2048 sc1
    v_sub_f32 v221, v221, v225
    v_mfma_f32_16x16x32_bf16 v[16:19], a[208:211], v[236:239], v[16:19]
    s_add_u32 s44, s40, 393216
    v_sub_f32 v222, v222, v226
    v_sub_f32 v223, v223, v227
    v_mfma_f32_16x16x32_bf16 v[16:19], a[196:199], v[232:235], v[16:19]
    s_add_u32 s42, s36, 927744
    v_add_f32 v224, v220, v96
    v_add_f32 v225, v221, v97
    v_add_f32 v226, v222, v98
    v_mfma_f32_16x16x32_bf16 v[20:23], a[200:203], v[232:235], v[20:23]
    ds_read_b128 v[232:235], v253 offset:33280
    v_add_f32 v227, v223, v99
    v_mfma_f32_16x16x32_bf16 v[20:23], a[212:215], v[236:239], v[20:23]
    buffer_load_dwordx4 a[252:255], v254, s[8:11], s42 offen offset:0 sc1
    v_mul_f32 v96, s28, v96
    s_waitcnt vmcnt(8)
    v_mfma_f32_16x16x32_bf16 v[0:3], a[216:219], v[236:239], v[0:3]
    s_waitcnt lgkmcnt(5)
    v_mul_f32 v97, s28, v97
    v_mul_f32 v98, s28, v98
    v_mfma_f32_16x16x32_bf16 v[4:7], a[220:223], v[236:239], v[4:7]
    v_mul_f32 v99, s28, v99
    v_mul_f32 v224, s26, v224
    v_mfma_f32_16x16x32_bf16 v[8:11], a[224:227], v[236:239], v[8:11]
    s_waitcnt lgkmcnt(4)
    v_mul_f32 v225, s26, v225
    v_mul_f32 v226, s26, v226
    v_mul_f32 v227, s26, v227
    v_mfma_f32_16x16x32_bf16 v[24:27], a[192:195], v[236:239], v[24:27]
    buffer_load_dwordx4 v[240:243], v254, s[8:11], s42 offen offset:1024 sc1
    v_mfma_f32_16x16x32_bf16 v[24:27], a[204:207], v[228:231], v[24:27]
    v_fmac_f32 v96, s34, v220
    v_fmac_f32 v97, s34, v221
    v_fmac_f32 v98, s34, v222
    v_mfma_f32_16x16x32_bf16 v[28:31], a[208:211], v[228:231], v[28:31]
    v_fmac_f32 v99, s34, v223
    v_cvt_pk_bf16_f32 v192, v224, v225
    v_mfma_f32_16x16x32_bf16 v[28:31], a[196:199], v[236:239], v[28:31]
    buffer_load_dwordx4 v[244:247], v254, s[8:11], s42 offen offset:2048 sc1
    v_cvt_pk_bf16_f32 v193, v226, v227
    v_mfma_f32_16x16x32_bf16 v[32:35], a[200:203], v[236:239], v[32:35]
    ds_read_b128 v[236:239], v253 offset:35104
    v_accvgpr_write_b32 a0, v192
    v_mfma_f32_16x16x32_bf16 v[32:35], a[212:215], v[228:231], v[32:35]
    v_accvgpr_write_b32 a1, v193
    v_accvgpr_read_b32 v220, a4
    v_accvgpr_read_b32 v221, a5
    v_mfma_f32_16x16x32_bf16 v[12:15], a[216:219], v[228:231], v[12:15]
    buffer_store_dwordx4 v[204:207], v254, s[12:15], s44 offen sc1
    s_add_u32 s44, s40, 394240
    v_accvgpr_read_b32 v222, a6
    v_mfma_f32_16x16x32_bf16 v[16:19], a[220:223], v[228:231], v[16:19]
    v_accvgpr_read_b32 v223, a7
    v_accvgpr_read_b32 v224, a100
    v_mfma_f32_16x16x32_bf16 v[20:23], a[224:227], v[228:231], v[20:23]
    s_waitcnt lgkmcnt(4)
    v_accvgpr_read_b32 v225, a101
    v_accvgpr_read_b32 v226, a102
    v_accvgpr_read_b32 v227, a103
    v_mfma_f32_16x16x32_bf16 v[36:39], a[192:195], v[228:231], v[36:39]
    s_waitcnt lgkmcnt(1)
    v_sub_f32 v220, v220, v224
    v_sub_f32 v221, v221, v225
    v_mfma_f32_16x16x32_bf16 v[36:39], a[204:207], v[232:235], v[36:39]
    v_sub_f32 v222, v222, v226
    v_sub_f32 v223, v223, v227
    v_add_f32 v224, v220, v100
    v_mfma_f32_16x16x32_bf16 v[40:43], a[208:211], v[232:235], v[40:43]
    v_add_f32 v225, v221, v101
    v_add_f32 v226, v222, v102
    v_mfma_f32_16x16x32_bf16 v[40:43], a[196:199], v[228:231], v[40:43]
    buffer_store_dwordx4 v[208:211], v254, s[12:15], s44 offen sc1
    v_add_f32 v227, v223, v103
    v_mul_f32 v100, s28, v100
    v_mul_f32 v101, s28, v101
    v_mfma_f32_16x16x32_bf16 v[44:47], a[200:203], v[228:231], v[44:47]
pad9:
    s_cbranch_vccnz pad13
    ds_read_b128 v[228:231], v253 offset:34848
    v_mul_f32 v102, s28, v102
    v_mfma_f32_16x16x32_bf16 v[44:47], a[212:215], v[232:235], v[44:47]
    ds_read_b128 v[204:207], v250 offset:4128
    v_mul_f32 v103, s28, v103
    v_mul_f32 v224, s26, v224
    v_mfma_f32_16x16x32_bf16 v[24:27], a[216:219], v[232:235], v[24:27]
    ds_read_b128 v[208:211], v250 offset:5152
    v_mul_f32 v225, s26, v225
    v_mfma_f32_16x16x32_bf16 v[28:31], a[220:223], v[232:235], v[28:31]
    s_add_u32 s44, s40, 395264
    v_mul_f32 v226, s26, v226
    v_mul_f32 v227, s26, v227
    v_fmac_f32 v100, s34, v220
    v_mfma_f32_16x16x32_bf16 v[32:35], a[224:227], v[232:235], v[32:35]
    v_fmac_f32 v101, s34, v221
    v_fmac_f32 v102, s34, v222
    v_mfma_f32_16x16x32_bf16 v[48:51], a[192:195], v[232:235], v[48:51]
    s_waitcnt lgkmcnt(3)
    v_fmac_f32 v103, s34, v223
    v_cvt_pk_bf16_f32 v194, v224, v225
    v_mfma_f32_16x16x32_bf16 v[48:51], a[204:207], v[236:239], v[48:51]
    v_cvt_pk_bf16_f32 v195, v226, v227
    v_accvgpr_write_b32 a2, v194
    v_accvgpr_write_b32 a3, v195
    v_mfma_f32_16x16x32_bf16 v[52:55], a[208:211], v[236:239], v[52:55]
    v_accvgpr_read_b32 v220, a8
    v_accvgpr_read_b32 v221, a9
    v_mfma_f32_16x16x32_bf16 v[52:55], a[196:199], v[232:235], v[52:55]
    v_accvgpr_read_b32 v222, a10
    v_accvgpr_read_b32 v223, a11
    v_accvgpr_read_b32 v224, a104
    v_mfma_f32_16x16x32_bf16 v[56:59], a[200:203], v[232:235], v[56:59]
    ds_read_b128 v[232:235], v253 offset:34592
    v_accvgpr_read_b32 v225, a105
    v_mfma_f32_16x16x32_bf16 v[56:59], a[212:215], v[236:239], v[56:59]
    v_accvgpr_read_b32 v226, a106
    v_accvgpr_read_b32 v227, a107
    v_sub_f32 v220, v220, v224
    v_mfma_f32_16x16x32_bf16 v[36:39], a[216:219], v[236:239], v[36:39]
    buffer_store_dwordx4 v[212:215], v254, s[12:15], s44 offen sc1
    v_sub_f32 v221, v221, v225
    v_sub_f32 v222, v222, v226
    v_mfma_f32_16x16x32_bf16 v[40:43], a[220:223], v[236:239], v[40:43]
    v_sub_f32 v223, v223, v227
    v_add_f32 v224, v220, v104
    v_add_f32 v225, v221, v105
    v_mfma_f32_16x16x32_bf16 v[44:47], a[224:227], v[236:239], v[44:47]
    v_add_f32 v226, v222, v106
    v_add_f32 v227, v223, v107
    v_mfma_f32_16x16x32_bf16 v[60:63], a[192:195], v[236:239], v[60:63]
    s_waitcnt lgkmcnt(3)
    v_mul_f32 v104, s28, v104
    v_mul_f32 v105, s28, v105
    v_mfma_f32_16x16x32_bf16 v[60:63], a[204:207], v[228:231], v[60:63]
    s_add_u32 s44, s40, 396288
    v_mul_f32 v106, s28, v106
    v_mul_f32 v107, s28, v107
    v_mul_f32 v224, s26, v224
    v_mfma_f32_16x16x32_bf16 v[64:67], a[208:211], v[228:231], v[64:67]
    v_mul_f32 v225, s26, v225
    v_mul_f32 v226, s26, v226
    v_mfma_f32_16x16x32_bf16 v[64:67], a[196:199], v[236:239], v[64:67]
    v_mul_f32 v227, s26, v227
    v_fmac_f32 v104, s34, v220
    v_fmac_f32 v105, s34, v221
    v_mfma_f32_16x16x32_bf16 v[68:71], a[200:203], v[236:239], v[68:71]
    ds_read_b128 v[236:239], v253 offset:34336
    v_fmac_f32 v106, s34, v222
    v_mfma_f32_16x16x32_bf16 v[68:71], a[212:215], v[228:231], v[68:71]
    v_fmac_f32 v107, s34, v223
    v_cvt_pk_bf16_f32 v196, v224, v225
    v_cvt_pk_bf16_f32 v197, v226, v227
    v_mfma_f32_16x16x32_bf16 v[48:51], a[216:219], v[228:231], v[48:51]
    v_accvgpr_write_b32 a4, v196
    v_accvgpr_write_b32 a5, v197
    v_mfma_f32_16x16x32_bf16 v[52:55], a[220:223], v[228:231], v[52:55]
    v_accvgpr_read_b32 v220, a12
    v_accvgpr_read_b32 v221, a13
    v_accvgpr_read_b32 v222, a14
    v_mfma_f32_16x16x32_bf16 v[56:59], a[224:227], v[228:231], v[56:59]
    v_accvgpr_read_b32 v223, a15
    v_accvgpr_read_b32 v224, a108
    v_mfma_f32_16x16x32_bf16 v[72:75], a[192:195], v[228:231], v[72:75]
    s_waitcnt lgkmcnt(1)
    v_accvgpr_read_b32 v225, a109
    v_accvgpr_read_b32 v226, a110
    v_accvgpr_read_b32 v227, a111
    v_mfma_f32_16x16x32_bf16 v[72:75], a[204:207], v[232:235], v[72:75]
    buffer_store_dwordx4 v[216:219], v254, s[12:15], s44 offen sc1
    v_sub_f32 v220, v220, v224
    v_sub_f32 v221, v221, v225
    v_mfma_f32_16x16x32_bf16 v[76:79], a[208:211], v[232:235], v[76:79]
    v_sub_f32 v222, v222, v226
    v_sub_f32 v223, v223, v227
    v_mfma_f32_16x16x32_bf16 v[76:79], a[196:199], v[228:231], v[76:79]
    v_add_f32 v224, v220, v108
    v_add_f32 v225, v221, v109
    v_add_f32 v226, v222, v110
    v_mfma_f32_16x16x32_bf16 v[80:83], a[200:203], v[228:231], v[80:83]
    ds_read_b128 v[228:231], v253 offset:34064
    v_add_f32 v227, v223, v111
    v_mfma_f32_16x16x32_bf16 v[80:83], a[212:215], v[232:235], v[80:83]
    v_mul_f32 v108, s28, v108
    v_mul_f32 v109, s28, v109
    v_mul_f32 v110, s28, v110
    v_mfma_f32_16x16x32_bf16 v[60:63], a[216:219], v[232:235], v[60:63]
    v_mul_f32 v111, s28, v111
    v_mul_f32 v224, s26, v224
    v_mfma_f32_16x16x32_bf16 v[64:67], a[220:223], v[232:235], v[64:67]
    v_mul_f32 v225, s26, v225
    v_mul_f32 v226, s26, v226
    v_mul_f32 v227, s26, v227
    v_mfma_f32_16x16x32_bf16 v[68:71], a[224:227], v[232:235], v[68:71]
    s_add_u32 s42, s36, 958464
    v_fmac_f32 v108, s34, v220
    v_fmac_f32 v109, s34, v221
    v_mfma_f32_16x16x32_bf16 v[84:87], a[192:195], v[232:235], v[84:87]
    buffer_load_dwordx4 a[192:195], v254, s[8:11], s42 offen offset:0 sc1
    v_fmac_f32 v110, s34, v222
    v_mfma_f32_16x16x32_bf16 v[88:91], a[196:199], v[232:235], v[88:91]
    v_fmac_f32 v111, s34, v223
    v_cvt_pk_bf16_f32 v198, v224, v225
    v_mfma_f32_16x16x32_bf16 v[92:95], a[200:203], v[232:235], v[92:95]
    s_waitcnt lgkmcnt(1)
    v_cvt_pk_bf16_f32 v199, v226, v227
    v_accvgpr_write_b32 a12, v198
    v_mfma_f32_16x16x32_bf16 v[84:87], a[204:207], v[236:239], v[84:87]
    ds_read_b128 v[232:235], v253 offset:15600
    v_accvgpr_write_b32 a13, v199
    v_accvgpr_read_b32 v220, a16
    v_mfma_f32_16x16x32_bf16 v[88:91], a[208:211], v[236:239], v[88:91]
    buffer_load_dwordx4 a[196:199], v254, s[8:11], s42 offen offset:1024 sc1
    v_mfma_f32_16x16x32_bf16 v[92:95], a[212:215], v[236:239], v[92:95]
    v_accvgpr_read_b32 v221, a17
    v_accvgpr_read_b32 v222, a18
    v_accvgpr_read_b32 v223, a19
    v_mfma_f32_16x16x32_bf16 v[72:75], a[216:219], v[236:239], v[72:75]
    s_waitcnt lgkmcnt(1)
    v_accvgpr_read_b32 v224, a112
    v_accvgpr_read_b32 v225, a113
    v_mfma_f32_16x16x32_bf16 v[76:79], a[220:223], v[236:239], v[76:79]
    buffer_load_dwordx4 a[200:203], v254, s[8:11], s42 offen offset:2048 sc1
    v_accvgpr_read_b32 v226, a114
    v_mfma_f32_16x16x32_bf16 v[80:83], a[224:227], v[236:239], v[80:83]
    ds_read_b128 v[236:239], v253 offset:15328
    v_accvgpr_read_b32 v227, a115
    v_mfma_f32_16x16x32_bf16 v[84:87], a[216:219], v[228:231], v[84:87]
    s_add_u32 s42, s36, 961536
    v_sub_f32 v220, v220, v224
    v_sub_f32 v221, v221, v225
    v_sub_f32 v222, v222, v226
    v_mfma_f32_16x16x32_bf16 v[88:91], a[220:223], v[228:231], v[88:91]
    buffer_load_dwordx4 a[204:207], v254, s[8:11], s42 offen offset:0 sc1
    v_mfma_f32_16x16x32_bf16 v[92:95], a[224:227], v[228:231], v[92:95]
    ds_read_b128 v[228:231], v253 offset:15072
    v_sub_f32 v223, v223, v227
    v_add_f32 v224, v220, v112
    s_waitcnt vmcnt(14)
    s_waitcnt lgkmcnt(2)
sub25:
    v_mfma_f32_16x16x32_bf16 v[0:3], a[228:231], v[232:235], v[0:3]
    v_add_f32 v225, v221, v113
    v_add_f32 v226, v222, v114
    v_mfma_f32_16x16x32_bf16 v[4:7], a[232:235], v[232:235], v[4:7]
    s_waitcnt vmcnt(11) lgkmcnt(1)
    v_add_f32 v227, v223, v115
    v_mul_f32 v112, s28, v112
    v_mfma_f32_16x16x32_bf16 v[8:11], a[236:239], v[232:235], v[8:11]
    ds_read_b128 v[232:235], v253 offset:14816
    v_mul_f32 v113, s28, v113
    v_mul_f32 v114, s28, v114
    v_mfma_f32_16x16x32_bf16 v[0:3], a[240:243], v[236:239], v[0:3]
    buffer_load_dwordx4 a[208:211], v254, s[8:11], s42 offen offset:1024 sc1
    v_mfma_f32_16x16x32_bf16 v[4:7], a[244:247], v[236:239], v[4:7]
    v_mul_f32 v115, s28, v115
    v_mul_f32 v224, s26, v224
    v_mul_f32 v225, s26, v225
    v_mfma_f32_16x16x32_bf16 v[8:11], a[248:251], v[236:239], v[8:11]
    v_mul_f32 v226, s26, v226
    v_mul_f32 v227, s26, v227
    v_mfma_f32_16x16x32_bf16 v[12:15], a[228:231], v[236:239], v[12:15]
    s_waitcnt lgkmcnt(1)
    v_fmac_f32 v112, s34, v220
    v_fmac_f32 v113, s34, v221
    v_fmac_f32 v114, s34, v222
    v_mfma_f32_16x16x32_bf16 v[12:15], a[240:243], v[228:231], v[12:15]
    buffer_load_dwordx4 a[212:215], v254, s[8:11], s42 offen offset:2048 sc1
    v_mfma_f32_16x16x32_bf16 v[16:19], a[244:247], v[228:231], v[16:19]
    v_fmac_f32 v115, s34, v223
    v_cvt_pk_bf16_f32 v200, v224, v225
    v_cvt_pk_bf16_f32 v201, v226, v227
    v_mfma_f32_16x16x32_bf16 v[16:19], a[232:235], v[236:239], v[16:19]
    s_add_u32 s42, s36, 964608
    v_accvgpr_write_b32 a14, v200
    v_accvgpr_write_b32 a15, v201
    v_mfma_f32_16x16x32_bf16 v[20:23], a[236:239], v[236:239], v[20:23]
    ds_read_b128 v[236:239], v253 offset:14560
    v_accvgpr_read_b32 v220, a20
    v_mfma_f32_16x16x32_bf16 v[20:23], a[248:251], v[228:231], v[20:23]
    buffer_load_dwordx4 a[216:219], v254, s[8:11], s42 offen offset:0 sc1
    v_accvgpr_read_b32 v221, a21
    s_waitcnt vmcnt(11)
    v_mfma_f32_16x16x32_bf16 v[0:3], a[252:255], v[228:231], v[0:3]
    v_accvgpr_read_b32 v222, a22
    v_accvgpr_read_b32 v223, a23
    v_mfma_f32_16x16x32_bf16 v[4:7], v[240:243], v[228:231], v[4:7]
    v_accvgpr_read_b32 v224, a116
    v_accvgpr_read_b32 v225, a117
    v_accvgpr_read_b32 v226, a118
    v_mfma_f32_16x16x32_bf16 v[8:11], v[244:247], v[228:231], v[8:11]
    s_waitcnt lgkmcnt(1)
    v_accvgpr_read_b32 v227, a119
    v_sub_f32 v220, v220, v224
    v_mfma_f32_16x16x32_bf16 v[24:27], a[228:231], v[228:231], v[24:27]
    buffer_load_dwordx4 a[220:223], v254, s[8:11], s42 offen offset:1024 sc1
    v_sub_f32 v221, v221, v225
    v_mfma_f32_16x16x32_bf16 v[24:27], a[240:243], v[232:235], v[24:27]
    v_sub_f32 v222, v222, v226
    v_sub_f32 v223, v223, v227
    v_mfma_f32_16x16x32_bf16 v[28:31], a[244:247], v[232:235], v[28:31]
    v_add_f32 v224, v220, v116
    v_add_f32 v225, v221, v117
    v_add_f32 v226, v222, v118
    v_mfma_f32_16x16x32_bf16 v[28:31], a[232:235], v[228:231], v[28:31]
    buffer_load_dwordx4 a[224:227], v254, s[8:11], s42 offen offset:2048 sc1
    v_mfma_f32_16x16x32_bf16 v[32:35], a[236:239], v[228:231], v[32:35]
    ds_read_b128 v[228:231], v253 offset:16384
    s_add_u32 s44, s40, 397312
    v_add_f32 v227, v223, v119
    v_mfma_f32_16x16x32_bf16 v[32:35], a[248:251], v[232:235], v[32:35]
    v_mul_f32 v116, s28, v116
    v_mul_f32 v117, s28, v117
    v_mfma_f32_16x16x32_bf16 v[12:15], a[252:255], v[232:235], v[12:15]
    v_mul_f32 v118, s28, v118
    v_mul_f32 v119, s28, v119
    v_mfma_f32_16x16x32_bf16 v[16:19], v[240:243], v[232:235], v[16:19]
    v_mul_f32 v224, s26, v224
    v_mul_f32 v225, s26, v225
    v_mul_f32 v226, s26, v226
    v_mfma_f32_16x16x32_bf16 v[20:23], v[244:247], v[232:235], v[20:23]
    v_mul_f32 v227, s26, v227
    v_fmac_f32 v116, s34, v220
    v_mfma_f32_16x16x32_bf16 v[36:39], a[228:231], v[232:235], v[36:39]
    s_waitcnt lgkmcnt(1)
    v_fmac_f32 v117, s34, v221
    v_fmac_f32 v118, s34, v222
    v_fmac_f32 v119, s34, v223
    v_mfma_f32_16x16x32_bf16 v[36:39], a[240:243], v[236:239], v[36:39]
    v_cvt_pk_bf16_f32 v202, v224, v225
    v_cvt_pk_bf16_f32 v203, v226, v227
    v_mfma_f32_16x16x32_bf16 v[40:43], a[244:247], v[236:239], v[40:43]
    v_accvgpr_write_b32 a16, v202
    v_accvgpr_write_b32 a17, v203
    v_accvgpr_read_b32 v220, a24
    v_mfma_f32_16x16x32_bf16 v[40:43], a[232:235], v[232:235], v[40:43]
    v_accvgpr_read_b32 v221, a25
    v_accvgpr_read_b32 v222, a26
    v_mfma_f32_16x16x32_bf16 v[44:47], a[236:239], v[232:235], v[44:47]
    ds_read_b128 v[232:235], v253 offset:16128
    v_accvgpr_read_b32 v223, a27
    v_accvgpr_read_b32 v224, a120
    v_mfma_f32_16x16x32_bf16 v[44:47], a[248:251], v[236:239], v[44:47]
    v_accvgpr_read_b32 v225, a121
    v_accvgpr_read_b32 v226, a122
    v_mfma_f32_16x16x32_bf16 v[24:27], a[252:255], v[236:239], v[24:27]
    v_accvgpr_read_b32 v227, a123
    v_sub_f32 v220, v220, v224
    v_mfma_f32_16x16x32_bf16 v[28:31], v[240:243], v[236:239], v[28:31]
    buffer_store_dwordx4 v[204:207], v254, s[12:15], s44 offen sc1
    v_sub_f32 v221, v221, v225
    v_sub_f32 v222, v222, v226
    v_sub_f32 v223, v223, v227
    v_mfma_f32_16x16x32_bf16 v[32:35], v[244:247], v[236:239], v[32:35]
    v_add_f32 v224, v220, v120
    v_add_f32 v225, v221, v121
    v_mfma_f32_16x16x32_bf16 v[48:51], a[228:231], v[236:239], v[48:51]
    s_waitcnt lgkmcnt(1)
    v_add_f32 v226, v222, v122
    v_add_f32 v227, v223, v123
    v_mul_f32 v120, s28, v120
    v_mfma_f32_16x16x32_bf16 v[48:51], a[240:243], v[228:231], v[48:51]
    v_mul_f32 v121, s28, v121
    v_mul_f32 v122, s28, v122
    v_mfma_f32_16x16x32_bf16 v[52:55], a[244:247], v[228:231], v[52:55]
    v_mul_f32 v123, s28, v123
    v_mul_f32 v224, s26, v224
    v_mul_f32 v225, s26, v225
    v_mfma_f32_16x16x32_bf16 v[52:55], a[232:235], v[236:239], v[52:55]
    v_mul_f32 v226, s26, v226
    v_mul_f32 v227, s26, v227
    v_mfma_f32_16x16x32_bf16 v[56:59], a[236:239], v[236:239], v[56:59]
    ds_read_b128 v[236:239], v253 offset:15872
    v_fmac_f32 v120, s34, v220
    v_fmac_f32 v121, s34, v221
    v_mfma_f32_16x16x32_bf16 v[56:59], a[248:251], v[228:231], v[56:59]
    ds_read_b128 a[96:99], v250 offset:6208
    s_add_u32 s44, s40, 398336
    v_mfma_f32_16x16x32_bf16 v[36:39], a[252:255], v[228:231], v[36:39]
    v_fmac_f32 v122, s34, v222
    v_fmac_f32 v123, s34, v223
    v_cvt_pk_bf16_f32 v192, v224, v225
    v_mfma_f32_16x16x32_bf16 v[40:43], v[240:243], v[228:231], v[40:43]
    v_cvt_pk_bf16_f32 v193, v226, v227
    v_accvgpr_write_b32 a24, v192
    v_mfma_f32_16x16x32_bf16 v[44:47], v[244:247], v[228:231], v[44:47]
    ds_read_b128 a[100:103], v250 offset:7232
    v_accvgpr_write_b32 a25, v193
    v_mfma_f32_16x16x32_bf16 v[60:63], a[228:231], v[228:231], v[60:63]
    s_waitcnt lgkmcnt(3)
    v_accvgpr_read_b32 v220, a28
    v_accvgpr_read_b32 v221, a29
    v_accvgpr_read_b32 v222, a30
    v_mfma_f32_16x16x32_bf16 v[60:63], a[240:243], v[232:235], v[60:63]
    v_accvgpr_read_b32 v223, a31
    v_accvgpr_read_b32 v224, a124
    v_mfma_f32_16x16x32_bf16 v[64:67], a[244:247], v[232:235], v[64:67]
    v_accvgpr_read_b32 v225, a125
    v_accvgpr_read_b32 v226, a126
    v_accvgpr_read_b32 v227, a127
    v_mfma_f32_16x16x32_bf16 v[64:67], a[232:235], v[228:231], v[64:67]
    ds_read_b128 a[104:107], v250 offset:8256
    v_mfma_f32_16x16x32_bf16 v[68:71], a[236:239], v[228:231], v[68:71]
    ds_read_b128 v[228:231], v253 offset:15616
    v_sub_f32 v220, v220, v224
    v_sub_f32 v221, v221, v225
    v_mfma_f32_16x16x32_bf16 v[68:71], a[248:251], v[232:235], v[68:71]
    v_sub_f32 v222, v222, v226
    v_sub_f32 v223, v223, v227
    v_mfma_f32_16x16x32_bf16 v[48:51], a[252:255], v[232:235], v[48:51]
    ds_read_b128 a[108:111], v250 offset:9312
    v_add_f32 v224, v220, v124
    v_add_f32 v225, v221, v125
    v_mfma_f32_16x16x32_bf16 v[52:55], v[240:243], v[232:235], v[52:55]
    v_add_f32 v226, v222, v126
    v_add_f32 v227, v223, v127
    v_mfma_f32_16x16x32_bf16 v[56:59], v[244:247], v[232:235], v[56:59]
    s_waitcnt lgkmcnt(5)
    v_mul_f32 v124, s28, v124
    v_mul_f32 v125, s28, v125
    v_mfma_f32_16x16x32_bf16 v[72:75], a[228:231], v[232:235], v[72:75]
    buffer_store_dwordx4 v[208:211], v254, s[12:15], s44 offen sc1
    v_mul_f32 v126, s28, v126
    v_mul_f32 v127, s28, v127
    v_mul_f32 v224, s26, v224
    v_mfma_f32_16x16x32_bf16 v[72:75], a[240:243], v[236:239], v[72:75]
    ds_read_b128 a[112:115], v250 offset:10336
    v_mul_f32 v225, s26, v225
    v_mfma_f32_16x16x32_bf16 v[76:79], a[244:247], v[236:239], v[76:79]
    v_mul_f32 v226, s26, v226
    v_mul_f32 v227, s26, v227
    v_fmac_f32 v124, s34, v220
    v_mfma_f32_16x16x32_bf16 v[76:79], a[232:235], v[232:235], v[76:79]
    v_fmac_f32 v125, s34, v221
    v_fmac_f32 v126, s34, v222
    v_mfma_f32_16x16x32_bf16 v[80:83], a[236:239], v[232:235], v[80:83]
    ds_read_b128 v[232:235], v253 offset:15344
    v_fmac_f32 v127, s34, v223
    v_cvt_pk_bf16_f32 v194, v224, v225
    v_mfma_f32_16x16x32_bf16 v[80:83], a[248:251], v[236:239], v[80:83]
    ds_read_b128 a[116:119], v250 offset:11360
    v_cvt_pk_bf16_f32 v195, v226, v227
    v_mfma_f32_16x16x32_bf16 v[60:63], a[252:255], v[236:239], v[60:63]
    s_waitcnt lgkmcnt(4)
    v_accvgpr_write_b32 a26, v194
    v_accvgpr_write_b32 a27, v195
    v_accvgpr_read_b32 v220, a32
    v_mfma_f32_16x16x32_bf16 v[64:67], v[240:243], v[236:239], v[64:67]
    s_add_u32 s44, s40, 399360
    v_accvgpr_read_b32 v221, a33
    v_accvgpr_read_b32 v222, a34
    v_mfma_f32_16x16x32_bf16 v[68:71], v[244:247], v[236:239], v[68:71]
    s_add_u32 s42, s36, 995328
    v_accvgpr_read_b32 v223, a35
    v_accvgpr_read_b32 v224, a128
    v_accvgpr_read_b32 v225, a129
    v_mfma_f32_16x16x32_bf16 v[84:87], a[228:231], v[236:239], v[84:87]
    buffer_load_dwordx4 a[228:231], v254, s[8:11], s42 offen offset:0 sc1
    v_mfma_f32_16x16x32_bf16 v[88:91], a[232:235], v[236:239], v[88:91]
    s_waitcnt lgkmcnt(0)
    v_accvgpr_read_b32 v226, a130
    v_accvgpr_read_b32 v227, a131
    v_mfma_f32_16x16x32_bf16 v[92:95], a[236:239], v[236:239], v[92:95]
    s_barrier
    v_sub_f32 v220, v220, v224
    v_mfma_f32_16x16x32_bf16 v[84:87], a[240:243], v[228:231], v[84:87]
    ds_read_b128 v[236:239], v253 offset:17680
    v_sub_f32 v221, v221, v225
    v_mfma_f32_16x16x32_bf16 v[88:91], a[244:247], v[228:231], v[88:91]
    buffer_load_dwordx4 a[232:235], v254, s[8:11], s42 offen offset:1024 sc1
    v_sub_f32 v222, v222, v226
    v_mfma_f32_16x16x32_bf16 v[92:95], a[248:251], v[228:231], v[92:95]
    v_sub_f32 v223, v223, v227
    v_add_f32 v224, v220, v128
    v_mfma_f32_16x16x32_bf16 v[72:75], a[252:255], v[228:231], v[72:75]
    ds_write_b128 v248, a[0:3] offset:0
    v_add_f32 v225, v221, v129
    v_mfma_f32_16x16x32_bf16 v[76:79], v[240:243], v[228:231], v[76:79]
    buffer_load_dwordx4 a[236:239], v254, s[8:11], s42 offen offset:2048 sc1
    v_mfma_f32_16x16x32_bf16 v[80:83], v[244:247], v[228:231], v[80:83]
    ds_read_b128 v[228:231], v253 offset:17408
    v_add_f32 v226, v222, v130
    v_add_f32 v227, v223, v131
    v_mfma_f32_16x16x32_bf16 v[84:87], a[252:255], v[232:235], v[84:87]
    s_add_u32 s42, s36, 998400
    v_mul_f32 v128, s28, v128
    v_mul_f32 v129, s28, v129
    v_mfma_f32_16x16x32_bf16 v[88:91], v[240:243], v[232:235], v[88:91]
    buffer_load_dwordx4 a[240:243], v254, s[8:11], s42 offen offset:0 sc1
    v_mfma_f32_16x16x32_bf16 v[92:95], v[244:247], v[232:235], v[92:95]
    ds_read_b128 v[232:235], v253 offset:17152
    v_mul_f32 v130, s28, v130
    v_mul_f32 v131, s28, v131
    s_waitcnt vmcnt(12)
    s_waitcnt lgkmcnt(3)
sub26:
    v_mfma_f32_16x16x32_bf16 v[0:3], a[192:195], v[236:239], v[0:3]
    s_waitcnt vmcnt(9) lgkmcnt(1)
    v_mul_f32 v224, s26, v224
    v_mul_f32 v225, s26, v225
    v_mfma_f32_16x16x32_bf16 v[4:7], a[196:199], v[236:239], v[4:7]
    ds_write_b64 v249, a[4:5] offset:64
    v_mul_f32 v226, s26, v226
    v_mfma_f32_16x16x32_bf16 v[8:11], a[200:203], v[236:239], v[8:11]
    ds_read_b128 v[236:239], v253 offset:16896
    v_mul_f32 v227, s26, v227
    v_mfma_f32_16x16x32_bf16 v[0:3], a[204:207], v[228:231], v[0:3]
    buffer_load_dwordx4 a[244:247], v254, s[8:11], s42 offen offset:1024 sc1
    v_fmac_f32 v128, s34, v220
    v_mfma_f32_16x16x32_bf16 v[4:7], a[208:211], v[228:231], v[4:7]
    v_fmac_f32 v129, s34, v221
    v_fmac_f32 v130, s34, v222
    v_mfma_f32_16x16x32_bf16 v[8:11], a[212:215], v[228:231], v[8:11]
    v_fmac_f32 v131, s34, v223
    v_cvt_pk_bf16_f32 v196, v224, v225
    v_cvt_pk_bf16_f32 v197, v226, v227
    v_mfma_f32_16x16x32_bf16 v[12:15], a[192:195], v[228:231], v[12:15]
    s_waitcnt lgkmcnt(2)
    v_accvgpr_write_b32 a28, v196
    v_accvgpr_write_b32 a29, v197
    v_mfma_f32_16x16x32_bf16 v[12:15], a[204:207], v[232:235], v[12:15]
    buffer_load_dwordx4 a[248:251], v254, s[8:11], s42 offen offset:2048 sc1
    v_accvgpr_read_b32 v220, a36
    v_mfma_f32_16x16x32_bf16 v[16:19], a[208:211], v[232:235], v[16:19]
    v_accvgpr_read_b32 v221, a37
    v_accvgpr_read_b32 v222, a38
    v_mfma_f32_16x16x32_bf16 v[16:19], a[196:199], v[228:231], v[16:19]
    s_add_u32 s42, s36, 1001472
    v_accvgpr_read_b32 v223, a39
    v_accvgpr_read_b32 v224, a132
    v_mfma_f32_16x16x32_bf16 v[20:23], a[200:203], v[228:231], v[20:23]
    ds_read_b128 v[228:231], v253 offset:16640
    v_accvgpr_read_b32 v225, a133
    v_accvgpr_read_b32 v226, a134
    v_mfma_f32_16x16x32_bf16 v[20:23], a[212:215], v[232:235], v[20:23]
    buffer_load_dwordx4 a[252:255], v254, s[8:11], s42 offen offset:0 sc1
    s_waitcnt vmcnt(9)
    v_mfma_f32_16x16x32_bf16 v[0:3], a[216:219], v[232:235], v[0:3]
    ds_write_b128 v248, a[12:15] offset:384
    v_accvgpr_read_b32 v227, a135
    v_mfma_f32_16x16x32_bf16 v[4:7], a[220:223], v[232:235], v[4:7]
    v_sub_f32 v220, v220, v224
    v_sub_f32 v221, v221, v225
    v_mfma_f32_16x16x32_bf16 v[8:11], a[224:227], v[232:235], v[8:11]
    s_waitcnt lgkmcnt(2)
    v_sub_f32 v222, v222, v226
    v_sub_f32 v223, v223, v227
    v_add_f32 v224, v220, v132
    v_mfma_f32_16x16x32_bf16 v[24:27], a[192:195], v[232:235], v[24:27]
    buffer_load_dwordx4 v[240:243], v254, s[8:11], s42 offen offset:1024 sc1
    v_mfma_f32_16x16x32_bf16 v[24:27], a[204:207], v[236:239], v[24:27]
    v_add_f32 v225, v221, v133
    v_add_f32 v226, v222, v134
    v_add_f32 v227, v223, v135
    v_mfma_f32_16x16x32_bf16 v[28:31], a[208:211], v[236:239], v[28:31]
    v_mul_f32 v132, s28, v132
    v_mul_f32 v133, s28, v133
    v_mfma_f32_16x16x32_bf16 v[28:31], a[196:199], v[232:235], v[28:31]
    buffer_load_dwordx4 v[244:247], v254, s[8:11], s42 offen offset:2048 sc1
    v_mfma_f32_16x16x32_bf16 v[32:35], a[200:203], v[232:235], v[32:35]
    ds_read_b128 v[232:235], v253 offset:18464
    v_mul_f32 v134, s28, v134
    v_mul_f32 v135, s28, v135
    v_mfma_f32_16x16x32_bf16 v[32:35], a[212:215], v[236:239], v[32:35]
    ds_write_b64 v249, a[16:17] offset:448
    v_mfma_f32_16x16x32_bf16 v[12:15], a[216:219], v[236:239], v[12:15]
    buffer_store_dwordx4 a[96:99], v254, s[12:15], s44 offen sc1
    s_add_u32 s44, s40, 400384
    v_mul_f32 v224, s26, v224
    v_mfma_f32_16x16x32_bf16 v[16:19], a[220:223], v[236:239], v[16:19]
    v_mul_f32 v225, s26, v225
    v_mul_f32 v226, s26, v226
    v_mfma_f32_16x16x32_bf16 v[20:23], a[224:227], v[236:239], v[20:23]
    s_waitcnt lgkmcnt(3)
    v_mul_f32 v227, s26, v227
    v_fmac_f32 v132, s34, v220
    v_fmac_f32 v133, s34, v221
    v_mfma_f32_16x16x32_bf16 v[36:39], a[192:195], v[236:239], v[36:39]
    buffer_store_dwordx4 a[100:103], v254, s[12:15], s44 offen sc1
    v_fmac_f32 v134, s34, v222
    v_fmac_f32 v135, s34, v223
    v_mfma_f32_16x16x32_bf16 v[36:39], a[204:207], v[228:231], v[36:39]
    v_cvt_pk_bf16_f32 v198, v224, v225
    v_cvt_pk_bf16_f32 v199, v226, v227
    v_accvgpr_read_b32 v220, a40
    v_mfma_f32_16x16x32_bf16 v[40:43], a[208:211], v[228:231], v[40:43]
    v_accvgpr_read_b32 v221, a41
    v_accvgpr_read_b32 v222, a42
    v_mfma_f32_16x16x32_bf16 v[40:43], a[196:199], v[236:239], v[40:43]
    s_add_u32 s44, s40, 401408
    v_accvgpr_read_b32 v223, a43
    v_accvgpr_read_b32 v224, a136
    v_accvgpr_read_b32 v225, a137
    v_mfma_f32_16x16x32_bf16 v[44:47], a[200:203], v[236:239], v[44:47]
    ds_read_b128 v[236:239], v253 offset:18208
    v_accvgpr_read_b32 v226, a138
    v_mfma_f32_16x16x32_bf16 v[44:47], a[212:215], v[228:231], v[44:47]
    v_accvgpr_read_b32 v227, a139
    v_sub_f32 v220, v220, v224
    v_mfma_f32_16x16x32_bf16 v[24:27], a[216:219], v[228:231], v[24:27]
    v_sub_f32 v221, v221, v225
    v_sub_f32 v222, v222, v226
    v_sub_f32 v223, v223, v227
    v_mfma_f32_16x16x32_bf16 v[28:31], a[220:223], v[228:231], v[28:31]
    v_add_f32 v224, v220, v136
    v_add_f32 v225, v221, v137
    v_mfma_f32_16x16x32_bf16 v[32:35], a[224:227], v[228:231], v[32:35]
    v_add_f32 v226, v222, v138
    v_add_f32 v227, v223, v139
    v_mul_f32 v136, s28, v136
    v_mfma_f32_16x16x32_bf16 v[48:51], a[192:195], v[228:231], v[48:51]
    s_waitcnt lgkmcnt(2)
    v_mul_f32 v137, s28, v137
    v_mul_f32 v138, s28, v138
    v_mfma_f32_16x16x32_bf16 v[48:51], a[204:207], v[232:235], v[48:51]
    v_mul_f32 v139, s28, v139
    v_mul_f32 v224, s26, v224
    v_mul_f32 v225, s26, v225
    v_mfma_f32_16x16x32_bf16 v[52:55], a[208:211], v[232:235], v[52:55]
    v_mul_f32 v226, s26, v226
    v_mul_f32 v227, s26, v227
    v_mfma_f32_16x16x32_bf16 v[52:55], a[196:199], v[228:231], v[52:55]
    v_fmac_f32 v136, s34, v220
    v_fmac_f32 v137, s34, v221
    v_fmac_f32 v138, s34, v222
    v_mfma_f32_16x16x32_bf16 v[56:59], a[200:203], v[228:231], v[56:59]
    ds_read_b128 v[228:231], v253 offset:17952
    v_fmac_f32 v139, s34, v223
    v_mfma_f32_16x16x32_bf16 v[56:59], a[212:215], v[232:235], v[56:59]
    v_cvt_pk_bf16_f32 v200, v224, v225
    v_cvt_pk_bf16_f32 v201, v226, v227
    v_mfma_f32_16x16x32_bf16 v[36:39], a[216:219], v[232:235], v[36:39]
    v_mfma_f32_16x16x32_bf16 v[40:43], a[220:223], v[232:235], v[40:43]
    buffer_store_dwordx4 a[104:107], v254, s[12:15], s44 offen sc1
    v_mfma_f32_16x16x32_bf16 v[44:47], a[224:227], v[232:235], v[44:47]
    ds_write_b128 v248, a[24:27] offset:768
    v_mfma_f32_16x16x32_bf16 v[60:63], a[192:195], v[232:235], v[60:63]
    s_waitcnt lgkmcnt(2)
    v_mfma_f32_16x16x32_bf16 v[60:63], a[204:207], v[236:239], v[60:63]
    v_mfma_f32_16x16x32_bf16 v[64:67], a[208:211], v[236:239], v[64:67]
    v_mfma_f32_16x16x32_bf16 v[64:67], a[196:199], v[232:235], v[64:67]
    ds_write_b128 v248, v[198:201] offset:1152
    v_accvgpr_read_b32 v220, a44
    v_mfma_f32_16x16x32_bf16 v[68:71], a[200:203], v[232:235], v[68:71]
    ds_read_b128 v[232:235], v253 offset:17696
    v_accvgpr_read_b32 v221, a45
    v_mfma_f32_16x16x32_bf16 v[68:71], a[212:215], v[236:239], v[68:71]
    s_add_u32 s44, s40, 402432
    v_accvgpr_read_b32 v222, a46
    v_accvgpr_read_b32 v223, a47
    v_accvgpr_read_b32 v224, a140
    v_mfma_f32_16x16x32_bf16 v[48:51], a[216:219], v[236:239], v[48:51]
    v_accvgpr_read_b32 v225, a141
    v_accvgpr_read_b32 v226, a142
    v_mfma_f32_16x16x32_bf16 v[52:55], a[220:223], v[236:239], v[52:55]
    ds_write_b64 v249, a[28:29] offset:832
    v_mfma_f32_16x16x32_bf16 v[56:59], a[224:227], v[236:239], v[56:59]
    v_accvgpr_read_b32 v227, a143
    v_sub_f32 v220, v220, v224
    v_sub_f32 v221, v221, v225
    v_mfma_f32_16x16x32_bf16 v[72:75], a[192:195], v[236:239], v[72:75]
    s_waitcnt lgkmcnt(4)
    v_sub_f32 v222, v222, v226
    v_sub_f32 v223, v223, v227
    v_mfma_f32_16x16x32_bf16 v[72:75], a[204:207], v[228:231], v[72:75]
    v_add_f32 v224, v220, v140
    v_add_f32 v225, v221, v141
    v_add_f32 v226, v222, v142
    v_mfma_f32_16x16x32_bf16 v[76:79], a[208:211], v[228:231], v[76:79]
    v_add_f32 v227, v223, v143
    v_mul_f32 v140, s28, v140
    v_mfma_f32_16x16x32_bf16 v[76:79], a[196:199], v[236:239], v[76:79]
    v_mul_f32 v141, s28, v141
    v_mul_f32 v142, s28, v142
    v_mul_f32 v143, s28, v143
    v_mfma_f32_16x16x32_bf16 v[80:83], a[200:203], v[236:239], v[80:83]
    ds_read_b128 v[236:239], v253 offset:17424
    v_mul_f32 v224, s26, v224
    v_mfma_f32_16x16x32_bf16 v[80:83], a[212:215], v[228:231], v[80:83]
    v_mul_f32 v225, s26, v225
    v_mul_f32 v226, s26, v226
    v_mul_f32 v227, s26, v227
    v_mfma_f32_16x16x32_bf16 v[60:63], a[216:219], v[228:231], v[60:63]
    v_fmac_f32 v140, s34, v220
    v_fmac_f32 v141, s34, v221
    v_mfma_f32_16x16x32_bf16 v[64:67], a[220:223], v[228:231], v[64:67]
    s_waitcnt lgkmcnt(2)
    v_fmac_f32 v142, s34, v222
    v_fmac_f32 v143, s34, v223
    v_mfma_f32_16x16x32_bf16 v[68:71], a[224:227], v[228:231], v[68:71]
    s_add_u32 s42, s36, 1032192
    v_cvt_pk_bf16_f32 v202, v224, v225
    v_cvt_pk_bf16_f32 v203, v226, v227
    v_mfma_f32_16x16x32_bf16 v[84:87], a[192:195], v[228:231], v[84:87]
    buffer_load_dwordx4 a[192:195], v254, s[8:11], s42 offen offset:0 sc1
    v_mfma_f32_16x16x32_bf16 v[88:91], a[196:199], v[228:231], v[88:91]
    s_waitcnt lgkmcnt(0)
    v_mfma_f32_16x16x32_bf16 v[92:95], a[200:203], v[228:231], v[92:95]
    s_barrier
    v_mfma_f32_16x16x32_bf16 v[84:87], a[204:207], v[232:235], v[84:87]
    ds_read_b128 v[228:231], v253 offset:19760
    v_mfma_f32_16x16x32_bf16 v[88:91], a[208:211], v[232:235], v[88:91]
    buffer_load_dwordx4 a[196:199], v254, s[8:11], s42 offen offset:1024 sc1
    v_mfma_f32_16x16x32_bf16 v[92:95], a[212:215], v[232:235], v[92:95]
    ds_read_b128 a[120:123], v250 offset:0
    v_mfma_f32_16x16x32_bf16 v[72:75], a[216:219], v[232:235], v[72:75]
    ds_write_b64 v249, v[202:203] offset:1216
    v_mfma_f32_16x16x32_bf16 v[76:79], a[220:223], v[232:235], v[76:79]
    buffer_load_dwordx4 a[200:203], v254, s[8:11], s42 offen offset:2048 sc1
    v_accvgpr_read_b32 v220, a48
    v_mfma_f32_16x16x32_bf16 v[80:83], a[224:227], v[232:235], v[80:83]
    ds_read_b128 v[232:235], v253 offset:19488
    v_accvgpr_read_b32 v221, a49
    v_mfma_f32_16x16x32_bf16 v[84:87], a[216:219], v[236:239], v[84:87]
pad10:
    s_cbranch_vccnz warm_ret
    s_add_u32 s42, s36, 1035264
    v_accvgpr_read_b32 v222, a50
    v_accvgpr_read_b32 v223, a51
    v_mfma_f32_16x16x32_bf16 v[88:91], a[220:223], v[236:239], v[88:91]
    buffer_load_dwordx4 a[204:207], v254, s[8:11], s42 offen offset:0 sc1
    v_accvgpr_read_b32 v224, a144
    v_mfma_f32_16x16x32_bf16 v[92:95], a[224:227], v[236:239], v[92:95]
    ds_read_b128 v[236:239], v253 offset:19232
    v_accvgpr_read_b32 v225, a145
    s_waitcnt vmcnt(13)
    s_waitcnt lgkmcnt(4)
sub27:
    v_mfma_f32_16x16x32_bf16 v[0:3], a[228:231], v[228:231], v[0:3]
    s_waitcnt vmcnt(10) lgkmcnt(1)
    v_accvgpr_read_b32 v226, a146
    v_accvgpr_read_b32 v227, a147
    v_sub_f32 v220, v220, v224
    v_mfma_f32_16x16x32_bf16 v[4:7], a[232:235], v[228:231], v[4:7]
    ds_read_b128 a[124:127], v250 offset:3104
    v_sub_f32 v221, v221, v225
    v_mfma_f32_16x16x32_bf16 v[8:11], a[236:239], v[228:231], v[8:11]
    ds_read_b128 v[228:231], v253 offset:18976
    v_sub_f32 v222, v222, v226
    v_sub_f32 v223, v223, v227
    v_mfma_f32_16x16x32_bf16 v[0:3], a[240:243], v[232:235], v[0:3]
    buffer_load_dwordx4 a[208:211], v254, s[8:11], s42 offen offset:1024 sc1
    v_mfma_f32_16x16x32_bf16 v[4:7], a[244:247], v[232:235], v[4:7]
    v_add_f32 v224, v220, v144
    v_add_f32 v225, v221, v145
    v_add_f32 v226, v222, v146
    v_mfma_f32_16x16x32_bf16 v[8:11], a[248:251], v[232:235], v[8:11]
    v_add_f32 v227, v223, v147
    v_mul_f32 v144, s28, v144
    v_mfma_f32_16x16x32_bf16 v[12:15], a[228:231], v[232:235], v[12:15]
    s_waitcnt lgkmcnt(2)
    v_mul_f32 v145, s28, v145
    v_mul_f32 v146, s28, v146
    v_mfma_f32_16x16x32_bf16 v[12:15], a[240:243], v[236:239], v[12:15]
    buffer_load_dwordx4 a[212:215], v254, s[8:11], s42 offen offset:2048 sc1
    v_mul_f32 v147, s28, v147
    v_mfma_f32_16x16x32_bf16 v[16:19], a[244:247], v[236:239], v[16:19]
    v_mul_f32 v224, s26, v224
    v_mul_f32 v225, s26, v225
    v_mfma_f32_16x16x32_bf16 v[16:19], a[232:235], v[232:235], v[16:19]
    s_add_u32 s42, s36, 1038336
    v_mul_f32 v226, s26, v226
    v_mul_f32 v227, s26, v227
    v_fmac_f32 v144, s34, v220
    v_mfma_f32_16x16x32_bf16 v[20:23], a[236:239], v[232:235], v[20:23]
    ds_read_b128 v[232:235], v253 offset:18720
    v_fmac_f32 v145, s34, v221
    v_mfma_f32_16x16x32_bf16 v[20:23], a[248:251], v[236:239], v[20:23]
    buffer_load_dwordx4 a[216:219], v254, s[8:11], s42 offen offset:0 sc1
    v_fmac_f32 v146, s34, v222
    s_waitcnt vmcnt(10)
    v_mfma_f32_16x16x32_bf16 v[0:3], a[252:255], v[236:239], v[0:3]
    ds_read_b128 a[128:131], v250 offset:6208
    v_fmac_f32 v147, s34, v223
    v_mfma_f32_16x16x32_bf16 v[4:7], v[240:243], v[236:239], v[4:7]
    v_cvt_pk_bf16_f32 v192, v224, v225
    v_cvt_pk_bf16_f32 v193, v226, v227
    v_accvgpr_read_b32 v220, a52
    v_mfma_f32_16x16x32_bf16 v[8:11], v[244:247], v[236:239], v[8:11]
    s_waitcnt lgkmcnt(2)
    v_accvgpr_read_b32 v221, a53
    v_accvgpr_read_b32 v222, a54
    v_mfma_f32_16x16x32_bf16 v[24:27], a[228:231], v[236:239], v[24:27]
    buffer_load_dwordx4 a[220:223], v254, s[8:11], s42 offen offset:1024 sc1
    v_accvgpr_read_b32 v223, a55
    v_mfma_f32_16x16x32_bf16 v[24:27], a[240:243], v[228:231], v[24:27]
    v_accvgpr_read_b32 v224, a148
    v_accvgpr_read_b32 v225, a149
    v_mfma_f32_16x16x32_bf16 v[28:31], a[244:247], v[228:231], v[28:31]
    v_accvgpr_read_b32 v226, a150
    v_accvgpr_read_b32 v227, a151
    v_mfma_f32_16x16x32_bf16 v[28:31], a[232:235], v[236:239], v[28:31]
    buffer_load_dwordx4 a[224:227], v254, s[8:11], s42 offen offset:2048 sc1
    v_sub_f32 v220, v220, v224
    v_mfma_f32_16x16x32_bf16 v[32:35], a[236:239], v[236:239], v[32:35]
    ds_read_b128 v[236:239], v253 offset:20544
    v_sub_f32 v221, v221, v225
    v_mfma_f32_16x16x32_bf16 v[32:35], a[248:251], v[228:231], v[32:35]
    ds_read_b128 a[132:135], v250 offset:9312
    v_sub_f32 v222, v222, v226
    v_sub_f32 v223, v223, v227
    v_mfma_f32_16x16x32_bf16 v[12:15], a[252:255], v[228:231], v[12:15]
    buffer_store_dwordx4 a[108:111], v254, s[12:15], s44 offen sc1
    s_add_u32 s44, s40, 403456
    v_mfma_f32_16x16x32_bf16 v[16:19], v[240:243], v[228:231], v[16:19]
    v_add_f32 v224, v220, v148
    v_add_f32 v225, v221, v149
    v_add_f32 v226, v222, v150
    v_mfma_f32_16x16x32_bf16 v[20:23], v[244:247], v[228:231], v[20:23]
    s_waitcnt lgkmcnt(3)
    v_add_f32 v227, v223, v151
    v_mul_f32 v148, s28, v148
    v_mfma_f32_16x16x32_bf16 v[36:39], a[228:231], v[228:231], v[36:39]
    buffer_store_dwordx4 a[112:115], v254, s[12:15], s44 offen sc1
    s_add_u32 s44, s40, 404480
    v_mul_f32 v149, s28, v149
    v_mfma_f32_16x16x32_bf16 v[36:39], a[240:243], v[232:235], v[36:39]
    v_mul_f32 v150, s28, v150
    v_mul_f32 v151, s28, v151
    v_mfma_f32_16x16x32_bf16 v[40:43], a[244:247], v[232:235], v[40:43]
    v_mul_f32 v224, s26, v224
    v_mul_f32 v225, s26, v225
    v_mfma_f32_16x16x32_bf16 v[40:43], a[232:235], v[228:231], v[40:43]
    v_mul_f32 v226, s26, v226
    v_mul_f32 v227, s26, v227
    v_fmac_f32 v148, s34, v220
    v_mfma_f32_16x16x32_bf16 v[44:47], a[236:239], v[228:231], v[44:47]
    ds_read_b128 v[228:231], v253 offset:20288
    v_fmac_f32 v149, s34, v221
    v_mfma_f32_16x16x32_bf16 v[44:47], a[248:251], v[232:235], v[44:47]
    buffer_store_dwordx4 a[116:119], v254, s[12:15], s44 offen sc1
    v_fmac_f32 v150, s34, v222
    v_fmac_f32 v151, s34, v223
    v_cvt_pk_bf16_f32 v194, v224, v225
    v_mfma_f32_16x16x32_bf16 v[24:27], a[252:255], v[232:235], v[24:27]
    v_cvt_pk_bf16_f32 v195, v226, v227
    v_mfma_f32_16x16x32_bf16 v[28:31], v[240:243], v[232:235], v[28:31]
    ds_write_b128 v248, v[192:195] offset:1536
    v_accvgpr_read_b32 v220, a56
    v_mfma_f32_16x16x32_bf16 v[32:35], v[244:247], v[232:235], v[32:35]
    v_accvgpr_read_b32 v221, a57
    v_accvgpr_read_b32 v222, a58
    v_mfma_f32_16x16x32_bf16 v[48:51], a[228:231], v[232:235], v[48:51]
    s_waitcnt lgkmcnt(3)
    v_accvgpr_read_b32 v223, a59
    v_accvgpr_read_b32 v224, a152
    v_accvgpr_read_b32 v225, a153
    v_mfma_f32_16x16x32_bf16 v[48:51], a[240:243], v[236:239], v[48:51]
    v_accvgpr_read_b32 v226, a154
    v_accvgpr_read_b32 v227, a155
    v_mfma_f32_16x16x32_bf16 v[52:55], a[244:247], v[236:239], v[52:55]
    v_sub_f32 v220, v220, v224
    v_sub_f32 v221, v221, v225
    v_sub_f32 v222, v222, v226
    v_mfma_f32_16x16x32_bf16 v[52:55], a[232:235], v[232:235], v[52:55]
    v_sub_f32 v223, v223, v227
    v_add_f32 v224, v220, v152
    v_mfma_f32_16x16x32_bf16 v[56:59], a[236:239], v[232:235], v[56:59]
    ds_read_b128 v[232:235], v253 offset:20032
    s_add_u32 s44, s40, 196608
    v_mfma_f32_16x16x32_bf16 v[56:59], a[248:251], v[236:239], v[56:59]
    v_add_f32 v225, v221, v153
    v_add_f32 v226, v222, v154
    v_add_f32 v227, v223, v155
    v_mfma_f32_16x16x32_bf16 v[36:39], a[252:255], v[236:239], v[36:39]
    v_mul_f32 v152, s28, v152
    v_mul_f32 v153, s28, v153
    v_mfma_f32_16x16x32_bf16 v[40:43], v[240:243], v[236:239], v[40:43]
    v_mul_f32 v154, s28, v154
    v_mul_f32 v155, s28, v155
    v_mul_f32 v224, s26, v224
    v_mfma_f32_16x16x32_bf16 v[44:47], v[244:247], v[236:239], v[44:47]
    v_mul_f32 v225, s26, v225
    v_mul_f32 v226, s26, v226
    v_mfma_f32_16x16x32_bf16 v[60:63], a[228:231], v[236:239], v[60:63]
    s_waitcnt lgkmcnt(2)
    v_mul_f32 v227, s26, v227
    v_fmac_f32 v152, s34, v220
    v_fmac_f32 v153, s34, v221
    v_mfma_f32_16x16x32_bf16 v[60:63], a[240:243], v[228:231], v[60:63]
    v_fmac_f32 v154, s34, v222
    v_fmac_f32 v155, s34, v223
    v_mfma_f32_16x16x32_bf16 v[64:67], a[244:247], v[228:231], v[64:67]
    v_cvt_pk_bf16_f32 v196, v224, v225
    v_cvt_pk_bf16_f32 v197, v226, v227
    v_mfma_f32_16x16x32_bf16 v[64:67], a[232:235], v[236:239], v[64:67]
    v_mfma_f32_16x16x32_bf16 v[68:71], a[236:239], v[236:239], v[68:71]
    ds_read_b128 v[236:239], v253 offset:19776
    v_mfma_f32_16x16x32_bf16 v[68:71], a[248:251], v[228:231], v[68:71]
    ds_write_b64 v249, v[196:197] offset:1600
    v_accvgpr_read_b32 v220, a60
    v_mfma_f32_16x16x32_bf16 v[48:51], a[252:255], v[228:231], v[48:51]
    v_accvgpr_read_b32 v221, a61
    v_accvgpr_read_b32 v222, a62
    v_mfma_f32_16x16x32_bf16 v[52:55], v[240:243], v[228:231], v[52:55]
    v_accvgpr_read_b32 v223, a63
    v_accvgpr_read_b32 v224, a156
    v_accvgpr_read_b32 v225, a157
    v_mfma_f32_16x16x32_bf16 v[56:59], v[244:247], v[228:231], v[56:59]
    v_accvgpr_read_b32 v226, a158
    v_accvgpr_read_b32 v227, a159
    v_mfma_f32_16x16x32_bf16 v[72:75], a[228:231], v[228:231], v[72:75]
    s_waitcnt lgkmcnt(2)
    v_sub_f32 v220, v220, v224
    v_sub_f32 v221, v221, v225
    v_sub_f32 v222, v222, v226
    v_mfma_f32_16x16x32_bf16 v[72:75], a[240:243], v[232:235], v[72:75]
    v_sub_f32 v223, v223, v227
    v_add_f32 v224, v220, v156
    v_mfma_f32_16x16x32_bf16 v[76:79], a[244:247], v[232:235], v[76:79]
    buffer_store_dwordx4 a[120:123], v254, s[12:15], s44 offen sc1
    v_add_f32 v225, v221, v157
    v_add_f32 v226, v222, v158
    v_add_f32 v227, v223, v159
    v_mfma_f32_16x16x32_bf16 v[76:79], a[232:235], v[228:231], v[76:79]
    v_mul_f32 v156, s28, v156
    v_mul_f32 v157, s28, v157
    v_mfma_f32_16x16x32_bf16 v[80:83], a[236:239], v[228:231], v[80:83]
    ds_read_b128 v[228:231], v253 offset:19504
    v_mul_f32 v158, s28, v158
    v_mul_f32 v159, s28, v159
    v_mfma_f32_16x16x32_bf16 v[80:83], a[248:251], v[232:235], v[80:83]
    v_mul_f32 v224, s26, v224
    v_mul_f32 v225, s26, v225
    v_mfma_f32_16x16x32_bf16 v[60:63], a[252:255], v[232:235], v[60:63]
    v_mul_f32 v226, s26, v226
    v_mul_f32 v227, s26, v227
    v_mfma_f32_16x16x32_bf16 v[64:67], v[240:243], v[232:235], v[64:67]
    v_fmac_f32 v156, s34, v220
    v_fmac_f32 v157, s34, v221
    v_fmac_f32 v158, s34, v222
    v_mfma_f32_16x16x32_bf16 v[68:71], v[244:247], v[232:235], v[68:71]
    s_add_u32 s42, s37, 1069056
    v_fmac_f32 v159, s34, v223
    v_cvt_pk_bf16_f32 v198, v224, v225
    v_mfma_f32_16x16x32_bf16 v[84:87], a[228:231], v[232:235], v[84:87]
    buffer_load_dwordx4 a[228:231], v254, s[8:11], s42 offen offset:0 sc1
    v_cvt_pk_bf16_f32 v199, v226, v227
    v_mfma_f32_16x16x32_bf16 v[88:91], a[232:235], v[232:235], v[88:91]
    s_waitcnt lgkmcnt(2)
    v_accvgpr_read_b32 v220, a64
    v_accvgpr_read_b32 v221, a65
    v_mfma_f32_16x16x32_bf16 v[92:95], a[236:239], v[232:235], v[92:95]
    s_add_u32 s44, s40, 199680
    v_accvgpr_read_b32 v222, a66
    v_accvgpr_read_b32 v223, a67
    v_accvgpr_read_b32 v224, a160
    v_mfma_f32_16x16x32_bf16 v[84:87], a[240:243], v[236:239], v[84:87]
    ds_read_b128 v[232:235], v253 offset:21840
    v_accvgpr_read_b32 v225, a161
    v_mfma_f32_16x16x32_bf16 v[88:91], a[244:247], v[236:239], v[88:91]
    buffer_load_dwordx4 a[232:235], v254, s[8:11], s42 offen offset:1024 sc1
    v_accvgpr_read_b32 v226, a162
    v_mfma_f32_16x16x32_bf16 v[92:95], a[248:251], v[236:239], v[92:95]
    v_accvgpr_read_b32 v227, a163
    v_sub_f32 v220, v220, v224
    v_mfma_f32_16x16x32_bf16 v[72:75], a[252:255], v[236:239], v[72:75]
    s_waitcnt lgkmcnt(1)
    v_sub_f32 v221, v221, v225
    v_sub_f32 v222, v222, v226
    v_mfma_f32_16x16x32_bf16 v[76:79], v[240:243], v[236:239], v[76:79]
    buffer_load_dwordx4 a[236:239], v254, s[8:11], s42 offen offset:2048 sc1
    v_sub_f32 v223, v223, v227
    v_mfma_f32_16x16x32_bf16 v[80:83], v[244:247], v[236:239], v[80:83]
    ds_read_b128 v[236:239], v253 offset:21568
    v_add_f32 v224, v220, v160
    v_mfma_f32_16x16x32_bf16 v[84:87], a[252:255], v[228:231], v[84:87]
    s_add_u32 s42, s37, 1072128
    v_add_f32 v225, v221, v161
    v_add_f32 v226, v222, v162
    v_add_f32 v227, v223, v163
    v_mfma_f32_16x16x32_bf16 v[88:91], v[240:243], v[228:231], v[88:91]
    buffer_load_dwordx4 a[240:243], v254, s[8:11], s42 offen offset:0 sc1
    v_mfma_f32_16x16x32_bf16 v[92:95], v[244:247], v[228:231], v[92:95]
    ds_read_b128 v[228:231], v253 offset:21312
    v_mul_f32 v160, s28, v160
    s_waitcnt vmcnt(14)
    s_waitcnt lgkmcnt(2)
sub28:
    v_mfma_f32_16x16x32_bf16 v[0:3], a[192:195], v[232:235], v[0:3]
    v_mul_f32 v161, s28, v161
    v_mul_f32 v162, s28, v162
    v_mfma_f32_16x16x32_bf16 v[4:7], a[196:199], v[232:235], v[4:7]
    s_waitcnt vmcnt(11) lgkmcnt(1)
    v_mul_f32 v163, s28, v163
    v_mul_f32 v224, s26, v224
    v_mul_f32 v225, s26, v225
    v_mfma_f32_16x16x32_bf16 v[8:11], a[200:203], v[232:235], v[8:11]
    ds_read_b128 v[232:235], v253 offset:21056
    v_mul_f32 v226, s26, v226
    v_mfma_f32_16x16x32_bf16 v[0:3], a[204:207], v[236:239], v[0:3]
    buffer_load_dwordx4 a[244:247], v254, s[8:11], s42 offen offset:1024 sc1
    v_mul_f32 v227, s26, v227
    v_mfma_f32_16x16x32_bf16 v[4:7], a[208:211], v[236:239], v[4:7]
    v_fmac_f32 v160, s34, v220
    v_fmac_f32 v161, s34, v221
    v_mfma_f32_16x16x32_bf16 v[8:11], a[212:215], v[236:239], v[8:11]
    v_fmac_f32 v162, s34, v222
    v_fmac_f32 v163, s34, v223
    v_mfma_f32_16x16x32_bf16 v[12:15], a[192:195], v[236:239], v[12:15]
    s_waitcnt lgkmcnt(1)
    v_cvt_pk_bf16_f32 v200, v224, v225
    v_cvt_pk_bf16_f32 v201, v226, v227
    v_mfma_f32_16x16x32_bf16 v[12:15], a[204:207], v[228:231], v[12:15]
    buffer_load_dwordx4 a[248:251], v254, s[8:11], s42 offen offset:2048 sc1
    v_mfma_f32_16x16x32_bf16 v[16:19], a[208:211], v[228:231], v[16:19]
    ds_write_b128 v248, v[198:201] offset:1920
    v_accvgpr_read_b32 v220, a68
    v_mfma_f32_16x16x32_bf16 v[16:19], a[196:199], v[236:239], v[16:19]
    s_add_u32 s42, s37, 1075200
    v_accvgpr_read_b32 v221, a69
    v_accvgpr_read_b32 v222, a70
    v_mfma_f32_16x16x32_bf16 v[20:23], a[200:203], v[236:239], v[20:23]
    ds_read_b128 v[236:239], v253 offset:20800
    v_accvgpr_read_b32 v223, a71
    v_accvgpr_read_b32 v224, a164
    v_mfma_f32_16x16x32_bf16 v[20:23], a[212:215], v[228:231], v[20:23]
    buffer_load_dwordx4 a[252:255], v254, s[8:11], s42 offen offset:0 sc1
    s_waitcnt vmcnt(11)
    v_mfma_f32_16x16x32_bf16 v[0:3], a[216:219], v[228:231], v[0:3]
    v_accvgpr_read_b32 v225, a165
    v_accvgpr_read_b32 v226, a166
    v_accvgpr_read_b32 v227, a167
    v_mfma_f32_16x16x32_bf16 v[4:7], a[220:223], v[228:231], v[4:7]
    v_sub_f32 v220, v220, v224
    v_sub_f32 v221, v221, v225
    v_mfma_f32_16x16x32_bf16 v[8:11], a[224:227], v[228:231], v[8:11]
    s_waitcnt lgkmcnt(2)
    v_sub_f32 v222, v222, v226
    v_sub_f32 v223, v223, v227
    v_mfma_f32_16x16x32_bf16 v[24:27], a[192:195], v[228:231], v[24:27]
    buffer_load_dwordx4 v[240:243], v254, s[8:11], s42 offen offset:1024 sc1
    v_add_f32 v224, v220, v164
    v_mfma_f32_16x16x32_bf16 v[24:27], a[204:207], v[232:235], v[24:27]
    v_add_f32 v225, v221, v165
    v_add_f32 v226, v222, v166
    v_mfma_f32_16x16x32_bf16 v[28:31], a[208:211], v[232:235], v[28:31]
    v_add_f32 v227, v223, v167
    v_mul_f32 v164, s28, v164
    v_mul_f32 v165, s28, v165
    v_mfma_f32_16x16x32_bf16 v[28:31], a[196:199], v[228:231], v[28:31]
    buffer_load_dwordx4 v[244:247], v254, s[8:11], s42 offen offset:2048 sc1
    v_mfma_f32_16x16x32_bf16 v[32:35], a[200:203], v[228:231], v[32:35]
    ds_read_b128 v[228:231], v253 offset:22624
    v_mul_f32 v166, s28, v166
    v_mul_f32 v167, s28, v167
    v_mfma_f32_16x16x32_bf16 v[32:35], a[212:215], v[232:235], v[32:35]
    v_mul_f32 v224, s26, v224
    v_mul_f32 v225, s26, v225
    v_mfma_f32_16x16x32_bf16 v[12:15], a[216:219], v[232:235], v[12:15]
    buffer_store_dwordx4 a[124:127], v254, s[12:15], s44 offen sc1
    s_add_u32 s44, s40, 202752
    v_mul_f32 v226, s26, v226
    v_mul_f32 v227, s26, v227
    v_mfma_f32_16x16x32_bf16 v[16:19], a[220:223], v[232:235], v[16:19]
    v_fmac_f32 v164, s34, v220
    v_fmac_f32 v165, s34, v221
    v_mfma_f32_16x16x32_bf16 v[20:23], a[224:227], v[232:235], v[20:23]
    v_fmac_f32 v166, s34, v222
    v_fmac_f32 v167, s34, v223
    v_cvt_pk_bf16_f32 v202, v224, v225
    v_mfma_f32_16x16x32_bf16 v[36:39], a[192:195], v[232:235], v[36:39]
    s_waitcnt lgkmcnt(1)
    v_cvt_pk_bf16_f32 v203, v226, v227
    v_mfma_f32_16x16x32_bf16 v[36:39], a[204:207], v[236:239], v[36:39]
    ds_write_b64 v249, v[202:203] offset:1984
    v_mfma_f32_16x16x32_bf16 v[40:43], a[208:211], v[236:239], v[40:43]
    v_accvgpr_read_b32 v220, a72
    v_accvgpr_read_b32 v221, a73
    v_accvgpr_read_b32 v222, a74
    v_mfma_f32_16x16x32_bf16 v[40:43], a[196:199], v[232:235], v[40:43]
    v_accvgpr_read_b32 v223, a75
    v_accvgpr_read_b32 v224, a168
    v_mfma_f32_16x16x32_bf16 v[44:47], a[200:203], v[232:235], v[44:47]
    ds_read_b128 v[232:235], v253 offset:22368
    v_accvgpr_read_b32 v225, a169
    v_accvgpr_read_b32 v226, a170
    v_mfma_f32_16x16x32_bf16 v[44:47], a[212:215], v[236:239], v[44:47]
    v_accvgpr_read_b32 v227, a171
    v_sub_f32 v220, v220, v224
    v_mfma_f32_16x16x32_bf16 v[24:27], a[216:219], v[236:239], v[24:27]
    v_sub_f32 v221, v221, v225
    v_sub_f32 v222, v222, v226
    v_sub_f32 v223, v223, v227
    v_mfma_f32_16x16x32_bf16 v[28:31], a[220:223], v[236:239], v[28:31]
    buffer_store_dwordx4 a[128:131], v254, s[12:15], s44 offen sc1
    v_add_f32 v224, v220, v168
    v_add_f32 v225, v221, v169
    v_mfma_f32_16x16x32_bf16 v[32:35], a[224:227], v[236:239], v[32:35]
    v_add_f32 v226, v222, v170
    v_add_f32 v227, v223, v171
    v_mul_f32 v168, s28, v168
    v_mfma_f32_16x16x32_bf16 v[48:51], a[192:195], v[236:239], v[48:51]
    s_waitcnt lgkmcnt(2)
    v_mul_f32 v169, s28, v169
    v_mul_f32 v170, s28, v170
    v_mfma_f32_16x16x32_bf16 v[48:51], a[204:207], v[228:231], v[48:51]
    v_mul_f32 v171, s28, v171
    v_mul_f32 v224, s26, v224
    v_mfma_f32_16x16x32_bf16 v[52:55], a[208:211], v[228:231], v[52:55]
    v_mul_f32 v225, s26, v225
    v_mul_f32 v226, s26, v226
    v_mul_f32 v227, s26, v227
    v_mfma_f32_16x16x32_bf16 v[52:55], a[196:199], v[236:239], v[52:55]
    v_fmac_f32 v168, s34, v220
    v_fmac_f32 v169, s34, v221
    v_mfma_f32_16x16x32_bf16 v[56:59], a[200:203], v[236:239], v[56:59]
    ds_read_b128 v[236:239], v253 offset:22112
    v_fmac_f32 v170, s34, v222
    v_fmac_f32 v171, s34, v223
    v_mfma_f32_16x16x32_bf16 v[56:59], a[212:215], v[228:231], v[56:59]
    v_cvt_pk_bf16_f32 v192, v224, v225
    v_cvt_pk_bf16_f32 v193, v226, v227
    v_mfma_f32_16x16x32_bf16 v[36:39], a[216:219], v[228:231], v[36:39]
    v_accvgpr_read_b32 v220, a76
    v_accvgpr_read_b32 v221, a77
    v_accvgpr_read_b32 v222, a78
    v_mfma_f32_16x16x32_bf16 v[40:43], a[220:223], v[228:231], v[40:43]
    s_add_u32 s44, s40, 205824
    v_accvgpr_read_b32 v223, a79
    v_accvgpr_read_b32 v224, a172
    v_mfma_f32_16x16x32_bf16 v[44:47], a[224:227], v[228:231], v[44:47]
    v_accvgpr_read_b32 v225, a173
    v_accvgpr_read_b32 v226, a174
    v_accvgpr_read_b32 v227, a175
    v_mfma_f32_16x16x32_bf16 v[60:63], a[192:195], v[228:231], v[60:63]
    s_waitcnt lgkmcnt(1)
    v_sub_f32 v220, v220, v224
    v_sub_f32 v221, v221, v225
    v_mfma_f32_16x16x32_bf16 v[60:63], a[204:207], v[232:235], v[60:63]
    v_sub_f32 v222, v222, v226
    v_sub_f32 v223, v223, v227
    v_add_f32 v224, v220, v172
    v_mfma_f32_16x16x32_bf16 v[64:67], a[208:211], v[232:235], v[64:67]
    v_add_f32 v225, v221, v173
    v_add_f32 v226, v222, v174
    v_mfma_f32_16x16x32_bf16 v[64:67], a[196:199], v[228:231], v[64:67]
    v_add_f32 v227, v223, v175
    v_mul_f32 v172, s28, v172
    v_mfma_f32_16x16x32_bf16 v[68:71], a[200:203], v[228:231], v[68:71]
    ds_read_b128 v[228:231], v253 offset:21856
    v_mul_f32 v173, s28, v173
    v_mul_f32 v174, s28, v174
    v_mfma_f32_16x16x32_bf16 v[68:71], a[212:215], v[232:235], v[68:71]
    v_mul_f32 v175, s28, v175
    v_mul_f32 v224, s26, v224
    v_mfma_f32_16x16x32_bf16 v[48:51], a[216:219], v[232:235], v[48:51]
    v_mul_f32 v225, s26, v225
    v_mul_f32 v226, s26, v226
    v_mul_f32 v227, s26, v227
    v_mfma_f32_16x16x32_bf16 v[52:55], a[220:223], v[232:235], v[52:55]
    v_fmac_f32 v172, s34, v220
    v_fmac_f32 v173, s34, v221
    v_mfma_f32_16x16x32_bf16 v[56:59], a[224:227], v[232:235], v[56:59]
    v_fmac_f32 v174, s34, v222
    v_fmac_f32 v175, s34, v223
    v_cvt_pk_bf16_f32 v194, v224, v225
    v_mfma_f32_16x16x32_bf16 v[72:75], a[192:195], v[232:235], v[72:75]
    s_waitcnt lgkmcnt(1)
    v_cvt_pk_bf16_f32 v195, v226, v227
    v_mfma_f32_16x16x32_bf16 v[72:75], a[204:207], v[236:239], v[72:75]
    ds_write_b128 v248, v[192:195] offset:2304
    v_accvgpr_read_b32 v220, a80
    v_mfma_f32_16x16x32_bf16 v[76:79], a[208:211], v[236:239], v[76:79]
    v_accvgpr_read_b32 v221, a81
    v_accvgpr_read_b32 v222, a82
    v_mfma_f32_16x16x32_bf16 v[76:79], a[196:199], v[232:235], v[76:79]
    v_accvgpr_read_b32 v223, a83
    v_accvgpr_read_b32 v224, a176
    v_mfma_f32_16x16x32_bf16 v[80:83], a[200:203], v[232:235], v[80:83]
    ds_read_b128 v[232:235], v253 offset:21584
    v_accvgpr_read_b32 v225, a177
    v_accvgpr_read_b32 v226, a178
    v_mfma_f32_16x16x32_bf16 v[80:83], a[212:215], v[236:239], v[80:83]
    buffer_store_dwordx4 a[132:135], v254, s[12:15], s44 offen sc1
    v_accvgpr_read_b32 v227, a179
    v_sub_f32 v220, v220, v224
    v_mfma_f32_16x16x32_bf16 v[60:63], a[216:219], v[236:239], v[60:63]
    v_sub_f32 v221, v221, v225
    v_sub_f32 v222, v222, v226
    v_sub_f32 v223, v223, v227
    v_mfma_f32_16x16x32_bf16 v[64:67], a[220:223], v[236:239], v[64:67]
    s_waitcnt lgkmcnt(2)
    v_add_f32 v224, v220, v176
    v_add_f32 v225, v221, v177
    v_mfma_f32_16x16x32_bf16 v[68:71], a[224:227], v[236:239], v[68:71]
    s_add_u32 s42, s36, 1105920
    v_add_f32 v226, v222, v178
    v_add_f32 v227, v223, v179
    v_mul_f32 v176, s28, v176
    v_mfma_f32_16x16x32_bf16 v[84:87], a[192:195], v[236:239], v[84:87]
    buffer_load_dwordx4 a[192:195], v254, s[8:11], s42 offen offset:0 sc1
    v_mfma_f32_16x16x32_bf16 v[88:91], a[196:199], v[236:239], v[88:91]
    s_waitcnt lgkmcnt(0)
    v_mul_f32 v177, s28, v177
    v_mul_f32 v178, s28, v178
    v_mul_f32 v179, s28, v179
    v_mfma_f32_16x16x32_bf16 v[92:95], a[200:203], v[236:239], v[92:95]
    s_barrier
    v_mfma_f32_16x16x32_bf16 v[84:87], a[204:207], v[228:231], v[84:87]
    ds_read_b128 v[236:239], v253 offset:23920
    v_mul_f32 v224, s26, v224
    v_mul_f32 v225, s26, v225
    v_mfma_f32_16x16x32_bf16 v[88:91], a[208:211], v[228:231], v[88:91]
    buffer_load_dwordx4 a[196:199], v254, s[8:11], s42 offen offset:1024 sc1
    v_mfma_f32_16x16x32_bf16 v[92:95], a[212:215], v[228:231], v[92:95]
    ds_read_b128 a[136:139], v250 offset:1024
    s_add_u32 s44, s40, 197632
    v_mfma_f32_16x16x32_bf16 v[72:75], a[216:219], v[228:231], v[72:75]
    v_mul_f32 v226, s26, v226
    v_mul_f32 v227, s26, v227
    v_fmac_f32 v176, s34, v220
    v_mfma_f32_16x16x32_bf16 v[76:79], a[220:223], v[228:231], v[76:79]
    buffer_load_dwordx4 a[200:203], v254, s[8:11], s42 offen offset:2048 sc1
    v_mfma_f32_16x16x32_bf16 v[80:83], a[224:227], v[228:231], v[80:83]
    ds_read_b128 v[228:231], v253 offset:23648
    v_fmac_f32 v177, s34, v221
    v_fmac_f32 v178, s34, v222
    v_mfma_f32_16x16x32_bf16 v[84:87], a[216:219], v[232:235], v[84:87]
    s_add_u32 s42, s36, 1108992
    v_fmac_f32 v179, s34, v223
    v_cvt_pk_bf16_f32 v196, v224, v225
    v_mfma_f32_16x16x32_bf16 v[88:91], a[220:223], v[232:235], v[88:91]
    buffer_load_dwordx4 a[204:207], v254, s[8:11], s42 offen offset:0 sc1
    v_cvt_pk_bf16_f32 v197, v226, v227
    v_mfma_f32_16x16x32_bf16 v[92:95], a[224:227], v[232:235], v[92:95]
    ds_read_b128 v[232:235], v253 offset:23392
    s_waitcnt vmcnt(13)
    s_waitcnt lgkmcnt(3)
sub29:
    v_mfma_f32_16x16x32_bf16 v[0:3], a[228:231], v[236:239], v[0:3]
    ds_read_b128 a[140:143], v250 offset:4128
    v_mfma_f32_16x16x32_bf16 v[4:7], a[232:235], v[236:239], v[4:7]
    s_waitcnt vmcnt(10) lgkmcnt(2)
    v_mfma_f32_16x16x32_bf16 v[8:11], a[236:239], v[236:239], v[8:11]
    ds_read_b128 v[236:239], v253 offset:23136
    v_mfma_f32_16x16x32_bf16 v[0:3], a[240:243], v[228:231], v[0:3]
    buffer_load_dwordx4 a[208:211], v254, s[8:11], s42 offen offset:1024 sc1
    v_mfma_f32_16x16x32_bf16 v[4:7], a[244:247], v[228:231], v[4:7]
    ds_write_b64 v249, v[196:197] offset:2368
    v_mfma_f32_16x16x32_bf16 v[8:11], a[248:251], v[228:231], v[8:11]
    s_waitcnt lgkmcnt(3)
    v_accvgpr_read_b32 v220, a84
    v_accvgpr_read_b32 v221, a85
    v_accvgpr_read_b32 v222, a86
    v_mfma_f32_16x16x32_bf16 v[12:15], a[228:231], v[228:231], v[12:15]
    ds_read_b128 a[144:147], v250 offset:7232
    v_accvgpr_read_b32 v223, a87
    v_mfma_f32_16x16x32_bf16 v[12:15], a[240:243], v[232:235], v[12:15]
    buffer_load_dwordx4 a[212:215], v254, s[8:11], s42 offen offset:2048 sc1
    v_accvgpr_read_b32 v224, a180
    v_mfma_f32_16x16x32_bf16 v[16:19], a[244:247], v[232:235], v[16:19]
    v_accvgpr_read_b32 v225, a181
    v_accvgpr_read_b32 v226, a182
    v_mfma_f32_16x16x32_bf16 v[16:19], a[232:235], v[228:231], v[16:19]
    s_add_u32 s42, s36, 1112064
    v_accvgpr_read_b32 v227, a183
    v_sub_f32 v220, v220, v224
    v_sub_f32 v221, v221, v225
    v_mfma_f32_16x16x32_bf16 v[20:23], a[236:239], v[228:231], v[20:23]
    ds_read_b128 v[228:231], v253 offset:22880
    v_sub_f32 v222, v222, v226
    v_mfma_f32_16x16x32_bf16 v[20:23], a[248:251], v[232:235], v[20:23]
    buffer_load_dwordx4 a[216:219], v254, s[8:11], s42 offen offset:0 sc1
    v_sub_f32 v223, v223, v227
    s_waitcnt vmcnt(10)
    v_mfma_f32_16x16x32_bf16 v[0:3], a[252:255], v[232:235], v[0:3]
    v_add_f32 v224, v220, v180
    v_add_f32 v225, v221, v181
    v_mfma_f32_16x16x32_bf16 v[4:7], v[240:243], v[232:235], v[4:7]
    ds_read_b128 a[148:151], v250 offset:10336
    v_add_f32 v226, v222, v182
    v_mfma_f32_16x16x32_bf16 v[8:11], v[244:247], v[232:235], v[8:11]
    s_waitcnt lgkmcnt(4)
    v_add_f32 v227, v223, v183
    v_mul_f32 v180, s28, v180
    v_mul_f32 v181, s28, v181
    v_mfma_f32_16x16x32_bf16 v[24:27], a[228:231], v[232:235], v[24:27]
    buffer_load_dwordx4 a[220:223], v254, s[8:11], s42 offen offset:1024 sc1
    v_mfma_f32_16x16x32_bf16 v[24:27], a[240:243], v[236:239], v[24:27]
    v_mul_f32 v182, s28, v182
    v_mul_f32 v183, s28, v183
    v_mul_f32 v224, s26, v224
    v_mfma_f32_16x16x32_bf16 v[28:31], a[244:247], v[236:239], v[28:31]
    v_mul_f32 v225, s26, v225
    v_mul_f32 v226, s26, v226
    v_mfma_f32_16x16x32_bf16 v[28:31], a[232:235], v[232:235], v[28:31]
    buffer_load_dwordx4 a[224:227], v254, s[8:11], s42 offen offset:2048 sc1
    v_mul_f32 v227, s26, v227
    v_mfma_f32_16x16x32_bf16 v[32:35], a[236:239], v[232:235], v[32:35]
    ds_read_b128 v[232:235], v253 offset:24704
    v_and_b32 v215, 0x7fff, v255
    v_mfma_f32_16x16x32_bf16 v[32:35], a[248:251], v[236:239], v[32:35]
    v_fmac_f32 v180, s34, v220
    v_fmac_f32 v181, s34, v221
    v_fmac_f32 v182, s34, v222
    v_mfma_f32_16x16x32_bf16 v[12:15], a[252:255], v[236:239], v[12:15]
    buffer_load_dwordx2 v[204:205], v215, s[4:7], s16 offen offset:0
    v_mfma_f32_16x16x32_bf16 v[16:19], v[240:243], v[236:239], v[16:19]
    v_fmac_f32 v183, s34, v223
    v_cvt_pk_bf16_f32 v198, v224, v225
    v_mfma_f32_16x16x32_bf16 v[20:23], v[244:247], v[236:239], v[20:23]
    s_waitcnt lgkmcnt(2)
    v_cvt_pk_bf16_f32 v199, v226, v227
    v_accvgpr_read_b32 v220, a88
    v_accvgpr_read_b32 v221, a89
    v_mfma_f32_16x16x32_bf16 v[36:39], a[228:231], v[236:239], v[36:39]
    buffer_load_dwordx2 v[206:207], v215, s[4:7], s17 offen offset:0
    v_mfma_f32_16x16x32_bf16 v[36:39], a[240:243], v[228:231], v[36:39]
    v_accvgpr_read_b32 v222, a90
    v_accvgpr_read_b32 v223, a91
    v_accvgpr_read_b32 v224, a184
    v_mfma_f32_16x16x32_bf16 v[40:43], a[244:247], v[228:231], v[40:43]
    v_accvgpr_read_b32 v225, a185
    v_accvgpr_read_b32 v226, a186
    v_mfma_f32_16x16x32_bf16 v[40:43], a[232:235], v[236:239], v[40:43]
    buffer_load_dwordx2 v[208:209], v215, s[4:7], s18 offen offset:0
    v_accvgpr_read_b32 v227, a187
    v_mfma_f32_16x16x32_bf16 v[44:47], a[236:239], v[236:239], v[44:47]
    ds_read_b128 v[236:239], v253 offset:24448
    v_sub_f32 v220, v220, v224
    v_mfma_f32_16x16x32_bf16 v[44:47], a[248:251], v[228:231], v[44:47]
    v_sub_f32 v221, v221, v225
    v_sub_f32 v222, v222, v226
    v_sub_f32 v223, v223, v227
    v_mfma_f32_16x16x32_bf16 v[24:27], a[252:255], v[228:231], v[24:27]
    buffer_load_dwordx2 v[210:211], v215, s[4:7], s19 offen offset:0
    v_mfma_f32_16x16x32_bf16 v[28:31], v[240:243], v[228:231], v[28:31]
    v_add_f32 v224, v220, v184
    v_add_f32 v225, v221, v185
    v_add_f32 v226, v222, v186
    v_mfma_f32_16x16x32_bf16 v[32:35], v[244:247], v[228:231], v[32:35]
    s_waitcnt lgkmcnt(1)
    v_add_f32 v227, v223, v187
    v_mul_f32 v184, s28, v184
    v_mfma_f32_16x16x32_bf16 v[48:51], a[228:231], v[228:231], v[48:51]
    buffer_load_dwordx2 v[212:213], v215, s[4:7], s20 offen offset:0
    v_mfma_f32_16x16x32_bf16 v[48:51], a[240:243], v[232:235], v[48:51]
    v_mul_f32 v185, s28, v185
    v_mul_f32 v186, s28, v186
    v_mul_f32 v187, s28, v187
    v_mfma_f32_16x16x32_bf16 v[52:55], a[244:247], v[232:235], v[52:55]
    v_mul_f32 v224, s26, v224
    v_mul_f32 v225, s26, v225
    v_mfma_f32_16x16x32_bf16 v[52:55], a[232:235], v[228:231], v[52:55]
    buffer_load_dwordx2 v[214:215], v215, s[4:7], s21 offen offset:0
    v_mul_f32 v226, s26, v226
    v_mfma_f32_16x16x32_bf16 v[56:59], a[236:239], v[228:231], v[56:59]
    ds_read_b128 v[228:231], v253 offset:24192
    v_mul_f32 v227, s26, v227
    v_mfma_f32_16x16x32_bf16 v[56:59], a[248:251], v[232:235], v[56:59]
    v_fmac_f32 v184, s34, v220
    v_fmac_f32 v185, s34, v221
    v_fmac_f32 v186, s34, v222
    v_mfma_f32_16x16x32_bf16 v[36:39], a[252:255], v[232:235], v[36:39]
pad11:
    s_cbranch_vccnz warm_ret
    buffer_store_dwordx4 a[136:139], v254, s[12:15], s44 offen sc1
    s_add_u32 s44, s40, 200704
    v_mfma_f32_16x16x32_bf16 v[40:43], v[240:243], v[232:235], v[40:43]
    s_waitcnt lgkmcnt(1)
    v_fmac_f32 v187, s34, v223
    v_cvt_pk_bf16_f32 v200, v224, v225
    v_cvt_pk_bf16_f32 v201, v226, v227
    v_mfma_f32_16x16x32_bf16 v[44:47], v[244:247], v[232:235], v[44:47]
    ds_write_b128 v248, v[198:201] offset:2688
    v_mfma_f32_16x16x32_bf16 v[60:63], a[228:231], v[232:235], v[60:63]
    buffer_store_dwordx4 a[140:143], v254, s[12:15], s44 offen sc1
    v_accvgpr_read_b32 v220, a92
    v_accvgpr_read_b32 v221, a93
    v_mfma_f32_16x16x32_bf16 v[60:63], a[240:243], v[236:239], v[60:63]
    s_add_u32 s44, s40, 203776
    v_accvgpr_read_b32 v222, a94
    v_accvgpr_read_b32 v223, a95
    v_accvgpr_read_b32 v224, a188
    v_mfma_f32_16x16x32_bf16 v[64:67], a[244:247], v[236:239], v[64:67]
    v_accvgpr_read_b32 v225, a189
    v_accvgpr_read_b32 v226, a190
    v_mfma_f32_16x16x32_bf16 v[64:67], a[232:235], v[232:235], v[64:67]
    v_accvgpr_read_b32 v227, a191
    v_sub_f32 v220, v220, v224
    v_sub_f32 v221, v221, v225
    v_mfma_f32_16x16x32_bf16 v[68:71], a[236:239], v[232:235], v[68:71]
    ds_read_b128 v[232:235], v253 offset:23936
    v_sub_f32 v222, v222, v226
    v_mfma_f32_16x16x32_bf16 v[68:71], a[248:251], v[236:239], v[68:71]
    v_sub_f32 v223, v223, v227
    v_add_f32 v224, v220, v188
    v_add_f32 v225, v221, v189
    v_mfma_f32_16x16x32_bf16 v[48:51], a[252:255], v[236:239], v[48:51]
    v_add_f32 v226, v222, v190
    v_add_f32 v227, v223, v191
    v_mfma_f32_16x16x32_bf16 v[52:55], v[240:243], v[236:239], v[52:55]
    v_mul_f32 v188, s28, v188
    v_mul_f32 v189, s28, v189
    v_mul_f32 v190, s28, v190
    v_mfma_f32_16x16x32_bf16 v[56:59], v[244:247], v[236:239], v[56:59]
    v_mul_f32 v191, s28, v191
    v_mul_f32 v224, s26, v224
    v_mfma_f32_16x16x32_bf16 v[72:75], a[228:231], v[236:239], v[72:75]
    s_waitcnt lgkmcnt(2)
    v_mul_f32 v225, s26, v225
    v_mul_f32 v226, s26, v226
    v_mul_f32 v227, s26, v227
    v_mfma_f32_16x16x32_bf16 v[72:75], a[240:243], v[228:231], v[72:75]
    v_fmac_f32 v188, s34, v220
    v_fmac_f32 v189, s34, v221
    v_mfma_f32_16x16x32_bf16 v[76:79], a[244:247], v[228:231], v[76:79]
    v_fmac_f32 v190, s34, v222
    v_fmac_f32 v191, s34, v223
    v_mfma_f32_16x16x32_bf16 v[76:79], a[232:235], v[236:239], v[76:79]
    v_cvt_pk_bf16_f32 v202, v224, v225
    v_cvt_pk_bf16_f32 v203, v226, v227
    v_mfma_f32_16x16x32_bf16 v[80:83], a[236:239], v[236:239], v[80:83]
    ds_read_b128 v[236:239], v253 offset:23664
    v_mfma_f32_16x16x32_bf16 v[80:83], a[248:251], v[228:231], v[80:83]
    ds_write_b64 v249, v[202:203] offset:2752
    v_mfma_f32_16x16x32_bf16 v[60:63], a[252:255], v[228:231], v[60:63]
    v_mfma_f32_16x16x32_bf16 v[64:67], v[240:243], v[228:231], v[64:67]
    s_waitcnt lgkmcnt(2)
    v_mfma_f32_16x16x32_bf16 v[68:71], v[244:247], v[228:231], v[68:71]
    s_add_u32 s42, s36, 1142784
    v_mfma_f32_16x16x32_bf16 v[84:87], a[228:231], v[228:231], v[84:87]
    buffer_load_dwordx4 a[228:231], v254, s[8:11], s42 offen offset:0 sc1
    v_mfma_f32_16x16x32_bf16 v[88:91], a[232:235], v[228:231], v[88:91]
    s_waitcnt lgkmcnt(0)
    v_mfma_f32_16x16x32_bf16 v[92:95], a[236:239], v[228:231], v[92:95]
    s_barrier
    v_mfma_f32_16x16x32_bf16 v[84:87], a[240:243], v[232:235], v[84:87]
    ds_read_b128 v[228:231], v253 offset:36400
    v_mfma_f32_16x16x32_bf16 v[88:91], a[244:247], v[232:235], v[88:91]
    buffer_load_dwordx4 a[232:235], v254, s[8:11], s42 offen offset:1024 sc1
    v_mfma_f32_16x16x32_bf16 v[92:95], a[248:251], v[232:235], v[92:95]
    ds_read_b128 a[152:155], v250 offset:2048
    v_cvt_pk_bf16_f32 v8, v8, v9
    v_cvt_pk_bf16_f32 v9, v10, v11
    v_mfma_f32_16x16x32_bf16 v[72:75], a[252:255], v[232:235], v[72:75]
    ds_write_b64 v249, v[8:9] offset:12544
    v_mfma_f32_16x16x32_bf16 v[76:79], v[240:243], v[232:235], v[76:79]
    buffer_load_dwordx4 a[236:239], v254, s[8:11], s42 offen offset:2048 sc1
    v_cvt_pk_bf16_f32 v0, v0, v1
    v_mfma_f32_16x16x32_bf16 v[80:83], v[244:247], v[232:235], v[80:83]
    ds_read_b128 v[232:235], v253 offset:36128
    v_cvt_pk_bf16_f32 v1, v2, v3
    v_mfma_f32_16x16x32_bf16 v[84:87], a[252:255], v[236:239], v[84:87]
    s_add_u32 s42, s36, 1145856
    v_cvt_pk_bf16_f32 v2, v4, v5
    v_cvt_pk_bf16_f32 v3, v6, v7
    v_mfma_f32_16x16x32_bf16 v[88:91], v[240:243], v[236:239], v[88:91]
    buffer_load_dwordx4 a[240:243], v254, s[8:11], s42 offen offset:0 sc1
    v_mfma_f32_16x16x32_bf16 v[92:95], v[244:247], v[236:239], v[92:95]
    ds_read_b128 v[236:239], v253 offset:35872
    s_waitcnt vmcnt(18)
    s_waitcnt lgkmcnt(4)
sub30:
    v_mfma_f32_16x16x32_bf16 v[96:99], a[192:195], v[228:231], v[96:99]
    ds_write_b128 v248, v[0:3] offset:12480
    v_mfma_f32_16x16x32_bf16 v[100:103], a[196:199], v[228:231], v[100:103]
    ds_read_b128 a[156:159], v250 offset:5152
    v_mov_b32 v4, v248
    v_mov_b32 v5, v249
    v_mfma_f32_16x16x32_bf16 v[104:107], a[200:203], v[228:231], v[104:107]
    ds_read_b128 v[228:231], v253 offset:35616
    v_mov_b32 v6, v250
    s_waitcnt vmcnt(15)
    s_waitcnt lgkmcnt(4)
    v_mfma_f32_16x16x32_bf16 v[96:99], a[204:207], v[232:235], v[96:99]
    buffer_load_dwordx4 a[244:247], v254, s[8:11], s42 offen offset:1024 sc1
    v_cvt_pk_bf16_f32 v20, v20, v21
    v_mfma_f32_16x16x32_bf16 v[100:103], a[208:211], v[232:235], v[100:103]
    v_cvt_pk_bf16_f32 v21, v22, v23
    v_mfma_f32_16x16x32_bf16 v[104:107], a[212:215], v[232:235], v[104:107]
    ds_write_b64 v249, v[20:21] offset:12928
    v_cvt_pk_bf16_f32 v12, v12, v13
    v_mfma_f32_16x16x32_bf16 v[108:111], a[192:195], v[232:235], v[108:111]
    s_waitcnt lgkmcnt(4)
    v_cvt_pk_bf16_f32 v13, v14, v15
    v_cvt_pk_bf16_f32 v14, v16, v17
    v_mfma_f32_16x16x32_bf16 v[108:111], a[204:207], v[236:239], v[108:111]
    buffer_load_dwordx4 a[248:251], v254, s[8:11], s42 offen offset:2048 sc1
    v_cvt_pk_bf16_f32 v15, v18, v19
    v_mfma_f32_16x16x32_bf16 v[112:115], a[208:211], v[236:239], v[112:115]
    ds_write_b128 v248, v[12:15] offset:12864
    v_mfma_f32_16x16x32_bf16 v[112:115], a[196:199], v[232:235], v[112:115]
    s_add_u32 s42, s36, 1148928
    v_cvt_pk_bf16_f32 v32, v32, v33
    v_cvt_pk_bf16_f32 v33, v34, v35
    v_mfma_f32_16x16x32_bf16 v[116:119], a[200:203], v[232:235], v[116:119]
    ds_read_b128 v[232:235], v253 offset:35360
    v_mfma_f32_16x16x32_bf16 v[116:119], a[212:215], v[236:239], v[116:119]
    buffer_load_dwordx4 a[252:255], v254, s[8:11], s42 offen offset:0 sc1
    s_waitcnt vmcnt(15)
    v_mfma_f32_16x16x32_bf16 v[96:99], a[216:219], v[236:239], v[96:99]
    ds_read_b128 a[160:163], v250 offset:8256
    v_mfma_f32_16x16x32_bf16 v[100:103], a[220:223], v[236:239], v[100:103]
    ds_write_b64 v249, v[32:33] offset:13312
    v_cvt_pk_bf16_f32 v24, v24, v25
    v_mfma_f32_16x16x32_bf16 v[104:107], a[224:227], v[236:239], v[104:107]
    s_waitcnt lgkmcnt(5)
    v_cvt_pk_bf16_f32 v25, v26, v27
    v_cvt_pk_bf16_f32 v26, v28, v29
    v_mfma_f32_16x16x32_bf16 v[120:123], a[192:195], v[236:239], v[120:123]
    buffer_load_dwordx4 v[240:243], v254, s[8:11], s42 offen offset:1024 sc1
    v_cvt_pk_bf16_f32 v27, v30, v31
    v_mfma_f32_16x16x32_bf16 v[120:123], a[204:207], v[228:231], v[120:123]
    ds_write_b128 v248, v[24:27] offset:13248
    v_mfma_f32_16x16x32_bf16 v[124:127], a[208:211], v[228:231], v[124:127]
    v_cvt_pk_bf16_f32 v44, v44, v45
    v_cvt_pk_bf16_f32 v45, v46, v47
    v_mfma_f32_16x16x32_bf16 v[124:127], a[196:199], v[236:239], v[124:127]
    buffer_load_dwordx4 v[244:247], v254, s[8:11], s42 offen offset:2048 sc1
    v_mfma_f32_16x16x32_bf16 v[128:131], a[200:203], v[236:239], v[128:131]
    ds_read_b128 v[236:239], v253 offset:37184
    v_and_b32 v227, 0x7fff, v255
    v_mfma_f32_16x16x32_bf16 v[128:131], a[212:215], v[228:231], v[128:131]
    ds_read_b128 a[164:167], v250 offset:11360
    v_mfma_f32_16x16x32_bf16 v[108:111], a[216:219], v[228:231], v[108:111]
    buffer_load_dwordx2 v[216:217], v227, s[4:7], s16 offen offset:384
    v_mfma_f32_16x16x32_bf16 v[112:115], a[220:223], v[228:231], v[112:115]
    ds_write_b64 v249, v[44:45] offset:13696
    v_mfma_f32_16x16x32_bf16 v[116:119], a[224:227], v[228:231], v[116:119]
    s_waitcnt lgkmcnt(6)
    v_cvt_pk_bf16_f32 v36, v36, v37
    v_cvt_pk_bf16_f32 v37, v38, v39
    v_cvt_pk_bf16_f32 v38, v40, v41
    v_mfma_f32_16x16x32_bf16 v[132:135], a[192:195], v[228:231], v[132:135]
    buffer_load_dwordx2 v[218:219], v227, s[4:7], s17 offen offset:384
    v_mfma_f32_16x16x32_bf16 v[132:135], a[204:207], v[232:235], v[132:135]
    v_cvt_pk_bf16_f32 v39, v42, v43
    v_mfma_f32_16x16x32_bf16 v[136:139], a[208:211], v[232:235], v[136:139]
    ds_write_b128 v248, v[36:39] offset:13632
    v_mfma_f32_16x16x32_bf16 v[136:139], a[196:199], v[228:231], v[136:139]
    buffer_load_dwordx2 v[220:221], v227, s[4:7], s18 offen offset:384
    v_cvt_pk_bf16_f32 v56, v56, v57
    v_mfma_f32_16x16x32_bf16 v[140:143], a[200:203], v[228:231], v[140:143]
    ds_read_b128 v[228:231], v253 offset:36928
    v_cvt_pk_bf16_f32 v57, v58, v59
    v_mfma_f32_16x16x32_bf16 v[140:143], a[212:215], v[232:235], v[140:143]
    v_mfma_f32_16x16x32_bf16 v[120:123], a[216:219], v[232:235], v[120:123]
    buffer_load_dwordx2 v[222:223], v227, s[4:7], s19 offen offset:384
    v_mfma_f32_16x16x32_bf16 v[124:127], a[220:223], v[232:235], v[124:127]
    ds_write_b64 v249, v[56:57] offset:14080
    v_cvt_pk_bf16_f32 v48, v48, v49
    v_mfma_f32_16x16x32_bf16 v[128:131], a[224:227], v[232:235], v[128:131]
    s_waitcnt lgkmcnt(5)
    v_cvt_pk_bf16_f32 v49, v50, v51
    v_cvt_pk_bf16_f32 v50, v52, v53
    v_mfma_f32_16x16x32_bf16 v[144:147], a[192:195], v[232:235], v[144:147]
    buffer_load_dwordx2 v[224:225], v227, s[4:7], s20 offen offset:384
    v_cvt_pk_bf16_f32 v51, v54, v55
    v_mfma_f32_16x16x32_bf16 v[144:147], a[204:207], v[236:239], v[144:147]
    ds_write_b128 v248, v[48:51] offset:14016
    v_mfma_f32_16x16x32_bf16 v[148:151], a[208:211], v[236:239], v[148:151]
    v_cvt_pk_bf16_f32 v68, v68, v69
    v_cvt_pk_bf16_f32 v69, v70, v71
    v_mfma_f32_16x16x32_bf16 v[148:151], a[196:199], v[232:235], v[148:151]
    buffer_load_dwordx2 v[226:227], v227, s[4:7], s21 offen offset:384
    v_mfma_f32_16x16x32_bf16 v[152:155], a[200:203], v[232:235], v[152:155]
    ds_read_b128 v[232:235], v253 offset:36672
    v_mfma_f32_16x16x32_bf16 v[152:155], a[212:215], v[236:239], v[152:155]
    ds_write_b64 v249, v[68:69] offset:14464
    v_mfma_f32_16x16x32_bf16 v[132:135], a[216:219], v[236:239], v[132:135]
    buffer_store_dwordx4 a[144:147], v254, s[12:15], s44 offen sc1
    s_add_u32 s44, s40, 206848
    v_cvt_pk_bf16_f32 v60, v60, v61
    v_mfma_f32_16x16x32_bf16 v[136:139], a[220:223], v[236:239], v[136:139]
    v_cvt_pk_bf16_f32 v61, v62, v63
    v_cvt_pk_bf16_f32 v62, v64, v65
    v_mfma_f32_16x16x32_bf16 v[140:143], a[224:227], v[236:239], v[140:143]
    s_waitcnt lgkmcnt(4)
    v_cvt_pk_bf16_f32 v63, v66, v67
    v_mfma_f32_16x16x32_bf16 v[156:159], a[192:195], v[236:239], v[156:159]
    buffer_store_dwordx4 a[148:151], v254, s[12:15], s44 offen sc1
    s_add_u32 s44, s40, 198656
    v_mfma_f32_16x16x32_bf16 v[156:159], a[204:207], v[228:231], v[156:159]
    ds_write_b128 v248, v[60:63] offset:14400
    v_cvt_pk_bf16_f32 v80, v80, v81
    v_mfma_f32_16x16x32_bf16 v[160:163], a[208:211], v[228:231], v[160:163]
    v_cvt_pk_bf16_f32 v81, v82, v83
    v_mfma_f32_16x16x32_bf16 v[160:163], a[196:199], v[236:239], v[160:163]
    buffer_store_dwordx4 a[152:155], v254, s[12:15], s44 offen sc1
    v_mfma_f32_16x16x32_bf16 v[164:167], a[200:203], v[236:239], v[164:167]
    ds_read_b128 v[236:239], v253 offset:36416
    s_add_u32 s44, s40, 201728
    v_mfma_f32_16x16x32_bf16 v[164:167], a[212:215], v[228:231], v[164:167]
    ds_write_b64 v249, v[80:81] offset:14848
    v_cvt_pk_bf16_f32 v72, v72, v73
    v_mfma_f32_16x16x32_bf16 v[144:147], a[216:219], v[228:231], v[144:147]
    v_cvt_pk_bf16_f32 v73, v74, v75
    v_cvt_pk_bf16_f32 v74, v76, v77
    v_mfma_f32_16x16x32_bf16 v[148:151], a[220:223], v[228:231], v[148:151]
    v_cvt_pk_bf16_f32 v75, v78, v79
    v_mfma_f32_16x16x32_bf16 v[152:155], a[224:227], v[228:231], v[152:155]
    ds_write_b128 v248, v[72:75] offset:14784
    v_mfma_f32_16x16x32_bf16 v[168:171], a[192:195], v[228:231], v[168:171]
    s_waitcnt lgkmcnt(5)
    v_cvt_pk_bf16_f32 v92, v92, v93
    v_cvt_pk_bf16_f32 v93, v94, v95
    v_mfma_f32_16x16x32_bf16 v[168:171], a[204:207], v[232:235], v[168:171]
    v_mfma_f32_16x16x32_bf16 v[172:175], a[208:211], v[232:235], v[172:175]
    v_mfma_f32_16x16x32_bf16 v[172:175], a[196:199], v[228:231], v[172:175]
    ds_write_b64 v249, v[92:93] offset:15232
    v_mfma_f32_16x16x32_bf16 v[176:179], a[200:203], v[228:231], v[176:179]
    ds_read_b128 v[228:231], v253 offset:36144
    v_cvt_pk_bf16_f32 v84, v84, v85
    v_mfma_f32_16x16x32_bf16 v[176:179], a[212:215], v[232:235], v[176:179]
    v_cvt_pk_bf16_f32 v85, v86, v87
    v_cvt_pk_bf16_f32 v86, v88, v89
    v_mfma_f32_16x16x32_bf16 v[156:159], a[216:219], v[232:235], v[156:159]
    s_waitcnt lgkmcnt(4)
    v_cvt_pk_bf16_f32 v87, v90, v91
    v_mfma_f32_16x16x32_bf16 v[160:163], a[220:223], v[232:235], v[160:163]
    ds_write_b128 v248, v[84:87] offset:15168
    v_mfma_f32_16x16x32_bf16 v[164:167], a[224:227], v[232:235], v[164:167]
    s_add_u32 s42, s36, 1179648
    v_mfma_f32_16x16x32_bf16 v[180:183], a[192:195], v[232:235], v[180:183]
    buffer_load_dwordx4 a[192:195], v254, s[8:11], s42 offen offset:0 sc1
    v_mfma_f32_16x16x32_bf16 v[184:187], a[196:199], v[232:235], v[184:187]
    s_waitcnt lgkmcnt(0)
    s_waitcnt vmcnt(21)
    v_lshlrev_b32 v248, 16, v206
    v_mfma_f32_16x16x32_bf16 v[188:191], a[200:203], v[232:235], v[188:191]
    s_barrier
    v_lshlrev_b32 v249, 16, v208
    v_mfma_f32_16x16x32_bf16 v[180:183], a[204:207], v[236:239], v[180:183]
    ds_read_b128 v[232:235], v253 offset:38480
    v_lshlrev_b32 v250, 16, v210
    v_mfma_f32_16x16x32_bf16 v[184:187], a[208:211], v[236:239], v[184:187]
    buffer_load_dwordx4 a[196:199], v254, s[8:11], s42 offen offset:1024 sc1
    v_lshlrev_b32 v251, 16, v212
    v_mfma_f32_16x16x32_bf16 v[188:191], a[212:215], v[236:239], v[188:191]
    ds_read_b128 a[0:3], v6 offset:12480
    v_and_b32 v206, s22, v206
    v_mfma_f32_16x16x32_bf16 v[168:171], a[216:219], v[236:239], v[168:171]
    v_and_b32 v208, s22, v208
    v_and_b32 v210, s22, v210
    v_mfma_f32_16x16x32_bf16 v[172:175], a[220:223], v[236:239], v[172:175]
    buffer_load_dwordx4 a[200:203], v254, s[8:11], s42 offen offset:2048 sc1
    v_and_b32 v212, s22, v212
    v_mfma_f32_16x16x32_bf16 v[176:179], a[224:227], v[236:239], v[176:179]
    ds_read_b128 v[236:239], v253 offset:38208
    v_lshlrev_b32 v252, 16, v204
    v_mfma_f32_16x16x32_bf16 v[180:183], a[216:219], v[228:231], v[180:183]
    s_add_u32 s42, s36, 1182720
    v_and_b32 v204, s22, v204
    v_add_f32 v252, v252, v251
    v_add_f32 v204, v204, v212
    v_mfma_f32_16x16x32_bf16 v[184:187], a[220:223], v[228:231], v[184:187]
    buffer_load_dwordx4 a[204:207], v254, s[8:11], s42 offen offset:0 sc1
    v_mfma_f32_16x16x32_bf16 v[188:191], a[224:227], v[228:231], v[188:191]
    ds_read_b128 v[228:231], v253 offset:37952
    v_fmac_f32 v252, s23, v249
    s_waitcnt vmcnt(19)
    s_waitcnt lgkmcnt(3)
sub31:
    v_mfma_f32_16x16x32_bf16 v[96:99], a[228:231], v[232:235], v[96:99]
    v_fmac_f32 v204, s23, v208
    v_cvt_pk_bf16_f32 v204, v252, v204
    v_lshlrev_b32 v252, 16, v214
    v_mfma_f32_16x16x32_bf16 v[100:103], a[232:235], v[232:235], v[100:103]
    s_waitcnt vmcnt(16) lgkmcnt(1)
    v_and_b32 v214, s22, v214
    v_add_f32 v252, v252, v248
    v_mfma_f32_16x16x32_bf16 v[104:107], a[236:239], v[232:235], v[104:107]
    ds_read_b128 v[232:235], v253 offset:37696
    v_add_f32 v214, v214, v206
    v_fmac_f32 v252, s23, v250
    v_mfma_f32_16x16x32_bf16 v[96:99], a[240:243], v[236:239], v[96:99]
    buffer_load_dwordx4 a[208:211], v254, s[8:11], s42 offen offset:1024 sc1
    v_mfma_f32_16x16x32_bf16 v[100:103], a[244:247], v[236:239], v[100:103]
    v_fmac_f32 v214, s23, v210
    v_cvt_pk_bf16_f32 v214, v252, v214
    v_mfma_f32_16x16x32_bf16 v[104:107], a[248:251], v[236:239], v[104:107]
    v_fma_f32 v252, v249, s24, v251
    v_fmac_f32 v251, s25, v249
    v_fma_f32 v249, v248, s24, v250
    v_mfma_f32_16x16x32_bf16 v[108:111], a[228:231], v[236:239], v[108:111]
    s_waitcnt lgkmcnt(1)
    v_fmac_f32 v250, s25, v248
    v_fma_f32 v248, v250, s26, v251
    v_mfma_f32_16x16x32_bf16 v[108:111], a[240:243], v[228:231], v[108:111]
    buffer_load_dwordx4 a[212:215], v254, s[8:11], s42 offen offset:2048 sc1
    v_fmac_f32 v251, s27, v250
    v_mfma_f32_16x16x32_bf16 v[112:115], a[244:247], v[228:231], v[112:115]
    v_fma_f32 v250, v249, s28, v252
    v_fmac_f32 v252, s29, v249
    v_mfma_f32_16x16x32_bf16 v[112:115], a[232:235], v[236:239], v[112:115]
    s_add_u32 s42, s36, 1185792
    v_fma_f32 v249, v208, s24, v212
    v_fmac_f32 v212, s25, v208
    v_mfma_f32_16x16x32_bf16 v[116:119], a[236:239], v[236:239], v[116:119]
    ds_read_b128 v[236:239], v253 offset:37440
    v_fma_f32 v208, v206, s24, v210
    v_fmac_f32 v210, s25, v206
    v_mfma_f32_16x16x32_bf16 v[116:119], a[248:251], v[228:231], v[116:119]
    buffer_load_dwordx4 a[216:219], v254, s[8:11], s42 offen offset:0 sc1
    s_waitcnt vmcnt(16)
    v_mfma_f32_16x16x32_bf16 v[96:99], a[252:255], v[228:231], v[96:99]
    ds_read_b128 a[4:7], v6 offset:13504
    v_fma_f32 v206, v210, s26, v212
    v_fmac_f32 v212, s27, v210
    v_mfma_f32_16x16x32_bf16 v[100:103], v[240:243], v[228:231], v[100:103]
    v_fma_f32 v210, v208, s28, v249
    v_fmac_f32 v249, s29, v208
    v_mfma_f32_16x16x32_bf16 v[104:107], v[244:247], v[228:231], v[104:107]
    s_waitcnt lgkmcnt(2)
    v_cvt_pk_bf16_f32 v206, v248, v206
    v_cvt_pk_bf16_f32 v212, v251, v212
    v_mfma_f32_16x16x32_bf16 v[120:123], a[228:231], v[228:231], v[120:123]
    buffer_load_dwordx4 a[220:223], v254, s[8:11], s42 offen offset:1024 sc1
    v_cvt_pk_bf16_f32 v210, v250, v210
    v_mfma_f32_16x16x32_bf16 v[120:123], a[240:243], v[232:235], v[120:123]
    v_cvt_pk_bf16_f32 v208, v252, v249
    v_lshlrev_b32 v248, 16, v207
    v_mfma_f32_16x16x32_bf16 v[124:127], a[244:247], v[232:235], v[124:127]
    v_lshlrev_b32 v249, 16, v209
    v_lshlrev_b32 v250, 16, v211
    v_lshlrev_b32 v251, 16, v213
    v_mfma_f32_16x16x32_bf16 v[124:127], a[232:235], v[228:231], v[124:127]
    buffer_load_dwordx4 a[224:227], v254, s[8:11], s42 offen offset:2048 sc1
    v_mfma_f32_16x16x32_bf16 v[128:131], a[236:239], v[228:231], v[128:131]
    ds_read_b128 v[228:231], v253 offset:39264
    v_and_b32 v203, 0x7fff, v255
    v_mfma_f32_16x16x32_bf16 v[128:131], a[248:251], v[232:235], v[128:131]
    v_and_b32 v207, s22, v207
    v_and_b32 v209, s22, v209
    v_and_b32 v211, s22, v211
    v_mfma_f32_16x16x32_bf16 v[108:111], a[252:255], v[232:235], v[108:111]
    buffer_load_dwordx2 v[192:193], v203, s[4:7], s16 offen offset:768
    v_mfma_f32_16x16x32_bf16 v[112:115], v[240:243], v[232:235], v[112:115]
    v_and_b32 v213, s22, v213
    v_lshlrev_b32 v252, 16, v205
    v_and_b32 v205, s22, v205
    v_mfma_f32_16x16x32_bf16 v[116:119], v[244:247], v[232:235], v[116:119]
    s_waitcnt lgkmcnt(2)
    v_add_f32 v252, v252, v251
    v_add_f32 v205, v205, v213
    v_mfma_f32_16x16x32_bf16 v[132:135], a[228:231], v[232:235], v[132:135]
    buffer_load_dwordx2 v[194:195], v203, s[4:7], s17 offen offset:768
    v_mfma_f32_16x16x32_bf16 v[132:135], a[240:243], v[236:239], v[132:135]
    v_fmac_f32 v252, s23, v249
    v_fmac_f32 v205, s23, v209
    v_cvt_pk_bf16_f32 v205, v252, v205
    v_mfma_f32_16x16x32_bf16 v[136:139], a[244:247], v[236:239], v[136:139]
    v_lshlrev_b32 v252, 16, v215
    v_and_b32 v215, s22, v215
    v_mfma_f32_16x16x32_bf16 v[136:139], a[232:235], v[232:235], v[136:139]
    buffer_load_dwordx2 v[196:197], v203, s[4:7], s18 offen offset:768
    v_add_f32 v252, v252, v248
    v_mfma_f32_16x16x32_bf16 v[140:143], a[236:239], v[232:235], v[140:143]
    ds_read_b128 v[232:235], v253 offset:39008
    v_add_f32 v215, v215, v207
    v_mfma_f32_16x16x32_bf16 v[140:143], a[248:251], v[236:239], v[140:143]
    v_fmac_f32 v252, s23, v250
    v_fmac_f32 v215, s23, v211
    v_mfma_f32_16x16x32_bf16 v[120:123], a[252:255], v[236:239], v[120:123]
    buffer_load_dwordx2 v[198:199], v203, s[4:7], s19 offen offset:768
    v_cvt_pk_bf16_f32 v215, v252, v215
    v_mfma_f32_16x16x32_bf16 v[124:127], v[240:243], v[236:239], v[124:127]
    s_waitcnt lgkmcnt(1)
    v_fma_f32 v252, v249, s24, v251
    v_fmac_f32 v251, s25, v249
    v_mfma_f32_16x16x32_bf16 v[128:131], v[244:247], v[236:239], v[128:131]
    ds_read_b128 a[8:11], v6 offset:14528
    v_fma_f32 v249, v248, s24, v250
    v_fmac_f32 v250, s25, v248
    v_mfma_f32_16x16x32_bf16 v[144:147], a[228:231], v[236:239], v[144:147]
    buffer_load_dwordx2 v[200:201], v203, s[4:7], s20 offen offset:768
    v_mfma_f32_16x16x32_bf16 v[144:147], a[240:243], v[228:231], v[144:147]
    v_fma_f32 v248, v250, s26, v251
    v_fmac_f32 v251, s27, v250
    v_mfma_f32_16x16x32_bf16 v[148:151], a[244:247], v[228:231], v[148:151]
    v_fma_f32 v250, v249, s28, v252
    v_fmac_f32 v252, s29, v249
    v_fma_f32 v249, v209, s24, v213
    v_mfma_f32_16x16x32_bf16 v[148:151], a[232:235], v[236:239], v[148:151]
    buffer_load_dwordx2 v[202:203], v203, s[4:7], s21 offen offset:768
    v_mfma_f32_16x16x32_bf16 v[152:155], a[236:239], v[236:239], v[152:155]
    ds_read_b128 v[236:239], v253 offset:38752
    v_fmac_f32 v213, s25, v209
    v_fma_f32 v209, v207, s24, v211
    v_mfma_f32_16x16x32_bf16 v[152:155], a[248:251], v[228:231], v[152:155]
    v_fmac_f32 v211, s25, v207
    v_fma_f32 v207, v211, s26, v213
    v_mfma_f32_16x16x32_bf16 v[132:135], a[252:255], v[228:231], v[132:135]
    buffer_store_dwordx4 a[156:159], v254, s[12:15], s44 offen sc1
    s_add_u32 s44, s40, 204800
    v_mfma_f32_16x16x32_bf16 v[136:139], v[240:243], v[228:231], v[136:139]
    v_fmac_f32 v213, s27, v211
    v_fma_f32 v211, v209, s28, v249
    v_fmac_f32 v249, s29, v209
    v_mfma_f32_16x16x32_bf16 v[140:143], v[244:247], v[228:231], v[140:143]
    s_waitcnt lgkmcnt(2)
    v_cvt_pk_bf16_f32 v207, v248, v207
    v_cvt_pk_bf16_f32 v213, v251, v213
    v_mfma_f32_16x16x32_bf16 v[156:159], a[228:231], v[228:231], v[156:159]
    buffer_store_dwordx4 a[160:163], v254, s[12:15], s44 offen sc1
    s_add_u32 s44, s40, 207872
    v_cvt_pk_bf16_f32 v211, v250, v211
    v_mfma_f32_16x16x32_bf16 v[156:159], a[240:243], v[232:235], v[156:159]
    v_cvt_pk_bf16_f32 v209, v252, v249
    v_lshrrev_b32 v252, 15, v255
    v_mfma_f32_16x16x32_bf16 v[160:163], a[244:247], v[232:235], v[160:163]
    ds_write_b64 v252, v[206:207] offset:768
    v_mfma_f32_16x16x32_bf16 v[160:163], a[232:235], v[228:231], v[160:163]
    buffer_store_dwordx4 a[164:167], v254, s[12:15], s44 offen sc1
    s_waitcnt vmcnt(21)
    v_lshlrev_b32 v248, 16, v218
    v_lshlrev_b32 v249, 16, v220
    v_mfma_f32_16x16x32_bf16 v[164:167], a[236:239], v[228:231], v[164:167]
    ds_read_b128 v[228:231], v253 offset:38496
    v_mfma_f32_16x16x32_bf16 v[164:167], a[248:251], v[232:235], v[164:167]
    ds_write_b64 v252, v[212:213] offset:2848
    v_lshlrev_b32 v250, 16, v222
    v_mfma_f32_16x16x32_bf16 v[144:147], a[252:255], v[232:235], v[144:147]
    v_lshlrev_b32 v251, 16, v224
    v_mfma_f32_16x16x32_bf16 v[148:151], v[240:243], v[232:235], v[148:151]
    ds_write_b64 v252, v[210:211] offset:4928
    v_mfma_f32_16x16x32_bf16 v[152:155], v[244:247], v[232:235], v[152:155]
    s_waitcnt lgkmcnt(4)
    v_and_b32 v218, s22, v218
    v_and_b32 v220, s22, v220
    v_mfma_f32_16x16x32_bf16 v[168:171], a[228:231], v[232:235], v[168:171]
    s_add_u32 s44, s40, 0
    v_mfma_f32_16x16x32_bf16 v[168:171], a[240:243], v[236:239], v[168:171]
    ds_write_b64 v252, v[204:205] offset:34048
    v_and_b32 v222, s22, v222
    v_mfma_f32_16x16x32_bf16 v[172:175], a[244:247], v[236:239], v[172:175]
    ds_read_b128 a[12:15], v6 offset:15584
    v_and_b32 v224, s22, v224
    v_mfma_f32_16x16x32_bf16 v[172:175], a[232:235], v[232:235], v[172:175]
    ds_write_b64 v252, v[214:215] offset:36128
    v_mfma_f32_16x16x32_bf16 v[176:179], a[236:239], v[232:235], v[176:179]
    ds_read_b128 v[232:235], v253 offset:38224
    v_mfma_f32_16x16x32_bf16 v[176:179], a[248:251], v[236:239], v[176:179]
    ds_write_b64 v252, v[208:209] offset:7008
    v_mfma_f32_16x16x32_bf16 v[156:159], a[252:255], v[236:239], v[156:159]
    v_mfma_f32_16x16x32_bf16 v[160:163], v[240:243], v[236:239], v[160:163]
    v_mfma_f32_16x16x32_bf16 v[164:167], v[244:247], v[236:239], v[164:167]
    s_add_u32 s42, s36, 1216512
    v_mfma_f32_16x16x32_bf16 v[180:183], a[228:231], v[236:239], v[180:183]
    buffer_load_dwordx4 a[228:231], v254, s[8:11], s42 offen offset:0 sc1
    v_mfma_f32_16x16x32_bf16 v[184:187], a[232:235], v[236:239], v[184:187]
    v_lshlrev_b32 v252, 16, v216
    v_and_b32 v216, s22, v216
    v_add_f32 v252, v252, v251
    v_mfma_f32_16x16x32_bf16 v[188:191], a[236:239], v[236:239], v[188:191]
    s_waitcnt lgkmcnt(7)
    v_add_f32 v216, v216, v224
    v_fmac_f32 v252, s23, v249
    v_mfma_f32_16x16x32_bf16 v[180:183], a[240:243], v[228:231], v[180:183]
    ds_read_b128 v[236:239], v253 offset:26000
    v_fmac_f32 v216, s23, v220
    v_mfma_f32_16x16x32_bf16 v[184:187], a[244:247], v[228:231], v[184:187]
    buffer_load_dwordx4 a[232:235], v254, s[8:11], s42 offen offset:1024 sc1
    v_mfma_f32_16x16x32_bf16 v[188:191], a[248:251], v[228:231], v[188:191]
    v_cvt_pk_bf16_f32 v216, v252, v216
    v_lshlrev_b32 v252, 16, v226
    v_mfma_f32_16x16x32_bf16 v[168:171], a[252:255], v[228:231], v[168:171]
    s_waitcnt lgkmcnt(2)
    v_and_b32 v226, s22, v226
    v_add_f32 v252, v252, v248
    v_mfma_f32_16x16x32_bf16 v[172:175], v[240:243], v[228:231], v[172:175]
    buffer_load_dwordx4 a[236:239], v254, s[8:11], s42 offen offset:2048 sc1
    v_add_f32 v226, v226, v218
    v_mfma_f32_16x16x32_bf16 v[176:179], v[244:247], v[228:231], v[176:179]
    ds_read_b128 v[228:231], v253 offset:25728
    v_fmac_f32 v252, s23, v250
    v_mfma_f32_16x16x32_bf16 v[180:183], a[252:255], v[232:235], v[180:183]
    s_add_u32 s42, s36, 1219584
    v_fmac_f32 v226, s23, v222
    v_cvt_pk_bf16_f32 v226, v252, v226
    v_mfma_f32_16x16x32_bf16 v[184:187], v[240:243], v[232:235], v[184:187]
    buffer_load_dwordx4 a[240:243], v254, s[8:11], s42 offen offset:0 sc1
    v_mfma_f32_16x16x32_bf16 v[188:191], v[244:247], v[232:235], v[188:191]
    ds_read_b128 v[232:235], v253 offset:25472
    v_fma_f32 v252, v249, s24, v251
    s_waitcnt vmcnt(19)
    s_waitcnt lgkmcnt(2)
sub32:
    v_mfma_f32_16x16x32_bf16 v[96:99], a[192:195], v[236:239], v[96:99]
    s_waitcnt vmcnt(16) lgkmcnt(1)
    v_fmac_f32 v251, s25, v249
    v_fma_f32 v249, v248, s24, v250
    v_mfma_f32_16x16x32_bf16 v[100:103], a[196:199], v[236:239], v[100:103]
    ds_read_b128 a[16:19], v6 offset:16608
    v_fmac_f32 v250, s25, v248
    v_mfma_f32_16x16x32_bf16 v[104:107], a[200:203], v[236:239], v[104:107]
    ds_read_b128 v[236:239], v253 offset:25216
    v_fma_f32 v248, v250, s26, v251
    v_fmac_f32 v251, s27, v250
    v_mfma_f32_16x16x32_bf16 v[96:99], a[204:207], v[228:231], v[96:99]
    buffer_load_dwordx4 a[244:247], v254, s[8:11], s42 offen offset:1024 sc1
    v_mfma_f32_16x16x32_bf16 v[100:103], a[208:211], v[228:231], v[100:103]
    v_fma_f32 v250, v249, s28, v252
    v_fmac_f32 v252, s29, v249
    v_mfma_f32_16x16x32_bf16 v[104:107], a[212:215], v[228:231], v[104:107]
    v_fma_f32 v249, v220, s24, v224
    v_fmac_f32 v224, s25, v220
    v_mfma_f32_16x16x32_bf16 v[108:111], a[192:195], v[228:231], v[108:111]
    s_waitcnt lgkmcnt(2)
    v_fma_f32 v220, v218, s24, v222
    v_fmac_f32 v222, s25, v218
    v_mfma_f32_16x16x32_bf16 v[108:111], a[204:207], v[232:235], v[108:111]
    buffer_load_dwordx4 a[248:251], v254, s[8:11], s42 offen offset:2048 sc1
    v_mfma_f32_16x16x32_bf16 v[112:115], a[208:211], v[232:235], v[112:115]
    v_fma_f32 v218, v222, s26, v224
    v_fmac_f32 v224, s27, v222
    v_mfma_f32_16x16x32_bf16 v[112:115], a[196:199], v[228:231], v[112:115]
    s_add_u32 s42, s36, 1222656
    v_fma_f32 v222, v220, s28, v249
    v_fmac_f32 v249, s29, v220
    v_cvt_pk_bf16_f32 v218, v248, v218
    v_mfma_f32_16x16x32_bf16 v[116:119], a[200:203], v[228:231], v[116:119]
    ds_read_b128 v[228:231], v253 offset:24960
    v_cvt_pk_bf16_f32 v224, v251, v224
    v_mfma_f32_16x16x32_bf16 v[116:119], a[212:215], v[232:235], v[116:119]
    buffer_load_dwordx4 a[252:255], v254, s[8:11], s42 offen offset:0 sc1
    s_waitcnt vmcnt(16)
    v_mfma_f32_16x16x32_bf16 v[96:99], a[216:219], v[232:235], v[96:99]
    v_cvt_pk_bf16_f32 v222, v250, v222
    v_cvt_pk_bf16_f32 v220, v252, v249
    v_mfma_f32_16x16x32_bf16 v[100:103], a[220:223], v[232:235], v[100:103]
    v_lshlrev_b32 v248, 16, v219
    v_lshlrev_b32 v249, 16, v221
    v_mfma_f32_16x16x32_bf16 v[104:107], a[224:227], v[232:235], v[104:107]
    s_waitcnt lgkmcnt(1)
    v_lshlrev_b32 v250, 16, v223
    v_lshlrev_b32 v251, 16, v225
    v_mfma_f32_16x16x32_bf16 v[120:123], a[192:195], v[232:235], v[120:123]
    buffer_load_dwordx4 v[240:243], v254, s[8:11], s42 offen offset:1024 sc1
    v_and_b32 v219, s22, v219
    v_mfma_f32_16x16x32_bf16 v[120:123], a[204:207], v[236:239], v[120:123]
    v_and_b32 v221, s22, v221
    v_and_b32 v223, s22, v223
    v_mfma_f32_16x16x32_bf16 v[124:127], a[208:211], v[236:239], v[124:127]
    v_and_b32 v225, s22, v225
    v_lshlrev_b32 v252, 16, v217
    v_mfma_f32_16x16x32_bf16 v[124:127], a[196:199], v[232:235], v[124:127]
    buffer_load_dwordx4 v[244:247], v254, s[8:11], s42 offen offset:2048 sc1
    v_mfma_f32_16x16x32_bf16 v[128:131], a[200:203], v[232:235], v[128:131]
    ds_read_b128 v[232:235], v253 offset:26784
    v_and_b32 v215, 0x7fff, v255
    v_mfma_f32_16x16x32_bf16 v[128:131], a[212:215], v[236:239], v[128:131]
    v_and_b32 v217, s22, v217
    v_add_f32 v252, v252, v251
    v_mfma_f32_16x16x32_bf16 v[108:111], a[216:219], v[236:239], v[108:111]
    buffer_load_dwordx2 v[204:205], v215, s[4:7], s16 offen offset:1152
    v_mfma_f32_16x16x32_bf16 v[112:115], a[220:223], v[236:239], v[112:115]
    ds_read_b128 a[20:23], v6 offset:17632
    v_add_f32 v217, v217, v225
    v_fmac_f32 v252, s23, v249
    v_mfma_f32_16x16x32_bf16 v[116:119], a[224:227], v[236:239], v[116:119]
pad12:
    s_cbranch_vccnz warm_ret
    s_waitcnt lgkmcnt(2)
    v_fmac_f32 v217, s23, v221
    v_cvt_pk_bf16_f32 v217, v252, v217
    v_mfma_f32_16x16x32_bf16 v[132:135], a[192:195], v[236:239], v[132:135]
    buffer_load_dwordx2 v[206:207], v215, s[4:7], s17 offen offset:1152
    v_mfma_f32_16x16x32_bf16 v[132:135], a[204:207], v[228:231], v[132:135]
    v_lshlrev_b32 v252, 16, v227
    v_and_b32 v227, s22, v227
    v_mfma_f32_16x16x32_bf16 v[136:139], a[208:211], v[228:231], v[136:139]
    v_add_f32 v252, v252, v248
    v_add_f32 v227, v227, v219
    v_mfma_f32_16x16x32_bf16 v[136:139], a[196:199], v[236:239], v[136:139]
    buffer_load_dwordx2 v[208:209], v215, s[4:7], s18 offen offset:1152
    v_mfma_f32_16x16x32_bf16 v[140:143], a[200:203], v[236:239], v[140:143]
    ds_read_b128 v[236:239], v253 offset:26528
    v_fmac_f32 v252, s23, v250
    v_mfma_f32_16x16x32_bf16 v[140:143], a[212:215], v[228:231], v[140:143]
    v_fmac_f32 v227, s23, v223
    v_cvt_pk_bf16_f32 v227, v252, v227
    v_fma_f32 v252, v249, s24, v251
    v_mfma_f32_16x16x32_bf16 v[120:123], a[216:219], v[228:231], v[120:123]
    buffer_load_dwordx2 v[210:211], v215, s[4:7], s19 offen offset:1152
    v_mfma_f32_16x16x32_bf16 v[124:127], a[220:223], v[228:231], v[124:127]
    v_fmac_f32 v251, s25, v249
    v_fma_f32 v249, v248, s24, v250
    v_mfma_f32_16x16x32_bf16 v[128:131], a[224:227], v[228:231], v[128:131]
    s_waitcnt lgkmcnt(2)
    v_fmac_f32 v250, s25, v248
    v_fma_f32 v248, v250, s26, v251
    v_mfma_f32_16x16x32_bf16 v[144:147], a[192:195], v[228:231], v[144:147]
    buffer_load_dwordx2 v[212:213], v215, s[4:7], s20 offen offset:1152
    v_mfma_f32_16x16x32_bf16 v[144:147], a[204:207], v[232:235], v[144:147]
    v_fmac_f32 v251, s27, v250
    v_fma_f32 v250, v249, s28, v252
    v_mfma_f32_16x16x32_bf16 v[148:151], a[208:211], v[232:235], v[148:151]
    v_fmac_f32 v252, s29, v249
    v_fma_f32 v249, v221, s24, v225
    v_fmac_f32 v225, s25, v221
    v_mfma_f32_16x16x32_bf16 v[148:151], a[196:199], v[228:231], v[148:151]
    buffer_load_dwordx2 v[214:215], v215, s[4:7], s21 offen offset:1152
    v_mfma_f32_16x16x32_bf16 v[152:155], a[200:203], v[228:231], v[152:155]
    ds_read_b128 v[228:231], v253 offset:26272
    v_fma_f32 v221, v219, s24, v223
    v_mfma_f32_16x16x32_bf16 v[152:155], a[212:215], v[232:235], v[152:155]
    v_fmac_f32 v223, s25, v219
    v_fma_f32 v219, v223, s26, v225
    v_mfma_f32_16x16x32_bf16 v[132:135], a[216:219], v[232:235], v[132:135]
    buffer_store_dwordx4 a[0:3], v254, s[12:15], s44 offen sc1
    s_add_u32 s44, s40, 1024
    v_mfma_f32_16x16x32_bf16 v[136:139], a[220:223], v[232:235], v[136:139]
    v_fmac_f32 v225, s27, v223
    v_fma_f32 v223, v221, s28, v249
    v_mfma_f32_16x16x32_bf16 v[140:143], a[224:227], v[232:235], v[140:143]
    s_waitcnt lgkmcnt(1)
    v_fmac_f32 v249, s29, v221
    v_cvt_pk_bf16_f32 v219, v248, v219
    v_mfma_f32_16x16x32_bf16 v[156:159], a[192:195], v[232:235], v[156:159]
    ds_read_b128 a[24:27], v6 offset:18688
    v_cvt_pk_bf16_f32 v225, v251, v225
    v_cvt_pk_bf16_f32 v223, v250, v223
    v_mfma_f32_16x16x32_bf16 v[156:159], a[204:207], v[236:239], v[156:159]
    buffer_store_dwordx4 a[4:7], v254, s[12:15], s44 offen sc1
    s_add_u32 s44, s40, 2048
    v_mfma_f32_16x16x32_bf16 v[160:163], a[208:211], v[236:239], v[160:163]
    v_cvt_pk_bf16_f32 v221, v252, v249
    v_lshrrev_b32 v252, 15, v255
    v_mfma_f32_16x16x32_bf16 v[160:163], a[196:199], v[232:235], v[160:163]
    ds_write_b64 v252, v[218:219] offset:512
    v_mfma_f32_16x16x32_bf16 v[164:167], a[200:203], v[232:235], v[164:167]
    ds_read_b128 v[232:235], v253 offset:26016
    s_waitcnt vmcnt(20)
    v_mfma_f32_16x16x32_bf16 v[164:167], a[212:215], v[236:239], v[164:167]
    buffer_store_dwordx4 a[8:11], v254, s[12:15], s44 offen sc1
    s_add_u32 s44, s40, 3072
    v_lshlrev_b32 v248, 16, v194
    v_mfma_f32_16x16x32_bf16 v[144:147], a[216:219], v[236:239], v[144:147]
    v_lshlrev_b32 v249, 16, v196
    v_mfma_f32_16x16x32_bf16 v[148:151], a[220:223], v[236:239], v[148:151]
    ds_write_b64 v252, v[224:225] offset:2592
    v_lshlrev_b32 v250, 16, v198
    v_mfma_f32_16x16x32_bf16 v[152:155], a[224:227], v[236:239], v[152:155]
    s_waitcnt lgkmcnt(4)
    v_lshlrev_b32 v251, 16, v200
    v_mfma_f32_16x16x32_bf16 v[168:171], a[192:195], v[236:239], v[168:171]
    ds_write_b64 v252, v[222:223] offset:4672
    v_mfma_f32_16x16x32_bf16 v[168:171], a[204:207], v[228:231], v[168:171]
    v_and_b32 v194, s22, v194
    v_and_b32 v196, s22, v196
    v_mfma_f32_16x16x32_bf16 v[172:175], a[208:211], v[228:231], v[172:175]
    ds_write_b64 v252, v[216:217] offset:33792
    v_mfma_f32_16x16x32_bf16 v[172:175], a[196:199], v[236:239], v[172:175]
    v_and_b32 v198, s22, v198
    v_and_b32 v200, s22, v200
    v_mfma_f32_16x16x32_bf16 v[176:179], a[200:203], v[236:239], v[176:179]
    ds_read_b128 v[236:239], v253 offset:25744
    v_mfma_f32_16x16x32_bf16 v[176:179], a[212:215], v[228:231], v[176:179]
    ds_write_b64 v252, v[226:227] offset:35872
    v_mfma_f32_16x16x32_bf16 v[156:159], a[216:219], v[228:231], v[156:159]
    v_mfma_f32_16x16x32_bf16 v[160:163], a[220:223], v[228:231], v[160:163]
    ds_write_b64 v252, v[220:221] offset:6752
    v_mfma_f32_16x16x32_bf16 v[164:167], a[224:227], v[228:231], v[164:167]
    s_add_u32 s42, s36, 1253376
    v_mfma_f32_16x16x32_bf16 v[180:183], a[192:195], v[228:231], v[180:183]
    buffer_load_dwordx4 a[192:195], v254, s[8:11], s42 offen offset:0 sc1
    v_mfma_f32_16x16x32_bf16 v[184:187], a[196:199], v[228:231], v[184:187]
    s_waitcnt lgkmcnt(6)
    v_lshlrev_b32 v252, 16, v192
    v_and_b32 v192, s22, v192
    v_mfma_f32_16x16x32_bf16 v[188:191], a[200:203], v[228:231], v[188:191]
    ds_read_b128 a[28:31], v6 offset:19712
    v_add_f32 v252, v252, v251
    v_mfma_f32_16x16x32_bf16 v[180:183], a[204:207], v[232:235], v[180:183]
    ds_read_b128 v[228:231], v253 offset:28080
    v_add_f32 v192, v192, v200
    v_mfma_f32_16x16x32_bf16 v[184:187], a[208:211], v[232:235], v[184:187]
    buffer_load_dwordx4 a[196:199], v254, s[8:11], s42 offen offset:1024 sc1
    v_mfma_f32_16x16x32_bf16 v[188:191], a[212:215], v[232:235], v[188:191]
    ds_read_b128 v[216:219], v253 offset:39520
    v_fmac_f32 v252, s23, v249
    v_fmac_f32 v192, s23, v196
    v_mfma_f32_16x16x32_bf16 v[168:171], a[216:219], v[232:235], v[168:171]
    s_mov_b32 s45, 573637648
    v_cvt_pk_bf16_f32 v192, v252, v192
    v_lshlrev_b32 v252, 16, v202
    v_mfma_f32_16x16x32_bf16 v[172:175], a[220:223], v[232:235], v[172:175]
    buffer_load_dwordx4 a[200:203], v254, s[8:11], s42 offen offset:2048 sc1
    v_mfma_f32_16x16x32_bf16 v[176:179], a[224:227], v[232:235], v[176:179]
    ds_read_b128 v[232:235], v253 offset:27808
    v_and_b32 v202, s22, v202
    s_waitcnt lgkmcnt(6)
    v_mfma_f32_16x16x32_bf16 v[180:183], a[216:219], v[236:239], v[180:183]
    s_add_u32 s42, s36, 1256448
    v_bfe_u32 v220, v254, 5, 3
    v_add_f32 v252, v252, v248
    v_mfma_f32_16x16x32_bf16 v[184:187], a[220:223], v[236:239], v[184:187]
    buffer_load_dwordx4 a[204:207], v254, s[8:11], s42 offen offset:0 sc1
    v_mfma_f32_16x16x32_bf16 v[188:191], a[224:227], v[236:239], v[188:191]
    ds_read_b128 v[236:239], v253 offset:27552
    v_mul_u32_u24 v221, 5, v220
    s_waitcnt vmcnt(19)
    s_waitcnt lgkmcnt(3)
sub33:
    v_mfma_f32_16x16x32_bf16 v[96:99], a[228:231], v[228:231], v[96:99]
    v_add_f32 v202, v202, v194
    v_fmac_f32 v252, s23, v250
    v_mfma_f32_16x16x32_bf16 v[100:103], a[232:235], v[228:231], v[100:103]
    s_waitcnt vmcnt(16) lgkmcnt(1)
    v_fmac_f32 v202, s23, v198
    v_cvt_pk_bf16_f32 v202, v252, v202
    v_mfma_f32_16x16x32_bf16 v[104:107], a[236:239], v[228:231], v[104:107]
    ds_read_b128 v[228:231], v253 offset:27296
    v_bfe_u32 v221, s45, v221, 5
    v_mfma_f32_16x16x32_bf16 v[96:99], a[240:243], v[232:235], v[96:99]
    buffer_load_dwordx4 a[208:211], v254, s[8:11], s42 offen offset:1024 sc1
    v_fma_f32 v252, v249, s24, v251
    v_mfma_f32_16x16x32_bf16 v[100:103], a[244:247], v[232:235], v[100:103]
    v_fmac_f32 v251, s25, v249
    v_fma_f32 v249, v248, s24, v250
    v_mfma_f32_16x16x32_bf16 v[104:107], a[248:251], v[232:235], v[104:107]
    v_mul_u32_u24 v221, 65, v221
    v_fmac_f32 v250, s25, v248
    v_mfma_f32_16x16x32_bf16 v[108:111], a[228:231], v[232:235], v[108:111]
    s_waitcnt lgkmcnt(1)
    v_fma_f32 v248, v250, s26, v251
    v_fmac_f32 v251, s27, v250
    v_mfma_f32_16x16x32_bf16 v[108:111], a[240:243], v[236:239], v[108:111]
    buffer_load_dwordx4 a[212:215], v254, s[8:11], s42 offen offset:2048 sc1
    v_mfma_f32_16x16x32_bf16 v[112:115], a[244:247], v[236:239], v[112:115]
    v_sub_u32 v221, v221, v220
    v_fma_f32 v250, v249, s28, v252
    v_mfma_f32_16x16x32_bf16 v[112:115], a[232:235], v[232:235], v[112:115]
    s_add_u32 s42, s36, 1259520
    v_fmac_f32 v252, s29, v249
    v_fma_f32 v249, v196, s24, v200
    v_mfma_f32_16x16x32_bf16 v[116:119], a[236:239], v[232:235], v[116:119]
    ds_read_b128 v[232:235], v253 offset:27040
    v_lshl_add_u32 v220, v221, 5, v253
    v_mfma_f32_16x16x32_bf16 v[116:119], a[248:251], v[236:239], v[116:119]
    buffer_load_dwordx4 a[216:219], v254, s[8:11], s42 offen offset:0 sc1
    s_waitcnt vmcnt(16)
    v_mfma_f32_16x16x32_bf16 v[96:99], a[252:255], v[236:239], v[96:99]
    ds_read_b128 a[32:35], v6 offset:20736
    v_mfma_f32_16x16x32_bf16 v[100:103], v[240:243], v[236:239], v[100:103]
    v_fmac_f32 v200, s25, v196
    v_fma_f32 v196, v194, s24, v198
    v_fmac_f32 v198, s25, v194
    v_mfma_f32_16x16x32_bf16 v[104:107], v[244:247], v[236:239], v[104:107]
    s_waitcnt lgkmcnt(2)
    v_fma_f32 v194, v198, s26, v200
    v_fmac_f32 v200, s27, v198
    v_mfma_f32_16x16x32_bf16 v[120:123], a[228:231], v[236:239], v[120:123]
    buffer_load_dwordx4 a[220:223], v254, s[8:11], s42 offen offset:1024 sc1
    v_mfma_f32_16x16x32_bf16 v[120:123], a[240:243], v[228:231], v[120:123]
    s_mov_b64 exec, s[46:47]
    ds_write_b128 v220, v[216:219] offset:1024
    s_mov_b64 exec, -1
    v_mfma_f32_16x16x32_bf16 v[124:127], a[244:247], v[228:231], v[124:127]
    v_fma_f32 v198, v196, s28, v249
    v_fmac_f32 v249, s29, v196
    v_mfma_f32_16x16x32_bf16 v[124:127], a[232:235], v[236:239], v[124:127]
    buffer_load_dwordx4 a[224:227], v254, s[8:11], s42 offen offset:2048 sc1
    v_mfma_f32_16x16x32_bf16 v[128:131], a[236:239], v[236:239], v[128:131]
    ds_read_b128 v[236:239], v253 offset:28864
    v_cvt_pk_bf16_f32 v194, v248, v194
    v_mfma_f32_16x16x32_bf16 v[128:131], a[248:251], v[228:231], v[128:131]
    v_cvt_pk_bf16_f32 v200, v251, v200
    v_cvt_pk_bf16_f32 v198, v250, v198
    v_mfma_f32_16x16x32_bf16 v[108:111], a[252:255], v[228:231], v[108:111]
    buffer_store_dwordx4 a[12:15], v254, s[12:15], s44 offen sc1
    s_add_u32 s44, s40, 4096
    v_mfma_f32_16x16x32_bf16 v[112:115], v[240:243], v[228:231], v[112:115]
    v_cvt_pk_bf16_f32 v196, v252, v249
    v_lshlrev_b32 v248, 16, v195
    v_mfma_f32_16x16x32_bf16 v[116:119], v[244:247], v[228:231], v[116:119]
    s_waitcnt lgkmcnt(3)
    v_lshlrev_b32 v249, 16, v197
    v_lshlrev_b32 v250, 16, v199
    v_lshlrev_b32 v251, 16, v201
    v_mfma_f32_16x16x32_bf16 v[132:135], a[228:231], v[228:231], v[132:135]
    buffer_store_dwordx4 a[16:19], v254, s[12:15], s44 offen sc1
    s_add_u32 s44, s40, 5120
    v_and_b32 v195, s22, v195
    v_mfma_f32_16x16x32_bf16 v[132:135], a[240:243], v[232:235], v[132:135]
    v_and_b32 v197, s22, v197
    v_and_b32 v199, s22, v199
    v_mfma_f32_16x16x32_bf16 v[136:139], a[244:247], v[232:235], v[136:139]
    v_and_b32 v201, s22, v201
    v_lshlrev_b32 v252, 16, v193
    v_mfma_f32_16x16x32_bf16 v[136:139], a[232:235], v[228:231], v[136:139]
    v_and_b32 v193, s22, v193
    v_add_f32 v252, v252, v251
    v_mfma_f32_16x16x32_bf16 v[140:143], a[236:239], v[228:231], v[140:143]
    ds_read_b128 v[228:231], v253 offset:28608
    v_add_f32 v193, v193, v201
    v_mfma_f32_16x16x32_bf16 v[140:143], a[248:251], v[232:235], v[140:143]
    v_fmac_f32 v252, s23, v249
    v_fmac_f32 v193, s23, v197
    v_mfma_f32_16x16x32_bf16 v[120:123], a[252:255], v[232:235], v[120:123]
    v_cvt_pk_bf16_f32 v193, v252, v193
    v_lshlrev_b32 v252, 16, v203
    v_mfma_f32_16x16x32_bf16 v[124:127], v[240:243], v[232:235], v[124:127]
    ds_read_b128 a[36:39], v6 offset:21792
    v_and_b32 v203, s22, v203
    v_mfma_f32_16x16x32_bf16 v[128:131], v[244:247], v[232:235], v[128:131]
    v_add_f32 v252, v252, v248
    v_add_f32 v203, v203, v195
    v_mfma_f32_16x16x32_bf16 v[144:147], a[228:231], v[232:235], v[144:147]
    s_waitcnt lgkmcnt(2)
    v_fmac_f32 v252, s23, v250
    v_fmac_f32 v203, s23, v199
    v_cvt_pk_bf16_f32 v203, v252, v203
    v_mfma_f32_16x16x32_bf16 v[144:147], a[240:243], v[236:239], v[144:147]
    v_fma_f32 v252, v249, s24, v251
    v_fmac_f32 v251, s25, v249
    v_mfma_f32_16x16x32_bf16 v[148:151], a[244:247], v[236:239], v[148:151]
    v_fma_f32 v249, v248, s24, v250
    v_fmac_f32 v250, s25, v248
    v_mfma_f32_16x16x32_bf16 v[148:151], a[232:235], v[232:235], v[148:151]
    buffer_store_dwordx4 a[20:23], v254, s[12:15], s44 offen sc1
    v_fma_f32 v248, v250, s26, v251
    v_fmac_f32 v251, s27, v250
    v_mfma_f32_16x16x32_bf16 v[152:155], a[236:239], v[232:235], v[152:155]
    ds_read_b128 v[232:235], v253 offset:28352
    v_fma_f32 v250, v249, s28, v252
    v_mfma_f32_16x16x32_bf16 v[152:155], a[248:251], v[236:239], v[152:155]
    v_fmac_f32 v252, s29, v249
    v_fma_f32 v249, v197, s24, v201
    v_mfma_f32_16x16x32_bf16 v[132:135], a[252:255], v[236:239], v[132:135]
    v_fmac_f32 v201, s25, v197
    v_fma_f32 v197, v195, s24, v199
    v_mfma_f32_16x16x32_bf16 v[136:139], v[240:243], v[236:239], v[136:139]
    v_fmac_f32 v199, s25, v195
    v_fma_f32 v195, v199, s26, v201
    v_mfma_f32_16x16x32_bf16 v[140:143], v[244:247], v[236:239], v[140:143]
    v_fmac_f32 v201, s27, v199
    v_fma_f32 v199, v197, s28, v249
    v_mfma_f32_16x16x32_bf16 v[156:159], a[228:231], v[236:239], v[156:159]
    s_waitcnt lgkmcnt(2)
    v_fmac_f32 v249, s29, v197
    v_cvt_pk_bf16_f32 v195, v248, v195
    v_mfma_f32_16x16x32_bf16 v[156:159], a[240:243], v[228:231], v[156:159]
    v_cvt_pk_bf16_f32 v201, v251, v201
    v_cvt_pk_bf16_f32 v199, v250, v199
    v_cvt_pk_bf16_f32 v197, v252, v249
    v_mfma_f32_16x16x32_bf16 v[160:163], a[244:247], v[228:231], v[160:163]
    s_add_u32 s44, s40, 6144
    v_lshrrev_b32 v252, 15, v255
    v_mfma_f32_16x16x32_bf16 v[160:163], a[232:235], v[236:239], v[160:163]
    ds_write_b64 v252, v[194:195] offset:256
    v_mfma_f32_16x16x32_bf16 v[164:167], a[236:239], v[236:239], v[164:167]
    ds_read_b128 v[236:239], v253 offset:28096
    s_waitcnt vmcnt(15)
    v_mfma_f32_16x16x32_bf16 v[164:167], a[248:251], v[228:231], v[164:167]
    v_lshlrev_b32 v248, 16, v206
    v_lshlrev_b32 v249, 16, v208
    v_mfma_f32_16x16x32_bf16 v[144:147], a[252:255], v[228:231], v[144:147]
    ds_write_b64 v252, v[200:201] offset:2336
    v_mfma_f32_16x16x32_bf16 v[148:151], v[240:243], v[228:231], v[148:151]
    s_waitcnt lgkmcnt(3)
    v_lshlrev_b32 v250, 16, v210
    v_lshlrev_b32 v251, 16, v212
    v_mfma_f32_16x16x32_bf16 v[152:155], v[244:247], v[228:231], v[152:155]
    ds_write_b64 v252, v[198:199] offset:4416
    v_mfma_f32_16x16x32_bf16 v[168:171], a[228:231], v[228:231], v[168:171]
    ds_read_b128 a[40:43], v6 offset:22816
    v_mfma_f32_16x16x32_bf16 v[168:171], a[240:243], v[232:235], v[168:171]
    v_and_b32 v206, s22, v206
    v_and_b32 v208, s22, v208
    v_mfma_f32_16x16x32_bf16 v[172:175], a[244:247], v[232:235], v[172:175]
    ds_write_b64 v252, v[192:193] offset:33536
    v_and_b32 v210, s22, v210
    v_mfma_f32_16x16x32_bf16 v[172:175], a[232:235], v[228:231], v[172:175]
    v_and_b32 v212, s22, v212
    v_mfma_f32_16x16x32_bf16 v[176:179], a[236:239], v[228:231], v[176:179]
    ds_read_b128 v[228:231], v253 offset:27824
    v_mfma_f32_16x16x32_bf16 v[176:179], a[248:251], v[232:235], v[176:179]
    ds_write_b64 v252, v[202:203] offset:35616
    v_mfma_f32_16x16x32_bf16 v[156:159], a[252:255], v[232:235], v[156:159]
    v_mfma_f32_16x16x32_bf16 v[160:163], v[240:243], v[232:235], v[160:163]
    ds_write_b64 v252, v[196:197] offset:6496
    v_mfma_f32_16x16x32_bf16 v[164:167], v[244:247], v[232:235], v[164:167]
    s_add_u32 s42, s37, 1290240
    v_mfma_f32_16x16x32_bf16 v[180:183], a[228:231], v[232:235], v[180:183]
    buffer_load_dwordx4 a[228:231], v254, s[8:11], s42 offen offset:0 sc1
    v_mfma_f32_16x16x32_bf16 v[184:187], a[232:235], v[232:235], v[184:187]
    v_lshlrev_b32 v252, 16, v204
    v_and_b32 v204, s22, v204
    v_mfma_f32_16x16x32_bf16 v[188:191], a[236:239], v[232:235], v[188:191]
    s_waitcnt lgkmcnt(7)
    v_add_f32 v252, v252, v251
    v_add_f32 v204, v204, v212
    v_mfma_f32_16x16x32_bf16 v[180:183], a[240:243], v[236:239], v[180:183]
    ds_read_b128 v[232:235], v253 offset:30160
    v_fmac_f32 v252, s23, v249
    v_fmac_f32 v204, s23, v208
    v_mfma_f32_16x16x32_bf16 v[184:187], a[244:247], v[236:239], v[184:187]
    buffer_load_dwordx4 a[232:235], v254, s[8:11], s42 offen offset:1024 sc1
    v_mfma_f32_16x16x32_bf16 v[188:191], a[248:251], v[236:239], v[188:191]
    v_cvt_pk_bf16_f32 v204, v252, v204
    v_lshlrev_b32 v252, 16, v214
    v_mfma_f32_16x16x32_bf16 v[168:171], a[252:255], v[236:239], v[168:171]
    s_waitcnt lgkmcnt(3)
    v_and_b32 v214, s22, v214
    v_add_f32 v252, v252, v248
    v_mfma_f32_16x16x32_bf16 v[172:175], v[240:243], v[236:239], v[172:175]
    buffer_load_dwordx4 a[236:239], v254, s[8:11], s42 offen offset:2048 sc1
    v_mfma_f32_16x16x32_bf16 v[176:179], v[244:247], v[236:239], v[176:179]
    ds_read_b128 v[236:239], v253 offset:29888
    v_add_f32 v214, v214, v206
    v_fmac_f32 v252, s23, v250
    v_mfma_f32_16x16x32_bf16 v[180:183], a[252:255], v[228:231], v[180:183]
    s_add_u32 s42, s37, 1293312
    v_fmac_f32 v214, s23, v210
    v_cvt_pk_bf16_f32 v214, v252, v214
    v_mfma_f32_16x16x32_bf16 v[184:187], v[240:243], v[228:231], v[184:187]
    buffer_load_dwordx4 a[240:243], v254, s[8:11], s42 offen offset:0 sc1
    v_mfma_f32_16x16x32_bf16 v[188:191], v[244:247], v[228:231], v[188:191]
    ds_read_b128 v[228:231], v253 offset:29632
    v_fma_f32 v252, v249, s24, v251
    s_waitcnt vmcnt(13)
    s_waitcnt lgkmcnt(2)
sub34:
    v_mfma_f32_16x16x32_bf16 v[96:99], a[192:195], v[232:235], v[96:99]
    ds_read_b128 a[44:47], v6 offset:23840
    v_fmac_f32 v251, s25, v249
    v_mfma_f32_16x16x32_bf16 v[100:103], a[196:199], v[232:235], v[100:103]
    s_waitcnt vmcnt(10) lgkmcnt(2)
    v_fma_f32 v249, v248, s24, v250
    v_fmac_f32 v250, s25, v248
    v_fma_f32 v248, v250, s26, v251
    v_mfma_f32_16x16x32_bf16 v[104:107], a[200:203], v[232:235], v[104:107]
    ds_read_b128 v[232:235], v253 offset:29376
    v_fmac_f32 v251, s27, v250
    v_mfma_f32_16x16x32_bf16 v[96:99], a[204:207], v[236:239], v[96:99]
    buffer_load_dwordx4 a[244:247], v254, s[8:11], s42 offen offset:1024 sc1
    v_mfma_f32_16x16x32_bf16 v[100:103], a[208:211], v[236:239], v[100:103]
    v_fma_f32 v250, v249, s28, v252
    v_fmac_f32 v252, s29, v249
    v_mfma_f32_16x16x32_bf16 v[104:107], a[212:215], v[236:239], v[104:107]
    v_fma_f32 v249, v208, s24, v212
    v_fmac_f32 v212, s25, v208
    v_mfma_f32_16x16x32_bf16 v[108:111], a[192:195], v[236:239], v[108:111]
    s_waitcnt lgkmcnt(2)
    v_fma_f32 v208, v206, s24, v210
    v_fmac_f32 v210, s25, v206
    v_fma_f32 v206, v210, s26, v212
    v_mfma_f32_16x16x32_bf16 v[108:111], a[204:207], v[228:231], v[108:111]
    buffer_load_dwordx4 a[248:251], v254, s[8:11], s42 offen offset:2048 sc1
    v_mfma_f32_16x16x32_bf16 v[112:115], a[208:211], v[228:231], v[112:115]
    v_fmac_f32 v212, s27, v210
    v_fma_f32 v210, v208, s28, v249
    v_mfma_f32_16x16x32_bf16 v[112:115], a[196:199], v[236:239], v[112:115]
    s_add_u32 s42, s37, 1296384
    v_fmac_f32 v249, s29, v208
    v_cvt_pk_bf16_f32 v206, v248, v206
    v_mfma_f32_16x16x32_bf16 v[116:119], a[200:203], v[236:239], v[116:119]
    ds_read_b128 v[236:239], v253 offset:29120
    v_cvt_pk_bf16_f32 v212, v251, v212
    v_mfma_f32_16x16x32_bf16 v[116:119], a[212:215], v[228:231], v[116:119]
    buffer_load_dwordx4 a[252:255], v254, s[8:11], s42 offen offset:0 sc1
    v_cvt_pk_bf16_f32 v210, v250, v210
    s_waitcnt vmcnt(10)
    v_mfma_f32_16x16x32_bf16 v[96:99], a[216:219], v[228:231], v[96:99]
    v_cvt_pk_bf16_f32 v208, v252, v249
    v_lshlrev_b32 v248, 16, v207
    v_mfma_f32_16x16x32_bf16 v[100:103], a[220:223], v[228:231], v[100:103]
    v_lshlrev_b32 v249, 16, v209
    v_lshlrev_b32 v250, 16, v211
    v_mfma_f32_16x16x32_bf16 v[104:107], a[224:227], v[228:231], v[104:107]
    s_waitcnt lgkmcnt(1)
    v_lshlrev_b32 v251, 16, v213
    v_and_b32 v207, s22, v207
    v_mfma_f32_16x16x32_bf16 v[120:123], a[192:195], v[228:231], v[120:123]
    buffer_load_dwordx4 v[240:243], v254, s[8:11], s42 offen offset:1024 sc1
    v_mfma_f32_16x16x32_bf16 v[120:123], a[204:207], v[232:235], v[120:123]
    v_and_b32 v209, s22, v209
    v_and_b32 v211, s22, v211
    v_and_b32 v213, s22, v213
    v_mfma_f32_16x16x32_bf16 v[124:127], a[208:211], v[232:235], v[124:127]
    v_lshlrev_b32 v252, 16, v205
    v_and_b32 v205, s22, v205
    v_mfma_f32_16x16x32_bf16 v[124:127], a[196:199], v[228:231], v[124:127]
    buffer_load_dwordx4 v[244:247], v254, s[8:11], s42 offen offset:2048 sc1
    v_mfma_f32_16x16x32_bf16 v[128:131], a[200:203], v[228:231], v[128:131]
    ds_read_b128 v[228:231], v253 offset:30944
    v_and_b32 v203, 0x7fff, v255
    v_mfma_f32_16x16x32_bf16 v[128:131], a[212:215], v[232:235], v[128:131]
    v_add_f32 v252, v252, v251
    v_add_f32 v205, v205, v213
    v_mfma_f32_16x16x32_bf16 v[108:111], a[216:219], v[232:235], v[108:111]
    buffer_load_dwordx2 v[192:193], v203, s[4:7], s16 offen offset:64
    v_fmac_f32 v252, s23, v249
    v_mfma_f32_16x16x32_bf16 v[112:115], a[220:223], v[232:235], v[112:115]
    v_fmac_f32 v205, s23, v209
    v_cvt_pk_bf16_f32 v205, v252, v205
    v_mfma_f32_16x16x32_bf16 v[116:119], a[224:227], v[232:235], v[116:119]
    s_waitcnt lgkmcnt(1)
    v_lshlrev_b32 v252, 16, v215
    v_and_b32 v215, s22, v215
    v_mfma_f32_16x16x32_bf16 v[132:135], a[192:195], v[232:235], v[132:135]
    buffer_load_dwordx2 v[194:195], v203, s[4:7], s17 offen offset:64
    v_mfma_f32_16x16x32_bf16 v[132:135], a[204:207], v[236:239], v[132:135]
    v_add_f32 v252, v252, v248
    v_add_f32 v215, v215, v207
    v_mfma_f32_16x16x32_bf16 v[136:139], a[208:211], v[236:239], v[136:139]
    v_fmac_f32 v252, s23, v250
    v_fmac_f32 v215, s23, v211
    v_cvt_pk_bf16_f32 v215, v252, v215
    v_mfma_f32_16x16x32_bf16 v[136:139], a[196:199], v[232:235], v[136:139]
    buffer_load_dwordx2 v[196:197], v203, s[4:7], s18 offen offset:64
    v_mfma_f32_16x16x32_bf16 v[140:143], a[200:203], v[232:235], v[140:143]
    ds_read_b128 v[232:235], v253 offset:30688
    v_fma_f32 v252, v249, s24, v251
    v_mfma_f32_16x16x32_bf16 v[140:143], a[212:215], v[236:239], v[140:143]
    v_fmac_f32 v251, s25, v249
    v_fma_f32 v249, v248, s24, v250
    v_mfma_f32_16x16x32_bf16 v[120:123], a[216:219], v[236:239], v[120:123]
    buffer_load_dwordx2 v[198:199], v203, s[4:7], s19 offen offset:64
    v_mfma_f32_16x16x32_bf16 v[124:127], a[220:223], v[236:239], v[124:127]
    v_fmac_f32 v250, s25, v248
    v_fma_f32 v248, v250, s26, v251
    v_fmac_f32 v251, s27, v250
    v_mfma_f32_16x16x32_bf16 v[128:131], a[224:227], v[236:239], v[128:131]
    s_waitcnt lgkmcnt(1)
    v_fma_f32 v250, v249, s28, v252
    v_fmac_f32 v252, s29, v249
    v_mfma_f32_16x16x32_bf16 v[144:147], a[192:195], v[236:239], v[144:147]
    buffer_load_dwordx2 v[200:201], v203, s[4:7], s20 offen offset:64
    v_mfma_f32_16x16x32_bf16 v[144:147], a[204:207], v[228:231], v[144:147]
    v_fma_f32 v249, v209, s24, v213
    v_fmac_f32 v213, s25, v209
    v_mfma_f32_16x16x32_bf16 v[148:151], a[208:211], v[228:231], v[148:151]
    v_fma_f32 v209, v207, s24, v211
    v_fmac_f32 v211, s25, v207
    v_mfma_f32_16x16x32_bf16 v[148:151], a[196:199], v[236:239], v[148:151]
    buffer_load_dwordx2 v[202:203], v203, s[4:7], s21 offen offset:64
    v_fma_f32 v207, v211, s26, v213
    v_mfma_f32_16x16x32_bf16 v[152:155], a[200:203], v[236:239], v[152:155]
    ds_read_b128 v[236:239], v253 offset:30432
    v_fmac_f32 v213, s27, v211
    v_mfma_f32_16x16x32_bf16 v[152:155], a[212:215], v[228:231], v[152:155]
    v_fma_f32 v211, v209, s28, v249
    v_fmac_f32 v249, s29, v209
    v_mfma_f32_16x16x32_bf16 v[132:135], a[216:219], v[228:231], v[132:135]
    buffer_store_dwordx4 a[24:27], v254, s[12:15], s44 offen sc1
    s_add_u32 s44, s40, 7168
    v_mfma_f32_16x16x32_bf16 v[136:139], a[220:223], v[228:231], v[136:139]
    v_cvt_pk_bf16_f32 v207, v248, v207
    v_cvt_pk_bf16_f32 v213, v251, v213
    v_mfma_f32_16x16x32_bf16 v[140:143], a[224:227], v[228:231], v[140:143]
    s_waitcnt lgkmcnt(1)
    v_cvt_pk_bf16_f32 v211, v250, v211
    v_cvt_pk_bf16_f32 v209, v252, v249
    v_lshrrev_b32 v252, 15, v255
    v_mfma_f32_16x16x32_bf16 v[156:159], a[192:195], v[228:231], v[156:159]
    buffer_store_dwordx4 a[28:31], v254, s[12:15], s44 offen sc1
    s_add_u32 s44, s40, 8192
    v_mfma_f32_16x16x32_bf16 v[156:159], a[204:207], v[232:235], v[156:159]
    ds_write_b64 v252, v[206:207] offset:0
    v_mfma_f32_16x16x32_bf16 v[160:163], a[208:211], v[232:235], v[160:163]
    v_mfma_f32_16x16x32_bf16 v[160:163], a[196:199], v[228:231], v[160:163]
    buffer_store_dwordx4 a[32:35], v254, s[12:15], s44 offen sc1
    s_add_u32 s44, s40, 9216
    v_mfma_f32_16x16x32_bf16 v[164:167], a[200:203], v[228:231], v[164:167]
    ds_read_b128 v[228:231], v253 offset:30176
    v_mfma_f32_16x16x32_bf16 v[164:167], a[212:215], v[232:235], v[164:167]
    ds_write_b64 v252, v[212:213] offset:2080
    v_mfma_f32_16x16x32_bf16 v[144:147], a[216:219], v[232:235], v[144:147]
    v_mfma_f32_16x16x32_bf16 v[148:151], a[220:223], v[232:235], v[148:151]
    ds_write_b64 v252, v[210:211] offset:4160
    v_mfma_f32_16x16x32_bf16 v[152:155], a[224:227], v[232:235], v[152:155]
    s_waitcnt lgkmcnt(4)
    v_mfma_f32_16x16x32_bf16 v[168:171], a[192:195], v[232:235], v[168:171]
    ds_write_b64 v252, v[204:205] offset:33280
    v_mfma_f32_16x16x32_bf16 v[168:171], a[204:207], v[236:239], v[168:171]
    v_mfma_f32_16x16x32_bf16 v[172:175], a[208:211], v[236:239], v[172:175]
    ds_write_b64 v252, v[214:215] offset:35360
    v_mfma_f32_16x16x32_bf16 v[172:175], a[196:199], v[232:235], v[172:175]
    v_mfma_f32_16x16x32_bf16 v[176:179], a[200:203], v[232:235], v[176:179]
    ds_read_b128 v[232:235], v253 offset:29904
    v_mfma_f32_16x16x32_bf16 v[176:179], a[212:215], v[236:239], v[176:179]
    buffer_store_dwordx4 a[36:39], v254, s[12:15], s44 offen sc1
    v_mfma_f32_16x16x32_bf16 v[156:159], a[216:219], v[236:239], v[156:159]
    ds_write_b64 v252, v[208:209] offset:6240
    v_mfma_f32_16x16x32_bf16 v[160:163], a[220:223], v[236:239], v[160:163]
    s_waitcnt lgkmcnt(6)
    v_mfma_f32_16x16x32_bf16 v[164:167], a[224:227], v[236:239], v[164:167]
    s_add_u32 s42, s32, 0
    v_mfma_f32_16x16x32_bf16 v[180:183], a[192:195], v[236:239], v[180:183]
    buffer_load_dwordx4 a[192:195], v254, s[8:11], s42 offen offset:0 sc1
    v_mfma_f32_16x16x32_bf16 v[184:187], a[196:199], v[236:239], v[184:187]
    s_waitcnt lgkmcnt(0)
    v_mfma_f32_16x16x32_bf16 v[188:191], a[200:203], v[236:239], v[188:191]
    s_barrier
    v_mfma_f32_16x16x32_bf16 v[180:183], a[204:207], v[228:231], v[180:183]
    ds_read_b128 v[236:239], v253 offset:32240
    s_add_u32 s44, s40, 10240
    v_mfma_f32_16x16x32_bf16 v[184:187], a[208:211], v[228:231], v[184:187]
    buffer_load_dwordx4 a[196:199], v254, s[8:11], s42 offen offset:1024 sc1
    v_mfma_f32_16x16x32_bf16 v[188:191], a[212:215], v[228:231], v[188:191]
    v_mfma_f32_16x16x32_bf16 v[168:171], a[216:219], v[228:231], v[168:171]
    v_mfma_f32_16x16x32_bf16 v[172:175], a[220:223], v[228:231], v[172:175]
    buffer_load_dwordx4 a[200:203], v254, s[8:11], s42 offen offset:2048 sc1
    v_mfma_f32_16x16x32_bf16 v[176:179], a[224:227], v[228:231], v[176:179]
    ds_read_b128 v[228:231], v253 offset:31968
    v_mfma_f32_16x16x32_bf16 v[180:183], a[216:219], v[232:235], v[180:183]
    s_add_u32 s42, s32, 3072
    v_mfma_f32_16x16x32_bf16 v[184:187], a[220:223], v[232:235], v[184:187]
    buffer_load_dwordx4 a[204:207], v254, s[8:11], s42 offen offset:0 sc1
    v_mfma_f32_16x16x32_bf16 v[188:191], a[224:227], v[232:235], v[188:191]
    ds_read_b128 v[232:235], v253 offset:31712
    s_waitcnt vmcnt(20)
    s_waitcnt lgkmcnt(2)
sub35:
    v_mfma_f32_16x16x32_bf16 v[96:99], a[228:231], v[236:239], v[96:99]
    v_mfma_f32_16x16x32_bf16 v[100:103], a[232:235], v[236:239], v[100:103]
    s_waitcnt vmcnt(17) lgkmcnt(1)
    v_mfma_f32_16x16x32_bf16 v[104:107], a[236:239], v[236:239], v[104:107]
    ds_read_b128 v[236:239], v253 offset:31456
    v_mfma_f32_16x16x32_bf16 v[96:99], a[240:243], v[228:231], v[96:99]
    buffer_load_dwordx4 a[208:211], v254, s[8:11], s42 offen offset:1024 sc1
    v_mfma_f32_16x16x32_bf16 v[100:103], a[244:247], v[228:231], v[100:103]
    v_mfma_f32_16x16x32_bf16 v[104:107], a[248:251], v[228:231], v[104:107]
    v_mfma_f32_16x16x32_bf16 v[108:111], a[228:231], v[228:231], v[108:111]
    s_waitcnt lgkmcnt(1)
    v_mfma_f32_16x16x32_bf16 v[108:111], a[240:243], v[232:235], v[108:111]
    buffer_load_dwordx4 a[212:215], v254, s[8:11], s42 offen offset:2048 sc1
    v_mfma_f32_16x16x32_bf16 v[112:115], a[244:247], v[232:235], v[112:115]
    v_mfma_f32_16x16x32_bf16 v[112:115], a[232:235], v[228:231], v[112:115]
    s_add_u32 s42, s32, 6144
    v_mfma_f32_16x16x32_bf16 v[116:119], a[236:239], v[228:231], v[116:119]
    ds_read_b128 v[228:231], v253 offset:31200
    v_mfma_f32_16x16x32_bf16 v[116:119], a[248:251], v[232:235], v[116:119]
    buffer_load_dwordx4 a[216:219], v254, s[8:11], s42 offen offset:0 sc1
    s_waitcnt vmcnt(17)
    v_mfma_f32_16x16x32_bf16 v[96:99], a[252:255], v[232:235], v[96:99]
    v_mfma_f32_16x16x32_bf16 v[100:103], v[240:243], v[232:235], v[100:103]
    v_mfma_f32_16x16x32_bf16 v[104:107], v[244:247], v[232:235], v[104:107]
    s_waitcnt lgkmcnt(1)
    v_mfma_f32_16x16x32_bf16 v[120:123], a[228:231], v[232:235], v[120:123]
    buffer_load_dwordx4 a[220:223], v254, s[8:11], s42 offen offset:1024 sc1
    v_mfma_f32_16x16x32_bf16 v[120:123], a[240:243], v[236:239], v[120:123]
    v_mfma_f32_16x16x32_bf16 v[124:127], a[244:247], v[236:239], v[124:127]
    v_mfma_f32_16x16x32_bf16 v[124:127], a[232:235], v[232:235], v[124:127]
    buffer_load_dwordx4 a[224:227], v254, s[8:11], s42 offen offset:2048 sc1
    v_mfma_f32_16x16x32_bf16 v[128:131], a[236:239], v[232:235], v[128:131]
    ds_read_b128 v[232:235], v253 offset:33024
    v_and_b32 v215, 0x7fff, v255
    v_mfma_f32_16x16x32_bf16 v[128:131], a[248:251], v[236:239], v[128:131]
    v_cvt_pk_bf16_f32 v104, v104, v105
    v_cvt_pk_bf16_f32 v105, v106, v107
    v_mfma_f32_16x16x32_bf16 v[108:111], a[252:255], v[236:239], v[108:111]
    buffer_load_dwordx2 v[204:205], v215, s[4:7], s16 offen offset:448
    v_mfma_f32_16x16x32_bf16 v[112:115], v[240:243], v[236:239], v[112:115]
    ds_write_b64 v5, v[104:105] offset:16704
    v_mfma_f32_16x16x32_bf16 v[116:119], v[244:247], v[236:239], v[116:119]
    s_waitcnt lgkmcnt(2)
    v_cvt_pk_bf16_f32 v96, v96, v97
    v_cvt_pk_bf16_f32 v97, v98, v99
    v_mfma_f32_16x16x32_bf16 v[132:135], a[228:231], v[236:239], v[132:135]
    buffer_load_dwordx2 v[206:207], v215, s[4:7], s17 offen offset:448
    v_mfma_f32_16x16x32_bf16 v[132:135], a[240:243], v[228:231], v[132:135]
pad13:
    s_cbranch_vccnz warm_ret
    v_cvt_pk_bf16_f32 v98, v100, v101
    v_cvt_pk_bf16_f32 v99, v102, v103
    v_mfma_f32_16x16x32_bf16 v[136:139], a[244:247], v[228:231], v[136:139]
    ds_write_b128 v4, v[96:99] offset:16640
    v_mfma_f32_16x16x32_bf16 v[136:139], a[232:235], v[236:239], v[136:139]
    buffer_load_dwordx2 v[208:209], v215, s[4:7], s18 offen offset:448
    v_mfma_f32_16x16x32_bf16 v[140:143], a[236:239], v[236:239], v[140:143]
    ds_read_b128 v[236:239], v253 offset:32768
    v_mfma_f32_16x16x32_bf16 v[140:143], a[248:251], v[228:231], v[140:143]
    v_cvt_pk_bf16_f32 v116, v116, v117
    v_cvt_pk_bf16_f32 v117, v118, v119
    v_mfma_f32_16x16x32_bf16 v[120:123], a[252:255], v[228:231], v[120:123]
    buffer_load_dwordx2 v[210:211], v215, s[4:7], s19 offen offset:448
    v_mfma_f32_16x16x32_bf16 v[124:127], v[240:243], v[228:231], v[124:127]
    ds_write_b64 v5, v[116:117] offset:17088
    v_mfma_f32_16x16x32_bf16 v[128:131], v[244:247], v[228:231], v[128:131]
    s_waitcnt lgkmcnt(4)
    v_cvt_pk_bf16_f32 v108, v108, v109
    v_cvt_pk_bf16_f32 v109, v110, v111
    v_mfma_f32_16x16x32_bf16 v[144:147], a[228:231], v[228:231], v[144:147]
    buffer_load_dwordx2 v[212:213], v215, s[4:7], s20 offen offset:448
    v_mfma_f32_16x16x32_bf16 v[144:147], a[240:243], v[232:235], v[144:147]
    v_cvt_pk_bf16_f32 v110, v112, v113
    v_cvt_pk_bf16_f32 v111, v114, v115
    v_mfma_f32_16x16x32_bf16 v[148:151], a[244:247], v[232:235], v[148:151]
    ds_write_b128 v4, v[108:111] offset:17024
    v_mfma_f32_16x16x32_bf16 v[148:151], a[232:235], v[228:231], v[148:151]
    buffer_load_dwordx2 v[214:215], v215, s[4:7], s21 offen offset:448
    v_mfma_f32_16x16x32_bf16 v[152:155], a[236:239], v[228:231], v[152:155]
    ds_read_b128 v[228:231], v253 offset:32512
    v_mfma_f32_16x16x32_bf16 v[152:155], a[248:251], v[232:235], v[152:155]
    v_cvt_pk_bf16_f32 v128, v128, v129
    v_cvt_pk_bf16_f32 v129, v130, v131
    v_mfma_f32_16x16x32_bf16 v[132:135], a[252:255], v[232:235], v[132:135]
    buffer_store_dwordx4 a[40:43], v254, s[12:15], s44 offen sc1
    s_add_u32 s44, s40, 11264
    v_mfma_f32_16x16x32_bf16 v[136:139], v[240:243], v[232:235], v[136:139]
    ds_write_b64 v5, v[128:129] offset:17472
    v_mfma_f32_16x16x32_bf16 v[140:143], v[244:247], v[232:235], v[140:143]
    s_waitcnt lgkmcnt(4)
    v_cvt_pk_bf16_f32 v120, v120, v121
    v_cvt_pk_bf16_f32 v121, v122, v123
    v_mfma_f32_16x16x32_bf16 v[156:159], a[228:231], v[232:235], v[156:159]
    buffer_store_dwordx4 a[44:47], v254, s[12:15], s44 offen sc1
    v_cvt_pk_bf16_f32 v122, v124, v125
    v_cvt_pk_bf16_f32 v123, v126, v127
    v_mfma_f32_16x16x32_bf16 v[156:159], a[240:243], v[236:239], v[156:159]
    ds_write_b128 v4, v[120:123] offset:17408
    v_mfma_f32_16x16x32_bf16 v[160:163], a[244:247], v[236:239], v[160:163]
    v_mfma_f32_16x16x32_bf16 v[160:163], a[232:235], v[232:235], v[160:163]
    v_mfma_f32_16x16x32_bf16 v[164:167], a[236:239], v[232:235], v[164:167]
    ds_read_b128 v[232:235], v253 offset:32256
    v_mfma_f32_16x16x32_bf16 v[164:167], a[248:251], v[236:239], v[164:167]
    v_cvt_pk_bf16_f32 v140, v140, v141
    v_cvt_pk_bf16_f32 v141, v142, v143
    v_mfma_f32_16x16x32_bf16 v[144:147], a[252:255], v[236:239], v[144:147]
    ds_write_b64 v5, v[140:141] offset:17856
    v_mfma_f32_16x16x32_bf16 v[148:151], v[240:243], v[236:239], v[148:151]
    v_cvt_pk_bf16_f32 v132, v132, v133
    v_cvt_pk_bf16_f32 v133, v134, v135
    v_mfma_f32_16x16x32_bf16 v[152:155], v[244:247], v[236:239], v[152:155]
    s_waitcnt lgkmcnt(4)
    v_cvt_pk_bf16_f32 v134, v136, v137
    v_cvt_pk_bf16_f32 v135, v138, v139
    v_mfma_f32_16x16x32_bf16 v[168:171], a[228:231], v[236:239], v[168:171]
    ds_write_b128 v4, v[132:135] offset:17792
    v_mfma_f32_16x16x32_bf16 v[168:171], a[240:243], v[228:231], v[168:171]
    v_mfma_f32_16x16x32_bf16 v[172:175], a[244:247], v[228:231], v[172:175]
    v_mfma_f32_16x16x32_bf16 v[172:175], a[232:235], v[236:239], v[172:175]
    v_mfma_f32_16x16x32_bf16 v[176:179], a[236:239], v[236:239], v[176:179]
    ds_read_b128 v[236:239], v253 offset:31984
    v_mfma_f32_16x16x32_bf16 v[176:179], a[248:251], v[228:231], v[176:179]
    v_cvt_pk_bf16_f32 v152, v152, v153
    v_cvt_pk_bf16_f32 v153, v154, v155
    v_mfma_f32_16x16x32_bf16 v[156:159], a[252:255], v[228:231], v[156:159]
    ds_write_b64 v5, v[152:153] offset:18240
    v_mfma_f32_16x16x32_bf16 v[160:163], v[240:243], v[228:231], v[160:163]
    v_cvt_pk_bf16_f32 v144, v144, v145
    v_cvt_pk_bf16_f32 v145, v146, v147
    v_mfma_f32_16x16x32_bf16 v[164:167], v[244:247], v[228:231], v[164:167]
    s_add_u32 s42, s32, 36864
    v_cvt_pk_bf16_f32 v146, v148, v149
    v_cvt_pk_bf16_f32 v147, v150, v151
    v_mfma_f32_16x16x32_bf16 v[180:183], a[228:231], v[228:231], v[180:183]
    buffer_load_dwordx4 a[228:231], v254, s[8:11], s42 offen offset:0 sc1
    v_mfma_f32_16x16x32_bf16 v[184:187], a[232:235], v[228:231], v[184:187]
    ds_write_b128 v4, v[144:147] offset:18176
    v_mfma_f32_16x16x32_bf16 v[188:191], a[236:239], v[228:231], v[188:191]
    s_waitcnt lgkmcnt(5)
    v_mfma_f32_16x16x32_bf16 v[180:183], a[240:243], v[232:235], v[180:183]
    ds_read_b128 v[228:231], v253 offset:1040
    v_mfma_f32_16x16x32_bf16 v[184:187], a[244:247], v[232:235], v[184:187]
    buffer_load_dwordx4 a[232:235], v254, s[8:11], s42 offen offset:1024 sc1
    v_mfma_f32_16x16x32_bf16 v[188:191], a[248:251], v[232:235], v[188:191]
    v_mfma_f32_16x16x32_bf16 v[168:171], a[252:255], v[232:235], v[168:171]
    s_waitcnt lgkmcnt(3)
    v_mfma_f32_16x16x32_bf16 v[172:175], v[240:243], v[232:235], v[172:175]
    buffer_load_dwordx4 a[236:239], v254, s[8:11], s42 offen offset:2048 sc1
    v_mfma_f32_16x16x32_bf16 v[176:179], v[244:247], v[232:235], v[176:179]
    ds_read_b128 v[232:235], v253 offset:768
    v_mfma_f32_16x16x32_bf16 v[180:183], a[252:255], v[236:239], v[180:183]
    s_add_u32 s42, s32, 39936
    v_mfma_f32_16x16x32_bf16 v[184:187], v[240:243], v[236:239], v[184:187]
    buffer_load_dwordx4 a[240:243], v254, s[8:11], s42 offen offset:0 sc1
    v_mfma_f32_16x16x32_bf16 v[188:191], v[244:247], v[236:239], v[188:191]
    ds_read_b128 v[236:239], v253 offset:512
    s_waitcnt vmcnt(18)
    s_waitcnt lgkmcnt(2)
    s_add_u32 s41, s40, 589824
    s_add_u32 s40, s40, 6291456
    s_mov_b32 s33, 2130706432
    s_mov_b32 s48, 2130706432
    s_mov_b32 s38, 2130706432
    s_add_u32 s39, s39, 1
    s_cmp_lt_u32 s39, 2
    s_cbranch_scc1 blk_loop
    v_cvt_pk_bf16_f32 v164, v164, v165
    v_cvt_pk_bf16_f32 v165, v166, v167
    ds_write_b64 v5, v[164:165] offset:18624
    v_cvt_pk_bf16_f32 v156, v156, v157
    v_cvt_pk_bf16_f32 v157, v158, v159
    v_cvt_pk_bf16_f32 v158, v160, v161
    v_cvt_pk_bf16_f32 v159, v162, v163
    ds_write_b128 v4, v[156:159] offset:18560
    v_cvt_pk_bf16_f32 v176, v176, v177
    v_cvt_pk_bf16_f32 v177, v178, v179
    ds_write_b64 v5, v[176:177] offset:19008
    v_cvt_pk_bf16_f32 v168, v168, v169
    v_cvt_pk_bf16_f32 v169, v170, v171
    v_cvt_pk_bf16_f32 v170, v172, v173
    v_cvt_pk_bf16_f32 v171, v174, v175
    ds_write_b128 v4, v[168:171] offset:18944
    v_cvt_pk_bf16_f32 v188, v188, v189
    v_cvt_pk_bf16_f32 v189, v190, v191
    ds_write_b64 v5, v[188:189] offset:19392
    v_cvt_pk_bf16_f32 v180, v180, v181
    v_cvt_pk_bf16_f32 v181, v182, v183
    v_cvt_pk_bf16_f32 v182, v184, v185
    v_cvt_pk_bf16_f32 v183, v186, v187
    ds_write_b128 v4, v[180:183] offset:19328
    s_waitcnt lgkmcnt(0)
    s_barrier
    ds_read_b128 v[144:147], v6 offset:16640
    ds_read_b128 v[148:151], v6 offset:17664
    ds_read_b128 v[152:155], v6 offset:18688
    ds_read_b128 v[156:159], v6 offset:19744
    ds_read_b128 v[160:163], v6 offset:20768
    ds_read_b128 v[164:167], v6 offset:21792
    ds_read_b128 v[168:171], v6 offset:22848
    ds_read_b128 v[172:175], v6 offset:23872
    ds_read_b128 v[176:179], v6 offset:24896
    ds_read_b128 v[180:183], v6 offset:25952
    ds_read_b128 v[184:187], v6 offset:26976
    ds_read_b128 v[188:191], v6 offset:28000
    s_add_u32 s44, s41, 0
    s_waitcnt lgkmcnt(11)
    buffer_store_dwordx4 v[144:147], v254, s[12:15], s44 offen sc1
    s_add_u32 s44, s41, 1024
    s_waitcnt lgkmcnt(10)
    buffer_store_dwordx4 v[148:151], v254, s[12:15], s44 offen sc1
    s_add_u32 s44, s41, 2048
    s_waitcnt lgkmcnt(9)
    buffer_store_dwordx4 v[152:155], v254, s[12:15], s44 offen sc1
    s_add_u32 s44, s41, 3072
    s_waitcnt lgkmcnt(8)
    buffer_store_dwordx4 v[156:159], v254, s[12:15], s44 offen sc1
    s_add_u32 s44, s41, 4096
    s_waitcnt lgkmcnt(7)
    buffer_store_dwordx4 v[160:163], v254, s[12:15], s44 offen sc1
    s_add_u32 s44, s41, 5120
    s_waitcnt lgkmcnt(6)
    buffer_store_dwordx4 v[164:167], v254, s[12:15], s44 offen sc1
    s_add_u32 s44, s41, 6144
    s_waitcnt lgkmcnt(5)
    buffer_store_dwordx4 v[168:171], v254, s[12:15], s44 offen sc1
    s_add_u32 s44, s41, 7168
    s_waitcnt lgkmcnt(4)
    buffer_store_dwordx4 v[172:175], v254, s[12:15], s44 offen sc1
    s_add_u32 s44, s41, 8192
    s_waitcnt lgkmcnt(3)
    buffer_store_dwordx4 v[176:179], v254, s[12:15], s44 offen sc1
    s_add_u32 s44, s41, 9216
    s_waitcnt lgkmcnt(2)
    buffer_store_dwordx4 v[180:183], v254, s[12:15], s44 offen sc1
    s_add_u32 s44, s41, 10240
    s_waitcnt lgkmcnt(1)
    buffer_store_dwordx4 v[184:187], v254, s[12:15], s44 offen sc1
    s_add_u32 s44, s41, 11264
    s_waitcnt lgkmcnt(0)
    buffer_store_dwordx4 v[188:191], v254, s[12:15], s44 offen sc1
main_done:
    s_endpgm
code_end:
wt_loop:
    s_mul_i32 s73, s70, 43691
    s_lshr_b32 s73, s73, 17
    s_mul_i32 s74, s73, 3
    s_sub_u32 s74, s70, s74
    s_mul_i32 s75, s73, 43691
    s_lshr_b32 s75, s75, 17
    s_mul_i32 s76, s75, 3
    s_sub_u32 s76, s73, s76
    v_and_b32 v101, 15, v2
    v_lshrrev_b32 v102, 4, v2
    v_and_b32 v103, 12, v101
    s_lshl_b32 s78, s74, 2
    s_cmp_lt_u32 s74, 2
    s_cselect_b32 s77, 1, 0
    s_cselect_b32 s78, s78, 32
    v_mul_u32_u24 v103, s77, v103
    v_add_u32 v103, v103, v101
    v_add_u32 v103, s78, v103
    v_lshl_add_u32 v103, v103, 1, s52
    v_mul_u32_u24 v104, 3072, v102
    v_add_u32 v103, v103, v104
    s_mul_i32 s79, s76, 73728
    s_mul_i32 s80, s75, 12288
    s_add_u32 s79, s79, s80
    s_add_u32 s80, s79, 221184
    s_add_u32 s81, s79, 442368
    buffer_load_ushort v110, v103, s[60:63], s79 offen offset:0
    buffer_load_ushort v111, v103, s[60:63], s79 offen offset:384
    buffer_load_ushort v112, v103, s[60:63], s79 offen offset:768
    buffer_load_ushort v113, v103, s[60:63], s79 offen offset:1152
    buffer_load_ushort v114, v103, s[60:63], s79 offen offset:1536
    buffer_load_ushort v115, v103, s[60:63], s79 offen offset:1920
    buffer_load_ushort v116, v103, s[60:63], s79 offen offset:2304
    buffer_load_ushort v117, v103, s[60:63], s79 offen offset:2688
    buffer_load_ushort v118, v103, s[60:63], s80 offen offset:0
    buffer_load_ushort v119, v103, s[60:63], s80 offen offset:384
    buffer_load_ushort v120, v103, s[60:63], s80 offen offset:768
    buffer_load_ushort v121, v103, s[60:63], s80 offen offset:1152
    buffer_load_ushort v122, v103, s[60:63], s80 offen offset:1536
    buffer_load_ushort v123, v103, s[60:63], s80 offen offset:1920
    buffer_load_ushort v124, v103, s[60:63], s80 offen offset:2304
    buffer_load_ushort v125, v103, s[60:63], s80 offen offset:2688
    buffer_load_ushort v126, v103, s[60:63], s81 offen offset:0
    buffer_load_ushort v127, v103, s[60:63], s81 offen offset:384
    buffer_load_ushort v128, v103, s[60:63], s81 offen offset:768
    buffer_load_ushort v129, v103, s[60:63], s81 offen offset:1152
    buffer_load_ushort v130, v103, s[60:63], s81 offen offset:1536
    buffer_load_ushort v131, v103, s[60:63], s81 offen offset:1920
    buffer_load_ushort v132, v103, s[60:63], s81 offen offset:2304
    buffer_load_ushort v133, v103, s[60:63], s81 offen offset:2688
    s_mul_i32 s82, s76, 3072
    s_lshl_b32 s83, s74, 10
    s_add_u32 s82, s82, s83
    s_mul_i32 s83, s75, 36864
    s_lshl_b32 s84, s83, 2
    s_add_u32 s83, s83, s82
    s_add_u32 s84, s84, s82
    s_waitcnt vmcnt(0)
    v_lshlrev_b32 v110, 16, v110
    v_lshlrev_b32 v111, 16, v111
    v_lshlrev_b32 v112, 16, v112
    v_lshlrev_b32 v113, 16, v113
    v_lshlrev_b32 v114, 16, v114
    v_lshlrev_b32 v115, 16, v115
    v_lshlrev_b32 v116, 16, v116
    v_lshlrev_b32 v117, 16, v117
    v_lshlrev_b32 v118, 16, v118
    v_lshlrev_b32 v119, 16, v119
    v_lshlrev_b32 v120, 16, v120
    v_lshlrev_b32 v121, 16, v121
    v_lshlrev_b32 v122, 16, v122
    v_lshlrev_b32 v123, 16, v123
    v_lshlrev_b32 v124, 16, v124
    v_lshlrev_b32 v125, 16, v125
    v_lshlrev_b32 v126, 16, v126
    v_lshlrev_b32 v127, 16, v127
    v_lshlrev_b32 v128, 16, v128
    v_lshlrev_b32 v129, 16, v129
    v_lshlrev_b32 v130, 16, v130
    v_lshlrev_b32 v131, 16, v131
    v_lshlrev_b32 v132, 16, v132
    v_lshlrev_b32 v133, 16, v133
    v_mul_f32 v136, 0xbf170c51, v110
    v_fmac_f32 v136, 0xbe6c033f, v126
    v_fmamk_f32 v144, v118, 0xbebccf65, v136
    v_fmac_f32 v136, 0x3ebccf65, v118
    v_mul_f32 v137, 0xbf170c51, v111
    v_fmac_f32 v137, 0xbe6c033f, v127
    v_fmamk_f32 v145, v119, 0xbebccf65, v137
    v_fmac_f32 v137, 0x3ebccf65, v119
    v_mul_f32 v138, 0xbf170c51, v112
    v_fmac_f32 v138, 0xbe6c033f, v128
    v_fmamk_f32 v146, v120, 0xbebccf65, v138
    v_fmac_f32 v138, 0x3ebccf65, v120
    v_mul_f32 v139, 0xbf170c51, v113
    v_fmac_f32 v139, 0xbe6c033f, v129
    v_fmamk_f32 v147, v121, 0xbebccf65, v139
    v_fmac_f32 v139, 0x3ebccf65, v121
    v_mul_f32 v140, 0xbf170c51, v114
    v_fmac_f32 v140, 0xbe6c033f, v130
    v_fmamk_f32 v148, v122, 0xbebccf65, v140
    v_fmac_f32 v140, 0x3ebccf65, v122
    v_mul_f32 v141, 0xbf170c51, v115
    v_fmac_f32 v141, 0xbe6c033f, v131
    v_fmamk_f32 v149, v123, 0xbebccf65, v141
    v_fmac_f32 v141, 0x3ebccf65, v123
    v_mul_f32 v142, 0xbf170c51, v116
    v_fmac_f32 v142, 0xbe6c033f, v132
    v_fmamk_f32 v150, v124, 0xbebccf65, v142
    v_fmac_f32 v142, 0x3ebccf65, v124
    v_mul_f32 v143, 0xbf170c51, v117
    v_fmac_f32 v143, 0xbe6c033f, v133
    v_fmamk_f32 v151, v125, 0xbebccf65, v143
    v_fmac_f32 v143, 0x3ebccf65, v125
    v_cvt_pk_bf16_f32 v156, v144, v145
    v_cvt_pk_bf16_f32 v157, v146, v147
    v_cvt_pk_bf16_f32 v158, v148, v149
    v_cvt_pk_bf16_f32 v159, v150, v151
    s_add_u32 s85, s84, 0
    buffer_store_dwordx4 v[156:159], v254, s[8:11], s85 offen sc1
    v_cvt_pk_bf16_f32 v160, v136, v137
    v_cvt_pk_bf16_f32 v161, v138, v139
    v_cvt_pk_bf16_f32 v162, v140, v141
    v_cvt_pk_bf16_f32 v163, v142, v143
    s_add_u32 s85, s84, 36864
    buffer_store_dwordx4 v[160:163], v254, s[8:11], s85 offen sc1
    v_mul_f32 v136, 0x3e6c033f, v110
    v_fmac_f32 v136, 0x3f170c51, v126
    v_fmamk_f32 v144, v118, 0x3ebccf65, v136
    v_fmac_f32 v136, 0xbebccf65, v118
    v_mul_f32 v137, 0x3e6c033f, v111
    v_fmac_f32 v137, 0x3f170c51, v127
    v_fmamk_f32 v145, v119, 0x3ebccf65, v137
    v_fmac_f32 v137, 0xbebccf65, v119
    v_mul_f32 v138, 0x3e6c033f, v112
    v_fmac_f32 v138, 0x3f170c51, v128
    v_fmamk_f32 v146, v120, 0x3ebccf65, v138
    v_fmac_f32 v138, 0xbebccf65, v120
    v_mul_f32 v139, 0x3e6c033f, v113
    v_fmac_f32 v139, 0x3f170c51, v129
    v_fmamk_f32 v147, v121, 0x3ebccf65, v139
    v_fmac_f32 v139, 0xbebccf65, v121
    v_mul_f32 v140, 0x3e6c033f, v114
    v_fmac_f32 v140, 0x3f170c51, v130
    v_fmamk_f32 v148, v122, 0x3ebccf65, v140
    v_fmac_f32 v140, 0xbebccf65, v122
    v_mul_f32 v141, 0x3e6c033f, v115
    v_fmac_f32 v141, 0x3f170c51, v131
    v_fmamk_f32 v149, v123, 0x3ebccf65, v141
    v_fmac_f32 v141, 0xbebccf65, v123
    v_mul_f32 v142, 0x3e6c033f, v116
    v_fmac_f32 v142, 0x3f170c51, v132
    v_fmamk_f32 v150, v124, 0x3ebccf65, v142
    v_fmac_f32 v142, 0xbebccf65, v124
    v_mul_f32 v143, 0x3e6c033f, v117
    v_fmac_f32 v143, 0x3f170c51, v133
    v_fmamk_f32 v151, v125, 0x3ebccf65, v143
    v_fmac_f32 v143, 0xbebccf65, v125
    v_cvt_pk_bf16_f32 v164, v144, v145
    v_cvt_pk_bf16_f32 v165, v146, v147
    v_cvt_pk_bf16_f32 v166, v148, v149
    v_cvt_pk_bf16_f32 v167, v150, v151
    s_add_u32 s85, s84, 73728
    buffer_store_dwordx4 v[164:167], v254, s[8:11], s85 offen sc1
    v_cvt_pk_bf16_f32 v168, v136, v137
    v_cvt_pk_bf16_f32 v169, v138, v139
    v_cvt_pk_bf16_f32 v170, v140, v141
    v_cvt_pk_bf16_f32 v171, v142, v143
    s_add_u32 s85, s84, 110592
    buffer_store_dwordx4 v[168:171], v254, s[8:11], s85 offen sc1
    v_cvt_pk_bf16_f32 v152, v110, v111
    v_cvt_pk_bf16_f32 v153, v112, v113
    v_cvt_pk_bf16_f32 v154, v114, v115
    v_cvt_pk_bf16_f32 v155, v116, v117
    s_add_u32 s85, s83, 884736
    buffer_store_dwordx4 v[152:155], v254, s[8:11], s85 offen sc1
    v_cvt_pk_bf16_f32 v172, v126, v127
    v_cvt_pk_bf16_f32 v173, v128, v129
    v_cvt_pk_bf16_f32 v174, v130, v131
    v_cvt_pk_bf16_f32 v175, v132, v133
    s_add_u32 s85, s83, 1105920
    buffer_store_dwordx4 v[172:175], v254, s[8:11], s85 offen sc1
    s_add_u32 s70, s70, 1
    s_cmp_lt_u32 s70, 54
    s_cbranch_scc1 wt_loop
    s_waitcnt vmcnt(0)
    s_branch u_ready
.section .rodata,"a"
.p2align 6
.amdhsa_kernel standalone__winograd__vision_kernel
  .amdhsa_next_free_vgpr 512
  .amdhsa_next_free_sgpr 102
  .amdhsa_accum_offset 256
  .amdhsa_group_segment_fixed_size 0
  .amdhsa_kernarg_size 40
  .amdhsa_user_sgpr_count 2
  .amdhsa_user_sgpr_kernarg_segment_ptr 1
  .amdhsa_system_sgpr_workgroup_id_x 1
  .amdhsa_float_denorm_mode_32 3
.end_amdhsa_kernel
```

```asm
; @launch grid=(256,1,1) block=(256,1,1) lds=163840
.amdgcn_target "amdgcn-amd-amdhsa--gfx950"
.text
.globl standalone__winograd__vision_kernel
.p2align 8
.type standalone__winograd__vision_kernel,@function
standalone__winograd__vision_kernel:
    s_cmp_ge_u32 s2, 256
    s_cbranch_scc1 main_done
    s_load_dwordx4 s[4:7], s[0:1], 0
    s_load_dwordx4 s[12:15], s[0:1], 16
    s_load_dwordx2 s[8:9], s[0:1], 32
    s_getpc_b64 s[92:93]
pcref:
    v_and_b32 v70, 3, v0
    v_lshrrev_b32 v71, 6, v0
    v_lshl_add_u32 v70, v70, 7, v71
    s_lshr_b32 s94, s2, 3
    s_lshl_b32 s94, s94, 2
    v_add_lshl_u32 v70, v70, s94, 7
    v_min_u32 v70, code_end-pcref-4, v70
    v_add_co_u32 v72, vcc, s92, v70
    v_mov_b32 v73, s93
    s_nop 0
    v_addc_co_u32 v73, vcc, 0, v73, vcc
    global_load_dword v76, v[72:73], off
    v_lshrrev_b32 v1, 6, v0
    v_and_b32 v2, 63, v0
    v_readfirstlane_b32 s38, v1
    v_lshlrev_b32 v254, 4, v2
    v_mov_b32 v98, 0
    v_lshrrev_b32 v3, 3, v2
    v_and_b32 v4, 7, v2
    v_mul_u32_u24 v5, 3072, v3
    v_lshl_add_u32 v255, v4, 3, v5
    s_lshr_b32 s44, s2, 3
    s_and_b32 s48, s44, 3
    s_lshr_b32 s44, s44, 2
    s_and_b32 s49, s2, 7
    s_lshl_b32 s49, s49, 4
    s_add_u32 s49, s49, s44
    s_and_b32 s90, s38, 1
    s_lshr_b32 s91, s38, 1
    s_mul_i32 s50, s90, 24576
    s_mul_i32 s45, s91, 1536
    s_add_u32 s50, s50, s45
    s_mul_i32 s101, s38, 196608
    s_sub_u32 s101, s101, s50
    s_mul_i32 s53, s48, 49152
    s_add_u32 s53, s53, s50
    s_mul_i32 s43, s49, 786432
    s_add_u32 s43, s43, s53
    s_cmp_ge_u32 s49, 128
    s_cselect_b32 s43, 2130706432, s43
    s_sub_u32 s16, s43, 196608
    s_cmp_eq_u32 s49, 0
    s_cselect_b32 s16, 2130706432, s16
    s_mov_b32 s17, s43
    s_add_u32 s18, s43, 196608
    s_add_u32 s19, s43, 393216
    s_add_u32 s20, s43, 589824
    s_add_u32 s21, s43, 786432
    s_add_u32 s100, s43, s101
    s_mul_i32 s52, s38, 96
    s_mul_i32 s44, s38, 9216
    s_mov_b32 s70, s2
    v_mov_b32 v80, v255
    s_mul_i32 s73, s70, 43691
    s_lshr_b32 s73, s73, 17
    s_mul_i32 s74, s73, 3
    s_sub_u32 s74, s70, s74
    s_mul_i32 s75, s73, 43691
    s_lshr_b32 s75, s75, 17
    s_mul_i32 s76, s75, 3
    s_sub_u32 s76, s73, s76
    v_and_b32 v101, 15, v2
    v_lshrrev_b32 v102, 4, v2
    v_and_b32 v103, 12, v101
    s_lshl_b32 s78, s74, 2
    s_cmp_lt_u32 s74, 2
    s_cselect_b32 s77, 1, 0
    s_cselect_b32 s78, s78, 32
    v_mul_u32_u24 v103, s77, v103
    v_add_u32 v103, v103, v101
    v_add_u32 v103, s78, v103
    v_lshl_add_u32 v103, v103, 1, s52
    v_mul_u32_u24 v104, 3072, v102
    v_add_u32 v103, v103, v104
    s_mul_i32 s79, s76, 73728
    s_mul_i32 s80, s75, 12288
    s_add_u32 s79, s79, s80
    s_add_u32 s80, s79, 221184
    s_add_u32 s81, s79, 442368
    s_waitcnt lgkmcnt(0)
    s_mov_b32 s60, s6
    s_and_b32 s61, s7, 0xffff
    s_mov_b32 s62, 663552
    s_mov_b32 s63, 0x20000
    s_and_b32 s5, s5, 0xffff
    s_mov_b32 s6, 100663296
    s_mov_b32 s7, 0x20000
    s_add_u32 s8, s8, s44
    s_addc_u32 s9, s9, 0
    s_and_b32 s9, s9, 0xffff
    s_mov_b32 s10, 1299456
    s_mov_b32 s11, 0x20000
    s_mov_b32 s64, s14
    s_and_b32 s65, s15, 0xffff
    s_mov_b32 s66, 256
    s_mov_b32 s67, 0x20000
    s_mov_b64 s[68:69], s[14:15]
    s_mov_b32 s10, 1331200
    s_mov_b32 s88, 1327104
    buffer_load_dword v78, v98, s[8:11], s88 offen
    buffer_load_dword v79, v98, s[64:67], 0 offen offset:128 sc1
    s_cmp_lt_u32 s2, 54
    s_cbranch_scc1 wt_path
    buffer_load_dwordx2 v[8:9], v80, s[4:7], s16 offen offset:0
    buffer_load_dwordx2 v[10:11], v80, s[4:7], s17 offen offset:0
    buffer_load_dwordx2 v[12:13], v80, s[4:7], s18 offen offset:0
    buffer_load_dwordx2 v[14:15], v80, s[4:7], s19 offen offset:0
    buffer_load_dwordx2 v[16:17], v80, s[4:7], s20 offen offset:0
    buffer_load_dwordx2 v[18:19], v80, s[4:7], s21 offen offset:0
    buffer_load_dwordx2 v[20:21], v80, s[4:7], s16 offen offset:384
    buffer_load_dwordx2 v[22:23], v80, s[4:7], s17 offen offset:384
    buffer_load_dwordx2 v[24:25], v80, s[4:7], s18 offen offset:384
    buffer_load_dwordx2 v[26:27], v80, s[4:7], s19 offen offset:384
    buffer_load_dwordx2 v[28:29], v80, s[4:7], s20 offen offset:384
    buffer_load_dwordx2 v[30:31], v80, s[4:7], s21 offen offset:384
    s_branch wt_join
wt_path:
    buffer_load_ushort v110, v103, s[60:63], s79 offen offset:0
    buffer_load_ushort v111, v103, s[60:63], s79 offen offset:384
    buffer_load_ushort v112, v103, s[60:63], s79 offen offset:768
    buffer_load_ushort v113, v103, s[60:63], s79 offen offset:1152
    buffer_load_ushort v114, v103, s[60:63], s79 offen offset:1536
    buffer_load_ushort v115, v103, s[60:63], s79 offen offset:1920
    buffer_load_ushort v116, v103, s[60:63], s79 offen offset:2304
    buffer_load_ushort v117, v103, s[60:63], s79 offen offset:2688
    buffer_load_ushort v118, v103, s[60:63], s80 offen offset:0
    buffer_load_ushort v119, v103, s[60:63], s80 offen offset:384
    buffer_load_ushort v120, v103, s[60:63], s80 offen offset:768
    buffer_load_ushort v121, v103, s[60:63], s80 offen offset:1152
    buffer_load_ushort v122, v103, s[60:63], s80 offen offset:1536
    buffer_load_ushort v123, v103, s[60:63], s80 offen offset:1920
    buffer_load_ushort v124, v103, s[60:63], s80 offen offset:2304
    buffer_load_ushort v125, v103, s[60:63], s80 offen offset:2688
    buffer_load_ushort v126, v103, s[60:63], s81 offen offset:0
    buffer_load_ushort v127, v103, s[60:63], s81 offen offset:384
    buffer_load_ushort v128, v103, s[60:63], s81 offen offset:768
    buffer_load_ushort v129, v103, s[60:63], s81 offen offset:1152
    buffer_load_ushort v130, v103, s[60:63], s81 offen offset:1536
    buffer_load_ushort v131, v103, s[60:63], s81 offen offset:1920
    buffer_load_ushort v132, v103, s[60:63], s81 offen offset:2304
    buffer_load_ushort v133, v103, s[60:63], s81 offen offset:2688
    s_mul_i32 s82, s76, 3072
    s_lshl_b32 s83, s74, 10
    s_add_u32 s82, s82, s83
    s_mul_i32 s83, s75, 36864
    s_lshl_b32 s84, s83, 2
    s_add_u32 s83, s83, s82
    s_add_u32 s84, s84, s82
    s_waitcnt vmcnt(0)
    v_lshlrev_b32 v110, 16, v110
    v_lshlrev_b32 v111, 16, v111
    v_lshlrev_b32 v112, 16, v112
    v_lshlrev_b32 v113, 16, v113
    v_lshlrev_b32 v114, 16, v114
    v_lshlrev_b32 v115, 16, v115
    v_lshlrev_b32 v116, 16, v116
    v_lshlrev_b32 v117, 16, v117
    v_lshlrev_b32 v118, 16, v118
    v_lshlrev_b32 v119, 16, v119
    v_lshlrev_b32 v120, 16, v120
    v_lshlrev_b32 v121, 16, v121
    v_lshlrev_b32 v122, 16, v122
    v_lshlrev_b32 v123, 16, v123
    v_lshlrev_b32 v124, 16, v124
    v_lshlrev_b32 v125, 16, v125
    v_lshlrev_b32 v126, 16, v126
    v_lshlrev_b32 v127, 16, v127
    v_lshlrev_b32 v128, 16, v128
    v_lshlrev_b32 v129, 16, v129
    v_lshlrev_b32 v130, 16, v130
    v_lshlrev_b32 v131, 16, v131
    v_lshlrev_b32 v132, 16, v132
    v_lshlrev_b32 v133, 16, v133
    v_mul_f32 v136, 0xbedba55c, v110
    v_fmac_f32 v136, 0xbe0afea5, v126
    v_fmamk_f32 v144, v118, 0xbe771a08, v136
    v_fmac_f32 v136, 0x3e771a08, v118
    v_mul_f32 v137, 0xbedba55c, v111
    v_fmac_f32 v137, 0xbe0afea5, v127
    v_fmamk_f32 v145, v119, 0xbe771a08, v137
    v_fmac_f32 v137, 0x3e771a08, v119
    v_mul_f32 v138, 0xbedba55c, v112
    v_fmac_f32 v138, 0xbe0afea5, v128
    v_fmamk_f32 v146, v120, 0xbe771a08, v138
    v_fmac_f32 v138, 0x3e771a08, v120
    v_mul_f32 v139, 0xbedba55c, v113
    v_fmac_f32 v139, 0xbe0afea5, v129
    v_fmamk_f32 v147, v121, 0xbe771a08, v139
    v_fmac_f32 v139, 0x3e771a08, v121
    v_mul_f32 v140, 0xbedba55c, v114
    v_fmac_f32 v140, 0xbe0afea5, v130
    v_fmamk_f32 v148, v122, 0xbe771a08, v140
    v_fmac_f32 v140, 0x3e771a08, v122
    v_mul_f32 v141, 0xbedba55c, v115
    v_fmac_f32 v141, 0xbe0afea5, v131
    v_fmamk_f32 v149, v123, 0xbe771a08, v141
    v_fmac_f32 v141, 0x3e771a08, v123
    v_mul_f32 v142, 0xbedba55c, v116
    v_fmac_f32 v142, 0xbe0afea5, v132
    v_fmamk_f32 v150, v124, 0xbe771a08, v142
    v_fmac_f32 v142, 0x3e771a08, v124
    v_mul_f32 v143, 0xbedba55c, v117
    v_fmac_f32 v143, 0xbe0afea5, v133
    v_fmamk_f32 v151, v125, 0xbe771a08, v143
    v_fmac_f32 v143, 0x3e771a08, v125
    v_cvt_pk_bf16_f32 v156, v144, v145
    v_cvt_pk_bf16_f32 v157, v146, v147
    v_cvt_pk_bf16_f32 v158, v148, v149
    v_cvt_pk_bf16_f32 v159, v150, v151
    s_add_u32 s85, s84, 0
    buffer_store_dwordx4 v[156:159], v254, s[8:11], s85 offen sc1
    v_cvt_pk_bf16_f32 v160, v136, v137
    v_cvt_pk_bf16_f32 v161, v138, v139
    v_cvt_pk_bf16_f32 v162, v140, v141
    v_cvt_pk_bf16_f32 v163, v142, v143
    s_add_u32 s85, s84, 36864
    buffer_store_dwordx4 v[160:163], v254, s[8:11], s85 offen sc1
    v_mul_f32 v136, 0x3e0afea5, v110
    v_fmac_f32 v136, 0x3f0afea5, v126
    v_fmamk_f32 v144, v118, 0x3e8afea5, v136
    v_fmac_f32 v136, 0xbe8afea5, v118
    v_mul_f32 v137, 0x3e0afea5, v111
    v_fmac_f32 v137, 0x3f0afea5, v127
    v_fmamk_f32 v145, v119, 0x3e8afea5, v137
    v_fmac_f32 v137, 0xbe8afea5, v119
    v_mul_f32 v138, 0x3e0afea5, v112
    v_fmac_f32 v138, 0x3f0afea5, v128
    v_fmamk_f32 v146, v120, 0x3e8afea5, v138
    v_fmac_f32 v138, 0xbe8afea5, v120
    v_mul_f32 v139, 0x3e0afea5, v113
    v_fmac_f32 v139, 0x3f0afea5, v129
    v_fmamk_f32 v147, v121, 0x3e8afea5, v139
    v_fmac_f32 v139, 0xbe8afea5, v121
    v_mul_f32 v140, 0x3e0afea5, v114
    v_fmac_f32 v140, 0x3f0afea5, v130
    v_fmamk_f32 v148, v122, 0x3e8afea5, v140
    v_fmac_f32 v140, 0xbe8afea5, v122
    v_mul_f32 v141, 0x3e0afea5, v115
    v_fmac_f32 v141, 0x3f0afea5, v131
    v_fmamk_f32 v149, v123, 0x3e8afea5, v141
    v_fmac_f32 v141, 0xbe8afea5, v123
    v_mul_f32 v142, 0x3e0afea5, v116
    v_fmac_f32 v142, 0x3f0afea5, v132
    v_fmamk_f32 v150, v124, 0x3e8afea5, v142
    v_fmac_f32 v142, 0xbe8afea5, v124
    v_mul_f32 v143, 0x3e0afea5, v117
    v_fmac_f32 v143, 0x3f0afea5, v133
    v_fmamk_f32 v151, v125, 0x3e8afea5, v143
    v_fmac_f32 v143, 0xbe8afea5, v125
    v_cvt_pk_bf16_f32 v164, v144, v145
    v_cvt_pk_bf16_f32 v165, v146, v147
    v_cvt_pk_bf16_f32 v166, v148, v149
    v_cvt_pk_bf16_f32 v167, v150, v151
    s_add_u32 s85, s84, 73728
    buffer_store_dwordx4 v[164:167], v254, s[8:11], s85 offen sc1
    v_cvt_pk_bf16_f32 v168, v136, v137
    v_cvt_pk_bf16_f32 v169, v138, v139
    v_cvt_pk_bf16_f32 v170, v140, v141
    v_cvt_pk_bf16_f32 v171, v142, v143
    s_add_u32 s85, s84, 110592
    buffer_store_dwordx4 v[168:171], v254, s[8:11], s85 offen sc1
    v_cvt_pk_bf16_f32 v152, v110, v111
    v_cvt_pk_bf16_f32 v153, v112, v113
    v_cvt_pk_bf16_f32 v154, v114, v115
    v_cvt_pk_bf16_f32 v155, v116, v117
    s_add_u32 s85, s83, 884736
    buffer_store_dwordx4 v[152:155], v254, s[8:11], s85 offen sc1
    v_cvt_pk_bf16_f32 v172, v126, v127
    v_cvt_pk_bf16_f32 v173, v128, v129
    v_cvt_pk_bf16_f32 v174, v130, v131
    v_cvt_pk_bf16_f32 v175, v132, v133
    s_add_u32 s85, s83, 1105920
    buffer_store_dwordx4 v[172:175], v254, s[8:11], s85 offen sc1
    buffer_load_dwordx2 v[8:9], v80, s[4:7], s16 offen offset:0
    buffer_load_dwordx2 v[10:11], v80, s[4:7], s17 offen offset:0
    buffer_load_dwordx2 v[12:13], v80, s[4:7], s18 offen offset:0
    buffer_load_dwordx2 v[14:15], v80, s[4:7], s19 offen offset:0
    buffer_load_dwordx2 v[16:17], v80, s[4:7], s20 offen offset:0
    buffer_load_dwordx2 v[18:19], v80, s[4:7], s21 offen offset:0
wt_join:
    s_and_b32 s13, s13, 0xffff
    s_mov_b32 s14, 100663296
    s_mov_b32 s15, 0x20000
    v_lshrrev_b32 v5, 4, v2
    v_mul_u32_u24 v6, 40704, v5
    v_lshrrev_b32 v5, 1, v5
    v_lshl_add_u32 v6, v5, 6, v6
    v_and_b32 v5, 0xf0, v254
    v_add_u32 v253, v6, v5
    v_lshrrev_b32 v6, 1, v4
    v_mul_u32_u24 v7, 40704, v6
    v_lshrrev_b32 v6, 1, v6
    v_lshl_add_u32 v7, v6, 6, v7
    v_and_b32 v6, 1, v2
    v_lshl_add_u32 v7, v6, 3, v7
    v_lshl_add_u32 v7, v3, 4, v7
    s_lshl_b32 s44, s90, 7
    s_mul_i32 s45, s91, 1056
    s_add_u32 s44, s44, s45
    v_add_u32 v7, s44, v7
    v_lshl_or_b32 v255, v7, 15, v255
    s_mul_i32 s51, s38, 40704
    s_lshl_b32 s45, s91, 6
    s_add_u32 s51, s51, s45
    s_lshl_b32 s45, s90, 4
    s_add_u32 s51, s51, s45
    s_mul_i32 s40, s49, 786432
    s_mul_i32 s45, s48, 49152
    s_add_u32 s40, s40, s45
    s_mul_i32 s45, s38, 12288
    s_add_u32 s40, s40, s45
    s_mov_b32 s41, 2130706432
    s_mov_b32 s39, 0
    s_lshl_b32 s45, s38, 4
    s_mov_b32 s46, 0xfff
    s_mov_b32 s47, 0
    s_lshl_b64 s[46:47], s[46:47], s45
    s_mov_b32 s58, 0x0fff0fff
    s_mov_b32 s59, 0
    s_mov_b32 s23, 0xc08a2000
    s_mov_b32 s24, 0xbea20000
    s_mov_b32 s25, 0x3f4a4588
    s_mov_b32 s26, 0x3f100000
    s_mov_b32 s27, 0xbf100000
    s_mov_b32 s28, 0xc05a4588
    s_mov_b32 s29, 0x3fa20000
    s_mov_b32 s30, 0x3ea20000
    s_mov_b32 s31, 0x3e800000
    s_mov_b32 s34, 0x3f900000
    s_mov_b32 s35, 0x3db64000
    s_mov_b32 s22, 0xffff0000
    v_bfe_u32 v6, v254, 6, 2
    v_mul_u32_u24 v4, 40704, v6
    v_and_b32 v6, 0x80, v254
    v_lshrrev_b32 v6, 1, v6
    v_add_u32 v4, v4, v6
    v_and_b32 v6, 0x40, v254
    v_lshrrev_b32 v6, 2, v6
    v_add_u32 v4, v4, v6
    v_bfe_u32 v6, v254, 4, 2
    v_mul_u32_u24 v6, 3104, v6
    v_add_u32 v4, v4, v6
    v_add_u32 v4, s52, v4
    v_lshrrev_b32 v6, 8, v254
    v_lshl_add_u32 v5, v6, 3, v4
    v_lshl_add_u32 v4, v6, 4, v4
    v_add_u32 v6, s51, v254
    v_mov_b32 v192, 0
    v_mov_b32 v193, 0
    v_mov_b32 v203, 0
    v_mov_b32 v215, 0
    v_mov_b32 v224, 0
    v_mov_b32 v227, 0
    v_mov_b32 v252, 0
    s_mov_b32 s42, 0
    s_cmp_gt_u32 s48, 0
    s_cselect_b32 s45, 384, 0
    s_cselect_b32 s55, 0, 2130706432
    s_add_u32 s50, s50, s45
    s_add_u32 s54, s45, 49152
    s_cmp_eq_u32 s48, 3
    s_cselect_b32 s54, 2130706432, s54
    s_mov_b32 s56, 0xffff0000
    s_mov_b32 s57, 0
    s_cmp_ge_u32 s2, 54
    s_cbranch_scc1 pub_skip
    s_branch do_warm
wt_ret:
    s_mov_b32 s87, 1
    s_cmp_lg_u32 s38, 0
    s_waitcnt vmcnt(6)
    s_barrier
    s_cbranch_scc1 wt_pub
    s_atomic_add s87, s[68:69], 0 glc
    s_waitcnt lgkmcnt(0)
    s_cmp_lg_u32 s87, 53
    s_cbranch_scc1 wt_pub
    s_atomic_add s87, s[68:69], 128
wt_pub:
    buffer_load_dwordx2 v[20:21], v80, s[4:7], s16 offen offset:384
    buffer_load_dwordx2 v[22:23], v80, s[4:7], s17 offen offset:384
    buffer_load_dwordx2 v[24:25], v80, s[4:7], s18 offen offset:384
    buffer_load_dwordx2 v[26:27], v80, s[4:7], s19 offen offset:384
    buffer_load_dwordx2 v[28:29], v80, s[4:7], s20 offen offset:384
    buffer_load_dwordx2 v[30:31], v80, s[4:7], s21 offen offset:384
pub_skip:
    v_and_b32 v67, 0xf0, v254
    v_lshrrev_b32 v67, 1, v67
    v_add_u32 v67, s52, v67
    v_mov_b32 v66, s54
    v_mov_b32 v65, s55
    v_cndmask_b32 v66, v66, v65, s[56:57]
    v_add_u32 v67, v67, v66
    s_sub_u32 s45, s16, s50
    buffer_load_dwordx2 v[56:57], v67, s[4:7], s45 offen
    s_sub_u32 s45, s17, s50
    buffer_load_dwordx2 v[58:59], v67, s[4:7], s45 offen
    s_sub_u32 s45, s18, s50
    buffer_load_dwordx2 v[60:61], v67, s[4:7], s45 offen
    s_sub_u32 s45, s19, s50
    buffer_load_dwordx2 v[62:63], v67, s[4:7], s45 offen
    s_sub_u32 s45, s20, s50
    buffer_load_dwordx2 v[64:65], v67, s[4:7], s45 offen
    s_sub_u32 s45, s21, s50
    buffer_load_dwordx2 v[66:67], v67, s[4:7], s45 offen
    buffer_load_dwordx2 v[32:33], v80, s[4:7], s16 offen offset:768
    buffer_load_dwordx2 v[34:35], v80, s[4:7], s17 offen offset:768
    buffer_load_dwordx2 v[36:37], v80, s[4:7], s18 offen offset:768
    buffer_load_dwordx2 v[38:39], v80, s[4:7], s19 offen offset:768
    buffer_load_dwordx2 v[40:41], v80, s[4:7], s20 offen offset:768
    buffer_load_dwordx2 v[42:43], v80, s[4:7], s21 offen offset:768
    buffer_load_dwordx2 v[44:45], v80, s[4:7], s16 offen offset:1152
    buffer_load_dwordx2 v[46:47], v80, s[4:7], s17 offen offset:1152
    buffer_load_dwordx2 v[48:49], v80, s[4:7], s18 offen offset:1152
    buffer_load_dwordx2 v[50:51], v80, s[4:7], s19 offen offset:1152
    buffer_load_dwordx2 v[52:53], v80, s[4:7], s20 offen offset:1152
    buffer_load_dwordx2 v[54:55], v80, s[4:7], s21 offen offset:1152
    s_waitcnt vmcnt(24)
    v_lshlrev_b32 v176, 16, v8
    v_and_b32 v177, s22, v8
    v_lshlrev_b32 v178, 16, v10
    v_and_b32 v179, s22, v10
    v_lshlrev_b32 v180, 16, v12
    v_and_b32 v181, s22, v12
    v_lshlrev_b32 v182, 16, v14
    v_and_b32 v183, s22, v14
    v_lshlrev_b32 v184, 16, v16
    v_and_b32 v185, s22, v16
    v_lshlrev_b32 v186, 16, v18
    v_and_b32 v187, s22, v18
    v_pk_fma_f32 v[176:177], v[184:185], s[24:25], v[176:177] op_sel:[0,1,0]
    v_pk_fma_f32 v[186:187], v[178:179], s[28:29], v[186:187] op_sel:[0,1,0]
    v_pk_fma_f32 v[176:177], v[180:181], s[28:29], v[176:177] op_sel_hi:[1,0,1]
    v_pk_fma_f32 v[186:187], v[182:183], s[22:23], v[186:187] op_sel:[0,1,0]
    v_pk_fma_f32 v[188:189], v[180:181], s[24:25], v[184:185] op_sel_hi:[1,0,1]
    v_pk_fma_f32 v[184:185], v[180:181], -4.0, v[184:185] op_sel_hi:[1,0,1]
    v_pk_fma_f32 v[180:181], v[178:179], s[24:25], v[182:183] op_sel_hi:[1,0,1]
    v_pk_fma_f32 v[182:183], v[178:179], -4.0, v[182:183] op_sel_hi:[1,0,1]
    v_pk_fma_f32 v[178:179], v[182:183], s[26:27], v[184:185] op_sel_hi:[1,0,1]
    v_pk_fma_f32 v[184:185], v[182:183], s[26:27], v[184:185] op_sel:[0,1,0]
    v_pk_fma_f32 v[182:183], v[180:181], 2.0, v[188:189] op_sel_hi:[1,0,1]
    v_pk_fma_f32 v[180:181], v[180:181], -2.0, v[188:189] op_sel_hi:[1,0,1]
    v_cvt_pk_bf16_f32 v8, v176, v177
    v_cvt_pk_bf16_f32 v10, v178, v179
    v_cvt_pk_bf16_f32 v12, v180, v181
    v_cvt_pk_bf16_f32 v14, v182, v183
    v_cvt_pk_bf16_f32 v16, v184, v185
    v_cvt_pk_bf16_f32 v18, v186, v187
    v_lshlrev_b32 v176, 16, v9
    v_and_b32 v177, s22, v9
    v_lshlrev_b32 v178, 16, v11
    v_and_b32 v179, s22, v11
    v_lshlrev_b32 v180, 16, v13
    v_and_b32 v181, s22, v13
    v_lshlrev_b32 v182, 16, v15
    v_and_b32 v183, s22, v15
    v_lshlrev_b32 v184, 16, v17
    v_and_b32 v185, s22, v17
    v_lshlrev_b32 v186, 16, v19
    v_and_b32 v187, s22, v19
    v_pk_fma_f32 v[176:177], v[184:185], s[24:25], v[176:177] op_sel:[0,1,0]
    v_pk_fma_f32 v[186:187], v[178:179], s[28:29], v[186:187] op_sel:[0,1,0]
    v_pk_fma_f32 v[176:177], v[180:181], s[28:29], v[176:177] op_sel_hi:[1,0,1]
    v_pk_fma_f32 v[186:187], v[182:183], s[22:23], v[186:187] op_sel:[0,1,0]
    v_pk_fma_f32 v[188:189], v[180:181], s[24:25], v[184:185] op_sel_hi:[1,0,1]
    v_pk_fma_f32 v[184:185], v[180:181], -4.0, v[184:185] op_sel_hi:[1,0,1]
    v_pk_fma_f32 v[180:181], v[178:179], s[24:25], v[182:183] op_sel_hi:[1,0,1]
    v_pk_fma_f32 v[182:183], v[178:179], -4.0, v[182:183] op_sel_hi:[1,0,1]
    v_pk_fma_f32 v[178:179], v[182:183], s[26:27], v[184:185] op_sel_hi:[1,0,1]
    v_pk_fma_f32 v[184:185], v[182:183], s[26:27], v[184:185] op_sel:[0,1,0]
    v_pk_fma_f32 v[182:183], v[180:181], 2.0, v[188:189] op_sel_hi:[1,0,1]
    v_pk_fma_f32 v[180:181], v[180:181], -2.0, v[188:189] op_sel_hi:[1,0,1]
    v_cvt_pk_bf16_f32 v9, v176, v177
    v_cvt_pk_bf16_f32 v11, v178, v179
    v_cvt_pk_bf16_f32 v13, v180, v181
    v_cvt_pk_bf16_f32 v15, v182, v183
    v_cvt_pk_bf16_f32 v17, v184, v185
    v_cvt_pk_bf16_f32 v19, v186, v187
    v_lshrrev_b32 v252, 15, v255
    ds_write_b64 v252, v[8:9] offset:34048
    ds_write_b64 v252, v[10:11] offset:768
    ds_write_b64 v252, v[16:17] offset:2848
    ds_write_b64 v252, v[14:15] offset:4928
    ds_write_b64 v252, v[12:13] offset:7008
    ds_write_b64 v252, v[18:19] offset:36128
    s_waitcnt vmcnt(18)
    v_lshlrev_b32 v176, 16, v20
    v_and_b32 v177, s22, v20
    v_lshlrev_b32 v178, 16, v22
    v_and_b32 v179, s22, v22
    v_lshlrev_b32 v180, 16, v24
    v_and_b32 v181, s22, v24
    v_lshlrev_b32 v182, 16, v26
    v_and_b32 v183, s22, v26
    v_lshlrev_b32 v184, 16, v28
    v_and_b32 v185, s22, v28
    v_lshlrev_b32 v186, 16, v30
    v_and_b32 v187, s22, v30
    v_pk_fma_f32 v[176:177], v[184:185], s[24:25], v[176:177] op_sel:[0,1,0]
    v_pk_fma_f32 v[186:187], v[178:179], s[28:29], v[186:187] op_sel:[0,1,0]
    v_pk_fma_f32 v[176:177], v[180:181], s[28:29], v[176:177] op_sel_hi:[1,0,1]
    v_pk_fma_f32 v[186:187], v[182:183], s[22:23], v[186:187] op_sel:[0,1,0]
    v_pk_fma_f32 v[188:189], v[180:181], s[24:25], v[184:185] op_sel_hi:[1,0,1]
    v_pk_fma_f32 v[184:185], v[180:181], -4.0, v[184:185] op_sel_hi:[1,0,1]
    v_pk_fma_f32 v[180:181], v[178:179], s[24:25], v[182:183] op_sel_hi:[1,0,1]
    v_pk_fma_f32 v[182:183], v[178:179], -4.0, v[182:183] op_sel_hi:[1,0,1]
    v_pk_fma_f32 v[178:179], v[182:183], s[26:27], v[184:185] op_sel_hi:[1,0,1]
    v_pk_fma_f32 v[184:185], v[182:183], s[26:27], v[184:185] op_sel:[0,1,0]
    v_pk_fma_f32 v[182:183], v[180:181], 2.0, v[188:189] op_sel_hi:[1,0,1]
    v_pk_fma_f32 v[180:181], v[180:181], -2.0, v[188:189] op_sel_hi:[1,0,1]
    v_cvt_pk_bf16_f32 v20, v176, v177
    v_cvt_pk_bf16_f32 v22, v178, v179
    v_cvt_pk_bf16_f32 v24, v180, v181
    v_cvt_pk_bf16_f32 v26, v182, v183
    v_cvt_pk_bf16_f32 v28, v184, v185
    v_cvt_pk_bf16_f32 v30, v186, v187
    v_lshlrev_b32 v176, 16, v21
    v_and_b32 v177, s22, v21
    v_lshlrev_b32 v178, 16, v23
    v_and_b32 v179, s22, v23
    v_lshlrev_b32 v180, 16, v25
    v_and_b32 v181, s22, v25
    v_lshlrev_b32 v182, 16, v27
    v_and_b32 v183, s22, v27
    v_lshlrev_b32 v184, 16, v29
    v_and_b32 v185, s22, v29
    v_lshlrev_b32 v186, 16, v31
    v_and_b32 v187, s22, v31
    v_pk_fma_f32 v[176:177], v[184:185], s[24:25], v[176:177] op_sel:[0,1,0]
    v_pk_fma_f32 v[186:187], v[178:179], s[28:29], v[186:187] op_sel:[0,1,0]
    v_pk_fma_f32 v[176:177], v[180:181], s[28:29], v[176:177] op_sel_hi:[1,0,1]
    v_pk_fma_f32 v[186:187], v[182:183], s[22:23], v[186:187] op_sel:[0,1,0]
    v_pk_fma_f32 v[188:189], v[180:181], s[24:25], v[184:185] op_sel_hi:[1,0,1]
    v_pk_fma_f32 v[184:185], v[180:181], -4.0, v[184:185] op_sel_hi:[1,0,1]
    v_pk_fma_f32 v[180:181], v[178:179], s[24:25], v[182:183] op_sel_hi:[1,0,1]
    v_pk_fma_f32 v[182:183], v[178:179], -4.0, v[182:183] op_sel_hi:[1,0,1]
    v_pk_fma_f32 v[178:179], v[182:183], s[26:27], v[184:185] op_sel_hi:[1,0,1]
    v_pk_fma_f32 v[184:185], v[182:183], s[26:27], v[184:185] op_sel:[0,1,0]
    v_pk_fma_f32 v[182:183], v[180:181], 2.0, v[188:189] op_sel_hi:[1,0,1]
    v_pk_fma_f32 v[180:181], v[180:181], -2.0, v[188:189] op_sel_hi:[1,0,1]
    v_cvt_pk_bf16_f32 v21, v176, v177
    v_cvt_pk_bf16_f32 v23, v178, v179
    v_cvt_pk_bf16_f32 v25, v180, v181
    v_cvt_pk_bf16_f32 v27, v182, v183
    v_cvt_pk_bf16_f32 v29, v184, v185
    v_cvt_pk_bf16_f32 v31, v186, v187
    v_lshrrev_b32 v252, 15, v255
    ds_write_b64 v252, v[20:21] offset:33792
    ds_write_b64 v252, v[22:23] offset:512
    ds_write_b64 v252, v[28:29] offset:2592
    ds_write_b64 v252, v[26:27] offset:4672
    ds_write_b64 v252, v[24:25] offset:6752
    ds_write_b64 v252, v[30:31] offset:35872
    s_waitcnt vmcnt(12)
    v_lshlrev_b32 v176, 16, v56
    v_and_b32 v177, s22, v56
    v_lshlrev_b32 v178, 16, v58
    v_and_b32 v179, s22, v58
    v_lshlrev_b32 v180, 16, v60
    v_and_b32 v181, s22, v60
    v_lshlrev_b32 v182, 16, v62
    v_and_b32 v183, s22, v62
    v_lshlrev_b32 v184, 16, v64
    v_and_b32 v185, s22, v64
    v_lshlrev_b32 v186, 16, v66
    v_and_b32 v187, s22, v66
    v_pk_fma_f32 v[176:177], v[184:185], s[24:25], v[176:177] op_sel:[0,1,0]
    v_pk_fma_f32 v[186:187], v[178:179], s[28:29], v[186:187] op_sel:[0,1,0]
    v_pk_fma_f32 v[176:177], v[180:181], s[28:29], v[176:177] op_sel_hi:[1,0,1]
    v_pk_fma_f32 v[186:187], v[182:183], s[22:23], v[186:187] op_sel:[0,1,0]
    v_pk_fma_f32 v[188:189], v[180:181], s[24:25], v[184:185] op_sel_hi:[1,0,1]
    v_pk_fma_f32 v[184:185], v[180:181], -4.0, v[184:185] op_sel_hi:[1,0,1]
    v_pk_fma_f32 v[180:181], v[178:179], s[24:25], v[182:183] op_sel_hi:[1,0,1]
    v_pk_fma_f32 v[182:183], v[178:179], -4.0, v[182:183] op_sel_hi:[1,0,1]
    v_pk_fma_f32 v[178:179], v[182:183], s[26:27], v[184:185] op_sel_hi:[1,0,1]
    v_pk_fma_f32 v[184:185], v[182:183], s[26:27], v[184:185] op_sel:[0,1,0]
    v_pk_fma_f32 v[182:183], v[180:181], 2.0, v[188:189] op_sel_hi:[1,0,1]
    v_pk_fma_f32 v[180:181], v[180:181], -2.0, v[188:189] op_sel_hi:[1,0,1]
    v_cvt_pk_bf16_f32 v56, v176, v177
    v_cvt_pk_bf16_f32 v58, v178, v179
    v_cvt_pk_bf16_f32 v60, v180, v181
    v_cvt_pk_bf16_f32 v62, v182, v183
    v_cvt_pk_bf16_f32 v64, v184, v185
    v_cvt_pk_bf16_f32 v66, v186, v187
    v_lshlrev_b32 v176, 16, v57
    v_and_b32 v177, s22, v57
    v_lshlrev_b32 v178, 16, v59
    v_and_b32 v179, s22, v59
    v_lshlrev_b32 v180, 16, v61
    v_and_b32 v181, s22, v61
    v_lshlrev_b32 v182, 16, v63
    v_and_b32 v183, s22, v63
    v_lshlrev_b32 v184, 16, v65
    v_and_b32 v185, s22, v65
    v_lshlrev_b32 v186, 16, v67
    v_and_b32 v187, s22, v67
    v_pk_fma_f32 v[176:177], v[184:185], s[24:25], v[176:177] op_sel:[0,1,0]
    v_pk_fma_f32 v[186:187], v[178:179], s[28:29], v[186:187] op_sel:[0,1,0]
    v_pk_fma_f32 v[176:177], v[180:181], s[28:29], v[176:177] op_sel_hi:[1,0,1]
    v_pk_fma_f32 v[186:187], v[182:183], s[22:23], v[186:187] op_sel:[0,1,0]
    v_pk_fma_f32 v[188:189], v[180:181], s[24:25], v[184:185] op_sel_hi:[1,0,1]
    v_pk_fma_f32 v[184:185], v[180:181], -4.0, v[184:185] op_sel_hi:[1,0,1]
    v_pk_fma_f32 v[180:181], v[178:179], s[24:25], v[182:183] op_sel_hi:[1,0,1]
    v_pk_fma_f32 v[182:183], v[178:179], -4.0, v[182:183] op_sel_hi:[1,0,1]
    v_pk_fma_f32 v[178:179], v[182:183], s[26:27], v[184:185] op_sel_hi:[1,0,1]
    v_pk_fma_f32 v[184:185], v[182:183], s[26:27], v[184:185] op_sel:[0,1,0]
    v_pk_fma_f32 v[182:183], v[180:181], 2.0, v[188:189] op_sel_hi:[1,0,1]
    v_pk_fma_f32 v[180:181], v[180:181], -2.0, v[188:189] op_sel_hi:[1,0,1]
    v_cvt_pk_bf16_f32 v57, v176, v177
    v_cvt_pk_bf16_f32 v59, v178, v179
    v_cvt_pk_bf16_f32 v61, v180, v181
    v_cvt_pk_bf16_f32 v63, v182, v183
    v_cvt_pk_bf16_f32 v65, v184, v185
    v_cvt_pk_bf16_f32 v67, v186, v187
    v_and_b32 v248, 0xf0, v254
    v_lshrrev_b32 v248, 1, v248
    v_add_u32 v248, s52, v248
    v_and_b32 v252, 8, v248
    v_lshrrev_b32 v249, 6, v248
    v_mul_u32_u24 v249, 192, v249
    v_cmp_eq_u32 s[92:93], 0, v249
    v_add_u32 v252, v252, v249
    v_bfe_u32 v249, v248, 4, 2
    v_mul_u32_u24 v249, 40704, v249
    v_add_u32 v252, v252, v249
    v_and_b32 v249, 32, v248
    v_lshl_add_u32 v252, v249, 1, v252
    v_bfe_u32 v249, v254, 8, 1
    v_lshl_add_u32 v252, v249, 4, v252
    v_mov_b32 v249, 123328
    v_cndmask_b32 v252, v249, v252, s[58:59]
    ds_write_b64 v252, v[56:57] offset:39520
    ds_write_b64 v252, v[58:59] offset:39552
    ds_write_b64 v252, v[64:65] offset:39584
    ds_write_b64 v252, v[62:63] offset:39616
    ds_write_b64 v252, v[60:61] offset:39648
    ds_write_b64 v252, v[66:67] offset:39680
    s_and_b64 exec, s[92:93], s[58:59]
    ds_write_b64 v252, v[56:57] offset:34304
    ds_write_b64 v252, v[58:59] offset:1024
    ds_write_b64 v252, v[64:65] offset:3104
    ds_write_b64 v252, v[62:63] offset:5184
    ds_write_b64 v252, v[60:61] offset:7264
    ds_write_b64 v252, v[66:67] offset:36384
    s_mov_b64 exec, -1
    v_and_b32 v203, 0x7fff, v255
    buffer_load_dwordx2 v[192:193], v203, s[4:7], s16 offen offset:64
    buffer_load_dwordx2 v[194:195], v203, s[4:7], s17 offen offset:64
    buffer_load_dwordx2 v[196:197], v203, s[4:7], s18 offen offset:64
    buffer_load_dwordx2 v[198:199], v203, s[4:7], s19 offen offset:64
    buffer_load_dwordx2 v[200:201], v203, s[4:7], s20 offen offset:64
    buffer_load_dwordx2 v[202:203], v203, s[4:7], s21 offen offset:64
    v_and_b32 v215, 0x7fff, v255
    buffer_load_dwordx2 v[204:205], v215, s[4:7], s16 offen offset:448
    buffer_load_dwordx2 v[206:207], v215, s[4:7], s17 offen offset:448
    buffer_load_dwordx2 v[208:209], v215, s[4:7], s18 offen offset:448
    buffer_load_dwordx2 v[210:211], v215, s[4:7], s19 offen offset:448
    buffer_load_dwordx2 v[212:213], v215, s[4:7], s20 offen offset:448
    buffer_load_dwordx2 v[214:215], v215, s[4:7], s21 offen offset:448
    s_waitcnt vmcnt(18)
    v_lshlrev_b32 v176, 16, v32
    v_and_b32 v177, s22, v32
    v_lshlrev_b32 v178, 16, v34
    v_and_b32 v179, s22, v34
    v_lshlrev_b32 v180, 16, v36
    v_and_b32 v181, s22, v36
    v_lshlrev_b32 v182, 16, v38
    v_and_b32 v183, s22, v38
    v_lshlrev_b32 v184, 16, v40
    v_and_b32 v185, s22, v40
    v_lshlrev_b32 v186, 16, v42
    v_and_b32 v187, s22, v42
    v_pk_fma_f32 v[176:177], v[184:185], s[24:25], v[176:177] op_sel:[0,1,0]
    v_pk_fma_f32 v[186:187], v[178:179], s[28:29], v[186:187] op_sel:[0,1,0]
    v_pk_fma_f32 v[176:177], v[180:181], s[28:29], v[176:177] op_sel_hi:[1,0,1]
    v_pk_fma_f32 v[186:187], v[182:183], s[22:23], v[186:187] op_sel:[0,1,0]
    v_pk_fma_f32 v[188:189], v[180:181], s[24:25], v[184:185] op_sel_hi:[1,0,1]
    v_pk_fma_f32 v[184:185], v[180:181], -4.0, v[184:185] op_sel_hi:[1,0,1]
    v_pk_fma_f32 v[180:181], v[178:179], s[24:25], v[182:183] op_sel_hi:[1,0,1]
    v_pk_fma_f32 v[182:183], v[178:179], -4.0, v[182:183] op_sel_hi:[1,0,1]
    v_pk_fma_f32 v[178:179], v[182:183], s[26:27], v[184:185] op_sel_hi:[1,0,1]
    v_pk_fma_f32 v[184:185], v[182:183], s[26:27], v[184:185] op_sel:[0,1,0]
    v_pk_fma_f32 v[182:183], v[180:181], 2.0, v[188:189] op_sel_hi:[1,0,1]
    v_pk_fma_f32 v[180:181], v[180:181], -2.0, v[188:189] op_sel_hi:[1,0,1]
    v_cvt_pk_bf16_f32 v32, v176, v177
    v_cvt_pk_bf16_f32 v34, v178, v179
    v_cvt_pk_bf16_f32 v36, v180, v181
    v_cvt_pk_bf16_f32 v38, v182, v183
    v_cvt_pk_bf16_f32 v40, v184, v185
    v_cvt_pk_bf16_f32 v42, v186, v187
    v_lshlrev_b32 v176, 16, v33
    v_and_b32 v177, s22, v33
    v_lshlrev_b32 v178, 16, v35
    v_and_b32 v179, s22, v35
    v_lshlrev_b32 v180, 16, v37
    v_and_b32 v181, s22, v37
    v_lshlrev_b32 v182, 16, v39
    v_and_b32 v183, s22, v39
    v_lshlrev_b32 v184, 16, v41
    v_and_b32 v185, s22, v41
    v_lshlrev_b32 v186, 16, v43
    v_and_b32 v187, s22, v43
    v_pk_fma_f32 v[176:177], v[184:185], s[24:25], v[176:177] op_sel:[0,1,0]
    v_pk_fma_f32 v[186:187], v[178:179], s[28:29], v[186:187] op_sel:[0,1,0]
    v_pk_fma_f32 v[176:177], v[180:181], s[28:29], v[176:177] op_sel_hi:[1,0,1]
    v_pk_fma_f32 v[186:187], v[182:183], s[22:23], v[186:187] op_sel:[0,1,0]
    v_pk_fma_f32 v[188:189], v[180:181], s[24:25], v[184:185] op_sel_hi:[1,0,1]
    v_pk_fma_f32 v[184:185], v[180:181], -4.0, v[184:185] op_sel_hi:[1,0,1]
    v_pk_fma_f32 v[180:181], v[178:179], s[24:25], v[182:183] op_sel_hi:[1,0,1]
    v_pk_fma_f32 v[182:183], v[178:179], -4.0, v[182:183] op_sel_hi:[1,0,1]
    v_pk_fma_f32 v[178:179], v[182:183], s[26:27], v[184:185] op_sel_hi:[1,0,1]
    v_pk_fma_f32 v[184:185], v[182:183], s[26:27], v[184:185] op_sel:[0,1,0]
    v_pk_fma_f32 v[182:183], v[180:181], 2.0, v[188:189] op_sel_hi:[1,0,1]
    v_pk_fma_f32 v[180:181], v[180:181], -2.0, v[188:189] op_sel_hi:[1,0,1]
    v_cvt_pk_bf16_f32 v33, v176, v177
    v_cvt_pk_bf16_f32 v35, v178, v179
    v_cvt_pk_bf16_f32 v37, v180, v181
    v_cvt_pk_bf16_f32 v39, v182, v183
    v_cvt_pk_bf16_f32 v41, v184, v185
    v_cvt_pk_bf16_f32 v43, v186, v187
    v_lshrrev_b32 v252, 15, v255
    ds_write_b64 v252, v[32:33] offset:33536
    ds_write_b64 v252, v[34:35] offset:256
    ds_write_b64 v252, v[40:41] offset:2336
    ds_write_b64 v252, v[38:39] offset:4416
    ds_write_b64 v252, v[36:37] offset:6496
    ds_write_b64 v252, v[42:43] offset:35616
    s_waitcnt vmcnt(12)
    v_lshlrev_b32 v176, 16, v44
    v_and_b32 v177, s22, v44
    v_lshlrev_b32 v178, 16, v46
    v_and_b32 v179, s22, v46
    v_lshlrev_b32 v180, 16, v48
    v_and_b32 v181, s22, v48
    v_lshlrev_b32 v182, 16, v50
    v_and_b32 v183, s22, v50
    v_lshlrev_b32 v184, 16, v52
    v_and_b32 v185, s22, v52
    v_lshlrev_b32 v186, 16, v54
    v_and_b32 v187, s22, v54
    v_pk_fma_f32 v[176:177], v[184:185], s[24:25], v[176:177] op_sel:[0,1,0]
    v_pk_fma_f32 v[186:187], v[178:179], s[28:29], v[186:187] op_sel:[0,1,0]
    v_pk_fma_f32 v[176:177], v[180:181], s[28:29], v[176:177] op_sel_hi:[1,0,1]
    v_pk_fma_f32 v[186:187], v[182:183], s[22:23], v[186:187] op_sel:[0,1,0]
    v_pk_fma_f32 v[188:189], v[180:181], s[24:25], v[184:185] op_sel_hi:[1,0,1]
    v_pk_fma_f32 v[184:185], v[180:181], -4.0, v[184:185] op_sel_hi:[1,0,1]
    v_pk_fma_f32 v[180:181], v[178:179], s[24:25], v[182:183] op_sel_hi:[1,0,1]
    v_pk_fma_f32 v[182:183], v[178:179], -4.0, v[182:183] op_sel_hi:[1,0,1]
    v_pk_fma_f32 v[178:179], v[182:183], s[26:27], v[184:185] op_sel_hi:[1,0,1]
    v_pk_fma_f32 v[184:185], v[182:183], s[26:27], v[184:185] op_sel:[0,1,0]
    v_pk_fma_f32 v[182:183], v[180:181], 2.0, v[188:189] op_sel_hi:[1,0,1]
    v_pk_fma_f32 v[180:181], v[180:181], -2.0, v[188:189] op_sel_hi:[1,0,1]
    v_cvt_pk_bf16_f32 v44, v176, v177
    v_cvt_pk_bf16_f32 v46, v178, v179
    v_cvt_pk_bf16_f32 v48, v180, v181
    v_cvt_pk_bf16_f32 v50, v182, v183
    v_cvt_pk_bf16_f32 v52, v184, v185
    v_cvt_pk_bf16_f32 v54, v186, v187
    v_lshlrev_b32 v176, 16, v45
    v_and_b32 v177, s22, v45
    v_lshlrev_b32 v178, 16, v47
    v_and_b32 v179, s22, v47
    v_lshlrev_b32 v180, 16, v49
    v_and_b32 v181, s22, v49
    v_lshlrev_b32 v182, 16, v51
    v_and_b32 v183, s22, v51
    v_lshlrev_b32 v184, 16, v53
    v_and_b32 v185, s22, v53
    v_lshlrev_b32 v186, 16, v55
    v_and_b32 v187, s22, v55
    v_pk_fma_f32 v[176:177], v[184:185], s[24:25], v[176:177] op_sel:[0,1,0]
    v_pk_fma_f32 v[186:187], v[178:179], s[28:29], v[186:187] op_sel:[0,1,0]
    v_pk_fma_f32 v[176:177], v[180:181], s[28:29], v[176:177] op_sel_hi:[1,0,1]
    v_pk_fma_f32 v[186:187], v[182:183], s[22:23], v[186:187] op_sel:[0,1,0]
    v_pk_fma_f32 v[188:189], v[180:181], s[24:25], v[184:185] op_sel_hi:[1,0,1]
    v_pk_fma_f32 v[184:185], v[180:181], -4.0, v[184:185] op_sel_hi:[1,0,1]
    v_pk_fma_f32 v[180:181], v[178:179], s[24:25], v[182:183] op_sel_hi:[1,0,1]
    v_pk_fma_f32 v[182:183], v[178:179], -4.0, v[182:183] op_sel_hi:[1,0,1]
    v_pk_fma_f32 v[178:179], v[182:183], s[26:27], v[184:185] op_sel_hi:[1,0,1]
    v_pk_fma_f32 v[184:185], v[182:183], s[26:27], v[184:185] op_sel:[0,1,0]
    v_pk_fma_f32 v[182:183], v[180:181], 2.0, v[188:189] op_sel_hi:[1,0,1]
    v_pk_fma_f32 v[180:181], v[180:181], -2.0, v[188:189] op_sel_hi:[1,0,1]
    v_cvt_pk_bf16_f32 v45, v176, v177
    v_cvt_pk_bf16_f32 v47, v178, v179
    v_cvt_pk_bf16_f32 v49, v180, v181
    v_cvt_pk_bf16_f32 v51, v182, v183
    v_cvt_pk_bf16_f32 v53, v184, v185
    v_cvt_pk_bf16_f32 v55, v186, v187
    v_lshrrev_b32 v252, 15, v255
    ds_write_b64 v252, v[44:45] offset:33280
    ds_write_b64 v252, v[46:47] offset:0
    ds_write_b64 v252, v[52:53] offset:2080
    ds_write_b64 v252, v[50:51] offset:4160
    ds_write_b64 v252, v[48:49] offset:6240
    ds_write_b64 v252, v[54:55] offset:35360
    buffer_load_dword v97, v98, s[64:67], 0 offen offset:128 sc1
no_poll:
    s_cmp_lt_u32 s2, 54
    s_cbranch_scc1 warm_done
do_warm:
    s_mov_b64 vcc, -1
    s_cmp_eq_u32 s38, 0
    s_cbranch_scc1 pad0
    s_cmp_eq_u32 s38, 1
    s_cbranch_scc1 pad1
    s_cmp_eq_u32 s38, 2
    s_cbranch_scc1 pad2
    s_branch pad3
warm_ret:
    s_mov_b64 vcc, 0
    s_cmp_lt_u32 s2, 54
    s_cbranch_scc1 wt_ret
warm_done:
    s_mov_b32 s86, 0
    s_waitcnt vmcnt(0)
poll_loop:
    v_readfirstlane_b32 s87, v97
    s_add_u32 s86, s86, 1
    s_cmp_lg_u32 s87, 0
    s_cbranch_scc1 u_ready
    buffer_load_dword v97, v98, s[64:67], 0 offen offset:128 sc1
    s_cmp_lt_u32 s86, 512
    s_waitcnt vmcnt(0)
    s_cbranch_scc1 poll_loop
    s_mov_b32 s70, 0
    s_branch wt_loop
u_ready:
    s_mov_b32 s42, 0
    buffer_load_dwordx4 a[192:195], v254, s[8:11], s42 offen offset:0 sc1
    buffer_load_dwordx4 a[196:199], v254, s[8:11], s42 offen offset:1024 sc1
    buffer_load_dwordx4 a[200:203], v254, s[8:11], s42 offen offset:2048 sc1
    s_mov_b32 s42, 3072
    buffer_load_dwordx4 a[204:207], v254, s[8:11], s42 offen offset:0 sc1
    buffer_load_dwordx4 a[208:211], v254, s[8:11], s42 offen offset:1024 sc1
    buffer_load_dwordx4 a[212:215], v254, s[8:11], s42 offen offset:2048 sc1
    s_mov_b32 s42, 6144
    buffer_load_dwordx4 a[216:219], v254, s[8:11], s42 offen offset:0 sc1
    buffer_load_dwordx4 a[220:223], v254, s[8:11], s42 offen offset:1024 sc1
    buffer_load_dwordx4 a[224:227], v254, s[8:11], s42 offen offset:2048 sc1
    s_mov_b32 s42, 36864
    buffer_load_dwordx4 a[228:231], v254, s[8:11], s42 offen offset:0 sc1
    buffer_load_dwordx4 a[232:235], v254, s[8:11], s42 offen offset:1024 sc1
    buffer_load_dwordx4 a[236:239], v254, s[8:11], s42 offen offset:2048 sc1
    s_mov_b32 s42, 39936
    buffer_load_dwordx4 a[240:243], v254, s[8:11], s42 offen offset:0 sc1
u_done:
    s_waitcnt lgkmcnt(0)
    s_barrier
    ds_read_b128 v[228:231], v253 offset:1040
    ds_read_b128 v[232:235], v253 offset:768
    ds_read_b128 v[236:239], v253 offset:512
    s_waitcnt vmcnt(4) lgkmcnt(0)
    s_branch blk_loop
.p2align 12
blk_loop:
sub0:
    v_mfma_f32_16x16x32_bf16 a[0:3], a[192:195], v[228:231], 0
pad0:
    s_cbranch_vccnz pad4
    s_add_u32 s44, s41, 0
    v_cvt_pk_bf16_f32 v164, v164, v165
    v_cvt_pk_bf16_f32 v165, v166, v167
    v_mfma_f32_16x16x32_bf16 a[4:7], a[196:199], v[228:231], 0
    buffer_store_dwordx4 v[96:99], v254, s[12:15], s44 offen sc1
    s_add_u32 s44, s41, 3072
    v_lshlrev_b32 v248, 16, v194
    v_lshlrev_b32 v249, 16, v196
    v_mfma_f32_16x16x32_bf16 a[8:11], a[200:203], v[228:231], 0
    ds_read_b128 v[228:231], v253 offset:256
    v_lshlrev_b32 v250, 16, v198
    v_lshlrev_b32 v251, 16, v200
    s_waitcnt vmcnt(16)
    s_waitcnt lgkmcnt(2)
    v_mfma_f32_16x16x32_bf16 a[0:3], a[204:207], v[232:235], a[0:3]
    buffer_load_dwordx4 a[244:247], v254, s[8:11], s42 offen offset:1024 sc1
    v_and_b32 v194, s22, v194
    v_and_b32 v196, s22, v196
    v_mfma_f32_16x16x32_bf16 a[4:7], a[208:211], v[232:235], a[4:7]
    ds_write_b64 v5, v[164:165] offset:18624
    v_and_b32 v198, s22, v198
    v_mfma_f32_16x16x32_bf16 a[8:11], a[212:215], v[232:235], a[8:11]
    v_cvt_pk_bf16_f32 v156, v156, v157
    v_cvt_pk_bf16_f32 v157, v158, v159
    v_and_b32 v200, s22, v200
    v_mfma_f32_16x16x32_bf16 a[12:15], a[192:195], v[232:235], 0
    s_waitcnt lgkmcnt(2)
    v_cvt_pk_bf16_f32 v158, v160, v161
    v_cvt_pk_bf16_f32 v159, v162, v163
    v_lshlrev_b32 v252, 16, v192
    v_mfma_f32_16x16x32_bf16 a[12:15], a[204:207], v[236:239], a[12:15]
    buffer_load_dwordx4 a[248:251], v254, s[8:11], s42 offen offset:2048 sc1
    v_and_b32 v192, s22, v192
    v_fmac_f32 v252, s25, v251
    v_mfma_f32_16x16x32_bf16 a[16:19], a[208:211], v[236:239], 0
    ds_write_b128 v4, v[156:159] offset:18560
    v_fmac_f32 v192, s25, v200
    v_mfma_f32_16x16x32_bf16 a[16:19], a[196:199], v[232:235], a[16:19]
    s_mov_b32 s42, 43008
    v_cvt_pk_bf16_f32 v176, v176, v177
    v_cvt_pk_bf16_f32 v177, v178, v179
    v_fmac_f32 v252, s28, v249
    v_mfma_f32_16x16x32_bf16 a[20:23], a[200:203], v[232:235], 0
    ds_read_b128 v[232:235], v253 offset:0
    v_fmac_f32 v192, s28, v196
    v_cvt_pk_bf16_f32 v192, v252, v192
    v_mfma_f32_16x16x32_bf16 a[20:23], a[212:215], v[236:239], a[20:23]
    buffer_load_dwordx4 a[252:255], v254, s[8:11], s42 offen offset:0 sc1
    v_lshlrev_b32 v252, 16, v202
    v_and_b32 v202, s22, v202
    s_waitcnt vmcnt(14)
    v_mfma_f32_16x16x32_bf16 a[0:3], a[216:219], v[236:239], a[0:3]
    ds_write_b64 v5, v[176:177] offset:19008
    v_fmac_f32 v252, s29, v248
    v_mfma_f32_16x16x32_bf16 a[4:7], a[220:223], v[236:239], a[4:7]
    buffer_store_dwordx4 v[100:103], v254, s[12:15], s44 offen sc1
    s_add_u32 s44, s41, 6144
    v_cvt_pk_bf16_f32 v168, v168, v169
    v_fmac_f32 v202, s29, v194
    v_mfma_f32_16x16x32_bf16 a[8:11], a[224:227], v[236:239], a[8:11]
    s_waitcnt lgkmcnt(4)
    v_cvt_pk_bf16_f32 v169, v170, v171
    v_cvt_pk_bf16_f32 v170, v172, v173
    v_fmac_f32 v252, s23, v250
    v_mfma_f32_16x16x32_bf16 a[24:27], a[192:195], v[236:239], 0
    buffer_load_dwordx4 v[240:243], v254, s[8:11], s42 offen offset:1024 sc1
    v_fmac_f32 v202, s23, v198
    v_cvt_pk_bf16_f32 v202, v252, v202
    v_mfma_f32_16x16x32_bf16 a[24:27], a[204:207], v[228:231], a[24:27]
    buffer_store_dwordx4 v[104:107], v254, s[12:15], s44 offen sc1
    s_add_u32 s44, s41, 9216
    v_cvt_pk_bf16_f32 v171, v174, v175
    v_fma_f32 v252, v249, s24, v251
    v_mfma_f32_16x16x32_bf16 a[28:31], a[208:211], v[228:231], 0
    ds_write_b128 v4, v[168:171] offset:18944
    v_fmac_f32 v251, -4.0, v249
    v_mfma_f32_16x16x32_bf16 a[28:31], a[196:199], v[236:239], a[28:31]
    buffer_load_dwordx4 v[244:247], v254, s[8:11], s42 offen offset:2048 sc1
    v_fma_f32 v249, v248, s24, v250
    v_mfma_f32_16x16x32_bf16 a[32:35], a[200:203], v[236:239], 0
    ds_read_b128 v[236:239], v253 offset:1824
    v_and_b32 v227, 0x7fff, v255
    v_fmac_f32 v250, -4.0, v248
    v_fma_f32 v248, v250, s26, v251
    v_mfma_f32_16x16x32_bf16 a[32:35], a[212:215], v[228:231], a[32:35]
    v_cvt_pk_bf16_f32 v188, v188, v189
    v_cvt_pk_bf16_f32 v189, v190, v191
    v_fmac_f32 v251, s27, v250
    v_mfma_f32_16x16x32_bf16 a[12:15], a[216:219], v[228:231], a[12:15]
    buffer_store_dwordx4 v[108:111], v254, s[12:15], s44 offen sc1
    v_fma_f32 v250, v249, 2.0, v252
    v_fmac_f32 v252, -2.0, v249
    v_fma_f32 v249, v196, s24, v200
    v_mfma_f32_16x16x32_bf16 a[16:19], a[220:223], v[228:231], a[16:19]
    buffer_load_dwordx2 v[216:217], v227, s[4:7], s16 offen offset:832
    v_fmac_f32 v200, -4.0, v196
    v_mfma_f32_16x16x32_bf16 a[20:23], a[224:227], v[228:231], a[20:23]
    ds_write_b64 v5, v[188:189] offset:19392
    v_fma_f32 v196, v194, s24, v198
    v_fmac_f32 v198, -4.0, v194
    v_mfma_f32_16x16x32_bf16 a[36:39], a[192:195], v[228:231], 0
    s_waitcnt lgkmcnt(4)
    v_cvt_pk_bf16_f32 v180, v180, v181
    v_cvt_pk_bf16_f32 v181, v182, v183
    v_fma_f32 v194, v198, s26, v200
    v_mfma_f32_16x16x32_bf16 a[36:39], a[204:207], v[232:235], a[36:39]
    v_cvt_pk_bf16_f32 v182, v184, v185
    v_cvt_pk_bf16_f32 v183, v186, v187
    v_fmac_f32 v200, s27, v198
    v_mfma_f32_16x16x32_bf16 a[40:43], a[208:211], v[232:235], 0
    ds_write_b128 v4, v[180:183] offset:19328
    v_fma_f32 v198, v196, 2.0, v249
    v_mfma_f32_16x16x32_bf16 a[40:43], a[196:199], v[228:231], a[40:43]
    buffer_load_dwordx2 v[218:219], v227, s[4:7], s17 offen offset:832
    v_fmac_f32 v249, -2.0, v196
    v_cvt_pk_bf16_f32 v194, v248, v194
    v_mfma_f32_16x16x32_bf16 a[44:47], a[200:203], v[228:231], 0
    ds_read_b128 v[228:231], v253 offset:1568
    v_cvt_pk_bf16_f32 v200, v251, v200
    v_cvt_pk_bf16_f32 v198, v250, v198
    v_mfma_f32_16x16x32_bf16 a[44:47], a[212:215], v[232:235], a[44:47]
    s_waitcnt lgkmcnt(3)
    v_cvt_pk_bf16_f32 v196, v252, v249
    v_lshlrev_b32 v248, 16, v195
    v_lshlrev_b32 v249, 16, v197
    v_mfma_f32_16x16x32_bf16 a[24:27], a[216:219], v[232:235], a[24:27]
    s_waitcnt lgkmcnt(0)
    v_lshlrev_b32 v250, 16, v199
    v_lshlrev_b32 v251, 16, v201
    v_and_b32 v195, s22, v195
    v_mfma_f32_16x16x32_bf16 a[28:31], a[220:223], v[232:235], a[28:31]
    s_barrier
    v_and_b32 v197, s22, v197
    v_and_b32 v199, s22, v199
    v_mfma_f32_16x16x32_bf16 a[32:35], a[224:227], v[232:235], a[32:35]
    buffer_load_dwordx2 v[220:221], v227, s[4:7], s18 offen offset:832
    v_and_b32 v201, s22, v201
    v_mfma_f32_16x16x32_bf16 a[48:51], a[192:195], v[232:235], 0
    ds_read_b128 v[160:163], v6 offset:17664
    v_lshlrev_b32 v252, 16, v193
    v_and_b32 v193, s22, v193
    v_mfma_f32_16x16x32_bf16 a[48:51], a[204:207], v[236:239], a[48:51]
    v_fmac_f32 v252, s25, v251
    v_fmac_f32 v193, s25, v201
    v_fmac_f32 v252, s28, v249
    v_mfma_f32_16x16x32_bf16 a[52:55], a[208:211], v[236:239], 0
    v_fmac_f32 v193, s28, v197
    v_cvt_pk_bf16_f32 v193, v252, v193
    v_lshlrev_b32 v252, 16, v203
    v_and_b32 v203, s22, v203
    v_mfma_f32_16x16x32_bf16 a[52:55], a[196:199], v[232:235], a[52:55]
    v_fmac_f32 v252, s29, v248
    v_fmac_f32 v203, s29, v195
    v_fmac_f32 v252, s23, v250
    v_mfma_f32_16x16x32_bf16 a[56:59], a[200:203], v[232:235], 0
    ds_read_b128 v[232:235], v253 offset:1312
    s_add_u32 s44, s41, 1024
    v_fmac_f32 v203, s23, v199
    v_mfma_f32_16x16x32_bf16 a[56:59], a[212:215], v[236:239], a[56:59]
    buffer_load_dwordx2 v[222:223], v227, s[4:7], s19 offen offset:832
    v_cvt_pk_bf16_f32 v203, v252, v203
    v_mfma_f32_16x16x32_bf16 a[36:39], a[216:219], v[236:239], a[36:39]
    v_fma_f32 v252, v249, s24, v251
    v_fmac_f32 v251, -4.0, v249
    v_fma_f32 v249, v248, s24, v250
    v_fmac_f32 v250, -4.0, v248
    v_mfma_f32_16x16x32_bf16 a[40:43], a[220:223], v[236:239], a[40:43]
    v_fma_f32 v248, v250, s26, v251
    v_fmac_f32 v251, s27, v250
    v_fma_f32 v250, v249, 2.0, v252
    v_mfma_f32_16x16x32_bf16 a[44:47], a[224:227], v[236:239], a[44:47]
    v_fmac_f32 v252, -2.0, v249
    v_fma_f32 v249, v197, s24, v201
    v_fmac_f32 v201, -4.0, v197
    v_mfma_f32_16x16x32_bf16 a[60:63], a[192:195], v[236:239], 0
    ds_read_b128 v[164:167], v6 offset:20768
    s_waitcnt lgkmcnt(2)
    v_fma_f32 v197, v195, s24, v199
    v_mfma_f32_16x16x32_bf16 a[60:63], a[204:207], v[228:231], a[60:63]
    buffer_load_dwordx2 v[224:225], v227, s[4:7], s20 offen offset:832
    v_fmac_f32 v199, -4.0, v195
    v_fma_f32 v195, v199, s26, v201
    v_mfma_f32_16x16x32_bf16 a[64:67], a[208:211], v[228:231], 0
    v_fmac_f32 v201, s27, v199
    v_fma_f32 v199, v197, 2.0, v249
    v_fmac_f32 v249, -2.0, v197
    v_mfma_f32_16x16x32_bf16 a[64:67], a[196:199], v[236:239], a[64:67]
    v_cvt_pk_bf16_f32 v195, v248, v195
    v_cvt_pk_bf16_f32 v201, v251, v201
    v_cvt_pk_bf16_f32 v199, v250, v199
    v_mfma_f32_16x16x32_bf16 a[68:71], a[200:203], v[236:239], 0
    ds_read_b128 v[236:239], v253 offset:1056
    v_cvt_pk_bf16_f32 v197, v252, v249
    v_lshrrev_b32 v252, 15, v255
    v_mfma_f32_16x16x32_bf16 a[68:71], a[212:215], v[228:231], a[68:71]
    ds_write_b64 v252, v[194:195] offset:9088
    s_waitcnt vmcnt(18)
    v_lshlrev_b32 v248, 16, v206
    v_mfma_f32_16x16x32_bf16 a[48:51], a[216:219], v[228:231], a[48:51]
    buffer_load_dwordx2 v[226:227], v227, s[4:7], s21 offen offset:832
    v_lshlrev_b32 v249, 16, v208
    v_mfma_f32_16x16x32_bf16 a[52:55], a[220:223], v[228:231], a[52:55]
    ds_write_b64 v252, v[200:201] offset:11168
    v_lshlrev_b32 v250, 16, v210
    v_mfma_f32_16x16x32_bf16 a[56:59], a[224:227], v[228:231], a[56:59]
    s_waitcnt lgkmcnt(4)
    v_lshlrev_b32 v251, 16, v212
    v_mfma_f32_16x16x32_bf16 a[72:75], a[192:195], v[228:231], 0
    ds_write_b64 v252, v[198:199] offset:13248
    v_and_b32 v206, s22, v206
    v_and_b32 v208, s22, v208
    v_mfma_f32_16x16x32_bf16 a[72:75], a[204:207], v[232:235], a[72:75]
    ds_read_b128 v[168:171], v6 offset:23872
    v_mfma_f32_16x16x32_bf16 a[76:79], a[208:211], v[232:235], 0
    ds_write_b64 v252, v[192:193] offset:15328
    v_and_b32 v210, s22, v210
    v_mfma_f32_16x16x32_bf16 a[76:79], a[196:199], v[228:231], a[76:79]
    v_and_b32 v212, s22, v212
    v_mfma_f32_16x16x32_bf16 a[80:83], a[200:203], v[228:231], 0
    ds_read_b128 v[228:231], v253 offset:784
    v_mfma_f32_16x16x32_bf16 a[80:83], a[212:215], v[232:235], a[80:83]
    ds_write_b64 v252, v[202:203] offset:38208
    v_mfma_f32_16x16x32_bf16 a[60:63], a[216:219], v[232:235], a[60:63]
    v_mfma_f32_16x16x32_bf16 a[64:67], a[220:223], v[232:235], a[64:67]
    ds_write_b64 v252, v[196:197] offset:31968
    v_mfma_f32_16x16x32_bf16 a[68:71], a[224:227], v[232:235], a[68:71]
    s_mov_b32 s42, 73728
    v_mfma_f32_16x16x32_bf16 a[84:87], a[192:195], v[232:235], 0
    buffer_load_dwordx4 a[192:195], v254, s[8:11], s42 offen offset:0 sc1
    v_mfma_f32_16x16x32_bf16 a[88:91], a[196:199], v[232:235], 0
    s_waitcnt lgkmcnt(8)
    v_lshlrev_b32 v252, 16, v204
    v_and_b32 v204, s22, v204
    v_mfma_f32_16x16x32_bf16 a[92:95], a[200:203], v[232:235], 0
    ds_read_b128 v[172:175], v6 offset:26976
    v_fmac_f32 v252, s25, v251
    v_mfma_f32_16x16x32_bf16 a[84:87], a[204:207], v[236:239], a[84:87]
    ds_read_b128 v[232:235], v253 offset:3120
    v_fmac_f32 v204, s25, v212
    v_mfma_f32_16x16x32_bf16 a[88:91], a[208:211], v[236:239], a[88:91]
    buffer_load_dwordx4 a[196:199], v254, s[8:11], s42 offen offset:1024 sc1
    v_mfma_f32_16x16x32_bf16 a[92:95], a[212:215], v[236:239], a[92:95]
    v_fmac_f32 v252, s28, v249
    v_fmac_f32 v204, s28, v208
    v_mfma_f32_16x16x32_bf16 a[72:75], a[216:219], v[236:239], a[72:75]
    s_waitcnt lgkmcnt(4)
    v_cvt_pk_bf16_f32 v204, v252, v204
    v_lshlrev_b32 v252, 16, v214
    v_and_b32 v214, s22, v214
    v_mfma_f32_16x16x32_bf16 a[76:79], a[220:223], v[236:239], a[76:79]
    buffer_load_dwordx4 a[200:203], v254, s[8:11], s42 offen offset:2048 sc1
    v_mfma_f32_16x16x32_bf16 a[80:83], a[224:227], v[236:239], a[80:83]
    ds_read_b128 v[236:239], v253 offset:2848
    v_fmac_f32 v252, s29, v248
    v_mfma_f32_16x16x32_bf16 a[84:87], a[216:219], v[228:231], a[84:87]
    s_mov_b32 s42, 76800
    v_fmac_f32 v214, s29, v206
    v_fmac_f32 v252, s23, v250
    v_mfma_f32_16x16x32_bf16 a[88:91], a[220:223], v[228:231], a[88:91]
    buffer_load_dwordx4 a[204:207], v254, s[8:11], s42 offen offset:0 sc1
    v_mfma_f32_16x16x32_bf16 a[92:95], a[224:227], v[228:231], a[92:95]
    ds_read_b128 v[228:231], v253 offset:2592
    v_fmac_f32 v214, s23, v210
    s_waitcnt vmcnt(20)
    s_waitcnt lgkmcnt(2)
sub1:
    v_mfma_f32_16x16x32_bf16 a[96:99], a[228:231], v[232:235], 0
    ds_read_b128 v[176:179], v6 offset:18688
    v_cvt_pk_bf16_f32 v214, v252, v214
    v_mfma_f32_16x16x32_bf16 a[100:103], a[232:235], v[232:235], 0
    buffer_store_dwordx4 v[160:163], v254, s[12:15], s44 offen sc1
    s_add_u32 s44, s41, 4096
    v_fma_f32 v252, v249, s24, v251
    v_mfma_f32_16x16x32_bf16 a[104:107], a[236:239], v[232:235], 0
    ds_read_b128 v[232:235], v253 offset:2336
    v_fmac_f32 v251, -4.0, v249
    s_waitcnt vmcnt(17)
    s_waitcnt lgkmcnt(3)
    v_mfma_f32_16x16x32_bf16 a[96:99], a[240:243], v[236:239], a[96:99]
    buffer_load_dwordx4 a[208:211], v254, s[8:11], s42 offen offset:1024 sc1
    v_mfma_f32_16x16x32_bf16 a[100:103], a[244:247], v[236:239], a[100:103]
    v_fma_f32 v249, v248, s24, v250
    v_fmac_f32 v250, -4.0, v248
    v_mfma_f32_16x16x32_bf16 a[104:107], a[248:251], v[236:239], a[104:107]
    v_fma_f32 v248, v250, s26, v251
    v_fmac_f32 v251, s27, v250
    v_mfma_f32_16x16x32_bf16 a[108:111], a[228:231], v[236:239], 0
    s_waitcnt lgkmcnt(2)
    v_fma_f32 v250, v249, 2.0, v252
    v_fmac_f32 v252, -2.0, v249
    v_mfma_f32_16x16x32_bf16 a[108:111], a[240:243], v[228:231], a[108:111]
    buffer_load_dwordx4 a[212:215], v254, s[8:11], s42 offen offset:2048 sc1
    v_fma_f32 v249, v208, s24, v212
    v_mfma_f32_16x16x32_bf16 a[112:115], a[244:247], v[228:231], 0
    v_fmac_f32 v212, -4.0, v208
    v_fma_f32 v208, v206, s24, v210
    v_mfma_f32_16x16x32_bf16 a[112:115], a[232:235], v[236:239], a[112:115]
    s_mov_b32 s42, 79872
    v_fmac_f32 v210, -4.0, v206
    v_fma_f32 v206, v210, s26, v212
    v_mfma_f32_16x16x32_bf16 a[116:119], a[236:239], v[236:239], 0
    ds_read_b128 v[236:239], v253 offset:2080
    v_fmac_f32 v212, s27, v210
    v_mfma_f32_16x16x32_bf16 a[116:119], a[248:251], v[228:231], a[116:119]
    buffer_load_dwordx4 a[216:219], v254, s[8:11], s42 offen offset:0 sc1
    s_waitcnt vmcnt(15)
    v_mfma_f32_16x16x32_bf16 a[96:99], a[252:255], v[228:231], a[96:99]
    ds_read_b128 v[180:183], v6 offset:21792
    v_fma_f32 v210, v208, 2.0, v249
    v_mfma_f32_16x16x32_bf16 a[100:103], v[240:243], v[228:231], a[100:103]
    buffer_store_dwordx4 v[164:167], v254, s[12:15], s44 offen sc1
    s_add_u32 s44, s41, 7168
    v_mfma_f32_16x16x32_bf16 a[104:107], v[244:247], v[228:231], a[104:107]
    s_waitcnt lgkmcnt(2)
    v_fmac_f32 v249, -2.0, v208
    v_cvt_pk_bf16_f32 v206, v248, v206
    v_cvt_pk_bf16_f32 v212, v251, v212
    v_mfma_f32_16x16x32_bf16 a[120:123], a[228:231], v[228:231], 0
    buffer_load_dwordx4 a[220:223], v254, s[8:11], s42 offen offset:1024 sc1
    v_mfma_f32_16x16x32_bf16 a[120:123], a[240:243], v[232:235], a[120:123]
    buffer_store_dwordx4 v[168:171], v254, s[12:15], s44 offen sc1
    s_add_u32 s44, s41, 10240
    v_mfma_f32_16x16x32_bf16 a[124:127], a[244:247], v[232:235], 0
    v_cvt_pk_bf16_f32 v210, v250, v210
    v_cvt_pk_bf16_f32 v208, v252, v249
    v_mfma_f32_16x16x32_bf16 a[124:127], a[232:235], v[228:231], a[124:127]
    buffer_load_dwordx4 a[224:227], v254, s[8:11], s42 offen offset:2048 sc1
    v_mfma_f32_16x16x32_bf16 a[128:131], a[236:239], v[228:231], 0
    ds_read_b128 v[228:231], v253 offset:3904
    v_and_b32 v203, 0x7fff, v255
    v_mfma_f32_16x16x32_bf16 a[128:131], a[248:251], v[232:235], a[128:131]
    ds_read_b128 v[184:187], v6 offset:24896
    v_lshlrev_b32 v248, 16, v207
    v_mfma_f32_16x16x32_bf16 a[108:111], a[252:255], v[232:235], a[108:111]
    buffer_store_dwordx4 v[172:175], v254, s[12:15], s44 offen sc1
    v_lshlrev_b32 v249, 16, v209
    v_lshlrev_b32 v250, 16, v211
    v_lshlrev_b32 v251, 16, v213
    v_mfma_f32_16x16x32_bf16 a[112:115], v[240:243], v[232:235], a[112:115]
    buffer_load_dwordx2 v[192:193], v203, s[4:7], s16 offen offset:1216
    v_mfma_f32_16x16x32_bf16 a[116:119], v[244:247], v[232:235], a[116:119]
    v_and_b32 v207, s22, v207
    v_and_b32 v209, s22, v209
    v_mfma_f32_16x16x32_bf16 a[132:135], a[228:231], v[232:235], 0
    s_waitcnt lgkmcnt(3)
    v_and_b32 v211, s22, v211
    v_and_b32 v213, s22, v213
    v_mfma_f32_16x16x32_bf16 a[132:135], a[240:243], v[236:239], a[132:135]
    v_lshlrev_b32 v252, 16, v205
    v_and_b32 v205, s22, v205
    v_mfma_f32_16x16x32_bf16 a[136:139], a[244:247], v[236:239], 0
    s_add_u32 s44, s41, 2048
    v_fmac_f32 v252, s25, v251
    v_fmac_f32 v205, s25, v213
    v_mfma_f32_16x16x32_bf16 a[136:139], a[232:235], v[232:235], a[136:139]
    buffer_load_dwordx2 v[194:195], v203, s[4:7], s17 offen offset:1216
    v_fmac_f32 v252, s28, v249
    v_mfma_f32_16x16x32_bf16 a[140:143], a[236:239], v[232:235], 0
    ds_read_b128 v[232:235], v253 offset:3648
    v_fmac_f32 v205, s28, v209
    v_mfma_f32_16x16x32_bf16 a[140:143], a[248:251], v[236:239], a[140:143]
    v_cvt_pk_bf16_f32 v205, v252, v205
    v_lshlrev_b32 v252, 16, v215
    v_mfma_f32_16x16x32_bf16 a[120:123], a[252:255], v[236:239], a[120:123]
    ds_read_b128 v[188:191], v6 offset:28000
    v_and_b32 v215, s22, v215
    v_mfma_f32_16x16x32_bf16 a[124:127], v[240:243], v[236:239], a[124:127]
    v_fmac_f32 v252, s29, v248
    v_fmac_f32 v215, s29, v207
    v_mfma_f32_16x16x32_bf16 a[128:131], v[244:247], v[236:239], a[128:131]
    buffer_load_dwordx2 v[196:197], v203, s[4:7], s18 offen offset:1216
    v_mfma_f32_16x16x32_bf16 a[144:147], a[228:231], v[236:239], 0
    s_waitcnt lgkmcnt(3)
    v_fmac_f32 v252, s23, v250
    v_fmac_f32 v215, s23, v211
    v_mfma_f32_16x16x32_bf16 a[144:147], a[240:243], v[228:231], a[144:147]
    v_cvt_pk_bf16_f32 v215, v252, v215
    v_fma_f32 v252, v249, s24, v251
    v_fmac_f32 v251, -4.0, v249
    v_mfma_f32_16x16x32_bf16 a[148:151], a[244:247], v[228:231], 0
    v_fma_f32 v249, v248, s24, v250
    v_fmac_f32 v250, -4.0, v248
    v_mfma_f32_16x16x32_bf16 a[148:151], a[232:235], v[236:239], a[148:151]
    v_fma_f32 v248, v250, s26, v251
    v_fmac_f32 v251, s27, v250
    v_mfma_f32_16x16x32_bf16 a[152:155], a[236:239], v[236:239], 0
    ds_read_b128 v[236:239], v253 offset:3392
    v_fma_f32 v250, v249, 2.0, v252
    v_mfma_f32_16x16x32_bf16 a[152:155], a[248:251], v[228:231], a[152:155]
    buffer_load_dwordx2 v[198:199], v203, s[4:7], s19 offen offset:1216
    v_mfma_f32_16x16x32_bf16 a[132:135], a[252:255], v[228:231], a[132:135]
    v_fmac_f32 v252, -2.0, v249
    v_fma_f32 v249, v209, s24, v213
    v_mfma_f32_16x16x32_bf16 a[136:139], v[240:243], v[228:231], a[136:139]
    v_fmac_f32 v213, -4.0, v209
    v_fma_f32 v209, v207, s24, v211
    v_mfma_f32_16x16x32_bf16 a[140:143], v[244:247], v[228:231], a[140:143]
    v_fmac_f32 v211, -4.0, v207
    v_fma_f32 v207, v211, s26, v213
    v_fmac_f32 v213, s27, v211
    v_mfma_f32_16x16x32_bf16 a[156:159], a[228:231], v[228:231], 0
    s_waitcnt lgkmcnt(2)
    v_fma_f32 v211, v209, 2.0, v249
    v_fmac_f32 v249, -2.0, v209
    v_mfma_f32_16x16x32_bf16 a[156:159], a[240:243], v[232:235], a[156:159]
    buffer_load_dwordx2 v[200:201], v203, s[4:7], s20 offen offset:1216
    v_mfma_f32_16x16x32_bf16 a[160:163], a[244:247], v[232:235], 0
    v_cvt_pk_bf16_f32 v207, v248, v207
    v_cvt_pk_bf16_f32 v213, v251, v213
    v_mfma_f32_16x16x32_bf16 a[160:163], a[232:235], v[228:231], a[160:163]
    v_cvt_pk_bf16_f32 v211, v250, v211
    v_cvt_pk_bf16_f32 v209, v252, v249
    v_mfma_f32_16x16x32_bf16 a[164:167], a[236:239], v[228:231], 0
    ds_read_b128 v[228:231], v253 offset:3136
    v_lshrrev_b32 v252, 15, v255
    v_mfma_f32_16x16x32_bf16 a[164:167], a[248:251], v[232:235], a[164:167]
    ds_write_b64 v252, v[206:207] offset:8832
    s_waitcnt vmcnt(18)
    v_mfma_f32_16x16x32_bf16 a[144:147], a[252:255], v[232:235], a[144:147]
    buffer_load_dwordx2 v[202:203], v203, s[4:7], s21 offen offset:1216
    v_mfma_f32_16x16x32_bf16 a[148:151], v[240:243], v[232:235], a[148:151]
    v_lshlrev_b32 v248, 16, v218
    v_lshlrev_b32 v249, 16, v220
    v_mfma_f32_16x16x32_bf16 a[152:155], v[244:247], v[232:235], a[152:155]
    ds_write_b64 v252, v[212:213] offset:10912
    v_mfma_f32_16x16x32_bf16 a[168:171], a[228:231], v[232:235], 0
    s_waitcnt lgkmcnt(3)
    v_lshlrev_b32 v250, 16, v222
    v_lshlrev_b32 v251, 16, v224
    v_mfma_f32_16x16x32_bf16 a[168:171], a[240:243], v[236:239], a[168:171]
    ds_write_b64 v252, v[210:211] offset:12992
    v_mfma_f32_16x16x32_bf16 a[172:175], a[244:247], v[236:239], 0
    v_and_b32 v218, s22, v218
    v_and_b32 v220, s22, v220
    v_mfma_f32_16x16x32_bf16 a[172:175], a[232:235], v[232:235], a[172:175]
    ds_write_b64 v252, v[204:205] offset:15072
    v_and_b32 v222, s22, v222
    v_mfma_f32_16x16x32_bf16 a[176:179], a[236:239], v[232:235], 0
    ds_read_b128 v[232:235], v253 offset:2864
    v_and_b32 v224, s22, v224
    v_mfma_f32_16x16x32_bf16 a[176:179], a[248:251], v[236:239], a[176:179]
    ds_write_b64 v252, v[214:215] offset:37952
    v_mfma_f32_16x16x32_bf16 a[156:159], a[252:255], v[236:239], a[156:159]
    v_mfma_f32_16x16x32_bf16 a[160:163], v[240:243], v[236:239], a[160:163]
    ds_write_b64 v252, v[208:209] offset:31712
    v_mfma_f32_16x16x32_bf16 a[164:167], v[244:247], v[236:239], a[164:167]
    s_mov_b32 s42, 110592
    v_mfma_f32_16x16x32_bf16 a[180:183], a[228:231], v[236:239], 0
    buffer_load_dwordx4 a[228:231], v254, s[8:11], s42 offen offset:0 sc1
    v_mfma_f32_16x16x32_bf16 a[184:187], a[232:235], v[236:239], 0
    v_lshlrev_b32 v252, 16, v216
    v_and_b32 v216, s22, v216
    v_mfma_f32_16x16x32_bf16 a[188:191], a[236:239], v[236:239], 0
    s_waitcnt lgkmcnt(2)
    v_fmac_f32 v252, s25, v251
    v_fmac_f32 v216, s25, v224
    v_fmac_f32 v252, s28, v249
    v_mfma_f32_16x16x32_bf16 a[180:183], a[240:243], v[228:231], a[180:183]
    ds_read_b128 v[236:239], v253 offset:5200
    v_fmac_f32 v216, s28, v220
    v_mfma_f32_16x16x32_bf16 a[184:187], a[244:247], v[228:231], a[184:187]
    buffer_load_dwordx4 a[232:235], v254, s[8:11], s42 offen offset:1024 sc1
    v_mfma_f32_16x16x32_bf16 a[188:191], a[248:251], v[228:231], a[188:191]
    ds_read_b128 v[204:207], v253 offset:39712
    v_cvt_pk_bf16_f32 v216, v252, v216
    v_mfma_f32_16x16x32_bf16 a[168:171], a[252:255], v[228:231], a[168:171]
    s_mov_b32 s45, 619910279
    v_lshlrev_b32 v252, 16, v226
    v_and_b32 v226, s22, v226
    v_mfma_f32_16x16x32_bf16 a[172:175], v[240:243], v[228:231], a[172:175]
    buffer_load_dwordx4 a[236:239], v254, s[8:11], s42 offen offset:2048 sc1
    v_fmac_f32 v252, s29, v248
    v_mfma_f32_16x16x32_bf16 a[176:179], v[244:247], v[228:231], a[176:179]
    ds_read_b128 v[228:231], v253 offset:4928
    v_fmac_f32 v226, s29, v218
    v_mfma_f32_16x16x32_bf16 a[180:183], a[252:255], v[232:235], a[180:183]
    s_mov_b32 s42, 113664
    v_bfe_u32 v208, v254, 5, 3
    v_fmac_f32 v252, s23, v250
    v_mfma_f32_16x16x32_bf16 a[184:187], v[240:243], v[232:235], a[184:187]
    buffer_load_dwordx4 a[240:243], v254, s[8:11], s42 offen offset:0 sc1
    v_mfma_f32_16x16x32_bf16 a[188:191], v[244:247], v[232:235], a[188:191]
    ds_read_b128 v[232:235], v253 offset:4672
    v_mul_u32_u24 v209, 5, v208
    s_waitcnt vmcnt(20)
    s_waitcnt lgkmcnt(3)
sub2:
    v_mfma_f32_16x16x32_bf16 v[0:3], a[192:195], v[236:239], 0
    s_waitcnt vmcnt(16) lgkmcnt(1)
    v_fmac_f32 v226, s23, v222
    v_cvt_pk_bf16_f32 v226, v252, v226
    v_fma_f32 v252, v249, s24, v251
    v_mfma_f32_16x16x32_bf16 v[4:7], a[196:199], v[236:239], 0
    buffer_store_dwordx4 v[176:179], v254, s[12:15], s44 offen sc1
    s_add_u32 s44, s41, 5120
    v_mfma_f32_16x16x32_bf16 v[8:11], a[200:203], v[236:239], 0
    ds_read_b128 v[236:239], v253 offset:4416
    v_bfe_u32 v209, s45, v209, 5
    v_mfma_f32_16x16x32_bf16 v[0:3], a[204:207], v[228:231], v[0:3]
    buffer_load_dwordx4 a[244:247], v254, s[8:11], s42 offen offset:1024 sc1
    v_mfma_f32_16x16x32_bf16 v[4:7], a[208:211], v[228:231], v[4:7]
    v_fmac_f32 v251, -4.0, v249
    v_fma_f32 v249, v248, s24, v250
    v_mfma_f32_16x16x32_bf16 v[8:11], a[212:215], v[228:231], v[8:11]
    v_mul_u32_u24 v209, 65, v209
    v_fmac_f32 v250, -4.0, v248
    v_fma_f32 v248, v250, s26, v251
    v_mfma_f32_16x16x32_bf16 v[12:15], a[192:195], v[228:231], 0
    s_waitcnt lgkmcnt(1)
    v_fmac_f32 v251, s27, v250
    v_fma_f32 v250, v249, 2.0, v252
    v_mfma_f32_16x16x32_bf16 v[12:15], a[204:207], v[232:235], v[12:15]
    buffer_load_dwordx4 a[248:251], v254, s[8:11], s42 offen offset:2048 sc1
    v_mfma_f32_16x16x32_bf16 v[16:19], a[208:211], v[232:235], 0
    v_sub_u32 v209, v209, v208
    v_fmac_f32 v252, -2.0, v249
    v_mfma_f32_16x16x32_bf16 v[16:19], a[196:199], v[228:231], v[16:19]
    s_mov_b32 s42, 116736
    v_fma_f32 v249, v220, s24, v224
    v_fmac_f32 v224, -4.0, v220
    v_mfma_f32_16x16x32_bf16 v[20:23], a[200:203], v[228:231], 0
    ds_read_b128 v[228:231], v253 offset:4160
    v_lshl_add_u32 v208, v209, 5, v253
    v_fma_f32 v220, v218, s24, v222
    v_mfma_f32_16x16x32_bf16 v[20:23], a[212:215], v[232:235], v[20:23]
    buffer_load_dwordx4 a[252:255], v254, s[8:11], s42 offen offset:0 sc1
    s_waitcnt vmcnt(15)
    v_mfma_f32_16x16x32_bf16 v[0:3], a[216:219], v[232:235], v[0:3]
    v_fmac_f32 v222, -4.0, v218
    v_fma_f32 v218, v222, s26, v224
    v_mfma_f32_16x16x32_bf16 v[4:7], a[220:223], v[232:235], v[4:7]
    buffer_store_dwordx4 v[180:183], v254, s[12:15], s44 offen sc1
    s_add_u32 s44, s41, 8192
    v_mfma_f32_16x16x32_bf16 v[8:11], a[224:227], v[232:235], v[8:11]
    s_waitcnt lgkmcnt(1)
    v_fmac_f32 v224, s27, v222
    v_fma_f32 v222, v220, 2.0, v249
    v_mfma_f32_16x16x32_bf16 v[24:27], a[192:195], v[232:235], 0
    buffer_load_dwordx4 v[240:243], v254, s[8:11], s42 offen offset:1024 sc1
    v_fmac_f32 v249, -2.0, v220
    v_mfma_f32_16x16x32_bf16 v[24:27], a[204:207], v[236:239], v[24:27]
    buffer_store_dwordx4 v[184:187], v254, s[12:15], s44 offen sc1
    s_add_u32 s44, s41, 11264
    v_mfma_f32_16x16x32_bf16 v[28:31], a[208:211], v[236:239], 0
    s_mov_b64 exec, s[46:47]
    ds_write_b128 v208, v[204:207] offset:1024
    s_mov_b64 exec, -1
    v_mfma_f32_16x16x32_bf16 v[28:31], a[196:199], v[232:235], v[28:31]
    buffer_load_dwordx4 v[244:247], v254, s[8:11], s42 offen offset:2048 sc1
    v_mfma_f32_16x16x32_bf16 v[32:35], a[200:203], v[232:235], 0
    ds_read_b128 v[232:235], v253 offset:5984
    v_and_b32 v215, 0x7fff, v255
    v_mfma_f32_16x16x32_bf16 v[32:35], a[212:215], v[236:239], v[32:35]
    v_cvt_pk_bf16_f32 v218, v248, v218
    v_cvt_pk_bf16_f32 v224, v251, v224
    v_cvt_pk_bf16_f32 v222, v250, v222
    v_mfma_f32_16x16x32_bf16 v[12:15], a[216:219], v[236:239], v[12:15]
    buffer_store_dwordx4 v[188:191], v254, s[12:15], s44 offen sc1
    v_cvt_pk_bf16_f32 v220, v252, v249
    v_lshlrev_b32 v248, 16, v219
    v_mfma_f32_16x16x32_bf16 v[16:19], a[220:223], v[236:239], v[16:19]
    buffer_load_dwordx2 v[204:205], v215, s[4:7], s16 offen offset:128
    v_mfma_f32_16x16x32_bf16 v[20:23], a[224:227], v[236:239], v[20:23]
    v_lshlrev_b32 v249, 16, v221
    v_lshlrev_b32 v250, 16, v223
    v_mfma_f32_16x16x32_bf16 v[36:39], a[192:195], v[236:239], 0
    s_waitcnt lgkmcnt(2)
    v_lshlrev_b32 v251, 16, v225
    v_and_b32 v219, s22, v219
    v_mfma_f32_16x16x32_bf16 v[36:39], a[204:207], v[228:231], v[36:39]
    v_and_b32 v221, s22, v221
    v_and_b32 v223, s22, v223
    v_and_b32 v225, s22, v225
    v_mfma_f32_16x16x32_bf16 v[40:43], a[208:211], v[228:231], 0
    v_lshlrev_b32 v252, 16, v217
    v_and_b32 v217, s22, v217
    v_mfma_f32_16x16x32_bf16 v[40:43], a[196:199], v[236:239], v[40:43]
    buffer_load_dwordx2 v[206:207], v215, s[4:7], s17 offen offset:128
    v_mfma_f32_16x16x32_bf16 v[44:47], a[200:203], v[236:239], 0
    ds_read_b128 v[236:239], v253 offset:5728
    v_fmac_f32 v252, s25, v251
    v_mfma_f32_16x16x32_bf16 v[44:47], a[212:215], v[228:231], v[44:47]
    v_fmac_f32 v217, s25, v225
    v_fmac_f32 v252, s28, v249
    v_mfma_f32_16x16x32_bf16 v[24:27], a[216:219], v[228:231], v[24:27]
    v_fmac_f32 v217, s28, v221
    v_cvt_pk_bf16_f32 v217, v252, v217
    v_lshlrev_b32 v252, 16, v227
    v_mfma_f32_16x16x32_bf16 v[28:31], a[220:223], v[228:231], v[28:31]
    v_and_b32 v227, s22, v227
    v_fmac_f32 v252, s29, v248
    v_mfma_f32_16x16x32_bf16 v[32:35], a[224:227], v[228:231], v[32:35]
    buffer_load_dwordx2 v[208:209], v215, s[4:7], s18 offen offset:128
    v_mfma_f32_16x16x32_bf16 v[48:51], a[192:195], v[228:231], 0
    s_waitcnt lgkmcnt(1)
    v_fmac_f32 v227, s29, v219
    v_fmac_f32 v252, s23, v250
    v_mfma_f32_16x16x32_bf16 v[48:51], a[204:207], v[232:235], v[48:51]
    v_fmac_f32 v227, s23, v223
    v_cvt_pk_bf16_f32 v227, v252, v227
    v_mfma_f32_16x16x32_bf16 v[52:55], a[208:211], v[232:235], 0
    v_fma_f32 v252, v249, s24, v251
    v_fmac_f32 v251, -4.0, v249
    v_fma_f32 v249, v248, s24, v250
    v_mfma_f32_16x16x32_bf16 v[52:55], a[196:199], v[228:231], v[52:55]
    v_fmac_f32 v250, -4.0, v248
    v_fma_f32 v248, v250, s26, v251
    v_mfma_f32_16x16x32_bf16 v[56:59], a[200:203], v[228:231], 0
    ds_read_b128 v[228:231], v253 offset:5472
    v_fmac_f32 v251, s27, v250
    v_mfma_f32_16x16x32_bf16 v[56:59], a[212:215], v[232:235], v[56:59]
    buffer_load_dwordx2 v[210:211], v215, s[4:7], s19 offen offset:128
    v_mfma_f32_16x16x32_bf16 v[36:39], a[216:219], v[232:235], v[36:39]
    v_fma_f32 v250, v249, 2.0, v252
    v_fmac_f32 v252, -2.0, v249
    v_mfma_f32_16x16x32_bf16 v[40:43], a[220:223], v[232:235], v[40:43]
pad1:
    s_cbranch_vccnz pad5
    v_fma_f32 v249, v221, s24, v225
    v_fmac_f32 v225, -4.0, v221
    v_fma_f32 v221, v219, s24, v223
    v_mfma_f32_16x16x32_bf16 v[44:47], a[224:227], v[232:235], v[44:47]
    v_fmac_f32 v223, -4.0, v219
    v_fma_f32 v219, v223, s26, v225
    v_mfma_f32_16x16x32_bf16 v[60:63], a[192:195], v[232:235], 0
    s_waitcnt lgkmcnt(1)
    v_fmac_f32 v225, s27, v223
    v_fma_f32 v223, v221, 2.0, v249
    v_mfma_f32_16x16x32_bf16 v[60:63], a[204:207], v[236:239], v[60:63]
    buffer_load_dwordx2 v[212:213], v215, s[4:7], s20 offen offset:128
    v_mfma_f32_16x16x32_bf16 v[64:67], a[208:211], v[236:239], 0
    v_fmac_f32 v249, -2.0, v221
    v_cvt_pk_bf16_f32 v219, v248, v219
    v_mfma_f32_16x16x32_bf16 v[64:67], a[196:199], v[232:235], v[64:67]
    v_cvt_pk_bf16_f32 v225, v251, v225
    v_cvt_pk_bf16_f32 v223, v250, v223
    v_cvt_pk_bf16_f32 v221, v252, v249
    v_mfma_f32_16x16x32_bf16 v[68:71], a[200:203], v[232:235], 0
    ds_read_b128 v[232:235], v253 offset:5216
    v_lshrrev_b32 v252, 15, v255
    v_mfma_f32_16x16x32_bf16 v[68:71], a[212:215], v[236:239], v[68:71]
    ds_write_b64 v252, v[218:219] offset:8576
    v_mfma_f32_16x16x32_bf16 v[48:51], a[216:219], v[236:239], v[48:51]
    buffer_load_dwordx2 v[214:215], v215, s[4:7], s21 offen offset:128
    v_mfma_f32_16x16x32_bf16 v[52:55], a[220:223], v[236:239], v[52:55]
    s_waitcnt vmcnt(19)
    v_lshlrev_b32 v248, 16, v194
    v_lshlrev_b32 v249, 16, v196
    v_mfma_f32_16x16x32_bf16 v[56:59], a[224:227], v[236:239], v[56:59]
    ds_write_b64 v252, v[224:225] offset:10656
    v_lshlrev_b32 v250, 16, v198
    v_mfma_f32_16x16x32_bf16 v[72:75], a[192:195], v[236:239], 0
    s_waitcnt lgkmcnt(3)
    v_lshlrev_b32 v251, 16, v200
    v_mfma_f32_16x16x32_bf16 v[72:75], a[204:207], v[228:231], v[72:75]
    ds_write_b64 v252, v[222:223] offset:12736
    v_mfma_f32_16x16x32_bf16 v[76:79], a[208:211], v[228:231], 0
    v_and_b32 v194, s22, v194
    v_and_b32 v196, s22, v196
    v_mfma_f32_16x16x32_bf16 v[76:79], a[196:199], v[236:239], v[76:79]
    ds_write_b64 v252, v[216:217] offset:14816
    v_mfma_f32_16x16x32_bf16 v[80:83], a[200:203], v[236:239], 0
    ds_read_b128 v[236:239], v253 offset:4944
    v_and_b32 v198, s22, v198
    v_and_b32 v200, s22, v200
    v_mfma_f32_16x16x32_bf16 v[80:83], a[212:215], v[228:231], v[80:83]
    ds_write_b64 v252, v[226:227] offset:37696
    v_mfma_f32_16x16x32_bf16 v[60:63], a[216:219], v[228:231], v[60:63]
    v_mfma_f32_16x16x32_bf16 v[64:67], a[220:223], v[228:231], v[64:67]
    ds_write_b64 v252, v[220:221] offset:31456
    v_mfma_f32_16x16x32_bf16 v[68:71], a[224:227], v[228:231], v[68:71]
    s_mov_b32 s42, 147456
    v_mfma_f32_16x16x32_bf16 v[84:87], a[192:195], v[228:231], 0
    buffer_load_dwordx4 a[192:195], v254, s[8:11], s42 offen offset:0 sc1
    v_mfma_f32_16x16x32_bf16 v[88:91], a[196:199], v[228:231], 0
    v_lshlrev_b32 v252, 16, v192
    v_and_b32 v192, s22, v192
    v_mfma_f32_16x16x32_bf16 v[92:95], a[200:203], v[228:231], 0
    s_waitcnt lgkmcnt(7)
    v_fmac_f32 v252, s25, v251
    v_fmac_f32 v192, s25, v200
    v_mfma_f32_16x16x32_bf16 v[84:87], a[204:207], v[232:235], v[84:87]
    ds_read_b128 v[228:231], v253 offset:7280
    v_fmac_f32 v252, s28, v249
    v_mfma_f32_16x16x32_bf16 v[88:91], a[208:211], v[232:235], v[88:91]
    buffer_load_dwordx4 a[196:199], v254, s[8:11], s42 offen offset:1024 sc1
    v_mfma_f32_16x16x32_bf16 v[92:95], a[212:215], v[232:235], v[92:95]
    v_fmac_f32 v192, s28, v196
    v_cvt_pk_bf16_f32 v192, v252, v192
    v_mfma_f32_16x16x32_bf16 v[72:75], a[216:219], v[232:235], v[72:75]
    s_waitcnt lgkmcnt(3)
    v_lshlrev_b32 v252, 16, v202
    v_and_b32 v202, s22, v202
    v_mfma_f32_16x16x32_bf16 v[76:79], a[220:223], v[232:235], v[76:79]
    buffer_load_dwordx4 a[200:203], v254, s[8:11], s42 offen offset:2048 sc1
    v_mfma_f32_16x16x32_bf16 v[80:83], a[224:227], v[232:235], v[80:83]
    ds_read_b128 v[232:235], v253 offset:7008
    v_fmac_f32 v252, s29, v248
    v_mfma_f32_16x16x32_bf16 v[84:87], a[216:219], v[236:239], v[84:87]
    s_mov_b32 s42, 150528
    v_fmac_f32 v202, s29, v194
    v_fmac_f32 v252, s23, v250
    v_mfma_f32_16x16x32_bf16 v[88:91], a[220:223], v[236:239], v[88:91]
    buffer_load_dwordx4 a[204:207], v254, s[8:11], s42 offen offset:0 sc1
    v_mfma_f32_16x16x32_bf16 v[92:95], a[224:227], v[236:239], v[92:95]
    ds_read_b128 v[236:239], v253 offset:6752
    v_fmac_f32 v202, s23, v198
    s_waitcnt vmcnt(20)
    s_waitcnt lgkmcnt(2)
sub3:
    v_mfma_f32_16x16x32_bf16 v[96:99], a[228:231], v[228:231], 0
    v_cvt_pk_bf16_f32 v202, v252, v202
    v_fma_f32 v252, v249, s24, v251
    v_mfma_f32_16x16x32_bf16 v[100:103], a[232:235], v[228:231], 0
    s_waitcnt vmcnt(16) lgkmcnt(1)
    v_fmac_f32 v251, -4.0, v249
    v_fma_f32 v249, v248, s24, v250
    v_mfma_f32_16x16x32_bf16 v[104:107], a[236:239], v[228:231], 0
    ds_read_b128 v[228:231], v253 offset:6496
    v_fmac_f32 v250, -4.0, v248
    v_mfma_f32_16x16x32_bf16 v[96:99], a[240:243], v[232:235], v[96:99]
    buffer_load_dwordx4 a[208:211], v254, s[8:11], s42 offen offset:1024 sc1
    v_mfma_f32_16x16x32_bf16 v[100:103], a[244:247], v[232:235], v[100:103]
    v_fma_f32 v248, v250, s26, v251
    v_fmac_f32 v251, s27, v250
    v_mfma_f32_16x16x32_bf16 v[104:107], a[248:251], v[232:235], v[104:107]
    v_fma_f32 v250, v249, 2.0, v252
    v_fmac_f32 v252, -2.0, v249
    v_mfma_f32_16x16x32_bf16 v[108:111], a[228:231], v[232:235], 0
    s_waitcnt lgkmcnt(1)
    v_fma_f32 v249, v196, s24, v200
    v_fmac_f32 v200, -4.0, v196
    v_mfma_f32_16x16x32_bf16 v[108:111], a[240:243], v[236:239], v[108:111]
    buffer_load_dwordx4 a[212:215], v254, s[8:11], s42 offen offset:2048 sc1
    v_mfma_f32_16x16x32_bf16 v[112:115], a[244:247], v[236:239], 0
    v_fma_f32 v196, v194, s24, v198
    v_fmac_f32 v198, -4.0, v194
    v_mfma_f32_16x16x32_bf16 v[112:115], a[232:235], v[232:235], v[112:115]
    s_mov_b32 s42, 153600
    v_fma_f32 v194, v198, s26, v200
    v_fmac_f32 v200, s27, v198
    v_mfma_f32_16x16x32_bf16 v[116:119], a[236:239], v[232:235], 0
    ds_read_b128 v[232:235], v253 offset:6240
    v_fma_f32 v198, v196, 2.0, v249
    v_mfma_f32_16x16x32_bf16 v[116:119], a[248:251], v[236:239], v[116:119]
    buffer_load_dwordx4 a[216:219], v254, s[8:11], s42 offen offset:0 sc1
    s_waitcnt vmcnt(14)
    v_mfma_f32_16x16x32_bf16 v[96:99], a[252:255], v[236:239], v[96:99]
    v_fmac_f32 v249, -2.0, v196
    v_cvt_pk_bf16_f32 v194, v248, v194
    v_mfma_f32_16x16x32_bf16 v[100:103], v[240:243], v[236:239], v[100:103]
    v_cvt_pk_bf16_f32 v200, v251, v200
    v_cvt_pk_bf16_f32 v198, v250, v198
    v_mfma_f32_16x16x32_bf16 v[104:107], v[244:247], v[236:239], v[104:107]
    s_waitcnt lgkmcnt(1)
    v_cvt_pk_bf16_f32 v196, v252, v249
    v_lshlrev_b32 v248, 16, v195
    v_mfma_f32_16x16x32_bf16 v[120:123], a[228:231], v[236:239], 0
    buffer_load_dwordx4 a[220:223], v254, s[8:11], s42 offen offset:1024 sc1
    v_mfma_f32_16x16x32_bf16 v[120:123], a[240:243], v[228:231], v[120:123]
    v_lshlrev_b32 v249, 16, v197
    v_lshlrev_b32 v250, 16, v199
    v_mfma_f32_16x16x32_bf16 v[124:127], a[244:247], v[228:231], 0
    v_lshlrev_b32 v251, 16, v201
    v_and_b32 v195, s22, v195
    v_mfma_f32_16x16x32_bf16 v[124:127], a[232:235], v[236:239], v[124:127]
    buffer_load_dwordx4 a[224:227], v254, s[8:11], s42 offen offset:2048 sc1
    v_mfma_f32_16x16x32_bf16 v[128:131], a[236:239], v[236:239], 0
    ds_read_b128 v[236:239], v253 offset:8064
    v_and_b32 v227, 0x7fff, v255
    v_mfma_f32_16x16x32_bf16 v[128:131], a[248:251], v[228:231], v[128:131]
    v_and_b32 v197, s22, v197
    v_and_b32 v199, s22, v199
    v_mfma_f32_16x16x32_bf16 v[108:111], a[252:255], v[228:231], v[108:111]
    v_and_b32 v201, s22, v201
    v_lshlrev_b32 v252, 16, v193
    v_mfma_f32_16x16x32_bf16 v[112:115], v[240:243], v[228:231], v[112:115]
    buffer_load_dwordx2 v[216:217], v227, s[4:7], s16 offen offset:512
    v_mfma_f32_16x16x32_bf16 v[116:119], v[244:247], v[228:231], v[116:119]
    v_and_b32 v193, s22, v193
    v_fmac_f32 v252, s25, v251
    v_mfma_f32_16x16x32_bf16 v[132:135], a[228:231], v[228:231], 0
    s_waitcnt lgkmcnt(1)
    v_fmac_f32 v193, s25, v201
    v_fmac_f32 v252, s28, v249
    v_mfma_f32_16x16x32_bf16 v[132:135], a[240:243], v[232:235], v[132:135]
    v_fmac_f32 v193, s28, v197
    v_cvt_pk_bf16_f32 v193, v252, v193
    v_mfma_f32_16x16x32_bf16 v[136:139], a[244:247], v[232:235], 0
    v_lshlrev_b32 v252, 16, v203
    v_and_b32 v203, s22, v203
    v_mfma_f32_16x16x32_bf16 v[136:139], a[232:235], v[228:231], v[136:139]
    buffer_load_dwordx2 v[218:219], v227, s[4:7], s17 offen offset:512
    v_mfma_f32_16x16x32_bf16 v[140:143], a[236:239], v[228:231], 0
    ds_read_b128 v[228:231], v253 offset:7808
    v_fmac_f32 v252, s29, v248
    v_mfma_f32_16x16x32_bf16 v[140:143], a[248:251], v[232:235], v[140:143]
    v_fmac_f32 v203, s29, v195
    v_fmac_f32 v252, s23, v250
    v_mfma_f32_16x16x32_bf16 v[120:123], a[252:255], v[232:235], v[120:123]
    v_fmac_f32 v203, s23, v199
    v_cvt_pk_bf16_f32 v203, v252, v203
    v_mfma_f32_16x16x32_bf16 v[124:127], v[240:243], v[232:235], v[124:127]
    v_fma_f32 v252, v249, s24, v251
    v_fmac_f32 v251, -4.0, v249
    v_mfma_f32_16x16x32_bf16 v[128:131], v[244:247], v[232:235], v[128:131]
    buffer_load_dwordx2 v[220:221], v227, s[4:7], s18 offen offset:512
    v_mfma_f32_16x16x32_bf16 v[144:147], a[228:231], v[232:235], 0
    s_waitcnt lgkmcnt(1)
    v_fma_f32 v249, v248, s24, v250
    v_fmac_f32 v250, -4.0, v248
    v_mfma_f32_16x16x32_bf16 v[144:147], a[240:243], v[236:239], v[144:147]
    v_fma_f32 v248, v250, s26, v251
    v_fmac_f32 v251, s27, v250
    v_mfma_f32_16x16x32_bf16 v[148:151], a[244:247], v[236:239], 0
    v_fma_f32 v250, v249, 2.0, v252
    v_fmac_f32 v252, -2.0, v249
    v_mfma_f32_16x16x32_bf16 v[148:151], a[232:235], v[232:235], v[148:151]
    v_fma_f32 v249, v197, s24, v201
    v_fmac_f32 v201, -4.0, v197
    v_mfma_f32_16x16x32_bf16 v[152:155], a[236:239], v[232:235], 0
    ds_read_b128 v[232:235], v253 offset:7552
    v_fma_f32 v197, v195, s24, v199
    v_mfma_f32_16x16x32_bf16 v[152:155], a[248:251], v[236:239], v[152:155]
    buffer_load_dwordx2 v[222:223], v227, s[4:7], s19 offen offset:512
    v_mfma_f32_16x16x32_bf16 v[132:135], a[252:255], v[236:239], v[132:135]
    v_fmac_f32 v199, -4.0, v195
    v_fma_f32 v195, v199, s26, v201
    v_mfma_f32_16x16x32_bf16 v[136:139], v[240:243], v[236:239], v[136:139]
    v_fmac_f32 v201, s27, v199
    v_fma_f32 v199, v197, 2.0, v249
    v_mfma_f32_16x16x32_bf16 v[140:143], v[244:247], v[236:239], v[140:143]
    v_fmac_f32 v249, -2.0, v197
    v_cvt_pk_bf16_f32 v195, v248, v195
    v_mfma_f32_16x16x32_bf16 v[156:159], a[228:231], v[236:239], 0
    s_waitcnt lgkmcnt(1)
    v_cvt_pk_bf16_f32 v201, v251, v201
    v_cvt_pk_bf16_f32 v199, v250, v199
    v_mfma_f32_16x16x32_bf16 v[156:159], a[240:243], v[228:231], v[156:159]
    buffer_load_dwordx2 v[224:225], v227, s[4:7], s20 offen offset:512
    v_mfma_f32_16x16x32_bf16 v[160:163], a[244:247], v[228:231], 0
    v_cvt_pk_bf16_f32 v197, v252, v249
    v_lshrrev_b32 v252, 15, v255
    v_mfma_f32_16x16x32_bf16 v[160:163], a[232:235], v[236:239], v[160:163]
    ds_write_b64 v252, v[194:195] offset:8320
    v_mfma_f32_16x16x32_bf16 v[164:167], a[236:239], v[236:239], 0
    ds_read_b128 v[236:239], v253 offset:7296
    s_waitcnt vmcnt(14)
    v_mfma_f32_16x16x32_bf16 v[164:167], a[248:251], v[228:231], v[164:167]
    v_lshlrev_b32 v248, 16, v206
    v_lshlrev_b32 v249, 16, v208
    v_mfma_f32_16x16x32_bf16 v[144:147], a[252:255], v[228:231], v[144:147]
    buffer_load_dwordx2 v[226:227], v227, s[4:7], s21 offen offset:512
    v_mfma_f32_16x16x32_bf16 v[148:151], v[240:243], v[228:231], v[148:151]
    ds_write_b64 v252, v[200:201] offset:10400
    v_mfma_f32_16x16x32_bf16 v[152:155], v[244:247], v[228:231], v[152:155]
    s_waitcnt lgkmcnt(3)
    v_lshlrev_b32 v250, 16, v210
    v_lshlrev_b32 v251, 16, v212
    v_mfma_f32_16x16x32_bf16 v[168:171], a[228:231], v[228:231], 0
    ds_write_b64 v252, v[198:199] offset:12480
    v_mfma_f32_16x16x32_bf16 v[168:171], a[240:243], v[232:235], v[168:171]
    v_and_b32 v206, s22, v206
    v_and_b32 v208, s22, v208
    v_mfma_f32_16x16x32_bf16 v[172:175], a[244:247], v[232:235], 0
    ds_write_b64 v252, v[192:193] offset:14560
    v_mfma_f32_16x16x32_bf16 v[172:175], a[232:235], v[228:231], v[172:175]
    v_and_b32 v210, s22, v210
    v_and_b32 v212, s22, v212
    v_mfma_f32_16x16x32_bf16 v[176:179], a[236:239], v[228:231], 0
    ds_read_b128 v[228:231], v253 offset:7024
    v_mfma_f32_16x16x32_bf16 v[176:179], a[248:251], v[232:235], v[176:179]
    ds_write_b64 v252, v[202:203] offset:37440
    v_mfma_f32_16x16x32_bf16 v[156:159], a[252:255], v[232:235], v[156:159]
    s_waitcnt lgkmcnt(5)
    v_mfma_f32_16x16x32_bf16 v[160:163], v[240:243], v[232:235], v[160:163]
    ds_write_b64 v252, v[196:197] offset:31200
    v_mfma_f32_16x16x32_bf16 v[164:167], v[244:247], v[232:235], v[164:167]
    s_mov_b32 s42, 184320
    v_mfma_f32_16x16x32_bf16 v[180:183], a[228:231], v[232:235], 0
    buffer_load_dwordx4 a[228:231], v254, s[8:11], s42 offen offset:0 sc1
    v_mfma_f32_16x16x32_bf16 v[184:187], a[232:235], v[232:235], 0
    s_waitcnt lgkmcnt(0)
    v_lshlrev_b32 v252, 16, v204
    v_and_b32 v204, s22, v204
    v_mfma_f32_16x16x32_bf16 v[188:191], a[236:239], v[232:235], 0
    s_barrier
    v_mfma_f32_16x16x32_bf16 v[180:183], a[240:243], v[236:239], v[180:183]
    ds_read_b128 v[232:235], v253 offset:9360
    v_fmac_f32 v252, s25, v251
    v_fmac_f32 v204, s25, v212
    v_mfma_f32_16x16x32_bf16 v[184:187], a[244:247], v[236:239], v[184:187]
    buffer_load_dwordx4 a[232:235], v254, s[8:11], s42 offen offset:1024 sc1
    v_mfma_f32_16x16x32_bf16 v[188:191], a[248:251], v[236:239], v[188:191]
    v_fmac_f32 v252, s28, v249
    v_fmac_f32 v204, s28, v208
    v_mfma_f32_16x16x32_bf16 v[168:171], a[252:255], v[236:239], v[168:171]
    v_cvt_pk_bf16_f32 v204, v252, v204
    v_lshlrev_b32 v252, 16, v214
    v_mfma_f32_16x16x32_bf16 v[172:175], v[240:243], v[236:239], v[172:175]
    buffer_load_dwordx4 a[236:239], v254, s[8:11], s42 offen offset:2048 sc1
    v_mfma_f32_16x16x32_bf16 v[176:179], v[244:247], v[236:239], v[176:179]
    ds_read_b128 v[236:239], v253 offset:9088
    v_and_b32 v214, s22, v214
    v_mfma_f32_16x16x32_bf16 v[180:183], a[252:255], v[228:231], v[180:183]
    s_mov_b32 s42, 187392
    v_fmac_f32 v252, s29, v248
    v_fmac_f32 v214, s29, v206
    v_mfma_f32_16x16x32_bf16 v[184:187], v[240:243], v[228:231], v[184:187]
    buffer_load_dwordx4 a[240:243], v254, s[8:11], s42 offen offset:0 sc1
    v_mfma_f32_16x16x32_bf16 v[188:191], v[244:247], v[228:231], v[188:191]
    ds_read_b128 v[228:231], v253 offset:8832
    v_fmac_f32 v252, s23, v250
    s_waitcnt vmcnt(16)
    s_waitcnt lgkmcnt(2)
sub4:
    v_mfma_f32_16x16x32_bf16 a[0:3], a[192:195], v[232:235], a[0:3]
    v_fmac_f32 v214, s23, v210
    v_cvt_pk_bf16_f32 v214, v252, v214
    v_mfma_f32_16x16x32_bf16 a[4:7], a[196:199], v[232:235], a[4:7]
    s_waitcnt vmcnt(13) lgkmcnt(1)
    v_fma_f32 v252, v249, s24, v251
    v_fmac_f32 v251, -4.0, v249
    v_mfma_f32_16x16x32_bf16 a[8:11], a[200:203], v[232:235], a[8:11]
    ds_read_b128 v[232:235], v253 offset:8576
    v_fma_f32 v249, v248, s24, v250
    v_mfma_f32_16x16x32_bf16 a[0:3], a[204:207], v[236:239], a[0:3]
    buffer_load_dwordx4 a[244:247], v254, s[8:11], s42 offen offset:1024 sc1
    v_mfma_f32_16x16x32_bf16 a[4:7], a[208:211], v[236:239], a[4:7]
    v_fmac_f32 v250, -4.0, v248
    v_fma_f32 v248, v250, s26, v251
    v_mfma_f32_16x16x32_bf16 a[8:11], a[212:215], v[236:239], a[8:11]
    v_fmac_f32 v251, s27, v250
    v_fma_f32 v250, v249, 2.0, v252
    v_mfma_f32_16x16x32_bf16 a[12:15], a[192:195], v[236:239], a[12:15]
    s_waitcnt lgkmcnt(1)
    v_fmac_f32 v252, -2.0, v249
    v_fma_f32 v249, v208, s24, v212
    v_mfma_f32_16x16x32_bf16 a[12:15], a[204:207], v[228:231], a[12:15]
    buffer_load_dwordx4 a[248:251], v254, s[8:11], s42 offen offset:2048 sc1
    v_mfma_f32_16x16x32_bf16 a[16:19], a[208:211], v[228:231], a[16:19]
    v_fmac_f32 v212, -4.0, v208
    v_fma_f32 v208, v206, s24, v210
    v_mfma_f32_16x16x32_bf16 a[16:19], a[196:199], v[236:239], a[16:19]
    s_mov_b32 s42, 190464
    v_fmac_f32 v210, -4.0, v206
    v_fma_f32 v206, v210, s26, v212
    v_mfma_f32_16x16x32_bf16 a[20:23], a[200:203], v[236:239], a[20:23]
    ds_read_b128 v[236:239], v253 offset:8320
    v_fmac_f32 v212, s27, v210
    v_mfma_f32_16x16x32_bf16 a[20:23], a[212:215], v[228:231], a[20:23]
    buffer_load_dwordx4 a[252:255], v254, s[8:11], s42 offen offset:0 sc1
    v_fma_f32 v210, v208, 2.0, v249
    s_waitcnt vmcnt(13)
    v_mfma_f32_16x16x32_bf16 a[0:3], a[216:219], v[228:231], a[0:3]
    v_fmac_f32 v249, -2.0, v208
    v_cvt_pk_bf16_f32 v206, v248, v206
    v_mfma_f32_16x16x32_bf16 a[4:7], a[220:223], v[228:231], a[4:7]
    v_cvt_pk_bf16_f32 v212, v251, v212
    v_cvt_pk_bf16_f32 v210, v250, v210
    v_mfma_f32_16x16x32_bf16 a[8:11], a[224:227], v[228:231], a[8:11]
    s_waitcnt lgkmcnt(1)
    v_cvt_pk_bf16_f32 v208, v252, v249
    v_lshlrev_b32 v248, 16, v207
    v_mfma_f32_16x16x32_bf16 a[24:27], a[192:195], v[228:231], a[24:27]
    buffer_load_dwordx4 v[240:243], v254, s[8:11], s42 offen offset:1024 sc1
    v_mfma_f32_16x16x32_bf16 a[24:27], a[204:207], v[232:235], a[24:27]
    v_lshlrev_b32 v249, 16, v209
    v_lshlrev_b32 v250, 16, v211
    v_mfma_f32_16x16x32_bf16 a[28:31], a[208:211], v[232:235], a[28:31]
    v_lshlrev_b32 v251, 16, v213
    v_and_b32 v207, s22, v207
    v_mfma_f32_16x16x32_bf16 a[28:31], a[196:199], v[228:231], a[28:31]
    buffer_load_dwordx4 v[244:247], v254, s[8:11], s42 offen offset:2048 sc1
    v_mfma_f32_16x16x32_bf16 a[32:35], a[200:203], v[228:231], a[32:35]
    ds_read_b128 v[228:231], v253 offset:10144
    v_and_b32 v203, 0x7fff, v255
    v_mfma_f32_16x16x32_bf16 a[32:35], a[212:215], v[232:235], a[32:35]
    v_and_b32 v209, s22, v209
    v_and_b32 v211, s22, v211
    v_mfma_f32_16x16x32_bf16 a[12:15], a[216:219], v[232:235], a[12:15]
    v_and_b32 v213, s22, v213
    v_lshlrev_b32 v252, 16, v205
    v_mfma_f32_16x16x32_bf16 a[16:19], a[220:223], v[232:235], a[16:19]
    buffer_load_dwordx2 v[192:193], v203, s[4:7], s16 offen offset:896
    v_mfma_f32_16x16x32_bf16 a[20:23], a[224:227], v[232:235], a[20:23]
    v_and_b32 v205, s22, v205
    v_fmac_f32 v252, s25, v251
    v_mfma_f32_16x16x32_bf16 a[36:39], a[192:195], v[232:235], a[36:39]
    s_waitcnt lgkmcnt(1)
    v_fmac_f32 v205, s25, v213
    v_fmac_f32 v252, s28, v249
    v_mfma_f32_16x16x32_bf16 a[36:39], a[204:207], v[236:239], a[36:39]
    v_fmac_f32 v205, s28, v209
    v_cvt_pk_bf16_f32 v205, v252, v205
    v_mfma_f32_16x16x32_bf16 a[40:43], a[208:211], v[236:239], a[40:43]
    v_lshlrev_b32 v252, 16, v215
    v_and_b32 v215, s22, v215
    v_mfma_f32_16x16x32_bf16 a[40:43], a[196:199], v[232:235], a[40:43]
    buffer_load_dwordx2 v[194:195], v203, s[4:7], s17 offen offset:896
    v_mfma_f32_16x16x32_bf16 a[44:47], a[200:203], v[232:235], a[44:47]
    ds_read_b128 v[232:235], v253 offset:9888
    v_fmac_f32 v252, s29, v248
    v_mfma_f32_16x16x32_bf16 a[44:47], a[212:215], v[236:239], a[44:47]
    v_fmac_f32 v215, s29, v207
    v_fmac_f32 v252, s23, v250
    v_mfma_f32_16x16x32_bf16 a[24:27], a[216:219], v[236:239], a[24:27]
    v_fmac_f32 v215, s23, v211
    v_cvt_pk_bf16_f32 v215, v252, v215
    v_mfma_f32_16x16x32_bf16 a[28:31], a[220:223], v[236:239], a[28:31]
    v_fma_f32 v252, v249, s24, v251
    v_fmac_f32 v251, -4.0, v249
    v_fma_f32 v249, v248, s24, v250
    v_mfma_f32_16x16x32_bf16 a[32:35], a[224:227], v[236:239], a[32:35]
    buffer_load_dwordx2 v[196:197], v203, s[4:7], s18 offen offset:896
    v_mfma_f32_16x16x32_bf16 a[48:51], a[192:195], v[236:239], a[48:51]
    s_waitcnt lgkmcnt(1)
    v_fmac_f32 v250, -4.0, v248
    v_fma_f32 v248, v250, s26, v251
    v_mfma_f32_16x16x32_bf16 a[48:51], a[204:207], v[228:231], a[48:51]
    v_fmac_f32 v251, s27, v250
    v_fma_f32 v250, v249, 2.0, v252
    v_mfma_f32_16x16x32_bf16 a[52:55], a[208:211], v[228:231], a[52:55]
    v_fmac_f32 v252, -2.0, v249
    v_fma_f32 v249, v209, s24, v213
    v_mfma_f32_16x16x32_bf16 a[52:55], a[196:199], v[236:239], a[52:55]
    v_fmac_f32 v213, -4.0, v209
    v_fma_f32 v209, v207, s24, v211
    v_mfma_f32_16x16x32_bf16 a[56:59], a[200:203], v[236:239], a[56:59]
    ds_read_b128 v[236:239], v253 offset:9632
    v_fmac_f32 v211, -4.0, v207
    v_mfma_f32_16x16x32_bf16 a[56:59], a[212:215], v[228:231], a[56:59]
    buffer_load_dwordx2 v[198:199], v203, s[4:7], s19 offen offset:896
    v_mfma_f32_16x16x32_bf16 a[36:39], a[216:219], v[228:231], a[36:39]
    v_fma_f32 v207, v211, s26, v213
    v_fmac_f32 v213, s27, v211
    v_mfma_f32_16x16x32_bf16 a[40:43], a[220:223], v[228:231], a[40:43]
    v_fma_f32 v211, v209, 2.0, v249
    v_fmac_f32 v249, -2.0, v209
    v_mfma_f32_16x16x32_bf16 a[44:47], a[224:227], v[228:231], a[44:47]
    v_cvt_pk_bf16_f32 v207, v248, v207
    v_cvt_pk_bf16_f32 v213, v251, v213
    v_mfma_f32_16x16x32_bf16 a[60:63], a[192:195], v[228:231], a[60:63]
    s_waitcnt lgkmcnt(1)
    v_cvt_pk_bf16_f32 v211, v250, v211
    v_cvt_pk_bf16_f32 v209, v252, v249
    v_mfma_f32_16x16x32_bf16 a[60:63], a[204:207], v[232:235], a[60:63]
    buffer_load_dwordx2 v[200:201], v203, s[4:7], s20 offen offset:896
    v_mfma_f32_16x16x32_bf16 a[64:67], a[208:211], v[232:235], a[64:67]
    v_lshrrev_b32 v252, 15, v255
    v_mfma_f32_16x16x32_bf16 a[64:67], a[196:199], v[228:231], a[64:67]
    ds_write_b64 v252, v[206:207] offset:768
    v_mfma_f32_16x16x32_bf16 a[68:71], a[200:203], v[228:231], a[68:71]
    ds_read_b128 v[228:231], v253 offset:9376
    s_waitcnt vmcnt(14)
    v_mfma_f32_16x16x32_bf16 a[68:71], a[212:215], v[232:235], a[68:71]
    v_lshlrev_b32 v248, 16, v218
    v_lshlrev_b32 v249, 16, v220
    v_mfma_f32_16x16x32_bf16 a[48:51], a[216:219], v[232:235], a[48:51]
    buffer_load_dwordx2 v[202:203], v203, s[4:7], s21 offen offset:896
    v_mfma_f32_16x16x32_bf16 a[52:55], a[220:223], v[232:235], a[52:55]
    ds_write_b64 v252, v[212:213] offset:2848
    v_mfma_f32_16x16x32_bf16 a[56:59], a[224:227], v[232:235], a[56:59]
    s_waitcnt lgkmcnt(3)
    v_lshlrev_b32 v250, 16, v222
    v_lshlrev_b32 v251, 16, v224
    v_mfma_f32_16x16x32_bf16 a[72:75], a[192:195], v[232:235], a[72:75]
    ds_write_b64 v252, v[210:211] offset:4928
    v_and_b32 v218, s22, v218
    v_mfma_f32_16x16x32_bf16 a[72:75], a[204:207], v[236:239], a[72:75]
    v_and_b32 v220, s22, v220
    v_mfma_f32_16x16x32_bf16 a[76:79], a[208:211], v[236:239], a[76:79]
    ds_write_b64 v252, v[204:205] offset:17408
    v_mfma_f32_16x16x32_bf16 a[76:79], a[196:199], v[232:235], a[76:79]
    v_and_b32 v222, s22, v222
    v_and_b32 v224, s22, v224
    v_mfma_f32_16x16x32_bf16 a[80:83], a[200:203], v[232:235], a[80:83]
    ds_read_b128 v[232:235], v253 offset:9104
    v_mfma_f32_16x16x32_bf16 a[80:83], a[212:215], v[236:239], a[80:83]
    ds_write_b64 v252, v[214:215] offset:25728
    v_mfma_f32_16x16x32_bf16 a[60:63], a[216:219], v[236:239], a[60:63]
    v_mfma_f32_16x16x32_bf16 a[64:67], a[220:223], v[236:239], a[64:67]
    ds_write_b64 v252, v[208:209] offset:7008
    v_mfma_f32_16x16x32_bf16 a[68:71], a[224:227], v[236:239], a[68:71]
    s_mov_b32 s42, 221184
    v_mfma_f32_16x16x32_bf16 a[84:87], a[192:195], v[236:239], a[84:87]
    buffer_load_dwordx4 a[192:195], v254, s[8:11], s42 offen offset:0 sc1
    v_mfma_f32_16x16x32_bf16 a[88:91], a[196:199], v[236:239], a[88:91]
    v_lshlrev_b32 v252, 16, v216
    v_and_b32 v216, s22, v216
    v_mfma_f32_16x16x32_bf16 a[92:95], a[200:203], v[236:239], a[92:95]
    s_waitcnt lgkmcnt(6)
    v_fmac_f32 v252, s25, v251
    v_fmac_f32 v216, s25, v224
    v_mfma_f32_16x16x32_bf16 a[84:87], a[204:207], v[228:231], a[84:87]
    ds_read_b128 v[236:239], v253 offset:11440
    v_fmac_f32 v252, s28, v249
    v_mfma_f32_16x16x32_bf16 a[88:91], a[208:211], v[228:231], a[88:91]
    buffer_load_dwordx4 a[196:199], v254, s[8:11], s42 offen offset:1024 sc1
    v_mfma_f32_16x16x32_bf16 a[92:95], a[212:215], v[228:231], a[92:95]
    v_fmac_f32 v216, s28, v220
    v_cvt_pk_bf16_f32 v216, v252, v216
    v_mfma_f32_16x16x32_bf16 a[72:75], a[216:219], v[228:231], a[72:75]
    s_waitcnt lgkmcnt(3)
    v_lshlrev_b32 v252, 16, v226
    v_and_b32 v226, s22, v226
    v_mfma_f32_16x16x32_bf16 a[76:79], a[220:223], v[228:231], a[76:79]
    buffer_load_dwordx4 a[200:203], v254, s[8:11], s42 offen offset:2048 sc1
    v_mfma_f32_16x16x32_bf16 a[80:83], a[224:227], v[228:231], a[80:83]
    ds_read_b128 v[228:231], v253 offset:11168
    v_fmac_f32 v252, s29, v248
    v_mfma_f32_16x16x32_bf16 a[84:87], a[216:219], v[232:235], a[84:87]
    s_mov_b32 s42, 224256
    v_fmac_f32 v226, s29, v218
    v_fmac_f32 v252, s23, v250
    v_mfma_f32_16x16x32_bf16 a[88:91], a[220:223], v[232:235], a[88:91]
    buffer_load_dwordx4 a[204:207], v254, s[8:11], s42 offen offset:0 sc1
    v_mfma_f32_16x16x32_bf16 a[92:95], a[224:227], v[232:235], a[92:95]
    ds_read_b128 v[232:235], v253 offset:10912
    v_fmac_f32 v226, s23, v222
    s_waitcnt vmcnt(16)
    s_waitcnt lgkmcnt(2)
sub5:
    v_mfma_f32_16x16x32_bf16 a[96:99], a[228:231], v[236:239], a[96:99]
    v_cvt_pk_bf16_f32 v226, v252, v226
    v_fma_f32 v252, v249, s24, v251
    v_mfma_f32_16x16x32_bf16 a[100:103], a[232:235], v[236:239], a[100:103]
    s_waitcnt vmcnt(13) lgkmcnt(1)
    v_fmac_f32 v251, -4.0, v249
    v_fma_f32 v249, v248, s24, v250
    v_mfma_f32_16x16x32_bf16 a[104:107], a[236:239], v[236:239], a[104:107]
    ds_read_b128 v[236:239], v253 offset:10656
    v_fmac_f32 v250, -4.0, v248
    v_mfma_f32_16x16x32_bf16 a[96:99], a[240:243], v[228:231], a[96:99]
    buffer_load_dwordx4 a[208:211], v254, s[8:11], s42 offen offset:1024 sc1
    v_mfma_f32_16x16x32_bf16 a[100:103], a[244:247], v[228:231], a[100:103]
    v_fma_f32 v248, v250, s26, v251
    v_fmac_f32 v251, s27, v250
    v_mfma_f32_16x16x32_bf16 a[104:107], a[248:251], v[228:231], a[104:107]
    v_fma_f32 v250, v249, 2.0, v252
    v_fmac_f32 v252, -2.0, v249
    v_mfma_f32_16x16x32_bf16 a[108:111], a[228:231], v[228:231], a[108:111]
    s_waitcnt lgkmcnt(1)
    v_fma_f32 v249, v220, s24, v224
    v_fmac_f32 v224, -4.0, v220
    v_mfma_f32_16x16x32_bf16 a[108:111], a[240:243], v[232:235], a[108:111]
    buffer_load_dwordx4 a[212:215], v254, s[8:11], s42 offen offset:2048 sc1
    v_mfma_f32_16x16x32_bf16 a[112:115], a[244:247], v[232:235], a[112:115]
    v_fma_f32 v220, v218, s24, v222
    v_fmac_f32 v222, -4.0, v218
    v_mfma_f32_16x16x32_bf16 a[112:115], a[232:235], v[228:231], a[112:115]
    s_mov_b32 s42, 227328
    v_fma_f32 v218, v222, s26, v224
    v_fmac_f32 v224, s27, v222
    v_mfma_f32_16x16x32_bf16 a[116:119], a[236:239], v[228:231], a[116:119]
    ds_read_b128 v[228:231], v253 offset:10400
    v_fma_f32 v222, v220, 2.0, v249
    v_mfma_f32_16x16x32_bf16 a[116:119], a[248:251], v[232:235], a[116:119]
    buffer_load_dwordx4 a[216:219], v254, s[8:11], s42 offen offset:0 sc1
    s_waitcnt vmcnt(13)
    v_mfma_f32_16x16x32_bf16 a[96:99], a[252:255], v[232:235], a[96:99]
    v_fmac_f32 v249, -2.0, v220
    v_cvt_pk_bf16_f32 v218, v248, v218
    v_mfma_f32_16x16x32_bf16 a[100:103], v[240:243], v[232:235], a[100:103]
    v_cvt_pk_bf16_f32 v224, v251, v224
    v_cvt_pk_bf16_f32 v222, v250, v222
    v_mfma_f32_16x16x32_bf16 a[104:107], v[244:247], v[232:235], a[104:107]
    s_waitcnt lgkmcnt(1)
    v_cvt_pk_bf16_f32 v220, v252, v249
    v_lshlrev_b32 v248, 16, v219
    v_mfma_f32_16x16x32_bf16 a[120:123], a[228:231], v[232:235], a[120:123]
    buffer_load_dwordx4 a[220:223], v254, s[8:11], s42 offen offset:1024 sc1
    v_mfma_f32_16x16x32_bf16 a[120:123], a[240:243], v[236:239], a[120:123]
    v_lshlrev_b32 v249, 16, v221
    v_lshlrev_b32 v250, 16, v223
    v_mfma_f32_16x16x32_bf16 a[124:127], a[244:247], v[236:239], a[124:127]
    v_lshlrev_b32 v251, 16, v225
    v_and_b32 v219, s22, v219
    v_mfma_f32_16x16x32_bf16 a[124:127], a[232:235], v[232:235], a[124:127]
    buffer_load_dwordx4 a[224:227], v254, s[8:11], s42 offen offset:2048 sc1
    v_mfma_f32_16x16x32_bf16 a[128:131], a[236:239], v[232:235], a[128:131]
    ds_read_b128 v[232:235], v253 offset:12224
    v_and_b32 v215, 0x7fff, v255
    v_mfma_f32_16x16x32_bf16 a[128:131], a[248:251], v[236:239], a[128:131]
    v_and_b32 v221, s22, v221
    v_and_b32 v223, s22, v223
    v_mfma_f32_16x16x32_bf16 a[108:111], a[252:255], v[236:239], a[108:111]
    v_and_b32 v225, s22, v225
    v_lshlrev_b32 v252, 16, v217
    v_mfma_f32_16x16x32_bf16 a[112:115], v[240:243], v[236:239], a[112:115]
    buffer_load_dwordx2 v[204:205], v215, s[4:7], s16 offen offset:1280
    v_mfma_f32_16x16x32_bf16 a[116:119], v[244:247], v[236:239], a[116:119]
    v_and_b32 v217, s22, v217
    v_fmac_f32 v252, s25, v251
    v_mfma_f32_16x16x32_bf16 a[132:135], a[228:231], v[236:239], a[132:135]
    s_waitcnt lgkmcnt(1)
    v_fmac_f32 v217, s25, v225
    v_fmac_f32 v252, s28, v249
    v_mfma_f32_16x16x32_bf16 a[132:135], a[240:243], v[228:231], a[132:135]
    v_fmac_f32 v217, s28, v221
    v_cvt_pk_bf16_f32 v217, v252, v217
    v_mfma_f32_16x16x32_bf16 a[136:139], a[244:247], v[228:231], a[136:139]
    v_lshlrev_b32 v252, 16, v227
    v_and_b32 v227, s22, v227
    v_mfma_f32_16x16x32_bf16 a[136:139], a[232:235], v[236:239], a[136:139]
    buffer_load_dwordx2 v[206:207], v215, s[4:7], s17 offen offset:1280
    v_mfma_f32_16x16x32_bf16 a[140:143], a[236:239], v[236:239], a[140:143]
    ds_read_b128 v[236:239], v253 offset:11968
    v_fmac_f32 v252, s29, v248
    v_mfma_f32_16x16x32_bf16 a[140:143], a[248:251], v[228:231], a[140:143]
    v_fmac_f32 v227, s29, v219
    v_fmac_f32 v252, s23, v250
    v_mfma_f32_16x16x32_bf16 a[120:123], a[252:255], v[228:231], a[120:123]
    v_fmac_f32 v227, s23, v223
    v_cvt_pk_bf16_f32 v227, v252, v227
    v_mfma_f32_16x16x32_bf16 a[124:127], v[240:243], v[228:231], a[124:127]
    v_fma_f32 v252, v249, s24, v251
    v_fmac_f32 v251, -4.0, v249
    v_mfma_f32_16x16x32_bf16 a[128:131], v[244:247], v[228:231], a[128:131]
    buffer_load_dwordx2 v[208:209], v215, s[4:7], s18 offen offset:1280
    v_mfma_f32_16x16x32_bf16 a[144:147], a[228:231], v[228:231], a[144:147]
    s_waitcnt lgkmcnt(1)
    v_fma_f32 v249, v248, s24, v250
    v_fmac_f32 v250, -4.0, v248
    v_mfma_f32_16x16x32_bf16 a[144:147], a[240:243], v[232:235], a[144:147]
    v_fma_f32 v248, v250, s26, v251
    v_fmac_f32 v251, s27, v250
    v_mfma_f32_16x16x32_bf16 a[148:151], a[244:247], v[232:235], a[148:151]
    v_fma_f32 v250, v249, 2.0, v252
    v_fmac_f32 v252, -2.0, v249
    v_mfma_f32_16x16x32_bf16 a[148:151], a[232:235], v[228:231], a[148:151]
    v_fma_f32 v249, v221, s24, v225
    v_fmac_f32 v225, -4.0, v221
    v_mfma_f32_16x16x32_bf16 a[152:155], a[236:239], v[228:231], a[152:155]
    ds_read_b128 v[228:231], v253 offset:11712
    v_fma_f32 v221, v219, s24, v223
    v_mfma_f32_16x16x32_bf16 a[152:155], a[248:251], v[232:235], a[152:155]
    buffer_load_dwordx2 v[210:211], v215, s[4:7], s19 offen offset:1280
    v_mfma_f32_16x16x32_bf16 a[132:135], a[252:255], v[232:235], a[132:135]
pad2:
    s_cbranch_vccnz pad6
    v_fmac_f32 v223, -4.0, v219
    v_fma_f32 v219, v223, s26, v225
    v_mfma_f32_16x16x32_bf16 a[136:139], v[240:243], v[232:235], a[136:139]
    v_fmac_f32 v225, s27, v223
    v_fma_f32 v223, v221, 2.0, v249
    v_mfma_f32_16x16x32_bf16 a[140:143], v[244:247], v[232:235], a[140:143]
    v_fmac_f32 v249, -2.0, v221
    v_cvt_pk_bf16_f32 v219, v248, v219
    v_mfma_f32_16x16x32_bf16 a[156:159], a[228:231], v[232:235], a[156:159]
    s_waitcnt lgkmcnt(1)
    v_cvt_pk_bf16_f32 v225, v251, v225
    v_cvt_pk_bf16_f32 v223, v250, v223
    v_mfma_f32_16x16x32_bf16 a[156:159], a[240:243], v[236:239], a[156:159]
    buffer_load_dwordx2 v[212:213], v215, s[4:7], s20 offen offset:1280
    v_mfma_f32_16x16x32_bf16 a[160:163], a[244:247], v[236:239], a[160:163]
    v_cvt_pk_bf16_f32 v221, v252, v249
    v_lshrrev_b32 v252, 15, v255
    v_mfma_f32_16x16x32_bf16 a[160:163], a[232:235], v[232:235], a[160:163]
    ds_write_b64 v252, v[218:219] offset:512
    v_mfma_f32_16x16x32_bf16 a[164:167], a[236:239], v[232:235], a[164:167]
    ds_read_b128 v[232:235], v253 offset:11456
    s_waitcnt vmcnt(14)
    v_mfma_f32_16x16x32_bf16 a[164:167], a[248:251], v[236:239], a[164:167]
    v_lshlrev_b32 v248, 16, v194
    v_lshlrev_b32 v249, 16, v196
    v_mfma_f32_16x16x32_bf16 a[144:147], a[252:255], v[236:239], a[144:147]
    buffer_load_dwordx2 v[214:215], v215, s[4:7], s21 offen offset:1280
    v_mfma_f32_16x16x32_bf16 a[148:151], v[240:243], v[236:239], a[148:151]
    ds_write_b64 v252, v[224:225] offset:2592
    v_mfma_f32_16x16x32_bf16 a[152:155], v[244:247], v[236:239], a[152:155]
    s_waitcnt lgkmcnt(3)
    v_lshlrev_b32 v250, 16, v198
    v_lshlrev_b32 v251, 16, v200
    v_mfma_f32_16x16x32_bf16 a[168:171], a[228:231], v[236:239], a[168:171]
    ds_write_b64 v252, v[222:223] offset:4672
    v_mfma_f32_16x16x32_bf16 a[168:171], a[240:243], v[228:231], a[168:171]
    v_and_b32 v194, s22, v194
    v_and_b32 v196, s22, v196
    v_mfma_f32_16x16x32_bf16 a[172:175], a[244:247], v[228:231], a[172:175]
    ds_write_b64 v252, v[216:217] offset:17152
    v_mfma_f32_16x16x32_bf16 a[172:175], a[232:235], v[236:239], a[172:175]
    v_and_b32 v198, s22, v198
    v_and_b32 v200, s22, v200
    v_mfma_f32_16x16x32_bf16 a[176:179], a[236:239], v[236:239], a[176:179]
    ds_read_b128 v[236:239], v253 offset:11184
    v_mfma_f32_16x16x32_bf16 a[176:179], a[248:251], v[228:231], a[176:179]
    ds_write_b64 v252, v[226:227] offset:25472
    v_mfma_f32_16x16x32_bf16 a[156:159], a[252:255], v[228:231], a[156:159]
    v_mfma_f32_16x16x32_bf16 a[160:163], v[240:243], v[228:231], a[160:163]
    ds_write_b64 v252, v[220:221] offset:6752
    v_mfma_f32_16x16x32_bf16 a[164:167], v[244:247], v[228:231], a[164:167]
    s_mov_b32 s42, 258048
    v_mfma_f32_16x16x32_bf16 a[180:183], a[228:231], v[228:231], a[180:183]
    buffer_load_dwordx4 a[228:231], v254, s[8:11], s42 offen offset:0 sc1
    v_mfma_f32_16x16x32_bf16 a[184:187], a[232:235], v[228:231], a[184:187]
    v_lshlrev_b32 v252, 16, v192
    v_and_b32 v192, s22, v192
    v_mfma_f32_16x16x32_bf16 a[188:191], a[236:239], v[228:231], a[188:191]
    s_waitcnt lgkmcnt(2)
    v_fmac_f32 v252, s25, v251
    v_fmac_f32 v192, s25, v200
    v_mfma_f32_16x16x32_bf16 a[180:183], a[240:243], v[232:235], a[180:183]
    ds_read_b128 v[228:231], v253 offset:13520
    v_fmac_f32 v252, s28, v249
    v_mfma_f32_16x16x32_bf16 a[184:187], a[244:247], v[232:235], a[184:187]
    buffer_load_dwordx4 a[232:235], v254, s[8:11], s42 offen offset:1024 sc1
    v_mfma_f32_16x16x32_bf16 a[188:191], a[248:251], v[232:235], a[188:191]
    ds_read_b128 v[216:219], v253 offset:39904
    v_fmac_f32 v192, s28, v196
    v_mfma_f32_16x16x32_bf16 a[168:171], a[252:255], v[232:235], a[168:171]
    s_mov_b32 s45, 405865480
    v_cvt_pk_bf16_f32 v192, v252, v192
    v_lshlrev_b32 v252, 16, v202
    v_and_b32 v202, s22, v202
    v_mfma_f32_16x16x32_bf16 a[172:175], v[240:243], v[232:235], a[172:175]
    buffer_load_dwordx4 a[236:239], v254, s[8:11], s42 offen offset:2048 sc1
    v_mfma_f32_16x16x32_bf16 a[176:179], v[244:247], v[232:235], a[176:179]
    ds_read_b128 v[232:235], v253 offset:13248
    v_fmac_f32 v252, s29, v248
    v_mfma_f32_16x16x32_bf16 a[180:183], a[252:255], v[236:239], a[180:183]
    s_mov_b32 s42, 261120
    v_bfe_u32 v220, v254, 5, 3
    v_fmac_f32 v202, s29, v194
    v_mfma_f32_16x16x32_bf16 a[184:187], v[240:243], v[236:239], a[184:187]
    buffer_load_dwordx4 a[240:243], v254, s[8:11], s42 offen offset:0 sc1
    v_mfma_f32_16x16x32_bf16 a[188:191], v[244:247], v[236:239], a[188:191]
    ds_read_b128 v[236:239], v253 offset:12992
    v_mul_u32_u24 v221, 5, v220
    s_waitcnt vmcnt(16)
    s_waitcnt lgkmcnt(3)
sub6:
    v_mfma_f32_16x16x32_bf16 v[0:3], a[192:195], v[228:231], v[0:3]
    v_fmac_f32 v252, s23, v250
    v_fmac_f32 v202, s23, v198
    v_mfma_f32_16x16x32_bf16 v[4:7], a[196:199], v[228:231], v[4:7]
    s_waitcnt vmcnt(13) lgkmcnt(1)
    v_cvt_pk_bf16_f32 v202, v252, v202
    v_fma_f32 v252, v249, s24, v251
    v_fmac_f32 v251, -4.0, v249
    v_mfma_f32_16x16x32_bf16 v[8:11], a[200:203], v[228:231], v[8:11]
    ds_read_b128 v[228:231], v253 offset:12736
    v_bfe_u32 v221, s45, v221, 5
    v_mfma_f32_16x16x32_bf16 v[0:3], a[204:207], v[232:235], v[0:3]
    buffer_load_dwordx4 a[244:247], v254, s[8:11], s42 offen offset:1024 sc1
    v_mfma_f32_16x16x32_bf16 v[4:7], a[208:211], v[232:235], v[4:7]
    v_fma_f32 v249, v248, s24, v250
    v_fmac_f32 v250, -4.0, v248
    v_mfma_f32_16x16x32_bf16 v[8:11], a[212:215], v[232:235], v[8:11]
    v_mul_u32_u24 v221, 65, v221
    v_fma_f32 v248, v250, s26, v251
    v_mfma_f32_16x16x32_bf16 v[12:15], a[192:195], v[232:235], v[12:15]
    s_waitcnt lgkmcnt(1)
    v_fmac_f32 v251, s27, v250
    v_fma_f32 v250, v249, 2.0, v252
    v_mfma_f32_16x16x32_bf16 v[12:15], a[204:207], v[236:239], v[12:15]
    buffer_load_dwordx4 a[248:251], v254, s[8:11], s42 offen offset:2048 sc1
    v_fmac_f32 v252, -2.0, v249
    v_mfma_f32_16x16x32_bf16 v[16:19], a[208:211], v[236:239], v[16:19]
    v_sub_u32 v221, v221, v220
    v_fma_f32 v249, v196, s24, v200
    v_mfma_f32_16x16x32_bf16 v[16:19], a[196:199], v[232:235], v[16:19]
    s_mov_b32 s42, 264192
    v_fmac_f32 v200, -4.0, v196
    v_fma_f32 v196, v194, s24, v198
    v_mfma_f32_16x16x32_bf16 v[20:23], a[200:203], v[232:235], v[20:23]
    ds_read_b128 v[232:235], v253 offset:12480
    v_lshl_add_u32 v220, v221, 5, v253
    v_mfma_f32_16x16x32_bf16 v[20:23], a[212:215], v[236:239], v[20:23]
    buffer_load_dwordx4 a[252:255], v254, s[8:11], s42 offen offset:0 sc1
    s_waitcnt vmcnt(13)
    v_mfma_f32_16x16x32_bf16 v[0:3], a[216:219], v[236:239], v[0:3]
    v_fmac_f32 v198, -4.0, v194
    v_fma_f32 v194, v198, s26, v200
    v_mfma_f32_16x16x32_bf16 v[4:7], a[220:223], v[236:239], v[4:7]
    v_fmac_f32 v200, s27, v198
    v_fma_f32 v198, v196, 2.0, v249
    v_mfma_f32_16x16x32_bf16 v[8:11], a[224:227], v[236:239], v[8:11]
    s_waitcnt lgkmcnt(1)
    v_fmac_f32 v249, -2.0, v196
    v_cvt_pk_bf16_f32 v194, v248, v194
    v_cvt_pk_bf16_f32 v200, v251, v200
    v_mfma_f32_16x16x32_bf16 v[24:27], a[192:195], v[236:239], v[24:27]
    buffer_load_dwordx4 v[240:243], v254, s[8:11], s42 offen offset:1024 sc1
    v_mfma_f32_16x16x32_bf16 v[24:27], a[204:207], v[228:231], v[24:27]
    s_mov_b64 exec, s[46:47]
    ds_write_b128 v220, v[216:219] offset:1024
    s_mov_b64 exec, -1
    v_mfma_f32_16x16x32_bf16 v[28:31], a[208:211], v[228:231], v[28:31]
    v_cvt_pk_bf16_f32 v198, v250, v198
    v_cvt_pk_bf16_f32 v196, v252, v249
    v_mfma_f32_16x16x32_bf16 v[28:31], a[196:199], v[236:239], v[28:31]
    buffer_load_dwordx4 v[244:247], v254, s[8:11], s42 offen offset:2048 sc1
    v_mfma_f32_16x16x32_bf16 v[32:35], a[200:203], v[236:239], v[32:35]
    ds_read_b128 v[236:239], v253 offset:14304
    v_and_b32 v227, 0x7fff, v255
    v_mfma_f32_16x16x32_bf16 v[32:35], a[212:215], v[228:231], v[32:35]
    v_lshlrev_b32 v248, 16, v195
    v_lshlrev_b32 v249, 16, v197
    v_mfma_f32_16x16x32_bf16 v[12:15], a[216:219], v[228:231], v[12:15]
    v_lshlrev_b32 v250, 16, v199
    v_lshlrev_b32 v251, 16, v201
    v_and_b32 v195, s22, v195
    v_mfma_f32_16x16x32_bf16 v[16:19], a[220:223], v[228:231], v[16:19]
    buffer_load_dwordx2 v[216:217], v227, s[4:7], s16 offen offset:192
    v_mfma_f32_16x16x32_bf16 v[20:23], a[224:227], v[228:231], v[20:23]
    v_and_b32 v197, s22, v197
    v_and_b32 v199, s22, v199
    v_mfma_f32_16x16x32_bf16 v[36:39], a[192:195], v[228:231], v[36:39]
    s_waitcnt lgkmcnt(2)
    v_and_b32 v201, s22, v201
    v_lshlrev_b32 v252, 16, v193
    v_mfma_f32_16x16x32_bf16 v[36:39], a[204:207], v[232:235], v[36:39]
    v_and_b32 v193, s22, v193
    v_fmac_f32 v252, s25, v251
    v_mfma_f32_16x16x32_bf16 v[40:43], a[208:211], v[232:235], v[40:43]
    v_fmac_f32 v193, s25, v201
    v_fmac_f32 v252, s28, v249
    v_mfma_f32_16x16x32_bf16 v[40:43], a[196:199], v[228:231], v[40:43]
    buffer_load_dwordx2 v[218:219], v227, s[4:7], s17 offen offset:192
    v_fmac_f32 v193, s28, v197
    v_mfma_f32_16x16x32_bf16 v[44:47], a[200:203], v[228:231], v[44:47]
    ds_read_b128 v[228:231], v253 offset:14048
    v_cvt_pk_bf16_f32 v193, v252, v193
    v_mfma_f32_16x16x32_bf16 v[44:47], a[212:215], v[232:235], v[44:47]
    v_lshlrev_b32 v252, 16, v203
    v_and_b32 v203, s22, v203
    v_mfma_f32_16x16x32_bf16 v[24:27], a[216:219], v[232:235], v[24:27]
    v_fmac_f32 v252, s29, v248
    v_fmac_f32 v203, s29, v195
    v_mfma_f32_16x16x32_bf16 v[28:31], a[220:223], v[232:235], v[28:31]
    v_fmac_f32 v252, s23, v250
    v_fmac_f32 v203, s23, v199
    v_mfma_f32_16x16x32_bf16 v[32:35], a[224:227], v[232:235], v[32:35]
    buffer_load_dwordx2 v[220:221], v227, s[4:7], s18 offen offset:192
    v_mfma_f32_16x16x32_bf16 v[48:51], a[192:195], v[232:235], v[48:51]
    s_waitcnt lgkmcnt(1)
    v_cvt_pk_bf16_f32 v203, v252, v203
    v_fma_f32 v252, v249, s24, v251
    v_mfma_f32_16x16x32_bf16 v[48:51], a[204:207], v[236:239], v[48:51]
    v_fmac_f32 v251, -4.0, v249
    v_fma_f32 v249, v248, s24, v250
    v_fmac_f32 v250, -4.0, v248
    v_mfma_f32_16x16x32_bf16 v[52:55], a[208:211], v[236:239], v[52:55]
    v_fma_f32 v248, v250, s26, v251
    v_fmac_f32 v251, s27, v250
    v_mfma_f32_16x16x32_bf16 v[52:55], a[196:199], v[232:235], v[52:55]
    v_fma_f32 v250, v249, 2.0, v252
    v_fmac_f32 v252, -2.0, v249
    v_mfma_f32_16x16x32_bf16 v[56:59], a[200:203], v[232:235], v[56:59]
    ds_read_b128 v[232:235], v253 offset:13792
    v_fma_f32 v249, v197, s24, v201
    v_mfma_f32_16x16x32_bf16 v[56:59], a[212:215], v[236:239], v[56:59]
    buffer_load_dwordx2 v[222:223], v227, s[4:7], s19 offen offset:192
    v_mfma_f32_16x16x32_bf16 v[36:39], a[216:219], v[236:239], v[36:39]
    v_fmac_f32 v201, -4.0, v197
    v_fma_f32 v197, v195, s24, v199
    v_mfma_f32_16x16x32_bf16 v[40:43], a[220:223], v[236:239], v[40:43]
    v_fmac_f32 v199, -4.0, v195
    v_fma_f32 v195, v199, s26, v201
    v_mfma_f32_16x16x32_bf16 v[44:47], a[224:227], v[236:239], v[44:47]
    v_fmac_f32 v201, s27, v199
    v_fma_f32 v199, v197, 2.0, v249
    v_fmac_f32 v249, -2.0, v197
    v_mfma_f32_16x16x32_bf16 v[60:63], a[192:195], v[236:239], v[60:63]
    s_waitcnt lgkmcnt(1)
    v_cvt_pk_bf16_f32 v195, v248, v195
    v_cvt_pk_bf16_f32 v201, v251, v201
    v_mfma_f32_16x16x32_bf16 v[60:63], a[204:207], v[228:231], v[60:63]
    buffer_load_dwordx2 v[224:225], v227, s[4:7], s20 offen offset:192
    v_mfma_f32_16x16x32_bf16 v[64:67], a[208:211], v[228:231], v[64:67]
    v_cvt_pk_bf16_f32 v199, v250, v199
    v_cvt_pk_bf16_f32 v197, v252, v249
    v_mfma_f32_16x16x32_bf16 v[64:67], a[196:199], v[236:239], v[64:67]
    v_lshrrev_b32 v252, 15, v255
    v_mfma_f32_16x16x32_bf16 v[68:71], a[200:203], v[236:239], v[68:71]
    ds_read_b128 v[236:239], v253 offset:13536
    v_mfma_f32_16x16x32_bf16 v[68:71], a[212:215], v[228:231], v[68:71]
    ds_write_b64 v252, v[194:195] offset:256
    s_waitcnt vmcnt(14)
    v_mfma_f32_16x16x32_bf16 v[48:51], a[216:219], v[228:231], v[48:51]
    buffer_load_dwordx2 v[226:227], v227, s[4:7], s21 offen offset:192
    v_mfma_f32_16x16x32_bf16 v[52:55], a[220:223], v[228:231], v[52:55]
    v_lshlrev_b32 v248, 16, v206
    v_lshlrev_b32 v249, 16, v208
    v_mfma_f32_16x16x32_bf16 v[56:59], a[224:227], v[228:231], v[56:59]
    ds_write_b64 v252, v[200:201] offset:2336
    v_mfma_f32_16x16x32_bf16 v[72:75], a[192:195], v[228:231], v[72:75]
    s_waitcnt lgkmcnt(3)
    v_lshlrev_b32 v250, 16, v210
    v_lshlrev_b32 v251, 16, v212
    v_mfma_f32_16x16x32_bf16 v[72:75], a[204:207], v[232:235], v[72:75]
    ds_write_b64 v252, v[198:199] offset:4416
    v_mfma_f32_16x16x32_bf16 v[76:79], a[208:211], v[232:235], v[76:79]
    v_and_b32 v206, s22, v206
    v_and_b32 v208, s22, v208
    v_mfma_f32_16x16x32_bf16 v[76:79], a[196:199], v[228:231], v[76:79]
    ds_write_b64 v252, v[192:193] offset:16896
    v_and_b32 v210, s22, v210
    v_mfma_f32_16x16x32_bf16 v[80:83], a[200:203], v[228:231], v[80:83]
    ds_read_b128 v[228:231], v253 offset:13264
    v_and_b32 v212, s22, v212
    v_mfma_f32_16x16x32_bf16 v[80:83], a[212:215], v[232:235], v[80:83]
    ds_write_b64 v252, v[202:203] offset:25216
    v_mfma_f32_16x16x32_bf16 v[60:63], a[216:219], v[232:235], v[60:63]
    v_mfma_f32_16x16x32_bf16 v[64:67], a[220:223], v[232:235], v[64:67]
    ds_write_b64 v252, v[196:197] offset:6496
    v_mfma_f32_16x16x32_bf16 v[68:71], a[224:227], v[232:235], v[68:71]
    s_mov_b32 s42, 294912
    v_mfma_f32_16x16x32_bf16 v[84:87], a[192:195], v[232:235], v[84:87]
    buffer_load_dwordx4 a[192:195], v254, s[8:11], s42 offen offset:0 sc1
    v_mfma_f32_16x16x32_bf16 v[88:91], a[196:199], v[232:235], v[88:91]
    v_lshlrev_b32 v252, 16, v204
    v_and_b32 v204, s22, v204
    v_mfma_f32_16x16x32_bf16 v[92:95], a[200:203], v[232:235], v[92:95]
    s_waitcnt lgkmcnt(7)
    v_fmac_f32 v252, s25, v251
    v_fmac_f32 v204, s25, v212
    v_mfma_f32_16x16x32_bf16 v[84:87], a[204:207], v[236:239], v[84:87]
    ds_read_b128 v[232:235], v253 offset:32240
    v_fmac_f32 v252, s28, v249
    v_mfma_f32_16x16x32_bf16 v[88:91], a[208:211], v[236:239], v[88:91]
    buffer_load_dwordx4 a[196:199], v254, s[8:11], s42 offen offset:1024 sc1
    v_mfma_f32_16x16x32_bf16 v[92:95], a[212:215], v[236:239], v[92:95]
    v_fmac_f32 v204, s28, v208
    v_cvt_pk_bf16_f32 v204, v252, v204
    v_mfma_f32_16x16x32_bf16 v[72:75], a[216:219], v[236:239], v[72:75]
    s_waitcnt lgkmcnt(3)
    v_lshlrev_b32 v252, 16, v214
    v_and_b32 v214, s22, v214
    v_mfma_f32_16x16x32_bf16 v[76:79], a[220:223], v[236:239], v[76:79]
    buffer_load_dwordx4 a[200:203], v254, s[8:11], s42 offen offset:2048 sc1
    v_mfma_f32_16x16x32_bf16 v[80:83], a[224:227], v[236:239], v[80:83]
    ds_read_b128 v[236:239], v253 offset:31968
    v_fmac_f32 v252, s29, v248
    v_mfma_f32_16x16x32_bf16 v[84:87], a[216:219], v[228:231], v[84:87]
    s_mov_b32 s42, 297984
    v_fmac_f32 v214, s29, v206
    v_fmac_f32 v252, s23, v250
    v_mfma_f32_16x16x32_bf16 v[88:91], a[220:223], v[228:231], v[88:91]
    buffer_load_dwordx4 a[204:207], v254, s[8:11], s42 offen offset:0 sc1
    v_mfma_f32_16x16x32_bf16 v[92:95], a[224:227], v[228:231], v[92:95]
    ds_read_b128 v[228:231], v253 offset:31712
    v_fmac_f32 v214, s23, v210
    s_waitcnt vmcnt(16)
    s_waitcnt lgkmcnt(2)
sub7:
    v_mfma_f32_16x16x32_bf16 v[96:99], a[228:231], v[232:235], v[96:99]
    v_cvt_pk_bf16_f32 v214, v252, v214
    v_fma_f32 v252, v249, s24, v251
    v_mfma_f32_16x16x32_bf16 v[100:103], a[232:235], v[232:235], v[100:103]
    s_waitcnt vmcnt(13) lgkmcnt(1)
    v_fmac_f32 v251, -4.0, v249
    v_fma_f32 v249, v248, s24, v250
    v_mfma_f32_16x16x32_bf16 v[104:107], a[236:239], v[232:235], v[104:107]
    ds_read_b128 v[232:235], v253 offset:31456
    v_fmac_f32 v250, -4.0, v248
    v_mfma_f32_16x16x32_bf16 v[96:99], a[240:243], v[236:239], v[96:99]
    buffer_load_dwordx4 a[208:211], v254, s[8:11], s42 offen offset:1024 sc1
    v_mfma_f32_16x16x32_bf16 v[100:103], a[244:247], v[236:239], v[100:103]
    v_fma_f32 v248, v250, s26, v251
    v_fmac_f32 v251, s27, v250
    v_mfma_f32_16x16x32_bf16 v[104:107], a[248:251], v[236:239], v[104:107]
    v_fma_f32 v250, v249, 2.0, v252
    v_fmac_f32 v252, -2.0, v249
    v_mfma_f32_16x16x32_bf16 v[108:111], a[228:231], v[236:239], v[108:111]
    s_waitcnt lgkmcnt(1)
    v_fma_f32 v249, v208, s24, v212
    v_fmac_f32 v212, -4.0, v208
    v_mfma_f32_16x16x32_bf16 v[108:111], a[240:243], v[228:231], v[108:111]
    buffer_load_dwordx4 a[212:215], v254, s[8:11], s42 offen offset:2048 sc1
    v_mfma_f32_16x16x32_bf16 v[112:115], a[244:247], v[228:231], v[112:115]
    v_fma_f32 v208, v206, s24, v210
    v_fmac_f32 v210, -4.0, v206
    v_mfma_f32_16x16x32_bf16 v[112:115], a[232:235], v[236:239], v[112:115]
    s_mov_b32 s42, 301056
    v_fma_f32 v206, v210, s26, v212
    v_fmac_f32 v212, s27, v210
    v_mfma_f32_16x16x32_bf16 v[116:119], a[236:239], v[236:239], v[116:119]
    ds_read_b128 v[236:239], v253 offset:31200
    v_fma_f32 v210, v208, 2.0, v249
    v_mfma_f32_16x16x32_bf16 v[116:119], a[248:251], v[228:231], v[116:119]
    buffer_load_dwordx4 a[216:219], v254, s[8:11], s42 offen offset:0 sc1
    s_waitcnt vmcnt(13)
    v_mfma_f32_16x16x32_bf16 v[96:99], a[252:255], v[228:231], v[96:99]
    v_fmac_f32 v249, -2.0, v208
    v_cvt_pk_bf16_f32 v206, v248, v206
    v_mfma_f32_16x16x32_bf16 v[100:103], v[240:243], v[228:231], v[100:103]
    v_cvt_pk_bf16_f32 v212, v251, v212
    v_cvt_pk_bf16_f32 v210, v250, v210
    v_mfma_f32_16x16x32_bf16 v[104:107], v[244:247], v[228:231], v[104:107]
    s_waitcnt lgkmcnt(1)
    v_cvt_pk_bf16_f32 v208, v252, v249
    v_lshlrev_b32 v248, 16, v207
    v_mfma_f32_16x16x32_bf16 v[120:123], a[228:231], v[228:231], v[120:123]
    buffer_load_dwordx4 a[220:223], v254, s[8:11], s42 offen offset:1024 sc1
    v_mfma_f32_16x16x32_bf16 v[120:123], a[240:243], v[232:235], v[120:123]
    v_lshlrev_b32 v249, 16, v209
    v_lshlrev_b32 v250, 16, v211
    v_mfma_f32_16x16x32_bf16 v[124:127], a[244:247], v[232:235], v[124:127]
    v_lshlrev_b32 v251, 16, v213
    v_and_b32 v207, s22, v207
    v_mfma_f32_16x16x32_bf16 v[124:127], a[232:235], v[228:231], v[124:127]
    buffer_load_dwordx4 a[224:227], v254, s[8:11], s42 offen offset:2048 sc1
    v_mfma_f32_16x16x32_bf16 v[128:131], a[236:239], v[228:231], v[128:131]
    ds_read_b128 v[228:231], v253 offset:33024
    v_and_b32 v203, 0x7fff, v255
    v_mfma_f32_16x16x32_bf16 v[128:131], a[248:251], v[232:235], v[128:131]
    v_and_b32 v209, s22, v209
    v_and_b32 v211, s22, v211
    v_mfma_f32_16x16x32_bf16 v[108:111], a[252:255], v[232:235], v[108:111]
    v_and_b32 v213, s22, v213
    v_lshlrev_b32 v252, 16, v205
    v_mfma_f32_16x16x32_bf16 v[112:115], v[240:243], v[232:235], v[112:115]
    buffer_load_dwordx2 v[192:193], v203, s[4:7], s16 offen offset:576
    v_mfma_f32_16x16x32_bf16 v[116:119], v[244:247], v[232:235], v[116:119]
    v_and_b32 v205, s22, v205
    v_fmac_f32 v252, s25, v251
    v_mfma_f32_16x16x32_bf16 v[132:135], a[228:231], v[232:235], v[132:135]
    s_waitcnt lgkmcnt(1)
    v_fmac_f32 v205, s25, v213
    v_fmac_f32 v252, s28, v249
    v_mfma_f32_16x16x32_bf16 v[132:135], a[240:243], v[236:239], v[132:135]
    v_fmac_f32 v205, s28, v209
    v_cvt_pk_bf16_f32 v205, v252, v205
    v_mfma_f32_16x16x32_bf16 v[136:139], a[244:247], v[236:239], v[136:139]
    v_lshlrev_b32 v252, 16, v215
    v_and_b32 v215, s22, v215
    v_mfma_f32_16x16x32_bf16 v[136:139], a[232:235], v[232:235], v[136:139]
    buffer_load_dwordx2 v[194:195], v203, s[4:7], s17 offen offset:576
    v_mfma_f32_16x16x32_bf16 v[140:143], a[236:239], v[232:235], v[140:143]
    ds_read_b128 v[232:235], v253 offset:32768
    v_fmac_f32 v252, s29, v248
    v_mfma_f32_16x16x32_bf16 v[140:143], a[248:251], v[236:239], v[140:143]
    v_fmac_f32 v215, s29, v207
    v_fmac_f32 v252, s23, v250
    v_mfma_f32_16x16x32_bf16 v[120:123], a[252:255], v[236:239], v[120:123]
    v_fmac_f32 v215, s23, v211
    v_cvt_pk_bf16_f32 v215, v252, v215
    v_mfma_f32_16x16x32_bf16 v[124:127], v[240:243], v[236:239], v[124:127]
    v_fma_f32 v252, v249, s24, v251
    v_fmac_f32 v251, -4.0, v249
    v_mfma_f32_16x16x32_bf16 v[128:131], v[244:247], v[236:239], v[128:131]
    buffer_load_dwordx2 v[196:197], v203, s[4:7], s18 offen offset:576
    v_mfma_f32_16x16x32_bf16 v[144:147], a[228:231], v[236:239], v[144:147]
    s_waitcnt lgkmcnt(1)
    v_fma_f32 v249, v248, s24, v250
    v_fmac_f32 v250, -4.0, v248
    v_mfma_f32_16x16x32_bf16 v[144:147], a[240:243], v[228:231], v[144:147]
    v_fma_f32 v248, v250, s26, v251
    v_fmac_f32 v251, s27, v250
    v_mfma_f32_16x16x32_bf16 v[148:151], a[244:247], v[228:231], v[148:151]
    v_fma_f32 v250, v249, 2.0, v252
    v_fmac_f32 v252, -2.0, v249
    v_mfma_f32_16x16x32_bf16 v[148:151], a[232:235], v[236:239], v[148:151]
    v_fma_f32 v249, v209, s24, v213
    v_fmac_f32 v213, -4.0, v209
    v_mfma_f32_16x16x32_bf16 v[152:155], a[236:239], v[236:239], v[152:155]
    ds_read_b128 v[236:239], v253 offset:32512
    v_fma_f32 v209, v207, s24, v211
    v_mfma_f32_16x16x32_bf16 v[152:155], a[248:251], v[228:231], v[152:155]
    buffer_load_dwordx2 v[198:199], v203, s[4:7], s19 offen offset:576
    v_mfma_f32_16x16x32_bf16 v[132:135], a[252:255], v[228:231], v[132:135]
    v_fmac_f32 v211, -4.0, v207
    v_fma_f32 v207, v211, s26, v213
    v_mfma_f32_16x16x32_bf16 v[136:139], v[240:243], v[228:231], v[136:139]
    v_fmac_f32 v213, s27, v211
    v_fma_f32 v211, v209, 2.0, v249
    v_mfma_f32_16x16x32_bf16 v[140:143], v[244:247], v[228:231], v[140:143]
    v_fmac_f32 v249, -2.0, v209
    v_cvt_pk_bf16_f32 v207, v248, v207
    v_mfma_f32_16x16x32_bf16 v[156:159], a[228:231], v[228:231], v[156:159]
    s_waitcnt lgkmcnt(1)
    v_cvt_pk_bf16_f32 v213, v251, v213
    v_cvt_pk_bf16_f32 v211, v250, v211
    v_mfma_f32_16x16x32_bf16 v[156:159], a[240:243], v[232:235], v[156:159]
    buffer_load_dwordx2 v[200:201], v203, s[4:7], s20 offen offset:576
    v_mfma_f32_16x16x32_bf16 v[160:163], a[244:247], v[232:235], v[160:163]
    v_cvt_pk_bf16_f32 v209, v252, v249
    v_lshrrev_b32 v252, 15, v255
    v_mfma_f32_16x16x32_bf16 v[160:163], a[232:235], v[228:231], v[160:163]
    ds_write_b64 v252, v[206:207] offset:0
    v_mfma_f32_16x16x32_bf16 v[164:167], a[236:239], v[228:231], v[164:167]
    ds_read_b128 v[228:231], v253 offset:32256
    s_waitcnt vmcnt(14)
    v_mfma_f32_16x16x32_bf16 v[164:167], a[248:251], v[232:235], v[164:167]
    v_lshlrev_b32 v248, 16, v218
    v_lshlrev_b32 v249, 16, v220
    v_mfma_f32_16x16x32_bf16 v[144:147], a[252:255], v[232:235], v[144:147]
    buffer_load_dwordx2 v[202:203], v203, s[4:7], s21 offen offset:576
    v_mfma_f32_16x16x32_bf16 v[148:151], v[240:243], v[232:235], v[148:151]
    ds_write_b64 v252, v[212:213] offset:2080
    v_mfma_f32_16x16x32_bf16 v[152:155], v[244:247], v[232:235], v[152:155]
    s_waitcnt lgkmcnt(3)
    v_lshlrev_b32 v250, 16, v222
    v_lshlrev_b32 v251, 16, v224
    v_mfma_f32_16x16x32_bf16 v[168:171], a[228:231], v[232:235], v[168:171]
    ds_write_b64 v252, v[210:211] offset:4160
    v_mfma_f32_16x16x32_bf16 v[168:171], a[240:243], v[236:239], v[168:171]
    v_and_b32 v218, s22, v218
    v_and_b32 v220, s22, v220
    v_mfma_f32_16x16x32_bf16 v[172:175], a[244:247], v[236:239], v[172:175]
    ds_write_b64 v252, v[204:205] offset:16640
    v_mfma_f32_16x16x32_bf16 v[172:175], a[232:235], v[232:235], v[172:175]
    v_and_b32 v222, s22, v222
    v_and_b32 v224, s22, v224
    v_mfma_f32_16x16x32_bf16 v[176:179], a[236:239], v[232:235], v[176:179]
    ds_read_b128 v[232:235], v253 offset:31984
    v_mfma_f32_16x16x32_bf16 v[176:179], a[248:251], v[236:239], v[176:179]
    ds_write_b64 v252, v[214:215] offset:24960
    v_mfma_f32_16x16x32_bf16 v[156:159], a[252:255], v[236:239], v[156:159]
    s_waitcnt lgkmcnt(5)
    v_mfma_f32_16x16x32_bf16 v[160:163], v[240:243], v[236:239], v[160:163]
    ds_write_b64 v252, v[208:209] offset:6240
    v_mfma_f32_16x16x32_bf16 v[164:167], v[244:247], v[236:239], v[164:167]
    s_mov_b32 s42, 331776
    v_mfma_f32_16x16x32_bf16 v[180:183], a[228:231], v[236:239], v[180:183]
    buffer_load_dwordx4 a[228:231], v254, s[8:11], s42 offen offset:0 sc1
    v_mfma_f32_16x16x32_bf16 v[184:187], a[232:235], v[236:239], v[184:187]
    s_waitcnt lgkmcnt(0)
    v_lshlrev_b32 v252, 16, v216
    v_and_b32 v216, s22, v216
    v_mfma_f32_16x16x32_bf16 v[188:191], a[236:239], v[236:239], v[188:191]
    s_barrier
    v_mfma_f32_16x16x32_bf16 v[180:183], a[240:243], v[228:231], v[180:183]
    ds_read_b128 v[236:239], v253 offset:1040
    v_fmac_f32 v252, s25, v251
    v_mfma_f32_16x16x32_bf16 v[184:187], a[244:247], v[228:231], v[184:187]
    buffer_load_dwordx4 a[232:235], v254, s[8:11], s42 offen offset:1024 sc1
    v_mfma_f32_16x16x32_bf16 v[188:191], a[248:251], v[228:231], v[188:191]
    v_fmac_f32 v216, s25, v224
    v_fmac_f32 v252, s28, v249
    v_mfma_f32_16x16x32_bf16 v[168:171], a[252:255], v[228:231], v[168:171]
    v_fmac_f32 v216, s28, v220
    v_cvt_pk_bf16_f32 v216, v252, v216
    v_mfma_f32_16x16x32_bf16 v[172:175], v[240:243], v[228:231], v[172:175]
    buffer_load_dwordx4 a[236:239], v254, s[8:11], s42 offen offset:2048 sc1
    v_mfma_f32_16x16x32_bf16 v[176:179], v[244:247], v[228:231], v[176:179]
    ds_read_b128 v[228:231], v253 offset:768
    v_lshlrev_b32 v252, 16, v226
    v_mfma_f32_16x16x32_bf16 v[180:183], a[252:255], v[232:235], v[180:183]
    s_mov_b32 s42, 334848
    v_and_b32 v226, s22, v226
    v_fmac_f32 v252, s29, v248
    v_mfma_f32_16x16x32_bf16 v[184:187], v[240:243], v[232:235], v[184:187]
    buffer_load_dwordx4 a[240:243], v254, s[8:11], s42 offen offset:0 sc1
    v_mfma_f32_16x16x32_bf16 v[188:191], v[244:247], v[232:235], v[188:191]
    ds_read_b128 v[232:235], v253 offset:512
    v_fmac_f32 v226, s29, v218
    s_waitcnt vmcnt(16)
    s_waitcnt lgkmcnt(2)
sub8:
    v_mfma_f32_16x16x32_bf16 a[0:3], a[192:195], v[236:239], a[0:3]
    v_fmac_f32 v252, s23, v250
    v_fmac_f32 v226, s23, v222
    v_mfma_f32_16x16x32_bf16 a[4:7], a[196:199], v[236:239], a[4:7]
    s_waitcnt vmcnt(13) lgkmcnt(1)
    v_cvt_pk_bf16_f32 v226, v252, v226
    v_fma_f32 v252, v249, s24, v251
    v_mfma_f32_16x16x32_bf16 a[8:11], a[200:203], v[236:239], a[8:11]
    ds_read_b128 v[236:239], v253 offset:256
    v_fmac_f32 v251, -4.0, v249
    v_mfma_f32_16x16x32_bf16 a[0:3], a[204:207], v[228:231], a[0:3]
    buffer_load_dwordx4 a[244:247], v254, s[8:11], s42 offen offset:1024 sc1
    v_fma_f32 v249, v248, s24, v250
    v_mfma_f32_16x16x32_bf16 a[4:7], a[208:211], v[228:231], a[4:7]
    v_fmac_f32 v250, -4.0, v248
    v_fma_f32 v248, v250, s26, v251
    v_mfma_f32_16x16x32_bf16 a[8:11], a[212:215], v[228:231], a[8:11]
    v_fmac_f32 v251, s27, v250
    v_fma_f32 v250, v249, 2.0, v252
    v_mfma_f32_16x16x32_bf16 a[12:15], a[192:195], v[228:231], a[12:15]
    s_waitcnt lgkmcnt(1)
    v_fmac_f32 v252, -2.0, v249
    v_fma_f32 v249, v220, s24, v224
    v_mfma_f32_16x16x32_bf16 a[12:15], a[204:207], v[232:235], a[12:15]
    buffer_load_dwordx4 a[248:251], v254, s[8:11], s42 offen offset:2048 sc1
    v_mfma_f32_16x16x32_bf16 a[16:19], a[208:211], v[232:235], a[16:19]
    v_fmac_f32 v224, -4.0, v220
    v_fma_f32 v220, v218, s24, v222
    v_mfma_f32_16x16x32_bf16 a[16:19], a[196:199], v[228:231], a[16:19]
    s_mov_b32 s42, 337920
    v_fmac_f32 v222, -4.0, v218
    v_fma_f32 v218, v222, s26, v224
    v_mfma_f32_16x16x32_bf16 a[20:23], a[200:203], v[228:231], a[20:23]
    ds_read_b128 v[228:231], v253 offset:0
    v_fmac_f32 v224, s27, v222
    v_mfma_f32_16x16x32_bf16 a[20:23], a[212:215], v[232:235], a[20:23]
    buffer_load_dwordx4 a[252:255], v254, s[8:11], s42 offen offset:0 sc1
    s_waitcnt vmcnt(13)
    v_mfma_f32_16x16x32_bf16 a[0:3], a[216:219], v[232:235], a[0:3]
    v_fma_f32 v222, v220, 2.0, v249
    v_fmac_f32 v249, -2.0, v220
    v_mfma_f32_16x16x32_bf16 a[4:7], a[220:223], v[232:235], a[4:7]
    v_cvt_pk_bf16_f32 v218, v248, v218
    v_cvt_pk_bf16_f32 v224, v251, v224
    v_mfma_f32_16x16x32_bf16 a[8:11], a[224:227], v[232:235], a[8:11]
    s_waitcnt lgkmcnt(1)
    v_cvt_pk_bf16_f32 v222, v250, v222
    v_cvt_pk_bf16_f32 v220, v252, v249
    v_mfma_f32_16x16x32_bf16 a[24:27], a[192:195], v[232:235], a[24:27]
    buffer_load_dwordx4 v[240:243], v254, s[8:11], s42 offen offset:1024 sc1
    v_mfma_f32_16x16x32_bf16 a[24:27], a[204:207], v[236:239], a[24:27]
    v_lshlrev_b32 v248, 16, v219
    v_lshlrev_b32 v249, 16, v221
    v_mfma_f32_16x16x32_bf16 a[28:31], a[208:211], v[236:239], a[28:31]
    v_lshlrev_b32 v250, 16, v223
    v_lshlrev_b32 v251, 16, v225
    v_mfma_f32_16x16x32_bf16 a[28:31], a[196:199], v[232:235], a[28:31]
    buffer_load_dwordx4 v[244:247], v254, s[8:11], s42 offen offset:2048 sc1
    v_mfma_f32_16x16x32_bf16 a[32:35], a[200:203], v[232:235], a[32:35]
    ds_read_b128 v[232:235], v253 offset:1824
    v_and_b32 v215, 0x7fff, v255
    v_mfma_f32_16x16x32_bf16 a[32:35], a[212:215], v[236:239], a[32:35]
    v_and_b32 v219, s22, v219
    v_and_b32 v221, s22, v221
    v_mfma_f32_16x16x32_bf16 a[12:15], a[216:219], v[236:239], a[12:15]
    v_and_b32 v223, s22, v223
    v_and_b32 v225, s22, v225
    v_mfma_f32_16x16x32_bf16 a[16:19], a[220:223], v[236:239], a[16:19]
    buffer_load_dwordx2 v[204:205], v215, s[4:7], s16 offen offset:960
    v_mfma_f32_16x16x32_bf16 a[20:23], a[224:227], v[236:239], a[20:23]
    v_lshlrev_b32 v252, 16, v217
    v_and_b32 v217, s22, v217
    v_fmac_f32 v252, s25, v251
    v_mfma_f32_16x16x32_bf16 a[36:39], a[192:195], v[236:239], a[36:39]
    s_waitcnt lgkmcnt(1)
    v_fmac_f32 v217, s25, v225
    v_fmac_f32 v252, s28, v249
    v_mfma_f32_16x16x32_bf16 a[36:39], a[204:207], v[228:231], a[36:39]
    v_fmac_f32 v217, s28, v221
    v_cvt_pk_bf16_f32 v217, v252, v217
    v_mfma_f32_16x16x32_bf16 a[40:43], a[208:211], v[228:231], a[40:43]
    v_lshlrev_b32 v252, 16, v227
    v_and_b32 v227, s22, v227
    v_mfma_f32_16x16x32_bf16 a[40:43], a[196:199], v[236:239], a[40:43]
    buffer_load_dwordx2 v[206:207], v215, s[4:7], s17 offen offset:960
    v_mfma_f32_16x16x32_bf16 a[44:47], a[200:203], v[236:239], a[44:47]
    ds_read_b128 v[236:239], v253 offset:1568
    v_fmac_f32 v252, s29, v248
    v_mfma_f32_16x16x32_bf16 a[44:47], a[212:215], v[228:231], a[44:47]
    v_fmac_f32 v227, s29, v219
    v_fmac_f32 v252, s23, v250
    v_mfma_f32_16x16x32_bf16 a[24:27], a[216:219], v[228:231], a[24:27]
    v_fmac_f32 v227, s23, v223
    v_cvt_pk_bf16_f32 v227, v252, v227
    v_mfma_f32_16x16x32_bf16 a[28:31], a[220:223], v[228:231], a[28:31]
    v_fma_f32 v252, v249, s24, v251
    v_fmac_f32 v251, -4.0, v249
    v_mfma_f32_16x16x32_bf16 a[32:35], a[224:227], v[228:231], a[32:35]
    buffer_load_dwordx2 v[208:209], v215, s[4:7], s18 offen offset:960
    v_mfma_f32_16x16x32_bf16 a[48:51], a[192:195], v[228:231], a[48:51]
    s_waitcnt lgkmcnt(1)
    v_fma_f32 v249, v248, s24, v250
    v_fmac_f32 v250, -4.0, v248
    v_mfma_f32_16x16x32_bf16 a[48:51], a[204:207], v[232:235], a[48:51]
    v_fma_f32 v248, v250, s26, v251
    v_fmac_f32 v251, s27, v250
    v_mfma_f32_16x16x32_bf16 a[52:55], a[208:211], v[232:235], a[52:55]
    v_fma_f32 v250, v249, 2.0, v252
    v_fmac_f32 v252, -2.0, v249
    v_mfma_f32_16x16x32_bf16 a[52:55], a[196:199], v[228:231], a[52:55]
pad3:
    s_cbranch_vccnz pad7
    v_fma_f32 v249, v221, s24, v225
    v_fmac_f32 v225, -4.0, v221
    v_mfma_f32_16x16x32_bf16 a[56:59], a[200:203], v[228:231], a[56:59]
    ds_read_b128 v[228:231], v253 offset:1312
    v_fma_f32 v221, v219, s24, v223
    v_mfma_f32_16x16x32_bf16 a[56:59], a[212:215], v[232:235], a[56:59]
    buffer_load_dwordx2 v[210:211], v215, s[4:7], s19 offen offset:960
    v_mfma_f32_16x16x32_bf16 a[36:39], a[216:219], v[232:235], a[36:39]
    v_fmac_f32 v223, -4.0, v219
    v_fma_f32 v219, v223, s26, v225
    v_mfma_f32_16x16x32_bf16 a[40:43], a[220:223], v[232:235], a[40:43]
    v_fmac_f32 v225, s27, v223
    v_fma_f32 v223, v221, 2.0, v249
    v_mfma_f32_16x16x32_bf16 a[44:47], a[224:227], v[232:235], a[44:47]
    v_fmac_f32 v249, -2.0, v221
    v_cvt_pk_bf16_f32 v219, v248, v219
    v_mfma_f32_16x16x32_bf16 a[60:63], a[192:195], v[232:235], a[60:63]
    s_waitcnt lgkmcnt(1)
    v_cvt_pk_bf16_f32 v225, v251, v225
    v_cvt_pk_bf16_f32 v223, v250, v223
    v_mfma_f32_16x16x32_bf16 a[60:63], a[204:207], v[236:239], a[60:63]
    buffer_load_dwordx2 v[212:213], v215, s[4:7], s20 offen offset:960
    v_cvt_pk_bf16_f32 v221, v252, v249
    v_mfma_f32_16x16x32_bf16 a[64:67], a[208:211], v[236:239], a[64:67]
    v_lshrrev_b32 v252, 15, v255
    v_mfma_f32_16x16x32_bf16 a[64:67], a[196:199], v[232:235], a[64:67]
    ds_write_b64 v252, v[218:219] offset:9088
    v_mfma_f32_16x16x32_bf16 a[68:71], a[200:203], v[232:235], a[68:71]
    ds_read_b128 v[232:235], v253 offset:1056
    s_waitcnt vmcnt(14)
    v_mfma_f32_16x16x32_bf16 a[68:71], a[212:215], v[236:239], a[68:71]
    v_lshlrev_b32 v248, 16, v194
    v_lshlrev_b32 v249, 16, v196
    v_mfma_f32_16x16x32_bf16 a[48:51], a[216:219], v[236:239], a[48:51]
    buffer_load_dwordx2 v[214:215], v215, s[4:7], s21 offen offset:960
    v_mfma_f32_16x16x32_bf16 a[52:55], a[220:223], v[236:239], a[52:55]
    ds_write_b64 v252, v[224:225] offset:11168
    v_mfma_f32_16x16x32_bf16 a[56:59], a[224:227], v[236:239], a[56:59]
    s_waitcnt lgkmcnt(3)
    v_lshlrev_b32 v250, 16, v198
    v_lshlrev_b32 v251, 16, v200
    v_mfma_f32_16x16x32_bf16 a[72:75], a[192:195], v[236:239], a[72:75]
    ds_write_b64 v252, v[222:223] offset:13248
    v_mfma_f32_16x16x32_bf16 a[72:75], a[204:207], v[228:231], a[72:75]
    v_and_b32 v194, s22, v194
    v_and_b32 v196, s22, v196
    v_mfma_f32_16x16x32_bf16 a[76:79], a[208:211], v[228:231], a[76:79]
    ds_write_b64 v252, v[216:217] offset:19488
    v_mfma_f32_16x16x32_bf16 a[76:79], a[196:199], v[236:239], a[76:79]
    v_and_b32 v198, s22, v198
    v_and_b32 v200, s22, v200
    v_mfma_f32_16x16x32_bf16 a[80:83], a[200:203], v[236:239], a[80:83]
    ds_read_b128 v[236:239], v253 offset:784
    v_mfma_f32_16x16x32_bf16 a[80:83], a[212:215], v[228:231], a[80:83]
    ds_write_b64 v252, v[226:227] offset:27808
    v_mfma_f32_16x16x32_bf16 a[60:63], a[216:219], v[228:231], a[60:63]
    v_mfma_f32_16x16x32_bf16 a[64:67], a[220:223], v[228:231], a[64:67]
    ds_write_b64 v252, v[220:221] offset:31968
    v_mfma_f32_16x16x32_bf16 a[68:71], a[224:227], v[228:231], a[68:71]
    s_mov_b32 s42, 368640
    v_mfma_f32_16x16x32_bf16 a[84:87], a[192:195], v[228:231], a[84:87]
    buffer_load_dwordx4 a[192:195], v254, s[8:11], s42 offen offset:0 sc1
    v_mfma_f32_16x16x32_bf16 a[88:91], a[196:199], v[228:231], a[88:91]
    v_lshlrev_b32 v252, 16, v192
    v_and_b32 v192, s22, v192
    v_mfma_f32_16x16x32_bf16 a[92:95], a[200:203], v[228:231], a[92:95]
    s_waitcnt lgkmcnt(6)
    v_fmac_f32 v252, s25, v251
    v_fmac_f32 v192, s25, v200
    v_mfma_f32_16x16x32_bf16 a[84:87], a[204:207], v[232:235], a[84:87]
    ds_read_b128 v[228:231], v253 offset:3120
    v_fmac_f32 v252, s28, v249
    v_mfma_f32_16x16x32_bf16 a[88:91], a[208:211], v[232:235], a[88:91]
    buffer_load_dwordx4 a[196:199], v254, s[8:11], s42 offen offset:1024 sc1
    v_mfma_f32_16x16x32_bf16 a[92:95], a[212:215], v[232:235], a[92:95]
    v_fmac_f32 v192, s28, v196
    v_cvt_pk_bf16_f32 v192, v252, v192
    v_mfma_f32_16x16x32_bf16 a[72:75], a[216:219], v[232:235], a[72:75]
    s_waitcnt lgkmcnt(3)
    v_lshlrev_b32 v252, 16, v202
    v_and_b32 v202, s22, v202
    v_mfma_f32_16x16x32_bf16 a[76:79], a[220:223], v[232:235], a[76:79]
    buffer_load_dwordx4 a[200:203], v254, s[8:11], s42 offen offset:2048 sc1
    v_mfma_f32_16x16x32_bf16 a[80:83], a[224:227], v[232:235], a[80:83]
    ds_read_b128 v[232:235], v253 offset:2848
    v_fmac_f32 v252, s29, v248
    v_mfma_f32_16x16x32_bf16 a[84:87], a[216:219], v[236:239], a[84:87]
    s_mov_b32 s42, 371712
    v_fmac_f32 v202, s29, v194
    v_fmac_f32 v252, s23, v250
    v_mfma_f32_16x16x32_bf16 a[88:91], a[220:223], v[236:239], a[88:91]
    buffer_load_dwordx4 a[204:207], v254, s[8:11], s42 offen offset:0 sc1
    v_mfma_f32_16x16x32_bf16 a[92:95], a[224:227], v[236:239], a[92:95]
    ds_read_b128 v[236:239], v253 offset:2592
    v_fmac_f32 v202, s23, v198
    s_waitcnt vmcnt(16)
    s_waitcnt lgkmcnt(2)
sub9:
    v_mfma_f32_16x16x32_bf16 a[96:99], a[228:231], v[228:231], a[96:99]
    v_cvt_pk_bf16_f32 v202, v252, v202
    v_fma_f32 v252, v249, s24, v251
    v_mfma_f32_16x16x32_bf16 a[100:103], a[232:235], v[228:231], a[100:103]
    s_waitcnt vmcnt(13) lgkmcnt(1)
    v_fmac_f32 v251, -4.0, v249
    v_fma_f32 v249, v248, s24, v250
    v_mfma_f32_16x16x32_bf16 a[104:107], a[236:239], v[228:231], a[104:107]
    ds_read_b128 v[228:231], v253 offset:2336
    v_fmac_f32 v250, -4.0, v248
    v_mfma_f32_16x16x32_bf16 a[96:99], a[240:243], v[232:235], a[96:99]
    buffer_load_dwordx4 a[208:211], v254, s[8:11], s42 offen offset:1024 sc1
    v_mfma_f32_16x16x32_bf16 a[100:103], a[244:247], v[232:235], a[100:103]
    v_fma_f32 v248, v250, s26, v251
    v_fmac_f32 v251, s27, v250
    v_mfma_f32_16x16x32_bf16 a[104:107], a[248:251], v[232:235], a[104:107]
    v_fma_f32 v250, v249, 2.0, v252
    v_fmac_f32 v252, -2.0, v249
    v_mfma_f32_16x16x32_bf16 a[108:111], a[228:231], v[232:235], a[108:111]
    s_waitcnt lgkmcnt(1)
    v_fma_f32 v249, v196, s24, v200
    v_fmac_f32 v200, -4.0, v196
    v_mfma_f32_16x16x32_bf16 a[108:111], a[240:243], v[236:239], a[108:111]
    buffer_load_dwordx4 a[212:215], v254, s[8:11], s42 offen offset:2048 sc1
    v_mfma_f32_16x16x32_bf16 a[112:115], a[244:247], v[236:239], a[112:115]
    v_fma_f32 v196, v194, s24, v198
    v_fmac_f32 v198, -4.0, v194
    v_mfma_f32_16x16x32_bf16 a[112:115], a[232:235], v[232:235], a[112:115]
    s_mov_b32 s42, 374784
    v_fma_f32 v194, v198, s26, v200
    v_fmac_f32 v200, s27, v198
    v_mfma_f32_16x16x32_bf16 a[116:119], a[236:239], v[232:235], a[116:119]
    ds_read_b128 v[232:235], v253 offset:2080
    v_fma_f32 v198, v196, 2.0, v249
    v_mfma_f32_16x16x32_bf16 a[116:119], a[248:251], v[236:239], a[116:119]
    buffer_load_dwordx4 a[216:219], v254, s[8:11], s42 offen offset:0 sc1
    s_waitcnt vmcnt(13)
    v_mfma_f32_16x16x32_bf16 a[96:99], a[252:255], v[236:239], a[96:99]
    v_fmac_f32 v249, -2.0, v196
    v_cvt_pk_bf16_f32 v194, v248, v194
    v_mfma_f32_16x16x32_bf16 a[100:103], v[240:243], v[236:239], a[100:103]
    v_cvt_pk_bf16_f32 v200, v251, v200
    v_cvt_pk_bf16_f32 v198, v250, v198
    v_mfma_f32_16x16x32_bf16 a[104:107], v[244:247], v[236:239], a[104:107]
    s_waitcnt lgkmcnt(1)
    v_cvt_pk_bf16_f32 v196, v252, v249
    v_lshlrev_b32 v248, 16, v195
    v_mfma_f32_16x16x32_bf16 a[120:123], a[228:231], v[236:239], a[120:123]
    buffer_load_dwordx4 a[220:223], v254, s[8:11], s42 offen offset:1024 sc1
    v_mfma_f32_16x16x32_bf16 a[120:123], a[240:243], v[228:231], a[120:123]
    v_lshlrev_b32 v249, 16, v197
    v_lshlrev_b32 v250, 16, v199
    v_mfma_f32_16x16x32_bf16 a[124:127], a[244:247], v[228:231], a[124:127]
    v_lshlrev_b32 v251, 16, v201
    v_and_b32 v195, s22, v195
    v_mfma_f32_16x16x32_bf16 a[124:127], a[232:235], v[236:239], a[124:127]
    buffer_load_dwordx4 a[224:227], v254, s[8:11], s42 offen offset:2048 sc1
    v_mfma_f32_16x16x32_bf16 a[128:131], a[236:239], v[236:239], a[128:131]
    ds_read_b128 v[236:239], v253 offset:3904
    v_and_b32 v227, 0x7fff, v255
    v_mfma_f32_16x16x32_bf16 a[128:131], a[248:251], v[228:231], a[128:131]
    v_and_b32 v197, s22, v197
    v_and_b32 v199, s22, v199
    v_mfma_f32_16x16x32_bf16 a[108:111], a[252:255], v[228:231], a[108:111]
    v_and_b32 v201, s22, v201
    v_lshlrev_b32 v252, 16, v193
    v_mfma_f32_16x16x32_bf16 a[112:115], v[240:243], v[228:231], a[112:115]
    buffer_load_dwordx2 v[216:217], v227, s[4:7], s16 offen offset:1344
    v_mfma_f32_16x16x32_bf16 a[116:119], v[244:247], v[228:231], a[116:119]
    v_and_b32 v193, s22, v193
    v_fmac_f32 v252, s25, v251
    v_mfma_f32_16x16x32_bf16 a[132:135], a[228:231], v[228:231], a[132:135]
    s_waitcnt lgkmcnt(1)
    v_fmac_f32 v193, s25, v201
    v_fmac_f32 v252, s28, v249
    v_mfma_f32_16x16x32_bf16 a[132:135], a[240:243], v[232:235], a[132:135]
    v_fmac_f32 v193, s28, v197
    v_cvt_pk_bf16_f32 v193, v252, v193
    v_mfma_f32_16x16x32_bf16 a[136:139], a[244:247], v[232:235], a[136:139]
    v_lshlrev_b32 v252, 16, v203
    v_and_b32 v203, s22, v203
    v_mfma_f32_16x16x32_bf16 a[136:139], a[232:235], v[228:231], a[136:139]
    buffer_load_dwordx2 v[218:219], v227, s[4:7], s17 offen offset:1344
    v_mfma_f32_16x16x32_bf16 a[140:143], a[236:239], v[228:231], a[140:143]
    ds_read_b128 v[228:231], v253 offset:3648
    v_fmac_f32 v252, s29, v248
    v_mfma_f32_16x16x32_bf16 a[140:143], a[248:251], v[232:235], a[140:143]
    v_fmac_f32 v203, s29, v195
    v_fmac_f32 v252, s23, v250
    v_mfma_f32_16x16x32_bf16 a[120:123], a[252:255], v[232:235], a[120:123]
    v_fmac_f32 v203, s23, v199
    v_cvt_pk_bf16_f32 v203, v252, v203
    v_mfma_f32_16x16x32_bf16 a[124:127], v[240:243], v[232:235], a[124:127]
    v_fma_f32 v252, v249, s24, v251
    v_fmac_f32 v251, -4.0, v249
    v_mfma_f32_16x16x32_bf16 a[128:131], v[244:247], v[232:235], a[128:131]
    buffer_load_dwordx2 v[220:221], v227, s[4:7], s18 offen offset:1344
    v_mfma_f32_16x16x32_bf16 a[144:147], a[228:231], v[232:235], a[144:147]
    s_waitcnt lgkmcnt(1)
    v_fma_f32 v249, v248, s24, v250
    v_fmac_f32 v250, -4.0, v248
    v_mfma_f32_16x16x32_bf16 a[144:147], a[240:243], v[236:239], a[144:147]
    v_fma_f32 v248, v250, s26, v251
    v_fmac_f32 v251, s27, v250
    v_mfma_f32_16x16x32_bf16 a[148:151], a[244:247], v[236:239], a[148:151]
    v_fma_f32 v250, v249, 2.0, v252
    v_fmac_f32 v252, -2.0, v249
    v_mfma_f32_16x16x32_bf16 a[148:151], a[232:235], v[232:235], a[148:151]
    v_fma_f32 v249, v197, s24, v201
    v_fmac_f32 v201, -4.0, v197
    v_mfma_f32_16x16x32_bf16 a[152:155], a[236:239], v[232:235], a[152:155]
    ds_read_b128 v[232:235], v253 offset:3392
    v_fma_f32 v197, v195, s24, v199
    v_mfma_f32_16x16x32_bf16 a[152:155], a[248:251], v[236:239], a[152:155]
    buffer_load_dwordx2 v[222:223], v227, s[4:7], s19 offen offset:1344
    v_mfma_f32_16x16x32_bf16 a[132:135], a[252:255], v[236:239], a[132:135]
    v_fmac_f32 v199, -4.0, v195
    v_fma_f32 v195, v199, s26, v201
    v_mfma_f32_16x16x32_bf16 a[136:139], v[240:243], v[236:239], a[136:139]
    v_fmac_f32 v201, s27, v199
    v_fma_f32 v199, v197, 2.0, v249
    v_mfma_f32_16x16x32_bf16 a[140:143], v[244:247], v[236:239], a[140:143]
    v_fmac_f32 v249, -2.0, v197
    v_cvt_pk_bf16_f32 v195, v248, v195
    v_mfma_f32_16x16x32_bf16 a[156:159], a[228:231], v[236:239], a[156:159]
    s_waitcnt lgkmcnt(1)
    v_cvt_pk_bf16_f32 v201, v251, v201
    v_cvt_pk_bf16_f32 v199, v250, v199
    v_mfma_f32_16x16x32_bf16 a[156:159], a[240:243], v[228:231], a[156:159]
    buffer_load_dwordx2 v[224:225], v227, s[4:7], s20 offen offset:1344
    v_mfma_f32_16x16x32_bf16 a[160:163], a[244:247], v[228:231], a[160:163]
    v_cvt_pk_bf16_f32 v197, v252, v249
    v_lshrrev_b32 v252, 15, v255
    v_mfma_f32_16x16x32_bf16 a[160:163], a[232:235], v[236:239], a[160:163]
    ds_write_b64 v252, v[194:195] offset:8832
    v_mfma_f32_16x16x32_bf16 a[164:167], a[236:239], v[236:239], a[164:167]
    ds_read_b128 v[236:239], v253 offset:3136
    s_waitcnt vmcnt(14)
    v_mfma_f32_16x16x32_bf16 a[164:167], a[248:251], v[228:231], a[164:167]
    v_lshlrev_b32 v248, 16, v206
    v_lshlrev_b32 v249, 16, v208
    v_mfma_f32_16x16x32_bf16 a[144:147], a[252:255], v[228:231], a[144:147]
    buffer_load_dwordx2 v[226:227], v227, s[4:7], s21 offen offset:1344
    v_mfma_f32_16x16x32_bf16 a[148:151], v[240:243], v[228:231], a[148:151]
    ds_write_b64 v252, v[200:201] offset:10912
    v_mfma_f32_16x16x32_bf16 a[152:155], v[244:247], v[228:231], a[152:155]
    s_waitcnt lgkmcnt(3)
    v_lshlrev_b32 v250, 16, v210
    v_lshlrev_b32 v251, 16, v212
    v_mfma_f32_16x16x32_bf16 a[168:171], a[228:231], v[228:231], a[168:171]
    ds_write_b64 v252, v[198:199] offset:12992
    v_mfma_f32_16x16x32_bf16 a[168:171], a[240:243], v[232:235], a[168:171]
    v_and_b32 v206, s22, v206
    v_and_b32 v208, s22, v208
    v_mfma_f32_16x16x32_bf16 a[172:175], a[244:247], v[232:235], a[172:175]
    ds_write_b64 v252, v[192:193] offset:19232
    v_mfma_f32_16x16x32_bf16 a[172:175], a[232:235], v[228:231], a[172:175]
    v_and_b32 v210, s22, v210
    v_and_b32 v212, s22, v212
    v_mfma_f32_16x16x32_bf16 a[176:179], a[236:239], v[228:231], a[176:179]
    ds_read_b128 v[228:231], v253 offset:2864
    v_mfma_f32_16x16x32_bf16 a[176:179], a[248:251], v[232:235], a[176:179]
    ds_write_b64 v252, v[202:203] offset:27552
    v_mfma_f32_16x16x32_bf16 a[156:159], a[252:255], v[232:235], a[156:159]
    v_mfma_f32_16x16x32_bf16 a[160:163], v[240:243], v[232:235], a[160:163]
    ds_write_b64 v252, v[196:197] offset:31712
    v_mfma_f32_16x16x32_bf16 a[164:167], v[244:247], v[232:235], a[164:167]
    s_mov_b32 s42, 405504
    v_mfma_f32_16x16x32_bf16 a[180:183], a[228:231], v[232:235], a[180:183]
    buffer_load_dwordx4 a[228:231], v254, s[8:11], s42 offen offset:0 sc1
    v_mfma_f32_16x16x32_bf16 a[184:187], a[232:235], v[232:235], a[184:187]
    v_lshlrev_b32 v252, 16, v204
    v_and_b32 v204, s22, v204
    v_fmac_f32 v252, s25, v251
    v_mfma_f32_16x16x32_bf16 a[188:191], a[236:239], v[232:235], a[188:191]
    s_waitcnt lgkmcnt(2)
    v_fmac_f32 v204, s25, v212
    v_fmac_f32 v252, s28, v249
    v_mfma_f32_16x16x32_bf16 a[180:183], a[240:243], v[236:239], a[180:183]
    ds_read_b128 v[232:235], v253 offset:5200
    v_fmac_f32 v204, s28, v208
    v_mfma_f32_16x16x32_bf16 a[184:187], a[244:247], v[236:239], a[184:187]
    buffer_load_dwordx4 a[232:235], v254, s[8:11], s42 offen offset:1024 sc1
    v_mfma_f32_16x16x32_bf16 a[188:191], a[248:251], v[236:239], a[188:191]
    ds_read_b128 v[192:195], v253 offset:40096
    v_cvt_pk_bf16_f32 v204, v252, v204
    v_mfma_f32_16x16x32_bf16 a[168:171], a[252:255], v[236:239], a[168:171]
    s_mov_b32 s45, 452138121
    v_lshlrev_b32 v252, 16, v214
    v_and_b32 v214, s22, v214
    v_fmac_f32 v252, s29, v248
    v_mfma_f32_16x16x32_bf16 a[172:175], v[240:243], v[236:239], a[172:175]
    buffer_load_dwordx4 a[236:239], v254, s[8:11], s42 offen offset:2048 sc1
    v_mfma_f32_16x16x32_bf16 a[176:179], v[244:247], v[236:239], a[176:179]
    ds_read_b128 v[236:239], v253 offset:4928
    v_fmac_f32 v214, s29, v206
    v_mfma_f32_16x16x32_bf16 a[180:183], a[252:255], v[228:231], a[180:183]
    s_mov_b32 s42, 408576
    v_bfe_u32 v196, v254, 5, 3
    v_fmac_f32 v252, s23, v250
    v_mfma_f32_16x16x32_bf16 a[184:187], v[240:243], v[228:231], a[184:187]
    buffer_load_dwordx4 a[240:243], v254, s[8:11], s42 offen offset:0 sc1
    v_mfma_f32_16x16x32_bf16 a[188:191], v[244:247], v[228:231], a[188:191]
    ds_read_b128 v[228:231], v253 offset:4672
    v_mul_u32_u24 v197, 5, v196
    v_fmac_f32 v214, s23, v210
    s_waitcnt vmcnt(16)
    s_waitcnt lgkmcnt(3)
sub10:
    v_mfma_f32_16x16x32_bf16 v[0:3], a[192:195], v[232:235], v[0:3]
    v_cvt_pk_bf16_f32 v214, v252, v214
    v_fma_f32 v252, v249, s24, v251
    v_mfma_f32_16x16x32_bf16 v[4:7], a[196:199], v[232:235], v[4:7]
    s_waitcnt vmcnt(13) lgkmcnt(1)
    v_fmac_f32 v251, -4.0, v249
    v_fma_f32 v249, v248, s24, v250
    v_mfma_f32_16x16x32_bf16 v[8:11], a[200:203], v[232:235], v[8:11]
    ds_read_b128 v[232:235], v253 offset:4416
    v_bfe_u32 v197, s45, v197, 5
    v_mfma_f32_16x16x32_bf16 v[0:3], a[204:207], v[236:239], v[0:3]
    buffer_load_dwordx4 a[244:247], v254, s[8:11], s42 offen offset:1024 sc1
    v_mfma_f32_16x16x32_bf16 v[4:7], a[208:211], v[236:239], v[4:7]
    v_fmac_f32 v250, -4.0, v248
    v_fma_f32 v248, v250, s26, v251
    v_fmac_f32 v251, s27, v250
    v_mfma_f32_16x16x32_bf16 v[8:11], a[212:215], v[236:239], v[8:11]
    v_mul_u32_u24 v197, 65, v197
    v_fma_f32 v250, v249, 2.0, v252
    v_mfma_f32_16x16x32_bf16 v[12:15], a[192:195], v[236:239], v[12:15]
    s_waitcnt lgkmcnt(1)
    v_fmac_f32 v252, -2.0, v249
    v_fma_f32 v249, v208, s24, v212
    v_mfma_f32_16x16x32_bf16 v[12:15], a[204:207], v[228:231], v[12:15]
    buffer_load_dwordx4 a[248:251], v254, s[8:11], s42 offen offset:2048 sc1
    v_mfma_f32_16x16x32_bf16 v[16:19], a[208:211], v[228:231], v[16:19]
    v_sub_u32 v197, v197, v196
    v_fmac_f32 v212, -4.0, v208
    v_mfma_f32_16x16x32_bf16 v[16:19], a[196:199], v[236:239], v[16:19]
    s_mov_b32 s42, 411648
    v_fma_f32 v208, v206, s24, v210
    v_fmac_f32 v210, -4.0, v206
    v_fma_f32 v206, v210, s26, v212
    v_mfma_f32_16x16x32_bf16 v[20:23], a[200:203], v[236:239], v[20:23]
    ds_read_b128 v[236:239], v253 offset:4160
    v_lshl_add_u32 v196, v197, 5, v253
    v_mfma_f32_16x16x32_bf16 v[20:23], a[212:215], v[228:231], v[20:23]
    buffer_load_dwordx4 a[252:255], v254, s[8:11], s42 offen offset:0 sc1
    s_waitcnt vmcnt(13)
    v_mfma_f32_16x16x32_bf16 v[0:3], a[216:219], v[228:231], v[0:3]
    v_fmac_f32 v212, s27, v210
    v_fma_f32 v210, v208, 2.0, v249
    v_mfma_f32_16x16x32_bf16 v[4:7], a[220:223], v[228:231], v[4:7]
    v_fmac_f32 v249, -2.0, v208
    v_cvt_pk_bf16_f32 v206, v248, v206
    v_mfma_f32_16x16x32_bf16 v[8:11], a[224:227], v[228:231], v[8:11]
    s_waitcnt lgkmcnt(1)
    v_cvt_pk_bf16_f32 v212, v251, v212
    v_cvt_pk_bf16_f32 v210, v250, v210
    v_cvt_pk_bf16_f32 v208, v252, v249
    v_mfma_f32_16x16x32_bf16 v[24:27], a[192:195], v[228:231], v[24:27]
    buffer_load_dwordx4 v[240:243], v254, s[8:11], s42 offen offset:1024 sc1
    v_mfma_f32_16x16x32_bf16 v[24:27], a[204:207], v[232:235], v[24:27]
    s_mov_b64 exec, s[46:47]
    ds_write_b128 v196, v[192:195] offset:1024
    s_mov_b64 exec, -1
    v_mfma_f32_16x16x32_bf16 v[28:31], a[208:211], v[232:235], v[28:31]
    v_lshlrev_b32 v248, 16, v207
    v_lshlrev_b32 v249, 16, v209
    v_mfma_f32_16x16x32_bf16 v[28:31], a[196:199], v[228:231], v[28:31]
    buffer_load_dwordx4 v[244:247], v254, s[8:11], s42 offen offset:2048 sc1
    v_mfma_f32_16x16x32_bf16 v[32:35], a[200:203], v[228:231], v[32:35]
    ds_read_b128 v[228:231], v253 offset:5984
    v_and_b32 v203, 0x7fff, v255
    v_lshlrev_b32 v250, 16, v211
    v_mfma_f32_16x16x32_bf16 v[32:35], a[212:215], v[232:235], v[32:35]
    v_lshlrev_b32 v251, 16, v213
    v_and_b32 v207, s22, v207
    v_mfma_f32_16x16x32_bf16 v[12:15], a[216:219], v[232:235], v[12:15]
    v_and_b32 v209, s22, v209
    v_and_b32 v211, s22, v211
    v_mfma_f32_16x16x32_bf16 v[16:19], a[220:223], v[232:235], v[16:19]
    buffer_load_dwordx2 v[192:193], v203, s[4:7], s16 offen offset:256
    v_mfma_f32_16x16x32_bf16 v[20:23], a[224:227], v[232:235], v[20:23]
    v_and_b32 v213, s22, v213
    v_lshlrev_b32 v252, 16, v205
    v_mfma_f32_16x16x32_bf16 v[36:39], a[192:195], v[232:235], v[36:39]
    s_waitcnt lgkmcnt(2)
    v_and_b32 v205, s22, v205
    v_fmac_f32 v252, s25, v251
    v_fmac_f32 v205, s25, v213
    v_mfma_f32_16x16x32_bf16 v[36:39], a[204:207], v[236:239], v[36:39]
    v_fmac_f32 v252, s28, v249
    v_fmac_f32 v205, s28, v209
    v_mfma_f32_16x16x32_bf16 v[40:43], a[208:211], v[236:239], v[40:43]
    v_cvt_pk_bf16_f32 v205, v252, v205
    v_lshlrev_b32 v252, 16, v215
    v_mfma_f32_16x16x32_bf16 v[40:43], a[196:199], v[232:235], v[40:43]
    buffer_load_dwordx2 v[194:195], v203, s[4:7], s17 offen offset:256
    v_mfma_f32_16x16x32_bf16 v[44:47], a[200:203], v[232:235], v[44:47]
    ds_read_b128 v[232:235], v253 offset:5728
    v_and_b32 v215, s22, v215
    v_mfma_f32_16x16x32_bf16 v[44:47], a[212:215], v[236:239], v[44:47]
    v_fmac_f32 v252, s29, v248
    v_fmac_f32 v215, s29, v207
    v_fmac_f32 v252, s23, v250
    v_mfma_f32_16x16x32_bf16 v[24:27], a[216:219], v[236:239], v[24:27]
    v_fmac_f32 v215, s23, v211
    v_cvt_pk_bf16_f32 v215, v252, v215
    v_mfma_f32_16x16x32_bf16 v[28:31], a[220:223], v[236:239], v[28:31]
    v_fma_f32 v252, v249, s24, v251
    v_fmac_f32 v251, -4.0, v249
    v_mfma_f32_16x16x32_bf16 v[32:35], a[224:227], v[236:239], v[32:35]
    buffer_load_dwordx2 v[196:197], v203, s[4:7], s18 offen offset:256
    v_mfma_f32_16x16x32_bf16 v[48:51], a[192:195], v[236:239], v[48:51]
    s_waitcnt lgkmcnt(1)
    v_fma_f32 v249, v248, s24, v250
    v_fmac_f32 v250, -4.0, v248
    v_mfma_f32_16x16x32_bf16 v[48:51], a[204:207], v[228:231], v[48:51]
    v_fma_f32 v248, v250, s26, v251
    v_fmac_f32 v251, s27, v250
    v_fma_f32 v250, v249, 2.0, v252
    v_mfma_f32_16x16x32_bf16 v[52:55], a[208:211], v[228:231], v[52:55]
    v_fmac_f32 v252, -2.0, v249
    v_fma_f32 v249, v209, s24, v213
    v_mfma_f32_16x16x32_bf16 v[52:55], a[196:199], v[236:239], v[52:55]
    v_fmac_f32 v213, -4.0, v209
    v_fma_f32 v209, v207, s24, v211
    v_mfma_f32_16x16x32_bf16 v[56:59], a[200:203], v[236:239], v[56:59]
    ds_read_b128 v[236:239], v253 offset:5472
    v_fmac_f32 v211, -4.0, v207
    v_mfma_f32_16x16x32_bf16 v[56:59], a[212:215], v[228:231], v[56:59]
    buffer_load_dwordx2 v[198:199], v203, s[4:7], s19 offen offset:256
    v_mfma_f32_16x16x32_bf16 v[36:39], a[216:219], v[228:231], v[36:39]
    v_fma_f32 v207, v211, s26, v213
    v_fmac_f32 v213, s27, v211
    v_fma_f32 v211, v209, 2.0, v249
    v_mfma_f32_16x16x32_bf16 v[40:43], a[220:223], v[228:231], v[40:43]
    v_fmac_f32 v249, -2.0, v209
    v_cvt_pk_bf16_f32 v207, v248, v207
    v_mfma_f32_16x16x32_bf16 v[44:47], a[224:227], v[228:231], v[44:47]
    v_cvt_pk_bf16_f32 v213, v251, v213
    v_cvt_pk_bf16_f32 v211, v250, v211
    v_mfma_f32_16x16x32_bf16 v[60:63], a[192:195], v[228:231], v[60:63]
    s_waitcnt lgkmcnt(1)
    v_cvt_pk_bf16_f32 v209, v252, v249
    v_lshrrev_b32 v252, 15, v255
    v_mfma_f32_16x16x32_bf16 v[60:63], a[204:207], v[232:235], v[60:63]
    buffer_load_dwordx2 v[200:201], v203, s[4:7], s20 offen offset:256
    v_mfma_f32_16x16x32_bf16 v[64:67], a[208:211], v[232:235], v[64:67]
    ds_write_b64 v252, v[206:207] offset:8576
    s_waitcnt vmcnt(14)
    v_mfma_f32_16x16x32_bf16 v[64:67], a[196:199], v[228:231], v[64:67]
    v_lshlrev_b32 v248, 16, v218
    v_lshlrev_b32 v249, 16, v220
    v_mfma_f32_16x16x32_bf16 v[68:71], a[200:203], v[228:231], v[68:71]
    ds_read_b128 v[228:231], v253 offset:5216
    v_mfma_f32_16x16x32_bf16 v[68:71], a[212:215], v[232:235], v[68:71]
    ds_write_b64 v252, v[212:213] offset:10656
    v_mfma_f32_16x16x32_bf16 v[48:51], a[216:219], v[232:235], v[48:51]
    buffer_load_dwordx2 v[202:203], v203, s[4:7], s21 offen offset:256
    v_mfma_f32_16x16x32_bf16 v[52:55], a[220:223], v[232:235], v[52:55]
    v_lshlrev_b32 v250, 16, v222
    v_lshlrev_b32 v251, 16, v224
    v_mfma_f32_16x16x32_bf16 v[56:59], a[224:227], v[232:235], v[56:59]
    ds_write_b64 v252, v[210:211] offset:12736
    v_mfma_f32_16x16x32_bf16 v[72:75], a[192:195], v[232:235], v[72:75]
    s_waitcnt lgkmcnt(4)
    v_and_b32 v218, s22, v218
    v_and_b32 v220, s22, v220
    v_mfma_f32_16x16x32_bf16 v[72:75], a[204:207], v[236:239], v[72:75]
    ds_write_b64 v252, v[204:205] offset:18976
    v_mfma_f32_16x16x32_bf16 v[76:79], a[208:211], v[236:239], v[76:79]
    v_and_b32 v222, s22, v222
    v_and_b32 v224, s22, v224
    v_mfma_f32_16x16x32_bf16 v[76:79], a[196:199], v[232:235], v[76:79]
    ds_write_b64 v252, v[214:215] offset:27296
    v_mfma_f32_16x16x32_bf16 v[80:83], a[200:203], v[232:235], v[80:83]
    ds_read_b128 v[232:235], v253 offset:4944
    v_mfma_f32_16x16x32_bf16 v[80:83], a[212:215], v[236:239], v[80:83]
    ds_write_b64 v252, v[208:209] offset:31456
    v_mfma_f32_16x16x32_bf16 v[60:63], a[216:219], v[236:239], v[60:63]
    v_mfma_f32_16x16x32_bf16 v[64:67], a[220:223], v[236:239], v[64:67]
    v_mfma_f32_16x16x32_bf16 v[68:71], a[224:227], v[236:239], v[68:71]
    s_mov_b32 s42, 442368
    v_mfma_f32_16x16x32_bf16 v[84:87], a[192:195], v[236:239], v[84:87]
    buffer_load_dwordx4 a[192:195], v254, s[8:11], s42 offen offset:0 sc1
    v_mfma_f32_16x16x32_bf16 v[88:91], a[196:199], v[236:239], v[88:91]
    v_lshlrev_b32 v252, 16, v216
    v_and_b32 v216, s22, v216
    v_mfma_f32_16x16x32_bf16 v[92:95], a[200:203], v[236:239], v[92:95]
    s_waitcnt lgkmcnt(6)
    v_fmac_f32 v252, s25, v251
    v_fmac_f32 v216, s25, v224
    v_mfma_f32_16x16x32_bf16 v[84:87], a[204:207], v[228:231], v[84:87]
    ds_read_b128 v[236:239], v253 offset:7280
    v_fmac_f32 v252, s28, v249
    v_mfma_f32_16x16x32_bf16 v[88:91], a[208:211], v[228:231], v[88:91]
    buffer_load_dwordx4 a[196:199], v254, s[8:11], s42 offen offset:1024 sc1
    v_mfma_f32_16x16x32_bf16 v[92:95], a[212:215], v[228:231], v[92:95]
    v_fmac_f32 v216, s28, v220
    v_cvt_pk_bf16_f32 v216, v252, v216
    v_mfma_f32_16x16x32_bf16 v[72:75], a[216:219], v[228:231], v[72:75]
    s_waitcnt lgkmcnt(2)
    v_lshlrev_b32 v252, 16, v226
    v_and_b32 v226, s22, v226
    v_mfma_f32_16x16x32_bf16 v[76:79], a[220:223], v[228:231], v[76:79]
    buffer_load_dwordx4 a[200:203], v254, s[8:11], s42 offen offset:2048 sc1
    v_mfma_f32_16x16x32_bf16 v[80:83], a[224:227], v[228:231], v[80:83]
    ds_read_b128 v[228:231], v253 offset:7008
    v_fmac_f32 v252, s29, v248
    v_mfma_f32_16x16x32_bf16 v[84:87], a[216:219], v[232:235], v[84:87]
    s_mov_b32 s42, 445440
    v_fmac_f32 v226, s29, v218
    v_fmac_f32 v252, s23, v250
    v_mfma_f32_16x16x32_bf16 v[88:91], a[220:223], v[232:235], v[88:91]
    buffer_load_dwordx4 a[204:207], v254, s[8:11], s42 offen offset:0 sc1
    v_mfma_f32_16x16x32_bf16 v[92:95], a[224:227], v[232:235], v[92:95]
    ds_read_b128 v[232:235], v253 offset:6752
    v_fmac_f32 v226, s23, v222
    s_waitcnt vmcnt(16)
    s_waitcnt lgkmcnt(2)
sub11:
    v_mfma_f32_16x16x32_bf16 v[96:99], a[228:231], v[236:239], v[96:99]
    v_cvt_pk_bf16_f32 v226, v252, v226
    v_fma_f32 v252, v249, s24, v251
    v_mfma_f32_16x16x32_bf16 v[100:103], a[232:235], v[236:239], v[100:103]
    s_waitcnt vmcnt(13) lgkmcnt(1)
    v_fmac_f32 v251, -4.0, v249
    v_fma_f32 v249, v248, s24, v250
    v_mfma_f32_16x16x32_bf16 v[104:107], a[236:239], v[236:239], v[104:107]
    ds_read_b128 v[236:239], v253 offset:6496
    v_fmac_f32 v250, -4.0, v248
    v_mfma_f32_16x16x32_bf16 v[96:99], a[240:243], v[228:231], v[96:99]
    buffer_load_dwordx4 a[208:211], v254, s[8:11], s42 offen offset:1024 sc1
    v_mfma_f32_16x16x32_bf16 v[100:103], a[244:247], v[228:231], v[100:103]
    v_fma_f32 v248, v250, s26, v251
    v_fmac_f32 v251, s27, v250
    v_mfma_f32_16x16x32_bf16 v[104:107], a[248:251], v[228:231], v[104:107]
    v_fma_f32 v250, v249, 2.0, v252
    v_fmac_f32 v252, -2.0, v249
    v_mfma_f32_16x16x32_bf16 v[108:111], a[228:231], v[228:231], v[108:111]
    s_waitcnt lgkmcnt(1)
    v_fma_f32 v249, v220, s24, v224
    v_fmac_f32 v224, -4.0, v220
    v_mfma_f32_16x16x32_bf16 v[108:111], a[240:243], v[232:235], v[108:111]
    buffer_load_dwordx4 a[212:215], v254, s[8:11], s42 offen offset:2048 sc1
    v_mfma_f32_16x16x32_bf16 v[112:115], a[244:247], v[232:235], v[112:115]
    v_fma_f32 v220, v218, s24, v222
    v_fmac_f32 v222, -4.0, v218
    v_mfma_f32_16x16x32_bf16 v[112:115], a[232:235], v[228:231], v[112:115]
    s_mov_b32 s42, 448512
    v_fma_f32 v218, v222, s26, v224
    v_fmac_f32 v224, s27, v222
    v_mfma_f32_16x16x32_bf16 v[116:119], a[236:239], v[228:231], v[116:119]
    ds_read_b128 v[228:231], v253 offset:6240
    v_fma_f32 v222, v220, 2.0, v249
    v_mfma_f32_16x16x32_bf16 v[116:119], a[248:251], v[232:235], v[116:119]
    buffer_load_dwordx4 a[216:219], v254, s[8:11], s42 offen offset:0 sc1
    s_waitcnt vmcnt(13)
    v_mfma_f32_16x16x32_bf16 v[96:99], a[252:255], v[232:235], v[96:99]
    v_fmac_f32 v249, -2.0, v220
    v_cvt_pk_bf16_f32 v218, v248, v218
    v_mfma_f32_16x16x32_bf16 v[100:103], v[240:243], v[232:235], v[100:103]
    v_cvt_pk_bf16_f32 v224, v251, v224
    v_cvt_pk_bf16_f32 v222, v250, v222
    v_mfma_f32_16x16x32_bf16 v[104:107], v[244:247], v[232:235], v[104:107]
    s_waitcnt lgkmcnt(1)
    v_cvt_pk_bf16_f32 v220, v252, v249
    v_lshlrev_b32 v248, 16, v219
    v_mfma_f32_16x16x32_bf16 v[120:123], a[228:231], v[232:235], v[120:123]
    buffer_load_dwordx4 a[220:223], v254, s[8:11], s42 offen offset:1024 sc1
    v_mfma_f32_16x16x32_bf16 v[120:123], a[240:243], v[236:239], v[120:123]
    v_lshlrev_b32 v249, 16, v221
    v_lshlrev_b32 v250, 16, v223
    v_mfma_f32_16x16x32_bf16 v[124:127], a[244:247], v[236:239], v[124:127]
    v_lshlrev_b32 v251, 16, v225
    v_and_b32 v219, s22, v219
    v_mfma_f32_16x16x32_bf16 v[124:127], a[232:235], v[232:235], v[124:127]
    buffer_load_dwordx4 a[224:227], v254, s[8:11], s42 offen offset:2048 sc1
    v_mfma_f32_16x16x32_bf16 v[128:131], a[236:239], v[232:235], v[128:131]
    ds_read_b128 v[232:235], v253 offset:8064
    v_and_b32 v215, 0x7fff, v255
    v_mfma_f32_16x16x32_bf16 v[128:131], a[248:251], v[236:239], v[128:131]
    v_and_b32 v221, s22, v221
    v_and_b32 v223, s22, v223
    v_mfma_f32_16x16x32_bf16 v[108:111], a[252:255], v[236:239], v[108:111]
    v_and_b32 v225, s22, v225
    v_lshlrev_b32 v252, 16, v217
    v_mfma_f32_16x16x32_bf16 v[112:115], v[240:243], v[236:239], v[112:115]
    buffer_load_dwordx2 v[204:205], v215, s[4:7], s16 offen offset:640
    v_mfma_f32_16x16x32_bf16 v[116:119], v[244:247], v[236:239], v[116:119]
    v_and_b32 v217, s22, v217
    v_fmac_f32 v252, s25, v251
    v_mfma_f32_16x16x32_bf16 v[132:135], a[228:231], v[236:239], v[132:135]
    s_waitcnt lgkmcnt(1)
    v_fmac_f32 v217, s25, v225
    v_fmac_f32 v252, s28, v249
    v_mfma_f32_16x16x32_bf16 v[132:135], a[240:243], v[228:231], v[132:135]
    v_fmac_f32 v217, s28, v221
    v_cvt_pk_bf16_f32 v217, v252, v217
    v_mfma_f32_16x16x32_bf16 v[136:139], a[244:247], v[228:231], v[136:139]
    v_lshlrev_b32 v252, 16, v227
    v_and_b32 v227, s22, v227
    v_mfma_f32_16x16x32_bf16 v[136:139], a[232:235], v[236:239], v[136:139]
    buffer_load_dwordx2 v[206:207], v215, s[4:7], s17 offen offset:640
    v_mfma_f32_16x16x32_bf16 v[140:143], a[236:239], v[236:239], v[140:143]
    ds_read_b128 v[236:239], v253 offset:7808
    v_fmac_f32 v252, s29, v248
    v_mfma_f32_16x16x32_bf16 v[140:143], a[248:251], v[228:231], v[140:143]
    v_fmac_f32 v227, s29, v219
    v_fmac_f32 v252, s23, v250
    v_mfma_f32_16x16x32_bf16 v[120:123], a[252:255], v[228:231], v[120:123]
    v_fmac_f32 v227, s23, v223
    v_cvt_pk_bf16_f32 v227, v252, v227
    v_mfma_f32_16x16x32_bf16 v[124:127], v[240:243], v[228:231], v[124:127]
    v_fma_f32 v252, v249, s24, v251
    v_fmac_f32 v251, -4.0, v249
    v_mfma_f32_16x16x32_bf16 v[128:131], v[244:247], v[228:231], v[128:131]
    buffer_load_dwordx2 v[208:209], v215, s[4:7], s18 offen offset:640
    v_mfma_f32_16x16x32_bf16 v[144:147], a[228:231], v[228:231], v[144:147]
pad4:
    s_cbranch_vccnz pad8
    s_waitcnt lgkmcnt(1)
    v_fma_f32 v249, v248, s24, v250
    v_fmac_f32 v250, -4.0, v248
    v_mfma_f32_16x16x32_bf16 v[144:147], a[240:243], v[232:235], v[144:147]
    v_fma_f32 v248, v250, s26, v251
    v_fmac_f32 v251, s27, v250
    v_mfma_f32_16x16x32_bf16 v[148:151], a[244:247], v[232:235], v[148:151]
    v_fma_f32 v250, v249, 2.0, v252
    v_fmac_f32 v252, -2.0, v249
    v_mfma_f32_16x16x32_bf16 v[148:151], a[232:235], v[228:231], v[148:151]
    v_fma_f32 v249, v221, s24, v225
    v_fmac_f32 v225, -4.0, v221
    v_mfma_f32_16x16x32_bf16 v[152:155], a[236:239], v[228:231], v[152:155]
    ds_read_b128 v[228:231], v253 offset:7552
    v_fma_f32 v221, v219, s24, v223
    v_mfma_f32_16x16x32_bf16 v[152:155], a[248:251], v[232:235], v[152:155]
    buffer_load_dwordx2 v[210:211], v215, s[4:7], s19 offen offset:640
    v_mfma_f32_16x16x32_bf16 v[132:135], a[252:255], v[232:235], v[132:135]
    v_fmac_f32 v223, -4.0, v219
    v_fma_f32 v219, v223, s26, v225
    v_mfma_f32_16x16x32_bf16 v[136:139], v[240:243], v[232:235], v[136:139]
    v_fmac_f32 v225, s27, v223
    v_fma_f32 v223, v221, 2.0, v249
    v_mfma_f32_16x16x32_bf16 v[140:143], v[244:247], v[232:235], v[140:143]
    v_fmac_f32 v249, -2.0, v221
    v_cvt_pk_bf16_f32 v219, v248, v219
    v_mfma_f32_16x16x32_bf16 v[156:159], a[228:231], v[232:235], v[156:159]
    s_waitcnt lgkmcnt(1)
    v_cvt_pk_bf16_f32 v225, v251, v225
    v_cvt_pk_bf16_f32 v223, v250, v223
    v_mfma_f32_16x16x32_bf16 v[156:159], a[240:243], v[236:239], v[156:159]
    buffer_load_dwordx2 v[212:213], v215, s[4:7], s20 offen offset:640
    v_mfma_f32_16x16x32_bf16 v[160:163], a[244:247], v[236:239], v[160:163]
    v_cvt_pk_bf16_f32 v221, v252, v249
    v_lshrrev_b32 v252, 15, v255
    v_mfma_f32_16x16x32_bf16 v[160:163], a[232:235], v[232:235], v[160:163]
    ds_write_b64 v252, v[218:219] offset:8320
    v_mfma_f32_16x16x32_bf16 v[164:167], a[236:239], v[232:235], v[164:167]
    ds_read_b128 v[232:235], v253 offset:7296
    s_waitcnt vmcnt(14)
    v_mfma_f32_16x16x32_bf16 v[164:167], a[248:251], v[236:239], v[164:167]
    v_lshlrev_b32 v248, 16, v194
    v_lshlrev_b32 v249, 16, v196
    v_mfma_f32_16x16x32_bf16 v[144:147], a[252:255], v[236:239], v[144:147]
    buffer_load_dwordx2 v[214:215], v215, s[4:7], s21 offen offset:640
    v_mfma_f32_16x16x32_bf16 v[148:151], v[240:243], v[236:239], v[148:151]
    ds_write_b64 v252, v[224:225] offset:10400
    v_mfma_f32_16x16x32_bf16 v[152:155], v[244:247], v[236:239], v[152:155]
    s_waitcnt lgkmcnt(3)
    v_lshlrev_b32 v250, 16, v198
    v_lshlrev_b32 v251, 16, v200
    v_mfma_f32_16x16x32_bf16 v[168:171], a[228:231], v[236:239], v[168:171]
    ds_write_b64 v252, v[222:223] offset:12480
    v_mfma_f32_16x16x32_bf16 v[168:171], a[240:243], v[228:231], v[168:171]
    v_and_b32 v194, s22, v194
    v_and_b32 v196, s22, v196
    v_mfma_f32_16x16x32_bf16 v[172:175], a[244:247], v[228:231], v[172:175]
    ds_write_b64 v252, v[216:217] offset:18720
    v_mfma_f32_16x16x32_bf16 v[172:175], a[232:235], v[236:239], v[172:175]
    v_and_b32 v198, s22, v198
    v_and_b32 v200, s22, v200
    v_mfma_f32_16x16x32_bf16 v[176:179], a[236:239], v[236:239], v[176:179]
    ds_read_b128 v[236:239], v253 offset:7024
    v_mfma_f32_16x16x32_bf16 v[176:179], a[248:251], v[228:231], v[176:179]
    ds_write_b64 v252, v[226:227] offset:27040
    v_mfma_f32_16x16x32_bf16 v[156:159], a[252:255], v[228:231], v[156:159]
    s_waitcnt lgkmcnt(5)
    v_mfma_f32_16x16x32_bf16 v[160:163], v[240:243], v[228:231], v[160:163]
    ds_write_b64 v252, v[220:221] offset:31200
    v_mfma_f32_16x16x32_bf16 v[164:167], v[244:247], v[228:231], v[164:167]
    s_mov_b32 s42, 479232
    v_mfma_f32_16x16x32_bf16 v[180:183], a[228:231], v[228:231], v[180:183]
    buffer_load_dwordx4 a[228:231], v254, s[8:11], s42 offen offset:0 sc1
    v_mfma_f32_16x16x32_bf16 v[184:187], a[232:235], v[228:231], v[184:187]
    s_waitcnt lgkmcnt(0)
    v_lshlrev_b32 v252, 16, v192
    v_and_b32 v192, s22, v192
    v_mfma_f32_16x16x32_bf16 v[188:191], a[236:239], v[228:231], v[188:191]
    s_barrier
    v_mfma_f32_16x16x32_bf16 v[180:183], a[240:243], v[232:235], v[180:183]
    ds_read_b128 v[228:231], v253 offset:9360
    v_fmac_f32 v252, s25, v251
    v_mfma_f32_16x16x32_bf16 v[184:187], a[244:247], v[232:235], v[184:187]
    buffer_load_dwordx4 a[232:235], v254, s[8:11], s42 offen offset:1024 sc1
    v_mfma_f32_16x16x32_bf16 v[188:191], a[248:251], v[232:235], v[188:191]
    v_fmac_f32 v192, s25, v200
    v_fmac_f32 v252, s28, v249
    v_mfma_f32_16x16x32_bf16 v[168:171], a[252:255], v[232:235], v[168:171]
    v_fmac_f32 v192, s28, v196
    v_cvt_pk_bf16_f32 v192, v252, v192
    v_mfma_f32_16x16x32_bf16 v[172:175], v[240:243], v[232:235], v[172:175]
    buffer_load_dwordx4 a[236:239], v254, s[8:11], s42 offen offset:2048 sc1
    v_lshlrev_b32 v252, 16, v202
    v_mfma_f32_16x16x32_bf16 v[176:179], v[244:247], v[232:235], v[176:179]
    ds_read_b128 v[232:235], v253 offset:9088
    v_and_b32 v202, s22, v202
    v_mfma_f32_16x16x32_bf16 v[180:183], a[252:255], v[236:239], v[180:183]
    s_mov_b32 s42, 482304
    v_fmac_f32 v252, s29, v248
    v_fmac_f32 v202, s29, v194
    v_mfma_f32_16x16x32_bf16 v[184:187], v[240:243], v[236:239], v[184:187]
    buffer_load_dwordx4 a[240:243], v254, s[8:11], s42 offen offset:0 sc1
    v_mfma_f32_16x16x32_bf16 v[188:191], v[244:247], v[236:239], v[188:191]
    ds_read_b128 v[236:239], v253 offset:8832
    v_fmac_f32 v252, s23, v250
    s_waitcnt vmcnt(16)
    s_waitcnt lgkmcnt(2)
sub12:
    v_mfma_f32_16x16x32_bf16 a[0:3], a[192:195], v[228:231], a[0:3]
    v_fmac_f32 v202, s23, v198
    v_cvt_pk_bf16_f32 v202, v252, v202
    v_mfma_f32_16x16x32_bf16 a[4:7], a[196:199], v[228:231], a[4:7]
    s_waitcnt vmcnt(13) lgkmcnt(1)
    v_fma_f32 v252, v249, s24, v251
    v_fmac_f32 v251, -4.0, v249
    v_mfma_f32_16x16x32_bf16 a[8:11], a[200:203], v[228:231], a[8:11]
    ds_read_b128 v[228:231], v253 offset:8576
    v_fma_f32 v249, v248, s24, v250
    v_mfma_f32_16x16x32_bf16 a[0:3], a[204:207], v[232:235], a[0:3]
    buffer_load_dwordx4 a[244:247], v254, s[8:11], s42 offen offset:1024 sc1
    v_mfma_f32_16x16x32_bf16 a[4:7], a[208:211], v[232:235], a[4:7]
    v_fmac_f32 v250, -4.0, v248
    v_fma_f32 v248, v250, s26, v251
    v_mfma_f32_16x16x32_bf16 a[8:11], a[212:215], v[232:235], a[8:11]
    v_fmac_f32 v251, s27, v250
    v_fma_f32 v250, v249, 2.0, v252
    v_mfma_f32_16x16x32_bf16 a[12:15], a[192:195], v[232:235], a[12:15]
    s_waitcnt lgkmcnt(1)
    v_fmac_f32 v252, -2.0, v249
    v_fma_f32 v249, v196, s24, v200
    v_mfma_f32_16x16x32_bf16 a[12:15], a[204:207], v[236:239], a[12:15]
    buffer_load_dwordx4 a[248:251], v254, s[8:11], s42 offen offset:2048 sc1
    v_mfma_f32_16x16x32_bf16 a[16:19], a[208:211], v[236:239], a[16:19]
    v_fmac_f32 v200, -4.0, v196
    v_fma_f32 v196, v194, s24, v198
    v_mfma_f32_16x16x32_bf16 a[16:19], a[196:199], v[232:235], a[16:19]
    s_mov_b32 s42, 485376
    v_fmac_f32 v198, -4.0, v194
    v_fma_f32 v194, v198, s26, v200
    v_mfma_f32_16x16x32_bf16 a[20:23], a[200:203], v[232:235], a[20:23]
    ds_read_b128 v[232:235], v253 offset:8320
    v_fmac_f32 v200, s27, v198
    v_mfma_f32_16x16x32_bf16 a[20:23], a[212:215], v[236:239], a[20:23]
    buffer_load_dwordx4 a[252:255], v254, s[8:11], s42 offen offset:0 sc1
    s_waitcnt vmcnt(13)
    v_mfma_f32_16x16x32_bf16 a[0:3], a[216:219], v[236:239], a[0:3]
    v_fma_f32 v198, v196, 2.0, v249
    v_fmac_f32 v249, -2.0, v196
    v_mfma_f32_16x16x32_bf16 a[4:7], a[220:223], v[236:239], a[4:7]
    v_cvt_pk_bf16_f32 v194, v248, v194
    v_cvt_pk_bf16_f32 v200, v251, v200
    v_mfma_f32_16x16x32_bf16 a[8:11], a[224:227], v[236:239], a[8:11]
    s_waitcnt lgkmcnt(1)
    v_cvt_pk_bf16_f32 v198, v250, v198
    v_cvt_pk_bf16_f32 v196, v252, v249
    v_mfma_f32_16x16x32_bf16 a[24:27], a[192:195], v[236:239], a[24:27]
    buffer_load_dwordx4 v[240:243], v254, s[8:11], s42 offen offset:1024 sc1
    v_lshlrev_b32 v248, 16, v195
    v_mfma_f32_16x16x32_bf16 a[24:27], a[204:207], v[228:231], a[24:27]
    v_lshlrev_b32 v249, 16, v197
    v_lshlrev_b32 v250, 16, v199
    v_mfma_f32_16x16x32_bf16 a[28:31], a[208:211], v[228:231], a[28:31]
    v_lshlrev_b32 v251, 16, v201
    v_and_b32 v195, s22, v195
    v_mfma_f32_16x16x32_bf16 a[28:31], a[196:199], v[236:239], a[28:31]
    buffer_load_dwordx4 v[244:247], v254, s[8:11], s42 offen offset:2048 sc1
    v_mfma_f32_16x16x32_bf16 a[32:35], a[200:203], v[236:239], a[32:35]
    ds_read_b128 v[236:239], v253 offset:10144
    v_and_b32 v227, 0x7fff, v255
    v_mfma_f32_16x16x32_bf16 a[32:35], a[212:215], v[228:231], a[32:35]
    v_and_b32 v197, s22, v197
    v_and_b32 v199, s22, v199
    v_mfma_f32_16x16x32_bf16 a[12:15], a[216:219], v[228:231], a[12:15]
    v_and_b32 v201, s22, v201
    v_lshlrev_b32 v252, 16, v193
    v_mfma_f32_16x16x32_bf16 a[16:19], a[220:223], v[228:231], a[16:19]
    buffer_load_dwordx2 v[216:217], v227, s[4:7], s16 offen offset:1024
    v_mfma_f32_16x16x32_bf16 a[20:23], a[224:227], v[228:231], a[20:23]
    v_and_b32 v193, s22, v193
    v_fmac_f32 v252, s25, v251
    v_mfma_f32_16x16x32_bf16 a[36:39], a[192:195], v[228:231], a[36:39]
    s_waitcnt lgkmcnt(1)
    v_fmac_f32 v193, s25, v201
    v_fmac_f32 v252, s28, v249
    v_mfma_f32_16x16x32_bf16 a[36:39], a[204:207], v[232:235], a[36:39]
    v_fmac_f32 v193, s28, v197
    v_cvt_pk_bf16_f32 v193, v252, v193
    v_mfma_f32_16x16x32_bf16 a[40:43], a[208:211], v[232:235], a[40:43]
    v_lshlrev_b32 v252, 16, v203
    v_and_b32 v203, s22, v203
    v_mfma_f32_16x16x32_bf16 a[40:43], a[196:199], v[228:231], a[40:43]
    buffer_load_dwordx2 v[218:219], v227, s[4:7], s17 offen offset:1024
    v_mfma_f32_16x16x32_bf16 a[44:47], a[200:203], v[228:231], a[44:47]
    ds_read_b128 v[228:231], v253 offset:9888
    v_fmac_f32 v252, s29, v248
    v_mfma_f32_16x16x32_bf16 a[44:47], a[212:215], v[232:235], a[44:47]
    v_fmac_f32 v203, s29, v195
    v_fmac_f32 v252, s23, v250
    v_mfma_f32_16x16x32_bf16 a[24:27], a[216:219], v[232:235], a[24:27]
    v_fmac_f32 v203, s23, v199
    v_cvt_pk_bf16_f32 v203, v252, v203
    v_mfma_f32_16x16x32_bf16 a[28:31], a[220:223], v[232:235], a[28:31]
    v_fma_f32 v252, v249, s24, v251
    v_fmac_f32 v251, -4.0, v249
    v_mfma_f32_16x16x32_bf16 a[32:35], a[224:227], v[232:235], a[32:35]
    buffer_load_dwordx2 v[220:221], v227, s[4:7], s18 offen offset:1024
    v_mfma_f32_16x16x32_bf16 a[48:51], a[192:195], v[232:235], a[48:51]
    s_waitcnt lgkmcnt(1)
    v_fma_f32 v249, v248, s24, v250
    v_fmac_f32 v250, -4.0, v248
    v_mfma_f32_16x16x32_bf16 a[48:51], a[204:207], v[236:239], a[48:51]
    v_fma_f32 v248, v250, s26, v251
    v_fmac_f32 v251, s27, v250
    v_mfma_f32_16x16x32_bf16 a[52:55], a[208:211], v[236:239], a[52:55]
    v_fma_f32 v250, v249, 2.0, v252
    v_fmac_f32 v252, -2.0, v249
    v_fma_f32 v249, v197, s24, v201
    v_mfma_f32_16x16x32_bf16 a[52:55], a[196:199], v[232:235], a[52:55]
    v_fmac_f32 v201, -4.0, v197
    v_fma_f32 v197, v195, s24, v199
    v_mfma_f32_16x16x32_bf16 a[56:59], a[200:203], v[232:235], a[56:59]
    ds_read_b128 v[232:235], v253 offset:9632
    v_fmac_f32 v199, -4.0, v195
    v_mfma_f32_16x16x32_bf16 a[56:59], a[212:215], v[236:239], a[56:59]
    buffer_load_dwordx2 v[222:223], v227, s[4:7], s19 offen offset:1024
    v_mfma_f32_16x16x32_bf16 a[36:39], a[216:219], v[236:239], a[36:39]
    v_fma_f32 v195, v199, s26, v201
    v_fmac_f32 v201, s27, v199
    v_mfma_f32_16x16x32_bf16 a[40:43], a[220:223], v[236:239], a[40:43]
    v_fma_f32 v199, v197, 2.0, v249
    v_fmac_f32 v249, -2.0, v197
    v_mfma_f32_16x16x32_bf16 a[44:47], a[224:227], v[236:239], a[44:47]
    v_cvt_pk_bf16_f32 v195, v248, v195
    v_cvt_pk_bf16_f32 v201, v251, v201
    v_mfma_f32_16x16x32_bf16 a[60:63], a[192:195], v[236:239], a[60:63]
    s_waitcnt lgkmcnt(1)
    v_cvt_pk_bf16_f32 v199, v250, v199
    v_cvt_pk_bf16_f32 v197, v252, v249
    v_mfma_f32_16x16x32_bf16 a[60:63], a[204:207], v[228:231], a[60:63]
    buffer_load_dwordx2 v[224:225], v227, s[4:7], s20 offen offset:1024
    v_mfma_f32_16x16x32_bf16 a[64:67], a[208:211], v[228:231], a[64:67]
    v_lshrrev_b32 v252, 15, v255
    v_mfma_f32_16x16x32_bf16 a[64:67], a[196:199], v[236:239], a[64:67]
    ds_write_b64 v252, v[194:195] offset:768
    v_mfma_f32_16x16x32_bf16 a[68:71], a[200:203], v[236:239], a[68:71]
    ds_read_b128 v[236:239], v253 offset:9376
    s_waitcnt vmcnt(14)
    v_mfma_f32_16x16x32_bf16 a[68:71], a[212:215], v[228:231], a[68:71]
    v_lshlrev_b32 v248, 16, v206
    v_lshlrev_b32 v249, 16, v208
    v_mfma_f32_16x16x32_bf16 a[48:51], a[216:219], v[228:231], a[48:51]
    buffer_load_dwordx2 v[226:227], v227, s[4:7], s21 offen offset:1024
    v_mfma_f32_16x16x32_bf16 a[52:55], a[220:223], v[228:231], a[52:55]
    ds_write_b64 v252, v[200:201] offset:2848
    v_mfma_f32_16x16x32_bf16 a[56:59], a[224:227], v[228:231], a[56:59]
    s_waitcnt lgkmcnt(3)
    v_lshlrev_b32 v250, 16, v210
    v_lshlrev_b32 v251, 16, v212
    v_mfma_f32_16x16x32_bf16 a[72:75], a[192:195], v[228:231], a[72:75]
    ds_write_b64 v252, v[198:199] offset:4928
    v_mfma_f32_16x16x32_bf16 a[72:75], a[204:207], v[232:235], a[72:75]
    v_and_b32 v206, s22, v206
    v_and_b32 v208, s22, v208
    v_mfma_f32_16x16x32_bf16 a[76:79], a[208:211], v[232:235], a[76:79]
    ds_write_b64 v252, v[192:193] offset:21568
    v_mfma_f32_16x16x32_bf16 a[76:79], a[196:199], v[228:231], a[76:79]
    v_and_b32 v210, s22, v210
    v_and_b32 v212, s22, v212
    v_mfma_f32_16x16x32_bf16 a[80:83], a[200:203], v[228:231], a[80:83]
    ds_read_b128 v[228:231], v253 offset:9104
    v_mfma_f32_16x16x32_bf16 a[80:83], a[212:215], v[232:235], a[80:83]
    ds_write_b64 v252, v[202:203] offset:29888
    v_mfma_f32_16x16x32_bf16 a[60:63], a[216:219], v[232:235], a[60:63]
    v_mfma_f32_16x16x32_bf16 a[64:67], a[220:223], v[232:235], a[64:67]
    ds_write_b64 v252, v[196:197] offset:7008
    v_mfma_f32_16x16x32_bf16 a[68:71], a[224:227], v[232:235], a[68:71]
    s_mov_b32 s42, 516096
    v_mfma_f32_16x16x32_bf16 a[84:87], a[192:195], v[232:235], a[84:87]
    buffer_load_dwordx4 a[192:195], v254, s[8:11], s42 offen offset:0 sc1
    v_mfma_f32_16x16x32_bf16 a[88:91], a[196:199], v[232:235], a[88:91]
    v_lshlrev_b32 v252, 16, v204
    v_and_b32 v204, s22, v204
    v_mfma_f32_16x16x32_bf16 a[92:95], a[200:203], v[232:235], a[92:95]
    s_waitcnt lgkmcnt(6)
    v_fmac_f32 v252, s25, v251
    v_fmac_f32 v204, s25, v212
    v_mfma_f32_16x16x32_bf16 a[84:87], a[204:207], v[236:239], a[84:87]
    ds_read_b128 v[232:235], v253 offset:11440
    v_fmac_f32 v252, s28, v249
    v_mfma_f32_16x16x32_bf16 a[88:91], a[208:211], v[236:239], a[88:91]
    buffer_load_dwordx4 a[196:199], v254, s[8:11], s42 offen offset:1024 sc1
    v_mfma_f32_16x16x32_bf16 a[92:95], a[212:215], v[236:239], a[92:95]
    v_fmac_f32 v204, s28, v208
    v_cvt_pk_bf16_f32 v204, v252, v204
    v_mfma_f32_16x16x32_bf16 a[72:75], a[216:219], v[236:239], a[72:75]
    s_waitcnt lgkmcnt(3)
    v_lshlrev_b32 v252, 16, v214
    v_and_b32 v214, s22, v214
    v_mfma_f32_16x16x32_bf16 a[76:79], a[220:223], v[236:239], a[76:79]
    buffer_load_dwordx4 a[200:203], v254, s[8:11], s42 offen offset:2048 sc1
    v_mfma_f32_16x16x32_bf16 a[80:83], a[224:227], v[236:239], a[80:83]
    ds_read_b128 v[236:239], v253 offset:11168
    v_fmac_f32 v252, s29, v248
    v_mfma_f32_16x16x32_bf16 a[84:87], a[216:219], v[228:231], a[84:87]
    s_mov_b32 s42, 519168
    v_fmac_f32 v214, s29, v206
    v_fmac_f32 v252, s23, v250
    v_mfma_f32_16x16x32_bf16 a[88:91], a[220:223], v[228:231], a[88:91]
    buffer_load_dwordx4 a[204:207], v254, s[8:11], s42 offen offset:0 sc1
    v_mfma_f32_16x16x32_bf16 a[92:95], a[224:227], v[228:231], a[92:95]
    ds_read_b128 v[228:231], v253 offset:10912
    v_fmac_f32 v214, s23, v210
    s_waitcnt vmcnt(16)
    s_waitcnt lgkmcnt(2)
sub13:
    v_mfma_f32_16x16x32_bf16 a[96:99], a[228:231], v[232:235], a[96:99]
    v_cvt_pk_bf16_f32 v214, v252, v214
    v_fma_f32 v252, v249, s24, v251
    v_mfma_f32_16x16x32_bf16 a[100:103], a[232:235], v[232:235], a[100:103]
    s_waitcnt vmcnt(13) lgkmcnt(1)
    v_fmac_f32 v251, -4.0, v249
    v_fma_f32 v249, v248, s24, v250
    v_mfma_f32_16x16x32_bf16 a[104:107], a[236:239], v[232:235], a[104:107]
    ds_read_b128 v[232:235], v253 offset:10656
    v_fmac_f32 v250, -4.0, v248
    v_mfma_f32_16x16x32_bf16 a[96:99], a[240:243], v[236:239], a[96:99]
    buffer_load_dwordx4 a[208:211], v254, s[8:11], s42 offen offset:1024 sc1
    v_mfma_f32_16x16x32_bf16 a[100:103], a[244:247], v[236:239], a[100:103]
    v_fma_f32 v248, v250, s26, v251
    v_fmac_f32 v251, s27, v250
    v_mfma_f32_16x16x32_bf16 a[104:107], a[248:251], v[236:239], a[104:107]
    v_fma_f32 v250, v249, 2.0, v252
    v_fmac_f32 v252, -2.0, v249
    v_mfma_f32_16x16x32_bf16 a[108:111], a[228:231], v[236:239], a[108:111]
    s_waitcnt lgkmcnt(1)
    v_fma_f32 v249, v208, s24, v212
    v_fmac_f32 v212, -4.0, v208
    v_mfma_f32_16x16x32_bf16 a[108:111], a[240:243], v[228:231], a[108:111]
    buffer_load_dwordx4 a[212:215], v254, s[8:11], s42 offen offset:2048 sc1
    v_mfma_f32_16x16x32_bf16 a[112:115], a[244:247], v[228:231], a[112:115]
    v_fma_f32 v208, v206, s24, v210
    v_fmac_f32 v210, -4.0, v206
    v_mfma_f32_16x16x32_bf16 a[112:115], a[232:235], v[236:239], a[112:115]
    s_mov_b32 s42, 522240
    v_fma_f32 v206, v210, s26, v212
    v_fmac_f32 v212, s27, v210
    v_mfma_f32_16x16x32_bf16 a[116:119], a[236:239], v[236:239], a[116:119]
    ds_read_b128 v[236:239], v253 offset:10400
    v_fma_f32 v210, v208, 2.0, v249
    v_mfma_f32_16x16x32_bf16 a[116:119], a[248:251], v[228:231], a[116:119]
    buffer_load_dwordx4 a[216:219], v254, s[8:11], s42 offen offset:0 sc1
    s_waitcnt vmcnt(13)
    v_mfma_f32_16x16x32_bf16 a[96:99], a[252:255], v[228:231], a[96:99]
    v_fmac_f32 v249, -2.0, v208
    v_cvt_pk_bf16_f32 v206, v248, v206
    v_mfma_f32_16x16x32_bf16 a[100:103], v[240:243], v[228:231], a[100:103]
    v_cvt_pk_bf16_f32 v212, v251, v212
    v_cvt_pk_bf16_f32 v210, v250, v210
    v_mfma_f32_16x16x32_bf16 a[104:107], v[244:247], v[228:231], a[104:107]
    s_waitcnt lgkmcnt(1)
    v_cvt_pk_bf16_f32 v208, v252, v249
    v_lshlrev_b32 v248, 16, v207
    v_mfma_f32_16x16x32_bf16 a[120:123], a[228:231], v[228:231], a[120:123]
    buffer_load_dwordx4 a[220:223], v254, s[8:11], s42 offen offset:1024 sc1
    v_mfma_f32_16x16x32_bf16 a[120:123], a[240:243], v[232:235], a[120:123]
    v_lshlrev_b32 v249, 16, v209
    v_lshlrev_b32 v250, 16, v211
    v_mfma_f32_16x16x32_bf16 a[124:127], a[244:247], v[232:235], a[124:127]
    v_lshlrev_b32 v251, 16, v213
    v_and_b32 v207, s22, v207
    v_mfma_f32_16x16x32_bf16 a[124:127], a[232:235], v[228:231], a[124:127]
    buffer_load_dwordx4 a[224:227], v254, s[8:11], s42 offen offset:2048 sc1
    v_mfma_f32_16x16x32_bf16 a[128:131], a[236:239], v[228:231], a[128:131]
    ds_read_b128 v[228:231], v253 offset:12224
    v_and_b32 v203, 0x7fff, v255
    v_mfma_f32_16x16x32_bf16 a[128:131], a[248:251], v[232:235], a[128:131]
    v_and_b32 v209, s22, v209
    v_and_b32 v211, s22, v211
    v_mfma_f32_16x16x32_bf16 a[108:111], a[252:255], v[232:235], a[108:111]
    v_and_b32 v213, s22, v213
    v_lshlrev_b32 v252, 16, v205
    v_mfma_f32_16x16x32_bf16 a[112:115], v[240:243], v[232:235], a[112:115]
    buffer_load_dwordx2 v[192:193], v203, s[4:7], s16 offen offset:1408
    v_mfma_f32_16x16x32_bf16 a[116:119], v[244:247], v[232:235], a[116:119]
    v_and_b32 v205, s22, v205
    v_fmac_f32 v252, s25, v251
    v_mfma_f32_16x16x32_bf16 a[132:135], a[228:231], v[232:235], a[132:135]
    s_waitcnt lgkmcnt(1)
    v_fmac_f32 v205, s25, v213
    v_fmac_f32 v252, s28, v249
    v_mfma_f32_16x16x32_bf16 a[132:135], a[240:243], v[236:239], a[132:135]
    v_fmac_f32 v205, s28, v209
    v_cvt_pk_bf16_f32 v205, v252, v205
    v_mfma_f32_16x16x32_bf16 a[136:139], a[244:247], v[236:239], a[136:139]
    v_lshlrev_b32 v252, 16, v215
    v_and_b32 v215, s22, v215
    v_mfma_f32_16x16x32_bf16 a[136:139], a[232:235], v[232:235], a[136:139]
    buffer_load_dwordx2 v[194:195], v203, s[4:7], s17 offen offset:1408
    v_mfma_f32_16x16x32_bf16 a[140:143], a[236:239], v[232:235], a[140:143]
    ds_read_b128 v[232:235], v253 offset:11968
    v_fmac_f32 v252, s29, v248
    v_mfma_f32_16x16x32_bf16 a[140:143], a[248:251], v[236:239], a[140:143]
    v_fmac_f32 v215, s29, v207
    v_fmac_f32 v252, s23, v250
    v_mfma_f32_16x16x32_bf16 a[120:123], a[252:255], v[236:239], a[120:123]
    v_fmac_f32 v215, s23, v211
    v_cvt_pk_bf16_f32 v215, v252, v215
    v_mfma_f32_16x16x32_bf16 a[124:127], v[240:243], v[236:239], a[124:127]
    v_fma_f32 v252, v249, s24, v251
    v_fmac_f32 v251, -4.0, v249
    v_mfma_f32_16x16x32_bf16 a[128:131], v[244:247], v[236:239], a[128:131]
    buffer_load_dwordx2 v[196:197], v203, s[4:7], s18 offen offset:1408
    v_mfma_f32_16x16x32_bf16 a[144:147], a[228:231], v[236:239], a[144:147]
    s_waitcnt lgkmcnt(1)
    v_fma_f32 v249, v248, s24, v250
    v_fmac_f32 v250, -4.0, v248
    v_mfma_f32_16x16x32_bf16 a[144:147], a[240:243], v[228:231], a[144:147]
    v_fma_f32 v248, v250, s26, v251
    v_fmac_f32 v251, s27, v250
    v_mfma_f32_16x16x32_bf16 a[148:151], a[244:247], v[228:231], a[148:151]
    v_fma_f32 v250, v249, 2.0, v252
    v_fmac_f32 v252, -2.0, v249
    v_mfma_f32_16x16x32_bf16 a[148:151], a[232:235], v[236:239], a[148:151]
    v_fma_f32 v249, v209, s24, v213
    v_fmac_f32 v213, -4.0, v209
    v_mfma_f32_16x16x32_bf16 a[152:155], a[236:239], v[236:239], a[152:155]
    ds_read_b128 v[236:239], v253 offset:11712
    v_fma_f32 v209, v207, s24, v211
    v_mfma_f32_16x16x32_bf16 a[152:155], a[248:251], v[228:231], a[152:155]
    buffer_load_dwordx2 v[198:199], v203, s[4:7], s19 offen offset:1408
    v_mfma_f32_16x16x32_bf16 a[132:135], a[252:255], v[228:231], a[132:135]
    v_fmac_f32 v211, -4.0, v207
    v_fma_f32 v207, v211, s26, v213
    v_mfma_f32_16x16x32_bf16 a[136:139], v[240:243], v[228:231], a[136:139]
    v_fmac_f32 v213, s27, v211
    v_fma_f32 v211, v209, 2.0, v249
    v_mfma_f32_16x16x32_bf16 a[140:143], v[244:247], v[228:231], a[140:143]
    v_fmac_f32 v249, -2.0, v209
    v_cvt_pk_bf16_f32 v207, v248, v207
    v_mfma_f32_16x16x32_bf16 a[156:159], a[228:231], v[228:231], a[156:159]
    s_waitcnt lgkmcnt(1)
    v_cvt_pk_bf16_f32 v213, v251, v213
    v_cvt_pk_bf16_f32 v211, v250, v211
    v_mfma_f32_16x16x32_bf16 a[156:159], a[240:243], v[232:235], a[156:159]
    buffer_load_dwordx2 v[200:201], v203, s[4:7], s20 offen offset:1408
    v_mfma_f32_16x16x32_bf16 a[160:163], a[244:247], v[232:235], a[160:163]
    v_cvt_pk_bf16_f32 v209, v252, v249
    v_lshrrev_b32 v252, 15, v255
    v_mfma_f32_16x16x32_bf16 a[160:163], a[232:235], v[228:231], a[160:163]
    ds_write_b64 v252, v[206:207] offset:512
    v_mfma_f32_16x16x32_bf16 a[164:167], a[236:239], v[228:231], a[164:167]
    ds_read_b128 v[228:231], v253 offset:11456
    s_waitcnt vmcnt(14)
    v_mfma_f32_16x16x32_bf16 a[164:167], a[248:251], v[232:235], a[164:167]
    v_lshlrev_b32 v248, 16, v218
    v_lshlrev_b32 v249, 16, v220
    v_mfma_f32_16x16x32_bf16 a[144:147], a[252:255], v[232:235], a[144:147]
    buffer_load_dwordx2 v[202:203], v203, s[4:7], s21 offen offset:1408
    v_mfma_f32_16x16x32_bf16 a[148:151], v[240:243], v[232:235], a[148:151]
    ds_write_b64 v252, v[212:213] offset:2592
    v_mfma_f32_16x16x32_bf16 a[152:155], v[244:247], v[232:235], a[152:155]
    s_waitcnt lgkmcnt(3)
    v_lshlrev_b32 v250, 16, v222
    v_lshlrev_b32 v251, 16, v224
    v_mfma_f32_16x16x32_bf16 a[168:171], a[228:231], v[232:235], a[168:171]
    ds_write_b64 v252, v[210:211] offset:4672
    v_mfma_f32_16x16x32_bf16 a[168:171], a[240:243], v[236:239], a[168:171]
    v_and_b32 v218, s22, v218
    v_and_b32 v220, s22, v220
    v_mfma_f32_16x16x32_bf16 a[172:175], a[244:247], v[236:239], a[172:175]
    ds_write_b64 v252, v[204:205] offset:21312
    v_mfma_f32_16x16x32_bf16 a[172:175], a[232:235], v[232:235], a[172:175]
    v_and_b32 v222, s22, v222
    v_and_b32 v224, s22, v224
    v_mfma_f32_16x16x32_bf16 a[176:179], a[236:239], v[232:235], a[176:179]
    ds_read_b128 v[232:235], v253 offset:11184
    v_mfma_f32_16x16x32_bf16 a[176:179], a[248:251], v[236:239], a[176:179]
    ds_write_b64 v252, v[214:215] offset:29632
    v_mfma_f32_16x16x32_bf16 a[156:159], a[252:255], v[236:239], a[156:159]
    v_mfma_f32_16x16x32_bf16 a[160:163], v[240:243], v[236:239], a[160:163]
    ds_write_b64 v252, v[208:209] offset:6752
    v_mfma_f32_16x16x32_bf16 a[164:167], v[244:247], v[236:239], a[164:167]
    s_mov_b32 s42, 552960
    v_mfma_f32_16x16x32_bf16 a[180:183], a[228:231], v[236:239], a[180:183]
    buffer_load_dwordx4 a[228:231], v254, s[8:11], s42 offen offset:0 sc1
    v_mfma_f32_16x16x32_bf16 a[184:187], a[232:235], v[236:239], a[184:187]
    v_lshlrev_b32 v252, 16, v216
    v_and_b32 v216, s22, v216
    v_mfma_f32_16x16x32_bf16 a[188:191], a[236:239], v[236:239], a[188:191]
    s_waitcnt lgkmcnt(2)
    v_fmac_f32 v252, s25, v251
    v_fmac_f32 v216, s25, v224
    v_mfma_f32_16x16x32_bf16 a[180:183], a[240:243], v[228:231], a[180:183]
    ds_read_b128 v[236:239], v253 offset:13520
    v_fmac_f32 v252, s28, v249
    v_fmac_f32 v216, s28, v220
    v_mfma_f32_16x16x32_bf16 a[184:187], a[244:247], v[228:231], a[184:187]
    buffer_load_dwordx4 a[232:235], v254, s[8:11], s42 offen offset:1024 sc1
    v_mfma_f32_16x16x32_bf16 a[188:191], a[248:251], v[228:231], a[188:191]
    ds_read_b128 v[204:207], v253 offset:40288
    v_cvt_pk_bf16_f32 v216, v252, v216
    v_mfma_f32_16x16x32_bf16 a[168:171], a[252:255], v[228:231], a[168:171]
    s_mov_b32 s45, 472974346
    v_lshlrev_b32 v252, 16, v226
    v_and_b32 v226, s22, v226
    v_mfma_f32_16x16x32_bf16 a[172:175], v[240:243], v[228:231], a[172:175]
    buffer_load_dwordx4 a[236:239], v254, s[8:11], s42 offen offset:2048 sc1
    v_mfma_f32_16x16x32_bf16 a[176:179], v[244:247], v[228:231], a[176:179]
    ds_read_b128 v[228:231], v253 offset:13248
    v_fmac_f32 v252, s29, v248
    v_fmac_f32 v226, s29, v218
    v_mfma_f32_16x16x32_bf16 a[180:183], a[252:255], v[232:235], a[180:183]
    s_mov_b32 s42, 556032
    v_bfe_u32 v208, v254, 5, 3
    v_fmac_f32 v252, s23, v250
    v_mfma_f32_16x16x32_bf16 a[184:187], v[240:243], v[232:235], a[184:187]
    buffer_load_dwordx4 a[240:243], v254, s[8:11], s42 offen offset:0 sc1
    v_mfma_f32_16x16x32_bf16 a[188:191], v[244:247], v[232:235], a[188:191]
    ds_read_b128 v[232:235], v253 offset:12992
    v_mul_u32_u24 v209, 5, v208
    s_waitcnt vmcnt(16)
    s_waitcnt lgkmcnt(3)
sub14:
    v_mfma_f32_16x16x32_bf16 v[0:3], a[192:195], v[236:239], v[0:3]
    v_fmac_f32 v226, s23, v222
    v_cvt_pk_bf16_f32 v226, v252, v226
    v_mfma_f32_16x16x32_bf16 v[4:7], a[196:199], v[236:239], v[4:7]
    s_waitcnt vmcnt(13) lgkmcnt(1)
    v_fma_f32 v252, v249, s24, v251
    v_fmac_f32 v251, -4.0, v249
    v_fma_f32 v249, v248, s24, v250
    v_mfma_f32_16x16x32_bf16 v[8:11], a[200:203], v[236:239], v[8:11]
    ds_read_b128 v[236:239], v253 offset:12736
    v_bfe_u32 v209, s45, v209, 5
    v_mfma_f32_16x16x32_bf16 v[0:3], a[204:207], v[228:231], v[0:3]
    buffer_load_dwordx4 a[244:247], v254, s[8:11], s42 offen offset:1024 sc1
    v_mfma_f32_16x16x32_bf16 v[4:7], a[208:211], v[228:231], v[4:7]
    v_fmac_f32 v250, -4.0, v248
    v_fma_f32 v248, v250, s26, v251
    v_mfma_f32_16x16x32_bf16 v[8:11], a[212:215], v[228:231], v[8:11]
    v_mul_u32_u24 v209, 65, v209
    v_fmac_f32 v251, s27, v250
    v_mfma_f32_16x16x32_bf16 v[12:15], a[192:195], v[228:231], v[12:15]
    s_waitcnt lgkmcnt(1)
    v_fma_f32 v250, v249, 2.0, v252
    v_fmac_f32 v252, -2.0, v249
    v_fma_f32 v249, v220, s24, v224
    v_mfma_f32_16x16x32_bf16 v[12:15], a[204:207], v[232:235], v[12:15]
    buffer_load_dwordx4 a[248:251], v254, s[8:11], s42 offen offset:2048 sc1
    v_mfma_f32_16x16x32_bf16 v[16:19], a[208:211], v[232:235], v[16:19]
    v_sub_u32 v209, v209, v208
    v_fmac_f32 v224, -4.0, v220
    v_mfma_f32_16x16x32_bf16 v[16:19], a[196:199], v[228:231], v[16:19]
    s_mov_b32 s42, 559104
    v_fma_f32 v220, v218, s24, v222
    v_fmac_f32 v222, -4.0, v218
    v_mfma_f32_16x16x32_bf16 v[20:23], a[200:203], v[228:231], v[20:23]
    ds_read_b128 v[228:231], v253 offset:12480
    v_lshl_add_u32 v208, v209, 5, v253
    v_mfma_f32_16x16x32_bf16 v[20:23], a[212:215], v[232:235], v[20:23]
    buffer_load_dwordx4 a[252:255], v254, s[8:11], s42 offen offset:0 sc1
    v_fma_f32 v218, v222, s26, v224
    s_waitcnt vmcnt(13)
    v_mfma_f32_16x16x32_bf16 v[0:3], a[216:219], v[232:235], v[0:3]
    v_fmac_f32 v224, s27, v222
    v_fma_f32 v222, v220, 2.0, v249
    v_mfma_f32_16x16x32_bf16 v[4:7], a[220:223], v[232:235], v[4:7]
    v_fmac_f32 v249, -2.0, v220
    v_cvt_pk_bf16_f32 v218, v248, v218
    v_mfma_f32_16x16x32_bf16 v[8:11], a[224:227], v[232:235], v[8:11]
    s_waitcnt lgkmcnt(1)
    v_cvt_pk_bf16_f32 v224, v251, v224
    v_cvt_pk_bf16_f32 v222, v250, v222
    v_mfma_f32_16x16x32_bf16 v[24:27], a[192:195], v[232:235], v[24:27]
    buffer_load_dwordx4 v[240:243], v254, s[8:11], s42 offen offset:1024 sc1
    v_mfma_f32_16x16x32_bf16 v[24:27], a[204:207], v[236:239], v[24:27]
    s_mov_b64 exec, s[46:47]
    ds_write_b128 v208, v[204:207] offset:1024
    s_mov_b64 exec, -1
    v_cvt_pk_bf16_f32 v220, v252, v249
    v_mfma_f32_16x16x32_bf16 v[28:31], a[208:211], v[236:239], v[28:31]
    v_lshlrev_b32 v248, 16, v219
    v_lshlrev_b32 v249, 16, v221
    v_mfma_f32_16x16x32_bf16 v[28:31], a[196:199], v[232:235], v[28:31]
    buffer_load_dwordx4 v[244:247], v254, s[8:11], s42 offen offset:2048 sc1
    v_mfma_f32_16x16x32_bf16 v[32:35], a[200:203], v[232:235], v[32:35]
    ds_read_b128 v[232:235], v253 offset:14304
    v_and_b32 v215, 0x7fff, v255
    v_mfma_f32_16x16x32_bf16 v[32:35], a[212:215], v[236:239], v[32:35]
    v_lshlrev_b32 v250, 16, v223
    v_lshlrev_b32 v251, 16, v225
    v_mfma_f32_16x16x32_bf16 v[12:15], a[216:219], v[236:239], v[12:15]
    v_and_b32 v219, s22, v219
    v_and_b32 v221, s22, v221
    v_and_b32 v223, s22, v223
    v_mfma_f32_16x16x32_bf16 v[16:19], a[220:223], v[236:239], v[16:19]
    buffer_load_dwordx2 v[204:205], v215, s[4:7], s16 offen offset:320
    v_mfma_f32_16x16x32_bf16 v[20:23], a[224:227], v[236:239], v[20:23]
    v_and_b32 v225, s22, v225
    v_lshlrev_b32 v252, 16, v217
    v_mfma_f32_16x16x32_bf16 v[36:39], a[192:195], v[236:239], v[36:39]
    s_waitcnt lgkmcnt(2)
    v_and_b32 v217, s22, v217
    v_fmac_f32 v252, s25, v251
    v_mfma_f32_16x16x32_bf16 v[36:39], a[204:207], v[228:231], v[36:39]
    v_fmac_f32 v217, s25, v225
    v_fmac_f32 v252, s28, v249
    v_mfma_f32_16x16x32_bf16 v[40:43], a[208:211], v[228:231], v[40:43]
    v_fmac_f32 v217, s28, v221
    v_cvt_pk_bf16_f32 v217, v252, v217
    v_lshlrev_b32 v252, 16, v227
    v_mfma_f32_16x16x32_bf16 v[40:43], a[196:199], v[236:239], v[40:43]
    buffer_load_dwordx2 v[206:207], v215, s[4:7], s17 offen offset:320
    v_mfma_f32_16x16x32_bf16 v[44:47], a[200:203], v[236:239], v[44:47]
    ds_read_b128 v[236:239], v253 offset:14048
    v_and_b32 v227, s22, v227
    v_mfma_f32_16x16x32_bf16 v[44:47], a[212:215], v[228:231], v[44:47]
    v_fmac_f32 v252, s29, v248
    v_fmac_f32 v227, s29, v219
    v_mfma_f32_16x16x32_bf16 v[24:27], a[216:219], v[228:231], v[24:27]
pad5:
    s_cbranch_vccnz pad9
    v_fmac_f32 v252, s23, v250
    v_fmac_f32 v227, s23, v223
    v_mfma_f32_16x16x32_bf16 v[28:31], a[220:223], v[228:231], v[28:31]
    v_cvt_pk_bf16_f32 v227, v252, v227
    v_fma_f32 v252, v249, s24, v251
    v_fmac_f32 v251, -4.0, v249
    v_mfma_f32_16x16x32_bf16 v[32:35], a[224:227], v[228:231], v[32:35]
    buffer_load_dwordx2 v[208:209], v215, s[4:7], s18 offen offset:320
    v_mfma_f32_16x16x32_bf16 v[48:51], a[192:195], v[228:231], v[48:51]
    s_waitcnt lgkmcnt(1)
    v_fma_f32 v249, v248, s24, v250
    v_fmac_f32 v250, -4.0, v248
    v_mfma_f32_16x16x32_bf16 v[48:51], a[204:207], v[232:235], v[48:51]
    v_fma_f32 v248, v250, s26, v251
    v_fmac_f32 v251, s27, v250
    v_mfma_f32_16x16x32_bf16 v[52:55], a[208:211], v[232:235], v[52:55]
    v_fma_f32 v250, v249, 2.0, v252
    v_fmac_f32 v252, -2.0, v249
    v_mfma_f32_16x16x32_bf16 v[52:55], a[196:199], v[228:231], v[52:55]
    v_fma_f32 v249, v221, s24, v225
    v_fmac_f32 v225, -4.0, v221
    v_fma_f32 v221, v219, s24, v223
    v_mfma_f32_16x16x32_bf16 v[56:59], a[200:203], v[228:231], v[56:59]
    ds_read_b128 v[228:231], v253 offset:13792
    v_fmac_f32 v223, -4.0, v219
    v_mfma_f32_16x16x32_bf16 v[56:59], a[212:215], v[232:235], v[56:59]
    buffer_load_dwordx2 v[210:211], v215, s[4:7], s19 offen offset:320
    v_mfma_f32_16x16x32_bf16 v[36:39], a[216:219], v[232:235], v[36:39]
    v_fma_f32 v219, v223, s26, v225
    v_fmac_f32 v225, s27, v223
    v_mfma_f32_16x16x32_bf16 v[40:43], a[220:223], v[232:235], v[40:43]
    v_fma_f32 v223, v221, 2.0, v249
    v_fmac_f32 v249, -2.0, v221
    v_mfma_f32_16x16x32_bf16 v[44:47], a[224:227], v[232:235], v[44:47]
    v_cvt_pk_bf16_f32 v219, v248, v219
    v_cvt_pk_bf16_f32 v225, v251, v225
    v_cvt_pk_bf16_f32 v223, v250, v223
    v_mfma_f32_16x16x32_bf16 v[60:63], a[192:195], v[232:235], v[60:63]
    s_waitcnt lgkmcnt(1)
    v_cvt_pk_bf16_f32 v221, v252, v249
    v_lshrrev_b32 v252, 15, v255
    v_mfma_f32_16x16x32_bf16 v[60:63], a[204:207], v[236:239], v[60:63]
    buffer_load_dwordx2 v[212:213], v215, s[4:7], s20 offen offset:320
    v_mfma_f32_16x16x32_bf16 v[64:67], a[208:211], v[236:239], v[64:67]
    ds_write_b64 v252, v[218:219] offset:256
    v_mfma_f32_16x16x32_bf16 v[64:67], a[196:199], v[232:235], v[64:67]
    s_waitcnt vmcnt(14)
    v_lshlrev_b32 v248, 16, v194
    v_lshlrev_b32 v249, 16, v196
    v_mfma_f32_16x16x32_bf16 v[68:71], a[200:203], v[232:235], v[68:71]
    ds_read_b128 v[232:235], v253 offset:13536
    v_mfma_f32_16x16x32_bf16 v[68:71], a[212:215], v[236:239], v[68:71]
    ds_write_b64 v252, v[224:225] offset:2336
    v_mfma_f32_16x16x32_bf16 v[48:51], a[216:219], v[236:239], v[48:51]
    buffer_load_dwordx2 v[214:215], v215, s[4:7], s21 offen offset:320
    v_mfma_f32_16x16x32_bf16 v[52:55], a[220:223], v[236:239], v[52:55]
    v_lshlrev_b32 v250, 16, v198
    v_lshlrev_b32 v251, 16, v200
    v_mfma_f32_16x16x32_bf16 v[56:59], a[224:227], v[236:239], v[56:59]
    ds_write_b64 v252, v[222:223] offset:4416
    v_mfma_f32_16x16x32_bf16 v[72:75], a[192:195], v[236:239], v[72:75]
    s_waitcnt lgkmcnt(4)
    v_and_b32 v194, s22, v194
    v_and_b32 v196, s22, v196
    v_mfma_f32_16x16x32_bf16 v[72:75], a[204:207], v[228:231], v[72:75]
    ds_write_b64 v252, v[216:217] offset:21056
    v_mfma_f32_16x16x32_bf16 v[76:79], a[208:211], v[228:231], v[76:79]
    v_and_b32 v198, s22, v198
    v_and_b32 v200, s22, v200
    v_mfma_f32_16x16x32_bf16 v[76:79], a[196:199], v[236:239], v[76:79]
    ds_write_b64 v252, v[226:227] offset:29376
    v_mfma_f32_16x16x32_bf16 v[80:83], a[200:203], v[236:239], v[80:83]
    ds_read_b128 v[236:239], v253 offset:13264
    v_mfma_f32_16x16x32_bf16 v[80:83], a[212:215], v[228:231], v[80:83]
    ds_write_b64 v252, v[220:221] offset:6496
    v_mfma_f32_16x16x32_bf16 v[60:63], a[216:219], v[228:231], v[60:63]
    v_mfma_f32_16x16x32_bf16 v[64:67], a[220:223], v[228:231], v[64:67]
    v_mfma_f32_16x16x32_bf16 v[68:71], a[224:227], v[228:231], v[68:71]
    s_mov_b32 s42, 589824
    v_mfma_f32_16x16x32_bf16 v[84:87], a[192:195], v[228:231], v[84:87]
    buffer_load_dwordx4 a[192:195], v254, s[8:11], s42 offen offset:0 sc1
    v_mfma_f32_16x16x32_bf16 v[88:91], a[196:199], v[228:231], v[88:91]
    v_lshlrev_b32 v252, 16, v192
    v_and_b32 v192, s22, v192
    v_mfma_f32_16x16x32_bf16 v[92:95], a[200:203], v[228:231], v[92:95]
    s_waitcnt lgkmcnt(6)
    v_fmac_f32 v252, s25, v251
    v_fmac_f32 v192, s25, v200
    v_mfma_f32_16x16x32_bf16 v[84:87], a[204:207], v[232:235], v[84:87]
    ds_read_b128 v[228:231], v253 offset:32240
    v_fmac_f32 v252, s28, v249
    v_mfma_f32_16x16x32_bf16 v[88:91], a[208:211], v[232:235], v[88:91]
    buffer_load_dwordx4 a[196:199], v254, s[8:11], s42 offen offset:1024 sc1
    v_mfma_f32_16x16x32_bf16 v[92:95], a[212:215], v[232:235], v[92:95]
    v_fmac_f32 v192, s28, v196
    v_cvt_pk_bf16_f32 v192, v252, v192
    v_mfma_f32_16x16x32_bf16 v[72:75], a[216:219], v[232:235], v[72:75]
    s_waitcnt lgkmcnt(2)
    v_lshlrev_b32 v252, 16, v202
    v_and_b32 v202, s22, v202
    v_mfma_f32_16x16x32_bf16 v[76:79], a[220:223], v[232:235], v[76:79]
    buffer_load_dwordx4 a[200:203], v254, s[8:11], s42 offen offset:2048 sc1
    v_mfma_f32_16x16x32_bf16 v[80:83], a[224:227], v[232:235], v[80:83]
    ds_read_b128 v[232:235], v253 offset:31968
    v_fmac_f32 v252, s29, v248
    v_mfma_f32_16x16x32_bf16 v[84:87], a[216:219], v[236:239], v[84:87]
    s_mov_b32 s42, 592896
    v_fmac_f32 v202, s29, v194
    v_fmac_f32 v252, s23, v250
    v_mfma_f32_16x16x32_bf16 v[88:91], a[220:223], v[236:239], v[88:91]
    buffer_load_dwordx4 a[204:207], v254, s[8:11], s42 offen offset:0 sc1
    v_mfma_f32_16x16x32_bf16 v[92:95], a[224:227], v[236:239], v[92:95]
    ds_read_b128 v[236:239], v253 offset:31712
    v_fmac_f32 v202, s23, v198
    s_waitcnt vmcnt(16)
    s_waitcnt lgkmcnt(2)
sub15:
    v_mfma_f32_16x16x32_bf16 v[96:99], a[228:231], v[228:231], v[96:99]
    v_cvt_pk_bf16_f32 v202, v252, v202
    v_fma_f32 v252, v249, s24, v251
    v_mfma_f32_16x16x32_bf16 v[100:103], a[232:235], v[228:231], v[100:103]
    s_waitcnt vmcnt(13) lgkmcnt(1)
    v_fmac_f32 v251, -4.0, v249
    v_fma_f32 v249, v248, s24, v250
    v_mfma_f32_16x16x32_bf16 v[104:107], a[236:239], v[228:231], v[104:107]
    ds_read_b128 v[228:231], v253 offset:31456
    v_fmac_f32 v250, -4.0, v248
    v_mfma_f32_16x16x32_bf16 v[96:99], a[240:243], v[232:235], v[96:99]
    buffer_load_dwordx4 a[208:211], v254, s[8:11], s42 offen offset:1024 sc1
    v_mfma_f32_16x16x32_bf16 v[100:103], a[244:247], v[232:235], v[100:103]
    v_fma_f32 v248, v250, s26, v251
    v_fmac_f32 v251, s27, v250
    v_mfma_f32_16x16x32_bf16 v[104:107], a[248:251], v[232:235], v[104:107]
    v_fma_f32 v250, v249, 2.0, v252
    v_fmac_f32 v252, -2.0, v249
    v_mfma_f32_16x16x32_bf16 v[108:111], a[228:231], v[232:235], v[108:111]
    s_waitcnt lgkmcnt(1)
    v_fma_f32 v249, v196, s24, v200
    v_fmac_f32 v200, -4.0, v196
    v_mfma_f32_16x16x32_bf16 v[108:111], a[240:243], v[236:239], v[108:111]
    buffer_load_dwordx4 a[212:215], v254, s[8:11], s42 offen offset:2048 sc1
    v_mfma_f32_16x16x32_bf16 v[112:115], a[244:247], v[236:239], v[112:115]
    v_fma_f32 v196, v194, s24, v198
    v_fmac_f32 v198, -4.0, v194
    v_mfma_f32_16x16x32_bf16 v[112:115], a[232:235], v[232:235], v[112:115]
    s_mov_b32 s42, 595968
    v_fma_f32 v194, v198, s26, v200
    v_fmac_f32 v200, s27, v198
    v_mfma_f32_16x16x32_bf16 v[116:119], a[236:239], v[232:235], v[116:119]
    ds_read_b128 v[232:235], v253 offset:31200
    v_fma_f32 v198, v196, 2.0, v249
    v_mfma_f32_16x16x32_bf16 v[116:119], a[248:251], v[236:239], v[116:119]
    buffer_load_dwordx4 a[216:219], v254, s[8:11], s42 offen offset:0 sc1
    s_waitcnt vmcnt(13)
    v_mfma_f32_16x16x32_bf16 v[96:99], a[252:255], v[236:239], v[96:99]
    v_fmac_f32 v249, -2.0, v196
    v_cvt_pk_bf16_f32 v194, v248, v194
    v_mfma_f32_16x16x32_bf16 v[100:103], v[240:243], v[236:239], v[100:103]
    v_cvt_pk_bf16_f32 v200, v251, v200
    v_cvt_pk_bf16_f32 v198, v250, v198
    v_mfma_f32_16x16x32_bf16 v[104:107], v[244:247], v[236:239], v[104:107]
    s_waitcnt lgkmcnt(1)
    v_cvt_pk_bf16_f32 v196, v252, v249
    v_lshlrev_b32 v248, 16, v195
    v_mfma_f32_16x16x32_bf16 v[120:123], a[228:231], v[236:239], v[120:123]
    buffer_load_dwordx4 a[220:223], v254, s[8:11], s42 offen offset:1024 sc1
    v_mfma_f32_16x16x32_bf16 v[120:123], a[240:243], v[228:231], v[120:123]
    v_lshlrev_b32 v249, 16, v197
    v_lshlrev_b32 v250, 16, v199
    v_mfma_f32_16x16x32_bf16 v[124:127], a[244:247], v[228:231], v[124:127]
    v_lshlrev_b32 v251, 16, v201
    v_and_b32 v195, s22, v195
    v_mfma_f32_16x16x32_bf16 v[124:127], a[232:235], v[236:239], v[124:127]
    buffer_load_dwordx4 a[224:227], v254, s[8:11], s42 offen offset:2048 sc1
    v_mfma_f32_16x16x32_bf16 v[128:131], a[236:239], v[236:239], v[128:131]
    ds_read_b128 v[236:239], v253 offset:33024
    v_and_b32 v227, 0x7fff, v255
    v_mfma_f32_16x16x32_bf16 v[128:131], a[248:251], v[228:231], v[128:131]
    v_and_b32 v197, s22, v197
    v_and_b32 v199, s22, v199
    v_mfma_f32_16x16x32_bf16 v[108:111], a[252:255], v[228:231], v[108:111]
    v_and_b32 v201, s22, v201
    v_lshlrev_b32 v252, 16, v193
    v_mfma_f32_16x16x32_bf16 v[112:115], v[240:243], v[228:231], v[112:115]
    buffer_load_dwordx2 v[216:217], v227, s[4:7], s16 offen offset:704
    v_mfma_f32_16x16x32_bf16 v[116:119], v[244:247], v[228:231], v[116:119]
    v_and_b32 v193, s22, v193
    v_fmac_f32 v252, s25, v251
    v_mfma_f32_16x16x32_bf16 v[132:135], a[228:231], v[228:231], v[132:135]
    s_waitcnt lgkmcnt(1)
    v_fmac_f32 v193, s25, v201
    v_fmac_f32 v252, s28, v249
    v_mfma_f32_16x16x32_bf16 v[132:135], a[240:243], v[232:235], v[132:135]
    v_fmac_f32 v193, s28, v197
    v_cvt_pk_bf16_f32 v193, v252, v193
    v_mfma_f32_16x16x32_bf16 v[136:139], a[244:247], v[232:235], v[136:139]
    v_lshlrev_b32 v252, 16, v203
    v_and_b32 v203, s22, v203
    v_mfma_f32_16x16x32_bf16 v[136:139], a[232:235], v[228:231], v[136:139]
    buffer_load_dwordx2 v[218:219], v227, s[4:7], s17 offen offset:704
    v_mfma_f32_16x16x32_bf16 v[140:143], a[236:239], v[228:231], v[140:143]
    ds_read_b128 v[228:231], v253 offset:32768
    v_fmac_f32 v252, s29, v248
    v_mfma_f32_16x16x32_bf16 v[140:143], a[248:251], v[232:235], v[140:143]
    v_fmac_f32 v203, s29, v195
    v_fmac_f32 v252, s23, v250
    v_mfma_f32_16x16x32_bf16 v[120:123], a[252:255], v[232:235], v[120:123]
    v_fmac_f32 v203, s23, v199
    v_cvt_pk_bf16_f32 v203, v252, v203
    v_mfma_f32_16x16x32_bf16 v[124:127], v[240:243], v[232:235], v[124:127]
    v_fma_f32 v252, v249, s24, v251
    v_fmac_f32 v251, -4.0, v249
    v_mfma_f32_16x16x32_bf16 v[128:131], v[244:247], v[232:235], v[128:131]
    buffer_load_dwordx2 v[220:221], v227, s[4:7], s18 offen offset:704
    v_mfma_f32_16x16x32_bf16 v[144:147], a[228:231], v[232:235], v[144:147]
    s_waitcnt lgkmcnt(1)
    v_fma_f32 v249, v248, s24, v250
    v_fmac_f32 v250, -4.0, v248
    v_mfma_f32_16x16x32_bf16 v[144:147], a[240:243], v[236:239], v[144:147]
    v_fma_f32 v248, v250, s26, v251
    v_fmac_f32 v251, s27, v250
    v_mfma_f32_16x16x32_bf16 v[148:151], a[244:247], v[236:239], v[148:151]
    v_fma_f32 v250, v249, 2.0, v252
    v_fmac_f32 v252, -2.0, v249
    v_mfma_f32_16x16x32_bf16 v[148:151], a[232:235], v[232:235], v[148:151]
    v_fma_f32 v249, v197, s24, v201
    v_fmac_f32 v201, -4.0, v197
    v_mfma_f32_16x16x32_bf16 v[152:155], a[236:239], v[232:235], v[152:155]
    ds_read_b128 v[232:235], v253 offset:32512
    v_fma_f32 v197, v195, s24, v199
    v_mfma_f32_16x16x32_bf16 v[152:155], a[248:251], v[236:239], v[152:155]
    buffer_load_dwordx2 v[222:223], v227, s[4:7], s19 offen offset:704
    v_mfma_f32_16x16x32_bf16 v[132:135], a[252:255], v[236:239], v[132:135]
    v_fmac_f32 v199, -4.0, v195
    v_fma_f32 v195, v199, s26, v201
    v_mfma_f32_16x16x32_bf16 v[136:139], v[240:243], v[236:239], v[136:139]
    v_fmac_f32 v201, s27, v199
    v_fma_f32 v199, v197, 2.0, v249
    v_mfma_f32_16x16x32_bf16 v[140:143], v[244:247], v[236:239], v[140:143]
    v_fmac_f32 v249, -2.0, v197
    v_cvt_pk_bf16_f32 v195, v248, v195
    v_mfma_f32_16x16x32_bf16 v[156:159], a[228:231], v[236:239], v[156:159]
    s_waitcnt lgkmcnt(1)
    v_cvt_pk_bf16_f32 v201, v251, v201
    v_cvt_pk_bf16_f32 v199, v250, v199
    v_mfma_f32_16x16x32_bf16 v[156:159], a[240:243], v[228:231], v[156:159]
    buffer_load_dwordx2 v[224:225], v227, s[4:7], s20 offen offset:704
    v_mfma_f32_16x16x32_bf16 v[160:163], a[244:247], v[228:231], v[160:163]
    v_cvt_pk_bf16_f32 v197, v252, v249
    v_lshrrev_b32 v252, 15, v255
    v_mfma_f32_16x16x32_bf16 v[160:163], a[232:235], v[236:239], v[160:163]
    ds_write_b64 v252, v[194:195] offset:0
    v_mfma_f32_16x16x32_bf16 v[164:167], a[236:239], v[236:239], v[164:167]
    ds_read_b128 v[236:239], v253 offset:32256
    s_waitcnt vmcnt(14)
    v_mfma_f32_16x16x32_bf16 v[164:167], a[248:251], v[228:231], v[164:167]
    v_lshlrev_b32 v248, 16, v206
    v_lshlrev_b32 v249, 16, v208
    v_mfma_f32_16x16x32_bf16 v[144:147], a[252:255], v[228:231], v[144:147]
    buffer_load_dwordx2 v[226:227], v227, s[4:7], s21 offen offset:704
    v_mfma_f32_16x16x32_bf16 v[148:151], v[240:243], v[228:231], v[148:151]
    ds_write_b64 v252, v[200:201] offset:2080
    v_mfma_f32_16x16x32_bf16 v[152:155], v[244:247], v[228:231], v[152:155]
    s_waitcnt lgkmcnt(3)
    v_lshlrev_b32 v250, 16, v210
    v_lshlrev_b32 v251, 16, v212
    v_mfma_f32_16x16x32_bf16 v[168:171], a[228:231], v[228:231], v[168:171]
    ds_write_b64 v252, v[198:199] offset:4160
    v_mfma_f32_16x16x32_bf16 v[168:171], a[240:243], v[232:235], v[168:171]
    v_and_b32 v206, s22, v206
    v_and_b32 v208, s22, v208
    v_mfma_f32_16x16x32_bf16 v[172:175], a[244:247], v[232:235], v[172:175]
    ds_write_b64 v252, v[192:193] offset:20800
    v_mfma_f32_16x16x32_bf16 v[172:175], a[232:235], v[228:231], v[172:175]
    v_and_b32 v210, s22, v210
    v_and_b32 v212, s22, v212
    v_mfma_f32_16x16x32_bf16 v[176:179], a[236:239], v[228:231], v[176:179]
    ds_read_b128 v[228:231], v253 offset:31984
    v_mfma_f32_16x16x32_bf16 v[176:179], a[248:251], v[232:235], v[176:179]
    ds_write_b64 v252, v[202:203] offset:29120
    v_mfma_f32_16x16x32_bf16 v[156:159], a[252:255], v[232:235], v[156:159]
    s_waitcnt lgkmcnt(5)
    v_mfma_f32_16x16x32_bf16 v[160:163], v[240:243], v[232:235], v[160:163]
    ds_write_b64 v252, v[196:197] offset:6240
    v_mfma_f32_16x16x32_bf16 v[164:167], v[244:247], v[232:235], v[164:167]
    s_mov_b32 s42, 626688
    v_mfma_f32_16x16x32_bf16 v[180:183], a[228:231], v[232:235], v[180:183]
    buffer_load_dwordx4 a[228:231], v254, s[8:11], s42 offen offset:0 sc1
    v_mfma_f32_16x16x32_bf16 v[184:187], a[232:235], v[232:235], v[184:187]
    s_waitcnt lgkmcnt(0)
    v_lshlrev_b32 v252, 16, v204
    v_and_b32 v204, s22, v204
    v_mfma_f32_16x16x32_bf16 v[188:191], a[236:239], v[232:235], v[188:191]
    s_barrier
    v_mfma_f32_16x16x32_bf16 v[180:183], a[240:243], v[236:239], v[180:183]
    ds_read_b128 v[232:235], v253 offset:1040
    v_fmac_f32 v252, s25, v251
    v_mfma_f32_16x16x32_bf16 v[184:187], a[244:247], v[236:239], v[184:187]
    buffer_load_dwordx4 a[232:235], v254, s[8:11], s42 offen offset:1024 sc1
    v_mfma_f32_16x16x32_bf16 v[188:191], a[248:251], v[236:239], v[188:191]
    v_fmac_f32 v204, s25, v212
    v_fmac_f32 v252, s28, v249
    v_mfma_f32_16x16x32_bf16 v[168:171], a[252:255], v[236:239], v[168:171]
    v_fmac_f32 v204, s28, v208
    v_cvt_pk_bf16_f32 v204, v252, v204
    v_mfma_f32_16x16x32_bf16 v[172:175], v[240:243], v[236:239], v[172:175]
    buffer_load_dwordx4 a[236:239], v254, s[8:11], s42 offen offset:2048 sc1
    v_mfma_f32_16x16x32_bf16 v[176:179], v[244:247], v[236:239], v[176:179]
    ds_read_b128 v[236:239], v253 offset:768
    v_lshlrev_b32 v252, 16, v214
    v_mfma_f32_16x16x32_bf16 v[180:183], a[252:255], v[228:231], v[180:183]
    s_mov_b32 s42, 629760
    v_and_b32 v214, s22, v214
    v_fmac_f32 v252, s29, v248
    v_mfma_f32_16x16x32_bf16 v[184:187], v[240:243], v[228:231], v[184:187]
    buffer_load_dwordx4 a[240:243], v254, s[8:11], s42 offen offset:0 sc1
    v_mfma_f32_16x16x32_bf16 v[188:191], v[244:247], v[228:231], v[188:191]
    ds_read_b128 v[228:231], v253 offset:512
    v_fmac_f32 v214, s29, v206
    s_waitcnt vmcnt(16)
    s_waitcnt lgkmcnt(2)
sub16:
    v_mfma_f32_16x16x32_bf16 a[0:3], a[192:195], v[232:235], a[0:3]
    v_fmac_f32 v252, s23, v250
    v_fmac_f32 v214, s23, v210
    v_mfma_f32_16x16x32_bf16 a[4:7], a[196:199], v[232:235], a[4:7]
    s_waitcnt vmcnt(13) lgkmcnt(1)
    v_cvt_pk_bf16_f32 v214, v252, v214
    v_fma_f32 v252, v249, s24, v251
    v_mfma_f32_16x16x32_bf16 a[8:11], a[200:203], v[232:235], a[8:11]
    ds_read_b128 v[232:235], v253 offset:256
    v_fmac_f32 v251, -4.0, v249
    v_mfma_f32_16x16x32_bf16 a[0:3], a[204:207], v[236:239], a[0:3]
    buffer_load_dwordx4 a[244:247], v254, s[8:11], s42 offen offset:1024 sc1
    v_mfma_f32_16x16x32_bf16 a[4:7], a[208:211], v[236:239], a[4:7]
    v_fma_f32 v249, v248, s24, v250
    v_fmac_f32 v250, -4.0, v248
    v_mfma_f32_16x16x32_bf16 a[8:11], a[212:215], v[236:239], a[8:11]
    v_fma_f32 v248, v250, s26, v251
    v_fmac_f32 v251, s27, v250
    v_mfma_f32_16x16x32_bf16 a[12:15], a[192:195], v[236:239], a[12:15]
    s_waitcnt lgkmcnt(1)
    v_fma_f32 v250, v249, 2.0, v252
    v_fmac_f32 v252, -2.0, v249
    v_mfma_f32_16x16x32_bf16 a[12:15], a[204:207], v[228:231], a[12:15]
    buffer_load_dwordx4 a[248:251], v254, s[8:11], s42 offen offset:2048 sc1
    v_mfma_f32_16x16x32_bf16 a[16:19], a[208:211], v[228:231], a[16:19]
    v_fma_f32 v249, v208, s24, v212
    v_fmac_f32 v212, -4.0, v208
    v_mfma_f32_16x16x32_bf16 a[16:19], a[196:199], v[236:239], a[16:19]
    s_mov_b32 s42, 632832
    v_fma_f32 v208, v206, s24, v210
    v_fmac_f32 v210, -4.0, v206
    v_mfma_f32_16x16x32_bf16 a[20:23], a[200:203], v[236:239], a[20:23]
    ds_read_b128 v[236:239], v253 offset:0
    v_fma_f32 v206, v210, s26, v212
    v_mfma_f32_16x16x32_bf16 a[20:23], a[212:215], v[228:231], a[20:23]
    buffer_load_dwordx4 a[252:255], v254, s[8:11], s42 offen offset:0 sc1
    s_waitcnt vmcnt(13)
    v_mfma_f32_16x16x32_bf16 a[0:3], a[216:219], v[228:231], a[0:3]
    v_fmac_f32 v212, s27, v210
    v_fma_f32 v210, v208, 2.0, v249
    v_mfma_f32_16x16x32_bf16 a[4:7], a[220:223], v[228:231], a[4:7]
    v_fmac_f32 v249, -2.0, v208
    v_cvt_pk_bf16_f32 v206, v248, v206
    v_mfma_f32_16x16x32_bf16 a[8:11], a[224:227], v[228:231], a[8:11]
    s_waitcnt lgkmcnt(1)
    v_cvt_pk_bf16_f32 v212, v251, v212
    v_cvt_pk_bf16_f32 v210, v250, v210
    v_mfma_f32_16x16x32_bf16 a[24:27], a[192:195], v[228:231], a[24:27]
    buffer_load_dwordx4 v[240:243], v254, s[8:11], s42 offen offset:1024 sc1
    v_mfma_f32_16x16x32_bf16 a[24:27], a[204:207], v[232:235], a[24:27]
    v_cvt_pk_bf16_f32 v208, v252, v249
    v_lshlrev_b32 v248, 16, v207
    v_mfma_f32_16x16x32_bf16 a[28:31], a[208:211], v[232:235], a[28:31]
    v_lshlrev_b32 v249, 16, v209
    v_lshlrev_b32 v250, 16, v211
    v_mfma_f32_16x16x32_bf16 a[28:31], a[196:199], v[228:231], a[28:31]
    buffer_load_dwordx4 v[244:247], v254, s[8:11], s42 offen offset:2048 sc1
    v_mfma_f32_16x16x32_bf16 a[32:35], a[200:203], v[228:231], a[32:35]
    ds_read_b128 v[228:231], v253 offset:1824
    v_and_b32 v203, 0x7fff, v255
    v_mfma_f32_16x16x32_bf16 a[32:35], a[212:215], v[232:235], a[32:35]
    v_lshlrev_b32 v251, 16, v213
    v_and_b32 v207, s22, v207
    v_mfma_f32_16x16x32_bf16 a[12:15], a[216:219], v[232:235], a[12:15]
    v_and_b32 v209, s22, v209
    v_and_b32 v211, s22, v211
    v_mfma_f32_16x16x32_bf16 a[16:19], a[220:223], v[232:235], a[16:19]
    buffer_load_dwordx2 v[192:193], v203, s[4:7], s16 offen offset:1088
    v_mfma_f32_16x16x32_bf16 a[20:23], a[224:227], v[232:235], a[20:23]
    v_and_b32 v213, s22, v213
    v_lshlrev_b32 v252, 16, v205
    v_mfma_f32_16x16x32_bf16 a[36:39], a[192:195], v[232:235], a[36:39]
    s_waitcnt lgkmcnt(1)
    v_and_b32 v205, s22, v205
    v_fmac_f32 v252, s25, v251
    v_mfma_f32_16x16x32_bf16 a[36:39], a[204:207], v[236:239], a[36:39]
    v_fmac_f32 v205, s25, v213
    v_fmac_f32 v252, s28, v249
    v_mfma_f32_16x16x32_bf16 a[40:43], a[208:211], v[236:239], a[40:43]
    v_fmac_f32 v205, s28, v209
    v_cvt_pk_bf16_f32 v205, v252, v205
    v_mfma_f32_16x16x32_bf16 a[40:43], a[196:199], v[232:235], a[40:43]
    buffer_load_dwordx2 v[194:195], v203, s[4:7], s17 offen offset:1088
    v_mfma_f32_16x16x32_bf16 a[44:47], a[200:203], v[232:235], a[44:47]
    ds_read_b128 v[232:235], v253 offset:1568
    v_lshlrev_b32 v252, 16, v215
    v_mfma_f32_16x16x32_bf16 a[44:47], a[212:215], v[236:239], a[44:47]
    v_and_b32 v215, s22, v215
    v_fmac_f32 v252, s29, v248
    v_mfma_f32_16x16x32_bf16 a[24:27], a[216:219], v[236:239], a[24:27]
    v_fmac_f32 v215, s29, v207
    v_fmac_f32 v252, s23, v250
    v_mfma_f32_16x16x32_bf16 a[28:31], a[220:223], v[236:239], a[28:31]
    v_fmac_f32 v215, s23, v211
    v_cvt_pk_bf16_f32 v215, v252, v215
    v_mfma_f32_16x16x32_bf16 a[32:35], a[224:227], v[236:239], a[32:35]
    buffer_load_dwordx2 v[196:197], v203, s[4:7], s18 offen offset:1088
    v_mfma_f32_16x16x32_bf16 a[48:51], a[192:195], v[236:239], a[48:51]
    s_waitcnt lgkmcnt(1)
    v_fma_f32 v252, v249, s24, v251
    v_fmac_f32 v251, -4.0, v249
    v_mfma_f32_16x16x32_bf16 a[48:51], a[204:207], v[228:231], a[48:51]
    v_fma_f32 v249, v248, s24, v250
    v_fmac_f32 v250, -4.0, v248
    v_mfma_f32_16x16x32_bf16 a[52:55], a[208:211], v[228:231], a[52:55]
    v_fma_f32 v248, v250, s26, v251
    v_fmac_f32 v251, s27, v250
    v_mfma_f32_16x16x32_bf16 a[52:55], a[196:199], v[236:239], a[52:55]
    v_fma_f32 v250, v249, 2.0, v252
    v_mfma_f32_16x16x32_bf16 a[56:59], a[200:203], v[236:239], a[56:59]
    ds_read_b128 v[236:239], v253 offset:1312
    v_fmac_f32 v252, -2.0, v249
    v_mfma_f32_16x16x32_bf16 a[56:59], a[212:215], v[228:231], a[56:59]
    buffer_load_dwordx2 v[198:199], v203, s[4:7], s19 offen offset:1088
    v_mfma_f32_16x16x32_bf16 a[36:39], a[216:219], v[228:231], a[36:39]
    v_fma_f32 v249, v209, s24, v213
    v_fmac_f32 v213, -4.0, v209
    v_mfma_f32_16x16x32_bf16 a[40:43], a[220:223], v[228:231], a[40:43]
    v_fma_f32 v209, v207, s24, v211
    v_fmac_f32 v211, -4.0, v207
    v_mfma_f32_16x16x32_bf16 a[44:47], a[224:227], v[228:231], a[44:47]
    v_fma_f32 v207, v211, s26, v213
    v_fmac_f32 v213, s27, v211
    v_mfma_f32_16x16x32_bf16 a[60:63], a[192:195], v[228:231], a[60:63]
    s_waitcnt lgkmcnt(1)
    v_fma_f32 v211, v209, 2.0, v249
    v_mfma_f32_16x16x32_bf16 a[60:63], a[204:207], v[232:235], a[60:63]
    buffer_load_dwordx2 v[200:201], v203, s[4:7], s20 offen offset:1088
    v_mfma_f32_16x16x32_bf16 a[64:67], a[208:211], v[232:235], a[64:67]
    v_fmac_f32 v249, -2.0, v209
    v_cvt_pk_bf16_f32 v207, v248, v207
    v_mfma_f32_16x16x32_bf16 a[64:67], a[196:199], v[228:231], a[64:67]
    v_cvt_pk_bf16_f32 v213, v251, v213
    v_cvt_pk_bf16_f32 v211, v250, v211
    v_mfma_f32_16x16x32_bf16 a[68:71], a[200:203], v[228:231], a[68:71]
    ds_read_b128 v[228:231], v253 offset:1056
    v_cvt_pk_bf16_f32 v209, v252, v249
    v_mfma_f32_16x16x32_bf16 a[68:71], a[212:215], v[232:235], a[68:71]
    v_lshrrev_b32 v252, 15, v255
    v_mfma_f32_16x16x32_bf16 a[48:51], a[216:219], v[232:235], a[48:51]
    buffer_load_dwordx2 v[202:203], v203, s[4:7], s21 offen offset:1088
    v_mfma_f32_16x16x32_bf16 a[52:55], a[220:223], v[232:235], a[52:55]
    ds_write_b64 v252, v[206:207] offset:9088
    v_mfma_f32_16x16x32_bf16 a[56:59], a[224:227], v[232:235], a[56:59]
    s_waitcnt vmcnt(15) lgkmcnt(2)
    v_lshlrev_b32 v248, 16, v218
    v_lshlrev_b32 v249, 16, v220
    v_mfma_f32_16x16x32_bf16 a[72:75], a[192:195], v[232:235], a[72:75]
    ds_write_b64 v252, v[212:213] offset:11168
    v_mfma_f32_16x16x32_bf16 a[72:75], a[204:207], v[236:239], a[72:75]
    v_lshlrev_b32 v250, 16, v222
    v_lshlrev_b32 v251, 16, v224
    v_mfma_f32_16x16x32_bf16 a[76:79], a[208:211], v[236:239], a[76:79]
    ds_write_b64 v252, v[210:211] offset:13248
    v_mfma_f32_16x16x32_bf16 a[76:79], a[196:199], v[232:235], a[76:79]
    v_and_b32 v218, s22, v218
    v_mfma_f32_16x16x32_bf16 a[80:83], a[200:203], v[232:235], a[80:83]
    ds_read_b128 v[232:235], v253 offset:784
    v_and_b32 v220, s22, v220
    v_mfma_f32_16x16x32_bf16 a[80:83], a[212:215], v[236:239], a[80:83]
    ds_write_b64 v252, v[204:205] offset:23648
    v_mfma_f32_16x16x32_bf16 a[60:63], a[216:219], v[236:239], a[60:63]
    s_waitcnt lgkmcnt(5)
    v_and_b32 v222, s22, v222
    v_and_b32 v224, s22, v224
    v_mfma_f32_16x16x32_bf16 a[64:67], a[220:223], v[236:239], a[64:67]
    ds_write_b64 v252, v[214:215] offset:31968
    v_mfma_f32_16x16x32_bf16 a[68:71], a[224:227], v[236:239], a[68:71]
    s_mov_b32 s42, 663552
    v_mfma_f32_16x16x32_bf16 a[84:87], a[192:195], v[236:239], a[84:87]
    buffer_load_dwordx4 a[192:195], v254, s[8:11], s42 offen offset:0 sc1
    v_mfma_f32_16x16x32_bf16 a[88:91], a[196:199], v[236:239], a[88:91]
    s_waitcnt lgkmcnt(0)
    v_mfma_f32_16x16x32_bf16 a[92:95], a[200:203], v[236:239], a[92:95]
    s_barrier
    v_mfma_f32_16x16x32_bf16 a[84:87], a[204:207], v[228:231], a[84:87]
    ds_read_b128 v[236:239], v253 offset:3120
    v_mfma_f32_16x16x32_bf16 a[88:91], a[208:211], v[228:231], a[88:91]
    buffer_load_dwordx4 a[196:199], v254, s[8:11], s42 offen offset:1024 sc1
    v_mfma_f32_16x16x32_bf16 a[92:95], a[212:215], v[228:231], a[92:95]
    ds_write_b64 v252, v[208:209] offset:768
    v_mfma_f32_16x16x32_bf16 a[72:75], a[216:219], v[228:231], a[72:75]
    v_lshlrev_b32 v252, 16, v216
    v_and_b32 v216, s22, v216
    v_mfma_f32_16x16x32_bf16 a[76:79], a[220:223], v[228:231], a[76:79]
    buffer_load_dwordx4 a[200:203], v254, s[8:11], s42 offen offset:2048 sc1
    v_fmac_f32 v252, s25, v251
    v_mfma_f32_16x16x32_bf16 a[80:83], a[224:227], v[228:231], a[80:83]
    ds_read_b128 v[228:231], v253 offset:2848
    v_fmac_f32 v216, s25, v224
    v_mfma_f32_16x16x32_bf16 a[84:87], a[216:219], v[232:235], a[84:87]
    s_mov_b32 s42, 666624
    v_fmac_f32 v252, s28, v249
    v_fmac_f32 v216, s28, v220
    v_mfma_f32_16x16x32_bf16 a[88:91], a[220:223], v[232:235], a[88:91]
    buffer_load_dwordx4 a[204:207], v254, s[8:11], s42 offen offset:0 sc1
    v_mfma_f32_16x16x32_bf16 a[92:95], a[224:227], v[232:235], a[92:95]
    ds_read_b128 v[232:235], v253 offset:2592
    v_cvt_pk_bf16_f32 v216, v252, v216
    v_lshlrev_b32 v252, 16, v226
    s_waitcnt vmcnt(16)
    s_waitcnt lgkmcnt(3)
sub17:
    v_mfma_f32_16x16x32_bf16 a[96:99], a[228:231], v[236:239], a[96:99]
    v_and_b32 v226, s22, v226
    v_fmac_f32 v252, s29, v248
    v_mfma_f32_16x16x32_bf16 a[100:103], a[232:235], v[236:239], a[100:103]
    s_waitcnt vmcnt(13) lgkmcnt(1)
    v_fmac_f32 v226, s29, v218
    v_fmac_f32 v252, s23, v250
    v_mfma_f32_16x16x32_bf16 a[104:107], a[236:239], v[236:239], a[104:107]
    ds_read_b128 v[236:239], v253 offset:2336
    v_fmac_f32 v226, s23, v222
    v_cvt_pk_bf16_f32 v226, v252, v226
    v_mfma_f32_16x16x32_bf16 a[96:99], a[240:243], v[228:231], a[96:99]
    buffer_load_dwordx4 a[208:211], v254, s[8:11], s42 offen offset:1024 sc1
    v_mfma_f32_16x16x32_bf16 a[100:103], a[244:247], v[228:231], a[100:103]
    v_fma_f32 v252, v249, s24, v251
    v_fmac_f32 v251, -4.0, v249
    v_mfma_f32_16x16x32_bf16 a[104:107], a[248:251], v[228:231], a[104:107]
    v_fma_f32 v249, v248, s24, v250
    v_fmac_f32 v250, -4.0, v248
    v_fma_f32 v248, v250, s26, v251
    v_mfma_f32_16x16x32_bf16 a[108:111], a[228:231], v[228:231], a[108:111]
    s_waitcnt lgkmcnt(1)
    v_fmac_f32 v251, s27, v250
    v_fma_f32 v250, v249, 2.0, v252
    v_mfma_f32_16x16x32_bf16 a[108:111], a[240:243], v[232:235], a[108:111]
    buffer_load_dwordx4 a[212:215], v254, s[8:11], s42 offen offset:2048 sc1
    v_mfma_f32_16x16x32_bf16 a[112:115], a[244:247], v[232:235], a[112:115]
    v_fmac_f32 v252, -2.0, v249
    v_fma_f32 v249, v220, s24, v224
    v_mfma_f32_16x16x32_bf16 a[112:115], a[232:235], v[228:231], a[112:115]
    s_mov_b32 s42, 669696
    v_fmac_f32 v224, -4.0, v220
    v_fma_f32 v220, v218, s24, v222
    v_fmac_f32 v222, -4.0, v218
    v_mfma_f32_16x16x32_bf16 a[116:119], a[236:239], v[228:231], a[116:119]
    ds_read_b128 v[228:231], v253 offset:2080
    v_fma_f32 v218, v222, s26, v224
    v_mfma_f32_16x16x32_bf16 a[116:119], a[248:251], v[232:235], a[116:119]
    buffer_load_dwordx4 a[216:219], v254, s[8:11], s42 offen offset:0 sc1
    s_waitcnt vmcnt(13)
    v_mfma_f32_16x16x32_bf16 a[96:99], a[252:255], v[232:235], a[96:99]
    v_fmac_f32 v224, s27, v222
    v_fma_f32 v222, v220, 2.0, v249
    v_fmac_f32 v249, -2.0, v220
    v_mfma_f32_16x16x32_bf16 a[100:103], v[240:243], v[232:235], a[100:103]
    v_cvt_pk_bf16_f32 v218, v248, v218
    v_cvt_pk_bf16_f32 v224, v251, v224
    v_mfma_f32_16x16x32_bf16 a[104:107], v[244:247], v[232:235], a[104:107]
    s_waitcnt lgkmcnt(1)
    v_cvt_pk_bf16_f32 v222, v250, v222
    v_cvt_pk_bf16_f32 v220, v252, v249
    v_mfma_f32_16x16x32_bf16 a[120:123], a[228:231], v[232:235], a[120:123]
    buffer_load_dwordx4 a[220:223], v254, s[8:11], s42 offen offset:1024 sc1
    v_lshlrev_b32 v248, 16, v219
    v_mfma_f32_16x16x32_bf16 a[120:123], a[240:243], v[236:239], a[120:123]
    v_lshlrev_b32 v249, 16, v221
    v_lshlrev_b32 v250, 16, v223
    v_mfma_f32_16x16x32_bf16 a[124:127], a[244:247], v[236:239], a[124:127]
    v_lshlrev_b32 v251, 16, v225
    v_and_b32 v219, s22, v219
    v_mfma_f32_16x16x32_bf16 a[124:127], a[232:235], v[232:235], a[124:127]
    buffer_load_dwordx4 a[224:227], v254, s[8:11], s42 offen offset:2048 sc1
    v_mfma_f32_16x16x32_bf16 a[128:131], a[236:239], v[232:235], a[128:131]
    ds_read_b128 v[232:235], v253 offset:3904
    v_and_b32 v215, 0x7fff, v255
    v_and_b32 v221, s22, v221
    v_mfma_f32_16x16x32_bf16 a[128:131], a[248:251], v[236:239], a[128:131]
    v_and_b32 v223, s22, v223
    v_and_b32 v225, s22, v225
    v_mfma_f32_16x16x32_bf16 a[108:111], a[252:255], v[236:239], a[108:111]
    v_lshlrev_b32 v252, 16, v217
    v_and_b32 v217, s22, v217
    v_mfma_f32_16x16x32_bf16 a[112:115], v[240:243], v[236:239], a[112:115]
    buffer_load_dwordx2 v[204:205], v215, s[4:7], s16 offen offset:1472
    v_fmac_f32 v252, s25, v251
    v_mfma_f32_16x16x32_bf16 a[116:119], v[244:247], v[236:239], a[116:119]
    v_fmac_f32 v217, s25, v225
    v_fmac_f32 v252, s28, v249
    v_mfma_f32_16x16x32_bf16 a[132:135], a[228:231], v[236:239], a[132:135]
    s_waitcnt lgkmcnt(1)
    v_fmac_f32 v217, s28, v221
    v_cvt_pk_bf16_f32 v217, v252, v217
    v_mfma_f32_16x16x32_bf16 a[132:135], a[240:243], v[228:231], a[132:135]
    v_lshlrev_b32 v252, 16, v227
    v_and_b32 v227, s22, v227
    v_fmac_f32 v252, s29, v248
    v_mfma_f32_16x16x32_bf16 a[136:139], a[244:247], v[228:231], a[136:139]
    v_fmac_f32 v227, s29, v219
    v_fmac_f32 v252, s23, v250
    v_mfma_f32_16x16x32_bf16 a[136:139], a[232:235], v[236:239], a[136:139]
    buffer_load_dwordx2 v[206:207], v215, s[4:7], s17 offen offset:1472
    v_mfma_f32_16x16x32_bf16 a[140:143], a[236:239], v[236:239], a[140:143]
    ds_read_b128 v[236:239], v253 offset:3648
    v_fmac_f32 v227, s23, v223
    v_mfma_f32_16x16x32_bf16 a[140:143], a[248:251], v[228:231], a[140:143]
    v_cvt_pk_bf16_f32 v227, v252, v227
    v_fma_f32 v252, v249, s24, v251
    v_fmac_f32 v251, -4.0, v249
    v_mfma_f32_16x16x32_bf16 a[120:123], a[252:255], v[228:231], a[120:123]
pad6:
    s_cbranch_vccnz pad10
    v_fma_f32 v249, v248, s24, v250
    v_fmac_f32 v250, -4.0, v248
    v_mfma_f32_16x16x32_bf16 a[124:127], v[240:243], v[228:231], a[124:127]
    v_fma_f32 v248, v250, s26, v251
    v_fmac_f32 v251, s27, v250
    v_mfma_f32_16x16x32_bf16 a[128:131], v[244:247], v[228:231], a[128:131]
    buffer_load_dwordx2 v[208:209], v215, s[4:7], s18 offen offset:1472
    v_fma_f32 v250, v249, 2.0, v252
    v_mfma_f32_16x16x32_bf16 a[144:147], a[228:231], v[228:231], a[144:147]
    s_waitcnt lgkmcnt(1)
    v_fmac_f32 v252, -2.0, v249
    v_fma_f32 v249, v221, s24, v225
    v_mfma_f32_16x16x32_bf16 a[144:147], a[240:243], v[232:235], a[144:147]
    v_fmac_f32 v225, -4.0, v221
    v_fma_f32 v221, v219, s24, v223
    v_mfma_f32_16x16x32_bf16 a[148:151], a[244:247], v[232:235], a[148:151]
    v_fmac_f32 v223, -4.0, v219
    v_fma_f32 v219, v223, s26, v225
    v_fmac_f32 v225, s27, v223
    v_mfma_f32_16x16x32_bf16 a[148:151], a[232:235], v[228:231], a[148:151]
    v_fma_f32 v223, v221, 2.0, v249
    v_fmac_f32 v249, -2.0, v221
    v_mfma_f32_16x16x32_bf16 a[152:155], a[236:239], v[228:231], a[152:155]
    ds_read_b128 v[228:231], v253 offset:3392
    v_cvt_pk_bf16_f32 v219, v248, v219
    v_mfma_f32_16x16x32_bf16 a[152:155], a[248:251], v[232:235], a[152:155]
    buffer_load_dwordx2 v[210:211], v215, s[4:7], s19 offen offset:1472
    v_mfma_f32_16x16x32_bf16 a[132:135], a[252:255], v[232:235], a[132:135]
    v_cvt_pk_bf16_f32 v225, v251, v225
    v_cvt_pk_bf16_f32 v223, v250, v223
    v_cvt_pk_bf16_f32 v221, v252, v249
    v_mfma_f32_16x16x32_bf16 a[136:139], v[240:243], v[232:235], a[136:139]
    v_lshrrev_b32 v252, 15, v255
    v_mfma_f32_16x16x32_bf16 a[140:143], v[244:247], v[232:235], a[140:143]
    ds_write_b64 v252, v[218:219] offset:8832
    v_mfma_f32_16x16x32_bf16 a[156:159], a[228:231], v[232:235], a[156:159]
    s_waitcnt vmcnt(13) lgkmcnt(2)
    v_lshlrev_b32 v248, 16, v194
    v_lshlrev_b32 v249, 16, v196
    v_mfma_f32_16x16x32_bf16 a[156:159], a[240:243], v[236:239], a[156:159]
    buffer_load_dwordx2 v[212:213], v215, s[4:7], s20 offen offset:1472
    v_mfma_f32_16x16x32_bf16 a[160:163], a[244:247], v[236:239], a[160:163]
    ds_write_b64 v252, v[224:225] offset:10912
    v_mfma_f32_16x16x32_bf16 a[160:163], a[232:235], v[232:235], a[160:163]
    v_lshlrev_b32 v250, 16, v198
    v_lshlrev_b32 v251, 16, v200
    v_mfma_f32_16x16x32_bf16 a[164:167], a[236:239], v[232:235], a[164:167]
    ds_read_b128 v[232:235], v253 offset:3136
    v_mfma_f32_16x16x32_bf16 a[164:167], a[248:251], v[236:239], a[164:167]
    ds_write_b64 v252, v[222:223] offset:12992
    v_mfma_f32_16x16x32_bf16 a[144:147], a[252:255], v[236:239], a[144:147]
    buffer_load_dwordx2 v[214:215], v215, s[4:7], s21 offen offset:1472
    v_mfma_f32_16x16x32_bf16 a[148:151], v[240:243], v[236:239], a[148:151]
    s_add_u32 s49, s49, 8
    v_and_b32 v194, s22, v194
    v_and_b32 v196, s22, v196
    v_mfma_f32_16x16x32_bf16 a[152:155], v[244:247], v[236:239], a[152:155]
    ds_write_b64 v252, v[216:217] offset:23392
    v_mfma_f32_16x16x32_bf16 a[168:171], a[228:231], v[236:239], a[168:171]
    s_waitcnt lgkmcnt(5)
    v_and_b32 v198, s22, v198
    v_and_b32 v200, s22, v200
    v_mfma_f32_16x16x32_bf16 a[168:171], a[240:243], v[228:231], a[168:171]
    s_cmp_eq_u32 s39, 1
    s_cselect_b32 s49, 128, s49
    v_mfma_f32_16x16x32_bf16 a[172:175], a[244:247], v[228:231], a[172:175]
    ds_write_b64 v252, v[226:227] offset:31712
    v_mfma_f32_16x16x32_bf16 a[172:175], a[232:235], v[236:239], a[172:175]
    v_mfma_f32_16x16x32_bf16 a[176:179], a[236:239], v[236:239], a[176:179]
    ds_read_b128 v[236:239], v253 offset:2864
    s_mul_i32 s43, s49, 786432
    v_mfma_f32_16x16x32_bf16 a[176:179], a[248:251], v[228:231], a[176:179]
    ds_write_b64 v252, v[220:221] offset:512
    v_mfma_f32_16x16x32_bf16 a[156:159], a[252:255], v[228:231], a[156:159]
    v_mfma_f32_16x16x32_bf16 a[160:163], v[240:243], v[228:231], a[160:163]
    s_add_u32 s43, s43, s53
    v_mfma_f32_16x16x32_bf16 a[164:167], v[244:247], v[228:231], a[164:167]
    s_mov_b32 s42, 700416
    v_mfma_f32_16x16x32_bf16 a[180:183], a[228:231], v[228:231], a[180:183]
    buffer_load_dwordx4 a[228:231], v254, s[8:11], s42 offen offset:0 sc1
    v_lshlrev_b32 v252, 16, v192
    v_mfma_f32_16x16x32_bf16 a[184:187], a[232:235], v[228:231], a[184:187]
    s_cmp_ge_u32 s49, 128
    s_cselect_b32 s43, 2130706432, s43
    v_and_b32 v192, s22, v192
    v_mfma_f32_16x16x32_bf16 a[188:191], a[236:239], v[228:231], a[188:191]
    s_waitcnt lgkmcnt(1)
    v_fmac_f32 v252, s25, v251
    v_fmac_f32 v192, s25, v200
    v_fmac_f32 v252, s28, v249
    v_mfma_f32_16x16x32_bf16 a[180:183], a[240:243], v[232:235], a[180:183]
    ds_read_b128 v[228:231], v253 offset:5200
    v_fmac_f32 v192, s28, v196
    v_mfma_f32_16x16x32_bf16 a[184:187], a[244:247], v[232:235], a[184:187]
    buffer_load_dwordx4 a[232:235], v254, s[8:11], s42 offen offset:1024 sc1
    v_cvt_pk_bf16_f32 v192, v252, v192
    v_mfma_f32_16x16x32_bf16 a[188:191], a[248:251], v[232:235], a[188:191]
    s_sub_u32 s16, s43, 196608
    v_lshlrev_b32 v252, 16, v202
    v_and_b32 v202, s22, v202
    v_mfma_f32_16x16x32_bf16 a[168:171], a[252:255], v[232:235], a[168:171]
    ds_read_b128 v[216:219], v253 offset:40480
    s_mov_b32 s45, 503518347
    v_mfma_f32_16x16x32_bf16 a[172:175], v[240:243], v[232:235], a[172:175]
    buffer_load_dwordx4 a[236:239], v254, s[8:11], s42 offen offset:2048 sc1
    v_fmac_f32 v252, s29, v248
    v_mfma_f32_16x16x32_bf16 a[176:179], v[244:247], v[232:235], a[176:179]
    ds_read_b128 v[232:235], v253 offset:4928
    v_fmac_f32 v202, s29, v194
    v_mfma_f32_16x16x32_bf16 a[180:183], a[252:255], v[236:239], a[180:183]
    s_mov_b32 s42, 703488
    v_bfe_u32 v220, v254, 5, 3
    v_fmac_f32 v252, s23, v250
    v_fmac_f32 v202, s23, v198
    v_mfma_f32_16x16x32_bf16 a[184:187], v[240:243], v[236:239], a[184:187]
    buffer_load_dwordx4 a[240:243], v254, s[8:11], s42 offen offset:0 sc1
    v_mfma_f32_16x16x32_bf16 a[188:191], v[244:247], v[236:239], a[188:191]
    ds_read_b128 v[236:239], v253 offset:4672
    v_mul_u32_u24 v221, 5, v220
    v_cvt_pk_bf16_f32 v202, v252, v202
    s_waitcnt vmcnt(16)
    s_waitcnt lgkmcnt(3)
sub18:
    v_mfma_f32_16x16x32_bf16 v[0:3], a[192:195], v[228:231], v[0:3]
    s_cmp_eq_u32 s49, 0
    s_cselect_b32 s16, 2130706432, s16
    s_mov_b32 s17, s43
    v_mfma_f32_16x16x32_bf16 v[4:7], a[196:199], v[228:231], v[4:7]
    s_waitcnt vmcnt(13) lgkmcnt(1)
    v_fma_f32 v252, v249, s24, v251
    v_fmac_f32 v251, -4.0, v249
    v_fma_f32 v249, v248, s24, v250
    v_mfma_f32_16x16x32_bf16 v[8:11], a[200:203], v[228:231], v[8:11]
    ds_read_b128 v[228:231], v253 offset:4416
    s_add_u32 s18, s43, 196608
    v_mfma_f32_16x16x32_bf16 v[0:3], a[204:207], v[232:235], v[0:3]
    buffer_load_dwordx4 a[244:247], v254, s[8:11], s42 offen offset:1024 sc1
    v_fmac_f32 v250, -4.0, v248
    v_mfma_f32_16x16x32_bf16 v[4:7], a[208:211], v[232:235], v[4:7]
    v_bfe_u32 v221, s45, v221, 5
    v_fma_f32 v248, v250, s26, v251
    v_mfma_f32_16x16x32_bf16 v[8:11], a[212:215], v[232:235], v[8:11]
    s_add_u32 s19, s43, 393216
    v_mul_u32_u24 v221, 65, v221
    v_fmac_f32 v251, s27, v250
    v_mfma_f32_16x16x32_bf16 v[12:15], a[192:195], v[232:235], v[12:15]
    s_waitcnt lgkmcnt(1)
    v_fma_f32 v250, v249, 2.0, v252
    v_fmac_f32 v252, -2.0, v249
    v_fma_f32 v249, v196, s24, v200
    v_mfma_f32_16x16x32_bf16 v[12:15], a[204:207], v[236:239], v[12:15]
    buffer_load_dwordx4 a[248:251], v254, s[8:11], s42 offen offset:2048 sc1
    v_mfma_f32_16x16x32_bf16 v[16:19], a[208:211], v[236:239], v[16:19]
    s_add_u32 s20, s43, 589824
    v_sub_u32 v221, v221, v220
    v_fmac_f32 v200, -4.0, v196
    v_fma_f32 v196, v194, s24, v198
    v_mfma_f32_16x16x32_bf16 v[16:19], a[196:199], v[232:235], v[16:19]
    s_mov_b32 s42, 706560
    v_fmac_f32 v198, -4.0, v194
    v_fma_f32 v194, v198, s26, v200
    v_mfma_f32_16x16x32_bf16 v[20:23], a[200:203], v[232:235], v[20:23]
    ds_read_b128 v[232:235], v253 offset:4160
    v_lshl_add_u32 v220, v221, 5, v253
    v_fmac_f32 v200, s27, v198
    v_mfma_f32_16x16x32_bf16 v[20:23], a[212:215], v[236:239], v[20:23]
    buffer_load_dwordx4 a[252:255], v254, s[8:11], s42 offen offset:0 sc1
    s_waitcnt vmcnt(13)
    v_mfma_f32_16x16x32_bf16 v[0:3], a[216:219], v[236:239], v[0:3]
    s_add_u32 s21, s43, 786432
    v_fma_f32 v198, v196, 2.0, v249
    v_fmac_f32 v249, -2.0, v196
    v_mfma_f32_16x16x32_bf16 v[4:7], a[220:223], v[236:239], v[4:7]
    s_waitcnt lgkmcnt(1)
    v_cvt_pk_bf16_f32 v194, v248, v194
    v_cvt_pk_bf16_f32 v200, v251, v200
    v_mfma_f32_16x16x32_bf16 v[8:11], a[224:227], v[236:239], v[8:11]
    s_add_u32 s100, s43, s101
    v_cvt_pk_bf16_f32 v198, v250, v198
    v_cvt_pk_bf16_f32 v196, v252, v249
    v_mfma_f32_16x16x32_bf16 v[24:27], a[192:195], v[236:239], v[24:27]
    buffer_load_dwordx4 v[240:243], v254, s[8:11], s42 offen offset:1024 sc1
    v_lshlrev_b32 v248, 16, v195
    v_mfma_f32_16x16x32_bf16 v[24:27], a[204:207], v[228:231], v[24:27]
    s_mov_b64 exec, s[46:47]
    ds_write_b128 v220, v[216:219] offset:1024
    s_mov_b64 exec, -1
    v_mfma_f32_16x16x32_bf16 v[28:31], a[208:211], v[228:231], v[28:31]
    v_lshlrev_b32 v249, 16, v197
    v_lshlrev_b32 v250, 16, v199
    v_lshlrev_b32 v251, 16, v201
    v_mfma_f32_16x16x32_bf16 v[28:31], a[196:199], v[236:239], v[28:31]
    buffer_load_dwordx4 v[244:247], v254, s[8:11], s42 offen offset:2048 sc1
    v_mfma_f32_16x16x32_bf16 v[32:35], a[200:203], v[236:239], v[32:35]
    ds_read_b128 v[236:239], v253 offset:5984
    v_and_b32 v224, 0x1f0, v254
    v_and_b32 v195, s22, v195
    v_mfma_f32_16x16x32_bf16 v[32:35], a[212:215], v[228:231], v[32:35]
    v_mul_u32_u24 v224, 96, v224
    v_and_b32 v197, s22, v197
    v_mfma_f32_16x16x32_bf16 v[12:15], a[216:219], v[228:231], v[12:15]
    buffer_load_dword v224, v224, s[4:7], s100 offen offset:0
    v_and_b32 v199, s22, v199
    v_mfma_f32_16x16x32_bf16 v[16:19], a[220:223], v[228:231], v[16:19]
    v_and_b32 v227, 0xf0, v254
    v_lshrrev_b32 v227, 1, v227
    v_mfma_f32_16x16x32_bf16 v[20:23], a[224:227], v[228:231], v[20:23]
    v_add_u32 v227, s52, v227
    v_mov_b32 v226, s54
    v_and_b32 v201, s22, v201
    v_mfma_f32_16x16x32_bf16 v[36:39], a[192:195], v[228:231], v[36:39]
    s_waitcnt lgkmcnt(2)
    v_mov_b32 v225, s55
    v_cndmask_b32 v226, v226, v225, s[56:57]
    v_mfma_f32_16x16x32_bf16 v[36:39], a[204:207], v[232:235], v[36:39]
    v_add_u32 v227, v227, v226
    s_sub_u32 s45, s16, s50
    v_mfma_f32_16x16x32_bf16 v[40:43], a[208:211], v[232:235], v[40:43]
    buffer_load_dwordx2 v[216:217], v227, s[4:7], s45 offen
    v_lshlrev_b32 v252, 16, v193
    v_mfma_f32_16x16x32_bf16 v[40:43], a[196:199], v[228:231], v[40:43]
    s_sub_u32 s45, s17, s50
    v_and_b32 v193, s22, v193
    v_fmac_f32 v252, s25, v251
    v_mfma_f32_16x16x32_bf16 v[44:47], a[200:203], v[228:231], v[44:47]
    ds_read_b128 v[228:231], v253 offset:5728
    v_fmac_f32 v193, s25, v201
    v_fmac_f32 v252, s28, v249
    v_mfma_f32_16x16x32_bf16 v[44:47], a[212:215], v[232:235], v[44:47]
    v_fmac_f32 v193, s28, v197
    v_cvt_pk_bf16_f32 v193, v252, v193
    v_mfma_f32_16x16x32_bf16 v[24:27], a[216:219], v[232:235], v[24:27]
    v_lshlrev_b32 v252, 16, v203
    v_and_b32 v203, s22, v203
    v_fmac_f32 v252, s29, v248
    v_mfma_f32_16x16x32_bf16 v[28:31], a[220:223], v[232:235], v[28:31]
    buffer_load_dwordx2 v[218:219], v227, s[4:7], s45 offen
    v_mfma_f32_16x16x32_bf16 v[32:35], a[224:227], v[232:235], v[32:35]
    s_sub_u32 s45, s18, s50
    v_fmac_f32 v203, s29, v195
    v_fmac_f32 v252, s23, v250
    v_fmac_f32 v203, s23, v199
    v_mfma_f32_16x16x32_bf16 v[48:51], a[192:195], v[232:235], v[48:51]
    s_waitcnt lgkmcnt(1)
    v_cvt_pk_bf16_f32 v203, v252, v203
    v_fma_f32 v252, v249, s24, v251
    v_mfma_f32_16x16x32_bf16 v[48:51], a[204:207], v[236:239], v[48:51]
    v_fmac_f32 v251, -4.0, v249
    v_fma_f32 v249, v248, s24, v250
    v_mfma_f32_16x16x32_bf16 v[52:55], a[208:211], v[236:239], v[52:55]
    v_fmac_f32 v250, -4.0, v248
    v_fma_f32 v248, v250, s26, v251
    v_fmac_f32 v251, s27, v250
    v_mfma_f32_16x16x32_bf16 v[52:55], a[196:199], v[232:235], v[52:55]
    buffer_load_dwordx2 v[220:221], v227, s[4:7], s45 offen
    v_mfma_f32_16x16x32_bf16 v[56:59], a[200:203], v[232:235], v[56:59]
    ds_read_b128 v[232:235], v253 offset:5472
    s_sub_u32 s45, s19, s50
    v_fma_f32 v250, v249, 2.0, v252
    v_mfma_f32_16x16x32_bf16 v[56:59], a[212:215], v[236:239], v[56:59]
    v_fmac_f32 v252, -2.0, v249
    v_fma_f32 v249, v197, s24, v201
    v_mfma_f32_16x16x32_bf16 v[36:39], a[216:219], v[236:239], v[36:39]
    v_fmac_f32 v201, -4.0, v197
    v_fma_f32 v197, v195, s24, v199
    v_fmac_f32 v199, -4.0, v195
    v_mfma_f32_16x16x32_bf16 v[40:43], a[220:223], v[236:239], v[40:43]
    s_waitcnt lgkmcnt(1)
    v_fma_f32 v195, v199, s26, v201
    v_fmac_f32 v201, s27, v199
    v_mfma_f32_16x16x32_bf16 v[44:47], a[224:227], v[236:239], v[44:47]
    buffer_load_dwordx2 v[222:223], v227, s[4:7], s45 offen
    v_fma_f32 v199, v197, 2.0, v249
    v_mfma_f32_16x16x32_bf16 v[60:63], a[192:195], v[236:239], v[60:63]
    s_sub_u32 s45, s20, s50
    v_fmac_f32 v249, -2.0, v197
    v_cvt_pk_bf16_f32 v195, v248, v195
    v_mfma_f32_16x16x32_bf16 v[60:63], a[204:207], v[228:231], v[60:63]
    v_cvt_pk_bf16_f32 v201, v251, v201
    v_cvt_pk_bf16_f32 v199, v250, v199
    v_cvt_pk_bf16_f32 v197, v252, v249
    v_mfma_f32_16x16x32_bf16 v[64:67], a[208:211], v[228:231], v[64:67]
    v_lshrrev_b32 v252, 15, v255
    v_mfma_f32_16x16x32_bf16 v[64:67], a[196:199], v[236:239], v[64:67]
    ds_write_b64 v252, v[194:195] offset:8576
    v_mfma_f32_16x16x32_bf16 v[68:71], a[200:203], v[236:239], v[68:71]
    ds_read_b128 v[236:239], v253 offset:5216
    s_waitcnt vmcnt(14)
    v_lshlrev_b32 v248, 16, v206
    v_mfma_f32_16x16x32_bf16 v[68:71], a[212:215], v[228:231], v[68:71]
    buffer_load_dwordx2 v[224:225], v227, s[4:7], s45 offen
    v_mfma_f32_16x16x32_bf16 v[48:51], a[216:219], v[228:231], v[48:51]
    s_sub_u32 s45, s21, s50
    v_lshlrev_b32 v249, 16, v208
    v_mfma_f32_16x16x32_bf16 v[52:55], a[220:223], v[228:231], v[52:55]
    ds_write_b64 v252, v[200:201] offset:10656
    v_mfma_f32_16x16x32_bf16 v[56:59], a[224:227], v[228:231], v[56:59]
    s_waitcnt lgkmcnt(3)
    v_lshlrev_b32 v250, 16, v210
    v_lshlrev_b32 v251, 16, v212
    v_mfma_f32_16x16x32_bf16 v[72:75], a[192:195], v[228:231], v[72:75]
    ds_write_b64 v252, v[198:199] offset:12736
    v_mfma_f32_16x16x32_bf16 v[72:75], a[204:207], v[232:235], v[72:75]
    buffer_load_dwordx2 v[226:227], v227, s[4:7], s45 offen
    v_and_b32 v206, s22, v206
    v_mfma_f32_16x16x32_bf16 v[76:79], a[208:211], v[232:235], v[76:79]
    v_and_b32 v208, s22, v208
    v_mfma_f32_16x16x32_bf16 v[76:79], a[196:199], v[228:231], v[76:79]
    ds_write_b64 v252, v[192:193] offset:23136
    v_mfma_f32_16x16x32_bf16 v[80:83], a[200:203], v[228:231], v[80:83]
    ds_read_b128 v[228:231], v253 offset:4944
    v_and_b32 v210, s22, v210
    v_and_b32 v212, s22, v212
    v_mfma_f32_16x16x32_bf16 v[80:83], a[212:215], v[232:235], v[80:83]
    ds_write_b64 v252, v[202:203] offset:31456
    v_mfma_f32_16x16x32_bf16 v[60:63], a[216:219], v[232:235], v[60:63]
    v_mfma_f32_16x16x32_bf16 v[64:67], a[220:223], v[232:235], v[64:67]
    ds_write_b64 v252, v[196:197] offset:256
    v_mfma_f32_16x16x32_bf16 v[68:71], a[224:227], v[232:235], v[68:71]
    s_mov_b32 s42, 737280
    v_mfma_f32_16x16x32_bf16 v[84:87], a[192:195], v[232:235], v[84:87]
    buffer_load_dwordx4 a[192:195], v254, s[8:11], s42 offen offset:0 sc1
    v_mfma_f32_16x16x32_bf16 v[88:91], a[196:199], v[232:235], v[88:91]
    v_lshlrev_b32 v252, 16, v204
    v_and_b32 v204, s22, v204
    v_mfma_f32_16x16x32_bf16 v[92:95], a[200:203], v[232:235], v[92:95]
    s_waitcnt lgkmcnt(6)
    v_fmac_f32 v252, s25, v251
    v_fmac_f32 v204, s25, v212
    v_mfma_f32_16x16x32_bf16 v[84:87], a[204:207], v[236:239], v[84:87]
    ds_read_b128 v[232:235], v253 offset:7280
    v_fmac_f32 v252, s28, v249
    v_mfma_f32_16x16x32_bf16 v[88:91], a[208:211], v[236:239], v[88:91]
    buffer_load_dwordx4 a[196:199], v254, s[8:11], s42 offen offset:1024 sc1
    v_mfma_f32_16x16x32_bf16 v[92:95], a[212:215], v[236:239], v[92:95]
    v_fmac_f32 v204, s28, v208
    v_cvt_pk_bf16_f32 v204, v252, v204
    v_mfma_f32_16x16x32_bf16 v[72:75], a[216:219], v[236:239], v[72:75]
    s_waitcnt lgkmcnt(3)
    v_lshlrev_b32 v252, 16, v214
    v_and_b32 v214, s22, v214
    v_mfma_f32_16x16x32_bf16 v[76:79], a[220:223], v[236:239], v[76:79]
    buffer_load_dwordx4 a[200:203], v254, s[8:11], s42 offen offset:2048 sc1
    v_mfma_f32_16x16x32_bf16 v[80:83], a[224:227], v[236:239], v[80:83]
    ds_read_b128 v[236:239], v253 offset:7008
    v_fmac_f32 v252, s29, v248
    v_mfma_f32_16x16x32_bf16 v[84:87], a[216:219], v[228:231], v[84:87]
    s_mov_b32 s42, 740352
    v_fmac_f32 v214, s29, v206
    v_fmac_f32 v252, s23, v250
    v_mfma_f32_16x16x32_bf16 v[88:91], a[220:223], v[228:231], v[88:91]
    buffer_load_dwordx4 a[204:207], v254, s[8:11], s42 offen offset:0 sc1
    v_mfma_f32_16x16x32_bf16 v[92:95], a[224:227], v[228:231], v[92:95]
    ds_read_b128 v[228:231], v253 offset:6752
    v_fmac_f32 v214, s23, v210
    s_waitcnt vmcnt(17)
    s_waitcnt lgkmcnt(2)
sub19:
    v_mfma_f32_16x16x32_bf16 v[96:99], a[228:231], v[232:235], v[96:99]
    v_cvt_pk_bf16_f32 v214, v252, v214
    v_fma_f32 v252, v249, s24, v251
    v_mfma_f32_16x16x32_bf16 v[100:103], a[232:235], v[232:235], v[100:103]
    s_waitcnt vmcnt(14) lgkmcnt(1)
    v_fmac_f32 v251, -4.0, v249
    v_fma_f32 v249, v248, s24, v250
    v_mfma_f32_16x16x32_bf16 v[104:107], a[236:239], v[232:235], v[104:107]
    ds_read_b128 v[232:235], v253 offset:6496
    v_fmac_f32 v250, -4.0, v248
    v_mfma_f32_16x16x32_bf16 v[96:99], a[240:243], v[236:239], v[96:99]
    buffer_load_dwordx4 a[208:211], v254, s[8:11], s42 offen offset:1024 sc1
    v_mfma_f32_16x16x32_bf16 v[100:103], a[244:247], v[236:239], v[100:103]
    v_fma_f32 v248, v250, s26, v251
    v_fmac_f32 v251, s27, v250
    v_mfma_f32_16x16x32_bf16 v[104:107], a[248:251], v[236:239], v[104:107]
    v_fma_f32 v250, v249, 2.0, v252
    v_fmac_f32 v252, -2.0, v249
    v_mfma_f32_16x16x32_bf16 v[108:111], a[228:231], v[236:239], v[108:111]
    s_waitcnt lgkmcnt(1)
    v_fma_f32 v249, v208, s24, v212
    v_fmac_f32 v212, -4.0, v208
    v_mfma_f32_16x16x32_bf16 v[108:111], a[240:243], v[228:231], v[108:111]
    buffer_load_dwordx4 a[212:215], v254, s[8:11], s42 offen offset:2048 sc1
    v_mfma_f32_16x16x32_bf16 v[112:115], a[244:247], v[228:231], v[112:115]
    v_fma_f32 v208, v206, s24, v210
    v_fmac_f32 v210, -4.0, v206
    v_mfma_f32_16x16x32_bf16 v[112:115], a[232:235], v[236:239], v[112:115]
    s_mov_b32 s42, 743424
    v_fma_f32 v206, v210, s26, v212
    v_fmac_f32 v212, s27, v210
    v_mfma_f32_16x16x32_bf16 v[116:119], a[236:239], v[236:239], v[116:119]
    ds_read_b128 v[236:239], v253 offset:6240
    v_fma_f32 v210, v208, 2.0, v249
    v_mfma_f32_16x16x32_bf16 v[116:119], a[248:251], v[228:231], v[116:119]
    buffer_load_dwordx4 a[216:219], v254, s[8:11], s42 offen offset:0 sc1
    s_waitcnt vmcnt(14)
    v_mfma_f32_16x16x32_bf16 v[96:99], a[252:255], v[228:231], v[96:99]
    v_fmac_f32 v249, -2.0, v208
    v_cvt_pk_bf16_f32 v206, v248, v206
    v_mfma_f32_16x16x32_bf16 v[100:103], v[240:243], v[228:231], v[100:103]
    v_cvt_pk_bf16_f32 v212, v251, v212
    v_cvt_pk_bf16_f32 v210, v250, v210
    v_mfma_f32_16x16x32_bf16 v[104:107], v[244:247], v[228:231], v[104:107]
    s_waitcnt lgkmcnt(1)
    v_cvt_pk_bf16_f32 v208, v252, v249
    v_lshlrev_b32 v248, 16, v207
    v_mfma_f32_16x16x32_bf16 v[120:123], a[228:231], v[228:231], v[120:123]
    buffer_load_dwordx4 a[220:223], v254, s[8:11], s42 offen offset:1024 sc1
    v_mfma_f32_16x16x32_bf16 v[120:123], a[240:243], v[232:235], v[120:123]
    v_lshlrev_b32 v249, 16, v209
    v_lshlrev_b32 v250, 16, v211
    v_mfma_f32_16x16x32_bf16 v[124:127], a[244:247], v[232:235], v[124:127]
    v_lshlrev_b32 v251, 16, v213
    v_and_b32 v207, s22, v207
    v_mfma_f32_16x16x32_bf16 v[124:127], a[232:235], v[228:231], v[124:127]
    buffer_load_dwordx4 a[224:227], v254, s[8:11], s42 offen offset:2048 sc1
    v_mfma_f32_16x16x32_bf16 v[128:131], a[236:239], v[228:231], v[128:131]
    ds_read_b128 v[228:231], v253 offset:8064
    v_and_b32 v209, s22, v209
    v_mfma_f32_16x16x32_bf16 v[128:131], a[248:251], v[232:235], v[128:131]
    v_and_b32 v211, s22, v211
    v_and_b32 v213, s22, v213
    v_mfma_f32_16x16x32_bf16 v[108:111], a[252:255], v[232:235], v[108:111]
    v_lshlrev_b32 v252, 16, v205
    v_and_b32 v205, s22, v205
    v_mfma_f32_16x16x32_bf16 v[112:115], v[240:243], v[232:235], v[112:115]
    v_fmac_f32 v252, s25, v251
    v_fmac_f32 v205, s25, v213
    v_mfma_f32_16x16x32_bf16 v[116:119], v[244:247], v[232:235], v[116:119]
    v_fmac_f32 v252, s28, v249
    v_mfma_f32_16x16x32_bf16 v[132:135], a[228:231], v[232:235], v[132:135]
    s_waitcnt lgkmcnt(1)
    v_fmac_f32 v205, s28, v209
    v_cvt_pk_bf16_f32 v205, v252, v205
    v_mfma_f32_16x16x32_bf16 v[132:135], a[240:243], v[236:239], v[132:135]
    v_lshlrev_b32 v252, 16, v215
    v_mfma_f32_16x16x32_bf16 v[136:139], a[244:247], v[236:239], v[136:139]
    v_and_b32 v215, s22, v215
    v_mfma_f32_16x16x32_bf16 v[136:139], a[232:235], v[232:235], v[136:139]
    v_fmac_f32 v252, s29, v248
    v_mfma_f32_16x16x32_bf16 v[140:143], a[236:239], v[232:235], v[140:143]
    ds_read_b128 v[232:235], v253 offset:7808
    v_fmac_f32 v215, s29, v207
    v_mfma_f32_16x16x32_bf16 v[140:143], a[248:251], v[236:239], v[140:143]
    v_fmac_f32 v252, s23, v250
    v_fmac_f32 v215, s23, v211
    v_mfma_f32_16x16x32_bf16 v[120:123], a[252:255], v[236:239], v[120:123]
    v_cvt_pk_bf16_f32 v215, v252, v215
    v_mfma_f32_16x16x32_bf16 v[124:127], v[240:243], v[236:239], v[124:127]
    v_fma_f32 v252, v249, s24, v251
    v_fmac_f32 v251, -4.0, v249
    v_mfma_f32_16x16x32_bf16 v[128:131], v[244:247], v[236:239], v[128:131]
    v_fma_f32 v249, v248, s24, v250
    v_mfma_f32_16x16x32_bf16 v[144:147], a[228:231], v[236:239], v[144:147]
    s_waitcnt lgkmcnt(1)
    v_fmac_f32 v250, -4.0, v248
    v_mfma_f32_16x16x32_bf16 v[144:147], a[240:243], v[228:231], v[144:147]
    v_fma_f32 v248, v250, s26, v251
    v_fmac_f32 v251, s27, v250
    v_mfma_f32_16x16x32_bf16 v[148:151], a[244:247], v[228:231], v[148:151]
    v_fma_f32 v250, v249, 2.0, v252
    v_mfma_f32_16x16x32_bf16 v[148:151], a[232:235], v[236:239], v[148:151]
    v_fmac_f32 v252, -2.0, v249
    v_mfma_f32_16x16x32_bf16 v[152:155], a[236:239], v[236:239], v[152:155]
    ds_read_b128 v[236:239], v253 offset:7552
    v_fma_f32 v249, v209, s24, v213
    v_mfma_f32_16x16x32_bf16 v[152:155], a[248:251], v[228:231], v[152:155]
    v_fmac_f32 v213, -4.0, v209
    v_fma_f32 v209, v207, s24, v211
    v_mfma_f32_16x16x32_bf16 v[132:135], a[252:255], v[228:231], v[132:135]
    v_fmac_f32 v211, -4.0, v207
    v_mfma_f32_16x16x32_bf16 v[136:139], v[240:243], v[228:231], v[136:139]
    v_fma_f32 v207, v211, s26, v213
    v_mfma_f32_16x16x32_bf16 v[140:143], v[244:247], v[228:231], v[140:143]
    v_fmac_f32 v213, s27, v211
    v_fma_f32 v211, v209, 2.0, v249
    v_mfma_f32_16x16x32_bf16 v[156:159], a[228:231], v[228:231], v[156:159]
    s_waitcnt lgkmcnt(1)
    v_fmac_f32 v249, -2.0, v209
    v_mfma_f32_16x16x32_bf16 v[156:159], a[240:243], v[232:235], v[156:159]
    v_cvt_pk_bf16_f32 v207, v248, v207
    v_mfma_f32_16x16x32_bf16 v[160:163], a[244:247], v[232:235], v[160:163]
    v_cvt_pk_bf16_f32 v213, v251, v213
    v_cvt_pk_bf16_f32 v211, v250, v211
    v_mfma_f32_16x16x32_bf16 v[160:163], a[232:235], v[228:231], v[160:163]
    v_cvt_pk_bf16_f32 v209, v252, v249
    v_mfma_f32_16x16x32_bf16 v[164:167], a[236:239], v[228:231], v[164:167]
    ds_read_b128 v[228:231], v253 offset:7296
    v_lshrrev_b32 v252, 15, v255
    v_mfma_f32_16x16x32_bf16 v[164:167], a[248:251], v[232:235], v[164:167]
    ds_write_b64 v252, v[206:207] offset:8320
    v_mfma_f32_16x16x32_bf16 v[144:147], a[252:255], v[232:235], v[144:147]
    v_mfma_f32_16x16x32_bf16 v[148:151], v[240:243], v[232:235], v[148:151]
    ds_write_b64 v252, v[212:213] offset:10400
    v_mfma_f32_16x16x32_bf16 v[152:155], v[244:247], v[232:235], v[152:155]
    s_waitcnt lgkmcnt(3)
    v_mfma_f32_16x16x32_bf16 v[168:171], a[228:231], v[232:235], v[168:171]
    ds_write_b64 v252, v[210:211] offset:12480
    v_mfma_f32_16x16x32_bf16 v[168:171], a[240:243], v[236:239], v[168:171]
    v_mfma_f32_16x16x32_bf16 v[172:175], a[244:247], v[236:239], v[172:175]
    ds_write_b64 v252, v[204:205] offset:22880
    v_mfma_f32_16x16x32_bf16 v[172:175], a[232:235], v[232:235], v[172:175]
    v_mfma_f32_16x16x32_bf16 v[176:179], a[236:239], v[232:235], v[176:179]
    ds_read_b128 v[232:235], v253 offset:7024
    v_mfma_f32_16x16x32_bf16 v[176:179], a[248:251], v[236:239], v[176:179]
    ds_write_b64 v252, v[214:215] offset:31200
    v_mfma_f32_16x16x32_bf16 v[156:159], a[252:255], v[236:239], v[156:159]
    s_waitcnt lgkmcnt(6)
    v_mfma_f32_16x16x32_bf16 v[160:163], v[240:243], v[236:239], v[160:163]
    ds_write_b64 v252, v[208:209] offset:0
    v_mfma_f32_16x16x32_bf16 v[164:167], v[244:247], v[236:239], v[164:167]
    s_mov_b32 s42, 774144
    v_mfma_f32_16x16x32_bf16 v[180:183], a[228:231], v[236:239], v[180:183]
    buffer_load_dwordx4 a[228:231], v254, s[8:11], s42 offen offset:0 sc1
    v_mfma_f32_16x16x32_bf16 v[184:187], a[232:235], v[236:239], v[184:187]
    s_waitcnt lgkmcnt(0)
    v_mfma_f32_16x16x32_bf16 v[188:191], a[236:239], v[236:239], v[188:191]
    s_barrier
    v_mfma_f32_16x16x32_bf16 v[180:183], a[240:243], v[228:231], v[180:183]
    ds_read_b128 v[236:239], v253 offset:9360
    s_waitcnt vmcnt(10)
    v_mfma_f32_16x16x32_bf16 v[184:187], a[244:247], v[228:231], v[184:187]
    buffer_load_dwordx4 a[232:235], v254, s[8:11], s42 offen offset:1024 sc1
    v_mfma_f32_16x16x32_bf16 v[188:191], a[248:251], v[228:231], v[188:191]
    v_lshlrev_b32 v248, 16, v218
    v_lshlrev_b32 v249, 16, v220
    v_mfma_f32_16x16x32_bf16 v[168:171], a[252:255], v[228:231], v[168:171]
    v_lshlrev_b32 v250, 16, v222
    v_lshlrev_b32 v251, 16, v224
    v_mfma_f32_16x16x32_bf16 v[172:175], v[240:243], v[228:231], v[172:175]
    buffer_load_dwordx4 a[236:239], v254, s[8:11], s42 offen offset:2048 sc1
    v_mfma_f32_16x16x32_bf16 v[176:179], v[244:247], v[228:231], v[176:179]
    ds_read_b128 v[228:231], v253 offset:9088
    v_and_b32 v218, s22, v218
    v_mfma_f32_16x16x32_bf16 v[180:183], a[252:255], v[232:235], v[180:183]
    s_mov_b32 s42, 777216
    v_and_b32 v220, s22, v220
    v_and_b32 v222, s22, v222
    v_mfma_f32_16x16x32_bf16 v[184:187], v[240:243], v[232:235], v[184:187]
    buffer_load_dwordx4 a[240:243], v254, s[8:11], s42 offen offset:0 sc1
    v_mfma_f32_16x16x32_bf16 v[188:191], v[244:247], v[232:235], v[188:191]
    ds_read_b128 v[232:235], v253 offset:8832
    v_and_b32 v224, s22, v224
    v_lshlrev_b32 v252, 16, v216
    s_waitcnt vmcnt(10)
    s_waitcnt lgkmcnt(2)
sub20:
    v_mfma_f32_16x16x32_bf16 a[0:3], a[192:195], v[236:239], a[0:3]
    v_and_b32 v216, s22, v216
    v_fmac_f32 v252, s25, v251
    v_mfma_f32_16x16x32_bf16 a[4:7], a[196:199], v[236:239], a[4:7]
    s_waitcnt vmcnt(7) lgkmcnt(1)
    v_fmac_f32 v216, s25, v224
    v_fmac_f32 v252, s28, v249
    v_mfma_f32_16x16x32_bf16 a[8:11], a[200:203], v[236:239], a[8:11]
    ds_read_b128 v[236:239], v253 offset:8576
    v_fmac_f32 v216, s28, v220
    v_mfma_f32_16x16x32_bf16 a[0:3], a[204:207], v[228:231], a[0:3]
    buffer_load_dwordx4 a[244:247], v254, s[8:11], s42 offen offset:1024 sc1
    v_mfma_f32_16x16x32_bf16 a[4:7], a[208:211], v[228:231], a[4:7]
    v_cvt_pk_bf16_f32 v216, v252, v216
    v_lshlrev_b32 v252, 16, v226
    v_mfma_f32_16x16x32_bf16 a[8:11], a[212:215], v[228:231], a[8:11]
    v_and_b32 v226, s22, v226
    v_fmac_f32 v252, s29, v248
    v_mfma_f32_16x16x32_bf16 a[12:15], a[192:195], v[228:231], a[12:15]
    s_waitcnt lgkmcnt(1)
    v_fmac_f32 v226, s29, v218
    v_fmac_f32 v252, s23, v250
    v_mfma_f32_16x16x32_bf16 a[12:15], a[204:207], v[232:235], a[12:15]
    buffer_load_dwordx4 a[248:251], v254, s[8:11], s42 offen offset:2048 sc1
    v_mfma_f32_16x16x32_bf16 a[16:19], a[208:211], v[232:235], a[16:19]
    v_fmac_f32 v226, s23, v222
    v_cvt_pk_bf16_f32 v226, v252, v226
    v_mfma_f32_16x16x32_bf16 a[16:19], a[196:199], v[228:231], a[16:19]
    s_mov_b32 s42, 780288
    v_fma_f32 v252, v249, s24, v251
    v_fmac_f32 v251, -4.0, v249
    v_fma_f32 v249, v248, s24, v250
    v_mfma_f32_16x16x32_bf16 a[20:23], a[200:203], v[228:231], a[20:23]
    ds_read_b128 v[228:231], v253 offset:8320
    v_fmac_f32 v250, -4.0, v248
    v_mfma_f32_16x16x32_bf16 a[20:23], a[212:215], v[232:235], a[20:23]
    buffer_load_dwordx4 a[252:255], v254, s[8:11], s42 offen offset:0 sc1
    s_waitcnt vmcnt(7)
    v_mfma_f32_16x16x32_bf16 a[0:3], a[216:219], v[232:235], a[0:3]
    v_fma_f32 v248, v250, s26, v251
    v_fmac_f32 v251, s27, v250
    v_mfma_f32_16x16x32_bf16 a[4:7], a[220:223], v[232:235], a[4:7]
    v_fma_f32 v250, v249, 2.0, v252
    v_fmac_f32 v252, -2.0, v249
    v_mfma_f32_16x16x32_bf16 a[8:11], a[224:227], v[232:235], a[8:11]
    s_waitcnt lgkmcnt(1)
    v_fma_f32 v249, v220, s24, v224
    v_fmac_f32 v224, -4.0, v220
    v_mfma_f32_16x16x32_bf16 a[24:27], a[192:195], v[232:235], a[24:27]
    buffer_load_dwordx4 v[240:243], v254, s[8:11], s42 offen offset:1024 sc1
    v_mfma_f32_16x16x32_bf16 a[24:27], a[204:207], v[236:239], a[24:27]
    v_fma_f32 v220, v218, s24, v222
    v_fmac_f32 v222, -4.0, v218
    v_mfma_f32_16x16x32_bf16 a[28:31], a[208:211], v[236:239], a[28:31]
    v_fma_f32 v218, v222, s26, v224
    v_fmac_f32 v224, s27, v222
    v_mfma_f32_16x16x32_bf16 a[28:31], a[196:199], v[232:235], a[28:31]
    buffer_load_dwordx4 v[244:247], v254, s[8:11], s42 offen offset:2048 sc1
    v_mfma_f32_16x16x32_bf16 a[32:35], a[200:203], v[232:235], a[32:35]
    ds_read_b128 v[232:235], v253 offset:10144
    v_and_b32 v192, 0x1f0, v254
    v_fma_f32 v222, v220, 2.0, v249
    v_mfma_f32_16x16x32_bf16 a[32:35], a[212:215], v[236:239], a[32:35]
    v_mul_u32_u24 v192, 96, v192
    v_fmac_f32 v249, -2.0, v220
    v_mfma_f32_16x16x32_bf16 a[12:15], a[216:219], v[236:239], a[12:15]
    buffer_load_dword v192, v192, s[4:7], s100 offen offset:384
    v_mfma_f32_16x16x32_bf16 a[16:19], a[220:223], v[236:239], a[16:19]
    v_cvt_pk_bf16_f32 v218, v248, v218
    v_cvt_pk_bf16_f32 v224, v251, v224
    v_mfma_f32_16x16x32_bf16 a[20:23], a[224:227], v[236:239], a[20:23]
pad7:
    s_cbranch_vccnz pad11
    v_cvt_pk_bf16_f32 v222, v250, v222
    v_cvt_pk_bf16_f32 v220, v252, v249
    v_mfma_f32_16x16x32_bf16 a[36:39], a[192:195], v[236:239], a[36:39]
    s_waitcnt lgkmcnt(1)
    v_lshlrev_b32 v248, 16, v219
    v_lshlrev_b32 v249, 16, v221
    v_mfma_f32_16x16x32_bf16 a[36:39], a[204:207], v[228:231], a[36:39]
    v_lshlrev_b32 v250, 16, v223
    v_lshlrev_b32 v251, 16, v225
    v_mfma_f32_16x16x32_bf16 a[40:43], a[208:211], v[228:231], a[40:43]
    v_and_b32 v219, s22, v219
    v_and_b32 v221, s22, v221
    v_mfma_f32_16x16x32_bf16 a[40:43], a[196:199], v[236:239], a[40:43]
    v_and_b32 v223, s22, v223
    v_and_b32 v225, s22, v225
    v_mfma_f32_16x16x32_bf16 a[44:47], a[200:203], v[236:239], a[44:47]
    ds_read_b128 v[236:239], v253 offset:9888
    v_lshlrev_b32 v252, 16, v217
    v_mfma_f32_16x16x32_bf16 a[44:47], a[212:215], v[228:231], a[44:47]
    v_and_b32 v217, s22, v217
    v_fmac_f32 v252, s25, v251
    v_fmac_f32 v217, s25, v225
    v_mfma_f32_16x16x32_bf16 a[24:27], a[216:219], v[228:231], a[24:27]
    v_fmac_f32 v252, s28, v249
    v_fmac_f32 v217, s28, v221
    v_mfma_f32_16x16x32_bf16 a[28:31], a[220:223], v[228:231], a[28:31]
    v_cvt_pk_bf16_f32 v217, v252, v217
    v_lshlrev_b32 v252, 16, v227
    v_mfma_f32_16x16x32_bf16 a[32:35], a[224:227], v[228:231], a[32:35]
    v_and_b32 v227, s22, v227
    v_fmac_f32 v252, s29, v248
    v_mfma_f32_16x16x32_bf16 a[48:51], a[192:195], v[228:231], a[48:51]
    s_waitcnt lgkmcnt(1)
    v_fmac_f32 v227, s29, v219
    v_fmac_f32 v252, s23, v250
    v_mfma_f32_16x16x32_bf16 a[48:51], a[204:207], v[232:235], a[48:51]
    v_fmac_f32 v227, s23, v223
    v_cvt_pk_bf16_f32 v227, v252, v227
    v_mfma_f32_16x16x32_bf16 a[52:55], a[208:211], v[232:235], a[52:55]
    v_fma_f32 v252, v249, s24, v251
    v_fmac_f32 v251, -4.0, v249
    v_mfma_f32_16x16x32_bf16 a[52:55], a[196:199], v[228:231], a[52:55]
    v_fma_f32 v249, v248, s24, v250
    v_fmac_f32 v250, -4.0, v248
    v_mfma_f32_16x16x32_bf16 a[56:59], a[200:203], v[228:231], a[56:59]
    ds_read_b128 v[228:231], v253 offset:9632
    v_fma_f32 v248, v250, s26, v251
    v_mfma_f32_16x16x32_bf16 a[56:59], a[212:215], v[232:235], a[56:59]
    v_fmac_f32 v251, s27, v250
    v_fma_f32 v250, v249, 2.0, v252
    v_mfma_f32_16x16x32_bf16 a[36:39], a[216:219], v[232:235], a[36:39]
    v_fmac_f32 v252, -2.0, v249
    v_fma_f32 v249, v221, s24, v225
    v_fmac_f32 v225, -4.0, v221
    v_mfma_f32_16x16x32_bf16 a[40:43], a[220:223], v[232:235], a[40:43]
    v_fma_f32 v221, v219, s24, v223
    v_fmac_f32 v223, -4.0, v219
    v_mfma_f32_16x16x32_bf16 a[44:47], a[224:227], v[232:235], a[44:47]
    v_fma_f32 v219, v223, s26, v225
    v_fmac_f32 v225, s27, v223
    v_mfma_f32_16x16x32_bf16 a[60:63], a[192:195], v[232:235], a[60:63]
    s_waitcnt lgkmcnt(1)
    v_fma_f32 v223, v221, 2.0, v249
    v_fmac_f32 v249, -2.0, v221
    v_mfma_f32_16x16x32_bf16 a[60:63], a[204:207], v[236:239], a[60:63]
    v_cvt_pk_bf16_f32 v219, v248, v219
    v_cvt_pk_bf16_f32 v225, v251, v225
    v_mfma_f32_16x16x32_bf16 a[64:67], a[208:211], v[236:239], a[64:67]
    v_cvt_pk_bf16_f32 v223, v250, v223
    v_cvt_pk_bf16_f32 v221, v252, v249
    v_mfma_f32_16x16x32_bf16 a[64:67], a[196:199], v[232:235], a[64:67]
    v_and_b32 v248, 0xf0, v254
    v_lshrrev_b32 v248, 1, v248
    v_mfma_f32_16x16x32_bf16 a[68:71], a[200:203], v[232:235], a[68:71]
    ds_read_b128 v[232:235], v253 offset:9376
    v_add_u32 v248, s52, v248
    v_mfma_f32_16x16x32_bf16 a[68:71], a[212:215], v[236:239], a[68:71]
    v_and_b32 v252, 8, v248
    v_lshrrev_b32 v249, 6, v248
    v_mfma_f32_16x16x32_bf16 a[48:51], a[216:219], v[236:239], a[48:51]
    v_mul_u32_u24 v249, 192, v249
    v_add_u32 v252, v252, v249
    v_mfma_f32_16x16x32_bf16 a[52:55], a[220:223], v[236:239], a[52:55]
    v_bfe_u32 v249, v248, 4, 2
    v_mul_u32_u24 v249, 40704, v249
    v_add_u32 v252, v252, v249
    v_mfma_f32_16x16x32_bf16 a[56:59], a[224:227], v[236:239], a[56:59]
    v_and_b32 v249, 32, v248
    v_lshl_add_u32 v252, v249, 1, v252
    v_mfma_f32_16x16x32_bf16 a[72:75], a[192:195], v[236:239], a[72:75]
    s_waitcnt lgkmcnt(1)
    v_bfe_u32 v249, v254, 8, 1
    v_lshl_add_u32 v252, v249, 4, v252
    v_mfma_f32_16x16x32_bf16 a[72:75], a[204:207], v[228:231], a[72:75]
    v_mov_b32 v249, 123328
    v_cndmask_b32 v252, v249, v252, s[58:59]
    v_mfma_f32_16x16x32_bf16 a[76:79], a[208:211], v[228:231], a[76:79]
    ds_write_b64 v252, v[216:217] offset:39520
    v_mfma_f32_16x16x32_bf16 a[76:79], a[196:199], v[236:239], a[76:79]
    v_mfma_f32_16x16x32_bf16 a[80:83], a[200:203], v[236:239], a[80:83]
    ds_read_b128 v[236:239], v253 offset:9104
    v_mfma_f32_16x16x32_bf16 a[80:83], a[212:215], v[228:231], a[80:83]
    ds_write_b64 v252, v[218:219] offset:39552
    v_mfma_f32_16x16x32_bf16 a[60:63], a[216:219], v[228:231], a[60:63]
    v_mfma_f32_16x16x32_bf16 a[64:67], a[220:223], v[228:231], a[64:67]
    ds_write_b64 v252, v[224:225] offset:39584
    v_mfma_f32_16x16x32_bf16 a[68:71], a[224:227], v[228:231], a[68:71]
    s_mov_b32 s42, 811008
    v_mfma_f32_16x16x32_bf16 a[84:87], a[192:195], v[228:231], a[84:87]
    buffer_load_dwordx4 a[192:195], v254, s[8:11], s42 offen offset:0 sc1
    v_mfma_f32_16x16x32_bf16 a[88:91], a[196:199], v[228:231], a[88:91]
    ds_write_b64 v252, v[222:223] offset:39616
    v_mfma_f32_16x16x32_bf16 a[92:95], a[200:203], v[228:231], a[92:95]
    s_waitcnt lgkmcnt(5)
    v_mfma_f32_16x16x32_bf16 a[84:87], a[204:207], v[232:235], a[84:87]
    ds_read_b128 v[228:231], v253 offset:11440
    v_mfma_f32_16x16x32_bf16 a[88:91], a[208:211], v[232:235], a[88:91]
    buffer_load_dwordx4 a[196:199], v254, s[8:11], s42 offen offset:1024 sc1
    v_mfma_f32_16x16x32_bf16 a[92:95], a[212:215], v[232:235], a[92:95]
    ds_write_b64 v252, v[220:221] offset:39648
    v_mfma_f32_16x16x32_bf16 a[72:75], a[216:219], v[232:235], a[72:75]
    s_waitcnt lgkmcnt(5)
    v_mfma_f32_16x16x32_bf16 a[76:79], a[220:223], v[232:235], a[76:79]
    buffer_load_dwordx4 a[200:203], v254, s[8:11], s42 offen offset:2048 sc1
    v_mfma_f32_16x16x32_bf16 a[80:83], a[224:227], v[232:235], a[80:83]
    ds_read_b128 v[232:235], v253 offset:11168
    v_mfma_f32_16x16x32_bf16 a[84:87], a[216:219], v[236:239], a[84:87]
    s_mov_b32 s42, 814080
    v_mfma_f32_16x16x32_bf16 a[88:91], a[220:223], v[236:239], a[88:91]
    buffer_load_dwordx4 a[204:207], v254, s[8:11], s42 offen offset:0 sc1
    v_mfma_f32_16x16x32_bf16 a[92:95], a[224:227], v[236:239], a[92:95]
    ds_read_b128 v[236:239], v253 offset:10912
    s_waitcnt vmcnt(11)
    s_waitcnt lgkmcnt(3)
sub21:
    v_mfma_f32_16x16x32_bf16 a[96:99], a[228:231], v[228:231], a[96:99]
    ds_write_b64 v252, v[226:227] offset:39680
    v_mfma_f32_16x16x32_bf16 a[100:103], a[232:235], v[228:231], a[100:103]
    s_waitcnt vmcnt(8) lgkmcnt(2)
    v_mfma_f32_16x16x32_bf16 a[104:107], a[236:239], v[228:231], a[104:107]
    ds_read_b128 v[228:231], v253 offset:10656
    v_bfe_u32 v251, v254, 6, 2
    v_mfma_f32_16x16x32_bf16 a[96:99], a[240:243], v[232:235], a[96:99]
    buffer_load_dwordx4 a[208:211], v254, s[8:11], s42 offen offset:1024 sc1
    v_mfma_f32_16x16x32_bf16 a[100:103], a[244:247], v[232:235], a[100:103]
    v_mul_u32_u24 v248, 40704, v251
    v_and_b32 v251, 0x80, v254
    v_mfma_f32_16x16x32_bf16 a[104:107], a[248:251], v[232:235], a[104:107]
    v_lshrrev_b32 v251, 1, v251
    v_add_u32 v248, v248, v251
    v_mfma_f32_16x16x32_bf16 a[108:111], a[228:231], v[232:235], a[108:111]
    s_waitcnt lgkmcnt(2)
    v_and_b32 v251, 0x40, v254
    v_lshrrev_b32 v251, 2, v251
    v_mfma_f32_16x16x32_bf16 a[108:111], a[240:243], v[236:239], a[108:111]
    buffer_load_dwordx4 a[212:215], v254, s[8:11], s42 offen offset:2048 sc1
    v_mfma_f32_16x16x32_bf16 a[112:115], a[244:247], v[236:239], a[112:115]
    v_add_u32 v248, v248, v251
    v_bfe_u32 v251, v254, 4, 2
    v_mfma_f32_16x16x32_bf16 a[112:115], a[232:235], v[232:235], a[112:115]
    s_mov_b32 s42, 817152
    v_mul_u32_u24 v251, 3104, v251
    v_add_u32 v248, v248, v251
    v_mfma_f32_16x16x32_bf16 a[116:119], a[236:239], v[232:235], a[116:119]
    ds_read_b128 v[232:235], v253 offset:10400
    v_add_u32 v248, s52, v248
    v_mfma_f32_16x16x32_bf16 a[116:119], a[248:251], v[236:239], a[116:119]
    buffer_load_dwordx4 a[216:219], v254, s[8:11], s42 offen offset:0 sc1
    s_waitcnt vmcnt(8)
    v_mfma_f32_16x16x32_bf16 a[96:99], a[252:255], v[236:239], a[96:99]
    v_lshrrev_b32 v251, 8, v254
    v_lshl_add_u32 v249, v251, 3, v248
    v_mfma_f32_16x16x32_bf16 a[100:103], v[240:243], v[236:239], a[100:103]
    v_lshl_add_u32 v248, v251, 4, v248
    v_add_u32 v250, s51, v254
    v_mfma_f32_16x16x32_bf16 a[104:107], v[244:247], v[236:239], a[104:107]
    s_waitcnt lgkmcnt(1)
    v_accvgpr_read_b32 v204, a0
    v_accvgpr_read_b32 v205, a1
    v_mfma_f32_16x16x32_bf16 a[120:123], a[228:231], v[236:239], a[120:123]
    buffer_load_dwordx4 a[220:223], v254, s[8:11], s42 offen offset:1024 sc1
    v_mfma_f32_16x16x32_bf16 a[120:123], a[240:243], v[228:231], a[120:123]
    v_accvgpr_read_b32 v206, a2
    v_accvgpr_read_b32 v207, a3
    v_mfma_f32_16x16x32_bf16 a[124:127], a[244:247], v[228:231], a[124:127]
    v_mfma_f32_16x16x32_bf16 a[124:127], a[232:235], v[236:239], a[124:127]
    buffer_load_dwordx4 a[224:227], v254, s[8:11], s42 offen offset:2048 sc1
    v_mfma_f32_16x16x32_bf16 a[128:131], a[236:239], v[236:239], a[128:131]
    ds_read_b128 v[236:239], v253 offset:12224
    v_and_b32 v193, 0x1f0, v254
    v_mfma_f32_16x16x32_bf16 a[128:131], a[248:251], v[228:231], a[128:131]
    v_mul_u32_u24 v193, 96, v193
    v_accvgpr_read_b32 v208, a96
    v_mfma_f32_16x16x32_bf16 a[108:111], a[252:255], v[228:231], a[108:111]
    buffer_load_dword v193, v193, s[4:7], s100 offen offset:768
    v_mfma_f32_16x16x32_bf16 a[112:115], v[240:243], v[228:231], a[112:115]
    v_accvgpr_read_b32 v209, a97
    v_accvgpr_read_b32 v210, a98
    v_mfma_f32_16x16x32_bf16 a[116:119], v[244:247], v[228:231], a[116:119]
    v_accvgpr_read_b32 v211, a99
    v_add_f32 v212, v204, v208
    v_mfma_f32_16x16x32_bf16 a[132:135], a[228:231], v[228:231], a[132:135]
    s_waitcnt lgkmcnt(1)
    v_add_f32 v213, v205, v209
    v_add_f32 v214, v206, v210
    v_mfma_f32_16x16x32_bf16 a[132:135], a[240:243], v[232:235], a[132:135]
    v_add_f32 v215, v207, v211
    v_sub_f32 v204, v204, v208
    v_mfma_f32_16x16x32_bf16 a[136:139], a[244:247], v[232:235], a[136:139]
    v_sub_f32 v205, v205, v209
    v_sub_f32 v206, v206, v210
    v_mfma_f32_16x16x32_bf16 a[136:139], a[232:235], v[228:231], a[136:139]
    v_sub_f32 v207, v207, v211
    v_accvgpr_write_b32 a0, v212
    v_mfma_f32_16x16x32_bf16 a[140:143], a[236:239], v[228:231], a[140:143]
    ds_read_b128 v[228:231], v253 offset:11968
    v_accvgpr_write_b32 a1, v213
    v_mfma_f32_16x16x32_bf16 a[140:143], a[248:251], v[232:235], a[140:143]
    v_accvgpr_write_b32 a2, v214
    v_accvgpr_write_b32 a3, v215
    v_mfma_f32_16x16x32_bf16 a[120:123], a[252:255], v[232:235], a[120:123]
    v_accvgpr_write_b32 a96, v204
    v_accvgpr_write_b32 a97, v205
    v_mfma_f32_16x16x32_bf16 a[124:127], v[240:243], v[232:235], a[124:127]
    v_accvgpr_write_b32 a98, v206
    v_accvgpr_write_b32 a99, v207
    v_mfma_f32_16x16x32_bf16 a[128:131], v[244:247], v[232:235], a[128:131]
    v_accvgpr_read_b32 v204, a4
    v_accvgpr_read_b32 v205, a5
    v_mfma_f32_16x16x32_bf16 a[144:147], a[228:231], v[232:235], a[144:147]
    s_waitcnt lgkmcnt(1)
    v_accvgpr_read_b32 v206, a6
    v_accvgpr_read_b32 v207, a7
    v_mfma_f32_16x16x32_bf16 a[144:147], a[240:243], v[236:239], a[144:147]
    v_accvgpr_read_b32 v208, a100
    v_accvgpr_read_b32 v209, a101
    v_mfma_f32_16x16x32_bf16 a[148:151], a[244:247], v[236:239], a[148:151]
    v_accvgpr_read_b32 v210, a102
    v_accvgpr_read_b32 v211, a103
    v_mfma_f32_16x16x32_bf16 a[148:151], a[232:235], v[232:235], a[148:151]
    v_add_f32 v212, v204, v208
    v_add_f32 v213, v205, v209
    v_mfma_f32_16x16x32_bf16 a[152:155], a[236:239], v[232:235], a[152:155]
    ds_read_b128 v[232:235], v253 offset:11712
    v_add_f32 v214, v206, v210
    v_mfma_f32_16x16x32_bf16 a[152:155], a[248:251], v[236:239], a[152:155]
    v_add_f32 v215, v207, v211
    v_sub_f32 v204, v204, v208
    v_mfma_f32_16x16x32_bf16 a[132:135], a[252:255], v[236:239], a[132:135]
    v_sub_f32 v205, v205, v209
    v_sub_f32 v206, v206, v210
    v_mfma_f32_16x16x32_bf16 a[136:139], v[240:243], v[236:239], a[136:139]
    v_sub_f32 v207, v207, v211
    v_accvgpr_write_b32 a4, v212
    v_mfma_f32_16x16x32_bf16 a[140:143], v[244:247], v[236:239], a[140:143]
    v_accvgpr_write_b32 a5, v213
    v_accvgpr_write_b32 a6, v214
    v_mfma_f32_16x16x32_bf16 a[156:159], a[228:231], v[236:239], a[156:159]
    s_waitcnt lgkmcnt(1)
    v_accvgpr_write_b32 a7, v215
    v_accvgpr_write_b32 a100, v204
    v_mfma_f32_16x16x32_bf16 a[156:159], a[240:243], v[228:231], a[156:159]
    v_accvgpr_write_b32 a101, v205
    v_accvgpr_write_b32 a102, v206
    v_mfma_f32_16x16x32_bf16 a[160:163], a[244:247], v[228:231], a[160:163]
    v_accvgpr_write_b32 a103, v207
    v_accvgpr_read_b32 v204, a8
    v_mfma_f32_16x16x32_bf16 a[160:163], a[232:235], v[236:239], a[160:163]
    v_accvgpr_read_b32 v205, a9
    v_accvgpr_read_b32 v206, a10
    v_mfma_f32_16x16x32_bf16 a[164:167], a[236:239], v[236:239], a[164:167]
    ds_read_b128 v[236:239], v253 offset:11456
    v_accvgpr_read_b32 v207, a11
    v_mfma_f32_16x16x32_bf16 a[164:167], a[248:251], v[228:231], a[164:167]
    v_accvgpr_read_b32 v208, a104
    v_accvgpr_read_b32 v209, a105
    v_mfma_f32_16x16x32_bf16 a[144:147], a[252:255], v[228:231], a[144:147]
    v_accvgpr_read_b32 v210, a106
    v_accvgpr_read_b32 v211, a107
    v_mfma_f32_16x16x32_bf16 a[148:151], v[240:243], v[228:231], a[148:151]
    v_add_f32 v212, v204, v208
    v_add_f32 v213, v205, v209
    v_mfma_f32_16x16x32_bf16 a[152:155], v[244:247], v[228:231], a[152:155]
    v_add_f32 v214, v206, v210
    v_add_f32 v215, v207, v211
    v_mfma_f32_16x16x32_bf16 a[168:171], a[228:231], v[228:231], a[168:171]
    s_waitcnt lgkmcnt(1)
    v_sub_f32 v204, v204, v208
    v_sub_f32 v205, v205, v209
    v_mfma_f32_16x16x32_bf16 a[168:171], a[240:243], v[232:235], a[168:171]
    v_sub_f32 v206, v206, v210
    v_sub_f32 v207, v207, v211
    v_mfma_f32_16x16x32_bf16 a[172:175], a[244:247], v[232:235], a[172:175]
    v_accvgpr_write_b32 a8, v212
    v_accvgpr_write_b32 a9, v213
    v_mfma_f32_16x16x32_bf16 a[172:175], a[232:235], v[228:231], a[172:175]
    v_accvgpr_write_b32 a10, v214
    v_accvgpr_write_b32 a11, v215
    v_mfma_f32_16x16x32_bf16 a[176:179], a[236:239], v[228:231], a[176:179]
    ds_read_b128 v[228:231], v253 offset:11184
    v_accvgpr_write_b32 a104, v204
    v_mfma_f32_16x16x32_bf16 a[176:179], a[248:251], v[232:235], a[176:179]
    v_accvgpr_write_b32 a105, v205
    v_accvgpr_write_b32 a106, v206
    v_mfma_f32_16x16x32_bf16 a[156:159], a[252:255], v[232:235], a[156:159]
    v_accvgpr_write_b32 a107, v207
    v_accvgpr_read_b32 v204, a12
    v_mfma_f32_16x16x32_bf16 a[160:163], v[240:243], v[232:235], a[160:163]
    v_accvgpr_read_b32 v205, a13
    v_accvgpr_read_b32 v206, a14
    v_mfma_f32_16x16x32_bf16 a[164:167], v[244:247], v[232:235], a[164:167]
    s_mov_b32 s42, 847872
    v_accvgpr_read_b32 v207, a15
    v_accvgpr_read_b32 v208, a108
    v_mfma_f32_16x16x32_bf16 a[180:183], a[228:231], v[232:235], a[180:183]
    buffer_load_dwordx4 a[228:231], v254, s[8:11], s42 offen offset:0 sc1
    v_mfma_f32_16x16x32_bf16 a[184:187], a[232:235], v[232:235], a[184:187]
    v_accvgpr_read_b32 v209, a109
    v_accvgpr_read_b32 v210, a110
    v_mfma_f32_16x16x32_bf16 a[188:191], a[236:239], v[232:235], a[188:191]
    s_waitcnt lgkmcnt(1)
    v_accvgpr_read_b32 v211, a111
    v_add_f32 v212, v204, v208
    v_mfma_f32_16x16x32_bf16 a[180:183], a[240:243], v[236:239], a[180:183]
    ds_read_b128 v[232:235], v253 offset:13520
    v_add_f32 v213, v205, v209
    v_mfma_f32_16x16x32_bf16 a[184:187], a[244:247], v[236:239], a[184:187]
    buffer_load_dwordx4 a[232:235], v254, s[8:11], s42 offen offset:1024 sc1
    v_mfma_f32_16x16x32_bf16 a[188:191], a[248:251], v[236:239], a[188:191]
    v_add_f32 v214, v206, v210
    v_add_f32 v215, v207, v211
    v_mfma_f32_16x16x32_bf16 a[168:171], a[252:255], v[236:239], a[168:171]
    s_waitcnt lgkmcnt(1)
    v_sub_f32 v204, v204, v208
    v_sub_f32 v205, v205, v209
    v_mfma_f32_16x16x32_bf16 a[172:175], v[240:243], v[236:239], a[172:175]
    buffer_load_dwordx4 a[236:239], v254, s[8:11], s42 offen offset:2048 sc1
    v_mfma_f32_16x16x32_bf16 a[176:179], v[244:247], v[236:239], a[176:179]
    ds_read_b128 v[236:239], v253 offset:13248
    v_sub_f32 v206, v206, v210
    v_mfma_f32_16x16x32_bf16 a[180:183], a[252:255], v[228:231], a[180:183]
    s_mov_b32 s42, 850944
    v_sub_f32 v207, v207, v211
    v_accvgpr_write_b32 a12, v212
    v_mfma_f32_16x16x32_bf16 a[184:187], v[240:243], v[228:231], a[184:187]
    buffer_load_dwordx4 a[240:243], v254, s[8:11], s42 offen offset:0 sc1
    v_mfma_f32_16x16x32_bf16 a[188:191], v[244:247], v[228:231], a[188:191]
    ds_read_b128 v[228:231], v253 offset:12992
    v_accvgpr_write_b32 a13, v213
    s_waitcnt vmcnt(11)
    s_waitcnt lgkmcnt(2)
sub22:
    v_mfma_f32_16x16x32_bf16 v[0:3], a[192:195], v[232:235], v[0:3]
    v_accvgpr_write_b32 a14, v214
    v_accvgpr_write_b32 a15, v215
    v_mfma_f32_16x16x32_bf16 v[4:7], a[196:199], v[232:235], v[4:7]
    s_waitcnt vmcnt(8) lgkmcnt(1)
    v_accvgpr_write_b32 a108, v204
    v_accvgpr_write_b32 a109, v205
    v_mfma_f32_16x16x32_bf16 v[8:11], a[200:203], v[232:235], v[8:11]
    ds_read_b128 v[232:235], v253 offset:12736
    v_accvgpr_write_b32 a110, v206
    v_mfma_f32_16x16x32_bf16 v[0:3], a[204:207], v[236:239], v[0:3]
    buffer_load_dwordx4 a[244:247], v254, s[8:11], s42 offen offset:1024 sc1
    v_mfma_f32_16x16x32_bf16 v[4:7], a[208:211], v[236:239], v[4:7]
    v_accvgpr_write_b32 a111, v207
    v_accvgpr_read_b32 v204, a16
    v_mfma_f32_16x16x32_bf16 v[8:11], a[212:215], v[236:239], v[8:11]
    v_accvgpr_read_b32 v205, a17
    v_accvgpr_read_b32 v206, a18
    v_mfma_f32_16x16x32_bf16 v[12:15], a[192:195], v[236:239], v[12:15]
    s_waitcnt lgkmcnt(1)
    v_accvgpr_read_b32 v207, a19
    v_accvgpr_read_b32 v208, a112
    v_mfma_f32_16x16x32_bf16 v[12:15], a[204:207], v[228:231], v[12:15]
    buffer_load_dwordx4 a[248:251], v254, s[8:11], s42 offen offset:2048 sc1
    v_mfma_f32_16x16x32_bf16 v[16:19], a[208:211], v[228:231], v[16:19]
    v_accvgpr_read_b32 v209, a113
    v_accvgpr_read_b32 v210, a114
    v_mfma_f32_16x16x32_bf16 v[16:19], a[196:199], v[236:239], v[16:19]
    s_mov_b32 s42, 854016
    v_accvgpr_read_b32 v211, a115
    v_add_f32 v212, v204, v208
    v_mfma_f32_16x16x32_bf16 v[20:23], a[200:203], v[236:239], v[20:23]
    ds_read_b128 v[236:239], v253 offset:12480
    v_add_f32 v213, v205, v209
    v_mfma_f32_16x16x32_bf16 v[20:23], a[212:215], v[228:231], v[20:23]
    buffer_load_dwordx4 a[252:255], v254, s[8:11], s42 offen offset:0 sc1
    s_waitcnt vmcnt(8)
    v_mfma_f32_16x16x32_bf16 v[0:3], a[216:219], v[228:231], v[0:3]
    v_add_f32 v214, v206, v210
    v_add_f32 v215, v207, v211
    v_mfma_f32_16x16x32_bf16 v[4:7], a[220:223], v[228:231], v[4:7]
    v_sub_f32 v204, v204, v208
    v_sub_f32 v205, v205, v209
    v_mfma_f32_16x16x32_bf16 v[8:11], a[224:227], v[228:231], v[8:11]
    s_waitcnt lgkmcnt(1)
    v_sub_f32 v206, v206, v210
    v_sub_f32 v207, v207, v211
    v_mfma_f32_16x16x32_bf16 v[24:27], a[192:195], v[228:231], v[24:27]
    buffer_load_dwordx4 v[240:243], v254, s[8:11], s42 offen offset:1024 sc1
    v_mfma_f32_16x16x32_bf16 v[24:27], a[204:207], v[232:235], v[24:27]
    v_accvgpr_write_b32 a16, v212
    v_accvgpr_write_b32 a17, v213
    v_mfma_f32_16x16x32_bf16 v[28:31], a[208:211], v[232:235], v[28:31]
    v_accvgpr_write_b32 a18, v214
    v_accvgpr_write_b32 a19, v215
    v_mfma_f32_16x16x32_bf16 v[28:31], a[196:199], v[228:231], v[28:31]
    buffer_load_dwordx4 v[244:247], v254, s[8:11], s42 offen offset:2048 sc1
    v_mfma_f32_16x16x32_bf16 v[32:35], a[200:203], v[228:231], v[32:35]
    ds_read_b128 v[228:231], v253 offset:14304
    v_accvgpr_write_b32 a112, v204
    v_mfma_f32_16x16x32_bf16 v[32:35], a[212:215], v[232:235], v[32:35]
    v_accvgpr_write_b32 a113, v205
    v_accvgpr_write_b32 a114, v206
    v_mfma_f32_16x16x32_bf16 v[12:15], a[216:219], v[232:235], v[12:15]
    v_accvgpr_write_b32 a115, v207
    v_accvgpr_read_b32 v204, a20
    v_mfma_f32_16x16x32_bf16 v[16:19], a[220:223], v[232:235], v[16:19]
    v_accvgpr_read_b32 v205, a21
    v_accvgpr_read_b32 v206, a22
    v_mfma_f32_16x16x32_bf16 v[20:23], a[224:227], v[232:235], v[20:23]
    v_accvgpr_read_b32 v207, a23
    v_accvgpr_read_b32 v208, a116
    v_mfma_f32_16x16x32_bf16 v[36:39], a[192:195], v[232:235], v[36:39]
    s_waitcnt lgkmcnt(1)
    v_accvgpr_read_b32 v209, a117
    v_accvgpr_read_b32 v210, a118
    v_mfma_f32_16x16x32_bf16 v[36:39], a[204:207], v[236:239], v[36:39]
    v_accvgpr_read_b32 v211, a119
    v_add_f32 v212, v204, v208
    v_mfma_f32_16x16x32_bf16 v[40:43], a[208:211], v[236:239], v[40:43]
    v_add_f32 v213, v205, v209
    v_add_f32 v214, v206, v210
    v_mfma_f32_16x16x32_bf16 v[40:43], a[196:199], v[232:235], v[40:43]
    v_add_f32 v215, v207, v211
    v_sub_f32 v204, v204, v208
    v_mfma_f32_16x16x32_bf16 v[44:47], a[200:203], v[232:235], v[44:47]
    ds_read_b128 v[232:235], v253 offset:14048
    v_sub_f32 v205, v205, v209
    v_mfma_f32_16x16x32_bf16 v[44:47], a[212:215], v[236:239], v[44:47]
    v_sub_f32 v206, v206, v210
    v_sub_f32 v207, v207, v211
    v_mfma_f32_16x16x32_bf16 v[24:27], a[216:219], v[236:239], v[24:27]
    v_accvgpr_write_b32 a20, v212
    v_accvgpr_write_b32 a21, v213
    v_mfma_f32_16x16x32_bf16 v[28:31], a[220:223], v[236:239], v[28:31]
    v_accvgpr_write_b32 a22, v214
    v_accvgpr_write_b32 a23, v215
    v_mfma_f32_16x16x32_bf16 v[32:35], a[224:227], v[236:239], v[32:35]
    v_accvgpr_write_b32 a116, v204
    v_accvgpr_write_b32 a117, v205
    v_mfma_f32_16x16x32_bf16 v[48:51], a[192:195], v[236:239], v[48:51]
    s_waitcnt lgkmcnt(1)
    v_accvgpr_write_b32 a118, v206
    v_accvgpr_write_b32 a119, v207
    v_mfma_f32_16x16x32_bf16 v[48:51], a[204:207], v[228:231], v[48:51]
    v_accvgpr_read_b32 v204, a84
    v_accvgpr_read_b32 v205, a85
    v_mfma_f32_16x16x32_bf16 v[52:55], a[208:211], v[228:231], v[52:55]
    v_accvgpr_read_b32 v206, a86
    v_accvgpr_read_b32 v207, a87
    v_mfma_f32_16x16x32_bf16 v[52:55], a[196:199], v[236:239], v[52:55]
    v_accvgpr_read_b32 v208, a180
    v_accvgpr_read_b32 v209, a181
    v_mfma_f32_16x16x32_bf16 v[56:59], a[200:203], v[236:239], v[56:59]
    ds_read_b128 v[236:239], v253 offset:13792
    v_accvgpr_read_b32 v210, a182
    v_mfma_f32_16x16x32_bf16 v[56:59], a[212:215], v[228:231], v[56:59]
    v_accvgpr_read_b32 v211, a183
    v_add_f32 v212, v204, v208
    v_mfma_f32_16x16x32_bf16 v[36:39], a[216:219], v[228:231], v[36:39]
    v_add_f32 v213, v205, v209
    v_add_f32 v214, v206, v210
    v_mfma_f32_16x16x32_bf16 v[40:43], a[220:223], v[228:231], v[40:43]
    v_add_f32 v215, v207, v211
    v_sub_f32 v204, v204, v208
    v_mfma_f32_16x16x32_bf16 v[44:47], a[224:227], v[228:231], v[44:47]
    v_sub_f32 v205, v205, v209
    v_sub_f32 v206, v206, v210
    v_mfma_f32_16x16x32_bf16 v[60:63], a[192:195], v[228:231], v[60:63]
    s_waitcnt lgkmcnt(1)
    v_sub_f32 v207, v207, v211
    v_accvgpr_write_b32 a84, v212
    v_mfma_f32_16x16x32_bf16 v[60:63], a[204:207], v[232:235], v[60:63]
    v_accvgpr_write_b32 a85, v213
    v_accvgpr_write_b32 a86, v214
    v_mfma_f32_16x16x32_bf16 v[64:67], a[208:211], v[232:235], v[64:67]
    v_accvgpr_write_b32 a87, v215
    v_accvgpr_write_b32 a180, v204
    v_mfma_f32_16x16x32_bf16 v[64:67], a[196:199], v[228:231], v[64:67]
    v_accvgpr_write_b32 a181, v205
    v_accvgpr_write_b32 a182, v206
    v_mfma_f32_16x16x32_bf16 v[68:71], a[200:203], v[228:231], v[68:71]
    ds_read_b128 v[228:231], v253 offset:13536
    v_accvgpr_write_b32 a183, v207
    v_mfma_f32_16x16x32_bf16 v[68:71], a[212:215], v[232:235], v[68:71]
    v_accvgpr_read_b32 v204, a88
    v_accvgpr_read_b32 v205, a89
    v_mfma_f32_16x16x32_bf16 v[48:51], a[216:219], v[232:235], v[48:51]
    v_accvgpr_read_b32 v206, a90
    v_accvgpr_read_b32 v207, a91
    v_mfma_f32_16x16x32_bf16 v[52:55], a[220:223], v[232:235], v[52:55]
    v_accvgpr_read_b32 v208, a184
    v_accvgpr_read_b32 v209, a185
    v_mfma_f32_16x16x32_bf16 v[56:59], a[224:227], v[232:235], v[56:59]
    v_accvgpr_read_b32 v210, a186
    v_accvgpr_read_b32 v211, a187
    v_mfma_f32_16x16x32_bf16 v[72:75], a[192:195], v[232:235], v[72:75]
    s_waitcnt lgkmcnt(1)
    v_add_f32 v212, v204, v208
    v_add_f32 v213, v205, v209
    v_mfma_f32_16x16x32_bf16 v[72:75], a[204:207], v[236:239], v[72:75]
    v_add_f32 v214, v206, v210
    v_add_f32 v215, v207, v211
    v_mfma_f32_16x16x32_bf16 v[76:79], a[208:211], v[236:239], v[76:79]
    v_sub_f32 v204, v204, v208
    v_sub_f32 v205, v205, v209
    v_mfma_f32_16x16x32_bf16 v[76:79], a[196:199], v[232:235], v[76:79]
    v_sub_f32 v206, v206, v210
    v_sub_f32 v207, v207, v211
    v_mfma_f32_16x16x32_bf16 v[80:83], a[200:203], v[232:235], v[80:83]
    ds_read_b128 v[232:235], v253 offset:13264
    v_accvgpr_write_b32 a88, v212
    v_mfma_f32_16x16x32_bf16 v[80:83], a[212:215], v[236:239], v[80:83]
    v_accvgpr_write_b32 a89, v213
    v_accvgpr_write_b32 a90, v214
    v_mfma_f32_16x16x32_bf16 v[60:63], a[216:219], v[236:239], v[60:63]
    v_accvgpr_write_b32 a91, v215
    v_accvgpr_write_b32 a184, v204
    v_mfma_f32_16x16x32_bf16 v[64:67], a[220:223], v[236:239], v[64:67]
    v_accvgpr_write_b32 a185, v205
    v_accvgpr_write_b32 a186, v206
    v_mfma_f32_16x16x32_bf16 v[68:71], a[224:227], v[236:239], v[68:71]
    s_mov_b32 s42, 884736
    v_accvgpr_write_b32 a187, v207
    v_accvgpr_read_b32 v204, a92
    v_mfma_f32_16x16x32_bf16 v[84:87], a[192:195], v[236:239], v[84:87]
    buffer_load_dwordx4 a[192:195], v254, s[8:11], s42 offen offset:0 sc1
    v_mfma_f32_16x16x32_bf16 v[88:91], a[196:199], v[236:239], v[88:91]
    v_accvgpr_read_b32 v205, a93
    v_accvgpr_read_b32 v206, a94
    v_mfma_f32_16x16x32_bf16 v[92:95], a[200:203], v[236:239], v[92:95]
    s_waitcnt lgkmcnt(1)
    v_accvgpr_read_b32 v207, a95
    v_accvgpr_read_b32 v208, a188
    v_mfma_f32_16x16x32_bf16 v[84:87], a[204:207], v[228:231], v[84:87]
    ds_read_b128 v[236:239], v253 offset:1040
    v_accvgpr_read_b32 v209, a189
    v_mfma_f32_16x16x32_bf16 v[88:91], a[208:211], v[228:231], v[88:91]
    buffer_load_dwordx4 a[196:199], v254, s[8:11], s42 offen offset:1024 sc1
    v_mfma_f32_16x16x32_bf16 v[92:95], a[212:215], v[228:231], v[92:95]
    v_accvgpr_read_b32 v210, a190
    v_accvgpr_read_b32 v211, a191
    v_mfma_f32_16x16x32_bf16 v[72:75], a[216:219], v[228:231], v[72:75]
    s_waitcnt lgkmcnt(1)
    v_add_f32 v212, v204, v208
    v_add_f32 v213, v205, v209
    v_mfma_f32_16x16x32_bf16 v[76:79], a[220:223], v[228:231], v[76:79]
    buffer_load_dwordx4 a[200:203], v254, s[8:11], s42 offen offset:2048 sc1
    v_mfma_f32_16x16x32_bf16 v[80:83], a[224:227], v[228:231], v[80:83]
    ds_read_b128 v[228:231], v253 offset:768
    v_add_f32 v214, v206, v210
    v_mfma_f32_16x16x32_bf16 v[84:87], a[216:219], v[232:235], v[84:87]
    s_mov_b32 s42, 887808
    v_add_f32 v215, v207, v211
    v_sub_f32 v204, v204, v208
    v_mfma_f32_16x16x32_bf16 v[88:91], a[220:223], v[232:235], v[88:91]
    buffer_load_dwordx4 a[204:207], v254, s[8:11], s42 offen offset:0 sc1
    v_mfma_f32_16x16x32_bf16 v[92:95], a[224:227], v[232:235], v[92:95]
    ds_read_b128 v[232:235], v253 offset:512
    v_sub_f32 v205, v205, v209
    s_waitcnt vmcnt(10)
    s_waitcnt lgkmcnt(2)
sub23:
    v_mfma_f32_16x16x32_bf16 v[96:99], a[228:231], v[236:239], v[96:99]
    v_sub_f32 v206, v206, v210
    v_sub_f32 v207, v207, v211
    v_mfma_f32_16x16x32_bf16 v[100:103], a[232:235], v[236:239], v[100:103]
    s_waitcnt vmcnt(7) lgkmcnt(1)
    v_accvgpr_write_b32 a92, v212
    v_accvgpr_write_b32 a93, v213
    v_mfma_f32_16x16x32_bf16 v[104:107], a[236:239], v[236:239], v[104:107]
    ds_read_b128 v[236:239], v253 offset:256
    v_accvgpr_write_b32 a94, v214
    v_mfma_f32_16x16x32_bf16 v[96:99], a[240:243], v[228:231], v[96:99]
    buffer_load_dwordx4 a[208:211], v254, s[8:11], s42 offen offset:1024 sc1
    v_mfma_f32_16x16x32_bf16 v[100:103], a[244:247], v[228:231], v[100:103]
pad8:
    s_cbranch_vccnz pad12
    v_accvgpr_write_b32 a95, v215
    v_accvgpr_write_b32 a188, v204
    v_mfma_f32_16x16x32_bf16 v[104:107], a[248:251], v[228:231], v[104:107]
    v_accvgpr_write_b32 a189, v205
    v_accvgpr_write_b32 a190, v206
    v_mfma_f32_16x16x32_bf16 v[108:111], a[228:231], v[228:231], v[108:111]
    s_waitcnt lgkmcnt(1)
    v_accvgpr_write_b32 a191, v207
    v_accvgpr_read_b32 v204, a0
    v_mfma_f32_16x16x32_bf16 v[108:111], a[240:243], v[232:235], v[108:111]
    buffer_load_dwordx4 a[212:215], v254, s[8:11], s42 offen offset:2048 sc1
    v_mfma_f32_16x16x32_bf16 v[112:115], a[244:247], v[232:235], v[112:115]
    v_accvgpr_read_b32 v205, a1
    v_accvgpr_read_b32 v206, a2
    v_mfma_f32_16x16x32_bf16 v[112:115], a[232:235], v[228:231], v[112:115]
    s_mov_b32 s42, 890880
    v_accvgpr_read_b32 v207, a3
    v_mfma_f32_16x16x32_bf16 v[116:119], a[236:239], v[228:231], v[116:119]
    ds_read_b128 v[228:231], v253 offset:0
    v_mfma_f32_16x16x32_bf16 v[116:119], a[248:251], v[232:235], v[116:119]
    buffer_load_dwordx4 a[216:219], v254, s[8:11], s42 offen offset:0 sc1
    s_waitcnt vmcnt(7)
    v_mfma_f32_16x16x32_bf16 v[96:99], a[252:255], v[232:235], v[96:99]
    v_mfma_f32_16x16x32_bf16 v[100:103], v[240:243], v[232:235], v[100:103]
    v_mfma_f32_16x16x32_bf16 v[104:107], v[244:247], v[232:235], v[104:107]
    s_waitcnt lgkmcnt(1)
    v_mfma_f32_16x16x32_bf16 v[120:123], a[228:231], v[232:235], v[120:123]
    buffer_load_dwordx4 a[220:223], v254, s[8:11], s42 offen offset:1024 sc1
    v_mfma_f32_16x16x32_bf16 v[120:123], a[240:243], v[236:239], v[120:123]
    v_mfma_f32_16x16x32_bf16 v[124:127], a[244:247], v[236:239], v[124:127]
    v_mfma_f32_16x16x32_bf16 v[124:127], a[232:235], v[232:235], v[124:127]
    buffer_load_dwordx4 a[224:227], v254, s[8:11], s42 offen offset:2048 sc1
    v_mfma_f32_16x16x32_bf16 v[128:131], a[236:239], v[232:235], v[128:131]
    ds_read_b128 v[232:235], v253 offset:1824
    v_and_b32 v252, 0x1f0, v254
    v_mfma_f32_16x16x32_bf16 v[128:131], a[248:251], v[236:239], v[128:131]
    v_mul_u32_u24 v252, 96, v252
    v_add_f32 v208, v0, v96
    v_mfma_f32_16x16x32_bf16 v[108:111], a[252:255], v[236:239], v[108:111]
    buffer_load_dword v252, v252, s[4:7], s100 offen offset:1152
    v_mfma_f32_16x16x32_bf16 v[112:115], v[240:243], v[236:239], v[112:115]
    v_add_f32 v209, v1, v97
    v_add_f32 v210, v2, v98
    v_mfma_f32_16x16x32_bf16 v[116:119], v[244:247], v[236:239], v[116:119]
    v_add_f32 v211, v3, v99
    v_sub_f32 v96, v0, v96
    v_mfma_f32_16x16x32_bf16 v[132:135], a[228:231], v[236:239], v[132:135]
    s_waitcnt lgkmcnt(1)
    v_sub_f32 v97, v1, v97
    v_sub_f32 v98, v2, v98
    v_mfma_f32_16x16x32_bf16 v[132:135], a[240:243], v[228:231], v[132:135]
    v_sub_f32 v99, v3, v99
    v_fma_f32 v0, v208, s31, v204
    v_mfma_f32_16x16x32_bf16 v[136:139], a[244:247], v[228:231], v[136:139]
    v_fma_f32 v1, v209, s31, v205
    v_fma_f32 v2, v210, s31, v206
    v_mfma_f32_16x16x32_bf16 v[136:139], a[232:235], v[236:239], v[136:139]
    v_fma_f32 v3, v211, s31, v207
    v_fmac_f32 v208, s30, v204
    v_mfma_f32_16x16x32_bf16 v[140:143], a[236:239], v[236:239], v[140:143]
    ds_read_b128 v[236:239], v253 offset:1568
    v_fmac_f32 v209, s30, v205
    v_mfma_f32_16x16x32_bf16 v[140:143], a[248:251], v[228:231], v[140:143]
    v_fmac_f32 v210, s30, v206
    v_fmac_f32 v211, s30, v207
    v_mfma_f32_16x16x32_bf16 v[120:123], a[252:255], v[228:231], v[120:123]
    v_cvt_pk_bf16_f32 v194, v208, v209
    v_cvt_pk_bf16_f32 v195, v210, v211
    v_mfma_f32_16x16x32_bf16 v[124:127], v[240:243], v[228:231], v[124:127]
    v_accvgpr_read_b32 v204, a4
    v_accvgpr_read_b32 v205, a5
    v_mfma_f32_16x16x32_bf16 v[128:131], v[244:247], v[228:231], v[128:131]
    v_accvgpr_read_b32 v206, a6
    v_accvgpr_read_b32 v207, a7
    v_mfma_f32_16x16x32_bf16 v[144:147], a[228:231], v[228:231], v[144:147]
    s_waitcnt lgkmcnt(1)
    v_add_f32 v208, v4, v100
    v_add_f32 v209, v5, v101
    v_mfma_f32_16x16x32_bf16 v[144:147], a[240:243], v[232:235], v[144:147]
    v_add_f32 v210, v6, v102
    v_add_f32 v211, v7, v103
    v_mfma_f32_16x16x32_bf16 v[148:151], a[244:247], v[232:235], v[148:151]
    v_sub_f32 v100, v4, v100
    v_sub_f32 v101, v5, v101
    v_mfma_f32_16x16x32_bf16 v[148:151], a[232:235], v[228:231], v[148:151]
    v_sub_f32 v102, v6, v102
    v_sub_f32 v103, v7, v103
    v_mfma_f32_16x16x32_bf16 v[152:155], a[236:239], v[228:231], v[152:155]
    ds_read_b128 v[228:231], v253 offset:1312
    v_fma_f32 v4, v208, s31, v204
    v_mfma_f32_16x16x32_bf16 v[152:155], a[248:251], v[232:235], v[152:155]
    v_fma_f32 v5, v209, s31, v205
    v_fma_f32 v6, v210, s31, v206
    v_mfma_f32_16x16x32_bf16 v[132:135], a[252:255], v[232:235], v[132:135]
    v_fma_f32 v7, v211, s31, v207
    v_fmac_f32 v208, s30, v204
    v_mfma_f32_16x16x32_bf16 v[136:139], v[240:243], v[232:235], v[136:139]
    v_fmac_f32 v209, s30, v205
    v_fmac_f32 v210, s30, v206
    v_mfma_f32_16x16x32_bf16 v[140:143], v[244:247], v[232:235], v[140:143]
    v_fmac_f32 v211, s30, v207
    v_cvt_pk_bf16_f32 v196, v208, v209
    v_mfma_f32_16x16x32_bf16 v[156:159], a[228:231], v[232:235], v[156:159]
    s_waitcnt lgkmcnt(1)
    v_cvt_pk_bf16_f32 v197, v210, v211
    v_accvgpr_read_b32 v204, a8
    v_mfma_f32_16x16x32_bf16 v[156:159], a[240:243], v[236:239], v[156:159]
    v_accvgpr_read_b32 v205, a9
    v_accvgpr_read_b32 v206, a10
    v_mfma_f32_16x16x32_bf16 v[160:163], a[244:247], v[236:239], v[160:163]
    v_accvgpr_read_b32 v207, a11
    v_add_f32 v208, v8, v104
    v_mfma_f32_16x16x32_bf16 v[160:163], a[232:235], v[232:235], v[160:163]
    v_add_f32 v209, v9, v105
    v_add_f32 v210, v10, v106
    v_mfma_f32_16x16x32_bf16 v[164:167], a[236:239], v[232:235], v[164:167]
    ds_read_b128 v[232:235], v253 offset:1056
    v_add_f32 v211, v11, v107
    v_mfma_f32_16x16x32_bf16 v[164:167], a[248:251], v[236:239], v[164:167]
    v_sub_f32 v104, v8, v104
    v_sub_f32 v105, v9, v105
    v_mfma_f32_16x16x32_bf16 v[144:147], a[252:255], v[236:239], v[144:147]
    v_sub_f32 v106, v10, v106
    v_sub_f32 v107, v11, v107
    v_mfma_f32_16x16x32_bf16 v[148:151], v[240:243], v[236:239], v[148:151]
    v_fma_f32 v8, v208, s31, v204
    v_fma_f32 v9, v209, s31, v205
    v_mfma_f32_16x16x32_bf16 v[152:155], v[244:247], v[236:239], v[152:155]
    v_fma_f32 v10, v210, s31, v206
    v_fma_f32 v11, v211, s31, v207
    v_mfma_f32_16x16x32_bf16 v[168:171], a[228:231], v[236:239], v[168:171]
    s_waitcnt lgkmcnt(1)
    v_fmac_f32 v208, s30, v204
    v_fmac_f32 v209, s30, v205
    v_mfma_f32_16x16x32_bf16 v[168:171], a[240:243], v[228:231], v[168:171]
    v_fmac_f32 v210, s30, v206
    v_fmac_f32 v211, s30, v207
    v_mfma_f32_16x16x32_bf16 v[172:175], a[244:247], v[228:231], v[172:175]
    v_cvt_pk_bf16_f32 v198, v208, v209
    v_cvt_pk_bf16_f32 v199, v210, v211
    v_mfma_f32_16x16x32_bf16 v[172:175], a[232:235], v[236:239], v[172:175]
    v_mfma_f32_16x16x32_bf16 v[176:179], a[236:239], v[236:239], v[176:179]
    ds_read_b128 v[236:239], v253 offset:784
    v_mfma_f32_16x16x32_bf16 v[176:179], a[248:251], v[228:231], v[176:179]
    v_mfma_f32_16x16x32_bf16 v[156:159], a[252:255], v[228:231], v[156:159]
    v_mfma_f32_16x16x32_bf16 v[160:163], v[240:243], v[228:231], v[160:163]
    s_waitcnt lgkmcnt(1)
    v_mfma_f32_16x16x32_bf16 v[164:167], v[244:247], v[228:231], v[164:167]
    s_mov_b32 s42, 921600
    v_mfma_f32_16x16x32_bf16 v[180:183], a[228:231], v[228:231], v[180:183]
    buffer_load_dwordx4 a[228:231], v254, s[8:11], s42 offen offset:0 sc1
    v_mfma_f32_16x16x32_bf16 v[184:187], a[232:235], v[228:231], v[184:187]
    s_waitcnt lgkmcnt(0)
    v_mfma_f32_16x16x32_bf16 v[188:191], a[236:239], v[228:231], v[188:191]
    s_barrier
    v_mfma_f32_16x16x32_bf16 v[180:183], a[240:243], v[232:235], v[180:183]
    ds_read_b128 v[228:231], v253 offset:34320
    v_mfma_f32_16x16x32_bf16 v[184:187], a[244:247], v[232:235], v[184:187]
    buffer_load_dwordx4 a[232:235], v254, s[8:11], s42 offen offset:1024 sc1
    v_mfma_f32_16x16x32_bf16 v[188:191], a[248:251], v[232:235], v[188:191]
    ds_write_b64 v249, v[198:199] offset:64
    v_mfma_f32_16x16x32_bf16 v[168:171], a[252:255], v[232:235], v[168:171]
    ds_write_b128 v248, v[194:197] offset:0
    v_mfma_f32_16x16x32_bf16 v[172:175], v[240:243], v[232:235], v[172:175]
    buffer_load_dwordx4 a[236:239], v254, s[8:11], s42 offen offset:2048 sc1
    v_mfma_f32_16x16x32_bf16 v[176:179], v[244:247], v[232:235], v[176:179]
    ds_read_b128 v[232:235], v253 offset:34048
    v_mfma_f32_16x16x32_bf16 v[180:183], a[252:255], v[236:239], v[180:183]
    s_mov_b32 s42, 924672
    v_mfma_f32_16x16x32_bf16 v[184:187], v[240:243], v[236:239], v[184:187]
    buffer_load_dwordx4 a[240:243], v254, s[8:11], s42 offen offset:0 sc1
    v_mfma_f32_16x16x32_bf16 v[188:191], v[244:247], v[236:239], v[188:191]
    ds_read_b128 v[236:239], v253 offset:33792
    s_waitcnt vmcnt(11)
    s_waitcnt lgkmcnt(4)
    s_nop 0
    v_accvgpr_read_b32 v204, a12
    v_accvgpr_read_b32 v205, a13
    v_accvgpr_read_b32 v206, a14
    v_accvgpr_read_b32 v207, a15
    v_pk_add_f32 v[208:209], v[12:13], v[108:109]
    v_pk_add_f32 v[210:211], v[14:15], v[110:111]
    v_pk_add_f32 v[108:109], v[12:13], v[108:109] neg_lo:[0,1] neg_hi:[0,1]
    v_pk_add_f32 v[110:111], v[14:15], v[110:111] neg_lo:[0,1] neg_hi:[0,1]
    v_pk_fma_f32 v[12:13], v[208:209], s[30:31], v[204:205] op_sel:[0,1,0]
    v_pk_fma_f32 v[14:15], v[210:211], s[30:31], v[206:207] op_sel:[0,1,0]
    v_pk_fma_f32 v[204:205], v[204:205], s[30:31], v[208:209] op_sel_hi:[1,0,1]
    v_pk_fma_f32 v[206:207], v[206:207], s[30:31], v[210:211] op_sel_hi:[1,0,1]
    v_cvt_pk_bf16_f32 v220, v204, v205
    v_cvt_pk_bf16_f32 v221, v206, v207
    v_accvgpr_read_b32 v212, a16
    v_accvgpr_read_b32 v213, a17
    v_accvgpr_read_b32 v214, a18
    v_accvgpr_read_b32 v215, a19
    v_pk_add_f32 v[216:217], v[16:17], v[112:113]
    v_pk_add_f32 v[218:219], v[18:19], v[114:115]
    v_pk_add_f32 v[112:113], v[16:17], v[112:113] neg_lo:[0,1] neg_hi:[0,1]
    v_pk_add_f32 v[114:115], v[18:19], v[114:115] neg_lo:[0,1] neg_hi:[0,1]
    v_pk_fma_f32 v[16:17], v[216:217], s[30:31], v[212:213] op_sel:[0,1,0]
    v_pk_fma_f32 v[18:19], v[218:219], s[30:31], v[214:215] op_sel:[0,1,0]
    v_pk_fma_f32 v[212:213], v[212:213], s[30:31], v[216:217] op_sel_hi:[1,0,1]
    v_pk_fma_f32 v[214:215], v[214:215], s[30:31], v[218:219] op_sel_hi:[1,0,1]
    v_cvt_pk_bf16_f32 v222, v212, v213
    v_cvt_pk_bf16_f32 v223, v214, v215
    ds_write_b128 v248, v[220:223] offset:384
    v_accvgpr_read_b32 v204, a20
    v_accvgpr_read_b32 v205, a21
    v_accvgpr_read_b32 v206, a22
    v_accvgpr_read_b32 v207, a23
    v_pk_add_f32 v[208:209], v[20:21], v[116:117]
    v_pk_add_f32 v[210:211], v[22:23], v[118:119]
    v_pk_add_f32 v[116:117], v[20:21], v[116:117] neg_lo:[0,1] neg_hi:[0,1]
    v_pk_add_f32 v[118:119], v[22:23], v[118:119] neg_lo:[0,1] neg_hi:[0,1]
    v_pk_fma_f32 v[20:21], v[208:209], s[30:31], v[204:205] op_sel:[0,1,0]
    v_pk_fma_f32 v[22:23], v[210:211], s[30:31], v[206:207] op_sel:[0,1,0]
    v_pk_fma_f32 v[204:205], v[204:205], s[30:31], v[208:209] op_sel_hi:[1,0,1]
    v_pk_fma_f32 v[206:207], v[206:207], s[30:31], v[210:211] op_sel_hi:[1,0,1]
    v_cvt_pk_bf16_f32 v224, v204, v205
    v_cvt_pk_bf16_f32 v225, v206, v207
    v_accvgpr_read_b32 v204, a24
    v_accvgpr_read_b32 v205, a25
    v_accvgpr_read_b32 v206, a26
    v_accvgpr_read_b32 v207, a27
    v_accvgpr_read_b32 v208, a120
    v_accvgpr_read_b32 v209, a121
    v_accvgpr_read_b32 v210, a122
    v_accvgpr_read_b32 v211, a123
    v_pk_add_f32 v[204:205], v[204:205], v[208:209]
    v_pk_add_f32 v[206:207], v[206:207], v[210:211]
    v_pk_add_f32 v[208:209], v[24:25], v[120:121]
    v_pk_add_f32 v[210:211], v[26:27], v[122:123]
    v_pk_add_f32 v[120:121], v[24:25], v[120:121] neg_lo:[0,1] neg_hi:[0,1]
    v_pk_add_f32 v[122:123], v[26:27], v[122:123] neg_lo:[0,1] neg_hi:[0,1]
    v_pk_fma_f32 v[24:25], v[208:209], s[30:31], v[204:205] op_sel:[0,1,0]
    v_pk_fma_f32 v[26:27], v[210:211], s[30:31], v[206:207] op_sel:[0,1,0]
    v_pk_fma_f32 v[204:205], v[204:205], s[30:31], v[208:209] op_sel_hi:[1,0,1]
    v_pk_fma_f32 v[206:207], v[206:207], s[30:31], v[210:211] op_sel_hi:[1,0,1]
    v_cvt_pk_bf16_f32 v194, v204, v205
    v_cvt_pk_bf16_f32 v195, v206, v207
    ds_write_b64 v249, v[224:225] offset:448
    v_accvgpr_read_b32 v212, a28
    v_accvgpr_read_b32 v213, a29
    v_accvgpr_read_b32 v214, a30
    v_accvgpr_read_b32 v215, a31
    v_accvgpr_read_b32 v216, a124
    v_accvgpr_read_b32 v217, a125
    v_accvgpr_read_b32 v218, a126
    v_accvgpr_read_b32 v219, a127
    v_pk_add_f32 v[212:213], v[212:213], v[216:217]
    v_pk_add_f32 v[214:215], v[214:215], v[218:219]
    v_pk_add_f32 v[216:217], v[28:29], v[124:125]
    v_pk_add_f32 v[218:219], v[30:31], v[126:127]
    v_pk_add_f32 v[124:125], v[28:29], v[124:125] neg_lo:[0,1] neg_hi:[0,1]
    v_pk_add_f32 v[126:127], v[30:31], v[126:127] neg_lo:[0,1] neg_hi:[0,1]
    v_pk_fma_f32 v[28:29], v[216:217], s[30:31], v[212:213] op_sel:[0,1,0]
    v_pk_fma_f32 v[30:31], v[218:219], s[30:31], v[214:215] op_sel:[0,1,0]
    v_pk_fma_f32 v[212:213], v[212:213], s[30:31], v[216:217] op_sel_hi:[1,0,1]
    v_pk_fma_f32 v[214:215], v[214:215], s[30:31], v[218:219] op_sel_hi:[1,0,1]
    v_cvt_pk_bf16_f32 v196, v212, v213
    v_cvt_pk_bf16_f32 v197, v214, v215
    ds_write_b128 v248, v[194:197] offset:768
    v_accvgpr_read_b32 v204, a32
    v_accvgpr_read_b32 v205, a33
    v_accvgpr_read_b32 v206, a34
    v_accvgpr_read_b32 v207, a35
    v_accvgpr_read_b32 v208, a128
    v_accvgpr_read_b32 v209, a129
    v_accvgpr_read_b32 v210, a130
    v_accvgpr_read_b32 v211, a131
    v_pk_add_f32 v[204:205], v[204:205], v[208:209]
    v_pk_add_f32 v[206:207], v[206:207], v[210:211]
    v_pk_add_f32 v[208:209], v[32:33], v[128:129]
    v_pk_add_f32 v[210:211], v[34:35], v[130:131]
    v_pk_add_f32 v[128:129], v[32:33], v[128:129] neg_lo:[0,1] neg_hi:[0,1]
    v_pk_add_f32 v[130:131], v[34:35], v[130:131] neg_lo:[0,1] neg_hi:[0,1]
    v_pk_fma_f32 v[32:33], v[208:209], s[30:31], v[204:205] op_sel:[0,1,0]
    v_pk_fma_f32 v[34:35], v[210:211], s[30:31], v[206:207] op_sel:[0,1,0]
    v_pk_fma_f32 v[204:205], v[204:205], s[30:31], v[208:209] op_sel_hi:[1,0,1]
    v_pk_fma_f32 v[206:207], v[206:207], s[30:31], v[210:211] op_sel_hi:[1,0,1]
    v_cvt_pk_bf16_f32 v198, v204, v205
    v_cvt_pk_bf16_f32 v199, v206, v207
    v_accvgpr_read_b32 v204, a36
    v_accvgpr_read_b32 v205, a37
    v_accvgpr_read_b32 v206, a38
    v_accvgpr_read_b32 v207, a39
    v_accvgpr_read_b32 v208, a132
    v_accvgpr_read_b32 v209, a133
    v_accvgpr_read_b32 v210, a134
    v_accvgpr_read_b32 v211, a135
    v_pk_add_f32 v[204:205], v[204:205], v[208:209]
    v_pk_add_f32 v[206:207], v[206:207], v[210:211]
    v_pk_add_f32 v[208:209], v[36:37], v[132:133]
    v_pk_add_f32 v[210:211], v[38:39], v[134:135]
    v_pk_add_f32 v[132:133], v[36:37], v[132:133] neg_lo:[0,1] neg_hi:[0,1]
    v_pk_add_f32 v[134:135], v[38:39], v[134:135] neg_lo:[0,1] neg_hi:[0,1]
    v_pk_fma_f32 v[36:37], v[208:209], s[30:31], v[204:205] op_sel:[0,1,0]
    v_pk_fma_f32 v[38:39], v[210:211], s[30:31], v[206:207] op_sel:[0,1,0]
    v_pk_fma_f32 v[204:205], v[204:205], s[30:31], v[208:209] op_sel_hi:[1,0,1]
    v_pk_fma_f32 v[206:207], v[206:207], s[30:31], v[210:211] op_sel_hi:[1,0,1]
    v_cvt_pk_bf16_f32 v220, v204, v205
    v_cvt_pk_bf16_f32 v221, v206, v207
    ds_write_b64 v249, v[198:199] offset:832
    v_accvgpr_read_b32 v212, a40
    v_accvgpr_read_b32 v213, a41
    v_accvgpr_read_b32 v214, a42
    v_accvgpr_read_b32 v215, a43
    v_accvgpr_read_b32 v216, a136
    v_accvgpr_read_b32 v217, a137
    v_accvgpr_read_b32 v218, a138
    v_accvgpr_read_b32 v219, a139
    v_pk_add_f32 v[212:213], v[212:213], v[216:217]
    v_pk_add_f32 v[214:215], v[214:215], v[218:219]
    v_pk_add_f32 v[216:217], v[40:41], v[136:137]
    v_pk_add_f32 v[218:219], v[42:43], v[138:139]
    v_pk_add_f32 v[136:137], v[40:41], v[136:137] neg_lo:[0,1] neg_hi:[0,1]
    v_pk_add_f32 v[138:139], v[42:43], v[138:139] neg_lo:[0,1] neg_hi:[0,1]
    v_pk_fma_f32 v[40:41], v[216:217], s[30:31], v[212:213] op_sel:[0,1,0]
    v_pk_fma_f32 v[42:43], v[218:219], s[30:31], v[214:215] op_sel:[0,1,0]
    v_pk_fma_f32 v[212:213], v[212:213], s[30:31], v[216:217] op_sel_hi:[1,0,1]
    v_pk_fma_f32 v[214:215], v[214:215], s[30:31], v[218:219] op_sel_hi:[1,0,1]
    v_cvt_pk_bf16_f32 v222, v212, v213
    v_cvt_pk_bf16_f32 v223, v214, v215
    ds_write_b128 v248, v[220:223] offset:1152
    v_accvgpr_read_b32 v204, a44
    v_accvgpr_read_b32 v205, a45
    v_accvgpr_read_b32 v206, a46
    v_accvgpr_read_b32 v207, a47
    v_accvgpr_read_b32 v208, a140
    v_accvgpr_read_b32 v209, a141
    v_accvgpr_read_b32 v210, a142
    v_accvgpr_read_b32 v211, a143
    v_pk_add_f32 v[204:205], v[204:205], v[208:209]
    v_pk_add_f32 v[206:207], v[206:207], v[210:211]
    v_pk_add_f32 v[208:209], v[44:45], v[140:141]
    v_pk_add_f32 v[210:211], v[46:47], v[142:143]
    v_pk_add_f32 v[140:141], v[44:45], v[140:141] neg_lo:[0,1] neg_hi:[0,1]
    v_pk_add_f32 v[142:143], v[46:47], v[142:143] neg_lo:[0,1] neg_hi:[0,1]
    v_pk_fma_f32 v[44:45], v[208:209], s[30:31], v[204:205] op_sel:[0,1,0]
    v_pk_fma_f32 v[46:47], v[210:211], s[30:31], v[206:207] op_sel:[0,1,0]
    v_pk_fma_f32 v[204:205], v[204:205], s[30:31], v[208:209] op_sel_hi:[1,0,1]
    v_pk_fma_f32 v[206:207], v[206:207], s[30:31], v[210:211] op_sel_hi:[1,0,1]
    v_cvt_pk_bf16_f32 v224, v204, v205
    v_cvt_pk_bf16_f32 v225, v206, v207
    v_accvgpr_read_b32 v204, a48
    v_accvgpr_read_b32 v205, a49
    v_accvgpr_read_b32 v206, a50
    v_accvgpr_read_b32 v207, a51
    v_accvgpr_read_b32 v208, a144
    v_accvgpr_read_b32 v209, a145
    v_accvgpr_read_b32 v210, a146
    v_accvgpr_read_b32 v211, a147
    v_pk_add_f32 v[204:205], v[204:205], v[208:209]
    v_pk_add_f32 v[206:207], v[206:207], v[210:211]
    v_pk_add_f32 v[208:209], v[48:49], v[144:145]
    v_pk_add_f32 v[210:211], v[50:51], v[146:147]
    v_pk_add_f32 v[144:145], v[48:49], v[144:145] neg_lo:[0,1] neg_hi:[0,1]
    v_pk_add_f32 v[146:147], v[50:51], v[146:147] neg_lo:[0,1] neg_hi:[0,1]
    v_pk_fma_f32 v[48:49], v[208:209], s[30:31], v[204:205] op_sel:[0,1,0]
    v_pk_fma_f32 v[50:51], v[210:211], s[30:31], v[206:207] op_sel:[0,1,0]
    v_pk_fma_f32 v[204:205], v[204:205], s[30:31], v[208:209] op_sel_hi:[1,0,1]
    v_pk_fma_f32 v[206:207], v[206:207], s[30:31], v[210:211] op_sel_hi:[1,0,1]
    v_cvt_pk_bf16_f32 v194, v204, v205
    v_cvt_pk_bf16_f32 v195, v206, v207
    ds_write_b64 v249, v[224:225] offset:1216
    v_accvgpr_read_b32 v212, a52
    v_accvgpr_read_b32 v213, a53
    v_accvgpr_read_b32 v214, a54
    v_accvgpr_read_b32 v215, a55
    v_accvgpr_read_b32 v216, a148
    v_accvgpr_read_b32 v217, a149
    v_accvgpr_read_b32 v218, a150
    v_accvgpr_read_b32 v219, a151
    v_pk_add_f32 v[212:213], v[212:213], v[216:217]
    v_pk_add_f32 v[214:215], v[214:215], v[218:219]
    v_pk_add_f32 v[216:217], v[52:53], v[148:149]
    v_pk_add_f32 v[218:219], v[54:55], v[150:151]
    v_pk_add_f32 v[148:149], v[52:53], v[148:149] neg_lo:[0,1] neg_hi:[0,1]
    v_pk_add_f32 v[150:151], v[54:55], v[150:151] neg_lo:[0,1] neg_hi:[0,1]
    v_pk_fma_f32 v[52:53], v[216:217], s[30:31], v[212:213] op_sel:[0,1,0]
    v_pk_fma_f32 v[54:55], v[218:219], s[30:31], v[214:215] op_sel:[0,1,0]
    v_pk_fma_f32 v[212:213], v[212:213], s[30:31], v[216:217] op_sel_hi:[1,0,1]
    v_pk_fma_f32 v[214:215], v[214:215], s[30:31], v[218:219] op_sel_hi:[1,0,1]
    v_cvt_pk_bf16_f32 v196, v212, v213
    v_cvt_pk_bf16_f32 v197, v214, v215
    ds_write_b128 v248, v[194:197] offset:1536
    v_accvgpr_read_b32 v204, a56
    v_accvgpr_read_b32 v205, a57
    v_accvgpr_read_b32 v206, a58
    v_accvgpr_read_b32 v207, a59
    v_accvgpr_read_b32 v208, a152
    v_accvgpr_read_b32 v209, a153
    v_accvgpr_read_b32 v210, a154
    v_accvgpr_read_b32 v211, a155
    v_pk_add_f32 v[204:205], v[204:205], v[208:209]
    v_pk_add_f32 v[206:207], v[206:207], v[210:211]
    v_pk_add_f32 v[208:209], v[56:57], v[152:153]
    v_pk_add_f32 v[210:211], v[58:59], v[154:155]
    v_pk_add_f32 v[152:153], v[56:57], v[152:153] neg_lo:[0,1] neg_hi:[0,1]
    v_pk_add_f32 v[154:155], v[58:59], v[154:155] neg_lo:[0,1] neg_hi:[0,1]
    v_pk_fma_f32 v[56:57], v[208:209], s[30:31], v[204:205] op_sel:[0,1,0]
    v_pk_fma_f32 v[58:59], v[210:211], s[30:31], v[206:207] op_sel:[0,1,0]
    v_pk_fma_f32 v[204:205], v[204:205], s[30:31], v[208:209] op_sel_hi:[1,0,1]
    v_pk_fma_f32 v[206:207], v[206:207], s[30:31], v[210:211] op_sel_hi:[1,0,1]
    v_cvt_pk_bf16_f32 v198, v204, v205
    v_cvt_pk_bf16_f32 v199, v206, v207
    v_accvgpr_read_b32 v204, a60
    v_accvgpr_read_b32 v205, a61
    v_accvgpr_read_b32 v206, a62
    v_accvgpr_read_b32 v207, a63
    v_accvgpr_read_b32 v208, a156
    v_accvgpr_read_b32 v209, a157
    v_accvgpr_read_b32 v210, a158
    v_accvgpr_read_b32 v211, a159
    v_pk_add_f32 v[204:205], v[204:205], v[208:209]
    v_pk_add_f32 v[206:207], v[206:207], v[210:211]
    v_pk_add_f32 v[208:209], v[60:61], v[156:157]
    v_pk_add_f32 v[210:211], v[62:63], v[158:159]
    v_pk_add_f32 v[156:157], v[60:61], v[156:157] neg_lo:[0,1] neg_hi:[0,1]
    v_pk_add_f32 v[158:159], v[62:63], v[158:159] neg_lo:[0,1] neg_hi:[0,1]
    v_pk_fma_f32 v[60:61], v[208:209], s[30:31], v[204:205] op_sel:[0,1,0]
    v_pk_fma_f32 v[62:63], v[210:211], s[30:31], v[206:207] op_sel:[0,1,0]
    v_pk_fma_f32 v[204:205], v[204:205], s[30:31], v[208:209] op_sel_hi:[1,0,1]
    v_pk_fma_f32 v[206:207], v[206:207], s[30:31], v[210:211] op_sel_hi:[1,0,1]
    v_cvt_pk_bf16_f32 v220, v204, v205
    v_cvt_pk_bf16_f32 v221, v206, v207
    ds_write_b64 v249, v[198:199] offset:1600
    v_accvgpr_read_b32 v212, a64
    v_accvgpr_read_b32 v213, a65
    v_accvgpr_read_b32 v214, a66
    v_accvgpr_read_b32 v215, a67
    v_accvgpr_read_b32 v216, a160
    v_accvgpr_read_b32 v217, a161
    v_accvgpr_read_b32 v218, a162
    v_accvgpr_read_b32 v219, a163
    v_pk_add_f32 v[212:213], v[212:213], v[216:217]
    v_pk_add_f32 v[214:215], v[214:215], v[218:219]
    v_pk_add_f32 v[216:217], v[64:65], v[160:161]
    v_pk_add_f32 v[218:219], v[66:67], v[162:163]
    v_pk_add_f32 v[160:161], v[64:65], v[160:161] neg_lo:[0,1] neg_hi:[0,1]
    v_pk_add_f32 v[162:163], v[66:67], v[162:163] neg_lo:[0,1] neg_hi:[0,1]
    v_pk_fma_f32 v[64:65], v[216:217], s[30:31], v[212:213] op_sel:[0,1,0]
    v_pk_fma_f32 v[66:67], v[218:219], s[30:31], v[214:215] op_sel:[0,1,0]
    v_pk_fma_f32 v[212:213], v[212:213], s[30:31], v[216:217] op_sel_hi:[1,0,1]
    v_pk_fma_f32 v[214:215], v[214:215], s[30:31], v[218:219] op_sel_hi:[1,0,1]
    v_cvt_pk_bf16_f32 v222, v212, v213
    v_cvt_pk_bf16_f32 v223, v214, v215
    ds_write_b128 v248, v[220:223] offset:1920
    v_accvgpr_read_b32 v204, a68
    v_accvgpr_read_b32 v205, a69
    v_accvgpr_read_b32 v206, a70
    v_accvgpr_read_b32 v207, a71
    v_accvgpr_read_b32 v208, a164
    v_accvgpr_read_b32 v209, a165
    v_accvgpr_read_b32 v210, a166
    v_accvgpr_read_b32 v211, a167
    v_pk_add_f32 v[204:205], v[204:205], v[208:209]
    v_pk_add_f32 v[206:207], v[206:207], v[210:211]
    v_pk_add_f32 v[208:209], v[68:69], v[164:165]
    v_pk_add_f32 v[210:211], v[70:71], v[166:167]
    v_pk_add_f32 v[164:165], v[68:69], v[164:165] neg_lo:[0,1] neg_hi:[0,1]
    v_pk_add_f32 v[166:167], v[70:71], v[166:167] neg_lo:[0,1] neg_hi:[0,1]
    v_pk_fma_f32 v[68:69], v[208:209], s[30:31], v[204:205] op_sel:[0,1,0]
    v_pk_fma_f32 v[70:71], v[210:211], s[30:31], v[206:207] op_sel:[0,1,0]
    v_pk_fma_f32 v[204:205], v[204:205], s[30:31], v[208:209] op_sel_hi:[1,0,1]
    v_pk_fma_f32 v[206:207], v[206:207], s[30:31], v[210:211] op_sel_hi:[1,0,1]
    v_cvt_pk_bf16_f32 v224, v204, v205
    v_cvt_pk_bf16_f32 v225, v206, v207
    v_accvgpr_read_b32 v204, a72
    v_accvgpr_read_b32 v205, a73
    v_accvgpr_read_b32 v206, a74
    v_accvgpr_read_b32 v207, a75
    v_accvgpr_read_b32 v208, a168
    v_accvgpr_read_b32 v209, a169
    v_accvgpr_read_b32 v210, a170
    v_accvgpr_read_b32 v211, a171
    v_pk_add_f32 v[204:205], v[204:205], v[208:209]
    v_pk_add_f32 v[206:207], v[206:207], v[210:211]
    v_pk_add_f32 v[208:209], v[72:73], v[168:169]
    v_pk_add_f32 v[210:211], v[74:75], v[170:171]
    v_pk_add_f32 v[168:169], v[72:73], v[168:169] neg_lo:[0,1] neg_hi:[0,1]
    v_pk_add_f32 v[170:171], v[74:75], v[170:171] neg_lo:[0,1] neg_hi:[0,1]
    v_pk_fma_f32 v[72:73], v[208:209], s[30:31], v[204:205] op_sel:[0,1,0]
    v_pk_fma_f32 v[74:75], v[210:211], s[30:31], v[206:207] op_sel:[0,1,0]
    v_pk_fma_f32 v[204:205], v[204:205], s[30:31], v[208:209] op_sel_hi:[1,0,1]
    v_pk_fma_f32 v[206:207], v[206:207], s[30:31], v[210:211] op_sel_hi:[1,0,1]
    v_cvt_pk_bf16_f32 v194, v204, v205
    v_cvt_pk_bf16_f32 v195, v206, v207
    ds_write_b64 v249, v[224:225] offset:1984
    v_accvgpr_read_b32 v212, a76
    v_accvgpr_read_b32 v213, a77
    v_accvgpr_read_b32 v214, a78
    v_accvgpr_read_b32 v215, a79
    v_accvgpr_read_b32 v216, a172
    v_accvgpr_read_b32 v217, a173
    v_accvgpr_read_b32 v218, a174
    v_accvgpr_read_b32 v219, a175
    v_pk_add_f32 v[212:213], v[212:213], v[216:217]
    v_pk_add_f32 v[214:215], v[214:215], v[218:219]
    v_pk_add_f32 v[216:217], v[76:77], v[172:173]
    v_pk_add_f32 v[218:219], v[78:79], v[174:175]
    v_pk_add_f32 v[172:173], v[76:77], v[172:173] neg_lo:[0,1] neg_hi:[0,1]
    v_pk_add_f32 v[174:175], v[78:79], v[174:175] neg_lo:[0,1] neg_hi:[0,1]
    v_pk_fma_f32 v[76:77], v[216:217], s[30:31], v[212:213] op_sel:[0,1,0]
    v_pk_fma_f32 v[78:79], v[218:219], s[30:31], v[214:215] op_sel:[0,1,0]
    v_pk_fma_f32 v[212:213], v[212:213], s[30:31], v[216:217] op_sel_hi:[1,0,1]
    v_pk_fma_f32 v[214:215], v[214:215], s[30:31], v[218:219] op_sel_hi:[1,0,1]
    v_cvt_pk_bf16_f32 v196, v212, v213
    v_cvt_pk_bf16_f32 v197, v214, v215
    ds_write_b128 v248, v[194:197] offset:2304
    v_accvgpr_read_b32 v204, a80
    v_accvgpr_read_b32 v205, a81
    v_accvgpr_read_b32 v206, a82
    v_accvgpr_read_b32 v207, a83
    v_accvgpr_read_b32 v208, a176
    v_accvgpr_read_b32 v209, a177
    v_accvgpr_read_b32 v210, a178
    v_accvgpr_read_b32 v211, a179
    v_pk_add_f32 v[204:205], v[204:205], v[208:209]
    v_pk_add_f32 v[206:207], v[206:207], v[210:211]
    v_pk_add_f32 v[208:209], v[80:81], v[176:177]
    v_pk_add_f32 v[210:211], v[82:83], v[178:179]
    v_pk_add_f32 v[176:177], v[80:81], v[176:177] neg_lo:[0,1] neg_hi:[0,1]
    v_pk_add_f32 v[178:179], v[82:83], v[178:179] neg_lo:[0,1] neg_hi:[0,1]
    v_pk_fma_f32 v[80:81], v[208:209], s[30:31], v[204:205] op_sel:[0,1,0]
    v_pk_fma_f32 v[82:83], v[210:211], s[30:31], v[206:207] op_sel:[0,1,0]
    v_pk_fma_f32 v[204:205], v[204:205], s[30:31], v[208:209] op_sel_hi:[1,0,1]
    v_pk_fma_f32 v[206:207], v[206:207], s[30:31], v[210:211] op_sel_hi:[1,0,1]
    v_cvt_pk_bf16_f32 v198, v204, v205
    v_cvt_pk_bf16_f32 v199, v206, v207
    ds_write_b64 v249, v[198:199] offset:2368
    s_waitcnt lgkmcnt(0)
    s_barrier
sub24:
    v_mfma_f32_16x16x32_bf16 v[0:3], a[192:195], v[228:231], v[0:3]
    ds_read_b128 v[204:207], v250 offset:0
    v_accvgpr_read_b32 v220, a84
    v_mfma_f32_16x16x32_bf16 v[4:7], a[196:199], v[228:231], v[4:7]
    ds_read_b128 v[208:211], v250 offset:3104
    v_accvgpr_read_b32 v221, a85
    v_mfma_f32_16x16x32_bf16 v[8:11], a[200:203], v[228:231], v[8:11]
pad9:
    s_cbranch_vccnz pad13
    ds_read_b128 v[228:231], v253 offset:33536
    v_accvgpr_read_b32 v222, a86
    s_waitcnt vmcnt(8)
    v_mfma_f32_16x16x32_bf16 v[0:3], a[204:207], v[232:235], v[0:3]
    buffer_load_dwordx4 a[244:247], v254, s[8:11], s42 offen offset:1024 sc1
    v_mfma_f32_16x16x32_bf16 v[4:7], a[208:211], v[232:235], v[4:7]
    ds_read_b128 v[212:215], v250 offset:6208
    v_accvgpr_read_b32 v223, a87
    v_mfma_f32_16x16x32_bf16 v[8:11], a[212:215], v[232:235], v[8:11]
    ds_read_b128 v[216:219], v250 offset:9312
    v_add_f32 v224, v84, v180
    v_mfma_f32_16x16x32_bf16 v[12:15], a[192:195], v[232:235], v[12:15]
    v_add_f32 v225, v85, v181
    v_add_f32 v226, v86, v182
    v_mfma_f32_16x16x32_bf16 v[12:15], a[204:207], v[236:239], v[12:15]
    buffer_load_dwordx4 a[248:251], v254, s[8:11], s42 offen offset:2048 sc1
    v_mfma_f32_16x16x32_bf16 v[16:19], a[208:211], v[236:239], v[16:19]
    s_add_u32 s44, s40, 393216
    v_add_f32 v227, v87, v183
    v_sub_f32 v180, v84, v180
    v_mfma_f32_16x16x32_bf16 v[16:19], a[196:199], v[232:235], v[16:19]
    s_mov_b32 s42, 927744
    v_sub_f32 v181, v85, v181
    v_sub_f32 v182, v86, v182
    v_mfma_f32_16x16x32_bf16 v[20:23], a[200:203], v[232:235], v[20:23]
    ds_read_b128 v[232:235], v253 offset:33280
    v_sub_f32 v183, v87, v183
    v_mfma_f32_16x16x32_bf16 v[20:23], a[212:215], v[236:239], v[20:23]
    buffer_load_dwordx4 a[252:255], v254, s[8:11], s42 offen offset:0 sc1
    s_waitcnt vmcnt(8)
    v_mfma_f32_16x16x32_bf16 v[0:3], a[216:219], v[236:239], v[0:3]
    s_waitcnt lgkmcnt(5)
    v_fma_f32 v84, v224, s31, v220
    v_fma_f32 v85, v225, s31, v221
    v_mfma_f32_16x16x32_bf16 v[4:7], a[220:223], v[236:239], v[4:7]
    v_fma_f32 v86, v226, s31, v222
    v_fma_f32 v87, v227, s31, v223
    v_mfma_f32_16x16x32_bf16 v[8:11], a[224:227], v[236:239], v[8:11]
    s_waitcnt lgkmcnt(3)
    v_fmac_f32 v224, s30, v220
    v_fmac_f32 v225, s30, v221
    v_mfma_f32_16x16x32_bf16 v[24:27], a[192:195], v[236:239], v[24:27]
    buffer_load_dwordx4 v[240:243], v254, s[8:11], s42 offen offset:1024 sc1
    v_mfma_f32_16x16x32_bf16 v[24:27], a[204:207], v[228:231], v[24:27]
    v_fmac_f32 v226, s30, v222
    v_fmac_f32 v227, s30, v223
    v_mfma_f32_16x16x32_bf16 v[28:31], a[208:211], v[228:231], v[28:31]
    v_cvt_pk_bf16_f32 v192, v224, v225
    v_cvt_pk_bf16_f32 v193, v226, v227
    v_mfma_f32_16x16x32_bf16 v[28:31], a[196:199], v[236:239], v[28:31]
    buffer_load_dwordx4 v[244:247], v254, s[8:11], s42 offen offset:2048 sc1
    v_mfma_f32_16x16x32_bf16 v[32:35], a[200:203], v[236:239], v[32:35]
    ds_read_b128 v[236:239], v253 offset:35104
    v_accvgpr_read_b32 v220, a88
    v_mfma_f32_16x16x32_bf16 v[32:35], a[212:215], v[228:231], v[32:35]
    v_accvgpr_read_b32 v221, a89
    v_accvgpr_read_b32 v222, a90
    v_mfma_f32_16x16x32_bf16 v[12:15], a[216:219], v[228:231], v[12:15]
    buffer_store_dwordx4 v[204:207], v254, s[12:15], s44 offen sc1
    s_add_u32 s44, s40, 396288
    v_accvgpr_read_b32 v223, a91
    v_mfma_f32_16x16x32_bf16 v[16:19], a[220:223], v[228:231], v[16:19]
    v_add_f32 v224, v88, v184
    v_add_f32 v225, v89, v185
    v_mfma_f32_16x16x32_bf16 v[20:23], a[224:227], v[228:231], v[20:23]
    v_add_f32 v226, v90, v186
    v_add_f32 v227, v91, v187
    v_mfma_f32_16x16x32_bf16 v[36:39], a[192:195], v[228:231], v[36:39]
    s_waitcnt lgkmcnt(1)
    v_sub_f32 v184, v88, v184
    v_sub_f32 v185, v89, v185
    v_mfma_f32_16x16x32_bf16 v[36:39], a[204:207], v[232:235], v[36:39]
    v_sub_f32 v186, v90, v186
    v_sub_f32 v187, v91, v187
    v_mfma_f32_16x16x32_bf16 v[40:43], a[208:211], v[232:235], v[40:43]
    v_fma_f32 v88, v224, s31, v220
    v_fma_f32 v89, v225, s31, v221
    v_mfma_f32_16x16x32_bf16 v[40:43], a[196:199], v[228:231], v[40:43]
    v_fma_f32 v90, v226, s31, v222
    v_fma_f32 v91, v227, s31, v223
    v_mfma_f32_16x16x32_bf16 v[44:47], a[200:203], v[228:231], v[44:47]
    ds_read_b128 v[228:231], v253 offset:34848
    v_fmac_f32 v224, s30, v220
    v_mfma_f32_16x16x32_bf16 v[44:47], a[212:215], v[232:235], v[44:47]
    v_fmac_f32 v225, s30, v221
    v_fmac_f32 v226, s30, v222
    v_mfma_f32_16x16x32_bf16 v[24:27], a[216:219], v[232:235], v[24:27]
    buffer_store_dwordx4 v[208:211], v254, s[12:15], s44 offen sc1
    v_fmac_f32 v227, s30, v223
    v_cvt_pk_bf16_f32 v194, v224, v225
    v_mfma_f32_16x16x32_bf16 v[28:31], a[220:223], v[232:235], v[28:31]
    s_waitcnt lgkmcnt(1)
    v_cvt_pk_bf16_f32 v195, v226, v227
    v_accvgpr_read_b32 v220, a92
    v_mfma_f32_16x16x32_bf16 v[32:35], a[224:227], v[232:235], v[32:35]
    ds_read_b128 v[204:207], v250 offset:1024
    v_accvgpr_read_b32 v221, a93
    v_mfma_f32_16x16x32_bf16 v[48:51], a[192:195], v[232:235], v[48:51]
    ds_read_b128 v[208:211], v250 offset:4128
    v_accvgpr_read_b32 v222, a94
    v_mfma_f32_16x16x32_bf16 v[48:51], a[204:207], v[236:239], v[48:51]
    s_add_u32 s44, s40, 399360
    v_accvgpr_read_b32 v223, a95
    v_add_f32 v224, v92, v188
    v_mfma_f32_16x16x32_bf16 v[52:55], a[208:211], v[236:239], v[52:55]
    v_add_f32 v225, v93, v189
    v_add_f32 v226, v94, v190
    v_mfma_f32_16x16x32_bf16 v[52:55], a[196:199], v[232:235], v[52:55]
    v_add_f32 v227, v95, v191
    v_sub_f32 v188, v92, v188
    v_mfma_f32_16x16x32_bf16 v[56:59], a[200:203], v[232:235], v[56:59]
    ds_read_b128 v[232:235], v253 offset:34592
    v_sub_f32 v189, v93, v189
    v_mfma_f32_16x16x32_bf16 v[56:59], a[212:215], v[236:239], v[56:59]
    v_sub_f32 v190, v94, v190
    v_sub_f32 v191, v95, v191
    v_mfma_f32_16x16x32_bf16 v[36:39], a[216:219], v[236:239], v[36:39]
    v_fma_f32 v92, v224, s31, v220
    v_fma_f32 v93, v225, s31, v221
    v_mfma_f32_16x16x32_bf16 v[40:43], a[220:223], v[236:239], v[40:43]
    v_fma_f32 v94, v226, s31, v222
    v_fma_f32 v95, v227, s31, v223
    v_mfma_f32_16x16x32_bf16 v[44:47], a[224:227], v[236:239], v[44:47]
    v_fmac_f32 v224, s30, v220
    v_fmac_f32 v225, s30, v221
    v_mfma_f32_16x16x32_bf16 v[60:63], a[192:195], v[236:239], v[60:63]
    s_waitcnt lgkmcnt(3)
    v_fmac_f32 v226, s30, v222
    v_fmac_f32 v227, s30, v223
    v_mfma_f32_16x16x32_bf16 v[60:63], a[204:207], v[228:231], v[60:63]
    buffer_store_dwordx4 v[212:215], v254, s[12:15], s44 offen sc1
    v_cvt_pk_bf16_f32 v196, v224, v225
    v_cvt_pk_bf16_f32 v197, v226, v227
    v_mfma_f32_16x16x32_bf16 v[64:67], a[208:211], v[228:231], v[64:67]
    ds_write_b64 v249, v[196:197] offset:2752
    v_mfma_f32_16x16x32_bf16 v[64:67], a[196:199], v[236:239], v[64:67]
    v_accvgpr_read_b32 v220, a96
    v_accvgpr_read_b32 v221, a97
    v_mfma_f32_16x16x32_bf16 v[68:71], a[200:203], v[236:239], v[68:71]
    ds_read_b128 v[236:239], v253 offset:34336
    v_accvgpr_read_b32 v222, a98
    v_mfma_f32_16x16x32_bf16 v[68:71], a[212:215], v[228:231], v[68:71]
    ds_write_b128 v248, v[192:195] offset:2688
    v_mfma_f32_16x16x32_bf16 v[48:51], a[216:219], v[228:231], v[48:51]
    s_add_u32 s44, s40, 402432
    v_accvgpr_read_b32 v223, a99
    v_fma_f32 v224, v220, s34, v96 div:2
    v_mfma_f32_16x16x32_bf16 v[52:55], a[220:223], v[228:231], v[52:55]
    v_fma_f32 v225, v221, s34, v97 div:2
    v_fma_f32 v226, v222, s34, v98 div:2
    v_mfma_f32_16x16x32_bf16 v[56:59], a[224:227], v[228:231], v[56:59]
    v_fma_f32 v227, v223, s34, v99 div:2
    v_fma_f32 v96, v220, s35, v96 mul:2
    v_mfma_f32_16x16x32_bf16 v[72:75], a[192:195], v[228:231], v[72:75]
    s_waitcnt lgkmcnt(3)
    v_fma_f32 v97, v221, s35, v97 mul:2
    v_fma_f32 v98, v222, s35, v98 mul:2
    v_fma_f32 v99, v223, s35, v99 mul:2
    v_mfma_f32_16x16x32_bf16 v[72:75], a[204:207], v[232:235], v[72:75]
    v_cvt_pk_bf16_f32 v198, v224, v225
    v_cvt_pk_bf16_f32 v199, v226, v227
    v_mfma_f32_16x16x32_bf16 v[76:79], a[208:211], v[232:235], v[76:79]
    v_accvgpr_write_b32 a0, v198
    v_accvgpr_write_b32 a1, v199
    v_mfma_f32_16x16x32_bf16 v[76:79], a[196:199], v[228:231], v[76:79]
    v_accvgpr_read_b32 v220, a100
    v_accvgpr_read_b32 v221, a101
    v_mfma_f32_16x16x32_bf16 v[80:83], a[200:203], v[228:231], v[80:83]
    ds_read_b128 v[228:231], v253 offset:34064
    v_accvgpr_read_b32 v222, a102
    v_mfma_f32_16x16x32_bf16 v[80:83], a[212:215], v[232:235], v[80:83]
    v_accvgpr_read_b32 v223, a103
    v_fma_f32 v224, v220, s34, v100 div:2
    v_mfma_f32_16x16x32_bf16 v[60:63], a[216:219], v[232:235], v[60:63]
    buffer_store_dwordx4 v[216:219], v254, s[12:15], s44 offen sc1
    v_fma_f32 v225, v221, s34, v101 div:2
    v_fma_f32 v226, v222, s34, v102 div:2
    v_mfma_f32_16x16x32_bf16 v[64:67], a[220:223], v[232:235], v[64:67]
    s_waitcnt lgkmcnt(2)
    v_fma_f32 v227, v223, s34, v103 div:2
    v_fma_f32 v100, v220, s35, v100 mul:2
    v_mfma_f32_16x16x32_bf16 v[68:71], a[224:227], v[232:235], v[68:71]
    s_mov_b32 s42, 958464
    v_fma_f32 v101, v221, s35, v101 mul:2
    v_fma_f32 v102, v222, s35, v102 mul:2
    v_mfma_f32_16x16x32_bf16 v[84:87], a[192:195], v[232:235], v[84:87]
    buffer_load_dwordx4 a[192:195], v254, s[8:11], s42 offen offset:0 sc1
    v_mfma_f32_16x16x32_bf16 v[88:91], a[196:199], v[232:235], v[88:91]
    s_waitcnt lgkmcnt(0)
    v_fma_f32 v103, v223, s35, v103 mul:2
    v_cvt_pk_bf16_f32 v200, v224, v225
    v_mfma_f32_16x16x32_bf16 v[92:95], a[200:203], v[232:235], v[92:95]
    s_barrier
    v_mfma_f32_16x16x32_bf16 v[84:87], a[204:207], v[236:239], v[84:87]
    ds_read_b128 v[232:235], v253 offset:15600
    v_cvt_pk_bf16_f32 v201, v226, v227
    v_mfma_f32_16x16x32_bf16 v[88:91], a[208:211], v[236:239], v[88:91]
    buffer_load_dwordx4 a[196:199], v254, s[8:11], s42 offen offset:1024 sc1
    v_mfma_f32_16x16x32_bf16 v[92:95], a[212:215], v[236:239], v[92:95]
    v_accvgpr_write_b32 a2, v200
    v_accvgpr_write_b32 a3, v201
    v_mfma_f32_16x16x32_bf16 v[72:75], a[216:219], v[236:239], v[72:75]
    v_accvgpr_read_b32 v220, a104
    v_accvgpr_read_b32 v221, a105
    v_mfma_f32_16x16x32_bf16 v[76:79], a[220:223], v[236:239], v[76:79]
    buffer_load_dwordx4 a[200:203], v254, s[8:11], s42 offen offset:2048 sc1
    v_mfma_f32_16x16x32_bf16 v[80:83], a[224:227], v[236:239], v[80:83]
    ds_read_b128 v[236:239], v253 offset:15328
    v_accvgpr_read_b32 v222, a106
    v_mfma_f32_16x16x32_bf16 v[84:87], a[216:219], v[228:231], v[84:87]
    s_mov_b32 s42, 961536
    v_accvgpr_read_b32 v223, a107
    v_fma_f32 v224, v220, s34, v104 div:2
    v_mfma_f32_16x16x32_bf16 v[88:91], a[220:223], v[228:231], v[88:91]
    buffer_load_dwordx4 a[204:207], v254, s[8:11], s42 offen offset:0 sc1
    v_mfma_f32_16x16x32_bf16 v[92:95], a[224:227], v[228:231], v[92:95]
    ds_read_b128 v[228:231], v253 offset:15072
    v_fma_f32 v225, v221, s34, v105 div:2
    v_fma_f32 v226, v222, s34, v106 div:2
    s_waitcnt vmcnt(14)
    s_waitcnt lgkmcnt(2)
sub25:
    v_mfma_f32_16x16x32_bf16 v[0:3], a[228:231], v[232:235], v[0:3]
    v_fma_f32 v227, v223, s34, v107 div:2
    v_fma_f32 v104, v220, s35, v104 mul:2
    v_mfma_f32_16x16x32_bf16 v[4:7], a[232:235], v[232:235], v[4:7]
    s_waitcnt vmcnt(11) lgkmcnt(1)
    v_fma_f32 v105, v221, s35, v105 mul:2
    v_fma_f32 v106, v222, s35, v106 mul:2
    v_mfma_f32_16x16x32_bf16 v[8:11], a[236:239], v[232:235], v[8:11]
    ds_read_b128 v[232:235], v253 offset:14816
    v_fma_f32 v107, v223, s35, v107 mul:2
    v_mfma_f32_16x16x32_bf16 v[0:3], a[240:243], v[236:239], v[0:3]
    buffer_load_dwordx4 a[208:211], v254, s[8:11], s42 offen offset:1024 sc1
    v_mfma_f32_16x16x32_bf16 v[4:7], a[244:247], v[236:239], v[4:7]
    v_cvt_pk_bf16_f32 v202, v224, v225
    v_cvt_pk_bf16_f32 v203, v226, v227
    v_mfma_f32_16x16x32_bf16 v[8:11], a[248:251], v[236:239], v[8:11]
    v_accvgpr_write_b32 a4, v202
    v_accvgpr_write_b32 a5, v203
    v_mfma_f32_16x16x32_bf16 v[12:15], a[228:231], v[236:239], v[12:15]
    s_waitcnt lgkmcnt(1)
    v_accvgpr_read_b32 v220, a108
    v_accvgpr_read_b32 v221, a109
    v_mfma_f32_16x16x32_bf16 v[12:15], a[240:243], v[228:231], v[12:15]
    buffer_load_dwordx4 a[212:215], v254, s[8:11], s42 offen offset:2048 sc1
    v_mfma_f32_16x16x32_bf16 v[16:19], a[244:247], v[228:231], v[16:19]
    v_accvgpr_read_b32 v222, a110
    v_accvgpr_read_b32 v223, a111
    v_mfma_f32_16x16x32_bf16 v[16:19], a[232:235], v[236:239], v[16:19]
    s_mov_b32 s42, 964608
    v_fma_f32 v224, v220, s34, v108 div:2
    v_fma_f32 v225, v221, s34, v109 div:2
    v_mfma_f32_16x16x32_bf16 v[20:23], a[236:239], v[236:239], v[20:23]
    ds_read_b128 v[236:239], v253 offset:14560
    v_fma_f32 v226, v222, s34, v110 div:2
    v_mfma_f32_16x16x32_bf16 v[20:23], a[248:251], v[228:231], v[20:23]
    buffer_load_dwordx4 a[216:219], v254, s[8:11], s42 offen offset:0 sc1
    s_waitcnt vmcnt(11)
    v_mfma_f32_16x16x32_bf16 v[0:3], a[252:255], v[228:231], v[0:3]
    v_fma_f32 v227, v223, s34, v111 div:2
    v_fma_f32 v108, v220, s35, v108 mul:2
    v_mfma_f32_16x16x32_bf16 v[4:7], v[240:243], v[228:231], v[4:7]
    v_fma_f32 v109, v221, s35, v109 mul:2
    v_fma_f32 v110, v222, s35, v110 mul:2
    v_mfma_f32_16x16x32_bf16 v[8:11], v[244:247], v[228:231], v[8:11]
    s_waitcnt lgkmcnt(1)
    v_fma_f32 v111, v223, s35, v111 mul:2
    v_cvt_pk_bf16_f32 v192, v224, v225
    v_mfma_f32_16x16x32_bf16 v[24:27], a[228:231], v[228:231], v[24:27]
    buffer_load_dwordx4 a[220:223], v254, s[8:11], s42 offen offset:1024 sc1
    v_mfma_f32_16x16x32_bf16 v[24:27], a[240:243], v[232:235], v[24:27]
    s_add_u32 s44, s40, 394240
    v_cvt_pk_bf16_f32 v193, v226, v227
    v_accvgpr_write_b32 a12, v192
    v_mfma_f32_16x16x32_bf16 v[28:31], a[244:247], v[232:235], v[28:31]
    v_accvgpr_write_b32 a13, v193
    v_accvgpr_read_b32 v220, a112
    v_mfma_f32_16x16x32_bf16 v[28:31], a[232:235], v[228:231], v[28:31]
    buffer_load_dwordx4 a[224:227], v254, s[8:11], s42 offen offset:2048 sc1
    v_mfma_f32_16x16x32_bf16 v[32:35], a[236:239], v[228:231], v[32:35]
    ds_read_b128 v[228:231], v253 offset:16384
    v_accvgpr_read_b32 v221, a113
    v_accvgpr_read_b32 v222, a114
    v_mfma_f32_16x16x32_bf16 v[32:35], a[248:251], v[232:235], v[32:35]
    ds_read_b128 a[84:87], v250 offset:7232
    v_accvgpr_read_b32 v223, a115
    v_mfma_f32_16x16x32_bf16 v[12:15], a[252:255], v[232:235], v[12:15]
    v_fma_f32 v224, v220, s34, v112 div:2
    v_fma_f32 v225, v221, s34, v113 div:2
    v_mfma_f32_16x16x32_bf16 v[16:19], v[240:243], v[232:235], v[16:19]
    v_fma_f32 v226, v222, s34, v114 div:2
    v_fma_f32 v227, v223, s34, v115 div:2
    v_mfma_f32_16x16x32_bf16 v[20:23], v[244:247], v[232:235], v[20:23]
    v_fma_f32 v112, v220, s35, v112 mul:2
    v_fma_f32 v113, v221, s35, v113 mul:2
    v_mfma_f32_16x16x32_bf16 v[36:39], a[228:231], v[232:235], v[36:39]
    s_waitcnt lgkmcnt(2)
    v_fma_f32 v114, v222, s35, v114 mul:2
    v_fma_f32 v115, v223, s35, v115 mul:2
    v_mfma_f32_16x16x32_bf16 v[36:39], a[240:243], v[236:239], v[36:39]
    v_cvt_pk_bf16_f32 v194, v224, v225
    v_cvt_pk_bf16_f32 v195, v226, v227
    v_mfma_f32_16x16x32_bf16 v[40:43], a[244:247], v[236:239], v[40:43]
    ds_read_b128 a[88:91], v250 offset:10336
    v_accvgpr_write_b32 a14, v194
    v_mfma_f32_16x16x32_bf16 v[40:43], a[232:235], v[232:235], v[40:43]
    v_accvgpr_write_b32 a15, v195
    v_accvgpr_read_b32 v220, a116
    v_mfma_f32_16x16x32_bf16 v[44:47], a[236:239], v[232:235], v[44:47]
    ds_read_b128 v[232:235], v253 offset:16128
    v_accvgpr_read_b32 v221, a117
    v_mfma_f32_16x16x32_bf16 v[44:47], a[248:251], v[236:239], v[44:47]
    buffer_store_dwordx4 v[204:207], v254, s[12:15], s44 offen sc1
    v_accvgpr_read_b32 v222, a118
    v_accvgpr_read_b32 v223, a119
    v_mfma_f32_16x16x32_bf16 v[24:27], a[252:255], v[236:239], v[24:27]
    v_fma_f32 v224, v220, s34, v116 div:2
    v_fma_f32 v225, v221, s34, v117 div:2
    v_mfma_f32_16x16x32_bf16 v[28:31], v[240:243], v[236:239], v[28:31]
    v_fma_f32 v226, v222, s34, v118 div:2
    v_fma_f32 v227, v223, s34, v119 div:2
    v_mfma_f32_16x16x32_bf16 v[32:35], v[244:247], v[236:239], v[32:35]
    s_waitcnt lgkmcnt(3)
    v_fma_f32 v116, v220, s35, v116 mul:2
    v_fma_f32 v117, v221, s35, v117 mul:2
    v_mfma_f32_16x16x32_bf16 v[48:51], a[228:231], v[236:239], v[48:51]
    ds_read_b128 a[92:95], v250 offset:2048
    v_fma_f32 v118, v222, s35, v118 mul:2
    v_mfma_f32_16x16x32_bf16 v[48:51], a[240:243], v[228:231], v[48:51]
    s_add_u32 s44, s40, 397312
    v_fma_f32 v119, v223, s35, v119 mul:2
    v_cvt_pk_bf16_f32 v196, v224, v225
    v_mfma_f32_16x16x32_bf16 v[52:55], a[244:247], v[228:231], v[52:55]
    v_cvt_pk_bf16_f32 v197, v226, v227
    v_accvgpr_write_b32 a16, v196
    v_mfma_f32_16x16x32_bf16 v[52:55], a[232:235], v[236:239], v[52:55]
    v_accvgpr_write_b32 a17, v197
    v_accvgpr_read_b32 v220, a24
    v_mfma_f32_16x16x32_bf16 v[56:59], a[236:239], v[236:239], v[56:59]
    ds_read_b128 v[236:239], v253 offset:15872
    v_accvgpr_read_b32 v221, a25
    v_mfma_f32_16x16x32_bf16 v[56:59], a[248:251], v[228:231], v[56:59]
    v_accvgpr_read_b32 v222, a26
    v_accvgpr_read_b32 v223, a27
    v_mfma_f32_16x16x32_bf16 v[36:39], a[252:255], v[228:231], v[36:39]
    ds_read_b128 a[96:99], v250 offset:5152
    v_accvgpr_read_b32 v224, a120
    v_accvgpr_read_b32 v225, a121
    v_mfma_f32_16x16x32_bf16 v[40:43], v[240:243], v[228:231], v[40:43]
    v_accvgpr_read_b32 v226, a122
    v_accvgpr_read_b32 v227, a123
    v_mfma_f32_16x16x32_bf16 v[44:47], v[244:247], v[228:231], v[44:47]
    v_sub_f32 v220, v220, v224
    v_sub_f32 v221, v221, v225
    v_mfma_f32_16x16x32_bf16 v[60:63], a[228:231], v[228:231], v[60:63]
    s_waitcnt lgkmcnt(3)
    v_sub_f32 v222, v222, v226
    v_sub_f32 v223, v223, v227
    v_mfma_f32_16x16x32_bf16 v[60:63], a[240:243], v[232:235], v[60:63]
    v_fma_f32 v224, v220, s34, v120 div:2
    v_fma_f32 v225, v221, s34, v121 div:2
    v_mfma_f32_16x16x32_bf16 v[64:67], a[244:247], v[232:235], v[64:67]
    v_fma_f32 v226, v222, s34, v122 div:2
    v_fma_f32 v227, v223, s34, v123 div:2
    v_mfma_f32_16x16x32_bf16 v[64:67], a[232:235], v[228:231], v[64:67]
    v_fma_f32 v120, v220, s35, v120 mul:2
    v_fma_f32 v121, v221, s35, v121 mul:2
    v_mfma_f32_16x16x32_bf16 v[68:71], a[236:239], v[228:231], v[68:71]
    ds_read_b128 v[228:231], v253 offset:15616
    v_fma_f32 v122, v222, s35, v122 mul:2
    v_mfma_f32_16x16x32_bf16 v[68:71], a[248:251], v[232:235], v[68:71]
    ds_read_b128 a[100:103], v250 offset:8256
    v_fma_f32 v123, v223, s35, v123 mul:2
    v_mfma_f32_16x16x32_bf16 v[48:51], a[252:255], v[232:235], v[48:51]
    buffer_store_dwordx4 v[208:211], v254, s[12:15], s44 offen sc1
    v_cvt_pk_bf16_f32 v198, v224, v225
    v_cvt_pk_bf16_f32 v199, v226, v227
    v_mfma_f32_16x16x32_bf16 v[52:55], v[240:243], v[232:235], v[52:55]
    v_accvgpr_read_b32 v220, a28
    v_accvgpr_read_b32 v221, a29
    v_mfma_f32_16x16x32_bf16 v[56:59], v[244:247], v[232:235], v[56:59]
    v_accvgpr_read_b32 v222, a30
    v_accvgpr_read_b32 v223, a31
    v_mfma_f32_16x16x32_bf16 v[72:75], a[228:231], v[232:235], v[72:75]
    s_waitcnt lgkmcnt(3)
    v_accvgpr_read_b32 v224, a124
    v_accvgpr_read_b32 v225, a125
    v_mfma_f32_16x16x32_bf16 v[72:75], a[240:243], v[236:239], v[72:75]
    ds_read_b128 a[104:107], v250 offset:11360
    v_accvgpr_read_b32 v226, a126
    v_mfma_f32_16x16x32_bf16 v[76:79], a[244:247], v[236:239], v[76:79]
    v_accvgpr_read_b32 v227, a127
    v_sub_f32 v220, v220, v224
    v_mfma_f32_16x16x32_bf16 v[76:79], a[232:235], v[232:235], v[76:79]
    s_add_u32 s44, s40, 400384
    v_sub_f32 v221, v221, v225
    v_sub_f32 v222, v222, v226
    v_mfma_f32_16x16x32_bf16 v[80:83], a[236:239], v[232:235], v[80:83]
    ds_read_b128 v[232:235], v253 offset:15344
    v_sub_f32 v223, v223, v227
    v_mfma_f32_16x16x32_bf16 v[80:83], a[248:251], v[236:239], v[80:83]
    v_fma_f32 v224, v220, s34, v124 div:2
    v_fma_f32 v225, v221, s34, v125 div:2
    v_mfma_f32_16x16x32_bf16 v[60:63], a[252:255], v[236:239], v[60:63]
    v_fma_f32 v226, v222, s34, v126 div:2
    v_fma_f32 v227, v223, s34, v127 div:2
    v_mfma_f32_16x16x32_bf16 v[64:67], v[240:243], v[236:239], v[64:67]
    s_waitcnt lgkmcnt(3)
    v_fma_f32 v124, v220, s35, v124 mul:2
    v_fma_f32 v125, v221, s35, v125 mul:2
    v_mfma_f32_16x16x32_bf16 v[68:71], v[244:247], v[236:239], v[68:71]
    s_mov_b32 s42, 995328
    v_fma_f32 v126, v222, s35, v126 mul:2
    v_fma_f32 v127, v223, s35, v127 mul:2
    v_cvt_pk_bf16_f32 v200, v224, v225
    v_mfma_f32_16x16x32_bf16 v[84:87], a[228:231], v[236:239], v[84:87]
    buffer_load_dwordx4 a[228:231], v254, s[8:11], s42 offen offset:0 sc1
    v_mfma_f32_16x16x32_bf16 v[88:91], a[232:235], v[236:239], v[88:91]
    s_waitcnt lgkmcnt(0)
    v_cvt_pk_bf16_f32 v201, v226, v227
    v_mfma_f32_16x16x32_bf16 v[92:95], a[236:239], v[236:239], v[92:95]
    s_barrier
    v_mfma_f32_16x16x32_bf16 v[84:87], a[240:243], v[228:231], v[84:87]
    ds_read_b128 v[236:239], v253 offset:17680
    v_mfma_f32_16x16x32_bf16 v[88:91], a[244:247], v[228:231], v[88:91]
    buffer_load_dwordx4 a[232:235], v254, s[8:11], s42 offen offset:1024 sc1
    v_mfma_f32_16x16x32_bf16 v[92:95], a[248:251], v[228:231], v[92:95]
    ds_write_b128 v248, a[0:3] offset:0
    v_mfma_f32_16x16x32_bf16 v[72:75], a[252:255], v[228:231], v[72:75]
    v_mfma_f32_16x16x32_bf16 v[76:79], v[240:243], v[228:231], v[76:79]
    buffer_load_dwordx4 a[236:239], v254, s[8:11], s42 offen offset:2048 sc1
    v_mfma_f32_16x16x32_bf16 v[80:83], v[244:247], v[228:231], v[80:83]
    ds_read_b128 v[228:231], v253 offset:17408
    v_mfma_f32_16x16x32_bf16 v[84:87], a[252:255], v[232:235], v[84:87]
    s_mov_b32 s42, 998400
    v_mfma_f32_16x16x32_bf16 v[88:91], v[240:243], v[232:235], v[88:91]
    buffer_load_dwordx4 a[240:243], v254, s[8:11], s42 offen offset:0 sc1
    v_mfma_f32_16x16x32_bf16 v[92:95], v[244:247], v[232:235], v[92:95]
    ds_read_b128 v[232:235], v253 offset:17152
    s_waitcnt vmcnt(12)
    s_waitcnt lgkmcnt(3)
sub26:
    v_mfma_f32_16x16x32_bf16 v[0:3], a[192:195], v[236:239], v[0:3]
    s_waitcnt vmcnt(9) lgkmcnt(1)
    v_mfma_f32_16x16x32_bf16 v[4:7], a[196:199], v[236:239], v[4:7]
    ds_write_b64 v249, a[4:5] offset:64
    v_mfma_f32_16x16x32_bf16 v[8:11], a[200:203], v[236:239], v[8:11]
    ds_read_b128 v[236:239], v253 offset:16896
    v_mfma_f32_16x16x32_bf16 v[0:3], a[204:207], v[228:231], v[0:3]
    buffer_load_dwordx4 a[244:247], v254, s[8:11], s42 offen offset:1024 sc1
    v_mfma_f32_16x16x32_bf16 v[4:7], a[208:211], v[228:231], v[4:7]
    ds_write_b128 v248, v[198:201] offset:768
    v_mfma_f32_16x16x32_bf16 v[8:11], a[212:215], v[228:231], v[8:11]
    v_accvgpr_read_b32 v220, a32
    v_accvgpr_read_b32 v221, a33
    v_mfma_f32_16x16x32_bf16 v[12:15], a[192:195], v[228:231], v[12:15]
    s_waitcnt lgkmcnt(3)
    v_accvgpr_read_b32 v222, a34
    v_accvgpr_read_b32 v223, a35
    v_mfma_f32_16x16x32_bf16 v[12:15], a[204:207], v[232:235], v[12:15]
    buffer_load_dwordx4 a[248:251], v254, s[8:11], s42 offen offset:2048 sc1
    v_accvgpr_read_b32 v224, a128
    v_mfma_f32_16x16x32_bf16 v[16:19], a[208:211], v[232:235], v[16:19]
    v_accvgpr_read_b32 v225, a129
    v_accvgpr_read_b32 v226, a130
    v_mfma_f32_16x16x32_bf16 v[16:19], a[196:199], v[228:231], v[16:19]
    s_mov_b32 s42, 1001472
    v_accvgpr_read_b32 v227, a131
    v_sub_f32 v220, v220, v224
    v_mfma_f32_16x16x32_bf16 v[20:23], a[200:203], v[228:231], v[20:23]
    ds_read_b128 v[228:231], v253 offset:16640
    v_sub_f32 v221, v221, v225
    v_mfma_f32_16x16x32_bf16 v[20:23], a[212:215], v[232:235], v[20:23]
    buffer_load_dwordx4 a[252:255], v254, s[8:11], s42 offen offset:0 sc1
    s_waitcnt vmcnt(9)
    v_mfma_f32_16x16x32_bf16 v[0:3], a[216:219], v[232:235], v[0:3]
    ds_write_b128 v248, a[12:15] offset:384
    v_mfma_f32_16x16x32_bf16 v[4:7], a[220:223], v[232:235], v[4:7]
    v_sub_f32 v222, v222, v226
    v_sub_f32 v223, v223, v227
    v_mfma_f32_16x16x32_bf16 v[8:11], a[224:227], v[232:235], v[8:11]
    s_waitcnt lgkmcnt(3)
    v_fma_f32 v224, v220, s34, v128 div:2
    v_fma_f32 v225, v221, s34, v129 div:2
    v_mfma_f32_16x16x32_bf16 v[24:27], a[192:195], v[232:235], v[24:27]
    buffer_load_dwordx4 v[240:243], v254, s[8:11], s42 offen offset:1024 sc1
    v_mfma_f32_16x16x32_bf16 v[24:27], a[204:207], v[236:239], v[24:27]
    v_fma_f32 v226, v222, s34, v130 div:2
    v_fma_f32 v227, v223, s34, v131 div:2
    v_mfma_f32_16x16x32_bf16 v[28:31], a[208:211], v[236:239], v[28:31]
    v_fma_f32 v128, v220, s35, v128 mul:2
    v_fma_f32 v129, v221, s35, v129 mul:2
    v_mfma_f32_16x16x32_bf16 v[28:31], a[196:199], v[232:235], v[28:31]
    buffer_load_dwordx4 v[244:247], v254, s[8:11], s42 offen offset:2048 sc1
    v_mfma_f32_16x16x32_bf16 v[32:35], a[200:203], v[232:235], v[32:35]
    ds_read_b128 v[232:235], v253 offset:18464
    v_fma_f32 v130, v222, s35, v130 mul:2
    v_mfma_f32_16x16x32_bf16 v[32:35], a[212:215], v[236:239], v[32:35]
    ds_write_b64 v249, a[16:17] offset:448
    v_mfma_f32_16x16x32_bf16 v[12:15], a[216:219], v[236:239], v[12:15]
    buffer_store_dwordx4 a[84:87], v254, s[12:15], s44 offen sc1
    s_add_u32 s44, s40, 403456
    v_mfma_f32_16x16x32_bf16 v[16:19], a[220:223], v[236:239], v[16:19]
    v_fma_f32 v131, v223, s35, v131 mul:2
    v_cvt_pk_bf16_f32 v202, v224, v225
    v_mfma_f32_16x16x32_bf16 v[20:23], a[224:227], v[236:239], v[20:23]
    s_waitcnt lgkmcnt(3)
    v_cvt_pk_bf16_f32 v203, v226, v227
    v_mfma_f32_16x16x32_bf16 v[36:39], a[192:195], v[236:239], v[36:39]
    buffer_store_dwordx4 a[88:91], v254, s[12:15], s44 offen sc1
    s_add_u32 s44, s40, 395264
    v_mfma_f32_16x16x32_bf16 v[36:39], a[204:207], v[228:231], v[36:39]
    ds_write_b64 v249, v[202:203] offset:832
    v_mfma_f32_16x16x32_bf16 v[40:43], a[208:211], v[228:231], v[40:43]
    v_accvgpr_read_b32 v220, a36
    v_accvgpr_read_b32 v221, a37
    v_mfma_f32_16x16x32_bf16 v[40:43], a[196:199], v[236:239], v[40:43]
    v_accvgpr_read_b32 v222, a38
    v_accvgpr_read_b32 v223, a39
    v_accvgpr_read_b32 v224, a132
    v_mfma_f32_16x16x32_bf16 v[44:47], a[200:203], v[236:239], v[44:47]
    ds_read_b128 v[236:239], v253 offset:18208
    v_mfma_f32_16x16x32_bf16 v[44:47], a[212:215], v[228:231], v[44:47]
    v_accvgpr_read_b32 v225, a133
    v_accvgpr_read_b32 v226, a134
    v_mfma_f32_16x16x32_bf16 v[24:27], a[216:219], v[228:231], v[24:27]
    v_accvgpr_read_b32 v227, a135
    v_sub_f32 v220, v220, v224
    v_mfma_f32_16x16x32_bf16 v[28:31], a[220:223], v[228:231], v[28:31]
    v_sub_f32 v221, v221, v225
    v_sub_f32 v222, v222, v226
    v_mfma_f32_16x16x32_bf16 v[32:35], a[224:227], v[228:231], v[32:35]
    v_sub_f32 v223, v223, v227
    v_fma_f32 v224, v220, s34, v132 div:2
    v_mfma_f32_16x16x32_bf16 v[48:51], a[192:195], v[228:231], v[48:51]
    s_waitcnt lgkmcnt(3)
    v_fma_f32 v225, v221, s34, v133 div:2
    v_fma_f32 v226, v222, s34, v134 div:2
    v_mfma_f32_16x16x32_bf16 v[48:51], a[204:207], v[232:235], v[48:51]
    v_fma_f32 v227, v223, s34, v135 div:2
    v_fma_f32 v132, v220, s35, v132 mul:2
    v_mfma_f32_16x16x32_bf16 v[52:55], a[208:211], v[232:235], v[52:55]
    buffer_store_dwordx4 a[92:95], v254, s[12:15], s44 offen sc1
    v_fma_f32 v133, v221, s35, v133 mul:2
    v_fma_f32 v134, v222, s35, v134 mul:2
    v_mfma_f32_16x16x32_bf16 v[52:55], a[196:199], v[228:231], v[52:55]
    v_fma_f32 v135, v223, s35, v135 mul:2
    v_cvt_pk_bf16_f32 v192, v224, v225
    v_mfma_f32_16x16x32_bf16 v[56:59], a[200:203], v[228:231], v[56:59]
    ds_read_b128 v[228:231], v253 offset:17952
    v_cvt_pk_bf16_f32 v193, v226, v227
    v_mfma_f32_16x16x32_bf16 v[56:59], a[212:215], v[232:235], v[56:59]
    v_accvgpr_read_b32 v220, a40
    v_accvgpr_read_b32 v221, a41
    v_mfma_f32_16x16x32_bf16 v[36:39], a[216:219], v[232:235], v[36:39]
pad10:
    s_cbranch_vccnz warm_ret
    v_accvgpr_read_b32 v222, a42
    v_accvgpr_read_b32 v223, a43
    v_mfma_f32_16x16x32_bf16 v[40:43], a[220:223], v[232:235], v[40:43]
    v_accvgpr_read_b32 v224, a136
    v_accvgpr_read_b32 v225, a137
    v_mfma_f32_16x16x32_bf16 v[44:47], a[224:227], v[232:235], v[44:47]
    s_add_u32 s44, s40, 398336
    v_accvgpr_read_b32 v226, a138
    v_accvgpr_read_b32 v227, a139
    v_mfma_f32_16x16x32_bf16 v[60:63], a[192:195], v[232:235], v[60:63]
    s_waitcnt lgkmcnt(1)
    v_sub_f32 v220, v220, v224
    v_sub_f32 v221, v221, v225
    v_mfma_f32_16x16x32_bf16 v[60:63], a[204:207], v[236:239], v[60:63]
    v_sub_f32 v222, v222, v226
    v_sub_f32 v223, v223, v227
    v_mfma_f32_16x16x32_bf16 v[64:67], a[208:211], v[236:239], v[64:67]
    v_fma_f32 v224, v220, s34, v136 div:2
    v_fma_f32 v225, v221, s34, v137 div:2
    v_mfma_f32_16x16x32_bf16 v[64:67], a[196:199], v[232:235], v[64:67]
    v_fma_f32 v226, v222, s34, v138 div:2
    v_fma_f32 v227, v223, s34, v139 div:2
    v_mfma_f32_16x16x32_bf16 v[68:71], a[200:203], v[232:235], v[68:71]
    ds_read_b128 v[232:235], v253 offset:17696
    v_fma_f32 v136, v220, s35, v136 mul:2
    v_mfma_f32_16x16x32_bf16 v[68:71], a[212:215], v[236:239], v[68:71]
    v_fma_f32 v137, v221, s35, v137 mul:2
    v_fma_f32 v138, v222, s35, v138 mul:2
    v_fma_f32 v139, v223, s35, v139 mul:2
    v_mfma_f32_16x16x32_bf16 v[48:51], a[216:219], v[236:239], v[48:51]
    v_cvt_pk_bf16_f32 v194, v224, v225
    v_cvt_pk_bf16_f32 v195, v226, v227
    v_mfma_f32_16x16x32_bf16 v[52:55], a[220:223], v[236:239], v[52:55]
    ds_write_b128 v248, v[192:195] offset:1152
    v_mfma_f32_16x16x32_bf16 v[56:59], a[224:227], v[236:239], v[56:59]
    v_accvgpr_read_b32 v220, a44
    v_accvgpr_read_b32 v221, a45
    v_mfma_f32_16x16x32_bf16 v[72:75], a[192:195], v[236:239], v[72:75]
    s_waitcnt lgkmcnt(2)
    v_accvgpr_read_b32 v222, a46
    v_accvgpr_read_b32 v223, a47
    v_mfma_f32_16x16x32_bf16 v[72:75], a[204:207], v[228:231], v[72:75]
    v_accvgpr_read_b32 v224, a140
    v_accvgpr_read_b32 v225, a141
    v_mfma_f32_16x16x32_bf16 v[76:79], a[208:211], v[228:231], v[76:79]
    v_accvgpr_read_b32 v226, a142
    v_accvgpr_read_b32 v227, a143
    v_mfma_f32_16x16x32_bf16 v[76:79], a[196:199], v[236:239], v[76:79]
    buffer_store_dwordx4 a[96:99], v254, s[12:15], s44 offen sc1
    v_sub_f32 v220, v220, v224
    v_sub_f32 v221, v221, v225
    v_mfma_f32_16x16x32_bf16 v[80:83], a[200:203], v[236:239], v[80:83]
    ds_read_b128 v[236:239], v253 offset:17424
    v_sub_f32 v222, v222, v226
    v_mfma_f32_16x16x32_bf16 v[80:83], a[212:215], v[228:231], v[80:83]
    v_sub_f32 v223, v223, v227
    v_fma_f32 v224, v220, s34, v140 div:2
    v_mfma_f32_16x16x32_bf16 v[60:63], a[216:219], v[228:231], v[60:63]
    v_fma_f32 v225, v221, s34, v141 div:2
    v_fma_f32 v226, v222, s34, v142 div:2
    v_mfma_f32_16x16x32_bf16 v[64:67], a[220:223], v[228:231], v[64:67]
    s_waitcnt lgkmcnt(2)
    v_fma_f32 v227, v223, s34, v143 div:2
    v_fma_f32 v140, v220, s35, v140 mul:2
    v_mfma_f32_16x16x32_bf16 v[68:71], a[224:227], v[228:231], v[68:71]
    s_mov_b32 s42, 1032192
    v_fma_f32 v141, v221, s35, v141 mul:2
    v_fma_f32 v142, v222, s35, v142 mul:2
    v_mfma_f32_16x16x32_bf16 v[84:87], a[192:195], v[228:231], v[84:87]
    buffer_load_dwordx4 a[192:195], v254, s[8:11], s42 offen offset:0 sc1
    v_mfma_f32_16x16x32_bf16 v[88:91], a[196:199], v[228:231], v[88:91]
    s_waitcnt lgkmcnt(0)
    s_add_u32 s44, s40, 401408
    v_fma_f32 v143, v223, s35, v143 mul:2
    v_mfma_f32_16x16x32_bf16 v[92:95], a[200:203], v[228:231], v[92:95]
    s_barrier
    v_mfma_f32_16x16x32_bf16 v[84:87], a[204:207], v[232:235], v[84:87]
    ds_read_b128 v[228:231], v253 offset:19760
    v_cvt_pk_bf16_f32 v196, v224, v225
    v_mfma_f32_16x16x32_bf16 v[88:91], a[208:211], v[232:235], v[88:91]
    buffer_load_dwordx4 a[196:199], v254, s[8:11], s42 offen offset:1024 sc1
    v_mfma_f32_16x16x32_bf16 v[92:95], a[212:215], v[232:235], v[92:95]
    ds_read_b128 a[108:111], v250 offset:0
    v_cvt_pk_bf16_f32 v197, v226, v227
    v_mfma_f32_16x16x32_bf16 v[72:75], a[216:219], v[232:235], v[72:75]
    ds_write_b64 v249, v[196:197] offset:1216
    v_mfma_f32_16x16x32_bf16 v[76:79], a[220:223], v[232:235], v[76:79]
    buffer_load_dwordx4 a[200:203], v254, s[8:11], s42 offen offset:2048 sc1
    v_accvgpr_read_b32 v220, a48
    v_mfma_f32_16x16x32_bf16 v[80:83], a[224:227], v[232:235], v[80:83]
    ds_read_b128 v[232:235], v253 offset:19488
    v_mfma_f32_16x16x32_bf16 v[84:87], a[216:219], v[236:239], v[84:87]
    s_mov_b32 s42, 1035264
    v_accvgpr_read_b32 v221, a49
    v_accvgpr_read_b32 v222, a50
    v_mfma_f32_16x16x32_bf16 v[88:91], a[220:223], v[236:239], v[88:91]
    buffer_load_dwordx4 a[204:207], v254, s[8:11], s42 offen offset:0 sc1
    v_mfma_f32_16x16x32_bf16 v[92:95], a[224:227], v[236:239], v[92:95]
    ds_read_b128 v[236:239], v253 offset:19232
    v_accvgpr_read_b32 v223, a51
    s_waitcnt vmcnt(14)
    s_waitcnt lgkmcnt(4)
sub27:
    v_mfma_f32_16x16x32_bf16 v[0:3], a[228:231], v[228:231], v[0:3]
    s_waitcnt vmcnt(11) lgkmcnt(1)
    v_accvgpr_read_b32 v224, a144
    v_accvgpr_read_b32 v225, a145
    v_mfma_f32_16x16x32_bf16 v[4:7], a[232:235], v[228:231], v[4:7]
    ds_read_b128 a[112:115], v250 offset:3104
    v_accvgpr_read_b32 v226, a146
    v_mfma_f32_16x16x32_bf16 v[8:11], a[236:239], v[228:231], v[8:11]
    ds_read_b128 v[228:231], v253 offset:18976
    v_accvgpr_read_b32 v227, a147
    v_mfma_f32_16x16x32_bf16 v[0:3], a[240:243], v[232:235], v[0:3]
    buffer_load_dwordx4 a[208:211], v254, s[8:11], s42 offen offset:1024 sc1
    v_mfma_f32_16x16x32_bf16 v[4:7], a[244:247], v[232:235], v[4:7]
    v_sub_f32 v220, v220, v224
    v_sub_f32 v221, v221, v225
    v_mfma_f32_16x16x32_bf16 v[8:11], a[248:251], v[232:235], v[8:11]
    v_sub_f32 v222, v222, v226
    v_sub_f32 v223, v223, v227
    v_mfma_f32_16x16x32_bf16 v[12:15], a[228:231], v[232:235], v[12:15]
    s_waitcnt lgkmcnt(2)
    v_fma_f32 v224, v220, s34, v144 div:2
    v_fma_f32 v225, v221, s34, v145 div:2
    v_mfma_f32_16x16x32_bf16 v[12:15], a[240:243], v[236:239], v[12:15]
    buffer_load_dwordx4 a[212:215], v254, s[8:11], s42 offen offset:2048 sc1
    v_mfma_f32_16x16x32_bf16 v[16:19], a[244:247], v[236:239], v[16:19]
    v_fma_f32 v226, v222, s34, v146 div:2
    v_fma_f32 v227, v223, s34, v147 div:2
    v_mfma_f32_16x16x32_bf16 v[16:19], a[232:235], v[232:235], v[16:19]
    s_mov_b32 s42, 1038336
    v_fma_f32 v144, v220, s35, v144 mul:2
    v_fma_f32 v145, v221, s35, v145 mul:2
    v_mfma_f32_16x16x32_bf16 v[20:23], a[236:239], v[232:235], v[20:23]
    ds_read_b128 v[232:235], v253 offset:18720
    v_fma_f32 v146, v222, s35, v146 mul:2
    v_mfma_f32_16x16x32_bf16 v[20:23], a[248:251], v[236:239], v[20:23]
    buffer_load_dwordx4 a[216:219], v254, s[8:11], s42 offen offset:0 sc1
    s_waitcnt vmcnt(11)
    v_mfma_f32_16x16x32_bf16 v[0:3], a[252:255], v[236:239], v[0:3]
    ds_read_b128 a[116:119], v250 offset:6208
    v_fma_f32 v147, v223, s35, v147 mul:2
    v_mfma_f32_16x16x32_bf16 v[4:7], v[240:243], v[236:239], v[4:7]
    v_cvt_pk_bf16_f32 v198, v224, v225
    v_cvt_pk_bf16_f32 v199, v226, v227
    v_mfma_f32_16x16x32_bf16 v[8:11], v[244:247], v[236:239], v[8:11]
    s_waitcnt lgkmcnt(2)
    v_accvgpr_read_b32 v220, a52
    v_accvgpr_read_b32 v221, a53
    v_mfma_f32_16x16x32_bf16 v[24:27], a[228:231], v[236:239], v[24:27]
    buffer_load_dwordx4 a[220:223], v254, s[8:11], s42 offen offset:1024 sc1
    v_accvgpr_read_b32 v222, a54
    v_mfma_f32_16x16x32_bf16 v[24:27], a[240:243], v[228:231], v[24:27]
    v_accvgpr_read_b32 v223, a55
    v_accvgpr_read_b32 v224, a148
    v_mfma_f32_16x16x32_bf16 v[28:31], a[244:247], v[228:231], v[28:31]
    v_accvgpr_read_b32 v225, a149
    v_accvgpr_read_b32 v226, a150
    v_mfma_f32_16x16x32_bf16 v[28:31], a[232:235], v[236:239], v[28:31]
    buffer_load_dwordx4 a[224:227], v254, s[8:11], s42 offen offset:2048 sc1
    v_mfma_f32_16x16x32_bf16 v[32:35], a[236:239], v[236:239], v[32:35]
    ds_read_b128 v[236:239], v253 offset:20544
    v_accvgpr_read_b32 v227, a151
    v_mfma_f32_16x16x32_bf16 v[32:35], a[248:251], v[228:231], v[32:35]
    ds_read_b128 a[120:123], v250 offset:9312
    v_sub_f32 v220, v220, v224
    v_mfma_f32_16x16x32_bf16 v[12:15], a[252:255], v[228:231], v[12:15]
    buffer_store_dwordx4 a[100:103], v254, s[12:15], s44 offen sc1
    s_add_u32 s44, s40, 404480
    v_mfma_f32_16x16x32_bf16 v[16:19], v[240:243], v[228:231], v[16:19]
    v_sub_f32 v221, v221, v225
    v_sub_f32 v222, v222, v226
    v_mfma_f32_16x16x32_bf16 v[20:23], v[244:247], v[228:231], v[20:23]
    s_waitcnt lgkmcnt(3)
    v_sub_f32 v223, v223, v227
    v_fma_f32 v224, v220, s34, v148 div:2
    v_mfma_f32_16x16x32_bf16 v[36:39], a[228:231], v[228:231], v[36:39]
    buffer_store_dwordx4 a[104:107], v254, s[12:15], s44 offen sc1
    v_fma_f32 v225, v221, s34, v149 div:2
    v_fma_f32 v226, v222, s34, v150 div:2
    v_mfma_f32_16x16x32_bf16 v[36:39], a[240:243], v[232:235], v[36:39]
    v_fma_f32 v227, v223, s34, v151 div:2
    v_fma_f32 v148, v220, s35, v148 mul:2
    v_mfma_f32_16x16x32_bf16 v[40:43], a[244:247], v[232:235], v[40:43]
    v_fma_f32 v149, v221, s35, v149 mul:2
    v_fma_f32 v150, v222, s35, v150 mul:2
    v_mfma_f32_16x16x32_bf16 v[40:43], a[232:235], v[228:231], v[40:43]
    v_fma_f32 v151, v223, s35, v151 mul:2
    v_cvt_pk_bf16_f32 v200, v224, v225
    v_mfma_f32_16x16x32_bf16 v[44:47], a[236:239], v[228:231], v[44:47]
    ds_read_b128 v[228:231], v253 offset:20288
    v_cvt_pk_bf16_f32 v201, v226, v227
    v_mfma_f32_16x16x32_bf16 v[44:47], a[248:251], v[232:235], v[44:47]
    ds_write_b128 v248, v[198:201] offset:1536
    v_mfma_f32_16x16x32_bf16 v[24:27], a[252:255], v[232:235], v[24:27]
    s_add_u32 s44, s40, 196608
    v_accvgpr_read_b32 v220, a56
    v_accvgpr_read_b32 v221, a57
    v_mfma_f32_16x16x32_bf16 v[28:31], v[240:243], v[232:235], v[28:31]
    v_accvgpr_read_b32 v222, a58
    v_accvgpr_read_b32 v223, a59
    v_mfma_f32_16x16x32_bf16 v[32:35], v[244:247], v[232:235], v[32:35]
    v_accvgpr_read_b32 v224, a152
    v_accvgpr_read_b32 v225, a153
    v_mfma_f32_16x16x32_bf16 v[48:51], a[228:231], v[232:235], v[48:51]
    s_waitcnt lgkmcnt(3)
    v_accvgpr_read_b32 v226, a154
    v_accvgpr_read_b32 v227, a155
    v_mfma_f32_16x16x32_bf16 v[48:51], a[240:243], v[236:239], v[48:51]
    v_sub_f32 v220, v220, v224
    v_sub_f32 v221, v221, v225
    v_mfma_f32_16x16x32_bf16 v[52:55], a[244:247], v[236:239], v[52:55]
    v_sub_f32 v222, v222, v226
    v_sub_f32 v223, v223, v227
    v_fma_f32 v224, v220, s34, v152 div:2
    v_mfma_f32_16x16x32_bf16 v[52:55], a[232:235], v[232:235], v[52:55]
    v_fma_f32 v225, v221, s34, v153 div:2
    v_fma_f32 v226, v222, s34, v154 div:2
    v_mfma_f32_16x16x32_bf16 v[56:59], a[236:239], v[232:235], v[56:59]
    ds_read_b128 v[232:235], v253 offset:20032
    v_mfma_f32_16x16x32_bf16 v[56:59], a[248:251], v[236:239], v[56:59]
    v_fma_f32 v227, v223, s34, v155 div:2
    v_fma_f32 v152, v220, s35, v152 mul:2
    v_mfma_f32_16x16x32_bf16 v[36:39], a[252:255], v[236:239], v[36:39]
    v_fma_f32 v153, v221, s35, v153 mul:2
    v_fma_f32 v154, v222, s35, v154 mul:2
    v_mfma_f32_16x16x32_bf16 v[40:43], v[240:243], v[236:239], v[40:43]
    v_fma_f32 v155, v223, s35, v155 mul:2
    v_cvt_pk_bf16_f32 v202, v224, v225
    v_mfma_f32_16x16x32_bf16 v[44:47], v[244:247], v[236:239], v[44:47]
    s_waitcnt lgkmcnt(2)
    v_cvt_pk_bf16_f32 v203, v226, v227
    v_mfma_f32_16x16x32_bf16 v[60:63], a[228:231], v[236:239], v[60:63]
    ds_write_b64 v249, v[202:203] offset:1600
    v_mfma_f32_16x16x32_bf16 v[60:63], a[240:243], v[228:231], v[60:63]
    v_accvgpr_read_b32 v220, a60
    v_accvgpr_read_b32 v221, a61
    v_mfma_f32_16x16x32_bf16 v[64:67], a[244:247], v[228:231], v[64:67]
    v_accvgpr_read_b32 v222, a62
    v_accvgpr_read_b32 v223, a63
    v_mfma_f32_16x16x32_bf16 v[64:67], a[232:235], v[236:239], v[64:67]
    buffer_store_dwordx4 a[108:111], v254, s[12:15], s44 offen sc1
    v_accvgpr_read_b32 v224, a156
    v_accvgpr_read_b32 v225, a157
    v_mfma_f32_16x16x32_bf16 v[68:71], a[236:239], v[236:239], v[68:71]
    ds_read_b128 v[236:239], v253 offset:19776
    v_accvgpr_read_b32 v226, a158
    v_mfma_f32_16x16x32_bf16 v[68:71], a[248:251], v[228:231], v[68:71]
    v_accvgpr_read_b32 v227, a159
    v_sub_f32 v220, v220, v224
    v_mfma_f32_16x16x32_bf16 v[48:51], a[252:255], v[228:231], v[48:51]
    v_sub_f32 v221, v221, v225
    v_sub_f32 v222, v222, v226
    v_mfma_f32_16x16x32_bf16 v[52:55], v[240:243], v[228:231], v[52:55]
    v_sub_f32 v223, v223, v227
    v_fma_f32 v224, v220, s34, v156 div:2
    v_mfma_f32_16x16x32_bf16 v[56:59], v[244:247], v[228:231], v[56:59]
    v_fma_f32 v225, v221, s34, v157 div:2
    v_fma_f32 v226, v222, s34, v158 div:2
    v_mfma_f32_16x16x32_bf16 v[72:75], a[228:231], v[228:231], v[72:75]
    s_waitcnt lgkmcnt(2)
    v_fma_f32 v227, v223, s34, v159 div:2
    v_fma_f32 v156, v220, s35, v156 mul:2
    v_mfma_f32_16x16x32_bf16 v[72:75], a[240:243], v[232:235], v[72:75]
    v_fma_f32 v157, v221, s35, v157 mul:2
    v_fma_f32 v158, v222, s35, v158 mul:2
    v_mfma_f32_16x16x32_bf16 v[76:79], a[244:247], v[232:235], v[76:79]
    s_add_u32 s44, s40, 199680
    v_fma_f32 v159, v223, s35, v159 mul:2
    v_cvt_pk_bf16_f32 v192, v224, v225
    v_mfma_f32_16x16x32_bf16 v[76:79], a[232:235], v[228:231], v[76:79]
    v_cvt_pk_bf16_f32 v193, v226, v227
    v_accvgpr_read_b32 v220, a64
    v_mfma_f32_16x16x32_bf16 v[80:83], a[236:239], v[228:231], v[80:83]
    ds_read_b128 v[228:231], v253 offset:19504
    v_accvgpr_read_b32 v221, a65
    v_accvgpr_read_b32 v222, a66
    v_mfma_f32_16x16x32_bf16 v[80:83], a[248:251], v[232:235], v[80:83]
    v_accvgpr_read_b32 v223, a67
    v_accvgpr_read_b32 v224, a160
    v_mfma_f32_16x16x32_bf16 v[60:63], a[252:255], v[232:235], v[60:63]
    v_accvgpr_read_b32 v225, a161
    v_accvgpr_read_b32 v226, a162
    v_mfma_f32_16x16x32_bf16 v[64:67], v[240:243], v[232:235], v[64:67]
    v_accvgpr_read_b32 v227, a163
    v_sub_f32 v220, v220, v224
    v_mfma_f32_16x16x32_bf16 v[68:71], v[244:247], v[232:235], v[68:71]
    s_mov_b32 s42, 1069056
    v_sub_f32 v221, v221, v225
    v_sub_f32 v222, v222, v226
    v_mfma_f32_16x16x32_bf16 v[84:87], a[228:231], v[232:235], v[84:87]
    buffer_load_dwordx4 a[228:231], v254, s[8:11], s42 offen offset:0 sc1
    v_mfma_f32_16x16x32_bf16 v[88:91], a[232:235], v[232:235], v[88:91]
    v_sub_f32 v223, v223, v227
    v_fma_f32 v224, v220, s34, v160 div:2
    v_mfma_f32_16x16x32_bf16 v[92:95], a[236:239], v[232:235], v[92:95]
    s_waitcnt lgkmcnt(1)
    v_fma_f32 v225, v221, s34, v161 div:2
    v_fma_f32 v226, v222, s34, v162 div:2
    v_mfma_f32_16x16x32_bf16 v[84:87], a[240:243], v[236:239], v[84:87]
    ds_read_b128 v[232:235], v253 offset:21840
    v_fma_f32 v227, v223, s34, v163 div:2
    v_mfma_f32_16x16x32_bf16 v[88:91], a[244:247], v[236:239], v[88:91]
    buffer_load_dwordx4 a[232:235], v254, s[8:11], s42 offen offset:1024 sc1
    v_mfma_f32_16x16x32_bf16 v[92:95], a[248:251], v[236:239], v[92:95]
    v_fma_f32 v160, v220, s35, v160 mul:2
    v_fma_f32 v161, v221, s35, v161 mul:2
    v_mfma_f32_16x16x32_bf16 v[72:75], a[252:255], v[236:239], v[72:75]
    s_waitcnt lgkmcnt(1)
    v_fma_f32 v162, v222, s35, v162 mul:2
    v_fma_f32 v163, v223, s35, v163 mul:2
    v_mfma_f32_16x16x32_bf16 v[76:79], v[240:243], v[236:239], v[76:79]
    buffer_load_dwordx4 a[236:239], v254, s[8:11], s42 offen offset:2048 sc1
    v_mfma_f32_16x16x32_bf16 v[80:83], v[244:247], v[236:239], v[80:83]
    ds_read_b128 v[236:239], v253 offset:21568
    v_cvt_pk_bf16_f32 v194, v224, v225
    v_mfma_f32_16x16x32_bf16 v[84:87], a[252:255], v[228:231], v[84:87]
    s_mov_b32 s42, 1072128
    v_cvt_pk_bf16_f32 v195, v226, v227
    v_mfma_f32_16x16x32_bf16 v[88:91], v[240:243], v[228:231], v[88:91]
    buffer_load_dwordx4 a[240:243], v254, s[8:11], s42 offen offset:0 sc1
    v_mfma_f32_16x16x32_bf16 v[92:95], v[244:247], v[228:231], v[92:95]
    ds_read_b128 v[228:231], v253 offset:21312
    s_waitcnt vmcnt(13)
    s_waitcnt lgkmcnt(2)
sub28:
    v_mfma_f32_16x16x32_bf16 v[0:3], a[192:195], v[232:235], v[0:3]
    ds_write_b128 v248, v[192:195] offset:1920
    v_mfma_f32_16x16x32_bf16 v[4:7], a[196:199], v[232:235], v[4:7]
    s_waitcnt vmcnt(10) lgkmcnt(2)
    v_accvgpr_read_b32 v220, a68
    v_accvgpr_read_b32 v221, a69
    v_mfma_f32_16x16x32_bf16 v[8:11], a[200:203], v[232:235], v[8:11]
    ds_read_b128 v[232:235], v253 offset:21056
    v_accvgpr_read_b32 v222, a70
    v_mfma_f32_16x16x32_bf16 v[0:3], a[204:207], v[236:239], v[0:3]
    buffer_load_dwordx4 a[244:247], v254, s[8:11], s42 offen offset:1024 sc1
    v_accvgpr_read_b32 v223, a71
    v_mfma_f32_16x16x32_bf16 v[4:7], a[208:211], v[236:239], v[4:7]
    v_accvgpr_read_b32 v224, a164
    v_accvgpr_read_b32 v225, a165
    v_mfma_f32_16x16x32_bf16 v[8:11], a[212:215], v[236:239], v[8:11]
    v_accvgpr_read_b32 v226, a166
    v_accvgpr_read_b32 v227, a167
    v_mfma_f32_16x16x32_bf16 v[12:15], a[192:195], v[236:239], v[12:15]
    s_waitcnt lgkmcnt(2)
    v_sub_f32 v220, v220, v224
    v_sub_f32 v221, v221, v225
    v_mfma_f32_16x16x32_bf16 v[12:15], a[204:207], v[228:231], v[12:15]
    buffer_load_dwordx4 a[248:251], v254, s[8:11], s42 offen offset:2048 sc1
    v_mfma_f32_16x16x32_bf16 v[16:19], a[208:211], v[228:231], v[16:19]
    v_sub_f32 v222, v222, v226
    v_sub_f32 v223, v223, v227
    v_mfma_f32_16x16x32_bf16 v[16:19], a[196:199], v[236:239], v[16:19]
    s_mov_b32 s42, 1075200
    v_fma_f32 v224, v220, s34, v164 div:2
    v_fma_f32 v225, v221, s34, v165 div:2
    v_mfma_f32_16x16x32_bf16 v[20:23], a[200:203], v[236:239], v[20:23]
    ds_read_b128 v[236:239], v253 offset:20800
    v_fma_f32 v226, v222, s34, v166 div:2
    v_mfma_f32_16x16x32_bf16 v[20:23], a[212:215], v[228:231], v[20:23]
    buffer_load_dwordx4 a[252:255], v254, s[8:11], s42 offen offset:0 sc1
    s_waitcnt vmcnt(10)
    v_mfma_f32_16x16x32_bf16 v[0:3], a[216:219], v[228:231], v[0:3]
    v_fma_f32 v227, v223, s34, v167 div:2
    v_fma_f32 v164, v220, s35, v164 mul:2
    v_mfma_f32_16x16x32_bf16 v[4:7], a[220:223], v[228:231], v[4:7]
    v_fma_f32 v165, v221, s35, v165 mul:2
    v_fma_f32 v166, v222, s35, v166 mul:2
    v_mfma_f32_16x16x32_bf16 v[8:11], a[224:227], v[228:231], v[8:11]
    s_waitcnt lgkmcnt(1)
    v_fma_f32 v167, v223, s35, v167 mul:2
    v_cvt_pk_bf16_f32 v196, v224, v225
    v_mfma_f32_16x16x32_bf16 v[24:27], a[192:195], v[228:231], v[24:27]
    buffer_load_dwordx4 v[240:243], v254, s[8:11], s42 offen offset:1024 sc1
    v_mfma_f32_16x16x32_bf16 v[24:27], a[204:207], v[232:235], v[24:27]
    v_cvt_pk_bf16_f32 v197, v226, v227
    v_mfma_f32_16x16x32_bf16 v[28:31], a[208:211], v[232:235], v[28:31]
    ds_write_b64 v249, v[196:197] offset:1984
    v_mfma_f32_16x16x32_bf16 v[28:31], a[196:199], v[228:231], v[28:31]
    buffer_load_dwordx4 v[244:247], v254, s[8:11], s42 offen offset:2048 sc1
    v_mfma_f32_16x16x32_bf16 v[32:35], a[200:203], v[228:231], v[32:35]
    ds_read_b128 v[228:231], v253 offset:22624
    v_accvgpr_read_b32 v220, a72
    v_mfma_f32_16x16x32_bf16 v[32:35], a[212:215], v[232:235], v[32:35]
    v_accvgpr_read_b32 v221, a73
    v_accvgpr_read_b32 v222, a74
    v_mfma_f32_16x16x32_bf16 v[12:15], a[216:219], v[232:235], v[12:15]
    buffer_store_dwordx4 a[112:115], v254, s[12:15], s44 offen sc1
    s_add_u32 s44, s40, 202752
    v_mfma_f32_16x16x32_bf16 v[16:19], a[220:223], v[232:235], v[16:19]
    v_accvgpr_read_b32 v223, a75
    v_accvgpr_read_b32 v224, a168
    v_mfma_f32_16x16x32_bf16 v[20:23], a[224:227], v[232:235], v[20:23]
    s_waitcnt lgkmcnt(2)
    v_accvgpr_read_b32 v225, a169
    v_accvgpr_read_b32 v226, a170
    v_accvgpr_read_b32 v227, a171
    v_mfma_f32_16x16x32_bf16 v[36:39], a[192:195], v[232:235], v[36:39]
    buffer_store_dwordx4 a[116:119], v254, s[12:15], s44 offen sc1
    v_sub_f32 v220, v220, v224
    v_sub_f32 v221, v221, v225
    v_mfma_f32_16x16x32_bf16 v[36:39], a[204:207], v[236:239], v[36:39]
    v_sub_f32 v222, v222, v226
    v_sub_f32 v223, v223, v227
    v_mfma_f32_16x16x32_bf16 v[40:43], a[208:211], v[236:239], v[40:43]
    v_fma_f32 v224, v220, s34, v168 div:2
    v_fma_f32 v225, v221, s34, v169 div:2
    v_mfma_f32_16x16x32_bf16 v[40:43], a[196:199], v[232:235], v[40:43]
    v_fma_f32 v226, v222, s34, v170 div:2
    v_fma_f32 v227, v223, s34, v171 div:2
    v_mfma_f32_16x16x32_bf16 v[44:47], a[200:203], v[232:235], v[44:47]
    ds_read_b128 v[232:235], v253 offset:22368
    v_fma_f32 v168, v220, s35, v168 mul:2
    v_mfma_f32_16x16x32_bf16 v[44:47], a[212:215], v[236:239], v[44:47]
    s_add_u32 s44, s40, 205824
    v_fma_f32 v169, v221, s35, v169 mul:2
    v_fma_f32 v170, v222, s35, v170 mul:2
    v_mfma_f32_16x16x32_bf16 v[24:27], a[216:219], v[236:239], v[24:27]
    v_fma_f32 v171, v223, s35, v171 mul:2
    v_cvt_pk_bf16_f32 v198, v224, v225
    v_mfma_f32_16x16x32_bf16 v[28:31], a[220:223], v[236:239], v[28:31]
    v_cvt_pk_bf16_f32 v199, v226, v227
    v_accvgpr_read_b32 v220, a76
    v_mfma_f32_16x16x32_bf16 v[32:35], a[224:227], v[236:239], v[32:35]
    v_accvgpr_read_b32 v221, a77
    v_accvgpr_read_b32 v222, a78
    v_mfma_f32_16x16x32_bf16 v[48:51], a[192:195], v[236:239], v[48:51]
    s_waitcnt lgkmcnt(1)
    v_accvgpr_read_b32 v223, a79
    v_accvgpr_read_b32 v224, a172
    v_mfma_f32_16x16x32_bf16 v[48:51], a[204:207], v[228:231], v[48:51]
    v_accvgpr_read_b32 v225, a173
    v_accvgpr_read_b32 v226, a174
    v_mfma_f32_16x16x32_bf16 v[52:55], a[208:211], v[228:231], v[52:55]
    v_accvgpr_read_b32 v227, a175
    v_sub_f32 v220, v220, v224
    v_mfma_f32_16x16x32_bf16 v[52:55], a[196:199], v[236:239], v[52:55]
    v_sub_f32 v221, v221, v225
    v_sub_f32 v222, v222, v226
    v_mfma_f32_16x16x32_bf16 v[56:59], a[200:203], v[236:239], v[56:59]
    ds_read_b128 v[236:239], v253 offset:22112
    v_mfma_f32_16x16x32_bf16 v[56:59], a[212:215], v[228:231], v[56:59]
    v_sub_f32 v223, v223, v227
    v_fma_f32 v224, v220, s34, v172 div:2
    v_mfma_f32_16x16x32_bf16 v[36:39], a[216:219], v[228:231], v[36:39]
    v_fma_f32 v225, v221, s34, v173 div:2
    v_fma_f32 v226, v222, s34, v174 div:2
    v_mfma_f32_16x16x32_bf16 v[40:43], a[220:223], v[228:231], v[40:43]
    v_fma_f32 v227, v223, s34, v175 div:2
    v_fma_f32 v172, v220, s35, v172 mul:2
    v_mfma_f32_16x16x32_bf16 v[44:47], a[224:227], v[228:231], v[44:47]
    v_fma_f32 v173, v221, s35, v173 mul:2
    v_fma_f32 v174, v222, s35, v174 mul:2
    v_mfma_f32_16x16x32_bf16 v[60:63], a[192:195], v[228:231], v[60:63]
    s_waitcnt lgkmcnt(1)
    v_fma_f32 v175, v223, s35, v175 mul:2
    v_cvt_pk_bf16_f32 v200, v224, v225
    v_mfma_f32_16x16x32_bf16 v[60:63], a[204:207], v[232:235], v[60:63]
    v_cvt_pk_bf16_f32 v201, v226, v227
    v_mfma_f32_16x16x32_bf16 v[64:67], a[208:211], v[232:235], v[64:67]
    ds_write_b128 v248, v[198:201] offset:2304
    v_mfma_f32_16x16x32_bf16 v[64:67], a[196:199], v[228:231], v[64:67]
    buffer_store_dwordx4 a[120:123], v254, s[12:15], s44 offen sc1
    v_accvgpr_read_b32 v220, a80
    v_accvgpr_read_b32 v221, a81
    v_mfma_f32_16x16x32_bf16 v[68:71], a[200:203], v[228:231], v[68:71]
    ds_read_b128 v[228:231], v253 offset:21856
    v_accvgpr_read_b32 v222, a82
    v_mfma_f32_16x16x32_bf16 v[68:71], a[212:215], v[232:235], v[68:71]
    v_accvgpr_read_b32 v223, a83
    v_accvgpr_read_b32 v224, a176
    v_mfma_f32_16x16x32_bf16 v[48:51], a[216:219], v[232:235], v[48:51]
    v_accvgpr_read_b32 v225, a177
    v_accvgpr_read_b32 v226, a178
    v_mfma_f32_16x16x32_bf16 v[52:55], a[220:223], v[232:235], v[52:55]
    v_accvgpr_read_b32 v227, a179
    v_sub_f32 v220, v220, v224
    v_mfma_f32_16x16x32_bf16 v[56:59], a[224:227], v[232:235], v[56:59]
    v_sub_f32 v221, v221, v225
    v_sub_f32 v222, v222, v226
    v_mfma_f32_16x16x32_bf16 v[72:75], a[192:195], v[232:235], v[72:75]
    s_waitcnt lgkmcnt(2)
    v_sub_f32 v223, v223, v227
    v_fma_f32 v224, v220, s34, v176 div:2
    v_mfma_f32_16x16x32_bf16 v[72:75], a[204:207], v[236:239], v[72:75]
    v_fma_f32 v225, v221, s34, v177 div:2
    v_fma_f32 v226, v222, s34, v178 div:2
    v_mfma_f32_16x16x32_bf16 v[76:79], a[208:211], v[236:239], v[76:79]
    s_add_u32 s44, s40, 197632
    v_fma_f32 v227, v223, s34, v179 div:2
    v_fma_f32 v176, v220, s35, v176 mul:2
    v_mfma_f32_16x16x32_bf16 v[76:79], a[196:199], v[232:235], v[76:79]
    v_fma_f32 v177, v221, s35, v177 mul:2
    v_fma_f32 v178, v222, s35, v178 mul:2
    v_mfma_f32_16x16x32_bf16 v[80:83], a[200:203], v[232:235], v[80:83]
    ds_read_b128 v[232:235], v253 offset:21584
    v_fma_f32 v179, v223, s35, v179 mul:2
    v_mfma_f32_16x16x32_bf16 v[80:83], a[212:215], v[236:239], v[80:83]
    v_cvt_pk_bf16_f32 v202, v224, v225
    v_cvt_pk_bf16_f32 v203, v226, v227
    v_mfma_f32_16x16x32_bf16 v[60:63], a[216:219], v[236:239], v[60:63]
    ds_write_b64 v249, v[202:203] offset:2368
    v_mfma_f32_16x16x32_bf16 v[64:67], a[220:223], v[236:239], v[64:67]
    s_waitcnt lgkmcnt(2)
    v_accvgpr_read_b32 v220, a180
    v_accvgpr_read_b32 v221, a181
    v_mfma_f32_16x16x32_bf16 v[68:71], a[224:227], v[236:239], v[68:71]
    s_mov_b32 s42, 1105920
    v_accvgpr_read_b32 v222, a182
    v_accvgpr_read_b32 v223, a183
    v_mfma_f32_16x16x32_bf16 v[84:87], a[192:195], v[236:239], v[84:87]
    buffer_load_dwordx4 a[192:195], v254, s[8:11], s42 offen offset:0 sc1
    v_mfma_f32_16x16x32_bf16 v[88:91], a[196:199], v[236:239], v[88:91]
    s_waitcnt lgkmcnt(0)
    v_fma_f32 v224, v220, s34, v180 div:2
    v_fma_f32 v225, v221, s34, v181 div:2
    v_mfma_f32_16x16x32_bf16 v[92:95], a[200:203], v[236:239], v[92:95]
    s_barrier
    v_mfma_f32_16x16x32_bf16 v[84:87], a[204:207], v[228:231], v[84:87]
    ds_read_b128 v[236:239], v253 offset:23920
    v_fma_f32 v226, v222, s34, v182 div:2
    v_fma_f32 v227, v223, s34, v183 div:2
    v_mfma_f32_16x16x32_bf16 v[88:91], a[208:211], v[228:231], v[88:91]
    buffer_load_dwordx4 a[196:199], v254, s[8:11], s42 offen offset:1024 sc1
    v_mfma_f32_16x16x32_bf16 v[92:95], a[212:215], v[228:231], v[92:95]
    ds_read_b128 a[124:127], v250 offset:1024
    v_fma_f32 v180, v220, s35, v180 mul:2
    v_mfma_f32_16x16x32_bf16 v[72:75], a[216:219], v[228:231], v[72:75]
    v_fma_f32 v181, v221, s35, v181 mul:2
    v_fma_f32 v182, v222, s35, v182 mul:2
    v_mfma_f32_16x16x32_bf16 v[76:79], a[220:223], v[228:231], v[76:79]
    buffer_load_dwordx4 a[200:203], v254, s[8:11], s42 offen offset:2048 sc1
    v_mfma_f32_16x16x32_bf16 v[80:83], a[224:227], v[228:231], v[80:83]
    ds_read_b128 v[228:231], v253 offset:23648
    v_fma_f32 v183, v223, s35, v183 mul:2
    v_mfma_f32_16x16x32_bf16 v[84:87], a[216:219], v[232:235], v[84:87]
    s_mov_b32 s42, 1108992
    v_cvt_pk_bf16_f32 v192, v224, v225
    v_cvt_pk_bf16_f32 v193, v226, v227
    v_mfma_f32_16x16x32_bf16 v[88:91], a[220:223], v[232:235], v[88:91]
    buffer_load_dwordx4 a[204:207], v254, s[8:11], s42 offen offset:0 sc1
    v_mfma_f32_16x16x32_bf16 v[92:95], a[224:227], v[232:235], v[92:95]
    ds_read_b128 v[232:235], v253 offset:23392
    s_waitcnt lgkmcnt(2)
    s_waitcnt vmcnt(13)
sub29:
    v_mfma_f32_16x16x32_bf16 v[0:3], a[228:231], v[236:239], v[0:3]
    ds_read_b128 a[128:131], v250 offset:4128
    v_accvgpr_read_b32 v220, a184
    v_mfma_f32_16x16x32_bf16 v[4:7], a[232:235], v[236:239], v[4:7]
pad11:
    s_cbranch_vccnz warm_ret
    buffer_store_dwordx4 a[124:127], v254, s[12:15], s44 offen sc1
    v_accvgpr_read_b32 v221, a185
    v_accvgpr_read_b32 v222, a186
    v_mfma_f32_16x16x32_bf16 v[8:11], a[236:239], v[236:239], v[8:11]
    ds_read_b128 v[236:239], v253 offset:23136
    v_accvgpr_read_b32 v223, a187
    s_waitcnt vmcnt(11)
    s_waitcnt lgkmcnt(3)
    v_mfma_f32_16x16x32_bf16 v[0:3], a[240:243], v[228:231], v[0:3]
    buffer_load_dwordx4 a[208:211], v254, s[8:11], s42 offen offset:1024 sc1
    v_mfma_f32_16x16x32_bf16 v[4:7], a[244:247], v[228:231], v[4:7]
    s_waitcnt lgkmcnt(2)
    v_fma_f32 v224, v220, s34, v184 div:2
    v_fma_f32 v225, v221, s34, v185 div:2
    v_mfma_f32_16x16x32_bf16 v[8:11], a[248:251], v[228:231], v[8:11]
    s_add_u32 s44, s40, 200704
    v_fma_f32 v226, v222, s34, v186 div:2
    v_fma_f32 v227, v223, s34, v187 div:2
    v_mfma_f32_16x16x32_bf16 v[12:15], a[228:231], v[228:231], v[12:15]
    ds_read_b128 a[132:135], v250 offset:7232
    v_fma_f32 v184, v220, s35, v184 mul:2
    v_mfma_f32_16x16x32_bf16 v[12:15], a[240:243], v[232:235], v[12:15]
    buffer_load_dwordx4 a[212:215], v254, s[8:11], s42 offen offset:2048 sc1
    v_mfma_f32_16x16x32_bf16 v[16:19], a[244:247], v[232:235], v[16:19]
    v_fma_f32 v185, v221, s35, v185 mul:2
    v_fma_f32 v186, v222, s35, v186 mul:2
    v_mfma_f32_16x16x32_bf16 v[16:19], a[232:235], v[228:231], v[16:19]
    s_mov_b32 s42, 1112064
    v_fma_f32 v187, v223, s35, v187 mul:2
    v_cvt_pk_bf16_f32 v194, v224, v225
    v_mfma_f32_16x16x32_bf16 v[20:23], a[236:239], v[228:231], v[20:23]
    ds_read_b128 v[228:231], v253 offset:22880
    v_cvt_pk_bf16_f32 v195, v226, v227
    v_mfma_f32_16x16x32_bf16 v[20:23], a[248:251], v[232:235], v[20:23]
    buffer_load_dwordx4 a[216:219], v254, s[8:11], s42 offen offset:0 sc1
    s_waitcnt vmcnt(11)
    v_mfma_f32_16x16x32_bf16 v[0:3], a[252:255], v[232:235], v[0:3]
    ds_write_b128 v248, v[192:195] offset:2688
    v_mfma_f32_16x16x32_bf16 v[4:7], v[240:243], v[232:235], v[4:7]
    s_waitcnt lgkmcnt(3)
    v_accvgpr_read_b32 v220, a188
    v_mfma_f32_16x16x32_bf16 v[8:11], v[244:247], v[232:235], v[8:11]
    ds_read_b128 a[136:139], v250 offset:10336
    v_accvgpr_read_b32 v221, a189
    v_mfma_f32_16x16x32_bf16 v[24:27], a[228:231], v[232:235], v[24:27]
    buffer_load_dwordx4 a[220:223], v254, s[8:11], s42 offen offset:1024 sc1
    v_mfma_f32_16x16x32_bf16 v[24:27], a[240:243], v[236:239], v[24:27]
    v_accvgpr_read_b32 v222, a190
    v_accvgpr_read_b32 v223, a191
    v_mfma_f32_16x16x32_bf16 v[28:31], a[244:247], v[236:239], v[28:31]
    v_fma_f32 v224, v220, s34, v188 div:2
    v_fma_f32 v225, v221, s34, v189 div:2
    v_mfma_f32_16x16x32_bf16 v[28:31], a[232:235], v[232:235], v[28:31]
    buffer_load_dwordx4 a[224:227], v254, s[8:11], s42 offen offset:2048 sc1
    v_mfma_f32_16x16x32_bf16 v[32:35], a[236:239], v[232:235], v[32:35]
    ds_read_b128 v[232:235], v253 offset:24704
    v_and_b32 v215, 0x7fff, v255
    v_mfma_f32_16x16x32_bf16 v[32:35], a[248:251], v[236:239], v[32:35]
    v_cvt_pk_bf16_f32 v8, v8, v9
    v_cvt_pk_bf16_f32 v9, v10, v11
    v_mfma_f32_16x16x32_bf16 v[12:15], a[252:255], v[236:239], v[12:15]
    buffer_store_dwordx4 a[128:131], v254, s[12:15], s44 offen sc1
    v_cvt_pk_bf16_f32 v0, v0, v1
    v_cvt_pk_bf16_f32 v1, v2, v3
    v_mfma_f32_16x16x32_bf16 v[16:19], v[240:243], v[236:239], v[16:19]
    buffer_load_dwordx2 v[204:205], v215, s[4:7], s16 offen offset:0
    v_mfma_f32_16x16x32_bf16 v[20:23], v[244:247], v[236:239], v[20:23]
    v_cvt_pk_bf16_f32 v2, v4, v5
    v_cvt_pk_bf16_f32 v3, v6, v7
    v_mfma_f32_16x16x32_bf16 v[36:39], a[228:231], v[236:239], v[36:39]
    s_waitcnt lgkmcnt(3)
    v_mov_b32 v4, v248
    v_mov_b32 v5, v249
    v_mfma_f32_16x16x32_bf16 v[36:39], a[240:243], v[228:231], v[36:39]
    v_mov_b32 v6, v250
    v_fma_f32 v226, v222, s34, v190 div:2
    v_mfma_f32_16x16x32_bf16 v[40:43], a[244:247], v[228:231], v[40:43]
    v_fma_f32 v227, v223, s34, v191 div:2
    v_fma_f32 v188, v220, s35, v188 mul:2
    v_mfma_f32_16x16x32_bf16 v[40:43], a[232:235], v[236:239], v[40:43]
    buffer_load_dwordx2 v[206:207], v215, s[4:7], s17 offen offset:0
    v_mfma_f32_16x16x32_bf16 v[44:47], a[236:239], v[236:239], v[44:47]
    ds_read_b128 v[236:239], v253 offset:24448
    v_fma_f32 v189, v221, s35, v189 mul:2
    v_mfma_f32_16x16x32_bf16 v[44:47], a[248:251], v[228:231], v[44:47]
    s_add_u32 s44, s40, 203776
    v_cvt_pk_bf16_f32 v20, v20, v21
    v_cvt_pk_bf16_f32 v21, v22, v23
    v_mfma_f32_16x16x32_bf16 v[24:27], a[252:255], v[228:231], v[24:27]
    v_cvt_pk_bf16_f32 v12, v12, v13
    v_cvt_pk_bf16_f32 v13, v14, v15
    v_mfma_f32_16x16x32_bf16 v[28:31], v[240:243], v[228:231], v[28:31]
    v_cvt_pk_bf16_f32 v14, v16, v17
    v_cvt_pk_bf16_f32 v15, v18, v19
    v_fma_f32 v190, v222, s35, v190 mul:2
    v_mfma_f32_16x16x32_bf16 v[32:35], v[244:247], v[228:231], v[32:35]
    buffer_load_dwordx2 v[208:209], v215, s[4:7], s18 offen offset:0
    v_mfma_f32_16x16x32_bf16 v[48:51], a[228:231], v[228:231], v[48:51]
    s_waitcnt lgkmcnt(1)
    v_fma_f32 v191, v223, s35, v191 mul:2
    v_cvt_pk_bf16_f32 v196, v224, v225
    v_mfma_f32_16x16x32_bf16 v[48:51], a[240:243], v[232:235], v[48:51]
    v_cvt_pk_bf16_f32 v197, v226, v227
    v_mfma_f32_16x16x32_bf16 v[52:55], a[244:247], v[232:235], v[52:55]
    ds_write_b64 v249, v[196:197] offset:2752
    v_mfma_f32_16x16x32_bf16 v[52:55], a[232:235], v[228:231], v[52:55]
    v_mfma_f32_16x16x32_bf16 v[56:59], a[236:239], v[228:231], v[56:59]
    ds_read_b128 v[228:231], v253 offset:24192
    v_mfma_f32_16x16x32_bf16 v[56:59], a[248:251], v[232:235], v[56:59]
    buffer_load_dwordx2 v[210:211], v215, s[4:7], s19 offen offset:0
    v_mfma_f32_16x16x32_bf16 v[36:39], a[252:255], v[232:235], v[36:39]
    v_cvt_pk_bf16_f32 v32, v32, v33
    v_cvt_pk_bf16_f32 v33, v34, v35
    v_mfma_f32_16x16x32_bf16 v[40:43], v[240:243], v[232:235], v[40:43]
    v_cvt_pk_bf16_f32 v24, v24, v25
    v_cvt_pk_bf16_f32 v25, v26, v27
    v_mfma_f32_16x16x32_bf16 v[44:47], v[244:247], v[232:235], v[44:47]
    v_cvt_pk_bf16_f32 v26, v28, v29
    v_cvt_pk_bf16_f32 v27, v30, v31
    v_mfma_f32_16x16x32_bf16 v[60:63], a[228:231], v[232:235], v[60:63]
    s_waitcnt lgkmcnt(2)
    v_mfma_f32_16x16x32_bf16 v[60:63], a[240:243], v[236:239], v[60:63]
    buffer_load_dwordx2 v[212:213], v215, s[4:7], s20 offen offset:0
    v_mfma_f32_16x16x32_bf16 v[64:67], a[244:247], v[236:239], v[64:67]
    v_mfma_f32_16x16x32_bf16 v[64:67], a[232:235], v[232:235], v[64:67]
    v_mfma_f32_16x16x32_bf16 v[68:71], a[236:239], v[232:235], v[68:71]
    ds_read_b128 v[232:235], v253 offset:23936
    v_mfma_f32_16x16x32_bf16 v[68:71], a[248:251], v[236:239], v[68:71]
    v_cvt_pk_bf16_f32 v44, v44, v45
    v_cvt_pk_bf16_f32 v45, v46, v47
    v_mfma_f32_16x16x32_bf16 v[48:51], a[252:255], v[236:239], v[48:51]
    buffer_load_dwordx2 v[214:215], v215, s[4:7], s21 offen offset:0
    v_mfma_f32_16x16x32_bf16 v[52:55], v[240:243], v[236:239], v[52:55]
    v_cvt_pk_bf16_f32 v36, v36, v37
    v_cvt_pk_bf16_f32 v37, v38, v39
    v_mfma_f32_16x16x32_bf16 v[56:59], v[244:247], v[236:239], v[56:59]
    v_cvt_pk_bf16_f32 v38, v40, v41
    v_cvt_pk_bf16_f32 v39, v42, v43
    v_mfma_f32_16x16x32_bf16 v[72:75], a[228:231], v[236:239], v[72:75]
    s_waitcnt lgkmcnt(1)
    v_mfma_f32_16x16x32_bf16 v[72:75], a[240:243], v[228:231], v[72:75]
    v_mfma_f32_16x16x32_bf16 v[76:79], a[244:247], v[228:231], v[76:79]
    v_mfma_f32_16x16x32_bf16 v[76:79], a[232:235], v[236:239], v[76:79]
    v_mfma_f32_16x16x32_bf16 v[80:83], a[236:239], v[236:239], v[80:83]
    ds_read_b128 v[236:239], v253 offset:23664
    v_mfma_f32_16x16x32_bf16 v[80:83], a[248:251], v[228:231], v[80:83]
    v_cvt_pk_bf16_f32 v56, v56, v57
    v_cvt_pk_bf16_f32 v57, v58, v59
    v_mfma_f32_16x16x32_bf16 v[60:63], a[252:255], v[228:231], v[60:63]
    v_cvt_pk_bf16_f32 v48, v48, v49
    v_cvt_pk_bf16_f32 v49, v50, v51
    v_mfma_f32_16x16x32_bf16 v[64:67], v[240:243], v[228:231], v[64:67]
    s_waitcnt lgkmcnt(1)
    v_cvt_pk_bf16_f32 v50, v52, v53
    v_cvt_pk_bf16_f32 v51, v54, v55
    v_mfma_f32_16x16x32_bf16 v[68:71], v[244:247], v[228:231], v[68:71]
    s_mov_b32 s42, 1142784
    v_mfma_f32_16x16x32_bf16 v[84:87], a[228:231], v[228:231], v[84:87]
    buffer_load_dwordx4 a[228:231], v254, s[8:11], s42 offen offset:0 sc1
    v_mfma_f32_16x16x32_bf16 v[88:91], a[232:235], v[228:231], v[88:91]
    s_waitcnt lgkmcnt(0)
    v_mfma_f32_16x16x32_bf16 v[92:95], a[236:239], v[228:231], v[92:95]
    s_barrier
    v_mfma_f32_16x16x32_bf16 v[84:87], a[240:243], v[232:235], v[84:87]
    ds_read_b128 v[228:231], v253 offset:36400
    v_mfma_f32_16x16x32_bf16 v[88:91], a[244:247], v[232:235], v[88:91]
    buffer_load_dwordx4 a[232:235], v254, s[8:11], s42 offen offset:1024 sc1
    v_mfma_f32_16x16x32_bf16 v[92:95], a[248:251], v[232:235], v[92:95]
    ds_read_b128 a[140:143], v250 offset:2048
    v_cvt_pk_bf16_f32 v68, v68, v69
    v_mfma_f32_16x16x32_bf16 v[72:75], a[252:255], v[232:235], v[72:75]
    ds_write_b64 v249, v[8:9] offset:12544
    v_mfma_f32_16x16x32_bf16 v[76:79], v[240:243], v[232:235], v[76:79]
    buffer_load_dwordx4 a[236:239], v254, s[8:11], s42 offen offset:2048 sc1
    v_mfma_f32_16x16x32_bf16 v[80:83], v[244:247], v[232:235], v[80:83]
    ds_read_b128 v[232:235], v253 offset:36128
    v_cvt_pk_bf16_f32 v69, v70, v71
    v_mfma_f32_16x16x32_bf16 v[84:87], a[252:255], v[236:239], v[84:87]
    s_mov_b32 s42, 1145856
    v_cvt_pk_bf16_f32 v60, v60, v61
    v_cvt_pk_bf16_f32 v61, v62, v63
    v_mfma_f32_16x16x32_bf16 v[88:91], v[240:243], v[236:239], v[88:91]
    buffer_load_dwordx4 a[240:243], v254, s[8:11], s42 offen offset:0 sc1
    v_mfma_f32_16x16x32_bf16 v[92:95], v[244:247], v[236:239], v[92:95]
    ds_read_b128 v[236:239], v253 offset:35872
    v_cvt_pk_bf16_f32 v62, v64, v65
    s_waitcnt vmcnt(18)
    s_waitcnt lgkmcnt(4)
sub30:
    v_mfma_f32_16x16x32_bf16 v[96:99], a[192:195], v[228:231], v[96:99]
    ds_write_b128 v248, v[0:3] offset:12480
    v_mfma_f32_16x16x32_bf16 v[100:103], a[196:199], v[228:231], v[100:103]
    buffer_store_dwordx4 a[132:135], v254, s[12:15], s44 offen sc1
    s_add_u32 s44, s40, 206848
    v_mfma_f32_16x16x32_bf16 v[104:107], a[200:203], v[228:231], v[104:107]
    ds_read_b128 v[228:231], v253 offset:35616
    v_cvt_pk_bf16_f32 v63, v66, v67
    s_waitcnt vmcnt(15)
    s_waitcnt lgkmcnt(3)
    v_mfma_f32_16x16x32_bf16 v[96:99], a[204:207], v[232:235], v[96:99]
    buffer_load_dwordx4 a[244:247], v254, s[8:11], s42 offen offset:1024 sc1
    v_mfma_f32_16x16x32_bf16 v[100:103], a[208:211], v[232:235], v[100:103]
    ds_read_b128 a[144:147], v250 offset:5152
    v_cvt_pk_bf16_f32 v80, v80, v81
    v_mfma_f32_16x16x32_bf16 v[104:107], a[212:215], v[232:235], v[104:107]
    ds_write_b64 v249, v[20:21] offset:12928
    v_mfma_f32_16x16x32_bf16 v[108:111], a[192:195], v[232:235], v[108:111]
    s_waitcnt lgkmcnt(4)
    v_cvt_pk_bf16_f32 v81, v82, v83
    v_cvt_pk_bf16_f32 v72, v72, v73
    v_mfma_f32_16x16x32_bf16 v[108:111], a[204:207], v[236:239], v[108:111]
    buffer_load_dwordx4 a[248:251], v254, s[8:11], s42 offen offset:2048 sc1
    v_mfma_f32_16x16x32_bf16 v[112:115], a[208:211], v[236:239], v[112:115]
    ds_write_b128 v248, v[12:15] offset:12864
    v_mfma_f32_16x16x32_bf16 v[112:115], a[196:199], v[232:235], v[112:115]
    s_mov_b32 s42, 1148928
    v_cvt_pk_bf16_f32 v73, v74, v75
    v_cvt_pk_bf16_f32 v74, v76, v77
    v_mfma_f32_16x16x32_bf16 v[116:119], a[200:203], v[232:235], v[116:119]
    ds_read_b128 v[232:235], v253 offset:35360
    v_cvt_pk_bf16_f32 v75, v78, v79
    v_mfma_f32_16x16x32_bf16 v[116:119], a[212:215], v[236:239], v[116:119]
    buffer_load_dwordx4 a[252:255], v254, s[8:11], s42 offen offset:0 sc1
    s_waitcnt vmcnt(15)
    v_mfma_f32_16x16x32_bf16 v[96:99], a[216:219], v[236:239], v[96:99]
    ds_read_b128 a[148:151], v250 offset:8256
    v_cvt_pk_bf16_f32 v92, v92, v93
    v_mfma_f32_16x16x32_bf16 v[100:103], a[220:223], v[236:239], v[100:103]
    buffer_store_dwordx4 a[136:139], v254, s[12:15], s44 offen sc1
    s_add_u32 s44, s40, 198656
    v_mfma_f32_16x16x32_bf16 v[104:107], a[224:227], v[236:239], v[104:107]
    ds_write_b64 v249, v[32:33] offset:13312
    v_mfma_f32_16x16x32_bf16 v[120:123], a[192:195], v[236:239], v[120:123]
    buffer_load_dwordx4 v[240:243], v254, s[8:11], s42 offen offset:1024 sc1
    s_waitcnt lgkmcnt(6)
    v_mfma_f32_16x16x32_bf16 v[120:123], a[204:207], v[228:231], v[120:123]
    v_cvt_pk_bf16_f32 v93, v94, v95
    v_cvt_pk_bf16_f32 v84, v84, v85
    v_mfma_f32_16x16x32_bf16 v[124:127], a[208:211], v[228:231], v[124:127]
    ds_write_b128 v248, v[24:27] offset:13248
    v_mfma_f32_16x16x32_bf16 v[124:127], a[196:199], v[236:239], v[124:127]
    buffer_load_dwordx4 v[244:247], v254, s[8:11], s42 offen offset:2048 sc1
    v_mfma_f32_16x16x32_bf16 v[128:131], a[200:203], v[236:239], v[128:131]
    ds_read_b128 v[236:239], v253 offset:37184
    v_and_b32 v227, 0x7fff, v255
    v_mfma_f32_16x16x32_bf16 v[128:131], a[212:215], v[228:231], v[128:131]
    ds_read_b128 a[152:155], v250 offset:11360
    v_cvt_pk_bf16_f32 v85, v86, v87
    v_mfma_f32_16x16x32_bf16 v[108:111], a[216:219], v[228:231], v[108:111]
    buffer_store_dwordx4 a[140:143], v254, s[12:15], s44 offen sc1
    v_cvt_pk_bf16_f32 v86, v88, v89
    v_cvt_pk_bf16_f32 v87, v90, v91
    v_mfma_f32_16x16x32_bf16 v[112:115], a[220:223], v[228:231], v[112:115]
    buffer_load_dwordx2 v[216:217], v227, s[4:7], s16 offen offset:384
    v_mfma_f32_16x16x32_bf16 v[116:119], a[224:227], v[228:231], v[116:119]
    ds_write_b64 v249, v[44:45] offset:13696
    v_mfma_f32_16x16x32_bf16 v[132:135], a[192:195], v[228:231], v[132:135]
    s_waitcnt lgkmcnt(6)
    v_mfma_f32_16x16x32_bf16 v[132:135], a[204:207], v[232:235], v[132:135]
    ds_write_b128 v248, v[36:39] offset:13632
    v_mfma_f32_16x16x32_bf16 v[136:139], a[208:211], v[232:235], v[136:139]
    v_mfma_f32_16x16x32_bf16 v[136:139], a[196:199], v[228:231], v[136:139]
    buffer_load_dwordx2 v[218:219], v227, s[4:7], s17 offen offset:384
    v_mfma_f32_16x16x32_bf16 v[140:143], a[200:203], v[228:231], v[140:143]
    ds_read_b128 v[228:231], v253 offset:36928
    v_mfma_f32_16x16x32_bf16 v[140:143], a[212:215], v[232:235], v[140:143]
    s_add_u32 s44, s40, 201728
    v_mfma_f32_16x16x32_bf16 v[120:123], a[216:219], v[232:235], v[120:123]
    ds_write_b64 v249, v[56:57] offset:14080
    v_mfma_f32_16x16x32_bf16 v[124:127], a[220:223], v[232:235], v[124:127]
    s_waitcnt lgkmcnt(5)
    v_mfma_f32_16x16x32_bf16 v[128:131], a[224:227], v[232:235], v[128:131]
    buffer_load_dwordx2 v[220:221], v227, s[4:7], s18 offen offset:384
    v_mfma_f32_16x16x32_bf16 v[144:147], a[192:195], v[232:235], v[144:147]
    ds_write_b128 v248, v[48:51] offset:14016
    v_mfma_f32_16x16x32_bf16 v[144:147], a[204:207], v[236:239], v[144:147]
    v_mfma_f32_16x16x32_bf16 v[148:151], a[208:211], v[236:239], v[148:151]
    v_mfma_f32_16x16x32_bf16 v[148:151], a[196:199], v[232:235], v[148:151]
    v_mfma_f32_16x16x32_bf16 v[152:155], a[200:203], v[232:235], v[152:155]
    ds_read_b128 v[232:235], v253 offset:36672
    v_mfma_f32_16x16x32_bf16 v[152:155], a[212:215], v[236:239], v[152:155]
    buffer_load_dwordx2 v[222:223], v227, s[4:7], s19 offen offset:384
    v_mfma_f32_16x16x32_bf16 v[132:135], a[216:219], v[236:239], v[132:135]
    ds_write_b64 v249, v[68:69] offset:14464
    v_mfma_f32_16x16x32_bf16 v[136:139], a[220:223], v[236:239], v[136:139]
    v_mfma_f32_16x16x32_bf16 v[140:143], a[224:227], v[236:239], v[140:143]
    ds_write_b128 v248, v[60:63] offset:14400
    v_mfma_f32_16x16x32_bf16 v[156:159], a[192:195], v[236:239], v[156:159]
    s_waitcnt lgkmcnt(5)
    v_mfma_f32_16x16x32_bf16 v[156:159], a[204:207], v[228:231], v[156:159]
    buffer_load_dwordx2 v[224:225], v227, s[4:7], s20 offen offset:384
    v_mfma_f32_16x16x32_bf16 v[160:163], a[208:211], v[228:231], v[160:163]
    v_mfma_f32_16x16x32_bf16 v[160:163], a[196:199], v[236:239], v[160:163]
    ds_write_b64 v249, v[80:81] offset:14848
    v_mfma_f32_16x16x32_bf16 v[164:167], a[200:203], v[236:239], v[164:167]
    ds_read_b128 v[236:239], v253 offset:36416
    v_mfma_f32_16x16x32_bf16 v[164:167], a[212:215], v[228:231], v[164:167]
    ds_write_b128 v248, v[72:75] offset:14784
    v_mfma_f32_16x16x32_bf16 v[144:147], a[216:219], v[228:231], v[144:147]
    buffer_load_dwordx2 v[226:227], v227, s[4:7], s21 offen offset:384
    v_mfma_f32_16x16x32_bf16 v[148:151], a[220:223], v[228:231], v[148:151]
    v_mfma_f32_16x16x32_bf16 v[152:155], a[224:227], v[228:231], v[152:155]
    s_waitcnt lgkmcnt(5)
    v_mfma_f32_16x16x32_bf16 v[168:171], a[192:195], v[228:231], v[168:171]
    ds_write_b64 v249, v[92:93] offset:15232
    v_mfma_f32_16x16x32_bf16 v[168:171], a[204:207], v[232:235], v[168:171]
    v_mfma_f32_16x16x32_bf16 v[172:175], a[208:211], v[232:235], v[172:175]
    v_mfma_f32_16x16x32_bf16 v[172:175], a[196:199], v[228:231], v[172:175]
    ds_write_b128 v248, v[84:87] offset:15168
    v_mfma_f32_16x16x32_bf16 v[176:179], a[200:203], v[228:231], v[176:179]
    ds_read_b128 v[228:231], v253 offset:36144
    v_mfma_f32_16x16x32_bf16 v[176:179], a[212:215], v[232:235], v[176:179]
    v_mfma_f32_16x16x32_bf16 v[156:159], a[216:219], v[232:235], v[156:159]
    v_mfma_f32_16x16x32_bf16 v[160:163], a[220:223], v[232:235], v[160:163]
    s_waitcnt lgkmcnt(4)
    v_mfma_f32_16x16x32_bf16 v[164:167], a[224:227], v[232:235], v[164:167]
    s_mov_b32 s42, 1179648
    v_mfma_f32_16x16x32_bf16 v[180:183], a[192:195], v[232:235], v[180:183]
    buffer_load_dwordx4 a[192:195], v254, s[8:11], s42 offen offset:0 sc1
    v_mfma_f32_16x16x32_bf16 v[184:187], a[196:199], v[232:235], v[184:187]
    s_waitcnt lgkmcnt(0)
    s_waitcnt vmcnt(19)
    v_lshlrev_b32 v248, 16, v206
    v_mfma_f32_16x16x32_bf16 v[188:191], a[200:203], v[232:235], v[188:191]
    s_barrier
    v_lshlrev_b32 v249, 16, v208
    v_mfma_f32_16x16x32_bf16 v[180:183], a[204:207], v[236:239], v[180:183]
    ds_read_b128 v[232:235], v253 offset:38480
    v_lshlrev_b32 v250, 16, v210
    v_mfma_f32_16x16x32_bf16 v[184:187], a[208:211], v[236:239], v[184:187]
    buffer_load_dwordx4 a[196:199], v254, s[8:11], s42 offen offset:1024 sc1
    v_lshlrev_b32 v251, 16, v212
    v_mfma_f32_16x16x32_bf16 v[188:191], a[212:215], v[236:239], v[188:191]
    ds_read_b128 a[0:3], v6 offset:12480
    v_and_b32 v206, s22, v206
    v_mfma_f32_16x16x32_bf16 v[168:171], a[216:219], v[236:239], v[168:171]
    v_and_b32 v208, s22, v208
    v_and_b32 v210, s22, v210
    v_mfma_f32_16x16x32_bf16 v[172:175], a[220:223], v[236:239], v[172:175]
    buffer_load_dwordx4 a[200:203], v254, s[8:11], s42 offen offset:2048 sc1
    v_and_b32 v212, s22, v212
    v_mfma_f32_16x16x32_bf16 v[176:179], a[224:227], v[236:239], v[176:179]
    ds_read_b128 v[236:239], v253 offset:38208
    v_lshlrev_b32 v252, 16, v204
    v_mfma_f32_16x16x32_bf16 v[180:183], a[216:219], v[228:231], v[180:183]
    s_mov_b32 s42, 1182720
    v_and_b32 v204, s22, v204
    v_fmac_f32 v252, s25, v251
    v_fmac_f32 v204, s25, v212
    v_mfma_f32_16x16x32_bf16 v[184:187], a[220:223], v[228:231], v[184:187]
    buffer_load_dwordx4 a[204:207], v254, s[8:11], s42 offen offset:0 sc1
    v_mfma_f32_16x16x32_bf16 v[188:191], a[224:227], v[228:231], v[188:191]
    ds_read_b128 v[228:231], v253 offset:37952
    v_fmac_f32 v252, s28, v249
    s_waitcnt vmcnt(19)
    s_waitcnt lgkmcnt(3)
sub31:
    v_mfma_f32_16x16x32_bf16 v[96:99], a[228:231], v[232:235], v[96:99]
    s_waitcnt vmcnt(15) lgkmcnt(1)
    v_fmac_f32 v204, s28, v208
    v_cvt_pk_bf16_f32 v204, v252, v204
    v_lshlrev_b32 v252, 16, v214
    v_mfma_f32_16x16x32_bf16 v[100:103], a[232:235], v[232:235], v[100:103]
    buffer_store_dwordx4 a[144:147], v254, s[12:15], s44 offen sc1
    s_add_u32 s44, s40, 204800
    v_mfma_f32_16x16x32_bf16 v[104:107], a[236:239], v[232:235], v[104:107]
    ds_read_b128 v[232:235], v253 offset:37696
    v_and_b32 v214, s22, v214
    v_fmac_f32 v252, s29, v248
    v_mfma_f32_16x16x32_bf16 v[96:99], a[240:243], v[236:239], v[96:99]
    buffer_load_dwordx4 a[208:211], v254, s[8:11], s42 offen offset:1024 sc1
    v_mfma_f32_16x16x32_bf16 v[100:103], a[244:247], v[236:239], v[100:103]
    v_fmac_f32 v214, s29, v206
    v_fmac_f32 v252, s23, v250
    v_mfma_f32_16x16x32_bf16 v[104:107], a[248:251], v[236:239], v[104:107]
    v_fmac_f32 v214, s23, v210
    v_cvt_pk_bf16_f32 v214, v252, v214
    v_fma_f32 v252, v249, s24, v251
    v_mfma_f32_16x16x32_bf16 v[108:111], a[228:231], v[236:239], v[108:111]
    s_waitcnt lgkmcnt(1)
    v_fmac_f32 v251, -4.0, v249
    v_fma_f32 v249, v248, s24, v250
    v_mfma_f32_16x16x32_bf16 v[108:111], a[240:243], v[228:231], v[108:111]
    buffer_load_dwordx4 a[212:215], v254, s[8:11], s42 offen offset:2048 sc1
    v_fmac_f32 v250, -4.0, v248
    v_mfma_f32_16x16x32_bf16 v[112:115], a[244:247], v[228:231], v[112:115]
    v_fma_f32 v248, v250, s26, v251
    v_fmac_f32 v251, s27, v250
    v_mfma_f32_16x16x32_bf16 v[112:115], a[232:235], v[236:239], v[112:115]
    s_mov_b32 s42, 1185792
    v_fma_f32 v250, v249, 2.0, v252
    v_fmac_f32 v252, -2.0, v249
    v_mfma_f32_16x16x32_bf16 v[116:119], a[236:239], v[236:239], v[116:119]
    ds_read_b128 v[236:239], v253 offset:37440
    v_fma_f32 v249, v208, s24, v212
    v_fmac_f32 v212, -4.0, v208
    v_mfma_f32_16x16x32_bf16 v[116:119], a[248:251], v[228:231], v[116:119]
    buffer_load_dwordx4 a[216:219], v254, s[8:11], s42 offen offset:0 sc1
    s_waitcnt vmcnt(15)
    v_mfma_f32_16x16x32_bf16 v[96:99], a[252:255], v[228:231], v[96:99]
    ds_read_b128 a[4:7], v6 offset:13504
    v_fma_f32 v208, v206, s24, v210
    v_fmac_f32 v210, -4.0, v206
    v_mfma_f32_16x16x32_bf16 v[100:103], v[240:243], v[228:231], v[100:103]
    buffer_store_dwordx4 a[148:151], v254, s[12:15], s44 offen sc1
    s_add_u32 s44, s40, 207872
    v_mfma_f32_16x16x32_bf16 v[104:107], v[244:247], v[228:231], v[104:107]
    s_waitcnt lgkmcnt(2)
    v_fma_f32 v206, v210, s26, v212
    v_fmac_f32 v212, s27, v210
    v_mfma_f32_16x16x32_bf16 v[120:123], a[228:231], v[228:231], v[120:123]
    buffer_load_dwordx4 a[220:223], v254, s[8:11], s42 offen offset:1024 sc1
    v_fma_f32 v210, v208, 2.0, v249
    v_mfma_f32_16x16x32_bf16 v[120:123], a[240:243], v[232:235], v[120:123]
    v_fmac_f32 v249, -2.0, v208
    v_cvt_pk_bf16_f32 v206, v248, v206
    v_mfma_f32_16x16x32_bf16 v[124:127], a[244:247], v[232:235], v[124:127]
    v_cvt_pk_bf16_f32 v212, v251, v212
    v_cvt_pk_bf16_f32 v210, v250, v210
    v_cvt_pk_bf16_f32 v208, v252, v249
    v_mfma_f32_16x16x32_bf16 v[124:127], a[232:235], v[228:231], v[124:127]
    buffer_load_dwordx4 a[224:227], v254, s[8:11], s42 offen offset:2048 sc1
    v_mfma_f32_16x16x32_bf16 v[128:131], a[236:239], v[228:231], v[128:131]
    ds_read_b128 v[228:231], v253 offset:39264
    v_and_b32 v203, 0x7fff, v255
    v_mfma_f32_16x16x32_bf16 v[128:131], a[248:251], v[232:235], v[128:131]
    v_lshlrev_b32 v248, 16, v207
    v_lshlrev_b32 v249, 16, v209
    v_lshlrev_b32 v250, 16, v211
    v_mfma_f32_16x16x32_bf16 v[108:111], a[252:255], v[232:235], v[108:111]
    buffer_store_dwordx4 a[152:155], v254, s[12:15], s44 offen sc1
    v_lshlrev_b32 v251, 16, v213
    v_and_b32 v207, s22, v207
    v_mfma_f32_16x16x32_bf16 v[112:115], v[240:243], v[232:235], v[112:115]
    buffer_load_dwordx2 v[192:193], v203, s[4:7], s16 offen offset:768
    v_and_b32 v209, s22, v209
    v_mfma_f32_16x16x32_bf16 v[116:119], v[244:247], v[232:235], v[116:119]
    v_and_b32 v211, s22, v211
    v_and_b32 v213, s22, v213
    v_mfma_f32_16x16x32_bf16 v[132:135], a[228:231], v[232:235], v[132:135]
    s_waitcnt lgkmcnt(2)
    v_lshlrev_b32 v252, 16, v205
    v_and_b32 v205, s22, v205
    v_mfma_f32_16x16x32_bf16 v[132:135], a[240:243], v[236:239], v[132:135]
    v_fmac_f32 v252, s25, v251
    v_fmac_f32 v205, s25, v213
    v_fmac_f32 v252, s28, v249
    v_mfma_f32_16x16x32_bf16 v[136:139], a[244:247], v[236:239], v[136:139]
    v_fmac_f32 v205, s28, v209
    v_cvt_pk_bf16_f32 v205, v252, v205
    v_mfma_f32_16x16x32_bf16 v[136:139], a[232:235], v[232:235], v[136:139]
    buffer_load_dwordx2 v[194:195], v203, s[4:7], s17 offen offset:768
    v_lshlrev_b32 v252, 16, v215
    v_mfma_f32_16x16x32_bf16 v[140:143], a[236:239], v[232:235], v[140:143]
    ds_read_b128 v[232:235], v253 offset:39008
    v_and_b32 v215, s22, v215
    v_mfma_f32_16x16x32_bf16 v[140:143], a[248:251], v[236:239], v[140:143]
    v_fmac_f32 v252, s29, v248
    v_fmac_f32 v215, s29, v207
    v_mfma_f32_16x16x32_bf16 v[120:123], a[252:255], v[236:239], v[120:123]
    s_add_u32 s44, s40, 0
    v_fmac_f32 v252, s23, v250
    v_fmac_f32 v215, s23, v211
    v_cvt_pk_bf16_f32 v215, v252, v215
    v_mfma_f32_16x16x32_bf16 v[124:127], v[240:243], v[236:239], v[124:127]
    s_waitcnt lgkmcnt(1)
    v_fma_f32 v252, v249, s24, v251
    v_fmac_f32 v251, -4.0, v249
    v_mfma_f32_16x16x32_bf16 v[128:131], v[244:247], v[236:239], v[128:131]
    buffer_load_dwordx2 v[196:197], v203, s[4:7], s18 offen offset:768
    v_fma_f32 v249, v248, s24, v250
    v_mfma_f32_16x16x32_bf16 v[144:147], a[228:231], v[236:239], v[144:147]
    ds_read_b128 a[8:11], v6 offset:14528
    v_fmac_f32 v250, -4.0, v248
    v_mfma_f32_16x16x32_bf16 v[144:147], a[240:243], v[228:231], v[144:147]
    v_fma_f32 v248, v250, s26, v251
    v_fmac_f32 v251, s27, v250
    v_mfma_f32_16x16x32_bf16 v[148:151], a[244:247], v[228:231], v[148:151]
    v_fma_f32 v250, v249, 2.0, v252
    v_fmac_f32 v252, -2.0, v249
    v_fma_f32 v249, v209, s24, v213
    v_mfma_f32_16x16x32_bf16 v[148:151], a[232:235], v[236:239], v[148:151]
    v_fmac_f32 v213, -4.0, v209
    v_fma_f32 v209, v207, s24, v211
    v_mfma_f32_16x16x32_bf16 v[152:155], a[236:239], v[236:239], v[152:155]
    ds_read_b128 v[236:239], v253 offset:38752
    v_fmac_f32 v211, -4.0, v207
    v_mfma_f32_16x16x32_bf16 v[152:155], a[248:251], v[228:231], v[152:155]
    buffer_load_dwordx2 v[198:199], v203, s[4:7], s19 offen offset:768
    v_mfma_f32_16x16x32_bf16 v[132:135], a[252:255], v[228:231], v[132:135]
    v_fma_f32 v207, v211, s26, v213
    v_fmac_f32 v213, s27, v211
    v_mfma_f32_16x16x32_bf16 v[136:139], v[240:243], v[228:231], v[136:139]
    v_fma_f32 v211, v209, 2.0, v249
    v_fmac_f32 v249, -2.0, v209
    v_cvt_pk_bf16_f32 v207, v248, v207
    v_mfma_f32_16x16x32_bf16 v[140:143], v[244:247], v[228:231], v[140:143]
    v_cvt_pk_bf16_f32 v213, v251, v213
    v_cvt_pk_bf16_f32 v211, v250, v211
    v_mfma_f32_16x16x32_bf16 v[156:159], a[228:231], v[228:231], v[156:159]
    s_waitcnt lgkmcnt(2)
    v_cvt_pk_bf16_f32 v209, v252, v249
    v_lshrrev_b32 v252, 15, v255
    v_mfma_f32_16x16x32_bf16 v[156:159], a[240:243], v[232:235], v[156:159]
    buffer_load_dwordx2 v[200:201], v203, s[4:7], s20 offen offset:768
    v_mfma_f32_16x16x32_bf16 v[160:163], a[244:247], v[232:235], v[160:163]
    ds_write_b64 v252, v[206:207] offset:768
    v_mfma_f32_16x16x32_bf16 v[160:163], a[232:235], v[228:231], v[160:163]
    s_waitcnt vmcnt(17)
    v_lshlrev_b32 v248, 16, v218
    v_lshlrev_b32 v249, 16, v220
    v_mfma_f32_16x16x32_bf16 v[164:167], a[236:239], v[228:231], v[164:167]
    ds_read_b128 v[228:231], v253 offset:38496
    v_mfma_f32_16x16x32_bf16 v[164:167], a[248:251], v[232:235], v[164:167]
    ds_write_b64 v252, v[212:213] offset:2848
    v_lshlrev_b32 v250, 16, v222
    v_mfma_f32_16x16x32_bf16 v[144:147], a[252:255], v[232:235], v[144:147]
    buffer_load_dwordx2 v[202:203], v203, s[4:7], s21 offen offset:768
    v_mfma_f32_16x16x32_bf16 v[148:151], v[240:243], v[232:235], v[148:151]
    v_lshlrev_b32 v251, 16, v224
    v_mfma_f32_16x16x32_bf16 v[152:155], v[244:247], v[232:235], v[152:155]
    ds_write_b64 v252, v[210:211] offset:4928
    v_and_b32 v218, s22, v218
    v_mfma_f32_16x16x32_bf16 v[168:171], a[228:231], v[232:235], v[168:171]
    s_waitcnt lgkmcnt(4)
    v_and_b32 v220, s22, v220
    v_mfma_f32_16x16x32_bf16 v[168:171], a[240:243], v[236:239], v[168:171]
    ds_write_b64 v252, v[204:205] offset:34048
    v_and_b32 v222, s22, v222
    v_mfma_f32_16x16x32_bf16 v[172:175], a[244:247], v[236:239], v[172:175]
    ds_read_b128 a[12:15], v6 offset:15584
    v_and_b32 v224, s22, v224
    v_mfma_f32_16x16x32_bf16 v[172:175], a[232:235], v[232:235], v[172:175]
    ds_write_b64 v252, v[214:215] offset:36128
    v_mfma_f32_16x16x32_bf16 v[176:179], a[236:239], v[232:235], v[176:179]
    ds_read_b128 v[232:235], v253 offset:38224
    v_mfma_f32_16x16x32_bf16 v[176:179], a[248:251], v[236:239], v[176:179]
    ds_write_b64 v252, v[208:209] offset:7008
    v_mfma_f32_16x16x32_bf16 v[156:159], a[252:255], v[236:239], v[156:159]
    v_mfma_f32_16x16x32_bf16 v[160:163], v[240:243], v[236:239], v[160:163]
    v_mfma_f32_16x16x32_bf16 v[164:167], v[244:247], v[236:239], v[164:167]
    s_mov_b32 s42, 1216512
    v_mfma_f32_16x16x32_bf16 v[180:183], a[228:231], v[236:239], v[180:183]
    buffer_load_dwordx4 a[228:231], v254, s[8:11], s42 offen offset:0 sc1
    v_mfma_f32_16x16x32_bf16 v[184:187], a[232:235], v[236:239], v[184:187]
    v_lshlrev_b32 v252, 16, v216
    v_and_b32 v216, s22, v216
    v_mfma_f32_16x16x32_bf16 v[188:191], a[236:239], v[236:239], v[188:191]
    s_waitcnt lgkmcnt(7)
    v_fmac_f32 v252, s25, v251
    v_fmac_f32 v216, s25, v224
    v_mfma_f32_16x16x32_bf16 v[180:183], a[240:243], v[228:231], v[180:183]
    ds_read_b128 v[236:239], v253 offset:26000
    v_fmac_f32 v252, s28, v249
    v_mfma_f32_16x16x32_bf16 v[184:187], a[244:247], v[228:231], v[184:187]
    buffer_load_dwordx4 a[232:235], v254, s[8:11], s42 offen offset:1024 sc1
    v_mfma_f32_16x16x32_bf16 v[188:191], a[248:251], v[228:231], v[188:191]
    v_fmac_f32 v216, s28, v220
    v_cvt_pk_bf16_f32 v216, v252, v216
    v_mfma_f32_16x16x32_bf16 v[168:171], a[252:255], v[228:231], v[168:171]
    s_waitcnt lgkmcnt(2)
    v_lshlrev_b32 v252, 16, v226
    v_and_b32 v226, s22, v226
    v_mfma_f32_16x16x32_bf16 v[172:175], v[240:243], v[228:231], v[172:175]
    buffer_load_dwordx4 a[236:239], v254, s[8:11], s42 offen offset:2048 sc1
    v_fmac_f32 v252, s29, v248
    v_mfma_f32_16x16x32_bf16 v[176:179], v[244:247], v[228:231], v[176:179]
    ds_read_b128 v[228:231], v253 offset:25728
    v_fmac_f32 v226, s29, v218
    v_mfma_f32_16x16x32_bf16 v[180:183], a[252:255], v[232:235], v[180:183]
    s_mov_b32 s42, 1219584
    v_fmac_f32 v252, s23, v250
    v_fmac_f32 v226, s23, v222
    v_mfma_f32_16x16x32_bf16 v[184:187], v[240:243], v[232:235], v[184:187]
pad12:
    s_cbranch_vccnz warm_ret
    buffer_load_dwordx4 a[240:243], v254, s[8:11], s42 offen offset:0 sc1
    v_mfma_f32_16x16x32_bf16 v[188:191], v[244:247], v[232:235], v[188:191]
    ds_read_b128 v[232:235], v253 offset:25472
    v_cvt_pk_bf16_f32 v226, v252, v226
    s_waitcnt vmcnt(19)
    s_waitcnt lgkmcnt(2)
sub32:
    v_mfma_f32_16x16x32_bf16 v[96:99], a[192:195], v[236:239], v[96:99]
    s_waitcnt vmcnt(15) lgkmcnt(1)
    v_fma_f32 v252, v249, s24, v251
    v_fmac_f32 v251, -4.0, v249
    v_mfma_f32_16x16x32_bf16 v[100:103], a[196:199], v[236:239], v[100:103]
    buffer_store_dwordx4 a[0:3], v254, s[12:15], s44 offen sc1
    s_add_u32 s44, s40, 1024
    v_mfma_f32_16x16x32_bf16 v[104:107], a[200:203], v[236:239], v[104:107]
    ds_read_b128 v[236:239], v253 offset:25216
    v_fma_f32 v249, v248, s24, v250
    v_mfma_f32_16x16x32_bf16 v[96:99], a[204:207], v[228:231], v[96:99]
    buffer_load_dwordx4 a[244:247], v254, s[8:11], s42 offen offset:1024 sc1
    v_mfma_f32_16x16x32_bf16 v[100:103], a[208:211], v[228:231], v[100:103]
    ds_read_b128 a[16:19], v6 offset:16608
    v_fmac_f32 v250, -4.0, v248
    v_mfma_f32_16x16x32_bf16 v[104:107], a[212:215], v[228:231], v[104:107]
    v_fma_f32 v248, v250, s26, v251
    v_fmac_f32 v251, s27, v250
    v_fma_f32 v250, v249, 2.0, v252
    v_mfma_f32_16x16x32_bf16 v[108:111], a[192:195], v[228:231], v[108:111]
    s_waitcnt lgkmcnt(2)
    v_fmac_f32 v252, -2.0, v249
    v_fma_f32 v249, v220, s24, v224
    v_mfma_f32_16x16x32_bf16 v[108:111], a[204:207], v[232:235], v[108:111]
    buffer_load_dwordx4 a[248:251], v254, s[8:11], s42 offen offset:2048 sc1
    v_mfma_f32_16x16x32_bf16 v[112:115], a[208:211], v[232:235], v[112:115]
    v_fmac_f32 v224, -4.0, v220
    v_fma_f32 v220, v218, s24, v222
    v_mfma_f32_16x16x32_bf16 v[112:115], a[196:199], v[228:231], v[112:115]
    s_mov_b32 s42, 1222656
    v_fmac_f32 v222, -4.0, v218
    v_fma_f32 v218, v222, s26, v224
    v_mfma_f32_16x16x32_bf16 v[116:119], a[200:203], v[228:231], v[116:119]
    ds_read_b128 v[228:231], v253 offset:24960
    v_fmac_f32 v224, s27, v222
    v_mfma_f32_16x16x32_bf16 v[116:119], a[212:215], v[232:235], v[116:119]
    buffer_load_dwordx4 a[252:255], v254, s[8:11], s42 offen offset:0 sc1
    s_waitcnt vmcnt(15)
    v_mfma_f32_16x16x32_bf16 v[96:99], a[216:219], v[232:235], v[96:99]
    v_fma_f32 v222, v220, 2.0, v249
    v_fmac_f32 v249, -2.0, v220
    v_mfma_f32_16x16x32_bf16 v[100:103], a[220:223], v[232:235], v[100:103]
    buffer_store_dwordx4 a[4:7], v254, s[12:15], s44 offen sc1
    s_add_u32 s44, s40, 2048
    v_mfma_f32_16x16x32_bf16 v[104:107], a[224:227], v[232:235], v[104:107]
    s_waitcnt lgkmcnt(2)
    v_cvt_pk_bf16_f32 v218, v248, v218
    v_cvt_pk_bf16_f32 v224, v251, v224
    v_mfma_f32_16x16x32_bf16 v[120:123], a[192:195], v[232:235], v[120:123]
    buffer_load_dwordx4 v[240:243], v254, s[8:11], s42 offen offset:1024 sc1
    v_cvt_pk_bf16_f32 v222, v250, v222
    v_mfma_f32_16x16x32_bf16 v[120:123], a[204:207], v[236:239], v[120:123]
    v_cvt_pk_bf16_f32 v220, v252, v249
    v_lshlrev_b32 v248, 16, v219
    v_mfma_f32_16x16x32_bf16 v[124:127], a[208:211], v[236:239], v[124:127]
    v_lshlrev_b32 v249, 16, v221
    v_lshlrev_b32 v250, 16, v223
    v_mfma_f32_16x16x32_bf16 v[124:127], a[196:199], v[232:235], v[124:127]
    buffer_load_dwordx4 v[244:247], v254, s[8:11], s42 offen offset:2048 sc1
    v_mfma_f32_16x16x32_bf16 v[128:131], a[200:203], v[232:235], v[128:131]
    ds_read_b128 v[232:235], v253 offset:26784
    v_and_b32 v215, 0x7fff, v255
    v_mfma_f32_16x16x32_bf16 v[128:131], a[212:215], v[236:239], v[128:131]
    v_lshlrev_b32 v251, 16, v225
    v_and_b32 v219, s22, v219
    v_mfma_f32_16x16x32_bf16 v[108:111], a[216:219], v[236:239], v[108:111]
    buffer_store_dwordx4 a[8:11], v254, s[12:15], s44 offen sc1
    v_and_b32 v221, s22, v221
    v_and_b32 v223, s22, v223
    v_mfma_f32_16x16x32_bf16 v[112:115], a[220:223], v[236:239], v[112:115]
    buffer_load_dwordx2 v[204:205], v215, s[4:7], s16 offen offset:1152
    v_mfma_f32_16x16x32_bf16 v[116:119], a[224:227], v[236:239], v[116:119]
    ds_read_b128 a[20:23], v6 offset:17632
    v_and_b32 v225, s22, v225
    v_mfma_f32_16x16x32_bf16 v[132:135], a[192:195], v[236:239], v[132:135]
    s_waitcnt lgkmcnt(2)
    v_lshlrev_b32 v252, 16, v217
    v_and_b32 v217, s22, v217
    v_mfma_f32_16x16x32_bf16 v[132:135], a[204:207], v[228:231], v[132:135]
    s_add_u32 s44, s40, 3072
    v_fmac_f32 v252, s25, v251
    v_fmac_f32 v217, s25, v225
    v_fmac_f32 v252, s28, v249
    v_mfma_f32_16x16x32_bf16 v[136:139], a[208:211], v[228:231], v[136:139]
    v_fmac_f32 v217, s28, v221
    v_cvt_pk_bf16_f32 v217, v252, v217
    v_mfma_f32_16x16x32_bf16 v[136:139], a[196:199], v[236:239], v[136:139]
    buffer_load_dwordx2 v[206:207], v215, s[4:7], s17 offen offset:1152
    v_mfma_f32_16x16x32_bf16 v[140:143], a[200:203], v[236:239], v[140:143]
    ds_read_b128 v[236:239], v253 offset:26528
    v_lshlrev_b32 v252, 16, v227
    v_mfma_f32_16x16x32_bf16 v[140:143], a[212:215], v[228:231], v[140:143]
    v_and_b32 v227, s22, v227
    v_fmac_f32 v252, s29, v248
    v_mfma_f32_16x16x32_bf16 v[120:123], a[216:219], v[228:231], v[120:123]
    v_fmac_f32 v227, s29, v219
    v_fmac_f32 v252, s23, v250
    v_mfma_f32_16x16x32_bf16 v[124:127], a[220:223], v[228:231], v[124:127]
    v_fmac_f32 v227, s23, v223
    v_cvt_pk_bf16_f32 v227, v252, v227
    v_mfma_f32_16x16x32_bf16 v[128:131], a[224:227], v[228:231], v[128:131]
    buffer_load_dwordx2 v[208:209], v215, s[4:7], s18 offen offset:1152
    v_mfma_f32_16x16x32_bf16 v[144:147], a[192:195], v[228:231], v[144:147]
    s_waitcnt lgkmcnt(2)
    v_fma_f32 v252, v249, s24, v251
    v_fmac_f32 v251, -4.0, v249
    v_mfma_f32_16x16x32_bf16 v[144:147], a[204:207], v[232:235], v[144:147]
    v_fma_f32 v249, v248, s24, v250
    v_fmac_f32 v250, -4.0, v248
    v_mfma_f32_16x16x32_bf16 v[148:151], a[208:211], v[232:235], v[148:151]
    v_fma_f32 v248, v250, s26, v251
    v_fmac_f32 v251, s27, v250
    v_fma_f32 v250, v249, 2.0, v252
    v_mfma_f32_16x16x32_bf16 v[148:151], a[196:199], v[228:231], v[148:151]
    v_fmac_f32 v252, -2.0, v249
    v_fma_f32 v249, v221, s24, v225
    v_mfma_f32_16x16x32_bf16 v[152:155], a[200:203], v[228:231], v[152:155]
    ds_read_b128 v[228:231], v253 offset:26272
    v_fmac_f32 v225, -4.0, v221
    v_mfma_f32_16x16x32_bf16 v[152:155], a[212:215], v[232:235], v[152:155]
    buffer_load_dwordx2 v[210:211], v215, s[4:7], s19 offen offset:1152
    v_mfma_f32_16x16x32_bf16 v[132:135], a[216:219], v[232:235], v[132:135]
    v_fma_f32 v221, v219, s24, v223
    v_fmac_f32 v223, -4.0, v219
    v_mfma_f32_16x16x32_bf16 v[136:139], a[220:223], v[232:235], v[136:139]
    v_fma_f32 v219, v223, s26, v225
    v_fmac_f32 v225, s27, v223
    v_mfma_f32_16x16x32_bf16 v[140:143], a[224:227], v[232:235], v[140:143]
    s_waitcnt lgkmcnt(1)
    v_fma_f32 v223, v221, 2.0, v249
    v_fmac_f32 v249, -2.0, v221
    v_mfma_f32_16x16x32_bf16 v[156:159], a[192:195], v[232:235], v[156:159]
    ds_read_b128 a[24:27], v6 offset:18688
    v_cvt_pk_bf16_f32 v219, v248, v219
    v_mfma_f32_16x16x32_bf16 v[156:159], a[204:207], v[236:239], v[156:159]
    buffer_load_dwordx2 v[212:213], v215, s[4:7], s20 offen offset:1152
    v_mfma_f32_16x16x32_bf16 v[160:163], a[208:211], v[236:239], v[160:163]
    v_cvt_pk_bf16_f32 v225, v251, v225
    v_cvt_pk_bf16_f32 v223, v250, v223
    v_mfma_f32_16x16x32_bf16 v[160:163], a[196:199], v[232:235], v[160:163]
    v_cvt_pk_bf16_f32 v221, v252, v249
    v_lshrrev_b32 v252, 15, v255
    v_mfma_f32_16x16x32_bf16 v[164:167], a[200:203], v[232:235], v[164:167]
    ds_read_b128 v[232:235], v253 offset:26016
    v_mfma_f32_16x16x32_bf16 v[164:167], a[212:215], v[236:239], v[164:167]
    ds_write_b64 v252, v[218:219] offset:512
    v_mfma_f32_16x16x32_bf16 v[144:147], a[216:219], v[236:239], v[144:147]
    buffer_load_dwordx2 v[214:215], v215, s[4:7], s21 offen offset:1152
    v_mfma_f32_16x16x32_bf16 v[148:151], a[220:223], v[236:239], v[148:151]
    s_waitcnt vmcnt(18)
    v_lshlrev_b32 v248, 16, v194
    v_lshlrev_b32 v249, 16, v196
    v_mfma_f32_16x16x32_bf16 v[152:155], a[224:227], v[236:239], v[152:155]
    ds_write_b64 v252, v[224:225] offset:2592
    v_mfma_f32_16x16x32_bf16 v[168:171], a[192:195], v[236:239], v[168:171]
    s_waitcnt lgkmcnt(4)
    v_lshlrev_b32 v250, 16, v198
    v_lshlrev_b32 v251, 16, v200
    v_mfma_f32_16x16x32_bf16 v[168:171], a[204:207], v[228:231], v[168:171]
    ds_write_b64 v252, v[222:223] offset:4672
    v_mfma_f32_16x16x32_bf16 v[172:175], a[208:211], v[228:231], v[172:175]
    v_and_b32 v194, s22, v194
    v_and_b32 v196, s22, v196
    v_mfma_f32_16x16x32_bf16 v[172:175], a[196:199], v[236:239], v[172:175]
    ds_write_b64 v252, v[216:217] offset:33792
    v_mfma_f32_16x16x32_bf16 v[176:179], a[200:203], v[236:239], v[176:179]
    ds_read_b128 v[236:239], v253 offset:25744
    v_and_b32 v198, s22, v198
    v_and_b32 v200, s22, v200
    v_mfma_f32_16x16x32_bf16 v[176:179], a[212:215], v[228:231], v[176:179]
    ds_write_b64 v252, v[226:227] offset:35872
    v_mfma_f32_16x16x32_bf16 v[156:159], a[216:219], v[228:231], v[156:159]
    v_mfma_f32_16x16x32_bf16 v[160:163], a[220:223], v[228:231], v[160:163]
    ds_write_b64 v252, v[220:221] offset:6752
    v_mfma_f32_16x16x32_bf16 v[164:167], a[224:227], v[228:231], v[164:167]
    s_mov_b32 s42, 1253376
    v_mfma_f32_16x16x32_bf16 v[180:183], a[192:195], v[228:231], v[180:183]
    buffer_load_dwordx4 a[192:195], v254, s[8:11], s42 offen offset:0 sc1
    v_mfma_f32_16x16x32_bf16 v[184:187], a[196:199], v[228:231], v[184:187]
    s_waitcnt lgkmcnt(7)
    v_lshlrev_b32 v252, 16, v192
    v_and_b32 v192, s22, v192
    v_mfma_f32_16x16x32_bf16 v[188:191], a[200:203], v[228:231], v[188:191]
    ds_read_b128 a[28:31], v6 offset:19712
    v_fmac_f32 v252, s25, v251
    v_fmac_f32 v192, s25, v200
    v_mfma_f32_16x16x32_bf16 v[180:183], a[204:207], v[232:235], v[180:183]
    ds_read_b128 v[228:231], v253 offset:28080
    v_fmac_f32 v252, s28, v249
    v_mfma_f32_16x16x32_bf16 v[184:187], a[208:211], v[232:235], v[184:187]
    buffer_load_dwordx4 a[196:199], v254, s[8:11], s42 offen offset:1024 sc1
    v_mfma_f32_16x16x32_bf16 v[188:191], a[212:215], v[232:235], v[188:191]
    ds_read_b128 v[216:219], v253 offset:39520
    v_fmac_f32 v192, s28, v196
    v_mfma_f32_16x16x32_bf16 v[168:171], a[216:219], v[232:235], v[168:171]
    s_mov_b32 s45, 573637648
    v_cvt_pk_bf16_f32 v192, v252, v192
    v_lshlrev_b32 v252, 16, v202
    v_mfma_f32_16x16x32_bf16 v[172:175], a[220:223], v[232:235], v[172:175]
    buffer_load_dwordx4 a[200:203], v254, s[8:11], s42 offen offset:2048 sc1
    v_mfma_f32_16x16x32_bf16 v[176:179], a[224:227], v[232:235], v[176:179]
    ds_read_b128 v[232:235], v253 offset:27808
    v_and_b32 v202, s22, v202
    s_waitcnt lgkmcnt(6)
    v_mfma_f32_16x16x32_bf16 v[180:183], a[216:219], v[236:239], v[180:183]
    s_mov_b32 s42, 1256448
    v_bfe_u32 v220, v254, 5, 3
    v_fmac_f32 v252, s29, v248
    v_fmac_f32 v202, s29, v194
    v_mfma_f32_16x16x32_bf16 v[184:187], a[220:223], v[236:239], v[184:187]
    buffer_load_dwordx4 a[204:207], v254, s[8:11], s42 offen offset:0 sc1
    v_mfma_f32_16x16x32_bf16 v[188:191], a[224:227], v[236:239], v[188:191]
    ds_read_b128 v[236:239], v253 offset:27552
    v_mul_u32_u24 v221, 5, v220
    s_waitcnt vmcnt(19)
    s_waitcnt lgkmcnt(3)
sub33:
    v_mfma_f32_16x16x32_bf16 v[96:99], a[228:231], v[228:231], v[96:99]
    v_fmac_f32 v252, s23, v250
    v_fmac_f32 v202, s23, v198
    v_mfma_f32_16x16x32_bf16 v[100:103], a[232:235], v[228:231], v[100:103]
    s_waitcnt vmcnt(15) lgkmcnt(1)
    v_cvt_pk_bf16_f32 v202, v252, v202
    v_fma_f32 v252, v249, s24, v251
    v_mfma_f32_16x16x32_bf16 v[104:107], a[236:239], v[228:231], v[104:107]
    ds_read_b128 v[228:231], v253 offset:27296
    v_bfe_u32 v221, s45, v221, 5
    v_mfma_f32_16x16x32_bf16 v[96:99], a[240:243], v[232:235], v[96:99]
    buffer_load_dwordx4 a[208:211], v254, s[8:11], s42 offen offset:1024 sc1
    v_fmac_f32 v251, -4.0, v249
    v_mfma_f32_16x16x32_bf16 v[100:103], a[244:247], v[232:235], v[100:103]
    v_fma_f32 v249, v248, s24, v250
    v_fmac_f32 v250, -4.0, v248
    v_mfma_f32_16x16x32_bf16 v[104:107], a[248:251], v[232:235], v[104:107]
    v_mul_u32_u24 v221, 65, v221
    v_fma_f32 v248, v250, s26, v251
    v_mfma_f32_16x16x32_bf16 v[108:111], a[228:231], v[232:235], v[108:111]
    s_waitcnt lgkmcnt(1)
    v_fmac_f32 v251, s27, v250
    v_fma_f32 v250, v249, 2.0, v252
    v_mfma_f32_16x16x32_bf16 v[108:111], a[240:243], v[236:239], v[108:111]
    buffer_load_dwordx4 a[212:215], v254, s[8:11], s42 offen offset:2048 sc1
    v_mfma_f32_16x16x32_bf16 v[112:115], a[244:247], v[236:239], v[112:115]
    v_sub_u32 v221, v221, v220
    v_fmac_f32 v252, -2.0, v249
    v_mfma_f32_16x16x32_bf16 v[112:115], a[232:235], v[232:235], v[112:115]
    s_mov_b32 s42, 1259520
    v_fma_f32 v249, v196, s24, v200
    v_fmac_f32 v200, -4.0, v196
    v_mfma_f32_16x16x32_bf16 v[116:119], a[236:239], v[232:235], v[116:119]
    ds_read_b128 v[232:235], v253 offset:27040
    v_lshl_add_u32 v220, v221, 5, v253
    v_fma_f32 v196, v194, s24, v198
    v_mfma_f32_16x16x32_bf16 v[116:119], a[248:251], v[236:239], v[116:119]
    buffer_load_dwordx4 a[216:219], v254, s[8:11], s42 offen offset:0 sc1
    s_waitcnt vmcnt(14)
    v_mfma_f32_16x16x32_bf16 v[96:99], a[252:255], v[236:239], v[96:99]
    ds_read_b128 a[32:35], v6 offset:20736
    v_mfma_f32_16x16x32_bf16 v[100:103], v[240:243], v[236:239], v[100:103]
    v_fmac_f32 v198, -4.0, v194
    v_fma_f32 v194, v198, s26, v200
    v_mfma_f32_16x16x32_bf16 v[104:107], v[244:247], v[236:239], v[104:107]
    s_waitcnt lgkmcnt(2)
    v_fmac_f32 v200, s27, v198
    v_fma_f32 v198, v196, 2.0, v249
    v_mfma_f32_16x16x32_bf16 v[120:123], a[228:231], v[236:239], v[120:123]
    buffer_load_dwordx4 a[220:223], v254, s[8:11], s42 offen offset:1024 sc1
    v_mfma_f32_16x16x32_bf16 v[120:123], a[240:243], v[228:231], v[120:123]
    s_mov_b64 exec, s[46:47]
    ds_write_b128 v220, v[216:219] offset:1024
    s_mov_b64 exec, -1
    v_mfma_f32_16x16x32_bf16 v[124:127], a[244:247], v[228:231], v[124:127]
    v_fmac_f32 v249, -2.0, v196
    v_cvt_pk_bf16_f32 v194, v248, v194
    v_cvt_pk_bf16_f32 v200, v251, v200
    v_mfma_f32_16x16x32_bf16 v[124:127], a[232:235], v[236:239], v[124:127]
    buffer_load_dwordx4 a[224:227], v254, s[8:11], s42 offen offset:2048 sc1
    v_mfma_f32_16x16x32_bf16 v[128:131], a[236:239], v[236:239], v[128:131]
    ds_read_b128 v[236:239], v253 offset:28864
    v_cvt_pk_bf16_f32 v198, v250, v198
    v_mfma_f32_16x16x32_bf16 v[128:131], a[248:251], v[228:231], v[128:131]
    v_cvt_pk_bf16_f32 v196, v252, v249
    v_lshlrev_b32 v248, 16, v195
    v_mfma_f32_16x16x32_bf16 v[108:111], a[252:255], v[228:231], v[108:111]
    buffer_store_dwordx4 a[12:15], v254, s[12:15], s44 offen sc1
    s_add_u32 s44, s40, 4096
    v_mfma_f32_16x16x32_bf16 v[112:115], v[240:243], v[228:231], v[112:115]
    v_lshlrev_b32 v249, 16, v197
    v_lshlrev_b32 v250, 16, v199
    v_mfma_f32_16x16x32_bf16 v[116:119], v[244:247], v[228:231], v[116:119]
    s_waitcnt lgkmcnt(3)
    v_lshlrev_b32 v251, 16, v201
    v_and_b32 v195, s22, v195
    v_and_b32 v197, s22, v197
    v_mfma_f32_16x16x32_bf16 v[132:135], a[228:231], v[228:231], v[132:135]
    buffer_store_dwordx4 a[16:19], v254, s[12:15], s44 offen sc1
    s_add_u32 s44, s40, 5120
    v_mfma_f32_16x16x32_bf16 v[132:135], a[240:243], v[232:235], v[132:135]
    v_and_b32 v199, s22, v199
    v_and_b32 v201, s22, v201
    v_mfma_f32_16x16x32_bf16 v[136:139], a[244:247], v[232:235], v[136:139]
    v_lshlrev_b32 v252, 16, v193
    v_and_b32 v193, s22, v193
    v_mfma_f32_16x16x32_bf16 v[136:139], a[232:235], v[228:231], v[136:139]
    buffer_store_dwordx4 a[20:23], v254, s[12:15], s44 offen sc1
    s_add_u32 s44, s40, 6144
    v_fmac_f32 v252, s25, v251
    v_mfma_f32_16x16x32_bf16 v[140:143], a[236:239], v[228:231], v[140:143]
    ds_read_b128 v[228:231], v253 offset:28608
    v_mfma_f32_16x16x32_bf16 v[140:143], a[248:251], v[232:235], v[140:143]
    v_fmac_f32 v193, s25, v201
    v_fmac_f32 v252, s28, v249
    v_mfma_f32_16x16x32_bf16 v[120:123], a[252:255], v[232:235], v[120:123]
    v_fmac_f32 v193, s28, v197
    v_cvt_pk_bf16_f32 v193, v252, v193
    v_lshlrev_b32 v252, 16, v203
    v_mfma_f32_16x16x32_bf16 v[124:127], v[240:243], v[232:235], v[124:127]
    ds_read_b128 a[36:39], v6 offset:21792
    v_and_b32 v203, s22, v203
    v_mfma_f32_16x16x32_bf16 v[128:131], v[244:247], v[232:235], v[128:131]
    v_fmac_f32 v252, s29, v248
    v_fmac_f32 v203, s29, v195
    v_mfma_f32_16x16x32_bf16 v[144:147], a[228:231], v[232:235], v[144:147]
    s_waitcnt lgkmcnt(2)
    v_fmac_f32 v252, s23, v250
    v_fmac_f32 v203, s23, v199
    v_mfma_f32_16x16x32_bf16 v[144:147], a[240:243], v[236:239], v[144:147]
    v_cvt_pk_bf16_f32 v203, v252, v203
    v_fma_f32 v252, v249, s24, v251
    v_mfma_f32_16x16x32_bf16 v[148:151], a[244:247], v[236:239], v[148:151]
    v_fmac_f32 v251, -4.0, v249
    v_fma_f32 v249, v248, s24, v250
    v_mfma_f32_16x16x32_bf16 v[148:151], a[232:235], v[232:235], v[148:151]
    buffer_store_dwordx4 a[24:27], v254, s[12:15], s44 offen sc1
    v_fmac_f32 v250, -4.0, v248
    v_fma_f32 v248, v250, s26, v251
    v_mfma_f32_16x16x32_bf16 v[152:155], a[236:239], v[232:235], v[152:155]
    ds_read_b128 v[232:235], v253 offset:28352
    v_fmac_f32 v251, s27, v250
    v_fma_f32 v250, v249, 2.0, v252
    v_mfma_f32_16x16x32_bf16 v[152:155], a[248:251], v[236:239], v[152:155]
    v_fmac_f32 v252, -2.0, v249
    v_fma_f32 v249, v197, s24, v201
    v_mfma_f32_16x16x32_bf16 v[132:135], a[252:255], v[236:239], v[132:135]
    v_fmac_f32 v201, -4.0, v197
    v_fma_f32 v197, v195, s24, v199
    v_mfma_f32_16x16x32_bf16 v[136:139], v[240:243], v[236:239], v[136:139]
    v_fmac_f32 v199, -4.0, v195
    v_fma_f32 v195, v199, s26, v201
    v_mfma_f32_16x16x32_bf16 v[140:143], v[244:247], v[236:239], v[140:143]
    v_fmac_f32 v201, s27, v199
    v_fma_f32 v199, v197, 2.0, v249
    v_mfma_f32_16x16x32_bf16 v[156:159], a[228:231], v[236:239], v[156:159]
    s_waitcnt lgkmcnt(2)
    v_fmac_f32 v249, -2.0, v197
    v_cvt_pk_bf16_f32 v195, v248, v195
    v_mfma_f32_16x16x32_bf16 v[156:159], a[240:243], v[228:231], v[156:159]
    v_cvt_pk_bf16_f32 v201, v251, v201
    v_cvt_pk_bf16_f32 v199, v250, v199
    v_cvt_pk_bf16_f32 v197, v252, v249
    v_mfma_f32_16x16x32_bf16 v[160:163], a[244:247], v[228:231], v[160:163]
    s_add_u32 s44, s40, 7168
    v_lshrrev_b32 v252, 15, v255
    v_mfma_f32_16x16x32_bf16 v[160:163], a[232:235], v[236:239], v[160:163]
    ds_write_b64 v252, v[194:195] offset:256
    v_mfma_f32_16x16x32_bf16 v[164:167], a[236:239], v[236:239], v[164:167]
    ds_read_b128 v[236:239], v253 offset:28096
    s_waitcnt vmcnt(13)
    v_mfma_f32_16x16x32_bf16 v[164:167], a[248:251], v[228:231], v[164:167]
    v_lshlrev_b32 v248, 16, v206
    v_lshlrev_b32 v249, 16, v208
    v_mfma_f32_16x16x32_bf16 v[144:147], a[252:255], v[228:231], v[144:147]
    ds_write_b64 v252, v[200:201] offset:2336
    v_mfma_f32_16x16x32_bf16 v[148:151], v[240:243], v[228:231], v[148:151]
    s_waitcnt lgkmcnt(3)
    v_lshlrev_b32 v250, 16, v210
    v_lshlrev_b32 v251, 16, v212
    v_mfma_f32_16x16x32_bf16 v[152:155], v[244:247], v[228:231], v[152:155]
    ds_write_b64 v252, v[198:199] offset:4416
    v_and_b32 v206, s22, v206
    v_mfma_f32_16x16x32_bf16 v[168:171], a[228:231], v[228:231], v[168:171]
    ds_read_b128 a[40:43], v6 offset:22816
    v_mfma_f32_16x16x32_bf16 v[168:171], a[240:243], v[232:235], v[168:171]
    v_and_b32 v208, s22, v208
    v_mfma_f32_16x16x32_bf16 v[172:175], a[244:247], v[232:235], v[172:175]
    ds_write_b64 v252, v[192:193] offset:33536
    v_mfma_f32_16x16x32_bf16 v[172:175], a[232:235], v[228:231], v[172:175]
    v_and_b32 v210, s22, v210
    v_and_b32 v212, s22, v212
    v_mfma_f32_16x16x32_bf16 v[176:179], a[236:239], v[228:231], v[176:179]
    ds_read_b128 v[228:231], v253 offset:27824
    v_mfma_f32_16x16x32_bf16 v[176:179], a[248:251], v[232:235], v[176:179]
    ds_write_b64 v252, v[202:203] offset:35616
    v_mfma_f32_16x16x32_bf16 v[156:159], a[252:255], v[232:235], v[156:159]
    v_mfma_f32_16x16x32_bf16 v[160:163], v[240:243], v[232:235], v[160:163]
    ds_write_b64 v252, v[196:197] offset:6496
    v_mfma_f32_16x16x32_bf16 v[164:167], v[244:247], v[232:235], v[164:167]
    s_mov_b32 s42, 1290240
    v_mfma_f32_16x16x32_bf16 v[180:183], a[228:231], v[232:235], v[180:183]
    buffer_load_dwordx4 a[228:231], v254, s[8:11], s42 offen offset:0 sc1
    v_mfma_f32_16x16x32_bf16 v[184:187], a[232:235], v[232:235], v[184:187]
    v_lshlrev_b32 v252, 16, v204
    v_and_b32 v204, s22, v204
    v_mfma_f32_16x16x32_bf16 v[188:191], a[236:239], v[232:235], v[188:191]
    s_waitcnt lgkmcnt(7)
    v_fmac_f32 v252, s25, v251
    v_fmac_f32 v204, s25, v212
    v_mfma_f32_16x16x32_bf16 v[180:183], a[240:243], v[236:239], v[180:183]
    ds_read_b128 v[232:235], v253 offset:30160
    v_fmac_f32 v252, s28, v249
    v_mfma_f32_16x16x32_bf16 v[184:187], a[244:247], v[236:239], v[184:187]
    buffer_load_dwordx4 a[232:235], v254, s[8:11], s42 offen offset:1024 sc1
    v_mfma_f32_16x16x32_bf16 v[188:191], a[248:251], v[236:239], v[188:191]
    v_fmac_f32 v204, s28, v208
    v_cvt_pk_bf16_f32 v204, v252, v204
    v_mfma_f32_16x16x32_bf16 v[168:171], a[252:255], v[236:239], v[168:171]
    s_waitcnt lgkmcnt(3)
    v_lshlrev_b32 v252, 16, v214
    v_and_b32 v214, s22, v214
    v_mfma_f32_16x16x32_bf16 v[172:175], v[240:243], v[236:239], v[172:175]
    buffer_load_dwordx4 a[236:239], v254, s[8:11], s42 offen offset:2048 sc1
    v_mfma_f32_16x16x32_bf16 v[176:179], v[244:247], v[236:239], v[176:179]
    ds_read_b128 v[236:239], v253 offset:29888
    v_fmac_f32 v252, s29, v248
    v_mfma_f32_16x16x32_bf16 v[180:183], a[252:255], v[228:231], v[180:183]
    s_mov_b32 s42, 1293312
    v_fmac_f32 v214, s29, v206
    v_fmac_f32 v252, s23, v250
    v_mfma_f32_16x16x32_bf16 v[184:187], v[240:243], v[228:231], v[184:187]
    buffer_load_dwordx4 a[240:243], v254, s[8:11], s42 offen offset:0 sc1
    v_mfma_f32_16x16x32_bf16 v[188:191], v[244:247], v[228:231], v[188:191]
    ds_read_b128 v[228:231], v253 offset:29632
    v_fmac_f32 v214, s23, v210
    s_waitcnt vmcnt(14)
    s_waitcnt lgkmcnt(2)
sub34:
    v_mfma_f32_16x16x32_bf16 v[96:99], a[192:195], v[232:235], v[96:99]
    ds_read_b128 a[44:47], v6 offset:23840
    v_cvt_pk_bf16_f32 v214, v252, v214
    v_mfma_f32_16x16x32_bf16 v[100:103], a[196:199], v[232:235], v[100:103]
    buffer_store_dwordx4 a[28:31], v254, s[12:15], s44 offen sc1
    s_add_u32 s44, s40, 8192
    v_fma_f32 v252, v249, s24, v251
    v_mfma_f32_16x16x32_bf16 v[104:107], a[200:203], v[232:235], v[104:107]
    ds_read_b128 v[232:235], v253 offset:29376
    s_waitcnt vmcnt(12)
    s_waitcnt lgkmcnt(3)
    v_mfma_f32_16x16x32_bf16 v[96:99], a[204:207], v[236:239], v[96:99]
    buffer_load_dwordx4 a[244:247], v254, s[8:11], s42 offen offset:1024 sc1
    v_mfma_f32_16x16x32_bf16 v[100:103], a[208:211], v[236:239], v[100:103]
    v_fmac_f32 v251, -4.0, v249
    v_fma_f32 v249, v248, s24, v250
    v_mfma_f32_16x16x32_bf16 v[104:107], a[212:215], v[236:239], v[104:107]
    v_fmac_f32 v250, -4.0, v248
    v_fma_f32 v248, v250, s26, v251
    v_mfma_f32_16x16x32_bf16 v[108:111], a[192:195], v[236:239], v[108:111]
    s_waitcnt lgkmcnt(2)
    v_fmac_f32 v251, s27, v250
    v_fma_f32 v250, v249, 2.0, v252
    v_mfma_f32_16x16x32_bf16 v[108:111], a[204:207], v[228:231], v[108:111]
    buffer_load_dwordx4 a[248:251], v254, s[8:11], s42 offen offset:2048 sc1
    v_mfma_f32_16x16x32_bf16 v[112:115], a[208:211], v[228:231], v[112:115]
    v_fmac_f32 v252, -2.0, v249
    v_fma_f32 v249, v208, s24, v212
    v_mfma_f32_16x16x32_bf16 v[112:115], a[196:199], v[236:239], v[112:115]
    s_mov_b32 s42, 1296384
    v_fmac_f32 v212, -4.0, v208
    v_fma_f32 v208, v206, s24, v210
    v_mfma_f32_16x16x32_bf16 v[116:119], a[200:203], v[236:239], v[116:119]
    ds_read_b128 v[236:239], v253 offset:29120
    v_fmac_f32 v210, -4.0, v206
    v_mfma_f32_16x16x32_bf16 v[116:119], a[212:215], v[228:231], v[116:119]
    buffer_load_dwordx4 a[252:255], v254, s[8:11], s42 offen offset:0 sc1
    s_waitcnt vmcnt(12)
    v_mfma_f32_16x16x32_bf16 v[96:99], a[216:219], v[228:231], v[96:99]
    v_fma_f32 v206, v210, s26, v212
    v_fmac_f32 v212, s27, v210
    v_mfma_f32_16x16x32_bf16 v[100:103], a[220:223], v[228:231], v[100:103]
    buffer_store_dwordx4 a[32:35], v254, s[12:15], s44 offen sc1
    v_fma_f32 v210, v208, 2.0, v249
    v_fmac_f32 v249, -2.0, v208
    v_mfma_f32_16x16x32_bf16 v[104:107], a[224:227], v[228:231], v[104:107]
    s_waitcnt lgkmcnt(1)
    v_cvt_pk_bf16_f32 v206, v248, v206
    v_cvt_pk_bf16_f32 v212, v251, v212
    v_mfma_f32_16x16x32_bf16 v[120:123], a[192:195], v[228:231], v[120:123]
    buffer_load_dwordx4 v[240:243], v254, s[8:11], s42 offen offset:1024 sc1
    v_mfma_f32_16x16x32_bf16 v[120:123], a[204:207], v[232:235], v[120:123]
    v_cvt_pk_bf16_f32 v210, v250, v210
    v_cvt_pk_bf16_f32 v208, v252, v249
    v_mfma_f32_16x16x32_bf16 v[124:127], a[208:211], v[232:235], v[124:127]
    s_add_u32 s44, s40, 9216
    v_lshlrev_b32 v248, 16, v207
    v_lshlrev_b32 v249, 16, v209
    v_mfma_f32_16x16x32_bf16 v[124:127], a[196:199], v[228:231], v[124:127]
    buffer_load_dwordx4 v[244:247], v254, s[8:11], s42 offen offset:2048 sc1
    v_mfma_f32_16x16x32_bf16 v[128:131], a[200:203], v[228:231], v[128:131]
    ds_read_b128 v[228:231], v253 offset:30944
    v_and_b32 v203, 0x7fff, v255
    v_mfma_f32_16x16x32_bf16 v[128:131], a[212:215], v[232:235], v[128:131]
    v_lshlrev_b32 v250, 16, v211
    v_lshlrev_b32 v251, 16, v213
    v_mfma_f32_16x16x32_bf16 v[108:111], a[216:219], v[232:235], v[108:111]
    v_and_b32 v207, s22, v207
    v_and_b32 v209, s22, v209
    v_mfma_f32_16x16x32_bf16 v[112:115], a[220:223], v[232:235], v[112:115]
    buffer_load_dwordx2 v[192:193], v203, s[4:7], s16 offen offset:64
    v_mfma_f32_16x16x32_bf16 v[116:119], a[224:227], v[232:235], v[116:119]
    v_and_b32 v211, s22, v211
    v_and_b32 v213, s22, v213
    v_mfma_f32_16x16x32_bf16 v[132:135], a[192:195], v[232:235], v[132:135]
    s_waitcnt lgkmcnt(1)
    v_lshlrev_b32 v252, 16, v205
    v_and_b32 v205, s22, v205
    v_mfma_f32_16x16x32_bf16 v[132:135], a[204:207], v[236:239], v[132:135]
    v_fmac_f32 v252, s25, v251
    v_fmac_f32 v205, s25, v213
    v_mfma_f32_16x16x32_bf16 v[136:139], a[208:211], v[236:239], v[136:139]
    v_fmac_f32 v252, s28, v249
    v_fmac_f32 v205, s28, v209
    v_mfma_f32_16x16x32_bf16 v[136:139], a[196:199], v[232:235], v[136:139]
    buffer_load_dwordx2 v[194:195], v203, s[4:7], s17 offen offset:64
    v_mfma_f32_16x16x32_bf16 v[140:143], a[200:203], v[232:235], v[140:143]
    ds_read_b128 v[232:235], v253 offset:30688
    v_cvt_pk_bf16_f32 v205, v252, v205
    v_mfma_f32_16x16x32_bf16 v[140:143], a[212:215], v[236:239], v[140:143]
    v_lshlrev_b32 v252, 16, v215
    v_and_b32 v215, s22, v215
    v_mfma_f32_16x16x32_bf16 v[120:123], a[216:219], v[236:239], v[120:123]
    v_fmac_f32 v252, s29, v248
    v_fmac_f32 v215, s29, v207
    v_mfma_f32_16x16x32_bf16 v[124:127], a[220:223], v[236:239], v[124:127]
    v_fmac_f32 v252, s23, v250
    v_fmac_f32 v215, s23, v211
    v_mfma_f32_16x16x32_bf16 v[128:131], a[224:227], v[236:239], v[128:131]
    buffer_load_dwordx2 v[196:197], v203, s[4:7], s18 offen offset:64
    v_mfma_f32_16x16x32_bf16 v[144:147], a[192:195], v[236:239], v[144:147]
    s_waitcnt lgkmcnt(1)
    v_cvt_pk_bf16_f32 v215, v252, v215
    v_fma_f32 v252, v249, s24, v251
    v_mfma_f32_16x16x32_bf16 v[144:147], a[204:207], v[228:231], v[144:147]
    v_fmac_f32 v251, -4.0, v249
    v_fma_f32 v249, v248, s24, v250
    v_mfma_f32_16x16x32_bf16 v[148:151], a[208:211], v[228:231], v[148:151]
    v_fmac_f32 v250, -4.0, v248
    v_fma_f32 v248, v250, s26, v251
    v_mfma_f32_16x16x32_bf16 v[148:151], a[196:199], v[236:239], v[148:151]
    v_fmac_f32 v251, s27, v250
    v_fma_f32 v250, v249, 2.0, v252
    v_mfma_f32_16x16x32_bf16 v[152:155], a[200:203], v[236:239], v[152:155]
    ds_read_b128 v[236:239], v253 offset:30432
    v_fmac_f32 v252, -2.0, v249
    v_mfma_f32_16x16x32_bf16 v[152:155], a[212:215], v[228:231], v[152:155]
    buffer_load_dwordx2 v[198:199], v203, s[4:7], s19 offen offset:64
    v_mfma_f32_16x16x32_bf16 v[132:135], a[216:219], v[228:231], v[132:135]
    v_fma_f32 v249, v209, s24, v213
    v_fmac_f32 v213, -4.0, v209
    v_mfma_f32_16x16x32_bf16 v[136:139], a[220:223], v[228:231], v[136:139]
    v_fma_f32 v209, v207, s24, v211
    v_fmac_f32 v211, -4.0, v207
    v_mfma_f32_16x16x32_bf16 v[140:143], a[224:227], v[228:231], v[140:143]
    v_fma_f32 v207, v211, s26, v213
    v_fmac_f32 v213, s27, v211
    v_mfma_f32_16x16x32_bf16 v[156:159], a[192:195], v[228:231], v[156:159]
    s_waitcnt lgkmcnt(1)
    v_fma_f32 v211, v209, 2.0, v249
    v_fmac_f32 v249, -2.0, v209
    v_mfma_f32_16x16x32_bf16 v[156:159], a[204:207], v[232:235], v[156:159]
    buffer_load_dwordx2 v[200:201], v203, s[4:7], s20 offen offset:64
    v_mfma_f32_16x16x32_bf16 v[160:163], a[208:211], v[232:235], v[160:163]
    v_cvt_pk_bf16_f32 v207, v248, v207
    v_cvt_pk_bf16_f32 v213, v251, v213
    v_mfma_f32_16x16x32_bf16 v[160:163], a[196:199], v[228:231], v[160:163]
    v_cvt_pk_bf16_f32 v211, v250, v211
    v_cvt_pk_bf16_f32 v209, v252, v249
    v_mfma_f32_16x16x32_bf16 v[164:167], a[200:203], v[228:231], v[164:167]
    ds_read_b128 v[228:231], v253 offset:30176
    v_lshrrev_b32 v252, 15, v255
    v_mfma_f32_16x16x32_bf16 v[164:167], a[212:215], v[232:235], v[164:167]
    ds_write_b64 v252, v[206:207] offset:0
    v_mfma_f32_16x16x32_bf16 v[144:147], a[216:219], v[232:235], v[144:147]
    buffer_load_dwordx2 v[202:203], v203, s[4:7], s21 offen offset:64
    v_mfma_f32_16x16x32_bf16 v[148:151], a[220:223], v[232:235], v[148:151]
    ds_write_b64 v252, v[212:213] offset:2080
    v_mfma_f32_16x16x32_bf16 v[152:155], a[224:227], v[232:235], v[152:155]
    s_waitcnt lgkmcnt(3)
    v_mfma_f32_16x16x32_bf16 v[168:171], a[192:195], v[232:235], v[168:171]
    ds_write_b64 v252, v[210:211] offset:4160
    v_mfma_f32_16x16x32_bf16 v[168:171], a[204:207], v[236:239], v[168:171]
    v_mfma_f32_16x16x32_bf16 v[172:175], a[208:211], v[236:239], v[172:175]
    ds_write_b64 v252, v[204:205] offset:33280
    v_mfma_f32_16x16x32_bf16 v[172:175], a[196:199], v[232:235], v[172:175]
    v_mfma_f32_16x16x32_bf16 v[176:179], a[200:203], v[232:235], v[176:179]
    ds_read_b128 v[232:235], v253 offset:29904
    v_mfma_f32_16x16x32_bf16 v[176:179], a[212:215], v[236:239], v[176:179]
    ds_write_b64 v252, v[214:215] offset:35360
    v_mfma_f32_16x16x32_bf16 v[156:159], a[216:219], v[236:239], v[156:159]
    s_waitcnt lgkmcnt(6)
    v_mfma_f32_16x16x32_bf16 v[160:163], a[220:223], v[236:239], v[160:163]
    ds_write_b64 v252, v[208:209] offset:6240
    v_mfma_f32_16x16x32_bf16 v[164:167], a[224:227], v[236:239], v[164:167]
    s_mov_b32 s42, 0
    v_mfma_f32_16x16x32_bf16 v[180:183], a[192:195], v[236:239], v[180:183]
pad13:
    s_cbranch_vccnz warm_ret
    buffer_load_dwordx4 a[192:195], v254, s[8:11], s42 offen offset:0 sc1
    v_mfma_f32_16x16x32_bf16 v[184:187], a[196:199], v[236:239], v[184:187]
    s_waitcnt lgkmcnt(0)
    v_mfma_f32_16x16x32_bf16 v[188:191], a[200:203], v[236:239], v[188:191]
    s_barrier
    v_mfma_f32_16x16x32_bf16 v[180:183], a[204:207], v[228:231], v[180:183]
    ds_read_b128 v[236:239], v253 offset:32240
    v_mfma_f32_16x16x32_bf16 v[184:187], a[208:211], v[228:231], v[184:187]
    buffer_load_dwordx4 a[196:199], v254, s[8:11], s42 offen offset:1024 sc1
    v_mfma_f32_16x16x32_bf16 v[188:191], a[212:215], v[228:231], v[188:191]
    v_mfma_f32_16x16x32_bf16 v[168:171], a[216:219], v[228:231], v[168:171]
    v_mfma_f32_16x16x32_bf16 v[172:175], a[220:223], v[228:231], v[172:175]
    buffer_load_dwordx4 a[200:203], v254, s[8:11], s42 offen offset:2048 sc1
    v_mfma_f32_16x16x32_bf16 v[176:179], a[224:227], v[228:231], v[176:179]
    ds_read_b128 v[228:231], v253 offset:31968
    v_mfma_f32_16x16x32_bf16 v[180:183], a[216:219], v[232:235], v[180:183]
    s_mov_b32 s42, 3072
    v_mfma_f32_16x16x32_bf16 v[184:187], a[220:223], v[232:235], v[184:187]
    buffer_load_dwordx4 a[204:207], v254, s[8:11], s42 offen offset:0 sc1
    v_mfma_f32_16x16x32_bf16 v[188:191], a[224:227], v[232:235], v[188:191]
    ds_read_b128 v[232:235], v253 offset:31712
    s_waitcnt vmcnt(18)
    s_waitcnt lgkmcnt(2)
sub35:
    v_mfma_f32_16x16x32_bf16 v[96:99], a[228:231], v[236:239], v[96:99]
    s_waitcnt vmcnt(14) lgkmcnt(1)
    v_mfma_f32_16x16x32_bf16 v[100:103], a[232:235], v[236:239], v[100:103]
    buffer_store_dwordx4 a[36:39], v254, s[12:15], s44 offen sc1
    s_add_u32 s44, s40, 10240
    v_mfma_f32_16x16x32_bf16 v[104:107], a[236:239], v[236:239], v[104:107]
    ds_read_b128 v[236:239], v253 offset:31456
    v_mfma_f32_16x16x32_bf16 v[96:99], a[240:243], v[228:231], v[96:99]
    buffer_load_dwordx4 a[208:211], v254, s[8:11], s42 offen offset:1024 sc1
    v_mfma_f32_16x16x32_bf16 v[100:103], a[244:247], v[228:231], v[100:103]
    v_mfma_f32_16x16x32_bf16 v[104:107], a[248:251], v[228:231], v[104:107]
    v_mfma_f32_16x16x32_bf16 v[108:111], a[228:231], v[228:231], v[108:111]
    s_waitcnt lgkmcnt(1)
    v_mfma_f32_16x16x32_bf16 v[108:111], a[240:243], v[232:235], v[108:111]
    buffer_load_dwordx4 a[212:215], v254, s[8:11], s42 offen offset:2048 sc1
    v_mfma_f32_16x16x32_bf16 v[112:115], a[244:247], v[232:235], v[112:115]
    v_mfma_f32_16x16x32_bf16 v[112:115], a[232:235], v[228:231], v[112:115]
    s_mov_b32 s42, 6144
    v_mfma_f32_16x16x32_bf16 v[116:119], a[236:239], v[228:231], v[116:119]
    ds_read_b128 v[228:231], v253 offset:31200
    v_mfma_f32_16x16x32_bf16 v[116:119], a[248:251], v[232:235], v[116:119]
    buffer_load_dwordx4 a[216:219], v254, s[8:11], s42 offen offset:0 sc1
    s_waitcnt vmcnt(14)
    v_mfma_f32_16x16x32_bf16 v[96:99], a[252:255], v[232:235], v[96:99]
    v_mfma_f32_16x16x32_bf16 v[100:103], v[240:243], v[232:235], v[100:103]
    buffer_store_dwordx4 a[40:43], v254, s[12:15], s44 offen sc1
    s_add_u32 s44, s40, 11264
    v_mfma_f32_16x16x32_bf16 v[104:107], v[244:247], v[232:235], v[104:107]
    s_waitcnt lgkmcnt(1)
    v_mfma_f32_16x16x32_bf16 v[120:123], a[228:231], v[232:235], v[120:123]
    buffer_load_dwordx4 a[220:223], v254, s[8:11], s42 offen offset:1024 sc1
    v_mfma_f32_16x16x32_bf16 v[120:123], a[240:243], v[236:239], v[120:123]
    buffer_store_dwordx4 a[44:47], v254, s[12:15], s44 offen sc1
    v_mfma_f32_16x16x32_bf16 v[124:127], a[244:247], v[236:239], v[124:127]
    v_mfma_f32_16x16x32_bf16 v[124:127], a[232:235], v[232:235], v[124:127]
    buffer_load_dwordx4 a[224:227], v254, s[8:11], s42 offen offset:2048 sc1
    v_mfma_f32_16x16x32_bf16 v[128:131], a[236:239], v[232:235], v[128:131]
    ds_read_b128 v[232:235], v253 offset:33024
    v_and_b32 v215, 0x7fff, v255
    v_mfma_f32_16x16x32_bf16 v[128:131], a[248:251], v[236:239], v[128:131]
    v_cvt_pk_bf16_f32 v104, v104, v105
    v_cvt_pk_bf16_f32 v105, v106, v107
    v_mfma_f32_16x16x32_bf16 v[108:111], a[252:255], v[236:239], v[108:111]
    v_mfma_f32_16x16x32_bf16 v[112:115], v[240:243], v[236:239], v[112:115]
    buffer_load_dwordx2 v[204:205], v215, s[4:7], s16 offen offset:448
    v_mfma_f32_16x16x32_bf16 v[116:119], v[244:247], v[236:239], v[116:119]
    ds_write_b64 v5, v[104:105] offset:16704
    v_mfma_f32_16x16x32_bf16 v[132:135], a[228:231], v[236:239], v[132:135]
    s_waitcnt lgkmcnt(2)
    v_cvt_pk_bf16_f32 v96, v96, v97
    v_cvt_pk_bf16_f32 v97, v98, v99
    v_mfma_f32_16x16x32_bf16 v[132:135], a[240:243], v[228:231], v[132:135]
    v_cvt_pk_bf16_f32 v98, v100, v101
    v_cvt_pk_bf16_f32 v99, v102, v103
    v_mfma_f32_16x16x32_bf16 v[136:139], a[244:247], v[228:231], v[136:139]
    ds_write_b128 v4, v[96:99] offset:16640
    v_mfma_f32_16x16x32_bf16 v[136:139], a[232:235], v[236:239], v[136:139]
    buffer_load_dwordx2 v[206:207], v215, s[4:7], s17 offen offset:448
    v_mfma_f32_16x16x32_bf16 v[140:143], a[236:239], v[236:239], v[140:143]
    ds_read_b128 v[236:239], v253 offset:32768
    v_mfma_f32_16x16x32_bf16 v[140:143], a[248:251], v[228:231], v[140:143]
    v_cvt_pk_bf16_f32 v116, v116, v117
    v_cvt_pk_bf16_f32 v117, v118, v119
    v_mfma_f32_16x16x32_bf16 v[120:123], a[252:255], v[228:231], v[120:123]
    ds_write_b64 v5, v[116:117] offset:17088
    v_mfma_f32_16x16x32_bf16 v[124:127], v[240:243], v[228:231], v[124:127]
    v_cvt_pk_bf16_f32 v108, v108, v109
    v_cvt_pk_bf16_f32 v109, v110, v111
    v_mfma_f32_16x16x32_bf16 v[128:131], v[244:247], v[228:231], v[128:131]
    buffer_load_dwordx2 v[208:209], v215, s[4:7], s18 offen offset:448
    v_mfma_f32_16x16x32_bf16 v[144:147], a[228:231], v[228:231], v[144:147]
    s_waitcnt lgkmcnt(4)
    v_cvt_pk_bf16_f32 v110, v112, v113
    v_cvt_pk_bf16_f32 v111, v114, v115
    v_mfma_f32_16x16x32_bf16 v[144:147], a[240:243], v[232:235], v[144:147]
    ds_write_b128 v4, v[108:111] offset:17024
    v_mfma_f32_16x16x32_bf16 v[148:151], a[244:247], v[232:235], v[148:151]
    v_mfma_f32_16x16x32_bf16 v[148:151], a[232:235], v[228:231], v[148:151]
    v_mfma_f32_16x16x32_bf16 v[152:155], a[236:239], v[228:231], v[152:155]
    ds_read_b128 v[228:231], v253 offset:32512
    v_mfma_f32_16x16x32_bf16 v[152:155], a[248:251], v[232:235], v[152:155]
    buffer_load_dwordx2 v[210:211], v215, s[4:7], s19 offen offset:448
    v_mfma_f32_16x16x32_bf16 v[132:135], a[252:255], v[232:235], v[132:135]
    v_cvt_pk_bf16_f32 v128, v128, v129
    v_cvt_pk_bf16_f32 v129, v130, v131
    v_mfma_f32_16x16x32_bf16 v[136:139], v[240:243], v[232:235], v[136:139]
    ds_write_b64 v5, v[128:129] offset:17472
    v_mfma_f32_16x16x32_bf16 v[140:143], v[244:247], v[232:235], v[140:143]
    v_cvt_pk_bf16_f32 v120, v120, v121
    v_cvt_pk_bf16_f32 v121, v122, v123
    v_mfma_f32_16x16x32_bf16 v[156:159], a[228:231], v[232:235], v[156:159]
    s_waitcnt lgkmcnt(4)
    v_cvt_pk_bf16_f32 v122, v124, v125
    v_cvt_pk_bf16_f32 v123, v126, v127
    v_mfma_f32_16x16x32_bf16 v[156:159], a[240:243], v[236:239], v[156:159]
    buffer_load_dwordx2 v[212:213], v215, s[4:7], s20 offen offset:448
    v_mfma_f32_16x16x32_bf16 v[160:163], a[244:247], v[236:239], v[160:163]
    ds_write_b128 v4, v[120:123] offset:17408
    v_mfma_f32_16x16x32_bf16 v[160:163], a[232:235], v[232:235], v[160:163]
    v_mfma_f32_16x16x32_bf16 v[164:167], a[236:239], v[232:235], v[164:167]
    ds_read_b128 v[232:235], v253 offset:32256
    v_mfma_f32_16x16x32_bf16 v[164:167], a[248:251], v[236:239], v[164:167]
    s_waitcnt lgkmcnt(3)
    v_mfma_f32_16x16x32_bf16 v[144:147], a[252:255], v[236:239], v[144:147]
    buffer_load_dwordx2 v[214:215], v215, s[4:7], s21 offen offset:448
    v_mfma_f32_16x16x32_bf16 v[148:151], v[240:243], v[236:239], v[148:151]
    s_waitcnt lgkmcnt(0)
    v_cvt_pk_bf16_f32 v140, v140, v141
    v_cvt_pk_bf16_f32 v141, v142, v143
    v_mfma_f32_16x16x32_bf16 v[152:155], v[244:247], v[236:239], v[152:155]
    s_barrier
    v_mfma_f32_16x16x32_bf16 v[168:171], a[228:231], v[236:239], v[168:171]
    ds_write_b64 v5, v[140:141] offset:17856
    v_mfma_f32_16x16x32_bf16 v[168:171], a[240:243], v[228:231], v[168:171]
    v_cvt_pk_bf16_f32 v132, v132, v133
    v_cvt_pk_bf16_f32 v133, v134, v135
    v_mfma_f32_16x16x32_bf16 v[172:175], a[244:247], v[228:231], v[172:175]
    ds_read_b128 v[96:99], v6 offset:16640
    v_cvt_pk_bf16_f32 v134, v136, v137
    v_cvt_pk_bf16_f32 v135, v138, v139
    v_mfma_f32_16x16x32_bf16 v[172:175], a[232:235], v[236:239], v[172:175]
    ds_write_b128 v4, v[132:135] offset:17792
    v_mfma_f32_16x16x32_bf16 v[176:179], a[236:239], v[236:239], v[176:179]
    ds_read_b128 v[236:239], v253 offset:31984
    v_mfma_f32_16x16x32_bf16 v[176:179], a[248:251], v[228:231], v[176:179]
    v_cvt_pk_bf16_f32 v152, v152, v153
    v_cvt_pk_bf16_f32 v153, v154, v155
    v_mfma_f32_16x16x32_bf16 v[156:159], a[252:255], v[228:231], v[156:159]
    ds_read_b128 v[100:103], v6 offset:19744
    v_mfma_f32_16x16x32_bf16 v[160:163], v[240:243], v[228:231], v[160:163]
    ds_write_b64 v5, v[152:153] offset:18240
    v_mfma_f32_16x16x32_bf16 v[164:167], v[244:247], v[228:231], v[164:167]
    s_mov_b32 s42, 36864
    v_cvt_pk_bf16_f32 v144, v144, v145
    v_cvt_pk_bf16_f32 v145, v146, v147
    v_mfma_f32_16x16x32_bf16 v[180:183], a[228:231], v[228:231], v[180:183]
    buffer_load_dwordx4 a[228:231], v254, s[8:11], s42 offen offset:0 sc1
    v_mfma_f32_16x16x32_bf16 v[184:187], a[232:235], v[228:231], v[184:187]
    v_cvt_pk_bf16_f32 v146, v148, v149
    v_cvt_pk_bf16_f32 v147, v150, v151
    v_mfma_f32_16x16x32_bf16 v[188:191], a[236:239], v[228:231], v[188:191]
    ds_write_b128 v4, v[144:147] offset:18176
    v_mfma_f32_16x16x32_bf16 v[180:183], a[240:243], v[232:235], v[180:183]
    ds_read_b128 v[228:231], v253 offset:1040
    v_mfma_f32_16x16x32_bf16 v[184:187], a[244:247], v[232:235], v[184:187]
    buffer_load_dwordx4 a[232:235], v254, s[8:11], s42 offen offset:1024 sc1
    v_mfma_f32_16x16x32_bf16 v[188:191], a[248:251], v[232:235], v[188:191]
    ds_read_b128 v[104:107], v6 offset:22848
    v_mfma_f32_16x16x32_bf16 v[168:171], a[252:255], v[232:235], v[168:171]
    ds_read_b128 v[108:111], v6 offset:25952
    v_mfma_f32_16x16x32_bf16 v[172:175], v[240:243], v[232:235], v[172:175]
    buffer_load_dwordx4 a[236:239], v254, s[8:11], s42 offen offset:2048 sc1
    v_mfma_f32_16x16x32_bf16 v[176:179], v[244:247], v[232:235], v[176:179]
    ds_read_b128 v[232:235], v253 offset:768
    s_waitcnt lgkmcnt(7)
    v_mfma_f32_16x16x32_bf16 v[180:183], a[252:255], v[236:239], v[180:183]
    s_mov_b32 s42, 39936
    v_mfma_f32_16x16x32_bf16 v[184:187], v[240:243], v[236:239], v[184:187]
    buffer_load_dwordx4 a[240:243], v254, s[8:11], s42 offen offset:0 sc1
    v_mfma_f32_16x16x32_bf16 v[188:191], v[244:247], v[236:239], v[188:191]
    ds_read_b128 v[236:239], v253 offset:512
    s_waitcnt vmcnt(19)
    s_waitcnt lgkmcnt(4)
    s_add_u32 s41, s40, 589824
    s_add_u32 s40, s40, 6291456
    s_add_u32 s39, s39, 1
    s_cmp_lt_u32 s39, 2
    s_cbranch_scc1 blk_loop
    v_cvt_pk_bf16_f32 v164, v164, v165
    v_cvt_pk_bf16_f32 v165, v166, v167
    ds_write_b64 v5, v[164:165] offset:18624
    v_cvt_pk_bf16_f32 v156, v156, v157
    v_cvt_pk_bf16_f32 v157, v158, v159
    v_cvt_pk_bf16_f32 v158, v160, v161
    v_cvt_pk_bf16_f32 v159, v162, v163
    ds_write_b128 v4, v[156:159] offset:18560
    s_add_u32 s44, s41, 0
    buffer_store_dwordx4 v[96:99], v254, s[12:15], s44 offen sc1
    s_add_u32 s44, s41, 3072
    buffer_store_dwordx4 v[100:103], v254, s[12:15], s44 offen sc1
    s_add_u32 s44, s41, 6144
    s_waitcnt lgkmcnt(5)
    buffer_store_dwordx4 v[104:107], v254, s[12:15], s44 offen sc1
    s_add_u32 s44, s41, 9216
    s_waitcnt lgkmcnt(4)
    buffer_store_dwordx4 v[108:111], v254, s[12:15], s44 offen sc1
    s_waitcnt lgkmcnt(0)
    s_barrier
    ds_read_b128 v[16:19], v6 offset:17664
    ds_read_b128 v[20:23], v6 offset:20768
    ds_read_b128 v[24:27], v6 offset:23872
    ds_read_b128 v[28:31], v6 offset:26976
    v_cvt_pk_bf16_f32 v176, v176, v177
    v_cvt_pk_bf16_f32 v177, v178, v179
    ds_write_b64 v5, v[176:177] offset:19008
    v_cvt_pk_bf16_f32 v168, v168, v169
    v_cvt_pk_bf16_f32 v169, v170, v171
    v_cvt_pk_bf16_f32 v170, v172, v173
    v_cvt_pk_bf16_f32 v171, v174, v175
    ds_write_b128 v4, v[168:171] offset:18944
    v_cvt_pk_bf16_f32 v188, v188, v189
    v_cvt_pk_bf16_f32 v189, v190, v191
    ds_write_b64 v5, v[188:189] offset:19392
    v_cvt_pk_bf16_f32 v180, v180, v181
    v_cvt_pk_bf16_f32 v181, v182, v183
    v_cvt_pk_bf16_f32 v182, v184, v185
    v_cvt_pk_bf16_f32 v183, v186, v187
    ds_write_b128 v4, v[180:183] offset:19328
    s_add_u32 s44, s41, 1024
    s_waitcnt lgkmcnt(7)
    buffer_store_dwordx4 v[16:19], v254, s[12:15], s44 offen sc1
    s_add_u32 s44, s41, 4096
    s_waitcnt lgkmcnt(6)
    buffer_store_dwordx4 v[20:23], v254, s[12:15], s44 offen sc1
    s_add_u32 s44, s41, 7168
    s_waitcnt lgkmcnt(5)
    buffer_store_dwordx4 v[24:27], v254, s[12:15], s44 offen sc1
    s_add_u32 s44, s41, 10240
    s_waitcnt lgkmcnt(4)
    buffer_store_dwordx4 v[28:31], v254, s[12:15], s44 offen sc1
    s_waitcnt lgkmcnt(0)
    s_barrier
    ds_read_b128 v[32:35], v6 offset:18688
    ds_read_b128 v[36:39], v6 offset:21792
    ds_read_b128 v[40:43], v6 offset:24896
    ds_read_b128 v[44:47], v6 offset:28000
    s_add_u32 s44, s41, 2048
    s_waitcnt lgkmcnt(3)
    buffer_store_dwordx4 v[32:35], v254, s[12:15], s44 offen sc1
    s_add_u32 s44, s41, 5120
    s_waitcnt lgkmcnt(2)
    buffer_store_dwordx4 v[36:39], v254, s[12:15], s44 offen sc1
    s_add_u32 s44, s41, 8192
    s_waitcnt lgkmcnt(1)
    buffer_store_dwordx4 v[40:43], v254, s[12:15], s44 offen sc1
    s_add_u32 s44, s41, 11264
    s_waitcnt lgkmcnt(0)
    buffer_store_dwordx4 v[44:47], v254, s[12:15], s44 offen sc1
main_done:
    s_endpgm
code_end:
wt_loop:
    s_mul_i32 s73, s70, 43691
    s_lshr_b32 s73, s73, 17
    s_mul_i32 s74, s73, 3
    s_sub_u32 s74, s70, s74
    s_mul_i32 s75, s73, 43691
    s_lshr_b32 s75, s75, 17
    s_mul_i32 s76, s75, 3
    s_sub_u32 s76, s73, s76
    v_and_b32 v101, 15, v2
    v_lshrrev_b32 v102, 4, v2
    v_and_b32 v103, 12, v101
    s_lshl_b32 s78, s74, 2
    s_cmp_lt_u32 s74, 2
    s_cselect_b32 s77, 1, 0
    s_cselect_b32 s78, s78, 32
    v_mul_u32_u24 v103, s77, v103
    v_add_u32 v103, v103, v101
    v_add_u32 v103, s78, v103
    v_lshl_add_u32 v103, v103, 1, s52
    v_mul_u32_u24 v104, 3072, v102
    v_add_u32 v103, v103, v104
    s_mul_i32 s79, s76, 73728
    s_mul_i32 s80, s75, 12288
    s_add_u32 s79, s79, s80
    s_add_u32 s80, s79, 221184
    s_add_u32 s81, s79, 442368
    buffer_load_ushort v110, v103, s[60:63], s79 offen offset:0
    buffer_load_ushort v111, v103, s[60:63], s79 offen offset:384
    buffer_load_ushort v112, v103, s[60:63], s79 offen offset:768
    buffer_load_ushort v113, v103, s[60:63], s79 offen offset:1152
    buffer_load_ushort v114, v103, s[60:63], s79 offen offset:1536
    buffer_load_ushort v115, v103, s[60:63], s79 offen offset:1920
    buffer_load_ushort v116, v103, s[60:63], s79 offen offset:2304
    buffer_load_ushort v117, v103, s[60:63], s79 offen offset:2688
    buffer_load_ushort v118, v103, s[60:63], s80 offen offset:0
    buffer_load_ushort v119, v103, s[60:63], s80 offen offset:384
    buffer_load_ushort v120, v103, s[60:63], s80 offen offset:768
    buffer_load_ushort v121, v103, s[60:63], s80 offen offset:1152
    buffer_load_ushort v122, v103, s[60:63], s80 offen offset:1536
    buffer_load_ushort v123, v103, s[60:63], s80 offen offset:1920
    buffer_load_ushort v124, v103, s[60:63], s80 offen offset:2304
    buffer_load_ushort v125, v103, s[60:63], s80 offen offset:2688
    buffer_load_ushort v126, v103, s[60:63], s81 offen offset:0
    buffer_load_ushort v127, v103, s[60:63], s81 offen offset:384
    buffer_load_ushort v128, v103, s[60:63], s81 offen offset:768
    buffer_load_ushort v129, v103, s[60:63], s81 offen offset:1152
    buffer_load_ushort v130, v103, s[60:63], s81 offen offset:1536
    buffer_load_ushort v131, v103, s[60:63], s81 offen offset:1920
    buffer_load_ushort v132, v103, s[60:63], s81 offen offset:2304
    buffer_load_ushort v133, v103, s[60:63], s81 offen offset:2688
    s_mul_i32 s82, s76, 3072
    s_lshl_b32 s83, s74, 10
    s_add_u32 s82, s82, s83
    s_mul_i32 s83, s75, 36864
    s_lshl_b32 s84, s83, 2
    s_add_u32 s83, s83, s82
    s_add_u32 s84, s84, s82
    s_waitcnt vmcnt(0)
    v_lshlrev_b32 v110, 16, v110
    v_lshlrev_b32 v111, 16, v111
    v_lshlrev_b32 v112, 16, v112
    v_lshlrev_b32 v113, 16, v113
    v_lshlrev_b32 v114, 16, v114
    v_lshlrev_b32 v115, 16, v115
    v_lshlrev_b32 v116, 16, v116
    v_lshlrev_b32 v117, 16, v117
    v_lshlrev_b32 v118, 16, v118
    v_lshlrev_b32 v119, 16, v119
    v_lshlrev_b32 v120, 16, v120
    v_lshlrev_b32 v121, 16, v121
    v_lshlrev_b32 v122, 16, v122
    v_lshlrev_b32 v123, 16, v123
    v_lshlrev_b32 v124, 16, v124
    v_lshlrev_b32 v125, 16, v125
    v_lshlrev_b32 v126, 16, v126
    v_lshlrev_b32 v127, 16, v127
    v_lshlrev_b32 v128, 16, v128
    v_lshlrev_b32 v129, 16, v129
    v_lshlrev_b32 v130, 16, v130
    v_lshlrev_b32 v131, 16, v131
    v_lshlrev_b32 v132, 16, v132
    v_lshlrev_b32 v133, 16, v133
    v_mul_f32 v136, 0xbedba55c, v110
    v_fmac_f32 v136, 0xbe0afea5, v126
    v_fmamk_f32 v144, v118, 0xbe771a08, v136
    v_fmac_f32 v136, 0x3e771a08, v118
    v_mul_f32 v137, 0xbedba55c, v111
    v_fmac_f32 v137, 0xbe0afea5, v127
    v_fmamk_f32 v145, v119, 0xbe771a08, v137
    v_fmac_f32 v137, 0x3e771a08, v119
    v_mul_f32 v138, 0xbedba55c, v112
    v_fmac_f32 v138, 0xbe0afea5, v128
    v_fmamk_f32 v146, v120, 0xbe771a08, v138
    v_fmac_f32 v138, 0x3e771a08, v120
    v_mul_f32 v139, 0xbedba55c, v113
    v_fmac_f32 v139, 0xbe0afea5, v129
    v_fmamk_f32 v147, v121, 0xbe771a08, v139
    v_fmac_f32 v139, 0x3e771a08, v121
    v_mul_f32 v140, 0xbedba55c, v114
    v_fmac_f32 v140, 0xbe0afea5, v130
    v_fmamk_f32 v148, v122, 0xbe771a08, v140
    v_fmac_f32 v140, 0x3e771a08, v122
    v_mul_f32 v141, 0xbedba55c, v115
    v_fmac_f32 v141, 0xbe0afea5, v131
    v_fmamk_f32 v149, v123, 0xbe771a08, v141
    v_fmac_f32 v141, 0x3e771a08, v123
    v_mul_f32 v142, 0xbedba55c, v116
    v_fmac_f32 v142, 0xbe0afea5, v132
    v_fmamk_f32 v150, v124, 0xbe771a08, v142
    v_fmac_f32 v142, 0x3e771a08, v124
    v_mul_f32 v143, 0xbedba55c, v117
    v_fmac_f32 v143, 0xbe0afea5, v133
    v_fmamk_f32 v151, v125, 0xbe771a08, v143
    v_fmac_f32 v143, 0x3e771a08, v125
    v_cvt_pk_bf16_f32 v156, v144, v145
    v_cvt_pk_bf16_f32 v157, v146, v147
    v_cvt_pk_bf16_f32 v158, v148, v149
    v_cvt_pk_bf16_f32 v159, v150, v151
    s_add_u32 s85, s84, 0
    buffer_store_dwordx4 v[156:159], v254, s[8:11], s85 offen sc1
    v_cvt_pk_bf16_f32 v160, v136, v137
    v_cvt_pk_bf16_f32 v161, v138, v139
    v_cvt_pk_bf16_f32 v162, v140, v141
    v_cvt_pk_bf16_f32 v163, v142, v143
    s_add_u32 s85, s84, 36864
    buffer_store_dwordx4 v[160:163], v254, s[8:11], s85 offen sc1
    v_mul_f32 v136, 0x3e0afea5, v110
    v_fmac_f32 v136, 0x3f0afea5, v126
    v_fmamk_f32 v144, v118, 0x3e8afea5, v136
    v_fmac_f32 v136, 0xbe8afea5, v118
    v_mul_f32 v137, 0x3e0afea5, v111
    v_fmac_f32 v137, 0x3f0afea5, v127
    v_fmamk_f32 v145, v119, 0x3e8afea5, v137
    v_fmac_f32 v137, 0xbe8afea5, v119
    v_mul_f32 v138, 0x3e0afea5, v112
    v_fmac_f32 v138, 0x3f0afea5, v128
    v_fmamk_f32 v146, v120, 0x3e8afea5, v138
    v_fmac_f32 v138, 0xbe8afea5, v120
    v_mul_f32 v139, 0x3e0afea5, v113
    v_fmac_f32 v139, 0x3f0afea5, v129
    v_fmamk_f32 v147, v121, 0x3e8afea5, v139
    v_fmac_f32 v139, 0xbe8afea5, v121
    v_mul_f32 v140, 0x3e0afea5, v114
    v_fmac_f32 v140, 0x3f0afea5, v130
    v_fmamk_f32 v148, v122, 0x3e8afea5, v140
    v_fmac_f32 v140, 0xbe8afea5, v122
    v_mul_f32 v141, 0x3e0afea5, v115
    v_fmac_f32 v141, 0x3f0afea5, v131
    v_fmamk_f32 v149, v123, 0x3e8afea5, v141
    v_fmac_f32 v141, 0xbe8afea5, v123
    v_mul_f32 v142, 0x3e0afea5, v116
    v_fmac_f32 v142, 0x3f0afea5, v132
    v_fmamk_f32 v150, v124, 0x3e8afea5, v142
    v_fmac_f32 v142, 0xbe8afea5, v124
    v_mul_f32 v143, 0x3e0afea5, v117
    v_fmac_f32 v143, 0x3f0afea5, v133
    v_fmamk_f32 v151, v125, 0x3e8afea5, v143
    v_fmac_f32 v143, 0xbe8afea5, v125
    v_cvt_pk_bf16_f32 v164, v144, v145
    v_cvt_pk_bf16_f32 v165, v146, v147
    v_cvt_pk_bf16_f32 v166, v148, v149
    v_cvt_pk_bf16_f32 v167, v150, v151
    s_add_u32 s85, s84, 73728
    buffer_store_dwordx4 v[164:167], v254, s[8:11], s85 offen sc1
    v_cvt_pk_bf16_f32 v168, v136, v137
    v_cvt_pk_bf16_f32 v169, v138, v139
    v_cvt_pk_bf16_f32 v170, v140, v141
    v_cvt_pk_bf16_f32 v171, v142, v143
    s_add_u32 s85, s84, 110592
    buffer_store_dwordx4 v[168:171], v254, s[8:11], s85 offen sc1
    v_cvt_pk_bf16_f32 v152, v110, v111
    v_cvt_pk_bf16_f32 v153, v112, v113
    v_cvt_pk_bf16_f32 v154, v114, v115
    v_cvt_pk_bf16_f32 v155, v116, v117
    s_add_u32 s85, s83, 884736
    buffer_store_dwordx4 v[152:155], v254, s[8:11], s85 offen sc1
    v_cvt_pk_bf16_f32 v172, v126, v127
    v_cvt_pk_bf16_f32 v173, v128, v129
    v_cvt_pk_bf16_f32 v174, v130, v131
    v_cvt_pk_bf16_f32 v175, v132, v133
    s_add_u32 s85, s83, 1105920
    buffer_store_dwordx4 v[172:175], v254, s[8:11], s85 offen sc1
    s_add_u32 s70, s70, 1
    s_cmp_lt_u32 s70, 54
    s_cbranch_scc1 wt_loop
    s_waitcnt vmcnt(0)
    s_branch u_ready
.section .rodata,"a"
.p2align 6
.amdhsa_kernel standalone__winograd__vision_kernel
  .amdhsa_next_free_vgpr 512
  .amdhsa_next_free_sgpr 102
  .amdhsa_accum_offset 256
  .amdhsa_group_segment_fixed_size 0
  .amdhsa_kernarg_size 40
  .amdhsa_user_sgpr_count 2
  .amdhsa_user_sgpr_kernarg_segment_ptr 1
  .amdhsa_system_sgpr_workgroup_id_x 1
  .amdhsa_ieee_mode 0
.end_amdhsa_kernel
```

```asm
; @launch grid=(256,1,1) block=(256,1,1) lds=163840
.amdgcn_target "amdgcn-amd-amdhsa--gfx950"
.text
.globl standalone__winograd__vision_kernel
.p2align 8
.type standalone__winograd__vision_kernel,@function
standalone__winograd__vision_kernel:
    s_cmp_ge_u32 s2, 256
    s_cbranch_scc1 main_done
    s_load_dwordx4 s[4:7], s[0:1], 0
    s_load_dwordx4 s[12:15], s[0:1], 16
    s_load_dwordx2 s[8:9], s[0:1], 32
    s_getpc_b64 s[92:93]
pcref:
    v_and_b32 v70, 3, v0
    v_lshrrev_b32 v71, 6, v0
    v_lshl_add_u32 v70, v70, 7, v71
    s_lshr_b32 s94, s2, 3
    s_lshl_b32 s94, s94, 2
    v_add_lshl_u32 v70, v70, s94, 7
    v_min_u32 v70, code_end-pcref-4, v70
    v_add_co_u32 v72, vcc, s92, v70
    v_mov_b32 v73, s93
    s_nop 0
    v_addc_co_u32 v73, vcc, 0, v73, vcc
    global_load_dword v76, v[72:73], off
    v_lshrrev_b32 v1, 6, v0
    v_and_b32 v2, 63, v0
    v_readfirstlane_b32 s38, v1
    v_lshlrev_b32 v254, 4, v2
    v_mov_b32 v98, 0
    v_lshrrev_b32 v3, 3, v2
    v_and_b32 v4, 7, v2
    v_mul_u32_u24 v5, 3072, v3
    v_lshl_add_u32 v255, v4, 3, v5
    s_lshr_b32 s44, s2, 3
    s_and_b32 s48, s44, 3
    s_lshr_b32 s44, s44, 2
    s_and_b32 s49, s2, 7
    s_lshl_b32 s49, s49, 4
    s_add_u32 s49, s49, s44
    s_and_b32 s90, s38, 1
    s_lshr_b32 s91, s38, 1
    s_mul_i32 s50, s90, 24576
    s_mul_i32 s45, s91, 1536
    s_add_u32 s50, s50, s45
    s_mul_i32 s101, s38, 196608
    s_sub_u32 s101, s101, s50
    s_mul_i32 s53, s48, 49152
    s_add_u32 s53, s53, s50
    s_mul_i32 s43, s49, 786432
    s_add_u32 s43, s43, s53
    s_cmp_ge_u32 s49, 128
    s_cselect_b32 s43, 2130706432, s43
    s_sub_u32 s16, s43, 196608
    s_cmp_eq_u32 s49, 0
    s_cselect_b32 s16, 2130706432, s16
    s_mov_b32 s17, s43
    s_add_u32 s18, s43, 196608
    s_add_u32 s19, s43, 393216
    s_add_u32 s20, s43, 589824
    s_add_u32 s21, s43, 786432
    s_add_u32 s100, s43, s101
    s_mul_i32 s52, s38, 96
    s_mul_i32 s44, s38, 9216
    s_mov_b32 s70, s2
    v_mov_b32 v80, v255
    s_mul_i32 s73, s70, 43691
    s_lshr_b32 s73, s73, 17
    s_mul_i32 s74, s73, 3
    s_sub_u32 s74, s70, s74
    s_mul_i32 s75, s73, 43691
    s_lshr_b32 s75, s75, 17
    s_mul_i32 s76, s75, 3
    s_sub_u32 s76, s73, s76
    v_and_b32 v101, 15, v2
    v_lshrrev_b32 v102, 4, v2
    v_and_b32 v103, 12, v101
    s_lshl_b32 s78, s74, 2
    s_cmp_lt_u32 s74, 2
    s_cselect_b32 s77, 1, 0
    s_cselect_b32 s78, s78, 32
    v_mul_u32_u24 v103, s77, v103
    v_add_u32 v103, v103, v101
    v_add_u32 v103, s78, v103
    v_lshl_add_u32 v103, v103, 1, s52
    v_mul_u32_u24 v104, 3072, v102
    v_add_u32 v103, v103, v104
    s_mul_i32 s79, s76, 73728
    s_mul_i32 s80, s75, 12288
    s_add_u32 s79, s79, s80
    s_add_u32 s80, s79, 221184
    s_add_u32 s81, s79, 442368
    s_waitcnt lgkmcnt(0)
    s_mov_b32 s60, s6
    s_and_b32 s61, s7, 0xffff
    s_mov_b32 s62, 663552
    s_mov_b32 s63, 0x20000
    s_and_b32 s5, s5, 0xffff
    s_mov_b32 s6, 100663296
    s_mov_b32 s7, 0x20000
    s_add_u32 s8, s8, s44
    s_addc_u32 s9, s9, 0
    s_and_b32 s9, s9, 0xffff
    s_mov_b32 s10, 1299456
    s_mov_b32 s11, 0x20000
    s_mov_b32 s64, s14
    s_and_b32 s65, s15, 0xffff
    s_mov_b32 s66, 256
    s_mov_b32 s67, 0x20000
    s_mov_b64 s[68:69], s[14:15]
    s_cmp_lt_u32 s2, 54
    s_cbranch_scc1 wt_path
    buffer_load_dwordx2 v[8:9], v80, s[4:7], s16 offen offset:0
    buffer_load_dwordx2 v[10:11], v80, s[4:7], s17 offen offset:0
    buffer_load_dwordx2 v[12:13], v80, s[4:7], s18 offen offset:0
    buffer_load_dwordx2 v[14:15], v80, s[4:7], s19 offen offset:0
    buffer_load_dwordx2 v[16:17], v80, s[4:7], s20 offen offset:0
    buffer_load_dwordx2 v[18:19], v80, s[4:7], s21 offen offset:0
    buffer_load_dwordx2 v[20:21], v80, s[4:7], s16 offen offset:384
    buffer_load_dwordx2 v[22:23], v80, s[4:7], s17 offen offset:384
    buffer_load_dwordx2 v[24:25], v80, s[4:7], s18 offen offset:384
    buffer_load_dwordx2 v[26:27], v80, s[4:7], s19 offen offset:384
    buffer_load_dwordx2 v[28:29], v80, s[4:7], s20 offen offset:384
    buffer_load_dwordx2 v[30:31], v80, s[4:7], s21 offen offset:384
    s_branch wt_join
wt_path:
    buffer_load_ushort v110, v103, s[60:63], s79 offen offset:0
    buffer_load_ushort v111, v103, s[60:63], s79 offen offset:384
    buffer_load_ushort v112, v103, s[60:63], s79 offen offset:768
    buffer_load_ushort v113, v103, s[60:63], s79 offen offset:1152
    buffer_load_ushort v114, v103, s[60:63], s79 offen offset:1536
    buffer_load_ushort v115, v103, s[60:63], s79 offen offset:1920
    buffer_load_ushort v116, v103, s[60:63], s79 offen offset:2304
    buffer_load_ushort v117, v103, s[60:63], s79 offen offset:2688
    buffer_load_ushort v118, v103, s[60:63], s80 offen offset:0
    buffer_load_ushort v119, v103, s[60:63], s80 offen offset:384
    buffer_load_ushort v120, v103, s[60:63], s80 offen offset:768
    buffer_load_ushort v121, v103, s[60:63], s80 offen offset:1152
    buffer_load_ushort v122, v103, s[60:63], s80 offen offset:1536
    buffer_load_ushort v123, v103, s[60:63], s80 offen offset:1920
    buffer_load_ushort v124, v103, s[60:63], s80 offen offset:2304
    buffer_load_ushort v125, v103, s[60:63], s80 offen offset:2688
    buffer_load_ushort v126, v103, s[60:63], s81 offen offset:0
    buffer_load_ushort v127, v103, s[60:63], s81 offen offset:384
    buffer_load_ushort v128, v103, s[60:63], s81 offen offset:768
    buffer_load_ushort v129, v103, s[60:63], s81 offen offset:1152
    buffer_load_ushort v130, v103, s[60:63], s81 offen offset:1536
    buffer_load_ushort v131, v103, s[60:63], s81 offen offset:1920
    buffer_load_ushort v132, v103, s[60:63], s81 offen offset:2304
    buffer_load_ushort v133, v103, s[60:63], s81 offen offset:2688
    s_mul_i32 s82, s76, 3072
    s_lshl_b32 s83, s74, 10
    s_add_u32 s82, s82, s83
    s_mul_i32 s83, s75, 36864
    s_lshl_b32 s84, s83, 2
    s_add_u32 s83, s83, s82
    s_add_u32 s84, s84, s82
    s_waitcnt vmcnt(0)
    v_lshlrev_b32 v110, 16, v110
    v_lshlrev_b32 v111, 16, v111
    v_lshlrev_b32 v112, 16, v112
    v_lshlrev_b32 v113, 16, v113
    v_lshlrev_b32 v114, 16, v114
    v_lshlrev_b32 v115, 16, v115
    v_lshlrev_b32 v116, 16, v116
    v_lshlrev_b32 v117, 16, v117
    v_lshlrev_b32 v118, 16, v118
    v_lshlrev_b32 v119, 16, v119
    v_lshlrev_b32 v120, 16, v120
    v_lshlrev_b32 v121, 16, v121
    v_lshlrev_b32 v122, 16, v122
    v_lshlrev_b32 v123, 16, v123
    v_lshlrev_b32 v124, 16, v124
    v_lshlrev_b32 v125, 16, v125
    v_lshlrev_b32 v126, 16, v126
    v_lshlrev_b32 v127, 16, v127
    v_lshlrev_b32 v128, 16, v128
    v_lshlrev_b32 v129, 16, v129
    v_lshlrev_b32 v130, 16, v130
    v_lshlrev_b32 v131, 16, v131
    v_lshlrev_b32 v132, 16, v132
    v_lshlrev_b32 v133, 16, v133
    v_mul_f32 v136, 0xbedba55c, v110
    v_fmac_f32 v136, 0xbe0afea5, v126
    v_fmamk_f32 v144, v118, 0xbe771a08, v136
    v_fmac_f32 v136, 0x3e771a08, v118
    v_mul_f32 v137, 0xbedba55c, v111
    v_fmac_f32 v137, 0xbe0afea5, v127
    v_fmamk_f32 v145, v119, 0xbe771a08, v137
    v_fmac_f32 v137, 0x3e771a08, v119
    v_mul_f32 v138, 0xbedba55c, v112
    v_fmac_f32 v138, 0xbe0afea5, v128
    v_fmamk_f32 v146, v120, 0xbe771a08, v138
    v_fmac_f32 v138, 0x3e771a08, v120
    v_mul_f32 v139, 0xbedba55c, v113
    v_fmac_f32 v139, 0xbe0afea5, v129
    v_fmamk_f32 v147, v121, 0xbe771a08, v139
    v_fmac_f32 v139, 0x3e771a08, v121
    v_mul_f32 v140, 0xbedba55c, v114
    v_fmac_f32 v140, 0xbe0afea5, v130
    v_fmamk_f32 v148, v122, 0xbe771a08, v140
    v_fmac_f32 v140, 0x3e771a08, v122
    v_mul_f32 v141, 0xbedba55c, v115
    v_fmac_f32 v141, 0xbe0afea5, v131
    v_fmamk_f32 v149, v123, 0xbe771a08, v141
    v_fmac_f32 v141, 0x3e771a08, v123
    v_mul_f32 v142, 0xbedba55c, v116
    v_fmac_f32 v142, 0xbe0afea5, v132
    v_fmamk_f32 v150, v124, 0xbe771a08, v142
    v_fmac_f32 v142, 0x3e771a08, v124
    v_mul_f32 v143, 0xbedba55c, v117
    v_fmac_f32 v143, 0xbe0afea5, v133
    v_fmamk_f32 v151, v125, 0xbe771a08, v143
    v_fmac_f32 v143, 0x3e771a08, v125
    v_cvt_pk_bf16_f32 v156, v144, v145
    v_cvt_pk_bf16_f32 v157, v146, v147
    v_cvt_pk_bf16_f32 v158, v148, v149
    v_cvt_pk_bf16_f32 v159, v150, v151
    s_add_u32 s85, s84, 0
    buffer_store_dwordx4 v[156:159], v254, s[8:11], s85 offen sc1
    v_cvt_pk_bf16_f32 v160, v136, v137
    v_cvt_pk_bf16_f32 v161, v138, v139
    v_cvt_pk_bf16_f32 v162, v140, v141
    v_cvt_pk_bf16_f32 v163, v142, v143
    s_add_u32 s85, s84, 36864
    buffer_store_dwordx4 v[160:163], v254, s[8:11], s85 offen sc1
    v_mul_f32 v136, 0x3e0afea5, v110
    v_fmac_f32 v136, 0x3f0afea5, v126
    v_fmamk_f32 v144, v118, 0x3e8afea5, v136
    v_fmac_f32 v136, 0xbe8afea5, v118
    v_mul_f32 v137, 0x3e0afea5, v111
    v_fmac_f32 v137, 0x3f0afea5, v127
    v_fmamk_f32 v145, v119, 0x3e8afea5, v137
    v_fmac_f32 v137, 0xbe8afea5, v119
    v_mul_f32 v138, 0x3e0afea5, v112
    v_fmac_f32 v138, 0x3f0afea5, v128
    v_fmamk_f32 v146, v120, 0x3e8afea5, v138
    v_fmac_f32 v138, 0xbe8afea5, v120
    v_mul_f32 v139, 0x3e0afea5, v113
    v_fmac_f32 v139, 0x3f0afea5, v129
    v_fmamk_f32 v147, v121, 0x3e8afea5, v139
    v_fmac_f32 v139, 0xbe8afea5, v121
    v_mul_f32 v140, 0x3e0afea5, v114
    v_fmac_f32 v140, 0x3f0afea5, v130
    v_fmamk_f32 v148, v122, 0x3e8afea5, v140
    v_fmac_f32 v140, 0xbe8afea5, v122
    v_mul_f32 v141, 0x3e0afea5, v115
    v_fmac_f32 v141, 0x3f0afea5, v131
    v_fmamk_f32 v149, v123, 0x3e8afea5, v141
    v_fmac_f32 v141, 0xbe8afea5, v123
    v_mul_f32 v142, 0x3e0afea5, v116
    v_fmac_f32 v142, 0x3f0afea5, v132
    v_fmamk_f32 v150, v124, 0x3e8afea5, v142
    v_fmac_f32 v142, 0xbe8afea5, v124
    v_mul_f32 v143, 0x3e0afea5, v117
    v_fmac_f32 v143, 0x3f0afea5, v133
    v_fmamk_f32 v151, v125, 0x3e8afea5, v143
    v_fmac_f32 v143, 0xbe8afea5, v125
    v_cvt_pk_bf16_f32 v164, v144, v145
    v_cvt_pk_bf16_f32 v165, v146, v147
    v_cvt_pk_bf16_f32 v166, v148, v149
    v_cvt_pk_bf16_f32 v167, v150, v151
    s_add_u32 s85, s84, 73728
    buffer_store_dwordx4 v[164:167], v254, s[8:11], s85 offen sc1
    v_cvt_pk_bf16_f32 v168, v136, v137
    v_cvt_pk_bf16_f32 v169, v138, v139
    v_cvt_pk_bf16_f32 v170, v140, v141
    v_cvt_pk_bf16_f32 v171, v142, v143
    s_add_u32 s85, s84, 110592
    buffer_store_dwordx4 v[168:171], v254, s[8:11], s85 offen sc1
    v_cvt_pk_bf16_f32 v152, v110, v111
    v_cvt_pk_bf16_f32 v153, v112, v113
    v_cvt_pk_bf16_f32 v154, v114, v115
    v_cvt_pk_bf16_f32 v155, v116, v117
    s_add_u32 s85, s83, 884736
    buffer_store_dwordx4 v[152:155], v254, s[8:11], s85 offen sc1
    v_cvt_pk_bf16_f32 v172, v126, v127
    v_cvt_pk_bf16_f32 v173, v128, v129
    v_cvt_pk_bf16_f32 v174, v130, v131
    v_cvt_pk_bf16_f32 v175, v132, v133
    s_add_u32 s85, s83, 1105920
    buffer_store_dwordx4 v[172:175], v254, s[8:11], s85 offen sc1
    buffer_load_dwordx2 v[8:9], v80, s[4:7], s16 offen offset:0
    buffer_load_dwordx2 v[10:11], v80, s[4:7], s17 offen offset:0
    buffer_load_dwordx2 v[12:13], v80, s[4:7], s18 offen offset:0
    buffer_load_dwordx2 v[14:15], v80, s[4:7], s19 offen offset:0
    buffer_load_dwordx2 v[16:17], v80, s[4:7], s20 offen offset:0
    buffer_load_dwordx2 v[18:19], v80, s[4:7], s21 offen offset:0
wt_join:
    s_and_b32 s13, s13, 0xffff
    s_mov_b32 s14, 100663296
    s_mov_b32 s15, 0x20000
    v_lshrrev_b32 v5, 4, v2
    v_mul_u32_u24 v6, 40704, v5
    v_lshrrev_b32 v5, 1, v5
    v_lshl_add_u32 v6, v5, 6, v6
    v_and_b32 v5, 0xf0, v254
    v_add_u32 v253, v6, v5
    v_lshrrev_b32 v6, 1, v4
    v_mul_u32_u24 v7, 40704, v6
    v_lshrrev_b32 v6, 1, v6
    v_lshl_add_u32 v7, v6, 6, v7
    v_and_b32 v6, 1, v2
    v_lshl_add_u32 v7, v6, 3, v7
    v_lshl_add_u32 v7, v3, 4, v7
    s_lshl_b32 s44, s90, 7
    s_mul_i32 s45, s91, 1056
    s_add_u32 s44, s44, s45
    v_add_u32 v7, s44, v7
    v_lshl_or_b32 v255, v7, 15, v255
    s_mul_i32 s51, s38, 40704
    s_lshl_b32 s45, s91, 6
    s_add_u32 s51, s51, s45
    s_lshl_b32 s45, s90, 4
    s_add_u32 s51, s51, s45
    s_mul_i32 s40, s49, 786432
    s_mul_i32 s45, s48, 49152
    s_add_u32 s40, s40, s45
    s_mul_i32 s45, s38, 12288
    s_add_u32 s40, s40, s45
    s_mov_b32 s41, 2130706432
    s_mov_b32 s39, 0
    s_mov_b32 s36, 0
    s_lshl_b32 s45, s38, 4
    s_mov_b32 s46, 0xfff
    s_mov_b32 s47, 0
    s_lshl_b64 s[46:47], s[46:47], s45
    s_mov_b32 s58, 0x0fff0fff
    s_mov_b32 s59, 0
    s_mov_b32 s23, 0xc08a2000
    s_mov_b32 s24, 0xbea20000
    s_mov_b32 s25, 0x3f4a4588
    s_mov_b32 s26, 0x3f100000
    s_mov_b32 s27, 0xbf100000
    s_mov_b32 s28, 0xc05a4588
    s_mov_b32 s29, 0x3fa20000
    s_mov_b32 s30, 0x3ea20000
    s_mov_b32 s31, 0x3e800000
    s_mov_b32 s34, 0x3f900000
    s_mov_b32 s35, 0x3db64000
    s_mov_b32 s22, 0xffff0000
    v_bfe_u32 v6, v254, 6, 2
    v_mul_u32_u24 v4, 40704, v6
    v_and_b32 v6, 0x80, v254
    v_lshrrev_b32 v6, 1, v6
    v_add_u32 v4, v4, v6
    v_and_b32 v6, 0x40, v254
    v_lshrrev_b32 v6, 2, v6
    v_add_u32 v4, v4, v6
    v_bfe_u32 v6, v254, 4, 2
    v_mul_u32_u24 v6, 3104, v6
    v_add_u32 v4, v4, v6
    v_add_u32 v4, s52, v4
    v_lshrrev_b32 v6, 8, v254
    v_lshl_add_u32 v5, v6, 3, v4
    v_lshl_add_u32 v4, v6, 4, v4
    v_add_u32 v6, s51, v254
    v_mov_b32 v192, 0
    v_mov_b32 v193, 0
    v_mov_b32 v203, 0
    v_mov_b32 v215, 0
    v_mov_b32 v224, 0
    v_mov_b32 v227, 0
    v_mov_b32 v252, 0
    s_mov_b32 s42, 0
    s_cmp_gt_u32 s48, 0
    s_cselect_b32 s45, 384, 0
    s_cselect_b32 s55, 0, 2130706432
    s_add_u32 s50, s50, s45
    s_add_u32 s54, s45, 49152
    s_cmp_eq_u32 s48, 3
    s_cselect_b32 s54, 2130706432, s54
    s_mov_b32 s56, 0xffff0000
    s_mov_b32 s57, 0
    s_cmp_ge_u32 s2, 54
    s_cbranch_scc1 pub_skip
    s_branch do_warm
wt_ret:
    s_mov_b32 s87, 1
    s_cmp_lg_u32 s38, 0
    s_waitcnt vmcnt(0)
    s_barrier
    s_cbranch_scc1 wt_pub
    s_atomic_add s87, s[68:69], 0 glc
    s_waitcnt lgkmcnt(0)
    s_cmp_lg_u32 s87, 53
    s_cbranch_scc1 wt_pub
    s_atomic_add s87, s[68:69], 128
wt_pub:
    buffer_load_dwordx2 v[20:21], v80, s[4:7], s16 offen offset:384
    buffer_load_dwordx2 v[22:23], v80, s[4:7], s17 offen offset:384
    buffer_load_dwordx2 v[24:25], v80, s[4:7], s18 offen offset:384
    buffer_load_dwordx2 v[26:27], v80, s[4:7], s19 offen offset:384
    buffer_load_dwordx2 v[28:29], v80, s[4:7], s20 offen offset:384
    buffer_load_dwordx2 v[30:31], v80, s[4:7], s21 offen offset:384
pub_skip:
    v_and_b32 v67, 0xf0, v254
    v_lshrrev_b32 v67, 1, v67
    v_add_u32 v67, s52, v67
    v_mov_b32 v66, s54
    v_mov_b32 v65, s55
    v_cndmask_b32 v66, v66, v65, s[56:57]
    v_add_u32 v67, v67, v66
    s_sub_u32 s45, s16, s50
    buffer_load_dwordx2 v[56:57], v67, s[4:7], s45 offen
    s_sub_u32 s45, s17, s50
    buffer_load_dwordx2 v[58:59], v67, s[4:7], s45 offen
    s_sub_u32 s45, s18, s50
    buffer_load_dwordx2 v[60:61], v67, s[4:7], s45 offen
    s_sub_u32 s45, s19, s50
    buffer_load_dwordx2 v[62:63], v67, s[4:7], s45 offen
    s_sub_u32 s45, s20, s50
    buffer_load_dwordx2 v[64:65], v67, s[4:7], s45 offen
    s_sub_u32 s45, s21, s50
    buffer_load_dwordx2 v[66:67], v67, s[4:7], s45 offen
    buffer_load_dwordx2 v[32:33], v80, s[4:7], s16 offen offset:768
    buffer_load_dwordx2 v[34:35], v80, s[4:7], s17 offen offset:768
    buffer_load_dwordx2 v[36:37], v80, s[4:7], s18 offen offset:768
    buffer_load_dwordx2 v[38:39], v80, s[4:7], s19 offen offset:768
    buffer_load_dwordx2 v[40:41], v80, s[4:7], s20 offen offset:768
    buffer_load_dwordx2 v[42:43], v80, s[4:7], s21 offen offset:768
    buffer_load_dwordx2 v[44:45], v80, s[4:7], s16 offen offset:1152
    buffer_load_dwordx2 v[46:47], v80, s[4:7], s17 offen offset:1152
    buffer_load_dwordx2 v[48:49], v80, s[4:7], s18 offen offset:1152
    buffer_load_dwordx2 v[50:51], v80, s[4:7], s19 offen offset:1152
    buffer_load_dwordx2 v[52:53], v80, s[4:7], s20 offen offset:1152
    buffer_load_dwordx2 v[54:55], v80, s[4:7], s21 offen offset:1152
    s_waitcnt vmcnt(24)
    v_lshlrev_b32 v176, 16, v8
    v_and_b32 v177, s22, v8
    v_lshlrev_b32 v178, 16, v10
    v_and_b32 v179, s22, v10
    v_lshlrev_b32 v180, 16, v12
    v_and_b32 v181, s22, v12
    v_lshlrev_b32 v182, 16, v14
    v_and_b32 v183, s22, v14
    v_lshlrev_b32 v184, 16, v16
    v_and_b32 v185, s22, v16
    v_lshlrev_b32 v186, 16, v18
    v_and_b32 v187, s22, v18
    v_pk_fma_f32 v[176:177], v[184:185], s[24:25], v[176:177] op_sel:[0,1,0]
    v_pk_fma_f32 v[186:187], v[178:179], s[28:29], v[186:187] op_sel:[0,1,0]
    v_pk_fma_f32 v[176:177], v[180:181], s[28:29], v[176:177] op_sel_hi:[1,0,1]
    v_pk_fma_f32 v[186:187], v[182:183], s[22:23], v[186:187] op_sel:[0,1,0]
    v_pk_fma_f32 v[188:189], v[180:181], s[24:25], v[184:185] op_sel_hi:[1,0,1]
    v_pk_fma_f32 v[184:185], v[180:181], -4.0, v[184:185] op_sel_hi:[1,0,1]
    v_pk_fma_f32 v[180:181], v[178:179], s[24:25], v[182:183] op_sel_hi:[1,0,1]
    v_pk_fma_f32 v[182:183], v[178:179], -4.0, v[182:183] op_sel_hi:[1,0,1]
    v_pk_fma_f32 v[178:179], v[182:183], s[26:27], v[184:185] op_sel_hi:[1,0,1]
    v_pk_fma_f32 v[184:185], v[182:183], s[26:27], v[184:185] op_sel:[0,1,0]
    v_pk_fma_f32 v[182:183], v[180:181], 2.0, v[188:189] op_sel_hi:[1,0,1]
    v_pk_fma_f32 v[180:181], v[180:181], -2.0, v[188:189] op_sel_hi:[1,0,1]
    v_cvt_pk_bf16_f32 v8, v176, v177
    v_cvt_pk_bf16_f32 v10, v178, v179
    v_cvt_pk_bf16_f32 v12, v180, v181
    v_cvt_pk_bf16_f32 v14, v182, v183
    v_cvt_pk_bf16_f32 v16, v184, v185
    v_cvt_pk_bf16_f32 v18, v186, v187
    v_lshlrev_b32 v176, 16, v9
    v_and_b32 v177, s22, v9
    v_lshlrev_b32 v178, 16, v11
    v_and_b32 v179, s22, v11
    v_lshlrev_b32 v180, 16, v13
    v_and_b32 v181, s22, v13
    v_lshlrev_b32 v182, 16, v15
    v_and_b32 v183, s22, v15
    v_lshlrev_b32 v184, 16, v17
    v_and_b32 v185, s22, v17
    v_lshlrev_b32 v186, 16, v19
    v_and_b32 v187, s22, v19
    v_pk_fma_f32 v[176:177], v[184:185], s[24:25], v[176:177] op_sel:[0,1,0]
    v_pk_fma_f32 v[186:187], v[178:179], s[28:29], v[186:187] op_sel:[0,1,0]
    v_pk_fma_f32 v[176:177], v[180:181], s[28:29], v[176:177] op_sel_hi:[1,0,1]
    v_pk_fma_f32 v[186:187], v[182:183], s[22:23], v[186:187] op_sel:[0,1,0]
    v_pk_fma_f32 v[188:189], v[180:181], s[24:25], v[184:185] op_sel_hi:[1,0,1]
    v_pk_fma_f32 v[184:185], v[180:181], -4.0, v[184:185] op_sel_hi:[1,0,1]
    v_pk_fma_f32 v[180:181], v[178:179], s[24:25], v[182:183] op_sel_hi:[1,0,1]
    v_pk_fma_f32 v[182:183], v[178:179], -4.0, v[182:183] op_sel_hi:[1,0,1]
    v_pk_fma_f32 v[178:179], v[182:183], s[26:27], v[184:185] op_sel_hi:[1,0,1]
    v_pk_fma_f32 v[184:185], v[182:183], s[26:27], v[184:185] op_sel:[0,1,0]
    v_pk_fma_f32 v[182:183], v[180:181], 2.0, v[188:189] op_sel_hi:[1,0,1]
    v_pk_fma_f32 v[180:181], v[180:181], -2.0, v[188:189] op_sel_hi:[1,0,1]
    v_cvt_pk_bf16_f32 v9, v176, v177
    v_cvt_pk_bf16_f32 v11, v178, v179
    v_cvt_pk_bf16_f32 v13, v180, v181
    v_cvt_pk_bf16_f32 v15, v182, v183
    v_cvt_pk_bf16_f32 v17, v184, v185
    v_cvt_pk_bf16_f32 v19, v186, v187
    v_lshrrev_b32 v252, 15, v255
    ds_write_b64 v252, v[8:9] offset:34048
    ds_write_b64 v252, v[10:11] offset:768
    ds_write_b64 v252, v[16:17] offset:2848
    ds_write_b64 v252, v[14:15] offset:4928
    ds_write_b64 v252, v[12:13] offset:7008
    ds_write_b64 v252, v[18:19] offset:36128
    s_waitcnt vmcnt(18)
    v_lshlrev_b32 v176, 16, v20
    v_and_b32 v177, s22, v20
    v_lshlrev_b32 v178, 16, v22
    v_and_b32 v179, s22, v22
    v_lshlrev_b32 v180, 16, v24
    v_and_b32 v181, s22, v24
    v_lshlrev_b32 v182, 16, v26
    v_and_b32 v183, s22, v26
    v_lshlrev_b32 v184, 16, v28
    v_and_b32 v185, s22, v28
    v_lshlrev_b32 v186, 16, v30
    v_and_b32 v187, s22, v30
    v_pk_fma_f32 v[176:177], v[184:185], s[24:25], v[176:177] op_sel:[0,1,0]
    v_pk_fma_f32 v[186:187], v[178:179], s[28:29], v[186:187] op_sel:[0,1,0]
    v_pk_fma_f32 v[176:177], v[180:181], s[28:29], v[176:177] op_sel_hi:[1,0,1]
    v_pk_fma_f32 v[186:187], v[182:183], s[22:23], v[186:187] op_sel:[0,1,0]
    v_pk_fma_f32 v[188:189], v[180:181], s[24:25], v[184:185] op_sel_hi:[1,0,1]
    v_pk_fma_f32 v[184:185], v[180:181], -4.0, v[184:185] op_sel_hi:[1,0,1]
    v_pk_fma_f32 v[180:181], v[178:179], s[24:25], v[182:183] op_sel_hi:[1,0,1]
    v_pk_fma_f32 v[182:183], v[178:179], -4.0, v[182:183] op_sel_hi:[1,0,1]
    v_pk_fma_f32 v[178:179], v[182:183], s[26:27], v[184:185] op_sel_hi:[1,0,1]
    v_pk_fma_f32 v[184:185], v[182:183], s[26:27], v[184:185] op_sel:[0,1,0]
    v_pk_fma_f32 v[182:183], v[180:181], 2.0, v[188:189] op_sel_hi:[1,0,1]
    v_pk_fma_f32 v[180:181], v[180:181], -2.0, v[188:189] op_sel_hi:[1,0,1]
    v_cvt_pk_bf16_f32 v20, v176, v177
    v_cvt_pk_bf16_f32 v22, v178, v179
    v_cvt_pk_bf16_f32 v24, v180, v181
    v_cvt_pk_bf16_f32 v26, v182, v183
    v_cvt_pk_bf16_f32 v28, v184, v185
    v_cvt_pk_bf16_f32 v30, v186, v187
    v_lshlrev_b32 v176, 16, v21
    v_and_b32 v177, s22, v21
    v_lshlrev_b32 v178, 16, v23
    v_and_b32 v179, s22, v23
    v_lshlrev_b32 v180, 16, v25
    v_and_b32 v181, s22, v25
    v_lshlrev_b32 v182, 16, v27
    v_and_b32 v183, s22, v27
    v_lshlrev_b32 v184, 16, v29
    v_and_b32 v185, s22, v29
    v_lshlrev_b32 v186, 16, v31
    v_and_b32 v187, s22, v31
    v_pk_fma_f32 v[176:177], v[184:185], s[24:25], v[176:177] op_sel:[0,1,0]
    v_pk_fma_f32 v[186:187], v[178:179], s[28:29], v[186:187] op_sel:[0,1,0]
    v_pk_fma_f32 v[176:177], v[180:181], s[28:29], v[176:177] op_sel_hi:[1,0,1]
    v_pk_fma_f32 v[186:187], v[182:183], s[22:23], v[186:187] op_sel:[0,1,0]
    v_pk_fma_f32 v[188:189], v[180:181], s[24:25], v[184:185] op_sel_hi:[1,0,1]
    v_pk_fma_f32 v[184:185], v[180:181], -4.0, v[184:185] op_sel_hi:[1,0,1]
    v_pk_fma_f32 v[180:181], v[178:179], s[24:25], v[182:183] op_sel_hi:[1,0,1]
    v_pk_fma_f32 v[182:183], v[178:179], -4.0, v[182:183] op_sel_hi:[1,0,1]
    v_pk_fma_f32 v[178:179], v[182:183], s[26:27], v[184:185] op_sel_hi:[1,0,1]
    v_pk_fma_f32 v[184:185], v[182:183], s[26:27], v[184:185] op_sel:[0,1,0]
    v_pk_fma_f32 v[182:183], v[180:181], 2.0, v[188:189] op_sel_hi:[1,0,1]
    v_pk_fma_f32 v[180:181], v[180:181], -2.0, v[188:189] op_sel_hi:[1,0,1]
    v_cvt_pk_bf16_f32 v21, v176, v177
    v_cvt_pk_bf16_f32 v23, v178, v179
    v_cvt_pk_bf16_f32 v25, v180, v181
    v_cvt_pk_bf16_f32 v27, v182, v183
    v_cvt_pk_bf16_f32 v29, v184, v185
    v_cvt_pk_bf16_f32 v31, v186, v187
    v_lshrrev_b32 v252, 15, v255
    ds_write_b64 v252, v[20:21] offset:33792
    ds_write_b64 v252, v[22:23] offset:512
    ds_write_b64 v252, v[28:29] offset:2592
    ds_write_b64 v252, v[26:27] offset:4672
    ds_write_b64 v252, v[24:25] offset:6752
    ds_write_b64 v252, v[30:31] offset:35872
    s_waitcnt vmcnt(12)
    v_lshlrev_b32 v176, 16, v56
    v_and_b32 v177, s22, v56
    v_lshlrev_b32 v178, 16, v58
    v_and_b32 v179, s22, v58
    v_lshlrev_b32 v180, 16, v60
    v_and_b32 v181, s22, v60
    v_lshlrev_b32 v182, 16, v62
    v_and_b32 v183, s22, v62
    v_lshlrev_b32 v184, 16, v64
    v_and_b32 v185, s22, v64
    v_lshlrev_b32 v186, 16, v66
    v_and_b32 v187, s22, v66
    v_pk_fma_f32 v[176:177], v[184:185], s[24:25], v[176:177] op_sel:[0,1,0]
    v_pk_fma_f32 v[186:187], v[178:179], s[28:29], v[186:187] op_sel:[0,1,0]
    v_pk_fma_f32 v[176:177], v[180:181], s[28:29], v[176:177] op_sel_hi:[1,0,1]
    v_pk_fma_f32 v[186:187], v[182:183], s[22:23], v[186:187] op_sel:[0,1,0]
    v_pk_fma_f32 v[188:189], v[180:181], s[24:25], v[184:185] op_sel_hi:[1,0,1]
    v_pk_fma_f32 v[184:185], v[180:181], -4.0, v[184:185] op_sel_hi:[1,0,1]
    v_pk_fma_f32 v[180:181], v[178:179], s[24:25], v[182:183] op_sel_hi:[1,0,1]
    v_pk_fma_f32 v[182:183], v[178:179], -4.0, v[182:183] op_sel_hi:[1,0,1]
    v_pk_fma_f32 v[178:179], v[182:183], s[26:27], v[184:185] op_sel_hi:[1,0,1]
    v_pk_fma_f32 v[184:185], v[182:183], s[26:27], v[184:185] op_sel:[0,1,0]
    v_pk_fma_f32 v[182:183], v[180:181], 2.0, v[188:189] op_sel_hi:[1,0,1]
    v_pk_fma_f32 v[180:181], v[180:181], -2.0, v[188:189] op_sel_hi:[1,0,1]
    v_cvt_pk_bf16_f32 v56, v176, v177
    v_cvt_pk_bf16_f32 v58, v178, v179
    v_cvt_pk_bf16_f32 v60, v180, v181
    v_cvt_pk_bf16_f32 v62, v182, v183
    v_cvt_pk_bf16_f32 v64, v184, v185
    v_cvt_pk_bf16_f32 v66, v186, v187
    v_lshlrev_b32 v176, 16, v57
    v_and_b32 v177, s22, v57
    v_lshlrev_b32 v178, 16, v59
    v_and_b32 v179, s22, v59
    v_lshlrev_b32 v180, 16, v61
    v_and_b32 v181, s22, v61
    v_lshlrev_b32 v182, 16, v63
    v_and_b32 v183, s22, v63
    v_lshlrev_b32 v184, 16, v65
    v_and_b32 v185, s22, v65
    v_lshlrev_b32 v186, 16, v67
    v_and_b32 v187, s22, v67
    v_pk_fma_f32 v[176:177], v[184:185], s[24:25], v[176:177] op_sel:[0,1,0]
    v_pk_fma_f32 v[186:187], v[178:179], s[28:29], v[186:187] op_sel:[0,1,0]
    v_pk_fma_f32 v[176:177], v[180:181], s[28:29], v[176:177] op_sel_hi:[1,0,1]
    v_pk_fma_f32 v[186:187], v[182:183], s[22:23], v[186:187] op_sel:[0,1,0]
    v_pk_fma_f32 v[188:189], v[180:181], s[24:25], v[184:185] op_sel_hi:[1,0,1]
    v_pk_fma_f32 v[184:185], v[180:181], -4.0, v[184:185] op_sel_hi:[1,0,1]
    v_pk_fma_f32 v[180:181], v[178:179], s[24:25], v[182:183] op_sel_hi:[1,0,1]
    v_pk_fma_f32 v[182:183], v[178:179], -4.0, v[182:183] op_sel_hi:[1,0,1]
    v_pk_fma_f32 v[178:179], v[182:183], s[26:27], v[184:185] op_sel_hi:[1,0,1]
    v_pk_fma_f32 v[184:185], v[182:183], s[26:27], v[184:185] op_sel:[0,1,0]
    v_pk_fma_f32 v[182:183], v[180:181], 2.0, v[188:189] op_sel_hi:[1,0,1]
    v_pk_fma_f32 v[180:181], v[180:181], -2.0, v[188:189] op_sel_hi:[1,0,1]
    v_cvt_pk_bf16_f32 v57, v176, v177
    v_cvt_pk_bf16_f32 v59, v178, v179
    v_cvt_pk_bf16_f32 v61, v180, v181
    v_cvt_pk_bf16_f32 v63, v182, v183
    v_cvt_pk_bf16_f32 v65, v184, v185
    v_cvt_pk_bf16_f32 v67, v186, v187
    v_and_b32 v248, 0xf0, v254
    v_lshrrev_b32 v248, 1, v248
    v_add_u32 v248, s52, v248
    v_and_b32 v252, 8, v248
    v_lshrrev_b32 v249, 6, v248
    v_mul_u32_u24 v249, 192, v249
    v_cmp_eq_u32 s[92:93], 0, v249
    v_add_u32 v252, v252, v249
    v_bfe_u32 v249, v248, 4, 2
    v_mul_u32_u24 v249, 40704, v249
    v_add_u32 v252, v252, v249
    v_and_b32 v249, 32, v248
    v_lshl_add_u32 v252, v249, 1, v252
    v_bfe_u32 v249, v254, 8, 1
    v_lshl_add_u32 v252, v249, 4, v252
    v_mov_b32 v249, 123328
    v_cndmask_b32 v252, v249, v252, s[58:59]
    ds_write_b64 v252, v[56:57] offset:39520
    ds_write_b64 v252, v[58:59] offset:39552
    ds_write_b64 v252, v[64:65] offset:39584
    ds_write_b64 v252, v[62:63] offset:39616
    ds_write_b64 v252, v[60:61] offset:39648
    ds_write_b64 v252, v[66:67] offset:39680
    s_and_b64 exec, s[92:93], s[58:59]
    ds_write_b64 v252, v[56:57] offset:34304
    ds_write_b64 v252, v[58:59] offset:1024
    ds_write_b64 v252, v[64:65] offset:3104
    ds_write_b64 v252, v[62:63] offset:5184
    ds_write_b64 v252, v[60:61] offset:7264
    ds_write_b64 v252, v[66:67] offset:36384
    s_mov_b64 exec, -1
    v_and_b32 v203, 0x7fff, v255
    buffer_load_dwordx2 v[192:193], v203, s[4:7], s16 offen offset:64
    buffer_load_dwordx2 v[194:195], v203, s[4:7], s17 offen offset:64
    buffer_load_dwordx2 v[196:197], v203, s[4:7], s18 offen offset:64
    buffer_load_dwordx2 v[198:199], v203, s[4:7], s19 offen offset:64
    buffer_load_dwordx2 v[200:201], v203, s[4:7], s20 offen offset:64
    buffer_load_dwordx2 v[202:203], v203, s[4:7], s21 offen offset:64
    v_and_b32 v215, 0x7fff, v255
    buffer_load_dwordx2 v[204:205], v215, s[4:7], s16 offen offset:448
    buffer_load_dwordx2 v[206:207], v215, s[4:7], s17 offen offset:448
    buffer_load_dwordx2 v[208:209], v215, s[4:7], s18 offen offset:448
    buffer_load_dwordx2 v[210:211], v215, s[4:7], s19 offen offset:448
    buffer_load_dwordx2 v[212:213], v215, s[4:7], s20 offen offset:448
    buffer_load_dwordx2 v[214:215], v215, s[4:7], s21 offen offset:448
    s_waitcnt vmcnt(18)
    v_lshlrev_b32 v176, 16, v32
    v_and_b32 v177, s22, v32
    v_lshlrev_b32 v178, 16, v34
    v_and_b32 v179, s22, v34
    v_lshlrev_b32 v180, 16, v36
    v_and_b32 v181, s22, v36
    v_lshlrev_b32 v182, 16, v38
    v_and_b32 v183, s22, v38
    v_lshlrev_b32 v184, 16, v40
    v_and_b32 v185, s22, v40
    v_lshlrev_b32 v186, 16, v42
    v_and_b32 v187, s22, v42
    v_pk_fma_f32 v[176:177], v[184:185], s[24:25], v[176:177] op_sel:[0,1,0]
    v_pk_fma_f32 v[186:187], v[178:179], s[28:29], v[186:187] op_sel:[0,1,0]
    v_pk_fma_f32 v[176:177], v[180:181], s[28:29], v[176:177] op_sel_hi:[1,0,1]
    v_pk_fma_f32 v[186:187], v[182:183], s[22:23], v[186:187] op_sel:[0,1,0]
    v_pk_fma_f32 v[188:189], v[180:181], s[24:25], v[184:185] op_sel_hi:[1,0,1]
    v_pk_fma_f32 v[184:185], v[180:181], -4.0, v[184:185] op_sel_hi:[1,0,1]
    v_pk_fma_f32 v[180:181], v[178:179], s[24:25], v[182:183] op_sel_hi:[1,0,1]
    v_pk_fma_f32 v[182:183], v[178:179], -4.0, v[182:183] op_sel_hi:[1,0,1]
    v_pk_fma_f32 v[178:179], v[182:183], s[26:27], v[184:185] op_sel_hi:[1,0,1]
    v_pk_fma_f32 v[184:185], v[182:183], s[26:27], v[184:185] op_sel:[0,1,0]
    v_pk_fma_f32 v[182:183], v[180:181], 2.0, v[188:189] op_sel_hi:[1,0,1]
    v_pk_fma_f32 v[180:181], v[180:181], -2.0, v[188:189] op_sel_hi:[1,0,1]
    v_cvt_pk_bf16_f32 v32, v176, v177
    v_cvt_pk_bf16_f32 v34, v178, v179
    v_cvt_pk_bf16_f32 v36, v180, v181
    v_cvt_pk_bf16_f32 v38, v182, v183
    v_cvt_pk_bf16_f32 v40, v184, v185
    v_cvt_pk_bf16_f32 v42, v186, v187
    v_lshlrev_b32 v176, 16, v33
    v_and_b32 v177, s22, v33
    v_lshlrev_b32 v178, 16, v35
    v_and_b32 v179, s22, v35
    v_lshlrev_b32 v180, 16, v37
    v_and_b32 v181, s22, v37
    v_lshlrev_b32 v182, 16, v39
    v_and_b32 v183, s22, v39
    v_lshlrev_b32 v184, 16, v41
    v_and_b32 v185, s22, v41
    v_lshlrev_b32 v186, 16, v43
    v_and_b32 v187, s22, v43
    v_pk_fma_f32 v[176:177], v[184:185], s[24:25], v[176:177] op_sel:[0,1,0]
    v_pk_fma_f32 v[186:187], v[178:179], s[28:29], v[186:187] op_sel:[0,1,0]
    v_pk_fma_f32 v[176:177], v[180:181], s[28:29], v[176:177] op_sel_hi:[1,0,1]
    v_pk_fma_f32 v[186:187], v[182:183], s[22:23], v[186:187] op_sel:[0,1,0]
    v_pk_fma_f32 v[188:189], v[180:181], s[24:25], v[184:185] op_sel_hi:[1,0,1]
    v_pk_fma_f32 v[184:185], v[180:181], -4.0, v[184:185] op_sel_hi:[1,0,1]
    v_pk_fma_f32 v[180:181], v[178:179], s[24:25], v[182:183] op_sel_hi:[1,0,1]
    v_pk_fma_f32 v[182:183], v[178:179], -4.0, v[182:183] op_sel_hi:[1,0,1]
    v_pk_fma_f32 v[178:179], v[182:183], s[26:27], v[184:185] op_sel_hi:[1,0,1]
    v_pk_fma_f32 v[184:185], v[182:183], s[26:27], v[184:185] op_sel:[0,1,0]
    v_pk_fma_f32 v[182:183], v[180:181], 2.0, v[188:189] op_sel_hi:[1,0,1]
    v_pk_fma_f32 v[180:181], v[180:181], -2.0, v[188:189] op_sel_hi:[1,0,1]
    v_cvt_pk_bf16_f32 v33, v176, v177
    v_cvt_pk_bf16_f32 v35, v178, v179
    v_cvt_pk_bf16_f32 v37, v180, v181
    v_cvt_pk_bf16_f32 v39, v182, v183
    v_cvt_pk_bf16_f32 v41, v184, v185
    v_cvt_pk_bf16_f32 v43, v186, v187
    v_lshrrev_b32 v252, 15, v255
    ds_write_b64 v252, v[32:33] offset:33536
    ds_write_b64 v252, v[34:35] offset:256
    ds_write_b64 v252, v[40:41] offset:2336
    ds_write_b64 v252, v[38:39] offset:4416
    ds_write_b64 v252, v[36:37] offset:6496
    ds_write_b64 v252, v[42:43] offset:35616
    s_waitcnt vmcnt(12)
    v_lshlrev_b32 v176, 16, v44
    v_and_b32 v177, s22, v44
    v_lshlrev_b32 v178, 16, v46
    v_and_b32 v179, s22, v46
    v_lshlrev_b32 v180, 16, v48
    v_and_b32 v181, s22, v48
    v_lshlrev_b32 v182, 16, v50
    v_and_b32 v183, s22, v50
    v_lshlrev_b32 v184, 16, v52
    v_and_b32 v185, s22, v52
    v_lshlrev_b32 v186, 16, v54
    v_and_b32 v187, s22, v54
    v_pk_fma_f32 v[176:177], v[184:185], s[24:25], v[176:177] op_sel:[0,1,0]
    v_pk_fma_f32 v[186:187], v[178:179], s[28:29], v[186:187] op_sel:[0,1,0]
    v_pk_fma_f32 v[176:177], v[180:181], s[28:29], v[176:177] op_sel_hi:[1,0,1]
    v_pk_fma_f32 v[186:187], v[182:183], s[22:23], v[186:187] op_sel:[0,1,0]
    v_pk_fma_f32 v[188:189], v[180:181], s[24:25], v[184:185] op_sel_hi:[1,0,1]
    v_pk_fma_f32 v[184:185], v[180:181], -4.0, v[184:185] op_sel_hi:[1,0,1]
    v_pk_fma_f32 v[180:181], v[178:179], s[24:25], v[182:183] op_sel_hi:[1,0,1]
    v_pk_fma_f32 v[182:183], v[178:179], -4.0, v[182:183] op_sel_hi:[1,0,1]
    v_pk_fma_f32 v[178:179], v[182:183], s[26:27], v[184:185] op_sel_hi:[1,0,1]
    v_pk_fma_f32 v[184:185], v[182:183], s[26:27], v[184:185] op_sel:[0,1,0]
    v_pk_fma_f32 v[182:183], v[180:181], 2.0, v[188:189] op_sel_hi:[1,0,1]
    v_pk_fma_f32 v[180:181], v[180:181], -2.0, v[188:189] op_sel_hi:[1,0,1]
    v_cvt_pk_bf16_f32 v44, v176, v177
    v_cvt_pk_bf16_f32 v46, v178, v179
    v_cvt_pk_bf16_f32 v48, v180, v181
    v_cvt_pk_bf16_f32 v50, v182, v183
    v_cvt_pk_bf16_f32 v52, v184, v185
    v_cvt_pk_bf16_f32 v54, v186, v187
    v_lshlrev_b32 v176, 16, v45
    v_and_b32 v177, s22, v45
    v_lshlrev_b32 v178, 16, v47
    v_and_b32 v179, s22, v47
    v_lshlrev_b32 v180, 16, v49
    v_and_b32 v181, s22, v49
    v_lshlrev_b32 v182, 16, v51
    v_and_b32 v183, s22, v51
    v_lshlrev_b32 v184, 16, v53
    v_and_b32 v185, s22, v53
    v_lshlrev_b32 v186, 16, v55
    v_and_b32 v187, s22, v55
    v_pk_fma_f32 v[176:177], v[184:185], s[24:25], v[176:177] op_sel:[0,1,0]
    v_pk_fma_f32 v[186:187], v[178:179], s[28:29], v[186:187] op_sel:[0,1,0]
    v_pk_fma_f32 v[176:177], v[180:181], s[28:29], v[176:177] op_sel_hi:[1,0,1]
    v_pk_fma_f32 v[186:187], v[182:183], s[22:23], v[186:187] op_sel:[0,1,0]
    v_pk_fma_f32 v[188:189], v[180:181], s[24:25], v[184:185] op_sel_hi:[1,0,1]
    v_pk_fma_f32 v[184:185], v[180:181], -4.0, v[184:185] op_sel_hi:[1,0,1]
    v_pk_fma_f32 v[180:181], v[178:179], s[24:25], v[182:183] op_sel_hi:[1,0,1]
    v_pk_fma_f32 v[182:183], v[178:179], -4.0, v[182:183] op_sel_hi:[1,0,1]
    v_pk_fma_f32 v[178:179], v[182:183], s[26:27], v[184:185] op_sel_hi:[1,0,1]
    v_pk_fma_f32 v[184:185], v[182:183], s[26:27], v[184:185] op_sel:[0,1,0]
    v_pk_fma_f32 v[182:183], v[180:181], 2.0, v[188:189] op_sel_hi:[1,0,1]
    v_pk_fma_f32 v[180:181], v[180:181], -2.0, v[188:189] op_sel_hi:[1,0,1]
    v_cvt_pk_bf16_f32 v45, v176, v177
    v_cvt_pk_bf16_f32 v47, v178, v179
    v_cvt_pk_bf16_f32 v49, v180, v181
    v_cvt_pk_bf16_f32 v51, v182, v183
    v_cvt_pk_bf16_f32 v53, v184, v185
    v_cvt_pk_bf16_f32 v55, v186, v187
    v_lshrrev_b32 v252, 15, v255
    ds_write_b64 v252, v[44:45] offset:33280
    ds_write_b64 v252, v[46:47] offset:0
    ds_write_b64 v252, v[52:53] offset:2080
    ds_write_b64 v252, v[50:51] offset:4160
    ds_write_b64 v252, v[48:49] offset:6240
    ds_write_b64 v252, v[54:55] offset:35360
    buffer_load_dword v97, v98, s[64:67], 0 offen offset:128 sc1
no_poll:
    s_cmp_lt_u32 s2, 54
    s_cbranch_scc1 warm_done
do_warm:
    s_mov_b64 vcc, -1
    s_cmp_eq_u32 s38, 0
    s_cbranch_scc1 pad0
    s_cmp_eq_u32 s38, 1
    s_cbranch_scc1 pad1
    s_cmp_eq_u32 s38, 2
    s_cbranch_scc1 pad2
    s_branch pad3
warm_ret:
    s_mov_b64 vcc, 0
    s_cmp_lt_u32 s2, 54
    s_cbranch_scc1 wt_ret
warm_done:
    s_mov_b32 s86, 0
    s_waitcnt vmcnt(0)
poll_loop:
    v_readfirstlane_b32 s87, v97
    s_add_u32 s86, s86, 1
    s_cmp_lg_u32 s87, 0
    s_cbranch_scc1 u_ready
    buffer_load_dword v97, v98, s[64:67], 0 offen offset:128 sc1
    s_cmp_lt_u32 s86, 512
    s_waitcnt vmcnt(0)
    s_cbranch_scc1 poll_loop
    s_mov_b32 s70, 0
    s_branch wt_loop
u_ready:
    s_mov_b32 s42, 0
    buffer_load_dwordx4 a[192:195], v254, s[8:11], s42 offen offset:0 sc1
    buffer_load_dwordx4 a[196:199], v254, s[8:11], s42 offen offset:1024 sc1
    buffer_load_dwordx4 a[200:203], v254, s[8:11], s42 offen offset:2048 sc1
    s_mov_b32 s42, 3072
    buffer_load_dwordx4 a[204:207], v254, s[8:11], s42 offen offset:0 sc1
    buffer_load_dwordx4 a[208:211], v254, s[8:11], s42 offen offset:1024 sc1
    buffer_load_dwordx4 a[212:215], v254, s[8:11], s42 offen offset:2048 sc1
    s_mov_b32 s42, 6144
    buffer_load_dwordx4 a[216:219], v254, s[8:11], s42 offen offset:0 sc1
    buffer_load_dwordx4 a[220:223], v254, s[8:11], s42 offen offset:1024 sc1
    buffer_load_dwordx4 a[224:227], v254, s[8:11], s42 offen offset:2048 sc1
    s_mov_b32 s42, 36864
    buffer_load_dwordx4 a[228:231], v254, s[8:11], s42 offen offset:0 sc1
    buffer_load_dwordx4 a[232:235], v254, s[8:11], s42 offen offset:1024 sc1
    buffer_load_dwordx4 a[236:239], v254, s[8:11], s42 offen offset:2048 sc1
    s_mov_b32 s42, 39936
    buffer_load_dwordx4 a[240:243], v254, s[8:11], s42 offen offset:0 sc1
    buffer_load_dwordx4 a[244:247], v254, s[8:11], s42 offen offset:1024 sc1
    buffer_load_dwordx4 a[248:251], v254, s[8:11], s42 offen offset:2048 sc1
    s_mov_b32 s42, 43008
    buffer_load_dwordx4 a[252:255], v254, s[8:11], s42 offen offset:0 sc1
    buffer_load_dwordx4 v[240:243], v254, s[8:11], s42 offen offset:1024 sc1
    buffer_load_dwordx4 v[244:247], v254, s[8:11], s42 offen offset:2048 sc1
u_done:
    s_waitcnt lgkmcnt(0)
    s_barrier
    ds_read_b128 v[228:231], v253 offset:1040
    ds_read_b128 v[232:235], v253 offset:768
    ds_read_b128 v[236:239], v253 offset:512
    s_waitcnt vmcnt(9) lgkmcnt(0)
    s_branch blk_loop
.p2align 12
blk_loop:
sub0:
    v_mfma_f32_16x16x32_bf16 a[0:3], a[192:195], v[228:231], 0
pad0:
    s_cbranch_vccnz pad4
    s_waitcnt vmcnt(25)
    v_lshlrev_b32 v248, 16, v194
    v_lshlrev_b32 v249, 16, v196
    v_mfma_f32_16x16x32_bf16 a[4:7], a[196:199], v[228:231], 0
    v_cvt_pk_bf16_f32 v180, v180, v181
    v_cvt_pk_bf16_f32 v181, v182, v183
    v_mfma_f32_16x16x32_bf16 a[8:11], a[200:203], v[228:231], 0
    ds_read_b128 v[228:231], v253 offset:256
    v_cvt_pk_bf16_f32 v182, v184, v185
    v_mfma_f32_16x16x32_bf16 a[0:3], a[204:207], v[232:235], a[0:3]
    v_cvt_pk_bf16_f32 v183, v186, v187
    v_lshlrev_b32 v250, 16, v198
    v_mfma_f32_16x16x32_bf16 a[4:7], a[208:211], v[232:235], a[4:7]
    ds_write_b128 v4, v[180:183] offset:19328
    v_mfma_f32_16x16x32_bf16 a[8:11], a[212:215], v[232:235], a[8:11]
    v_lshlrev_b32 v251, 16, v200
    v_and_b32 v194, s22, v194
    v_mfma_f32_16x16x32_bf16 a[12:15], a[192:195], v[232:235], 0
    v_and_b32 v196, s22, v196
    v_and_b32 v198, s22, v198
    v_mfma_f32_16x16x32_bf16 a[12:15], a[204:207], v[236:239], a[12:15]
    v_cvt_pk_bf16_f32 v188, v188, v189
    v_cvt_pk_bf16_f32 v189, v190, v191
    v_and_b32 v200, s22, v200
    v_mfma_f32_16x16x32_bf16 a[16:19], a[208:211], v[236:239], 0
    ds_write_b64 v5, v[188:189] offset:19392
    v_mfma_f32_16x16x32_bf16 a[16:19], a[196:199], v[232:235], a[16:19]
    v_lshlrev_b32 v252, 16, v192
    v_and_b32 v192, s22, v192
    v_mfma_f32_16x16x32_bf16 a[20:23], a[200:203], v[232:235], 0
    ds_read_b128 v[232:235], v253 offset:0
    v_fmac_f32 v252, s25, v251
    v_mfma_f32_16x16x32_bf16 a[20:23], a[212:215], v[236:239], a[20:23]
    v_fmac_f32 v192, s25, v200
    v_fmac_f32 v252, s28, v249
    v_mfma_f32_16x16x32_bf16 a[0:3], a[216:219], v[236:239], a[0:3]
    v_fmac_f32 v192, s28, v196
    v_cvt_pk_bf16_f32 v192, v252, v192
    v_mfma_f32_16x16x32_bf16 a[4:7], a[220:223], v[236:239], a[4:7]
    s_waitcnt lgkmcnt(3)
    v_lshlrev_b32 v252, 16, v202
    v_and_b32 v202, s22, v202
    v_mfma_f32_16x16x32_bf16 a[8:11], a[224:227], v[236:239], a[8:11]
    s_waitcnt lgkmcnt(0)
    v_fmac_f32 v252, s29, v248
    v_fmac_f32 v202, s29, v194
    v_mfma_f32_16x16x32_bf16 a[24:27], a[192:195], v[236:239], 0
    s_barrier
    v_fmac_f32 v252, s23, v250
    v_mfma_f32_16x16x32_bf16 a[24:27], a[204:207], v[228:231], a[24:27]
    ds_read_b128 v[128:131], v6 offset:18688
    v_fmac_f32 v202, s23, v198
    v_mfma_f32_16x16x32_bf16 a[28:31], a[208:211], v[228:231], 0
    v_cvt_pk_bf16_f32 v202, v252, v202
    v_fma_f32 v252, v249, s24, v251
    v_mfma_f32_16x16x32_bf16 a[28:31], a[196:199], v[236:239], a[28:31]
    v_fmac_f32 v251, -4.0, v249
    v_fma_f32 v249, v248, s24, v250
    v_mfma_f32_16x16x32_bf16 a[32:35], a[200:203], v[236:239], 0
    ds_read_b128 v[236:239], v253 offset:1824
    v_fmac_f32 v250, -4.0, v248
    v_mfma_f32_16x16x32_bf16 a[32:35], a[212:215], v[228:231], a[32:35]
    v_fma_f32 v248, v250, s26, v251
    v_fmac_f32 v251, s27, v250
    v_mfma_f32_16x16x32_bf16 a[12:15], a[216:219], v[228:231], a[12:15]
    s_add_u32 s44, s41, 2048
    v_fma_f32 v250, v249, 2.0, v252
    v_fmac_f32 v252, -2.0, v249
    v_mfma_f32_16x16x32_bf16 a[16:19], a[220:223], v[228:231], a[16:19]
    v_and_b32 v227, 0x7fff, v255
    v_fma_f32 v249, v196, s24, v200
    v_mfma_f32_16x16x32_bf16 a[20:23], a[224:227], v[228:231], a[20:23]
    buffer_load_dwordx2 v[216:217], v227, s[4:7], s16 offen offset:832
    v_fmac_f32 v200, -4.0, v196
    v_mfma_f32_16x16x32_bf16 a[36:39], a[192:195], v[228:231], 0
    v_fma_f32 v196, v194, s24, v198
    v_fmac_f32 v198, -4.0, v194
    v_mfma_f32_16x16x32_bf16 a[36:39], a[204:207], v[232:235], a[36:39]
    v_fma_f32 v194, v198, s26, v200
    v_fmac_f32 v200, s27, v198
    v_mfma_f32_16x16x32_bf16 a[40:43], a[208:211], v[232:235], 0
    v_fma_f32 v198, v196, 2.0, v249
    v_fmac_f32 v249, -2.0, v196
    v_mfma_f32_16x16x32_bf16 a[40:43], a[196:199], v[228:231], a[40:43]
    ds_read_b128 v[132:135], v6 offset:21792
    s_waitcnt lgkmcnt(2)
    v_mfma_f32_16x16x32_bf16 a[44:47], a[200:203], v[228:231], 0
    ds_read_b128 v[228:231], v253 offset:1568
    v_cvt_pk_bf16_f32 v194, v248, v194
    v_mfma_f32_16x16x32_bf16 a[44:47], a[212:215], v[232:235], a[44:47]
    buffer_load_dwordx2 v[218:219], v227, s[4:7], s17 offen offset:832
    v_mfma_f32_16x16x32_bf16 a[24:27], a[216:219], v[232:235], a[24:27]
    v_cvt_pk_bf16_f32 v200, v251, v200
    v_cvt_pk_bf16_f32 v198, v250, v198
    v_mfma_f32_16x16x32_bf16 a[28:31], a[220:223], v[232:235], a[28:31]
    v_cvt_pk_bf16_f32 v196, v252, v249
    v_lshlrev_b32 v248, 16, v195
    v_lshlrev_b32 v249, 16, v197
    v_mfma_f32_16x16x32_bf16 a[32:35], a[224:227], v[232:235], a[32:35]
    v_lshlrev_b32 v250, 16, v199
    v_lshlrev_b32 v251, 16, v201
    v_mfma_f32_16x16x32_bf16 a[48:51], a[192:195], v[232:235], 0
    s_waitcnt lgkmcnt(2)
    v_and_b32 v195, s22, v195
    v_and_b32 v197, s22, v197
    v_mfma_f32_16x16x32_bf16 a[48:51], a[204:207], v[236:239], a[48:51]
    buffer_load_dwordx2 v[220:221], v227, s[4:7], s18 offen offset:832
    v_mfma_f32_16x16x32_bf16 a[52:55], a[208:211], v[236:239], 0
    v_and_b32 v199, s22, v199
    v_and_b32 v201, s22, v201
    v_mfma_f32_16x16x32_bf16 a[52:55], a[196:199], v[232:235], a[52:55]
    v_lshlrev_b32 v252, 16, v193
    v_and_b32 v193, s22, v193
    v_mfma_f32_16x16x32_bf16 a[56:59], a[200:203], v[232:235], 0
    ds_read_b128 v[232:235], v253 offset:1312
    v_fmac_f32 v252, s25, v251
    v_mfma_f32_16x16x32_bf16 a[56:59], a[212:215], v[236:239], a[56:59]
    ds_read_b128 v[136:139], v6 offset:24896
    v_fmac_f32 v193, s25, v201
    v_mfma_f32_16x16x32_bf16 a[36:39], a[216:219], v[236:239], a[36:39]
    buffer_load_dwordx2 v[222:223], v227, s[4:7], s19 offen offset:832
    v_fmac_f32 v252, s28, v249
    v_mfma_f32_16x16x32_bf16 a[40:43], a[220:223], v[236:239], a[40:43]
    v_fmac_f32 v193, s28, v197
    v_cvt_pk_bf16_f32 v193, v252, v193
    v_mfma_f32_16x16x32_bf16 a[44:47], a[224:227], v[236:239], a[44:47]
    v_lshlrev_b32 v252, 16, v203
    v_and_b32 v203, s22, v203
    v_mfma_f32_16x16x32_bf16 a[60:63], a[192:195], v[236:239], 0
    s_waitcnt lgkmcnt(2)
    v_fmac_f32 v252, s29, v248
    v_fmac_f32 v203, s29, v195
    v_mfma_f32_16x16x32_bf16 a[60:63], a[204:207], v[228:231], a[60:63]
    v_fmac_f32 v252, s23, v250
    v_fmac_f32 v203, s23, v199
    v_mfma_f32_16x16x32_bf16 a[64:67], a[208:211], v[228:231], 0
    buffer_load_dwordx2 v[224:225], v227, s[4:7], s20 offen offset:832
    v_mfma_f32_16x16x32_bf16 a[64:67], a[196:199], v[236:239], a[64:67]
    v_cvt_pk_bf16_f32 v203, v252, v203
    v_fma_f32 v252, v249, s24, v251
    v_mfma_f32_16x16x32_bf16 a[68:71], a[200:203], v[236:239], 0
    ds_read_b128 v[236:239], v253 offset:1056
    v_fmac_f32 v251, -4.0, v249
    v_mfma_f32_16x16x32_bf16 a[68:71], a[212:215], v[228:231], a[68:71]
    v_fma_f32 v249, v248, s24, v250
    v_fmac_f32 v250, -4.0, v248
    v_fma_f32 v248, v250, s26, v251
    v_mfma_f32_16x16x32_bf16 a[48:51], a[216:219], v[228:231], a[48:51]
    v_fmac_f32 v251, s27, v250
    v_fma_f32 v250, v249, 2.0, v252
    v_mfma_f32_16x16x32_bf16 a[52:55], a[220:223], v[228:231], a[52:55]
    buffer_load_dwordx2 v[226:227], v227, s[4:7], s21 offen offset:832
    v_mfma_f32_16x16x32_bf16 a[56:59], a[224:227], v[228:231], a[56:59]
    ds_read_b128 v[140:143], v6 offset:28000
    v_fmac_f32 v252, -2.0, v249
    v_mfma_f32_16x16x32_bf16 a[72:75], a[192:195], v[228:231], 0
    s_waitcnt lgkmcnt(3)
    v_fma_f32 v249, v197, s24, v201
    v_fmac_f32 v201, -4.0, v197
    v_mfma_f32_16x16x32_bf16 a[72:75], a[204:207], v[232:235], a[72:75]
    v_fma_f32 v197, v195, s24, v199
    v_fmac_f32 v199, -4.0, v195
    v_mfma_f32_16x16x32_bf16 a[76:79], a[208:211], v[232:235], 0
    v_fma_f32 v195, v199, s26, v201
    v_fmac_f32 v201, s27, v199
    v_mfma_f32_16x16x32_bf16 a[76:79], a[196:199], v[228:231], a[76:79]
    buffer_store_dwordx4 v[128:131], v254, s[12:15], s44 offen nt
    s_add_u32 s44, s41, 5120
    v_mfma_f32_16x16x32_bf16 a[80:83], a[200:203], v[228:231], 0
    ds_read_b128 v[228:231], v253 offset:784
    v_fma_f32 v199, v197, 2.0, v249
    v_fmac_f32 v249, -2.0, v197
    v_mfma_f32_16x16x32_bf16 a[80:83], a[212:215], v[232:235], a[80:83]
    s_mov_b32 s42, 73728
    v_cvt_pk_bf16_f32 v195, v248, v195
    v_cvt_pk_bf16_f32 v201, v251, v201
    v_mfma_f32_16x16x32_bf16 a[60:63], a[216:219], v[232:235], a[60:63]
    buffer_store_dwordx4 v[132:135], v254, s[12:15], s44 offen nt
    v_cvt_pk_bf16_f32 v199, v250, v199
    v_cvt_pk_bf16_f32 v197, v252, v249
    v_mfma_f32_16x16x32_bf16 a[64:67], a[220:223], v[232:235], a[64:67]
    v_lshrrev_b32 v252, 15, v255
    v_mfma_f32_16x16x32_bf16 a[68:71], a[224:227], v[232:235], a[68:71]
    ds_write_b64 v252, v[194:195] offset:9088
    v_mfma_f32_16x16x32_bf16 a[84:87], a[192:195], v[232:235], 0
    buffer_load_dwordx4 a[192:195], v254, s[8:11], s42 offen offset:0 sc1
    v_mfma_f32_16x16x32_bf16 a[88:91], a[196:199], v[232:235], 0
    s_add_u32 s44, s41, 8192
    v_lshrrev_b32 v194, 15, v255
    s_waitcnt vmcnt(15)
    v_mfma_f32_16x16x32_bf16 a[92:95], a[200:203], v[232:235], 0
    s_waitcnt lgkmcnt(3)
    v_lshlrev_b32 v248, 16, v206
    v_lshlrev_b32 v249, 16, v208
    v_mfma_f32_16x16x32_bf16 a[84:87], a[204:207], v[236:239], a[84:87]
    ds_read_b128 v[232:235], v253 offset:3120
    v_lshlrev_b32 v250, 16, v210
    v_lshlrev_b32 v251, 16, v212
    v_mfma_f32_16x16x32_bf16 a[88:91], a[208:211], v[236:239], a[88:91]
    buffer_load_dwordx4 a[196:199], v254, s[8:11], s42 offen offset:1024 sc1
    v_mfma_f32_16x16x32_bf16 a[92:95], a[212:215], v[236:239], a[92:95]
    ds_write_b64 v194, v[200:201] offset:11168
    v_mfma_f32_16x16x32_bf16 a[72:75], a[216:219], v[236:239], a[72:75]
    s_waitcnt lgkmcnt(3)
    v_and_b32 v206, s22, v206
    v_and_b32 v208, s22, v208
    v_mfma_f32_16x16x32_bf16 a[76:79], a[220:223], v[236:239], a[76:79]
    buffer_load_dwordx4 a[200:203], v254, s[8:11], s42 offen offset:2048 sc1
    v_mfma_f32_16x16x32_bf16 a[80:83], a[224:227], v[236:239], a[80:83]
    ds_read_b128 v[236:239], v253 offset:2848
    v_mfma_f32_16x16x32_bf16 a[84:87], a[216:219], v[228:231], a[84:87]
    s_mov_b32 s42, 76800
    v_and_b32 v210, s22, v210
    v_and_b32 v212, s22, v212
    v_mfma_f32_16x16x32_bf16 a[88:91], a[220:223], v[228:231], a[88:91]
    s_waitcnt vmcnt(11) lgkmcnt(2)
    v_lshlrev_b32 v252, 16, v204
    v_and_b32 v204, s22, v204
    v_mfma_f32_16x16x32_bf16 a[92:95], a[224:227], v[228:231], a[92:95]
    ds_read_b128 v[228:231], v253 offset:2592
    v_fmac_f32 v252, s25, v251
    v_fmac_f32 v204, s25, v212
sub1:
    v_mfma_f32_16x16x32_bf16 a[96:99], a[228:231], v[232:235], 0
    buffer_load_dwordx4 a[204:207], v254, s[8:11], s42 offen offset:0 sc1
    v_mfma_f32_16x16x32_bf16 a[100:103], a[232:235], v[232:235], 0
    s_waitcnt vmcnt(12) lgkmcnt(1)
    v_fmac_f32 v252, s28, v249
    v_fmac_f32 v204, s28, v208
    v_mfma_f32_16x16x32_bf16 a[104:107], a[236:239], v[232:235], 0
    ds_read_b128 v[232:235], v253 offset:2336
    v_cvt_pk_bf16_f32 v204, v252, v204
    v_mfma_f32_16x16x32_bf16 a[96:99], a[240:243], v[236:239], a[96:99]
    ds_write_b64 v194, v[198:199] offset:13248
    v_mfma_f32_16x16x32_bf16 a[100:103], a[244:247], v[236:239], a[100:103]
    buffer_load_dwordx4 a[208:211], v254, s[8:11], s42 offen offset:1024 sc1
    v_mfma_f32_16x16x32_bf16 a[104:107], a[248:251], v[236:239], a[104:107]
    ds_write_b64 v194, v[192:193] offset:15328
    v_mfma_f32_16x16x32_bf16 a[108:111], a[228:231], v[236:239], 0
    s_waitcnt lgkmcnt(3)
    v_lshlrev_b32 v252, 16, v214
    v_and_b32 v214, s22, v214
    v_mfma_f32_16x16x32_bf16 a[108:111], a[240:243], v[228:231], a[108:111]
    ds_write_b64 v194, v[202:203] offset:38208
    v_fmac_f32 v252, s29, v248
    v_mfma_f32_16x16x32_bf16 a[112:115], a[244:247], v[228:231], 0
    buffer_load_dwordx4 a[212:215], v254, s[8:11], s42 offen offset:2048 sc1
    v_mfma_f32_16x16x32_bf16 a[112:115], a[232:235], v[236:239], a[112:115]
    s_mov_b32 s42, 79872
    v_fmac_f32 v214, s29, v206
    v_fmac_f32 v252, s23, v250
    v_mfma_f32_16x16x32_bf16 a[116:119], a[236:239], v[236:239], 0
    ds_read_b128 v[236:239], v253 offset:2080
    v_fmac_f32 v214, s23, v210
    v_mfma_f32_16x16x32_bf16 a[116:119], a[248:251], v[228:231], a[116:119]
    s_waitcnt vmcnt(14)
    v_cvt_pk_bf16_f32 v214, v252, v214
    v_fma_f32 v252, v249, s24, v251
    v_mfma_f32_16x16x32_bf16 a[96:99], a[252:255], v[228:231], a[96:99]
    buffer_load_dwordx4 a[216:219], v254, s[8:11], s42 offen offset:0 sc1
    v_mfma_f32_16x16x32_bf16 a[100:103], v[240:243], v[228:231], a[100:103]
    ds_write_b64 v194, v[196:197] offset:31968
    v_mfma_f32_16x16x32_bf16 a[104:107], v[244:247], v[228:231], a[104:107]
    buffer_store_dwordx4 v[136:139], v254, s[12:15], s44 offen nt
    s_add_u32 s44, s41, 11264
    v_fmac_f32 v251, -4.0, v249
    v_mfma_f32_16x16x32_bf16 a[120:123], a[228:231], v[228:231], 0
    s_waitcnt lgkmcnt(5)
    v_fma_f32 v249, v248, s24, v250
    v_fmac_f32 v250, -4.0, v248
    v_mfma_f32_16x16x32_bf16 a[120:123], a[240:243], v[232:235], a[120:123]
    buffer_load_dwordx4 a[220:223], v254, s[8:11], s42 offen offset:1024 sc1
    v_mfma_f32_16x16x32_bf16 a[124:127], a[244:247], v[232:235], 0
    v_fma_f32 v248, v250, s26, v251
    v_fmac_f32 v251, s27, v250
    v_mfma_f32_16x16x32_bf16 a[124:127], a[232:235], v[228:231], a[124:127]
    v_fma_f32 v250, v249, 2.0, v252
    v_fmac_f32 v252, -2.0, v249
    v_mfma_f32_16x16x32_bf16 a[128:131], a[236:239], v[228:231], 0
    ds_read_b128 v[228:231], v253 offset:3904
    v_fma_f32 v249, v208, s24, v212
    v_mfma_f32_16x16x32_bf16 a[128:131], a[248:251], v[232:235], a[128:131]
    buffer_load_dwordx4 a[224:227], v254, s[8:11], s42 offen offset:2048 sc1
    v_mfma_f32_16x16x32_bf16 a[108:111], a[252:255], v[232:235], a[108:111]
    v_fmac_f32 v212, -4.0, v208
    v_fma_f32 v208, v206, s24, v210
    v_mfma_f32_16x16x32_bf16 a[112:115], v[240:243], v[232:235], a[112:115]
    buffer_store_dwordx4 v[140:143], v254, s[12:15], s44 offen nt
    v_and_b32 v203, 0x7fff, v255
    v_fmac_f32 v210, -4.0, v206
    v_mfma_f32_16x16x32_bf16 a[116:119], v[244:247], v[232:235], a[116:119]
    buffer_load_dwordx2 v[192:193], v203, s[4:7], s16 offen offset:1216
    v_fma_f32 v206, v210, s26, v212
    v_mfma_f32_16x16x32_bf16 a[132:135], a[228:231], v[232:235], 0
    s_waitcnt lgkmcnt(2)
    v_fmac_f32 v212, s27, v210
    v_fma_f32 v210, v208, 2.0, v249
    v_mfma_f32_16x16x32_bf16 a[132:135], a[240:243], v[236:239], a[132:135]
    v_fmac_f32 v249, -2.0, v208
    v_cvt_pk_bf16_f32 v206, v248, v206
    v_mfma_f32_16x16x32_bf16 a[136:139], a[244:247], v[236:239], 0
    v_cvt_pk_bf16_f32 v212, v251, v212
    v_cvt_pk_bf16_f32 v210, v250, v210
    v_mfma_f32_16x16x32_bf16 a[136:139], a[232:235], v[232:235], a[136:139]
    v_cvt_pk_bf16_f32 v208, v252, v249
    v_lshlrev_b32 v248, 16, v207
    v_mfma_f32_16x16x32_bf16 a[140:143], a[236:239], v[232:235], 0
    ds_read_b128 v[232:235], v253 offset:3648
    v_lshlrev_b32 v249, 16, v209
    v_mfma_f32_16x16x32_bf16 a[140:143], a[248:251], v[236:239], a[140:143]
    buffer_load_dwordx2 v[194:195], v203, s[4:7], s17 offen offset:1216
    v_mfma_f32_16x16x32_bf16 a[120:123], a[252:255], v[236:239], a[120:123]
    v_lshlrev_b32 v250, 16, v211
    v_lshlrev_b32 v251, 16, v213
    v_mfma_f32_16x16x32_bf16 a[124:127], v[240:243], v[236:239], a[124:127]
    v_and_b32 v207, s22, v207
    v_and_b32 v209, s22, v209
    v_and_b32 v211, s22, v211
    v_mfma_f32_16x16x32_bf16 a[128:131], v[244:247], v[236:239], a[128:131]
    v_and_b32 v213, s22, v213
    v_lshlrev_b32 v252, 16, v205
    v_mfma_f32_16x16x32_bf16 a[144:147], a[228:231], v[236:239], 0
    s_waitcnt lgkmcnt(1)
    v_and_b32 v205, s22, v205
    v_fmac_f32 v252, s25, v251
    v_mfma_f32_16x16x32_bf16 a[144:147], a[240:243], v[228:231], a[144:147]
    buffer_load_dwordx2 v[196:197], v203, s[4:7], s18 offen offset:1216
    v_mfma_f32_16x16x32_bf16 a[148:151], a[244:247], v[228:231], 0
    v_fmac_f32 v205, s25, v213
    v_fmac_f32 v252, s28, v249
    v_mfma_f32_16x16x32_bf16 a[148:151], a[232:235], v[236:239], a[148:151]
    v_fmac_f32 v205, s28, v209
    v_cvt_pk_bf16_f32 v205, v252, v205
    v_mfma_f32_16x16x32_bf16 a[152:155], a[236:239], v[236:239], 0
    ds_read_b128 v[236:239], v253 offset:3392
    v_lshlrev_b32 v252, 16, v215
    v_mfma_f32_16x16x32_bf16 a[152:155], a[248:251], v[228:231], a[152:155]
    v_and_b32 v215, s22, v215
    v_fmac_f32 v252, s29, v248
    v_mfma_f32_16x16x32_bf16 a[132:135], a[252:255], v[228:231], a[132:135]
    buffer_load_dwordx2 v[198:199], v203, s[4:7], s19 offen offset:1216
    v_fmac_f32 v215, s29, v207
    v_mfma_f32_16x16x32_bf16 a[136:139], v[240:243], v[228:231], a[136:139]
    v_fmac_f32 v252, s23, v250
    v_fmac_f32 v215, s23, v211
    v_mfma_f32_16x16x32_bf16 a[140:143], v[244:247], v[228:231], a[140:143]
    v_cvt_pk_bf16_f32 v215, v252, v215
    v_fma_f32 v252, v249, s24, v251
    v_mfma_f32_16x16x32_bf16 a[156:159], a[228:231], v[228:231], 0
    s_waitcnt lgkmcnt(1)
    v_fmac_f32 v251, -4.0, v249
    v_fma_f32 v249, v248, s24, v250
    v_mfma_f32_16x16x32_bf16 a[156:159], a[240:243], v[232:235], a[156:159]
    v_fmac_f32 v250, -4.0, v248
    v_fma_f32 v248, v250, s26, v251
    v_mfma_f32_16x16x32_bf16 a[160:163], a[244:247], v[232:235], 0
    buffer_load_dwordx2 v[200:201], v203, s[4:7], s20 offen offset:1216
    v_mfma_f32_16x16x32_bf16 a[160:163], a[232:235], v[228:231], a[160:163]
    v_fmac_f32 v251, s27, v250
    v_fma_f32 v250, v249, 2.0, v252
    v_mfma_f32_16x16x32_bf16 a[164:167], a[236:239], v[228:231], 0
    ds_read_b128 v[228:231], v253 offset:3136
    v_fmac_f32 v252, -2.0, v249
    v_mfma_f32_16x16x32_bf16 a[164:167], a[248:251], v[232:235], a[164:167]
    v_fma_f32 v249, v209, s24, v213
    v_fmac_f32 v213, -4.0, v209
    v_fma_f32 v209, v207, s24, v211
    v_mfma_f32_16x16x32_bf16 a[144:147], a[252:255], v[232:235], a[144:147]
    v_fmac_f32 v211, -4.0, v207
    v_fma_f32 v207, v211, s26, v213
    v_mfma_f32_16x16x32_bf16 a[148:151], v[240:243], v[232:235], a[148:151]
    buffer_load_dwordx2 v[202:203], v203, s[4:7], s21 offen offset:1216
    v_mfma_f32_16x16x32_bf16 a[152:155], v[244:247], v[232:235], a[152:155]
    v_fmac_f32 v213, s27, v211
    v_fma_f32 v211, v209, 2.0, v249
    v_mfma_f32_16x16x32_bf16 a[168:171], a[228:231], v[232:235], 0
    s_waitcnt lgkmcnt(1)
    v_fmac_f32 v249, -2.0, v209
    v_cvt_pk_bf16_f32 v207, v248, v207
    v_mfma_f32_16x16x32_bf16 a[168:171], a[240:243], v[236:239], a[168:171]
    v_cvt_pk_bf16_f32 v213, v251, v213
    v_cvt_pk_bf16_f32 v211, v250, v211
    v_mfma_f32_16x16x32_bf16 a[172:175], a[244:247], v[236:239], 0
    v_cvt_pk_bf16_f32 v209, v252, v249
    v_lshrrev_b32 v252, 15, v255
    v_mfma_f32_16x16x32_bf16 a[172:175], a[232:235], v[232:235], a[172:175]
    ds_write_b64 v252, v[206:207] offset:8832
    v_mfma_f32_16x16x32_bf16 a[176:179], a[236:239], v[232:235], 0
    ds_read_b128 v[232:235], v253 offset:2864
    v_lshrrev_b32 v206, 15, v255
    s_waitcnt vmcnt(19)
    v_mfma_f32_16x16x32_bf16 a[176:179], a[248:251], v[236:239], a[176:179]
    s_mov_b32 s42, 110592
    v_lshlrev_b32 v248, 16, v218
    v_lshlrev_b32 v249, 16, v220
    v_mfma_f32_16x16x32_bf16 a[156:159], a[252:255], v[236:239], a[156:159]
    ds_write_b64 v206, v[212:213] offset:10912
    v_mfma_f32_16x16x32_bf16 a[160:163], v[240:243], v[236:239], a[160:163]
    v_lshlrev_b32 v250, 16, v222
    v_lshlrev_b32 v251, 16, v224
    v_mfma_f32_16x16x32_bf16 a[164:167], v[244:247], v[236:239], a[164:167]
    ds_write_b64 v206, v[210:211] offset:12992
    v_mfma_f32_16x16x32_bf16 a[180:183], a[228:231], v[236:239], 0
    buffer_load_dwordx4 a[228:231], v254, s[8:11], s42 offen offset:0 sc1
    v_mfma_f32_16x16x32_bf16 a[184:187], a[232:235], v[236:239], 0
    ds_write_b64 v206, v[204:205] offset:15072
    v_mfma_f32_16x16x32_bf16 a[188:191], a[236:239], v[236:239], 0
    s_waitcnt lgkmcnt(5)
    v_and_b32 v218, s22, v218
    v_and_b32 v220, s22, v220
    v_mfma_f32_16x16x32_bf16 a[180:183], a[240:243], v[228:231], a[180:183]
    ds_read_b128 v[236:239], v253 offset:5200
    v_and_b32 v222, s22, v222
    v_and_b32 v224, s22, v224
    v_mfma_f32_16x16x32_bf16 a[184:187], a[244:247], v[228:231], a[184:187]
    buffer_load_dwordx4 a[232:235], v254, s[8:11], s42 offen offset:1024 sc1
    v_mfma_f32_16x16x32_bf16 a[188:191], a[248:251], v[228:231], a[188:191]
    ds_write_b64 v206, v[214:215] offset:37952
    v_mfma_f32_16x16x32_bf16 a[168:171], a[252:255], v[228:231], a[168:171]
    s_waitcnt lgkmcnt(5)
    v_lshlrev_b32 v252, 16, v216
    v_and_b32 v216, s22, v216
    v_mfma_f32_16x16x32_bf16 a[172:175], v[240:243], v[228:231], a[172:175]
    buffer_load_dwordx4 a[236:239], v254, s[8:11], s42 offen offset:2048 sc1
    v_mfma_f32_16x16x32_bf16 a[176:179], v[244:247], v[228:231], a[176:179]
    ds_read_b128 v[228:231], v253 offset:4928
    v_fmac_f32 v252, s25, v251
    v_mfma_f32_16x16x32_bf16 a[180:183], a[252:255], v[232:235], a[180:183]
    s_mov_b32 s42, 113664
    v_fmac_f32 v216, s25, v224
    v_fmac_f32 v252, s28, v249
    v_mfma_f32_16x16x32_bf16 a[184:187], v[240:243], v[232:235], a[184:187]
    s_waitcnt vmcnt(17) lgkmcnt(2)
    v_fmac_f32 v216, s28, v220
    v_cvt_pk_bf16_f32 v216, v252, v216
    v_mfma_f32_16x16x32_bf16 a[188:191], v[244:247], v[232:235], a[188:191]
    ds_read_b128 v[232:235], v253 offset:4672
    v_lshlrev_b32 v252, 16, v226
    v_and_b32 v226, s22, v226
sub2:
    v_mfma_f32_16x16x32_bf16 v[0:3], a[192:195], v[236:239], 0
    buffer_load_dwordx4 a[240:243], v254, s[8:11], s42 offen offset:0 sc1
    v_mfma_f32_16x16x32_bf16 v[4:7], a[196:199], v[236:239], 0
    s_waitcnt vmcnt(15) lgkmcnt(1)
    v_fmac_f32 v252, s29, v248
    v_fmac_f32 v226, s29, v218
    v_mfma_f32_16x16x32_bf16 v[8:11], a[200:203], v[236:239], 0
    ds_read_b128 v[236:239], v253 offset:4416
    v_fmac_f32 v252, s23, v250
    v_mfma_f32_16x16x32_bf16 v[0:3], a[204:207], v[228:231], v[0:3]
    ds_write_b64 v206, v[208:209] offset:31712
    v_mfma_f32_16x16x32_bf16 v[4:7], a[208:211], v[228:231], v[4:7]
    buffer_load_dwordx4 a[244:247], v254, s[8:11], s42 offen offset:1024 sc1
    v_mfma_f32_16x16x32_bf16 v[8:11], a[212:215], v[228:231], v[8:11]
    ds_read_b128 v[204:207], v253 offset:39712
    s_mov_b32 s45, 619910279
    v_mfma_f32_16x16x32_bf16 v[12:15], a[192:195], v[228:231], 0
    s_waitcnt lgkmcnt(3)
    v_bfe_u32 v208, v254, 5, 3
    v_mul_u32_u24 v209, 5, v208
    v_mfma_f32_16x16x32_bf16 v[12:15], a[204:207], v[232:235], v[12:15]
    v_bfe_u32 v209, s45, v209, 5
    v_mul_u32_u24 v209, 65, v209
    v_fmac_f32 v226, s23, v222
    v_mfma_f32_16x16x32_bf16 v[16:19], a[208:211], v[232:235], 0
    buffer_load_dwordx4 a[248:251], v254, s[8:11], s42 offen offset:2048 sc1
    v_mfma_f32_16x16x32_bf16 v[16:19], a[196:199], v[228:231], v[16:19]
    s_mov_b32 s42, 116736
    v_sub_u32 v209, v209, v208
    v_lshl_add_u32 v208, v209, 5, v253
    v_mfma_f32_16x16x32_bf16 v[20:23], a[200:203], v[228:231], 0
    ds_read_b128 v[228:231], v253 offset:4160
    s_waitcnt lgkmcnt(1)
    v_mfma_f32_16x16x32_bf16 v[20:23], a[212:215], v[232:235], v[20:23]
    s_waitcnt vmcnt(13)
    v_cvt_pk_bf16_f32 v226, v252, v226
    v_fma_f32 v252, v249, s24, v251
    v_mfma_f32_16x16x32_bf16 v[0:3], a[216:219], v[232:235], v[0:3]
    buffer_load_dwordx4 a[252:255], v254, s[8:11], s42 offen offset:0 sc1
    v_mfma_f32_16x16x32_bf16 v[4:7], a[220:223], v[232:235], v[4:7]
    s_mov_b64 exec, s[46:47]
    ds_write_b128 v208, v[204:207] offset:1024
    s_mov_b64 exec, -1
    v_mfma_f32_16x16x32_bf16 v[8:11], a[224:227], v[232:235], v[8:11]
    v_fmac_f32 v251, -4.0, v249
    v_fma_f32 v249, v248, s24, v250
    v_mfma_f32_16x16x32_bf16 v[24:27], a[192:195], v[232:235], 0
    v_fmac_f32 v250, -4.0, v248
    v_fma_f32 v248, v250, s26, v251
    v_fmac_f32 v251, s27, v250
    v_mfma_f32_16x16x32_bf16 v[24:27], a[204:207], v[236:239], v[24:27]
    buffer_load_dwordx4 v[240:243], v254, s[8:11], s42 offen offset:1024 sc1
    v_mfma_f32_16x16x32_bf16 v[28:31], a[208:211], v[236:239], 0
    v_fma_f32 v250, v249, 2.0, v252
    v_fmac_f32 v252, -2.0, v249
    v_mfma_f32_16x16x32_bf16 v[28:31], a[196:199], v[232:235], v[28:31]
    v_fma_f32 v249, v220, s24, v224
    v_fmac_f32 v224, -4.0, v220
    v_mfma_f32_16x16x32_bf16 v[32:35], a[200:203], v[232:235], 0
    ds_read_b128 v[232:235], v253 offset:5984
    v_fma_f32 v220, v218, s24, v222
    v_mfma_f32_16x16x32_bf16 v[32:35], a[212:215], v[236:239], v[32:35]
    buffer_load_dwordx4 v[244:247], v254, s[8:11], s42 offen offset:2048 sc1
    v_mfma_f32_16x16x32_bf16 v[12:15], a[216:219], v[236:239], v[12:15]
    v_fmac_f32 v222, -4.0, v218
    v_fma_f32 v218, v222, s26, v224
    v_mfma_f32_16x16x32_bf16 v[16:19], a[220:223], v[236:239], v[16:19]
    v_and_b32 v215, 0x7fff, v255
    v_fmac_f32 v224, s27, v222
    v_mfma_f32_16x16x32_bf16 v[20:23], a[224:227], v[236:239], v[20:23]
    buffer_load_dwordx2 v[204:205], v215, s[4:7], s16 offen offset:128
    v_fma_f32 v222, v220, 2.0, v249
    v_mfma_f32_16x16x32_bf16 v[36:39], a[192:195], v[236:239], 0
    s_waitcnt lgkmcnt(2)
    v_fmac_f32 v249, -2.0, v220
    v_cvt_pk_bf16_f32 v218, v248, v218
    v_mfma_f32_16x16x32_bf16 v[36:39], a[204:207], v[228:231], v[36:39]
    v_cvt_pk_bf16_f32 v224, v251, v224
    v_cvt_pk_bf16_f32 v222, v250, v222
    v_mfma_f32_16x16x32_bf16 v[40:43], a[208:211], v[228:231], 0
    v_cvt_pk_bf16_f32 v220, v252, v249
    v_lshlrev_b32 v248, 16, v219
    v_mfma_f32_16x16x32_bf16 v[40:43], a[196:199], v[236:239], v[40:43]
    v_lshlrev_b32 v249, 16, v221
    v_lshlrev_b32 v250, 16, v223
    v_mfma_f32_16x16x32_bf16 v[44:47], a[200:203], v[236:239], 0
    ds_read_b128 v[236:239], v253 offset:5728
    v_lshlrev_b32 v251, 16, v225
    v_mfma_f32_16x16x32_bf16 v[44:47], a[212:215], v[228:231], v[44:47]
    buffer_load_dwordx2 v[206:207], v215, s[4:7], s17 offen offset:128
    v_mfma_f32_16x16x32_bf16 v[24:27], a[216:219], v[228:231], v[24:27]
    v_and_b32 v219, s22, v219
    v_and_b32 v221, s22, v221
    v_mfma_f32_16x16x32_bf16 v[28:31], a[220:223], v[228:231], v[28:31]
    v_and_b32 v223, s22, v223
    v_and_b32 v225, s22, v225
    v_lshlrev_b32 v252, 16, v217
    v_mfma_f32_16x16x32_bf16 v[32:35], a[224:227], v[228:231], v[32:35]
    v_and_b32 v217, s22, v217
    v_fmac_f32 v252, s25, v251
    v_mfma_f32_16x16x32_bf16 v[48:51], a[192:195], v[228:231], 0
    s_waitcnt lgkmcnt(1)
    v_fmac_f32 v217, s25, v225
    v_fmac_f32 v252, s28, v249
    v_mfma_f32_16x16x32_bf16 v[48:51], a[204:207], v[232:235], v[48:51]
    buffer_load_dwordx2 v[208:209], v215, s[4:7], s18 offen offset:128
    v_mfma_f32_16x16x32_bf16 v[52:55], a[208:211], v[232:235], 0
    v_fmac_f32 v217, s28, v221
    v_cvt_pk_bf16_f32 v217, v252, v217
    v_mfma_f32_16x16x32_bf16 v[52:55], a[196:199], v[228:231], v[52:55]
    v_lshlrev_b32 v252, 16, v227
    v_and_b32 v227, s22, v227
    v_mfma_f32_16x16x32_bf16 v[56:59], a[200:203], v[228:231], 0
    ds_read_b128 v[228:231], v253 offset:5472
    v_fmac_f32 v252, s29, v248
    v_mfma_f32_16x16x32_bf16 v[56:59], a[212:215], v[232:235], v[56:59]
    v_fmac_f32 v227, s29, v219
    v_fmac_f32 v252, s23, v250
    v_mfma_f32_16x16x32_bf16 v[36:39], a[216:219], v[232:235], v[36:39]
    buffer_load_dwordx2 v[210:211], v215, s[4:7], s19 offen offset:128
    v_fmac_f32 v227, s23, v223
    v_mfma_f32_16x16x32_bf16 v[40:43], a[220:223], v[232:235], v[40:43]
    v_cvt_pk_bf16_f32 v227, v252, v227
    v_fma_f32 v252, v249, s24, v251
    v_mfma_f32_16x16x32_bf16 v[44:47], a[224:227], v[232:235], v[44:47]
    v_fmac_f32 v251, -4.0, v249
    v_fma_f32 v249, v248, s24, v250
    v_mfma_f32_16x16x32_bf16 v[60:63], a[192:195], v[232:235], 0
    s_waitcnt lgkmcnt(1)
    v_fmac_f32 v250, -4.0, v248
    v_fma_f32 v248, v250, s26, v251
    v_mfma_f32_16x16x32_bf16 v[60:63], a[204:207], v[236:239], v[60:63]
    v_fmac_f32 v251, s27, v250
    v_fma_f32 v250, v249, 2.0, v252
    v_mfma_f32_16x16x32_bf16 v[64:67], a[208:211], v[236:239], 0
    buffer_load_dwordx2 v[212:213], v215, s[4:7], s20 offen offset:128
    v_mfma_f32_16x16x32_bf16 v[64:67], a[196:199], v[232:235], v[64:67]
    v_fmac_f32 v252, -2.0, v249
    v_fma_f32 v249, v221, s24, v225
    v_mfma_f32_16x16x32_bf16 v[68:71], a[200:203], v[232:235], 0
    ds_read_b128 v[232:235], v253 offset:5216
    v_fmac_f32 v225, -4.0, v221
    v_mfma_f32_16x16x32_bf16 v[68:71], a[212:215], v[236:239], v[68:71]
    v_fma_f32 v221, v219, s24, v223
    v_fmac_f32 v223, -4.0, v219
    v_fma_f32 v219, v223, s26, v225
    v_mfma_f32_16x16x32_bf16 v[48:51], a[216:219], v[236:239], v[48:51]
    v_fmac_f32 v225, s27, v223
    v_fma_f32 v223, v221, 2.0, v249
    v_mfma_f32_16x16x32_bf16 v[52:55], a[220:223], v[236:239], v[52:55]
    buffer_load_dwordx2 v[214:215], v215, s[4:7], s21 offen offset:128
    v_mfma_f32_16x16x32_bf16 v[56:59], a[224:227], v[236:239], v[56:59]
    v_fmac_f32 v249, -2.0, v221
    v_cvt_pk_bf16_f32 v219, v248, v219
    v_mfma_f32_16x16x32_bf16 v[72:75], a[192:195], v[236:239], 0
    s_waitcnt lgkmcnt(1)
    v_cvt_pk_bf16_f32 v225, v251, v225
    v_cvt_pk_bf16_f32 v223, v250, v223
    v_mfma_f32_16x16x32_bf16 v[72:75], a[204:207], v[228:231], v[72:75]
    v_cvt_pk_bf16_f32 v221, v252, v249
    v_lshrrev_b32 v252, 15, v255
    v_mfma_f32_16x16x32_bf16 v[76:79], a[208:211], v[228:231], 0
    ds_write_b64 v252, v[218:219] offset:8576
    v_mfma_f32_16x16x32_bf16 v[76:79], a[196:199], v[236:239], v[76:79]
    s_waitcnt vmcnt(15)
    v_lshrrev_b32 v218, 15, v255
    v_lshlrev_b32 v248, 16, v194
    v_mfma_f32_16x16x32_bf16 v[80:83], a[200:203], v[236:239], 0
    ds_read_b128 v[236:239], v253 offset:4944
    v_lshlrev_b32 v249, 16, v196
    v_lshlrev_b32 v250, 16, v198
    v_mfma_f32_16x16x32_bf16 v[80:83], a[212:215], v[228:231], v[80:83]
    s_mov_b32 s42, 147456
    v_lshlrev_b32 v251, 16, v200
    v_and_b32 v194, s22, v194
    v_mfma_f32_16x16x32_bf16 v[60:63], a[216:219], v[228:231], v[60:63]
    ds_write_b64 v218, v[224:225] offset:10656
    v_mfma_f32_16x16x32_bf16 v[64:67], a[220:223], v[228:231], v[64:67]
    v_and_b32 v196, s22, v196
    v_and_b32 v198, s22, v198
    v_mfma_f32_16x16x32_bf16 v[68:71], a[224:227], v[228:231], v[68:71]
    ds_write_b64 v218, v[222:223] offset:12736
    v_mfma_f32_16x16x32_bf16 v[84:87], a[192:195], v[228:231], 0
pad1:
    s_cbranch_vccnz pad5
    buffer_load_dwordx4 a[192:195], v254, s[8:11], s42 offen offset:0 sc1
    v_mfma_f32_16x16x32_bf16 v[88:91], a[196:199], v[228:231], 0
    ds_write_b64 v218, v[216:217] offset:14816
    v_mfma_f32_16x16x32_bf16 v[92:95], a[200:203], v[228:231], 0
    s_waitcnt lgkmcnt(5)
    v_and_b32 v200, s22, v200
    v_lshlrev_b32 v252, 16, v192
    v_mfma_f32_16x16x32_bf16 v[84:87], a[204:207], v[232:235], v[84:87]
    ds_read_b128 v[228:231], v253 offset:7280
    v_and_b32 v192, s22, v192
    v_fmac_f32 v252, s25, v251
    v_mfma_f32_16x16x32_bf16 v[88:91], a[208:211], v[232:235], v[88:91]
    buffer_load_dwordx4 a[196:199], v254, s[8:11], s42 offen offset:1024 sc1
    v_mfma_f32_16x16x32_bf16 v[92:95], a[212:215], v[232:235], v[92:95]
    ds_write_b64 v218, v[226:227] offset:37696
    v_mfma_f32_16x16x32_bf16 v[72:75], a[216:219], v[232:235], v[72:75]
    s_waitcnt lgkmcnt(5)
    v_fmac_f32 v192, s25, v200
    v_fmac_f32 v252, s28, v249
    v_mfma_f32_16x16x32_bf16 v[76:79], a[220:223], v[232:235], v[76:79]
    buffer_load_dwordx4 a[200:203], v254, s[8:11], s42 offen offset:2048 sc1
    v_mfma_f32_16x16x32_bf16 v[80:83], a[224:227], v[232:235], v[80:83]
    ds_read_b128 v[232:235], v253 offset:7008
    v_fmac_f32 v192, s28, v196
    v_mfma_f32_16x16x32_bf16 v[84:87], a[216:219], v[236:239], v[84:87]
    s_mov_b32 s42, 150528
    v_cvt_pk_bf16_f32 v192, v252, v192
    v_lshlrev_b32 v252, 16, v202
    v_mfma_f32_16x16x32_bf16 v[88:91], a[220:223], v[236:239], v[88:91]
    s_waitcnt vmcnt(15) lgkmcnt(2)
    v_and_b32 v202, s22, v202
    v_fmac_f32 v252, s29, v248
    v_mfma_f32_16x16x32_bf16 v[92:95], a[224:227], v[236:239], v[92:95]
    ds_read_b128 v[236:239], v253 offset:6752
    v_fmac_f32 v202, s29, v194
    v_fmac_f32 v252, s23, v250
sub3:
    v_mfma_f32_16x16x32_bf16 v[96:99], a[228:231], v[228:231], 0
    buffer_load_dwordx4 a[204:207], v254, s[8:11], s42 offen offset:0 sc1
    v_mfma_f32_16x16x32_bf16 v[100:103], a[232:235], v[228:231], 0
    s_waitcnt vmcnt(13) lgkmcnt(1)
    v_fmac_f32 v202, s23, v198
    v_cvt_pk_bf16_f32 v202, v252, v202
    v_mfma_f32_16x16x32_bf16 v[104:107], a[236:239], v[228:231], 0
    ds_read_b128 v[228:231], v253 offset:6496
    v_fma_f32 v252, v249, s24, v251
    v_mfma_f32_16x16x32_bf16 v[96:99], a[240:243], v[232:235], v[96:99]
    ds_write_b64 v218, v[220:221] offset:31456
    v_mfma_f32_16x16x32_bf16 v[100:103], a[244:247], v[232:235], v[100:103]
    buffer_load_dwordx4 a[208:211], v254, s[8:11], s42 offen offset:1024 sc1
    v_mfma_f32_16x16x32_bf16 v[104:107], a[248:251], v[232:235], v[104:107]
    v_fmac_f32 v251, -4.0, v249
    v_fma_f32 v249, v248, s24, v250
    v_mfma_f32_16x16x32_bf16 v[108:111], a[228:231], v[232:235], 0
    s_waitcnt lgkmcnt(2)
    v_fmac_f32 v250, -4.0, v248
    v_fma_f32 v248, v250, s26, v251
    v_mfma_f32_16x16x32_bf16 v[108:111], a[240:243], v[236:239], v[108:111]
    v_fmac_f32 v251, s27, v250
    v_fma_f32 v250, v249, 2.0, v252
    v_fmac_f32 v252, -2.0, v249
    v_mfma_f32_16x16x32_bf16 v[112:115], a[244:247], v[236:239], 0
    buffer_load_dwordx4 a[212:215], v254, s[8:11], s42 offen offset:2048 sc1
    v_mfma_f32_16x16x32_bf16 v[112:115], a[232:235], v[232:235], v[112:115]
    s_mov_b32 s42, 153600
    v_fma_f32 v249, v196, s24, v200
    v_fmac_f32 v200, -4.0, v196
    v_mfma_f32_16x16x32_bf16 v[116:119], a[236:239], v[232:235], 0
    ds_read_b128 v[232:235], v253 offset:6240
    v_fma_f32 v196, v194, s24, v198
    v_mfma_f32_16x16x32_bf16 v[116:119], a[248:251], v[236:239], v[116:119]
    s_waitcnt vmcnt(12)
    v_fmac_f32 v198, -4.0, v194
    v_fma_f32 v194, v198, s26, v200
    v_mfma_f32_16x16x32_bf16 v[96:99], a[252:255], v[236:239], v[96:99]
    buffer_load_dwordx4 a[216:219], v254, s[8:11], s42 offen offset:0 sc1
    v_mfma_f32_16x16x32_bf16 v[100:103], v[240:243], v[236:239], v[100:103]
    v_fmac_f32 v200, s27, v198
    v_fma_f32 v198, v196, 2.0, v249
    v_mfma_f32_16x16x32_bf16 v[104:107], v[244:247], v[236:239], v[104:107]
    v_fmac_f32 v249, -2.0, v196
    v_cvt_pk_bf16_f32 v194, v248, v194
    v_mfma_f32_16x16x32_bf16 v[120:123], a[228:231], v[236:239], 0
    s_waitcnt lgkmcnt(2)
    v_cvt_pk_bf16_f32 v200, v251, v200
    v_cvt_pk_bf16_f32 v198, v250, v198
    v_cvt_pk_bf16_f32 v196, v252, v249
    v_mfma_f32_16x16x32_bf16 v[120:123], a[240:243], v[228:231], v[120:123]
    buffer_load_dwordx4 a[220:223], v254, s[8:11], s42 offen offset:1024 sc1
    v_mfma_f32_16x16x32_bf16 v[124:127], a[244:247], v[228:231], 0
    v_lshlrev_b32 v248, 16, v195
    v_lshlrev_b32 v249, 16, v197
    v_mfma_f32_16x16x32_bf16 v[124:127], a[232:235], v[236:239], v[124:127]
    v_lshlrev_b32 v250, 16, v199
    v_lshlrev_b32 v251, 16, v201
    v_mfma_f32_16x16x32_bf16 v[128:131], a[236:239], v[236:239], 0
    ds_read_b128 v[236:239], v253 offset:8064
    v_and_b32 v195, s22, v195
    v_mfma_f32_16x16x32_bf16 v[128:131], a[248:251], v[228:231], v[128:131]
    buffer_load_dwordx4 a[224:227], v254, s[8:11], s42 offen offset:2048 sc1
    v_mfma_f32_16x16x32_bf16 v[108:111], a[252:255], v[228:231], v[108:111]
    v_and_b32 v197, s22, v197
    v_and_b32 v199, s22, v199
    v_mfma_f32_16x16x32_bf16 v[112:115], v[240:243], v[228:231], v[112:115]
    v_and_b32 v227, 0x7fff, v255
    v_and_b32 v201, s22, v201
    v_mfma_f32_16x16x32_bf16 v[116:119], v[244:247], v[228:231], v[116:119]
    buffer_load_dwordx2 v[216:217], v227, s[4:7], s16 offen offset:512
    v_lshlrev_b32 v252, 16, v193
    v_mfma_f32_16x16x32_bf16 v[132:135], a[228:231], v[228:231], 0
    s_waitcnt lgkmcnt(1)
    v_and_b32 v193, s22, v193
    v_fmac_f32 v252, s25, v251
    v_mfma_f32_16x16x32_bf16 v[132:135], a[240:243], v[232:235], v[132:135]
    v_fmac_f32 v193, s25, v201
    v_fmac_f32 v252, s28, v249
    v_mfma_f32_16x16x32_bf16 v[136:139], a[244:247], v[232:235], 0
    v_fmac_f32 v193, s28, v197
    v_cvt_pk_bf16_f32 v193, v252, v193
    v_mfma_f32_16x16x32_bf16 v[136:139], a[232:235], v[228:231], v[136:139]
    v_lshlrev_b32 v252, 16, v203
    v_and_b32 v203, s22, v203
    v_mfma_f32_16x16x32_bf16 v[140:143], a[236:239], v[228:231], 0
    ds_read_b128 v[228:231], v253 offset:7808
    v_fmac_f32 v252, s29, v248
    v_mfma_f32_16x16x32_bf16 v[140:143], a[248:251], v[232:235], v[140:143]
    buffer_load_dwordx2 v[218:219], v227, s[4:7], s17 offen offset:512
    v_mfma_f32_16x16x32_bf16 v[120:123], a[252:255], v[232:235], v[120:123]
    v_fmac_f32 v203, s29, v195
    v_fmac_f32 v252, s23, v250
    v_mfma_f32_16x16x32_bf16 v[124:127], v[240:243], v[232:235], v[124:127]
    v_fmac_f32 v203, s23, v199
    v_cvt_pk_bf16_f32 v203, v252, v203
    v_fma_f32 v252, v249, s24, v251
    v_mfma_f32_16x16x32_bf16 v[128:131], v[244:247], v[232:235], v[128:131]
    v_fmac_f32 v251, -4.0, v249
    v_fma_f32 v249, v248, s24, v250
    v_mfma_f32_16x16x32_bf16 v[144:147], a[228:231], v[232:235], 0
    s_waitcnt lgkmcnt(1)
    v_fmac_f32 v250, -4.0, v248
    v_fma_f32 v248, v250, s26, v251
    v_mfma_f32_16x16x32_bf16 v[144:147], a[240:243], v[236:239], v[144:147]
    buffer_load_dwordx2 v[220:221], v227, s[4:7], s18 offen offset:512
    v_mfma_f32_16x16x32_bf16 v[148:151], a[244:247], v[236:239], 0
    v_fmac_f32 v251, s27, v250
    v_fma_f32 v250, v249, 2.0, v252
    v_mfma_f32_16x16x32_bf16 v[148:151], a[232:235], v[232:235], v[148:151]
    v_fmac_f32 v252, -2.0, v249
    v_fma_f32 v249, v197, s24, v201
    v_mfma_f32_16x16x32_bf16 v[152:155], a[236:239], v[232:235], 0
    ds_read_b128 v[232:235], v253 offset:7552
    v_fmac_f32 v201, -4.0, v197
    v_mfma_f32_16x16x32_bf16 v[152:155], a[248:251], v[236:239], v[152:155]
    v_fma_f32 v197, v195, s24, v199
    v_fmac_f32 v199, -4.0, v195
    v_mfma_f32_16x16x32_bf16 v[132:135], a[252:255], v[236:239], v[132:135]
    buffer_load_dwordx2 v[222:223], v227, s[4:7], s19 offen offset:512
    v_fma_f32 v195, v199, s26, v201
    v_mfma_f32_16x16x32_bf16 v[136:139], v[240:243], v[236:239], v[136:139]
    v_fmac_f32 v201, s27, v199
    v_fma_f32 v199, v197, 2.0, v249
    v_mfma_f32_16x16x32_bf16 v[140:143], v[244:247], v[236:239], v[140:143]
    v_fmac_f32 v249, -2.0, v197
    v_cvt_pk_bf16_f32 v195, v248, v195
    v_mfma_f32_16x16x32_bf16 v[156:159], a[228:231], v[236:239], 0
    s_waitcnt lgkmcnt(1)
    v_cvt_pk_bf16_f32 v201, v251, v201
    v_cvt_pk_bf16_f32 v199, v250, v199
    v_mfma_f32_16x16x32_bf16 v[156:159], a[240:243], v[228:231], v[156:159]
    v_cvt_pk_bf16_f32 v197, v252, v249
    v_lshrrev_b32 v252, 15, v255
    v_mfma_f32_16x16x32_bf16 v[160:163], a[244:247], v[228:231], 0
    buffer_load_dwordx2 v[224:225], v227, s[4:7], s20 offen offset:512
    v_mfma_f32_16x16x32_bf16 v[160:163], a[232:235], v[236:239], v[160:163]
    ds_write_b64 v252, v[194:195] offset:8320
    v_mfma_f32_16x16x32_bf16 v[164:167], a[236:239], v[236:239], 0
    ds_read_b128 v[236:239], v253 offset:7296
    v_lshrrev_b32 v194, 15, v255
    v_mfma_f32_16x16x32_bf16 v[164:167], a[248:251], v[228:231], v[164:167]
    ds_write_b64 v194, v[200:201] offset:10400
    v_mfma_f32_16x16x32_bf16 v[144:147], a[252:255], v[228:231], v[144:147]
    s_waitcnt vmcnt(14)
    v_lshlrev_b32 v248, 16, v206
    v_lshlrev_b32 v249, 16, v208
    v_mfma_f32_16x16x32_bf16 v[148:151], v[240:243], v[228:231], v[148:151]
    buffer_load_dwordx2 v[226:227], v227, s[4:7], s21 offen offset:512
    v_mfma_f32_16x16x32_bf16 v[152:155], v[244:247], v[228:231], v[152:155]
    ds_write_b64 v194, v[198:199] offset:12480
    v_mfma_f32_16x16x32_bf16 v[168:171], a[228:231], v[228:231], 0
    s_waitcnt lgkmcnt(4)
    v_lshlrev_b32 v250, 16, v210
    v_lshlrev_b32 v251, 16, v212
    v_mfma_f32_16x16x32_bf16 v[168:171], a[240:243], v[232:235], v[168:171]
    ds_write_b64 v194, v[192:193] offset:14560
    v_mfma_f32_16x16x32_bf16 v[172:175], a[244:247], v[232:235], 0
    v_and_b32 v206, s22, v206
    v_and_b32 v208, s22, v208
    v_mfma_f32_16x16x32_bf16 v[172:175], a[232:235], v[228:231], v[172:175]
    ds_write_b64 v194, v[202:203] offset:37440
    v_mfma_f32_16x16x32_bf16 v[176:179], a[236:239], v[228:231], 0
    ds_read_b128 v[228:231], v253 offset:7024
    v_and_b32 v210, s22, v210
    v_mfma_f32_16x16x32_bf16 v[176:179], a[248:251], v[232:235], v[176:179]
    s_mov_b32 s42, 184320
    v_and_b32 v212, s22, v212
    v_lshlrev_b32 v252, 16, v204
    v_mfma_f32_16x16x32_bf16 v[156:159], a[252:255], v[232:235], v[156:159]
    ds_write_b64 v194, v[196:197] offset:31200
    v_mfma_f32_16x16x32_bf16 v[160:163], v[240:243], v[232:235], v[160:163]
    v_and_b32 v204, s22, v204
    v_fmac_f32 v252, s25, v251
    v_mfma_f32_16x16x32_bf16 v[164:167], v[244:247], v[232:235], v[164:167]
    s_waitcnt lgkmcnt(6)
    v_fmac_f32 v204, s25, v212
    v_fmac_f32 v252, s28, v249
    v_mfma_f32_16x16x32_bf16 v[180:183], a[228:231], v[232:235], 0
    buffer_load_dwordx4 a[228:231], v254, s[8:11], s42 offen offset:0 sc1
    v_mfma_f32_16x16x32_bf16 v[184:187], a[232:235], v[232:235], 0
    s_waitcnt lgkmcnt(0)
    v_fmac_f32 v204, s28, v208
    v_cvt_pk_bf16_f32 v204, v252, v204
    v_mfma_f32_16x16x32_bf16 v[188:191], a[236:239], v[232:235], 0
    s_barrier
    v_mfma_f32_16x16x32_bf16 v[180:183], a[240:243], v[236:239], v[180:183]
    ds_read_b128 v[232:235], v253 offset:9360
    v_lshlrev_b32 v252, 16, v214
    v_and_b32 v214, s22, v214
    v_mfma_f32_16x16x32_bf16 v[184:187], a[244:247], v[236:239], v[184:187]
    buffer_load_dwordx4 a[232:235], v254, s[8:11], s42 offen offset:1024 sc1
    v_mfma_f32_16x16x32_bf16 v[188:191], a[248:251], v[236:239], v[188:191]
    v_fmac_f32 v252, s29, v248
    v_fmac_f32 v214, s29, v206
    v_mfma_f32_16x16x32_bf16 v[168:171], a[252:255], v[236:239], v[168:171]
    v_fmac_f32 v252, s23, v250
    v_fmac_f32 v214, s23, v210
    v_mfma_f32_16x16x32_bf16 v[172:175], v[240:243], v[236:239], v[172:175]
    buffer_load_dwordx4 a[236:239], v254, s[8:11], s42 offen offset:2048 sc1
    v_mfma_f32_16x16x32_bf16 v[176:179], v[244:247], v[236:239], v[176:179]
    ds_read_b128 v[236:239], v253 offset:9088
    v_cvt_pk_bf16_f32 v214, v252, v214
    v_mfma_f32_16x16x32_bf16 v[180:183], a[252:255], v[228:231], v[180:183]
    s_mov_b32 s42, 187392
    v_fma_f32 v252, v249, s24, v251
    v_fmac_f32 v251, -4.0, v249
    v_mfma_f32_16x16x32_bf16 v[184:187], v[240:243], v[228:231], v[184:187]
    s_waitcnt vmcnt(15) lgkmcnt(1)
    v_fma_f32 v249, v248, s24, v250
    v_fmac_f32 v250, -4.0, v248
    v_mfma_f32_16x16x32_bf16 v[188:191], v[244:247], v[228:231], v[188:191]
    ds_read_b128 v[228:231], v253 offset:8832
    v_fma_f32 v248, v250, s26, v251
sub4:
    v_mfma_f32_16x16x32_bf16 a[0:3], a[192:195], v[232:235], a[0:3]
    buffer_load_dwordx4 a[240:243], v254, s[8:11], s42 offen offset:0 sc1
    v_mfma_f32_16x16x32_bf16 a[4:7], a[196:199], v[232:235], a[4:7]
    s_waitcnt vmcnt(13) lgkmcnt(1)
    v_fmac_f32 v251, s27, v250
    v_fma_f32 v250, v249, 2.0, v252
    v_mfma_f32_16x16x32_bf16 a[8:11], a[200:203], v[232:235], a[8:11]
    ds_read_b128 v[232:235], v253 offset:8576
    v_fmac_f32 v252, -2.0, v249
    v_mfma_f32_16x16x32_bf16 a[0:3], a[204:207], v[236:239], a[0:3]
    v_fma_f32 v249, v208, s24, v212
    v_fmac_f32 v212, -4.0, v208
    v_mfma_f32_16x16x32_bf16 a[4:7], a[208:211], v[236:239], a[4:7]
    buffer_load_dwordx4 a[244:247], v254, s[8:11], s42 offen offset:1024 sc1
    v_mfma_f32_16x16x32_bf16 a[8:11], a[212:215], v[236:239], a[8:11]
    v_fma_f32 v208, v206, s24, v210
    v_fmac_f32 v210, -4.0, v206
    v_mfma_f32_16x16x32_bf16 a[12:15], a[192:195], v[236:239], a[12:15]
    s_waitcnt lgkmcnt(1)
    v_fma_f32 v206, v210, s26, v212
    v_fmac_f32 v212, s27, v210
    v_mfma_f32_16x16x32_bf16 a[12:15], a[204:207], v[228:231], a[12:15]
    v_fma_f32 v210, v208, 2.0, v249
    v_fmac_f32 v249, -2.0, v208
    v_mfma_f32_16x16x32_bf16 a[16:19], a[208:211], v[228:231], a[16:19]
    buffer_load_dwordx4 a[248:251], v254, s[8:11], s42 offen offset:2048 sc1
    v_mfma_f32_16x16x32_bf16 a[16:19], a[196:199], v[236:239], a[16:19]
    s_mov_b32 s42, 190464
    v_cvt_pk_bf16_f32 v206, v248, v206
    v_cvt_pk_bf16_f32 v212, v251, v212
    v_mfma_f32_16x16x32_bf16 a[20:23], a[200:203], v[236:239], a[20:23]
    ds_read_b128 v[236:239], v253 offset:8320
    v_cvt_pk_bf16_f32 v210, v250, v210
    v_mfma_f32_16x16x32_bf16 a[20:23], a[212:215], v[228:231], a[20:23]
    s_waitcnt vmcnt(12)
    v_cvt_pk_bf16_f32 v208, v252, v249
    v_lshlrev_b32 v248, 16, v207
    v_mfma_f32_16x16x32_bf16 a[0:3], a[216:219], v[228:231], a[0:3]
    buffer_load_dwordx4 a[252:255], v254, s[8:11], s42 offen offset:0 sc1
    v_mfma_f32_16x16x32_bf16 a[4:7], a[220:223], v[228:231], a[4:7]
    v_lshlrev_b32 v249, 16, v209
    v_lshlrev_b32 v250, 16, v211
    v_mfma_f32_16x16x32_bf16 a[8:11], a[224:227], v[228:231], a[8:11]
    v_lshlrev_b32 v251, 16, v213
    v_and_b32 v207, s22, v207
    v_mfma_f32_16x16x32_bf16 a[24:27], a[192:195], v[228:231], a[24:27]
    s_waitcnt lgkmcnt(1)
    v_and_b32 v209, s22, v209
    v_and_b32 v211, s22, v211
    v_mfma_f32_16x16x32_bf16 a[24:27], a[204:207], v[232:235], a[24:27]
    buffer_load_dwordx4 v[240:243], v254, s[8:11], s42 offen offset:1024 sc1
    v_mfma_f32_16x16x32_bf16 a[28:31], a[208:211], v[232:235], a[28:31]
    v_and_b32 v213, s22, v213
    v_lshlrev_b32 v252, 16, v205
    v_mfma_f32_16x16x32_bf16 a[28:31], a[196:199], v[228:231], a[28:31]
    v_and_b32 v205, s22, v205
    v_fmac_f32 v252, s25, v251
    v_mfma_f32_16x16x32_bf16 a[32:35], a[200:203], v[228:231], a[32:35]
    ds_read_b128 v[228:231], v253 offset:10144
    v_fmac_f32 v205, s25, v213
    v_mfma_f32_16x16x32_bf16 a[32:35], a[212:215], v[232:235], a[32:35]
    buffer_load_dwordx4 v[244:247], v254, s[8:11], s42 offen offset:2048 sc1
    v_mfma_f32_16x16x32_bf16 a[12:15], a[216:219], v[232:235], a[12:15]
    v_fmac_f32 v252, s28, v249
    v_fmac_f32 v205, s28, v209
    v_mfma_f32_16x16x32_bf16 a[16:19], a[220:223], v[232:235], a[16:19]
    v_and_b32 v203, 0x7fff, v255
    v_cvt_pk_bf16_f32 v205, v252, v205
    v_mfma_f32_16x16x32_bf16 a[20:23], a[224:227], v[232:235], a[20:23]
    buffer_load_dwordx2 v[192:193], v203, s[4:7], s16 offen offset:896
    v_mfma_f32_16x16x32_bf16 a[36:39], a[192:195], v[232:235], a[36:39]
    s_waitcnt lgkmcnt(1)
    v_lshlrev_b32 v252, 16, v215
    v_and_b32 v215, s22, v215
    v_mfma_f32_16x16x32_bf16 a[36:39], a[204:207], v[236:239], a[36:39]
    v_fmac_f32 v252, s29, v248
    v_fmac_f32 v215, s29, v207
    v_mfma_f32_16x16x32_bf16 a[40:43], a[208:211], v[236:239], a[40:43]
    v_fmac_f32 v252, s23, v250
    v_fmac_f32 v215, s23, v211
    v_mfma_f32_16x16x32_bf16 a[40:43], a[196:199], v[232:235], a[40:43]
    v_cvt_pk_bf16_f32 v215, v252, v215
    v_fma_f32 v252, v249, s24, v251
    v_mfma_f32_16x16x32_bf16 a[44:47], a[200:203], v[232:235], a[44:47]
    ds_read_b128 v[232:235], v253 offset:9888
    v_fmac_f32 v251, -4.0, v249
    v_mfma_f32_16x16x32_bf16 a[44:47], a[212:215], v[236:239], a[44:47]
    buffer_load_dwordx2 v[194:195], v203, s[4:7], s17 offen offset:896
    v_mfma_f32_16x16x32_bf16 a[24:27], a[216:219], v[236:239], a[24:27]
    v_fma_f32 v249, v248, s24, v250
    v_fmac_f32 v250, -4.0, v248
    v_mfma_f32_16x16x32_bf16 a[28:31], a[220:223], v[236:239], a[28:31]
    v_fma_f32 v248, v250, s26, v251
    v_fmac_f32 v251, s27, v250
    v_fma_f32 v250, v249, 2.0, v252
    v_mfma_f32_16x16x32_bf16 a[32:35], a[224:227], v[236:239], a[32:35]
    v_fmac_f32 v252, -2.0, v249
    v_fma_f32 v249, v209, s24, v213
    v_mfma_f32_16x16x32_bf16 a[48:51], a[192:195], v[236:239], a[48:51]
    s_waitcnt lgkmcnt(1)
    v_fmac_f32 v213, -4.0, v209
    v_fma_f32 v209, v207, s24, v211
    v_mfma_f32_16x16x32_bf16 a[48:51], a[204:207], v[228:231], a[48:51]
    buffer_load_dwordx2 v[196:197], v203, s[4:7], s18 offen offset:896
    v_mfma_f32_16x16x32_bf16 a[52:55], a[208:211], v[228:231], a[52:55]
    v_fmac_f32 v211, -4.0, v207
    v_fma_f32 v207, v211, s26, v213
    v_mfma_f32_16x16x32_bf16 a[52:55], a[196:199], v[236:239], a[52:55]
    v_fmac_f32 v213, s27, v211
    v_fma_f32 v211, v209, 2.0, v249
    v_mfma_f32_16x16x32_bf16 a[56:59], a[200:203], v[236:239], a[56:59]
    ds_read_b128 v[236:239], v253 offset:9632
    v_fmac_f32 v249, -2.0, v209
    v_mfma_f32_16x16x32_bf16 a[56:59], a[212:215], v[228:231], a[56:59]
    v_cvt_pk_bf16_f32 v207, v248, v207
    v_cvt_pk_bf16_f32 v213, v251, v213
    v_mfma_f32_16x16x32_bf16 a[36:39], a[216:219], v[228:231], a[36:39]
    buffer_load_dwordx2 v[198:199], v203, s[4:7], s19 offen offset:896
    v_mfma_f32_16x16x32_bf16 a[40:43], a[220:223], v[228:231], a[40:43]
    v_cvt_pk_bf16_f32 v211, v250, v211
    v_cvt_pk_bf16_f32 v209, v252, v249
    v_mfma_f32_16x16x32_bf16 a[44:47], a[224:227], v[228:231], a[44:47]
    v_lshrrev_b32 v252, 15, v255
    v_mfma_f32_16x16x32_bf16 a[60:63], a[192:195], v[228:231], a[60:63]
    s_waitcnt lgkmcnt(1)
    v_mfma_f32_16x16x32_bf16 a[60:63], a[204:207], v[232:235], a[60:63]
    ds_write_b64 v252, v[206:207] offset:768
    v_mfma_f32_16x16x32_bf16 a[64:67], a[208:211], v[232:235], a[64:67]
    buffer_load_dwordx2 v[200:201], v203, s[4:7], s20 offen offset:896
    v_mfma_f32_16x16x32_bf16 a[64:67], a[196:199], v[228:231], a[64:67]
    v_lshrrev_b32 v206, 15, v255
    v_mfma_f32_16x16x32_bf16 a[68:71], a[200:203], v[228:231], a[68:71]
    ds_read_b128 v[228:231], v253 offset:9376
    s_waitcnt vmcnt(14)
    v_mfma_f32_16x16x32_bf16 a[68:71], a[212:215], v[232:235], a[68:71]
    ds_write_b64 v206, v[212:213] offset:2848
    v_mfma_f32_16x16x32_bf16 a[48:51], a[216:219], v[232:235], a[48:51]
    v_lshlrev_b32 v248, 16, v218
    v_lshlrev_b32 v249, 16, v220
    v_mfma_f32_16x16x32_bf16 a[52:55], a[220:223], v[232:235], a[52:55]
    buffer_load_dwordx2 v[202:203], v203, s[4:7], s21 offen offset:896
    v_mfma_f32_16x16x32_bf16 a[56:59], a[224:227], v[232:235], a[56:59]
    ds_write_b64 v206, v[210:211] offset:4928
    v_mfma_f32_16x16x32_bf16 a[72:75], a[192:195], v[232:235], a[72:75]
    s_waitcnt lgkmcnt(4)
    v_lshlrev_b32 v250, 16, v222
    v_lshlrev_b32 v251, 16, v224
    v_mfma_f32_16x16x32_bf16 a[72:75], a[204:207], v[236:239], a[72:75]
    ds_write_b64 v206, v[204:205] offset:17408
    v_mfma_f32_16x16x32_bf16 a[76:79], a[208:211], v[236:239], a[76:79]
    v_and_b32 v218, s22, v218
    v_and_b32 v220, s22, v220
    v_mfma_f32_16x16x32_bf16 a[76:79], a[196:199], v[232:235], a[76:79]
    ds_write_b64 v206, v[214:215] offset:25728
    v_mfma_f32_16x16x32_bf16 a[80:83], a[200:203], v[232:235], a[80:83]
    ds_read_b128 v[232:235], v253 offset:9104
    v_and_b32 v222, s22, v222
    v_mfma_f32_16x16x32_bf16 a[80:83], a[212:215], v[236:239], a[80:83]
    s_mov_b32 s42, 221184
    v_and_b32 v224, s22, v224
    v_lshlrev_b32 v252, 16, v216
    v_mfma_f32_16x16x32_bf16 a[60:63], a[216:219], v[236:239], a[60:63]
    ds_write_b64 v206, v[208:209] offset:7008
    v_mfma_f32_16x16x32_bf16 a[64:67], a[220:223], v[236:239], a[64:67]
    v_and_b32 v216, s22, v216
    v_fmac_f32 v252, s25, v251
    v_mfma_f32_16x16x32_bf16 a[68:71], a[224:227], v[236:239], a[68:71]
    v_fmac_f32 v216, s25, v224
    v_fmac_f32 v252, s28, v249
    v_mfma_f32_16x16x32_bf16 a[84:87], a[192:195], v[236:239], a[84:87]
    buffer_load_dwordx4 a[192:195], v254, s[8:11], s42 offen offset:0 sc1
    v_mfma_f32_16x16x32_bf16 a[88:91], a[196:199], v[236:239], a[88:91]
    v_fmac_f32 v216, s28, v220
    v_cvt_pk_bf16_f32 v216, v252, v216
    v_mfma_f32_16x16x32_bf16 a[92:95], a[200:203], v[236:239], a[92:95]
    s_waitcnt lgkmcnt(6)
    v_lshlrev_b32 v252, 16, v226
    v_and_b32 v226, s22, v226
    v_mfma_f32_16x16x32_bf16 a[84:87], a[204:207], v[228:231], a[84:87]
    ds_read_b128 v[236:239], v253 offset:11440
    v_fmac_f32 v252, s29, v248
    v_mfma_f32_16x16x32_bf16 a[88:91], a[208:211], v[228:231], a[88:91]
    buffer_load_dwordx4 a[196:199], v254, s[8:11], s42 offen offset:1024 sc1
    v_mfma_f32_16x16x32_bf16 a[92:95], a[212:215], v[228:231], a[92:95]
    v_fmac_f32 v226, s29, v218
    v_fmac_f32 v252, s23, v250
    v_mfma_f32_16x16x32_bf16 a[72:75], a[216:219], v[228:231], a[72:75]
    s_waitcnt lgkmcnt(2)
    v_fmac_f32 v226, s23, v222
    v_cvt_pk_bf16_f32 v226, v252, v226
    v_mfma_f32_16x16x32_bf16 a[76:79], a[220:223], v[228:231], a[76:79]
    buffer_load_dwordx4 a[200:203], v254, s[8:11], s42 offen offset:2048 sc1
    v_mfma_f32_16x16x32_bf16 a[80:83], a[224:227], v[228:231], a[80:83]
    ds_read_b128 v[228:231], v253 offset:11168
    v_fma_f32 v252, v249, s24, v251
    v_mfma_f32_16x16x32_bf16 a[84:87], a[216:219], v[232:235], a[84:87]
    s_mov_b32 s42, 224256
    v_fmac_f32 v251, -4.0, v249
    v_fma_f32 v249, v248, s24, v250
    v_mfma_f32_16x16x32_bf16 a[88:91], a[220:223], v[232:235], a[88:91]
    s_waitcnt vmcnt(15) lgkmcnt(1)
    v_fmac_f32 v250, -4.0, v248
    v_fma_f32 v248, v250, s26, v251
    v_mfma_f32_16x16x32_bf16 a[92:95], a[224:227], v[232:235], a[92:95]
    ds_read_b128 v[232:235], v253 offset:10912
    v_fmac_f32 v251, s27, v250
    v_fma_f32 v250, v249, 2.0, v252
sub5:
    v_mfma_f32_16x16x32_bf16 a[96:99], a[228:231], v[236:239], a[96:99]
    buffer_load_dwordx4 a[204:207], v254, s[8:11], s42 offen offset:0 sc1
    v_mfma_f32_16x16x32_bf16 a[100:103], a[232:235], v[236:239], a[100:103]
    s_waitcnt vmcnt(13) lgkmcnt(1)
    v_fmac_f32 v252, -2.0, v249
    v_fma_f32 v249, v220, s24, v224
    v_mfma_f32_16x16x32_bf16 a[104:107], a[236:239], v[236:239], a[104:107]
    ds_read_b128 v[236:239], v253 offset:10656
    v_fmac_f32 v224, -4.0, v220
    v_mfma_f32_16x16x32_bf16 a[96:99], a[240:243], v[228:231], a[96:99]
    v_fma_f32 v220, v218, s24, v222
    v_fmac_f32 v222, -4.0, v218
    v_mfma_f32_16x16x32_bf16 a[100:103], a[244:247], v[228:231], a[100:103]
    buffer_load_dwordx4 a[208:211], v254, s[8:11], s42 offen offset:1024 sc1
    v_mfma_f32_16x16x32_bf16 a[104:107], a[248:251], v[228:231], a[104:107]
    v_fma_f32 v218, v222, s26, v224
    v_fmac_f32 v224, s27, v222
    v_mfma_f32_16x16x32_bf16 a[108:111], a[228:231], v[228:231], a[108:111]
    s_waitcnt lgkmcnt(1)
    v_fma_f32 v222, v220, 2.0, v249
    v_fmac_f32 v249, -2.0, v220
    v_mfma_f32_16x16x32_bf16 a[108:111], a[240:243], v[232:235], a[108:111]
    v_cvt_pk_bf16_f32 v218, v248, v218
    v_cvt_pk_bf16_f32 v224, v251, v224
    v_mfma_f32_16x16x32_bf16 a[112:115], a[244:247], v[232:235], a[112:115]
    buffer_load_dwordx4 a[212:215], v254, s[8:11], s42 offen offset:2048 sc1
    v_mfma_f32_16x16x32_bf16 a[112:115], a[232:235], v[228:231], a[112:115]
    s_mov_b32 s42, 227328
    v_cvt_pk_bf16_f32 v222, v250, v222
    v_cvt_pk_bf16_f32 v220, v252, v249
    v_mfma_f32_16x16x32_bf16 a[116:119], a[236:239], v[228:231], a[116:119]
    ds_read_b128 v[228:231], v253 offset:10400
    v_lshlrev_b32 v248, 16, v219
    v_mfma_f32_16x16x32_bf16 a[116:119], a[248:251], v[232:235], a[116:119]
    s_waitcnt vmcnt(12)
    v_lshlrev_b32 v249, 16, v221
    v_lshlrev_b32 v250, 16, v223
    v_mfma_f32_16x16x32_bf16 a[96:99], a[252:255], v[232:235], a[96:99]
    buffer_load_dwordx4 a[216:219], v254, s[8:11], s42 offen offset:0 sc1
    v_mfma_f32_16x16x32_bf16 a[100:103], v[240:243], v[232:235], a[100:103]
    v_lshlrev_b32 v251, 16, v225
    v_and_b32 v219, s22, v219
    v_mfma_f32_16x16x32_bf16 a[104:107], v[244:247], v[232:235], a[104:107]
    v_and_b32 v221, s22, v221
    v_and_b32 v223, s22, v223
    v_mfma_f32_16x16x32_bf16 a[120:123], a[228:231], v[232:235], a[120:123]
    s_waitcnt lgkmcnt(1)
    v_and_b32 v225, s22, v225
    v_lshlrev_b32 v252, 16, v217
    v_mfma_f32_16x16x32_bf16 a[120:123], a[240:243], v[236:239], a[120:123]
    buffer_load_dwordx4 a[220:223], v254, s[8:11], s42 offen offset:1024 sc1
    v_mfma_f32_16x16x32_bf16 a[124:127], a[244:247], v[236:239], a[124:127]
    v_and_b32 v217, s22, v217
    v_fmac_f32 v252, s25, v251
    v_mfma_f32_16x16x32_bf16 a[124:127], a[232:235], v[232:235], a[124:127]
    v_fmac_f32 v217, s25, v225
    v_fmac_f32 v252, s28, v249
    v_mfma_f32_16x16x32_bf16 a[128:131], a[236:239], v[232:235], a[128:131]
    ds_read_b128 v[232:235], v253 offset:12224
    v_fmac_f32 v217, s28, v221
    v_mfma_f32_16x16x32_bf16 a[128:131], a[248:251], v[236:239], a[128:131]
    buffer_load_dwordx4 a[224:227], v254, s[8:11], s42 offen offset:2048 sc1
    v_mfma_f32_16x16x32_bf16 a[108:111], a[252:255], v[236:239], a[108:111]
    v_cvt_pk_bf16_f32 v217, v252, v217
    v_lshlrev_b32 v252, 16, v227
    v_mfma_f32_16x16x32_bf16 a[112:115], v[240:243], v[236:239], a[112:115]
    v_and_b32 v215, 0x7fff, v255
    v_and_b32 v227, s22, v227
    v_mfma_f32_16x16x32_bf16 a[116:119], v[244:247], v[236:239], a[116:119]
    buffer_load_dwordx2 v[204:205], v215, s[4:7], s16 offen offset:1280
    v_mfma_f32_16x16x32_bf16 a[132:135], a[228:231], v[236:239], a[132:135]
    s_waitcnt lgkmcnt(1)
    v_fmac_f32 v252, s29, v248
    v_fmac_f32 v227, s29, v219
    v_mfma_f32_16x16x32_bf16 a[132:135], a[240:243], v[228:231], a[132:135]
    v_fmac_f32 v252, s23, v250
    v_fmac_f32 v227, s23, v223
    v_mfma_f32_16x16x32_bf16 a[136:139], a[244:247], v[228:231], a[136:139]
    v_cvt_pk_bf16_f32 v227, v252, v227
    v_fma_f32 v252, v249, s24, v251
    v_mfma_f32_16x16x32_bf16 a[136:139], a[232:235], v[236:239], a[136:139]
    v_fmac_f32 v251, -4.0, v249
    v_fma_f32 v249, v248, s24, v250
    v_mfma_f32_16x16x32_bf16 a[140:143], a[236:239], v[236:239], a[140:143]
    ds_read_b128 v[236:239], v253 offset:11968
    v_fmac_f32 v250, -4.0, v248
    v_mfma_f32_16x16x32_bf16 a[140:143], a[248:251], v[228:231], a[140:143]
    buffer_load_dwordx2 v[206:207], v215, s[4:7], s17 offen offset:1280
    v_mfma_f32_16x16x32_bf16 a[120:123], a[252:255], v[228:231], a[120:123]
    v_fma_f32 v248, v250, s26, v251
    v_fmac_f32 v251, s27, v250
    v_mfma_f32_16x16x32_bf16 a[124:127], v[240:243], v[228:231], a[124:127]
    v_fma_f32 v250, v249, 2.0, v252
    v_fmac_f32 v252, -2.0, v249
    v_mfma_f32_16x16x32_bf16 a[128:131], v[244:247], v[228:231], a[128:131]
    v_fma_f32 v249, v221, s24, v225
    v_fmac_f32 v225, -4.0, v221
    v_mfma_f32_16x16x32_bf16 a[144:147], a[228:231], v[228:231], a[144:147]
    s_waitcnt lgkmcnt(1)
    v_fma_f32 v221, v219, s24, v223
    v_fmac_f32 v223, -4.0, v219
    v_mfma_f32_16x16x32_bf16 a[144:147], a[240:243], v[232:235], a[144:147]
    buffer_load_dwordx2 v[208:209], v215, s[4:7], s18 offen offset:1280
    v_mfma_f32_16x16x32_bf16 a[148:151], a[244:247], v[232:235], a[148:151]
    v_fma_f32 v219, v223, s26, v225
    v_fmac_f32 v225, s27, v223
    v_mfma_f32_16x16x32_bf16 a[148:151], a[232:235], v[228:231], a[148:151]
    v_fma_f32 v223, v221, 2.0, v249
    v_fmac_f32 v249, -2.0, v221
    v_mfma_f32_16x16x32_bf16 a[152:155], a[236:239], v[228:231], a[152:155]
    ds_read_b128 v[228:231], v253 offset:11712
    v_cvt_pk_bf16_f32 v219, v248, v219
    v_mfma_f32_16x16x32_bf16 a[152:155], a[248:251], v[232:235], a[152:155]
    v_cvt_pk_bf16_f32 v225, v251, v225
    v_cvt_pk_bf16_f32 v223, v250, v223
    v_mfma_f32_16x16x32_bf16 a[132:135], a[252:255], v[232:235], a[132:135]
    buffer_load_dwordx2 v[210:211], v215, s[4:7], s19 offen offset:1280
    v_cvt_pk_bf16_f32 v221, v252, v249
    v_mfma_f32_16x16x32_bf16 a[136:139], v[240:243], v[232:235], a[136:139]
    v_lshrrev_b32 v252, 15, v255
    v_mfma_f32_16x16x32_bf16 a[140:143], v[244:247], v[232:235], a[140:143]
    ds_write_b64 v252, v[218:219] offset:512
    v_mfma_f32_16x16x32_bf16 a[156:159], a[228:231], v[232:235], a[156:159]
    s_waitcnt lgkmcnt(2)
    v_lshrrev_b32 v218, 15, v255
    v_mfma_f32_16x16x32_bf16 a[156:159], a[240:243], v[236:239], a[156:159]
    ds_write_b64 v218, v[224:225] offset:2592
    v_mfma_f32_16x16x32_bf16 a[160:163], a[244:247], v[236:239], a[160:163]
    buffer_load_dwordx2 v[212:213], v215, s[4:7], s20 offen offset:1280
    v_mfma_f32_16x16x32_bf16 a[160:163], a[232:235], v[232:235], a[160:163]
    ds_write_b64 v218, v[222:223] offset:4672
    v_mfma_f32_16x16x32_bf16 a[164:167], a[236:239], v[232:235], a[164:167]
    ds_read_b128 v[232:235], v253 offset:11456
    s_waitcnt vmcnt(14)
    v_mfma_f32_16x16x32_bf16 a[164:167], a[248:251], v[236:239], a[164:167]
    ds_write_b64 v218, v[216:217] offset:17152
    v_mfma_f32_16x16x32_bf16 a[144:147], a[252:255], v[236:239], a[144:147]
    v_lshlrev_b32 v248, 16, v194
    v_lshlrev_b32 v249, 16, v196
    v_mfma_f32_16x16x32_bf16 a[148:151], v[240:243], v[236:239], a[148:151]
    buffer_load_dwordx2 v[214:215], v215, s[4:7], s21 offen offset:1280
    v_mfma_f32_16x16x32_bf16 a[152:155], v[244:247], v[236:239], a[152:155]
    ds_write_b64 v218, v[226:227] offset:25472
    v_mfma_f32_16x16x32_bf16 a[168:171], a[228:231], v[236:239], a[168:171]
    s_waitcnt lgkmcnt(6)
    v_lshlrev_b32 v250, 16, v198
    v_lshlrev_b32 v251, 16, v200
    v_mfma_f32_16x16x32_bf16 a[168:171], a[240:243], v[228:231], a[168:171]
    ds_write_b64 v218, v[220:221] offset:6752
    v_mfma_f32_16x16x32_bf16 a[172:175], a[244:247], v[228:231], a[172:175]
    ds_read_b128 v[216:219], v253 offset:39904
    s_mov_b32 s45, 405865480
    v_mfma_f32_16x16x32_bf16 a[172:175], a[232:235], v[236:239], a[172:175]
    v_bfe_u32 v220, v254, 5, 3
    v_mul_u32_u24 v221, 5, v220
    v_mfma_f32_16x16x32_bf16 a[176:179], a[236:239], v[236:239], a[176:179]
    ds_read_b128 v[236:239], v253 offset:11184
    v_bfe_u32 v221, s45, v221, 5
    v_mfma_f32_16x16x32_bf16 a[176:179], a[248:251], v[228:231], a[176:179]
pad2:
    s_cbranch_vccnz pad6
    s_mov_b32 s42, 258048
    v_mul_u32_u24 v221, 65, v221
    v_sub_u32 v221, v221, v220
    v_mfma_f32_16x16x32_bf16 a[156:159], a[252:255], v[228:231], a[156:159]
    v_lshl_add_u32 v220, v221, 5, v253
    s_waitcnt lgkmcnt(1)
    v_mfma_f32_16x16x32_bf16 a[160:163], v[240:243], v[228:231], a[160:163]
    s_mov_b64 exec, s[46:47]
    ds_write_b128 v220, v[216:219] offset:1024
    s_mov_b64 exec, -1
    v_mfma_f32_16x16x32_bf16 a[164:167], v[244:247], v[228:231], a[164:167]
    v_and_b32 v194, s22, v194
    v_and_b32 v196, s22, v196
    v_mfma_f32_16x16x32_bf16 a[180:183], a[228:231], v[228:231], a[180:183]
    buffer_load_dwordx4 a[228:231], v254, s[8:11], s42 offen offset:0 sc1
    v_mfma_f32_16x16x32_bf16 a[184:187], a[232:235], v[228:231], a[184:187]
    v_and_b32 v198, s22, v198
    v_and_b32 v200, s22, v200
    v_mfma_f32_16x16x32_bf16 a[188:191], a[236:239], v[228:231], a[188:191]
    v_lshlrev_b32 v252, 16, v192
    v_and_b32 v192, s22, v192
    v_mfma_f32_16x16x32_bf16 a[180:183], a[240:243], v[232:235], a[180:183]
    ds_read_b128 v[228:231], v253 offset:13520
    v_fmac_f32 v252, s25, v251
    v_mfma_f32_16x16x32_bf16 a[184:187], a[244:247], v[232:235], a[184:187]
    buffer_load_dwordx4 a[232:235], v254, s[8:11], s42 offen offset:1024 sc1
    v_mfma_f32_16x16x32_bf16 a[188:191], a[248:251], v[232:235], a[188:191]
    v_fmac_f32 v192, s25, v200
    v_fmac_f32 v252, s28, v249
    v_mfma_f32_16x16x32_bf16 a[168:171], a[252:255], v[232:235], a[168:171]
    s_waitcnt lgkmcnt(2)
    v_fmac_f32 v192, s28, v196
    v_cvt_pk_bf16_f32 v192, v252, v192
    v_mfma_f32_16x16x32_bf16 a[172:175], v[240:243], v[232:235], a[172:175]
    buffer_load_dwordx4 a[236:239], v254, s[8:11], s42 offen offset:2048 sc1
    v_mfma_f32_16x16x32_bf16 a[176:179], v[244:247], v[232:235], a[176:179]
    ds_read_b128 v[232:235], v253 offset:13248
    v_lshlrev_b32 v252, 16, v202
    v_mfma_f32_16x16x32_bf16 a[180:183], a[252:255], v[236:239], a[180:183]
    s_mov_b32 s42, 261120
    v_and_b32 v202, s22, v202
    v_fmac_f32 v252, s29, v248
    v_mfma_f32_16x16x32_bf16 a[184:187], v[240:243], v[236:239], a[184:187]
    s_waitcnt vmcnt(15) lgkmcnt(1)
    v_fmac_f32 v202, s29, v194
    v_fmac_f32 v252, s23, v250
    v_mfma_f32_16x16x32_bf16 a[188:191], v[244:247], v[236:239], a[188:191]
    ds_read_b128 v[236:239], v253 offset:12992
    v_fmac_f32 v202, s23, v198
sub6:
    v_mfma_f32_16x16x32_bf16 v[0:3], a[192:195], v[228:231], v[0:3]
    buffer_load_dwordx4 a[240:243], v254, s[8:11], s42 offen offset:0 sc1
    v_mfma_f32_16x16x32_bf16 v[4:7], a[196:199], v[228:231], v[4:7]
    s_waitcnt vmcnt(13) lgkmcnt(1)
    v_cvt_pk_bf16_f32 v202, v252, v202
    v_fma_f32 v252, v249, s24, v251
    v_mfma_f32_16x16x32_bf16 v[8:11], a[200:203], v[228:231], v[8:11]
    ds_read_b128 v[228:231], v253 offset:12736
    v_fmac_f32 v251, -4.0, v249
    v_mfma_f32_16x16x32_bf16 v[0:3], a[204:207], v[232:235], v[0:3]
    v_fma_f32 v249, v248, s24, v250
    v_fmac_f32 v250, -4.0, v248
    v_mfma_f32_16x16x32_bf16 v[4:7], a[208:211], v[232:235], v[4:7]
    buffer_load_dwordx4 a[244:247], v254, s[8:11], s42 offen offset:1024 sc1
    v_mfma_f32_16x16x32_bf16 v[8:11], a[212:215], v[232:235], v[8:11]
    v_fma_f32 v248, v250, s26, v251
    v_fmac_f32 v251, s27, v250
    v_mfma_f32_16x16x32_bf16 v[12:15], a[192:195], v[232:235], v[12:15]
    s_waitcnt lgkmcnt(1)
    v_fma_f32 v250, v249, 2.0, v252
    v_fmac_f32 v252, -2.0, v249
    v_mfma_f32_16x16x32_bf16 v[12:15], a[204:207], v[236:239], v[12:15]
    v_fma_f32 v249, v196, s24, v200
    v_fmac_f32 v200, -4.0, v196
    v_fma_f32 v196, v194, s24, v198
    v_mfma_f32_16x16x32_bf16 v[16:19], a[208:211], v[236:239], v[16:19]
    buffer_load_dwordx4 a[248:251], v254, s[8:11], s42 offen offset:2048 sc1
    v_mfma_f32_16x16x32_bf16 v[16:19], a[196:199], v[232:235], v[16:19]
    s_mov_b32 s42, 264192
    v_fmac_f32 v198, -4.0, v194
    v_fma_f32 v194, v198, s26, v200
    v_mfma_f32_16x16x32_bf16 v[20:23], a[200:203], v[232:235], v[20:23]
    ds_read_b128 v[232:235], v253 offset:12480
    v_fmac_f32 v200, s27, v198
    v_mfma_f32_16x16x32_bf16 v[20:23], a[212:215], v[236:239], v[20:23]
    s_waitcnt vmcnt(12)
    v_fma_f32 v198, v196, 2.0, v249
    v_fmac_f32 v249, -2.0, v196
    v_mfma_f32_16x16x32_bf16 v[0:3], a[216:219], v[236:239], v[0:3]
    buffer_load_dwordx4 a[252:255], v254, s[8:11], s42 offen offset:0 sc1
    v_mfma_f32_16x16x32_bf16 v[4:7], a[220:223], v[236:239], v[4:7]
    v_cvt_pk_bf16_f32 v194, v248, v194
    v_cvt_pk_bf16_f32 v200, v251, v200
    v_mfma_f32_16x16x32_bf16 v[8:11], a[224:227], v[236:239], v[8:11]
    v_cvt_pk_bf16_f32 v198, v250, v198
    v_cvt_pk_bf16_f32 v196, v252, v249
    v_mfma_f32_16x16x32_bf16 v[24:27], a[192:195], v[236:239], v[24:27]
    s_waitcnt lgkmcnt(1)
    v_lshlrev_b32 v248, 16, v195
    v_lshlrev_b32 v249, 16, v197
    v_mfma_f32_16x16x32_bf16 v[24:27], a[204:207], v[228:231], v[24:27]
    buffer_load_dwordx4 v[240:243], v254, s[8:11], s42 offen offset:1024 sc1
    v_mfma_f32_16x16x32_bf16 v[28:31], a[208:211], v[228:231], v[28:31]
    v_lshlrev_b32 v250, 16, v199
    v_lshlrev_b32 v251, 16, v201
    v_mfma_f32_16x16x32_bf16 v[28:31], a[196:199], v[236:239], v[28:31]
    v_and_b32 v195, s22, v195
    v_and_b32 v197, s22, v197
    v_mfma_f32_16x16x32_bf16 v[32:35], a[200:203], v[236:239], v[32:35]
    ds_read_b128 v[236:239], v253 offset:14304
    v_and_b32 v199, s22, v199
    v_mfma_f32_16x16x32_bf16 v[32:35], a[212:215], v[228:231], v[32:35]
    buffer_load_dwordx4 v[244:247], v254, s[8:11], s42 offen offset:2048 sc1
    v_mfma_f32_16x16x32_bf16 v[12:15], a[216:219], v[228:231], v[12:15]
    v_and_b32 v201, s22, v201
    v_lshlrev_b32 v252, 16, v193
    v_mfma_f32_16x16x32_bf16 v[16:19], a[220:223], v[228:231], v[16:19]
    v_and_b32 v227, 0x7fff, v255
    v_and_b32 v193, s22, v193
    v_mfma_f32_16x16x32_bf16 v[20:23], a[224:227], v[228:231], v[20:23]
    buffer_load_dwordx2 v[216:217], v227, s[4:7], s16 offen offset:192
    v_mfma_f32_16x16x32_bf16 v[36:39], a[192:195], v[228:231], v[36:39]
    s_waitcnt lgkmcnt(1)
    v_fmac_f32 v252, s25, v251
    v_fmac_f32 v193, s25, v201
    v_mfma_f32_16x16x32_bf16 v[36:39], a[204:207], v[232:235], v[36:39]
    v_fmac_f32 v252, s28, v249
    v_fmac_f32 v193, s28, v197
    v_mfma_f32_16x16x32_bf16 v[40:43], a[208:211], v[232:235], v[40:43]
    v_cvt_pk_bf16_f32 v193, v252, v193
    v_lshlrev_b32 v252, 16, v203
    v_mfma_f32_16x16x32_bf16 v[40:43], a[196:199], v[228:231], v[40:43]
    v_and_b32 v203, s22, v203
    v_fmac_f32 v252, s29, v248
    v_mfma_f32_16x16x32_bf16 v[44:47], a[200:203], v[228:231], v[44:47]
    ds_read_b128 v[228:231], v253 offset:14048
    v_fmac_f32 v203, s29, v195
    v_mfma_f32_16x16x32_bf16 v[44:47], a[212:215], v[232:235], v[44:47]
    buffer_load_dwordx2 v[218:219], v227, s[4:7], s17 offen offset:192
    v_mfma_f32_16x16x32_bf16 v[24:27], a[216:219], v[232:235], v[24:27]
    v_fmac_f32 v252, s23, v250
    v_fmac_f32 v203, s23, v199
    v_mfma_f32_16x16x32_bf16 v[28:31], a[220:223], v[232:235], v[28:31]
    v_cvt_pk_bf16_f32 v203, v252, v203
    v_fma_f32 v252, v249, s24, v251
    v_mfma_f32_16x16x32_bf16 v[32:35], a[224:227], v[232:235], v[32:35]
    v_fmac_f32 v251, -4.0, v249
    v_fma_f32 v249, v248, s24, v250
    v_mfma_f32_16x16x32_bf16 v[48:51], a[192:195], v[232:235], v[48:51]
    s_waitcnt lgkmcnt(1)
    v_fmac_f32 v250, -4.0, v248
    v_fma_f32 v248, v250, s26, v251
    v_mfma_f32_16x16x32_bf16 v[48:51], a[204:207], v[236:239], v[48:51]
    buffer_load_dwordx2 v[220:221], v227, s[4:7], s18 offen offset:192
    v_mfma_f32_16x16x32_bf16 v[52:55], a[208:211], v[236:239], v[52:55]
    v_fmac_f32 v251, s27, v250
    v_fma_f32 v250, v249, 2.0, v252
    v_mfma_f32_16x16x32_bf16 v[52:55], a[196:199], v[232:235], v[52:55]
    v_fmac_f32 v252, -2.0, v249
    v_fma_f32 v249, v197, s24, v201
    v_mfma_f32_16x16x32_bf16 v[56:59], a[200:203], v[232:235], v[56:59]
    ds_read_b128 v[232:235], v253 offset:13792
    v_fmac_f32 v201, -4.0, v197
    v_mfma_f32_16x16x32_bf16 v[56:59], a[212:215], v[236:239], v[56:59]
    v_fma_f32 v197, v195, s24, v199
    v_fmac_f32 v199, -4.0, v195
    v_mfma_f32_16x16x32_bf16 v[36:39], a[216:219], v[236:239], v[36:39]
    buffer_load_dwordx2 v[222:223], v227, s[4:7], s19 offen offset:192
    v_mfma_f32_16x16x32_bf16 v[40:43], a[220:223], v[236:239], v[40:43]
    v_fma_f32 v195, v199, s26, v201
    v_fmac_f32 v201, s27, v199
    v_mfma_f32_16x16x32_bf16 v[44:47], a[224:227], v[236:239], v[44:47]
    v_fma_f32 v199, v197, 2.0, v249
    v_fmac_f32 v249, -2.0, v197
    v_mfma_f32_16x16x32_bf16 v[60:63], a[192:195], v[236:239], v[60:63]
    s_waitcnt lgkmcnt(1)
    v_cvt_pk_bf16_f32 v195, v248, v195
    v_cvt_pk_bf16_f32 v201, v251, v201
    v_mfma_f32_16x16x32_bf16 v[60:63], a[204:207], v[228:231], v[60:63]
    v_cvt_pk_bf16_f32 v199, v250, v199
    v_cvt_pk_bf16_f32 v197, v252, v249
    v_mfma_f32_16x16x32_bf16 v[64:67], a[208:211], v[228:231], v[64:67]
    buffer_load_dwordx2 v[224:225], v227, s[4:7], s20 offen offset:192
    v_mfma_f32_16x16x32_bf16 v[64:67], a[196:199], v[236:239], v[64:67]
    v_lshrrev_b32 v252, 15, v255
    v_mfma_f32_16x16x32_bf16 v[68:71], a[200:203], v[236:239], v[68:71]
    ds_read_b128 v[236:239], v253 offset:13536
    v_mfma_f32_16x16x32_bf16 v[68:71], a[212:215], v[228:231], v[68:71]
    ds_write_b64 v252, v[194:195] offset:256
    s_waitcnt vmcnt(14)
    v_mfma_f32_16x16x32_bf16 v[48:51], a[216:219], v[228:231], v[48:51]
    v_lshrrev_b32 v194, 15, v255
    v_lshlrev_b32 v248, 16, v206
    v_mfma_f32_16x16x32_bf16 v[52:55], a[220:223], v[228:231], v[52:55]
    buffer_load_dwordx2 v[226:227], v227, s[4:7], s21 offen offset:192
    v_mfma_f32_16x16x32_bf16 v[56:59], a[224:227], v[228:231], v[56:59]
    ds_write_b64 v194, v[200:201] offset:2336
    v_mfma_f32_16x16x32_bf16 v[72:75], a[192:195], v[228:231], v[72:75]
    s_waitcnt lgkmcnt(3)
    v_lshlrev_b32 v249, 16, v208
    v_lshlrev_b32 v250, 16, v210
    v_mfma_f32_16x16x32_bf16 v[72:75], a[204:207], v[232:235], v[72:75]
    ds_write_b64 v194, v[198:199] offset:4416
    v_mfma_f32_16x16x32_bf16 v[76:79], a[208:211], v[232:235], v[76:79]
    v_lshlrev_b32 v251, 16, v212
    v_and_b32 v206, s22, v206
    v_mfma_f32_16x16x32_bf16 v[76:79], a[196:199], v[228:231], v[76:79]
    ds_write_b64 v194, v[192:193] offset:16896
    v_mfma_f32_16x16x32_bf16 v[80:83], a[200:203], v[228:231], v[80:83]
    ds_read_b128 v[228:231], v253 offset:13264
    v_and_b32 v208, s22, v208
    v_mfma_f32_16x16x32_bf16 v[80:83], a[212:215], v[232:235], v[80:83]
    s_mov_b32 s42, 294912
    v_and_b32 v210, s22, v210
    v_and_b32 v212, s22, v212
    v_mfma_f32_16x16x32_bf16 v[60:63], a[216:219], v[232:235], v[60:63]
    ds_write_b64 v194, v[202:203] offset:25216
    v_mfma_f32_16x16x32_bf16 v[64:67], a[220:223], v[232:235], v[64:67]
    v_lshlrev_b32 v252, 16, v204
    v_and_b32 v204, s22, v204
    v_mfma_f32_16x16x32_bf16 v[68:71], a[224:227], v[232:235], v[68:71]
    ds_write_b64 v194, v[196:197] offset:6496
    v_mfma_f32_16x16x32_bf16 v[84:87], a[192:195], v[232:235], v[84:87]
    buffer_load_dwordx4 a[192:195], v254, s[8:11], s42 offen offset:0 sc1
    v_mfma_f32_16x16x32_bf16 v[88:91], a[196:199], v[232:235], v[88:91]
    v_fmac_f32 v252, s25, v251
    v_fmac_f32 v204, s25, v212
    v_mfma_f32_16x16x32_bf16 v[92:95], a[200:203], v[232:235], v[92:95]
    s_waitcnt lgkmcnt(7)
    v_fmac_f32 v252, s28, v249
    v_fmac_f32 v204, s28, v208
    v_mfma_f32_16x16x32_bf16 v[84:87], a[204:207], v[236:239], v[84:87]
    ds_read_b128 v[232:235], v253 offset:32240
    v_cvt_pk_bf16_f32 v204, v252, v204
    v_mfma_f32_16x16x32_bf16 v[88:91], a[208:211], v[236:239], v[88:91]
    buffer_load_dwordx4 a[196:199], v254, s[8:11], s42 offen offset:1024 sc1
    v_mfma_f32_16x16x32_bf16 v[92:95], a[212:215], v[236:239], v[92:95]
    v_lshlrev_b32 v252, 16, v214
    v_and_b32 v214, s22, v214
    v_mfma_f32_16x16x32_bf16 v[72:75], a[216:219], v[236:239], v[72:75]
    s_waitcnt lgkmcnt(3)
    v_fmac_f32 v252, s29, v248
    v_fmac_f32 v214, s29, v206
    v_mfma_f32_16x16x32_bf16 v[76:79], a[220:223], v[236:239], v[76:79]
    buffer_load_dwordx4 a[200:203], v254, s[8:11], s42 offen offset:2048 sc1
    v_mfma_f32_16x16x32_bf16 v[80:83], a[224:227], v[236:239], v[80:83]
    ds_read_b128 v[236:239], v253 offset:31968
    v_fmac_f32 v252, s23, v250
    v_mfma_f32_16x16x32_bf16 v[84:87], a[216:219], v[228:231], v[84:87]
    s_mov_b32 s42, 297984
    v_fmac_f32 v214, s23, v210
    v_cvt_pk_bf16_f32 v214, v252, v214
    v_mfma_f32_16x16x32_bf16 v[88:91], a[220:223], v[228:231], v[88:91]
    s_waitcnt vmcnt(15) lgkmcnt(1)
    v_fma_f32 v252, v249, s24, v251
    v_fmac_f32 v251, -4.0, v249
    v_mfma_f32_16x16x32_bf16 v[92:95], a[224:227], v[228:231], v[92:95]
    ds_read_b128 v[228:231], v253 offset:31712
    v_fma_f32 v249, v248, s24, v250
sub7:
    v_mfma_f32_16x16x32_bf16 v[96:99], a[228:231], v[232:235], v[96:99]
    buffer_load_dwordx4 a[204:207], v254, s[8:11], s42 offen offset:0 sc1
    v_mfma_f32_16x16x32_bf16 v[100:103], a[232:235], v[232:235], v[100:103]
    s_waitcnt vmcnt(13) lgkmcnt(1)
    v_fmac_f32 v250, -4.0, v248
    v_fma_f32 v248, v250, s26, v251
    v_mfma_f32_16x16x32_bf16 v[104:107], a[236:239], v[232:235], v[104:107]
    ds_read_b128 v[232:235], v253 offset:31456
    v_fmac_f32 v251, s27, v250
    v_mfma_f32_16x16x32_bf16 v[96:99], a[240:243], v[236:239], v[96:99]
    v_fma_f32 v250, v249, 2.0, v252
    v_fmac_f32 v252, -2.0, v249
    v_mfma_f32_16x16x32_bf16 v[100:103], a[244:247], v[236:239], v[100:103]
    buffer_load_dwordx4 a[208:211], v254, s[8:11], s42 offen offset:1024 sc1
    v_mfma_f32_16x16x32_bf16 v[104:107], a[248:251], v[236:239], v[104:107]
    v_fma_f32 v249, v208, s24, v212
    v_fmac_f32 v212, -4.0, v208
    v_mfma_f32_16x16x32_bf16 v[108:111], a[228:231], v[236:239], v[108:111]
    s_waitcnt lgkmcnt(1)
    v_fma_f32 v208, v206, s24, v210
    v_fmac_f32 v210, -4.0, v206
    v_mfma_f32_16x16x32_bf16 v[108:111], a[240:243], v[228:231], v[108:111]
    v_fma_f32 v206, v210, s26, v212
    v_fmac_f32 v212, s27, v210
    v_mfma_f32_16x16x32_bf16 v[112:115], a[244:247], v[228:231], v[112:115]
    buffer_load_dwordx4 a[212:215], v254, s[8:11], s42 offen offset:2048 sc1
    v_mfma_f32_16x16x32_bf16 v[112:115], a[232:235], v[236:239], v[112:115]
    s_mov_b32 s42, 301056
    v_fma_f32 v210, v208, 2.0, v249
    v_fmac_f32 v249, -2.0, v208
    v_mfma_f32_16x16x32_bf16 v[116:119], a[236:239], v[236:239], v[116:119]
    ds_read_b128 v[236:239], v253 offset:31200
    v_cvt_pk_bf16_f32 v206, v248, v206
    v_mfma_f32_16x16x32_bf16 v[116:119], a[248:251], v[228:231], v[116:119]
    s_waitcnt vmcnt(12)
    v_cvt_pk_bf16_f32 v212, v251, v212
    v_cvt_pk_bf16_f32 v210, v250, v210
    v_mfma_f32_16x16x32_bf16 v[96:99], a[252:255], v[228:231], v[96:99]
    buffer_load_dwordx4 a[216:219], v254, s[8:11], s42 offen offset:0 sc1
    v_mfma_f32_16x16x32_bf16 v[100:103], v[240:243], v[228:231], v[100:103]
    v_cvt_pk_bf16_f32 v208, v252, v249
    v_lshlrev_b32 v248, 16, v207
    v_mfma_f32_16x16x32_bf16 v[104:107], v[244:247], v[228:231], v[104:107]
    v_lshlrev_b32 v249, 16, v209
    v_lshlrev_b32 v250, 16, v211
    v_mfma_f32_16x16x32_bf16 v[120:123], a[228:231], v[228:231], v[120:123]
    s_waitcnt lgkmcnt(1)
    v_lshlrev_b32 v251, 16, v213
    v_and_b32 v207, s22, v207
    v_and_b32 v209, s22, v209
    v_mfma_f32_16x16x32_bf16 v[120:123], a[240:243], v[232:235], v[120:123]
    buffer_load_dwordx4 a[220:223], v254, s[8:11], s42 offen offset:1024 sc1
    v_mfma_f32_16x16x32_bf16 v[124:127], a[244:247], v[232:235], v[124:127]
    v_and_b32 v211, s22, v211
    v_and_b32 v213, s22, v213
    v_mfma_f32_16x16x32_bf16 v[124:127], a[232:235], v[228:231], v[124:127]
    v_lshlrev_b32 v252, 16, v205
    v_and_b32 v205, s22, v205
    v_mfma_f32_16x16x32_bf16 v[128:131], a[236:239], v[228:231], v[128:131]
    ds_read_b128 v[228:231], v253 offset:33024
    v_fmac_f32 v252, s25, v251
    v_mfma_f32_16x16x32_bf16 v[128:131], a[248:251], v[232:235], v[128:131]
    buffer_load_dwordx4 a[224:227], v254, s[8:11], s42 offen offset:2048 sc1
    v_mfma_f32_16x16x32_bf16 v[108:111], a[252:255], v[232:235], v[108:111]
    v_fmac_f32 v205, s25, v213
    v_fmac_f32 v252, s28, v249
    v_mfma_f32_16x16x32_bf16 v[112:115], v[240:243], v[232:235], v[112:115]
    v_and_b32 v203, 0x7fff, v255
    v_fmac_f32 v205, s28, v209
    v_mfma_f32_16x16x32_bf16 v[116:119], v[244:247], v[232:235], v[116:119]
    buffer_load_dwordx2 v[192:193], v203, s[4:7], s16 offen offset:576
    v_mfma_f32_16x16x32_bf16 v[132:135], a[228:231], v[232:235], v[132:135]
    s_waitcnt lgkmcnt(1)
    v_cvt_pk_bf16_f32 v205, v252, v205
    v_lshlrev_b32 v252, 16, v215
    v_mfma_f32_16x16x32_bf16 v[132:135], a[240:243], v[236:239], v[132:135]
    v_and_b32 v215, s22, v215
    v_fmac_f32 v252, s29, v248
    v_mfma_f32_16x16x32_bf16 v[136:139], a[244:247], v[236:239], v[136:139]
    v_fmac_f32 v215, s29, v207
    v_fmac_f32 v252, s23, v250
    v_mfma_f32_16x16x32_bf16 v[136:139], a[232:235], v[232:235], v[136:139]
    v_fmac_f32 v215, s23, v211
    v_cvt_pk_bf16_f32 v215, v252, v215
    v_mfma_f32_16x16x32_bf16 v[140:143], a[236:239], v[232:235], v[140:143]
    ds_read_b128 v[232:235], v253 offset:32768
    v_fma_f32 v252, v249, s24, v251
    v_mfma_f32_16x16x32_bf16 v[140:143], a[248:251], v[236:239], v[140:143]
    buffer_load_dwordx2 v[194:195], v203, s[4:7], s17 offen offset:576
    v_mfma_f32_16x16x32_bf16 v[120:123], a[252:255], v[236:239], v[120:123]
    v_fmac_f32 v251, -4.0, v249
    v_fma_f32 v249, v248, s24, v250
    v_mfma_f32_16x16x32_bf16 v[124:127], v[240:243], v[236:239], v[124:127]
    v_fmac_f32 v250, -4.0, v248
    v_fma_f32 v248, v250, s26, v251
    v_mfma_f32_16x16x32_bf16 v[128:131], v[244:247], v[236:239], v[128:131]
    v_fmac_f32 v251, s27, v250
    v_fma_f32 v250, v249, 2.0, v252
    v_mfma_f32_16x16x32_bf16 v[144:147], a[228:231], v[236:239], v[144:147]
    s_waitcnt lgkmcnt(1)
    v_fmac_f32 v252, -2.0, v249
    v_fma_f32 v249, v209, s24, v213
    v_mfma_f32_16x16x32_bf16 v[144:147], a[240:243], v[228:231], v[144:147]
    buffer_load_dwordx2 v[196:197], v203, s[4:7], s18 offen offset:576
    v_mfma_f32_16x16x32_bf16 v[148:151], a[244:247], v[228:231], v[148:151]
    v_fmac_f32 v213, -4.0, v209
    v_fma_f32 v209, v207, s24, v211
    v_mfma_f32_16x16x32_bf16 v[148:151], a[232:235], v[236:239], v[148:151]
    v_fmac_f32 v211, -4.0, v207
    v_fma_f32 v207, v211, s26, v213
    v_mfma_f32_16x16x32_bf16 v[152:155], a[236:239], v[236:239], v[152:155]
    ds_read_b128 v[236:239], v253 offset:32512
    v_fmac_f32 v213, s27, v211
    v_mfma_f32_16x16x32_bf16 v[152:155], a[248:251], v[228:231], v[152:155]
    v_fma_f32 v211, v209, 2.0, v249
    v_fmac_f32 v249, -2.0, v209
    v_mfma_f32_16x16x32_bf16 v[132:135], a[252:255], v[228:231], v[132:135]
    buffer_load_dwordx2 v[198:199], v203, s[4:7], s19 offen offset:576
    v_mfma_f32_16x16x32_bf16 v[136:139], v[240:243], v[228:231], v[136:139]
    v_cvt_pk_bf16_f32 v207, v248, v207
    v_cvt_pk_bf16_f32 v213, v251, v213
    v_mfma_f32_16x16x32_bf16 v[140:143], v[244:247], v[228:231], v[140:143]
    v_cvt_pk_bf16_f32 v211, v250, v211
    v_cvt_pk_bf16_f32 v209, v252, v249
    v_mfma_f32_16x16x32_bf16 v[156:159], a[228:231], v[228:231], v[156:159]
    s_waitcnt lgkmcnt(1)
    v_lshrrev_b32 v252, 15, v255
    v_mfma_f32_16x16x32_bf16 v[156:159], a[240:243], v[232:235], v[156:159]
    ds_write_b64 v252, v[206:207] offset:0
    v_mfma_f32_16x16x32_bf16 v[160:163], a[244:247], v[232:235], v[160:163]
    buffer_load_dwordx2 v[200:201], v203, s[4:7], s20 offen offset:576
    v_mfma_f32_16x16x32_bf16 v[160:163], a[232:235], v[228:231], v[160:163]
    v_lshrrev_b32 v206, 15, v255
    v_mfma_f32_16x16x32_bf16 v[164:167], a[236:239], v[228:231], v[164:167]
    ds_read_b128 v[228:231], v253 offset:32256
    s_waitcnt vmcnt(14)
    v_mfma_f32_16x16x32_bf16 v[164:167], a[248:251], v[232:235], v[164:167]
    ds_write_b64 v206, v[212:213] offset:2080
    v_mfma_f32_16x16x32_bf16 v[144:147], a[252:255], v[232:235], v[144:147]
    v_lshlrev_b32 v248, 16, v218
    v_lshlrev_b32 v249, 16, v220
    v_mfma_f32_16x16x32_bf16 v[148:151], v[240:243], v[232:235], v[148:151]
    buffer_load_dwordx2 v[202:203], v203, s[4:7], s21 offen offset:576
    v_mfma_f32_16x16x32_bf16 v[152:155], v[244:247], v[232:235], v[152:155]
    ds_write_b64 v206, v[210:211] offset:4160
    v_mfma_f32_16x16x32_bf16 v[168:171], a[228:231], v[232:235], v[168:171]
    s_waitcnt lgkmcnt(4)
    v_lshlrev_b32 v250, 16, v222
    v_lshlrev_b32 v251, 16, v224
    v_mfma_f32_16x16x32_bf16 v[168:171], a[240:243], v[236:239], v[168:171]
    ds_write_b64 v206, v[204:205] offset:16640
    v_mfma_f32_16x16x32_bf16 v[172:175], a[244:247], v[236:239], v[172:175]
    v_and_b32 v218, s22, v218
    v_and_b32 v220, s22, v220
    v_mfma_f32_16x16x32_bf16 v[172:175], a[232:235], v[232:235], v[172:175]
    ds_write_b64 v206, v[214:215] offset:24960
    v_mfma_f32_16x16x32_bf16 v[176:179], a[236:239], v[232:235], v[176:179]
    ds_read_b128 v[232:235], v253 offset:31984
    v_and_b32 v222, s22, v222
    v_and_b32 v224, s22, v224
    v_mfma_f32_16x16x32_bf16 v[176:179], a[248:251], v[236:239], v[176:179]
    s_mov_b32 s42, 331776
    v_lshlrev_b32 v252, 16, v216
    v_and_b32 v216, s22, v216
    v_mfma_f32_16x16x32_bf16 v[156:159], a[252:255], v[236:239], v[156:159]
    ds_write_b64 v206, v[208:209] offset:6240
    v_mfma_f32_16x16x32_bf16 v[160:163], v[240:243], v[236:239], v[160:163]
    v_fmac_f32 v252, s25, v251
    v_fmac_f32 v216, s25, v224
    v_mfma_f32_16x16x32_bf16 v[164:167], v[244:247], v[236:239], v[164:167]
    s_waitcnt lgkmcnt(6)
    v_fmac_f32 v252, s28, v249
    v_fmac_f32 v216, s28, v220
    v_mfma_f32_16x16x32_bf16 v[180:183], a[228:231], v[236:239], v[180:183]
    buffer_load_dwordx4 a[228:231], v254, s[8:11], s42 offen offset:0 sc1
    v_mfma_f32_16x16x32_bf16 v[184:187], a[232:235], v[236:239], v[184:187]
    s_waitcnt lgkmcnt(0)
    v_cvt_pk_bf16_f32 v216, v252, v216
    v_lshlrev_b32 v252, 16, v226
    v_mfma_f32_16x16x32_bf16 v[188:191], a[236:239], v[236:239], v[188:191]
    s_barrier
    v_mfma_f32_16x16x32_bf16 v[180:183], a[240:243], v[228:231], v[180:183]
    ds_read_b128 v[236:239], v253 offset:1040
    v_and_b32 v226, s22, v226
    v_mfma_f32_16x16x32_bf16 v[184:187], a[244:247], v[228:231], v[184:187]
    buffer_load_dwordx4 a[232:235], v254, s[8:11], s42 offen offset:1024 sc1
    v_mfma_f32_16x16x32_bf16 v[188:191], a[248:251], v[228:231], v[188:191]
    v_fmac_f32 v252, s29, v248
    v_fmac_f32 v226, s29, v218
    v_mfma_f32_16x16x32_bf16 v[168:171], a[252:255], v[228:231], v[168:171]
    v_fmac_f32 v252, s23, v250
    v_fmac_f32 v226, s23, v222
    v_mfma_f32_16x16x32_bf16 v[172:175], v[240:243], v[228:231], v[172:175]
    buffer_load_dwordx4 a[236:239], v254, s[8:11], s42 offen offset:2048 sc1
    v_mfma_f32_16x16x32_bf16 v[176:179], v[244:247], v[228:231], v[176:179]
    ds_read_b128 v[228:231], v253 offset:768
    v_cvt_pk_bf16_f32 v226, v252, v226
    v_mfma_f32_16x16x32_bf16 v[180:183], a[252:255], v[232:235], v[180:183]
    s_mov_b32 s42, 334848
    v_fma_f32 v252, v249, s24, v251
    v_fmac_f32 v251, -4.0, v249
    v_mfma_f32_16x16x32_bf16 v[184:187], v[240:243], v[232:235], v[184:187]
    s_waitcnt vmcnt(15) lgkmcnt(1)
    v_fma_f32 v249, v248, s24, v250
    v_fmac_f32 v250, -4.0, v248
    v_mfma_f32_16x16x32_bf16 v[188:191], v[244:247], v[232:235], v[188:191]
    ds_read_b128 v[232:235], v253 offset:512
    v_fma_f32 v248, v250, s26, v251
sub8:
    v_mfma_f32_16x16x32_bf16 a[0:3], a[192:195], v[236:239], a[0:3]
    buffer_load_dwordx4 a[240:243], v254, s[8:11], s42 offen offset:0 sc1
    v_mfma_f32_16x16x32_bf16 a[4:7], a[196:199], v[236:239], a[4:7]
    s_waitcnt vmcnt(13) lgkmcnt(1)
    v_fmac_f32 v251, s27, v250
    v_fma_f32 v250, v249, 2.0, v252
    v_mfma_f32_16x16x32_bf16 a[8:11], a[200:203], v[236:239], a[8:11]
    ds_read_b128 v[236:239], v253 offset:256
    v_fmac_f32 v252, -2.0, v249
    v_mfma_f32_16x16x32_bf16 a[0:3], a[204:207], v[228:231], a[0:3]
    v_fma_f32 v249, v220, s24, v224
    v_fmac_f32 v224, -4.0, v220
    v_mfma_f32_16x16x32_bf16 a[4:7], a[208:211], v[228:231], a[4:7]
    buffer_load_dwordx4 a[244:247], v254, s[8:11], s42 offen offset:1024 sc1
    v_mfma_f32_16x16x32_bf16 a[8:11], a[212:215], v[228:231], a[8:11]
    v_fma_f32 v220, v218, s24, v222
    v_fmac_f32 v222, -4.0, v218
    v_mfma_f32_16x16x32_bf16 a[12:15], a[192:195], v[228:231], a[12:15]
    s_waitcnt lgkmcnt(1)
    v_fma_f32 v218, v222, s26, v224
    v_fmac_f32 v224, s27, v222
    v_mfma_f32_16x16x32_bf16 a[12:15], a[204:207], v[232:235], a[12:15]
    v_fma_f32 v222, v220, 2.0, v249
    v_fmac_f32 v249, -2.0, v220
    v_mfma_f32_16x16x32_bf16 a[16:19], a[208:211], v[232:235], a[16:19]
    buffer_load_dwordx4 a[248:251], v254, s[8:11], s42 offen offset:2048 sc1
    v_mfma_f32_16x16x32_bf16 a[16:19], a[196:199], v[228:231], a[16:19]
    s_mov_b32 s42, 337920
    v_cvt_pk_bf16_f32 v218, v248, v218
    v_cvt_pk_bf16_f32 v224, v251, v224
    v_mfma_f32_16x16x32_bf16 a[20:23], a[200:203], v[228:231], a[20:23]
    ds_read_b128 v[228:231], v253 offset:0
    v_cvt_pk_bf16_f32 v222, v250, v222
    v_mfma_f32_16x16x32_bf16 a[20:23], a[212:215], v[232:235], a[20:23]
    s_waitcnt vmcnt(12)
    v_cvt_pk_bf16_f32 v220, v252, v249
    v_lshlrev_b32 v248, 16, v219
    v_mfma_f32_16x16x32_bf16 a[0:3], a[216:219], v[232:235], a[0:3]
    buffer_load_dwordx4 a[252:255], v254, s[8:11], s42 offen offset:0 sc1
    v_mfma_f32_16x16x32_bf16 a[4:7], a[220:223], v[232:235], a[4:7]
    v_lshlrev_b32 v249, 16, v221
    v_lshlrev_b32 v250, 16, v223
    v_mfma_f32_16x16x32_bf16 a[8:11], a[224:227], v[232:235], a[8:11]
    v_lshlrev_b32 v251, 16, v225
    v_and_b32 v219, s22, v219
    v_mfma_f32_16x16x32_bf16 a[24:27], a[192:195], v[232:235], a[24:27]
    s_waitcnt lgkmcnt(1)
    v_and_b32 v221, s22, v221
    v_and_b32 v223, s22, v223
    v_mfma_f32_16x16x32_bf16 a[24:27], a[204:207], v[236:239], a[24:27]
    buffer_load_dwordx4 v[240:243], v254, s[8:11], s42 offen offset:1024 sc1
    v_mfma_f32_16x16x32_bf16 a[28:31], a[208:211], v[236:239], a[28:31]
    v_and_b32 v225, s22, v225
    v_lshlrev_b32 v252, 16, v217
    v_mfma_f32_16x16x32_bf16 a[28:31], a[196:199], v[232:235], a[28:31]
    v_and_b32 v217, s22, v217
    v_fmac_f32 v252, s25, v251
    v_mfma_f32_16x16x32_bf16 a[32:35], a[200:203], v[232:235], a[32:35]
    ds_read_b128 v[232:235], v253 offset:1824
    v_fmac_f32 v217, s25, v225
    v_mfma_f32_16x16x32_bf16 a[32:35], a[212:215], v[236:239], a[32:35]
    buffer_load_dwordx4 v[244:247], v254, s[8:11], s42 offen offset:2048 sc1
    v_mfma_f32_16x16x32_bf16 a[12:15], a[216:219], v[236:239], a[12:15]
    v_fmac_f32 v252, s28, v249
    v_fmac_f32 v217, s28, v221
    v_mfma_f32_16x16x32_bf16 a[16:19], a[220:223], v[236:239], a[16:19]
    v_and_b32 v215, 0x7fff, v255
    v_cvt_pk_bf16_f32 v217, v252, v217
    v_mfma_f32_16x16x32_bf16 a[20:23], a[224:227], v[236:239], a[20:23]
    buffer_load_dwordx2 v[204:205], v215, s[4:7], s16 offen offset:960
    v_lshlrev_b32 v252, 16, v227
    v_mfma_f32_16x16x32_bf16 a[36:39], a[192:195], v[236:239], a[36:39]
    s_waitcnt lgkmcnt(1)
    v_and_b32 v227, s22, v227
    v_fmac_f32 v252, s29, v248
    v_mfma_f32_16x16x32_bf16 a[36:39], a[204:207], v[228:231], a[36:39]
    v_fmac_f32 v227, s29, v219
    v_fmac_f32 v252, s23, v250
    v_mfma_f32_16x16x32_bf16 a[40:43], a[208:211], v[228:231], a[40:43]
    v_fmac_f32 v227, s23, v223
    v_cvt_pk_bf16_f32 v227, v252, v227
    v_mfma_f32_16x16x32_bf16 a[40:43], a[196:199], v[236:239], a[40:43]
    v_fma_f32 v252, v249, s24, v251
    v_fmac_f32 v251, -4.0, v249
    v_mfma_f32_16x16x32_bf16 a[44:47], a[200:203], v[236:239], a[44:47]
    ds_read_b128 v[236:239], v253 offset:1568
    v_fma_f32 v249, v248, s24, v250
    v_mfma_f32_16x16x32_bf16 a[44:47], a[212:215], v[228:231], a[44:47]
    buffer_load_dwordx2 v[206:207], v215, s[4:7], s17 offen offset:960
    v_mfma_f32_16x16x32_bf16 a[24:27], a[216:219], v[228:231], a[24:27]
    v_fmac_f32 v250, -4.0, v248
    v_fma_f32 v248, v250, s26, v251
    v_mfma_f32_16x16x32_bf16 a[28:31], a[220:223], v[228:231], a[28:31]
    v_fmac_f32 v251, s27, v250
    v_fma_f32 v250, v249, 2.0, v252
    v_mfma_f32_16x16x32_bf16 a[32:35], a[224:227], v[228:231], a[32:35]
    v_fmac_f32 v252, -2.0, v249
    v_fma_f32 v249, v221, s24, v225
    v_mfma_f32_16x16x32_bf16 a[48:51], a[192:195], v[228:231], a[48:51]
    s_waitcnt lgkmcnt(1)
    v_fmac_f32 v225, -4.0, v221
    v_fma_f32 v221, v219, s24, v223
    v_mfma_f32_16x16x32_bf16 a[48:51], a[204:207], v[232:235], a[48:51]
    buffer_load_dwordx2 v[208:209], v215, s[4:7], s18 offen offset:960
    v_mfma_f32_16x16x32_bf16 a[52:55], a[208:211], v[232:235], a[52:55]
    v_fmac_f32 v223, -4.0, v219
    v_fma_f32 v219, v223, s26, v225
    v_mfma_f32_16x16x32_bf16 a[52:55], a[196:199], v[228:231], a[52:55]
    v_fmac_f32 v225, s27, v223
    v_fma_f32 v223, v221, 2.0, v249
    v_mfma_f32_16x16x32_bf16 a[56:59], a[200:203], v[228:231], a[56:59]
    ds_read_b128 v[228:231], v253 offset:1312
    v_fmac_f32 v249, -2.0, v221
    v_mfma_f32_16x16x32_bf16 a[56:59], a[212:215], v[232:235], a[56:59]
    v_cvt_pk_bf16_f32 v219, v248, v219
    v_cvt_pk_bf16_f32 v225, v251, v225
    v_mfma_f32_16x16x32_bf16 a[36:39], a[216:219], v[232:235], a[36:39]
    buffer_load_dwordx2 v[210:211], v215, s[4:7], s19 offen offset:960
    v_mfma_f32_16x16x32_bf16 a[40:43], a[220:223], v[232:235], a[40:43]
    v_cvt_pk_bf16_f32 v223, v250, v223
    v_cvt_pk_bf16_f32 v221, v252, v249
    v_mfma_f32_16x16x32_bf16 a[44:47], a[224:227], v[232:235], a[44:47]
    v_lshrrev_b32 v252, 15, v255
    v_mfma_f32_16x16x32_bf16 a[60:63], a[192:195], v[232:235], a[60:63]
    s_waitcnt lgkmcnt(1)
    v_mfma_f32_16x16x32_bf16 a[60:63], a[204:207], v[236:239], a[60:63]
    ds_write_b64 v252, v[218:219] offset:9088
    v_mfma_f32_16x16x32_bf16 a[64:67], a[208:211], v[236:239], a[64:67]
    buffer_load_dwordx2 v[212:213], v215, s[4:7], s20 offen offset:960
    v_mfma_f32_16x16x32_bf16 a[64:67], a[196:199], v[232:235], a[64:67]
    v_lshrrev_b32 v218, 15, v255
    v_mfma_f32_16x16x32_bf16 a[68:71], a[200:203], v[232:235], a[68:71]
    ds_read_b128 v[232:235], v253 offset:1056
    s_waitcnt vmcnt(14)
    v_mfma_f32_16x16x32_bf16 a[68:71], a[212:215], v[236:239], a[68:71]
    ds_write_b64 v218, v[224:225] offset:11168
    v_mfma_f32_16x16x32_bf16 a[48:51], a[216:219], v[236:239], a[48:51]
    v_lshlrev_b32 v248, 16, v194
    v_lshlrev_b32 v249, 16, v196
    v_mfma_f32_16x16x32_bf16 a[52:55], a[220:223], v[236:239], a[52:55]
    buffer_load_dwordx2 v[214:215], v215, s[4:7], s21 offen offset:960
    v_mfma_f32_16x16x32_bf16 a[56:59], a[224:227], v[236:239], a[56:59]
    ds_write_b64 v218, v[222:223] offset:13248
    v_mfma_f32_16x16x32_bf16 a[72:75], a[192:195], v[236:239], a[72:75]
    s_waitcnt lgkmcnt(4)
    v_lshlrev_b32 v250, 16, v198
    v_lshlrev_b32 v251, 16, v200
    v_mfma_f32_16x16x32_bf16 a[72:75], a[204:207], v[228:231], a[72:75]
    ds_write_b64 v218, v[216:217] offset:19488
    v_mfma_f32_16x16x32_bf16 a[76:79], a[208:211], v[228:231], a[76:79]
    v_and_b32 v194, s22, v194
    v_and_b32 v196, s22, v196
    v_mfma_f32_16x16x32_bf16 a[76:79], a[196:199], v[236:239], a[76:79]
pad3:
    s_cbranch_vccnz pad7
    ds_write_b64 v218, v[226:227] offset:27808
    v_mfma_f32_16x16x32_bf16 a[80:83], a[200:203], v[236:239], a[80:83]
    ds_read_b128 v[236:239], v253 offset:784
    v_and_b32 v198, s22, v198
    v_mfma_f32_16x16x32_bf16 a[80:83], a[212:215], v[228:231], a[80:83]
    s_mov_b32 s42, 368640
    v_and_b32 v200, s22, v200
    v_lshlrev_b32 v252, 16, v192
    v_mfma_f32_16x16x32_bf16 a[60:63], a[216:219], v[228:231], a[60:63]
    ds_write_b64 v218, v[220:221] offset:31968
    v_mfma_f32_16x16x32_bf16 a[64:67], a[220:223], v[228:231], a[64:67]
    v_and_b32 v192, s22, v192
    v_fmac_f32 v252, s25, v251
    v_mfma_f32_16x16x32_bf16 a[68:71], a[224:227], v[228:231], a[68:71]
    v_fmac_f32 v192, s25, v200
    v_fmac_f32 v252, s28, v249
    v_mfma_f32_16x16x32_bf16 a[84:87], a[192:195], v[228:231], a[84:87]
    buffer_load_dwordx4 a[192:195], v254, s[8:11], s42 offen offset:0 sc1
    v_mfma_f32_16x16x32_bf16 a[88:91], a[196:199], v[228:231], a[88:91]
    v_fmac_f32 v192, s28, v196
    v_cvt_pk_bf16_f32 v192, v252, v192
    v_mfma_f32_16x16x32_bf16 a[92:95], a[200:203], v[228:231], a[92:95]
    s_waitcnt lgkmcnt(6)
    v_lshlrev_b32 v252, 16, v202
    v_and_b32 v202, s22, v202
    v_mfma_f32_16x16x32_bf16 a[84:87], a[204:207], v[232:235], a[84:87]
    ds_read_b128 v[228:231], v253 offset:3120
    v_fmac_f32 v252, s29, v248
    v_fmac_f32 v202, s29, v194
    v_mfma_f32_16x16x32_bf16 a[88:91], a[208:211], v[232:235], a[88:91]
    buffer_load_dwordx4 a[196:199], v254, s[8:11], s42 offen offset:1024 sc1
    v_mfma_f32_16x16x32_bf16 a[92:95], a[212:215], v[232:235], a[92:95]
    v_fmac_f32 v252, s23, v250
    v_fmac_f32 v202, s23, v198
    v_mfma_f32_16x16x32_bf16 a[72:75], a[216:219], v[232:235], a[72:75]
    s_waitcnt lgkmcnt(2)
    v_cvt_pk_bf16_f32 v202, v252, v202
    v_fma_f32 v252, v249, s24, v251
    v_mfma_f32_16x16x32_bf16 a[76:79], a[220:223], v[232:235], a[76:79]
    buffer_load_dwordx4 a[200:203], v254, s[8:11], s42 offen offset:2048 sc1
    v_mfma_f32_16x16x32_bf16 a[80:83], a[224:227], v[232:235], a[80:83]
    ds_read_b128 v[232:235], v253 offset:2848
    v_fmac_f32 v251, -4.0, v249
    v_mfma_f32_16x16x32_bf16 a[84:87], a[216:219], v[236:239], a[84:87]
    s_mov_b32 s42, 371712
    v_fma_f32 v249, v248, s24, v250
    v_fmac_f32 v250, -4.0, v248
    v_mfma_f32_16x16x32_bf16 a[88:91], a[220:223], v[236:239], a[88:91]
    s_waitcnt vmcnt(15) lgkmcnt(1)
    v_fma_f32 v248, v250, s26, v251
    v_fmac_f32 v251, s27, v250
    v_mfma_f32_16x16x32_bf16 a[92:95], a[224:227], v[236:239], a[92:95]
    ds_read_b128 v[236:239], v253 offset:2592
    v_fma_f32 v250, v249, 2.0, v252
sub9:
    v_mfma_f32_16x16x32_bf16 a[96:99], a[228:231], v[228:231], a[96:99]
    buffer_load_dwordx4 a[204:207], v254, s[8:11], s42 offen offset:0 sc1
    v_mfma_f32_16x16x32_bf16 a[100:103], a[232:235], v[228:231], a[100:103]
    s_waitcnt vmcnt(13) lgkmcnt(1)
    v_fmac_f32 v252, -2.0, v249
    v_fma_f32 v249, v196, s24, v200
    v_mfma_f32_16x16x32_bf16 a[104:107], a[236:239], v[228:231], a[104:107]
    ds_read_b128 v[228:231], v253 offset:2336
    v_fmac_f32 v200, -4.0, v196
    v_mfma_f32_16x16x32_bf16 a[96:99], a[240:243], v[232:235], a[96:99]
    v_fma_f32 v196, v194, s24, v198
    v_fmac_f32 v198, -4.0, v194
    v_mfma_f32_16x16x32_bf16 a[100:103], a[244:247], v[232:235], a[100:103]
    buffer_load_dwordx4 a[208:211], v254, s[8:11], s42 offen offset:1024 sc1
    v_mfma_f32_16x16x32_bf16 a[104:107], a[248:251], v[232:235], a[104:107]
    v_fma_f32 v194, v198, s26, v200
    v_fmac_f32 v200, s27, v198
    v_mfma_f32_16x16x32_bf16 a[108:111], a[228:231], v[232:235], a[108:111]
    s_waitcnt lgkmcnt(1)
    v_fma_f32 v198, v196, 2.0, v249
    v_fmac_f32 v249, -2.0, v196
    v_mfma_f32_16x16x32_bf16 a[108:111], a[240:243], v[236:239], a[108:111]
    v_cvt_pk_bf16_f32 v194, v248, v194
    v_cvt_pk_bf16_f32 v200, v251, v200
    v_mfma_f32_16x16x32_bf16 a[112:115], a[244:247], v[236:239], a[112:115]
    buffer_load_dwordx4 a[212:215], v254, s[8:11], s42 offen offset:2048 sc1
    v_mfma_f32_16x16x32_bf16 a[112:115], a[232:235], v[232:235], a[112:115]
    s_mov_b32 s42, 374784
    v_cvt_pk_bf16_f32 v198, v250, v198
    v_cvt_pk_bf16_f32 v196, v252, v249
    v_mfma_f32_16x16x32_bf16 a[116:119], a[236:239], v[232:235], a[116:119]
    ds_read_b128 v[232:235], v253 offset:2080
    v_lshlrev_b32 v248, 16, v195
    v_mfma_f32_16x16x32_bf16 a[116:119], a[248:251], v[236:239], a[116:119]
    s_waitcnt vmcnt(12)
    v_lshlrev_b32 v249, 16, v197
    v_lshlrev_b32 v250, 16, v199
    v_mfma_f32_16x16x32_bf16 a[96:99], a[252:255], v[236:239], a[96:99]
    buffer_load_dwordx4 a[216:219], v254, s[8:11], s42 offen offset:0 sc1
    v_mfma_f32_16x16x32_bf16 a[100:103], v[240:243], v[236:239], a[100:103]
    v_lshlrev_b32 v251, 16, v201
    v_and_b32 v195, s22, v195
    v_mfma_f32_16x16x32_bf16 a[104:107], v[244:247], v[236:239], a[104:107]
    v_and_b32 v197, s22, v197
    v_and_b32 v199, s22, v199
    v_mfma_f32_16x16x32_bf16 a[120:123], a[228:231], v[236:239], a[120:123]
    s_waitcnt lgkmcnt(1)
    v_and_b32 v201, s22, v201
    v_lshlrev_b32 v252, 16, v193
    v_mfma_f32_16x16x32_bf16 a[120:123], a[240:243], v[228:231], a[120:123]
    buffer_load_dwordx4 a[220:223], v254, s[8:11], s42 offen offset:1024 sc1
    v_mfma_f32_16x16x32_bf16 a[124:127], a[244:247], v[228:231], a[124:127]
    v_and_b32 v193, s22, v193
    v_fmac_f32 v252, s25, v251
    v_mfma_f32_16x16x32_bf16 a[124:127], a[232:235], v[236:239], a[124:127]
    v_fmac_f32 v193, s25, v201
    v_fmac_f32 v252, s28, v249
    v_mfma_f32_16x16x32_bf16 a[128:131], a[236:239], v[236:239], a[128:131]
    ds_read_b128 v[236:239], v253 offset:3904
    v_fmac_f32 v193, s28, v197
    v_mfma_f32_16x16x32_bf16 a[128:131], a[248:251], v[228:231], a[128:131]
    buffer_load_dwordx4 a[224:227], v254, s[8:11], s42 offen offset:2048 sc1
    v_mfma_f32_16x16x32_bf16 a[108:111], a[252:255], v[228:231], a[108:111]
    v_cvt_pk_bf16_f32 v193, v252, v193
    v_lshlrev_b32 v252, 16, v203
    v_mfma_f32_16x16x32_bf16 a[112:115], v[240:243], v[228:231], a[112:115]
    v_and_b32 v227, 0x7fff, v255
    v_and_b32 v203, s22, v203
    v_mfma_f32_16x16x32_bf16 a[116:119], v[244:247], v[228:231], a[116:119]
    buffer_load_dwordx2 v[216:217], v227, s[4:7], s16 offen offset:1344
    v_mfma_f32_16x16x32_bf16 a[132:135], a[228:231], v[228:231], a[132:135]
    s_waitcnt lgkmcnt(1)
    v_fmac_f32 v252, s29, v248
    v_fmac_f32 v203, s29, v195
    v_mfma_f32_16x16x32_bf16 a[132:135], a[240:243], v[232:235], a[132:135]
    v_fmac_f32 v252, s23, v250
    v_fmac_f32 v203, s23, v199
    v_mfma_f32_16x16x32_bf16 a[136:139], a[244:247], v[232:235], a[136:139]
    v_cvt_pk_bf16_f32 v203, v252, v203
    v_fma_f32 v252, v249, s24, v251
    v_mfma_f32_16x16x32_bf16 a[136:139], a[232:235], v[228:231], a[136:139]
    v_fmac_f32 v251, -4.0, v249
    v_fma_f32 v249, v248, s24, v250
    v_mfma_f32_16x16x32_bf16 a[140:143], a[236:239], v[228:231], a[140:143]
    ds_read_b128 v[228:231], v253 offset:3648
    v_fmac_f32 v250, -4.0, v248
    v_mfma_f32_16x16x32_bf16 a[140:143], a[248:251], v[232:235], a[140:143]
    buffer_load_dwordx2 v[218:219], v227, s[4:7], s17 offen offset:1344
    v_mfma_f32_16x16x32_bf16 a[120:123], a[252:255], v[232:235], a[120:123]
    v_fma_f32 v248, v250, s26, v251
    v_fmac_f32 v251, s27, v250
    v_mfma_f32_16x16x32_bf16 a[124:127], v[240:243], v[232:235], a[124:127]
    v_fma_f32 v250, v249, 2.0, v252
    v_fmac_f32 v252, -2.0, v249
    v_fma_f32 v249, v197, s24, v201
    v_mfma_f32_16x16x32_bf16 a[128:131], v[244:247], v[232:235], a[128:131]
    v_fmac_f32 v201, -4.0, v197
    v_fma_f32 v197, v195, s24, v199
    v_mfma_f32_16x16x32_bf16 a[144:147], a[228:231], v[232:235], a[144:147]
    s_waitcnt lgkmcnt(1)
    v_fmac_f32 v199, -4.0, v195
    v_fma_f32 v195, v199, s26, v201
    v_mfma_f32_16x16x32_bf16 a[144:147], a[240:243], v[236:239], a[144:147]
    buffer_load_dwordx2 v[220:221], v227, s[4:7], s18 offen offset:1344
    v_mfma_f32_16x16x32_bf16 a[148:151], a[244:247], v[236:239], a[148:151]
    v_fmac_f32 v201, s27, v199
    v_fma_f32 v199, v197, 2.0, v249
    v_mfma_f32_16x16x32_bf16 a[148:151], a[232:235], v[232:235], a[148:151]
    v_fmac_f32 v249, -2.0, v197
    v_cvt_pk_bf16_f32 v195, v248, v195
    v_mfma_f32_16x16x32_bf16 a[152:155], a[236:239], v[232:235], a[152:155]
    ds_read_b128 v[232:235], v253 offset:3392
    v_cvt_pk_bf16_f32 v201, v251, v201
    v_mfma_f32_16x16x32_bf16 a[152:155], a[248:251], v[236:239], a[152:155]
    v_cvt_pk_bf16_f32 v199, v250, v199
    v_cvt_pk_bf16_f32 v197, v252, v249
    v_mfma_f32_16x16x32_bf16 a[132:135], a[252:255], v[236:239], a[132:135]
    buffer_load_dwordx2 v[222:223], v227, s[4:7], s19 offen offset:1344
    v_mfma_f32_16x16x32_bf16 a[136:139], v[240:243], v[236:239], a[136:139]
    v_lshrrev_b32 v252, 15, v255
    v_mfma_f32_16x16x32_bf16 a[140:143], v[244:247], v[236:239], a[140:143]
    ds_write_b64 v252, v[194:195] offset:8832
    v_mfma_f32_16x16x32_bf16 a[156:159], a[228:231], v[236:239], a[156:159]
    s_waitcnt lgkmcnt(2)
    v_lshrrev_b32 v194, 15, v255
    v_mfma_f32_16x16x32_bf16 a[156:159], a[240:243], v[228:231], a[156:159]
    ds_write_b64 v194, v[200:201] offset:10912
    v_mfma_f32_16x16x32_bf16 a[160:163], a[244:247], v[228:231], a[160:163]
    buffer_load_dwordx2 v[224:225], v227, s[4:7], s20 offen offset:1344
    v_mfma_f32_16x16x32_bf16 a[160:163], a[232:235], v[236:239], a[160:163]
    ds_write_b64 v194, v[198:199] offset:12992
    v_mfma_f32_16x16x32_bf16 a[164:167], a[236:239], v[236:239], a[164:167]
    ds_read_b128 v[236:239], v253 offset:3136
    s_waitcnt vmcnt(14)
    v_mfma_f32_16x16x32_bf16 a[164:167], a[248:251], v[228:231], a[164:167]
    ds_write_b64 v194, v[192:193] offset:19232
    v_mfma_f32_16x16x32_bf16 a[144:147], a[252:255], v[228:231], a[144:147]
    v_lshlrev_b32 v248, 16, v206
    v_lshlrev_b32 v249, 16, v208
    v_mfma_f32_16x16x32_bf16 a[148:151], v[240:243], v[228:231], a[148:151]
    buffer_load_dwordx2 v[226:227], v227, s[4:7], s21 offen offset:1344
    v_mfma_f32_16x16x32_bf16 a[152:155], v[244:247], v[228:231], a[152:155]
    ds_write_b64 v194, v[202:203] offset:27552
    v_mfma_f32_16x16x32_bf16 a[168:171], a[228:231], v[228:231], a[168:171]
    s_waitcnt lgkmcnt(6)
    v_lshlrev_b32 v250, 16, v210
    v_lshlrev_b32 v251, 16, v212
    v_mfma_f32_16x16x32_bf16 a[168:171], a[240:243], v[232:235], a[168:171]
    ds_write_b64 v194, v[196:197] offset:31712
    v_mfma_f32_16x16x32_bf16 a[172:175], a[244:247], v[232:235], a[172:175]
    ds_read_b128 v[192:195], v253 offset:40096
    s_mov_b32 s45, 452138121
    v_mfma_f32_16x16x32_bf16 a[172:175], a[232:235], v[228:231], a[172:175]
    v_bfe_u32 v196, v254, 5, 3
    v_mul_u32_u24 v197, 5, v196
    v_mfma_f32_16x16x32_bf16 a[176:179], a[236:239], v[228:231], a[176:179]
    ds_read_b128 v[228:231], v253 offset:2864
    v_bfe_u32 v197, s45, v197, 5
    v_mfma_f32_16x16x32_bf16 a[176:179], a[248:251], v[232:235], a[176:179]
    s_mov_b32 s42, 405504
    v_mul_u32_u24 v197, 65, v197
    v_sub_u32 v197, v197, v196
    v_mfma_f32_16x16x32_bf16 a[156:159], a[252:255], v[232:235], a[156:159]
    v_lshl_add_u32 v196, v197, 5, v253
    s_waitcnt lgkmcnt(1)
    v_mfma_f32_16x16x32_bf16 a[160:163], v[240:243], v[232:235], a[160:163]
    s_mov_b64 exec, s[46:47]
    ds_write_b128 v196, v[192:195] offset:1024
    s_mov_b64 exec, -1
    v_mfma_f32_16x16x32_bf16 a[164:167], v[244:247], v[232:235], a[164:167]
    v_and_b32 v206, s22, v206
    v_and_b32 v208, s22, v208
    v_mfma_f32_16x16x32_bf16 a[180:183], a[228:231], v[232:235], a[180:183]
    buffer_load_dwordx4 a[228:231], v254, s[8:11], s42 offen offset:0 sc1
    v_mfma_f32_16x16x32_bf16 a[184:187], a[232:235], v[232:235], a[184:187]
    v_and_b32 v210, s22, v210
    v_and_b32 v212, s22, v212
    v_mfma_f32_16x16x32_bf16 a[188:191], a[236:239], v[232:235], a[188:191]
    v_lshlrev_b32 v252, 16, v204
    v_and_b32 v204, s22, v204
    v_mfma_f32_16x16x32_bf16 a[180:183], a[240:243], v[236:239], a[180:183]
    ds_read_b128 v[232:235], v253 offset:5200
    v_fmac_f32 v252, s25, v251
    v_mfma_f32_16x16x32_bf16 a[184:187], a[244:247], v[236:239], a[184:187]
    buffer_load_dwordx4 a[232:235], v254, s[8:11], s42 offen offset:1024 sc1
    v_mfma_f32_16x16x32_bf16 a[188:191], a[248:251], v[236:239], a[188:191]
    v_fmac_f32 v204, s25, v212
    v_fmac_f32 v252, s28, v249
    v_mfma_f32_16x16x32_bf16 a[168:171], a[252:255], v[236:239], a[168:171]
    s_waitcnt lgkmcnt(2)
    v_fmac_f32 v204, s28, v208
    v_cvt_pk_bf16_f32 v204, v252, v204
    v_mfma_f32_16x16x32_bf16 a[172:175], v[240:243], v[236:239], a[172:175]
    buffer_load_dwordx4 a[236:239], v254, s[8:11], s42 offen offset:2048 sc1
    v_mfma_f32_16x16x32_bf16 a[176:179], v[244:247], v[236:239], a[176:179]
    ds_read_b128 v[236:239], v253 offset:4928
    v_lshlrev_b32 v252, 16, v214
    v_mfma_f32_16x16x32_bf16 a[180:183], a[252:255], v[228:231], a[180:183]
    s_mov_b32 s42, 408576
    v_and_b32 v214, s22, v214
    v_fmac_f32 v252, s29, v248
    v_mfma_f32_16x16x32_bf16 a[184:187], v[240:243], v[228:231], a[184:187]
    s_waitcnt vmcnt(15) lgkmcnt(1)
    v_fmac_f32 v214, s29, v206
    v_fmac_f32 v252, s23, v250
    v_mfma_f32_16x16x32_bf16 a[188:191], v[244:247], v[228:231], a[188:191]
    ds_read_b128 v[228:231], v253 offset:4672
    v_fmac_f32 v214, s23, v210
    v_cvt_pk_bf16_f32 v214, v252, v214
sub10:
    v_mfma_f32_16x16x32_bf16 v[0:3], a[192:195], v[232:235], v[0:3]
    buffer_load_dwordx4 a[240:243], v254, s[8:11], s42 offen offset:0 sc1
    v_mfma_f32_16x16x32_bf16 v[4:7], a[196:199], v[232:235], v[4:7]
    s_waitcnt vmcnt(13) lgkmcnt(1)
    v_fma_f32 v252, v249, s24, v251
    v_fmac_f32 v251, -4.0, v249
    v_mfma_f32_16x16x32_bf16 v[8:11], a[200:203], v[232:235], v[8:11]
    ds_read_b128 v[232:235], v253 offset:4416
    v_fma_f32 v249, v248, s24, v250
    v_mfma_f32_16x16x32_bf16 v[0:3], a[204:207], v[236:239], v[0:3]
    v_fmac_f32 v250, -4.0, v248
    v_fma_f32 v248, v250, s26, v251
    v_mfma_f32_16x16x32_bf16 v[4:7], a[208:211], v[236:239], v[4:7]
    buffer_load_dwordx4 a[244:247], v254, s[8:11], s42 offen offset:1024 sc1
    v_mfma_f32_16x16x32_bf16 v[8:11], a[212:215], v[236:239], v[8:11]
    v_fmac_f32 v251, s27, v250
    v_fma_f32 v250, v249, 2.0, v252
    v_mfma_f32_16x16x32_bf16 v[12:15], a[192:195], v[236:239], v[12:15]
    s_waitcnt lgkmcnt(1)
    v_fmac_f32 v252, -2.0, v249
    v_fma_f32 v249, v208, s24, v212
    v_mfma_f32_16x16x32_bf16 v[12:15], a[204:207], v[228:231], v[12:15]
    v_fmac_f32 v212, -4.0, v208
    v_fma_f32 v208, v206, s24, v210
    v_mfma_f32_16x16x32_bf16 v[16:19], a[208:211], v[228:231], v[16:19]
    buffer_load_dwordx4 a[248:251], v254, s[8:11], s42 offen offset:2048 sc1
    v_mfma_f32_16x16x32_bf16 v[16:19], a[196:199], v[236:239], v[16:19]
    s_mov_b32 s42, 411648
    v_fmac_f32 v210, -4.0, v206
    v_fma_f32 v206, v210, s26, v212
    v_mfma_f32_16x16x32_bf16 v[20:23], a[200:203], v[236:239], v[20:23]
    ds_read_b128 v[236:239], v253 offset:4160
    v_fmac_f32 v212, s27, v210
    v_mfma_f32_16x16x32_bf16 v[20:23], a[212:215], v[228:231], v[20:23]
    s_waitcnt vmcnt(12)
    v_fma_f32 v210, v208, 2.0, v249
    v_fmac_f32 v249, -2.0, v208
    v_mfma_f32_16x16x32_bf16 v[0:3], a[216:219], v[228:231], v[0:3]
    buffer_load_dwordx4 a[252:255], v254, s[8:11], s42 offen offset:0 sc1
    v_mfma_f32_16x16x32_bf16 v[4:7], a[220:223], v[228:231], v[4:7]
    v_cvt_pk_bf16_f32 v206, v248, v206
    v_cvt_pk_bf16_f32 v212, v251, v212
    v_mfma_f32_16x16x32_bf16 v[8:11], a[224:227], v[228:231], v[8:11]
    v_cvt_pk_bf16_f32 v210, v250, v210
    v_cvt_pk_bf16_f32 v208, v252, v249
    v_mfma_f32_16x16x32_bf16 v[24:27], a[192:195], v[228:231], v[24:27]
    s_waitcnt lgkmcnt(1)
    v_lshlrev_b32 v248, 16, v207
    v_lshlrev_b32 v249, 16, v209
    v_mfma_f32_16x16x32_bf16 v[24:27], a[204:207], v[232:235], v[24:27]
    buffer_load_dwordx4 v[240:243], v254, s[8:11], s42 offen offset:1024 sc1
    v_mfma_f32_16x16x32_bf16 v[28:31], a[208:211], v[232:235], v[28:31]
    v_lshlrev_b32 v250, 16, v211
    v_lshlrev_b32 v251, 16, v213
    v_mfma_f32_16x16x32_bf16 v[28:31], a[196:199], v[228:231], v[28:31]
    v_and_b32 v207, s22, v207
    v_and_b32 v209, s22, v209
    v_mfma_f32_16x16x32_bf16 v[32:35], a[200:203], v[228:231], v[32:35]
    ds_read_b128 v[228:231], v253 offset:5984
    v_and_b32 v211, s22, v211
    v_mfma_f32_16x16x32_bf16 v[32:35], a[212:215], v[232:235], v[32:35]
    buffer_load_dwordx4 v[244:247], v254, s[8:11], s42 offen offset:2048 sc1
    v_mfma_f32_16x16x32_bf16 v[12:15], a[216:219], v[232:235], v[12:15]
    v_and_b32 v213, s22, v213
    v_lshlrev_b32 v252, 16, v205
    v_mfma_f32_16x16x32_bf16 v[16:19], a[220:223], v[232:235], v[16:19]
    v_and_b32 v203, 0x7fff, v255
    v_and_b32 v205, s22, v205
    v_mfma_f32_16x16x32_bf16 v[20:23], a[224:227], v[232:235], v[20:23]
    buffer_load_dwordx2 v[192:193], v203, s[4:7], s16 offen offset:256
    v_mfma_f32_16x16x32_bf16 v[36:39], a[192:195], v[232:235], v[36:39]
    s_waitcnt lgkmcnt(1)
    v_fmac_f32 v252, s25, v251
    v_fmac_f32 v205, s25, v213
    v_mfma_f32_16x16x32_bf16 v[36:39], a[204:207], v[236:239], v[36:39]
    v_fmac_f32 v252, s28, v249
    v_fmac_f32 v205, s28, v209
    v_mfma_f32_16x16x32_bf16 v[40:43], a[208:211], v[236:239], v[40:43]
    v_cvt_pk_bf16_f32 v205, v252, v205
    v_lshlrev_b32 v252, 16, v215
    v_mfma_f32_16x16x32_bf16 v[40:43], a[196:199], v[232:235], v[40:43]
    v_and_b32 v215, s22, v215
    v_fmac_f32 v252, s29, v248
    v_mfma_f32_16x16x32_bf16 v[44:47], a[200:203], v[232:235], v[44:47]
    ds_read_b128 v[232:235], v253 offset:5728
    v_fmac_f32 v215, s29, v207
    v_mfma_f32_16x16x32_bf16 v[44:47], a[212:215], v[236:239], v[44:47]
    buffer_load_dwordx2 v[194:195], v203, s[4:7], s17 offen offset:256
    v_mfma_f32_16x16x32_bf16 v[24:27], a[216:219], v[236:239], v[24:27]
    v_fmac_f32 v252, s23, v250
    v_fmac_f32 v215, s23, v211
    v_mfma_f32_16x16x32_bf16 v[28:31], a[220:223], v[236:239], v[28:31]
    v_cvt_pk_bf16_f32 v215, v252, v215
    v_fma_f32 v252, v249, s24, v251
    v_mfma_f32_16x16x32_bf16 v[32:35], a[224:227], v[236:239], v[32:35]
    v_fmac_f32 v251, -4.0, v249
    v_fma_f32 v249, v248, s24, v250
    v_mfma_f32_16x16x32_bf16 v[48:51], a[192:195], v[236:239], v[48:51]
    s_waitcnt lgkmcnt(1)
    v_fmac_f32 v250, -4.0, v248
    v_fma_f32 v248, v250, s26, v251
    v_mfma_f32_16x16x32_bf16 v[48:51], a[204:207], v[228:231], v[48:51]
    buffer_load_dwordx2 v[196:197], v203, s[4:7], s18 offen offset:256
    v_mfma_f32_16x16x32_bf16 v[52:55], a[208:211], v[228:231], v[52:55]
    v_fmac_f32 v251, s27, v250
    v_fma_f32 v250, v249, 2.0, v252
    v_mfma_f32_16x16x32_bf16 v[52:55], a[196:199], v[236:239], v[52:55]
    v_fmac_f32 v252, -2.0, v249
    v_fma_f32 v249, v209, s24, v213
    v_mfma_f32_16x16x32_bf16 v[56:59], a[200:203], v[236:239], v[56:59]
    ds_read_b128 v[236:239], v253 offset:5472
    v_fmac_f32 v213, -4.0, v209
    v_mfma_f32_16x16x32_bf16 v[56:59], a[212:215], v[228:231], v[56:59]
    v_fma_f32 v209, v207, s24, v211
    v_fmac_f32 v211, -4.0, v207
    v_mfma_f32_16x16x32_bf16 v[36:39], a[216:219], v[228:231], v[36:39]
    buffer_load_dwordx2 v[198:199], v203, s[4:7], s19 offen offset:256
    v_fma_f32 v207, v211, s26, v213
    v_mfma_f32_16x16x32_bf16 v[40:43], a[220:223], v[228:231], v[40:43]
    v_fmac_f32 v213, s27, v211
    v_fma_f32 v211, v209, 2.0, v249
    v_mfma_f32_16x16x32_bf16 v[44:47], a[224:227], v[228:231], v[44:47]
    v_fmac_f32 v249, -2.0, v209
    v_cvt_pk_bf16_f32 v207, v248, v207
    v_mfma_f32_16x16x32_bf16 v[60:63], a[192:195], v[228:231], v[60:63]
    s_waitcnt lgkmcnt(1)
    v_cvt_pk_bf16_f32 v213, v251, v213
    v_cvt_pk_bf16_f32 v211, v250, v211
    v_mfma_f32_16x16x32_bf16 v[60:63], a[204:207], v[232:235], v[60:63]
    v_cvt_pk_bf16_f32 v209, v252, v249
    v_lshrrev_b32 v252, 15, v255
    v_mfma_f32_16x16x32_bf16 v[64:67], a[208:211], v[232:235], v[64:67]
    buffer_load_dwordx2 v[200:201], v203, s[4:7], s20 offen offset:256
    v_mfma_f32_16x16x32_bf16 v[64:67], a[196:199], v[228:231], v[64:67]
    ds_write_b64 v252, v[206:207] offset:8576
    v_mfma_f32_16x16x32_bf16 v[68:71], a[200:203], v[228:231], v[68:71]
    ds_read_b128 v[228:231], v253 offset:5216
    v_lshrrev_b32 v206, 15, v255
    v_mfma_f32_16x16x32_bf16 v[68:71], a[212:215], v[232:235], v[68:71]
    ds_write_b64 v206, v[212:213] offset:10656
    v_mfma_f32_16x16x32_bf16 v[48:51], a[216:219], v[232:235], v[48:51]
    s_waitcnt vmcnt(14)
    v_lshlrev_b32 v248, 16, v218
    v_lshlrev_b32 v249, 16, v220
    v_mfma_f32_16x16x32_bf16 v[52:55], a[220:223], v[232:235], v[52:55]
    buffer_load_dwordx2 v[202:203], v203, s[4:7], s21 offen offset:256
    v_mfma_f32_16x16x32_bf16 v[56:59], a[224:227], v[232:235], v[56:59]
    ds_write_b64 v206, v[210:211] offset:12736
    v_mfma_f32_16x16x32_bf16 v[72:75], a[192:195], v[232:235], v[72:75]
    s_waitcnt lgkmcnt(4)
    v_lshlrev_b32 v250, 16, v222
    v_lshlrev_b32 v251, 16, v224
    v_mfma_f32_16x16x32_bf16 v[72:75], a[204:207], v[236:239], v[72:75]
    ds_write_b64 v206, v[204:205] offset:18976
    v_mfma_f32_16x16x32_bf16 v[76:79], a[208:211], v[236:239], v[76:79]
    v_and_b32 v218, s22, v218
    v_and_b32 v220, s22, v220
    v_mfma_f32_16x16x32_bf16 v[76:79], a[196:199], v[232:235], v[76:79]
    ds_write_b64 v206, v[214:215] offset:27296
    v_mfma_f32_16x16x32_bf16 v[80:83], a[200:203], v[232:235], v[80:83]
    ds_read_b128 v[232:235], v253 offset:4944
    v_and_b32 v222, s22, v222
    v_mfma_f32_16x16x32_bf16 v[80:83], a[212:215], v[236:239], v[80:83]
    s_mov_b32 s42, 442368
    v_and_b32 v224, s22, v224
    v_lshlrev_b32 v252, 16, v216
    v_mfma_f32_16x16x32_bf16 v[60:63], a[216:219], v[236:239], v[60:63]
    ds_write_b64 v206, v[208:209] offset:31456
    v_mfma_f32_16x16x32_bf16 v[64:67], a[220:223], v[236:239], v[64:67]
    v_and_b32 v216, s22, v216
    v_fmac_f32 v252, s25, v251
    v_mfma_f32_16x16x32_bf16 v[68:71], a[224:227], v[236:239], v[68:71]
    v_fmac_f32 v216, s25, v224
    v_fmac_f32 v252, s28, v249
    v_mfma_f32_16x16x32_bf16 v[84:87], a[192:195], v[236:239], v[84:87]
    buffer_load_dwordx4 a[192:195], v254, s[8:11], s42 offen offset:0 sc1
    v_mfma_f32_16x16x32_bf16 v[88:91], a[196:199], v[236:239], v[88:91]
    v_fmac_f32 v216, s28, v220
    v_cvt_pk_bf16_f32 v216, v252, v216
    v_mfma_f32_16x16x32_bf16 v[92:95], a[200:203], v[236:239], v[92:95]
    s_waitcnt lgkmcnt(6)
    v_lshlrev_b32 v252, 16, v226
    v_and_b32 v226, s22, v226
    v_mfma_f32_16x16x32_bf16 v[84:87], a[204:207], v[228:231], v[84:87]
    ds_read_b128 v[236:239], v253 offset:7280
    v_fmac_f32 v252, s29, v248
    v_mfma_f32_16x16x32_bf16 v[88:91], a[208:211], v[228:231], v[88:91]
    buffer_load_dwordx4 a[196:199], v254, s[8:11], s42 offen offset:1024 sc1
    v_mfma_f32_16x16x32_bf16 v[92:95], a[212:215], v[228:231], v[92:95]
    v_fmac_f32 v226, s29, v218
    v_fmac_f32 v252, s23, v250
    v_mfma_f32_16x16x32_bf16 v[72:75], a[216:219], v[228:231], v[72:75]
    s_waitcnt lgkmcnt(2)
    v_fmac_f32 v226, s23, v222
    v_cvt_pk_bf16_f32 v226, v252, v226
    v_mfma_f32_16x16x32_bf16 v[76:79], a[220:223], v[228:231], v[76:79]
    buffer_load_dwordx4 a[200:203], v254, s[8:11], s42 offen offset:2048 sc1
    v_mfma_f32_16x16x32_bf16 v[80:83], a[224:227], v[228:231], v[80:83]
    ds_read_b128 v[228:231], v253 offset:7008
    v_fma_f32 v252, v249, s24, v251
    v_mfma_f32_16x16x32_bf16 v[84:87], a[216:219], v[232:235], v[84:87]
    s_mov_b32 s42, 445440
    v_fmac_f32 v251, -4.0, v249
    v_fma_f32 v249, v248, s24, v250
    v_mfma_f32_16x16x32_bf16 v[88:91], a[220:223], v[232:235], v[88:91]
    s_waitcnt vmcnt(15) lgkmcnt(1)
    v_fmac_f32 v250, -4.0, v248
    v_fma_f32 v248, v250, s26, v251
    v_mfma_f32_16x16x32_bf16 v[92:95], a[224:227], v[232:235], v[92:95]
    ds_read_b128 v[232:235], v253 offset:6752
    v_fmac_f32 v251, s27, v250
sub11:
    v_mfma_f32_16x16x32_bf16 v[96:99], a[228:231], v[236:239], v[96:99]
    buffer_load_dwordx4 a[204:207], v254, s[8:11], s42 offen offset:0 sc1
    v_mfma_f32_16x16x32_bf16 v[100:103], a[232:235], v[236:239], v[100:103]
    s_waitcnt vmcnt(13) lgkmcnt(1)
    v_fma_f32 v250, v249, 2.0, v252
    v_fmac_f32 v252, -2.0, v249
    v_mfma_f32_16x16x32_bf16 v[104:107], a[236:239], v[236:239], v[104:107]
    ds_read_b128 v[236:239], v253 offset:6496
    v_fma_f32 v249, v220, s24, v224
    v_mfma_f32_16x16x32_bf16 v[96:99], a[240:243], v[228:231], v[96:99]
    v_fmac_f32 v224, -4.0, v220
    v_fma_f32 v220, v218, s24, v222
    v_mfma_f32_16x16x32_bf16 v[100:103], a[244:247], v[228:231], v[100:103]
    buffer_load_dwordx4 a[208:211], v254, s[8:11], s42 offen offset:1024 sc1
    v_mfma_f32_16x16x32_bf16 v[104:107], a[248:251], v[228:231], v[104:107]
    v_fmac_f32 v222, -4.0, v218
    v_fma_f32 v218, v222, s26, v224
    v_mfma_f32_16x16x32_bf16 v[108:111], a[228:231], v[228:231], v[108:111]
    s_waitcnt lgkmcnt(1)
    v_fmac_f32 v224, s27, v222
    v_fma_f32 v222, v220, 2.0, v249
    v_mfma_f32_16x16x32_bf16 v[108:111], a[240:243], v[232:235], v[108:111]
    v_fmac_f32 v249, -2.0, v220
    v_cvt_pk_bf16_f32 v218, v248, v218
    v_cvt_pk_bf16_f32 v224, v251, v224
    v_mfma_f32_16x16x32_bf16 v[112:115], a[244:247], v[232:235], v[112:115]
    buffer_load_dwordx4 a[212:215], v254, s[8:11], s42 offen offset:2048 sc1
    v_mfma_f32_16x16x32_bf16 v[112:115], a[232:235], v[228:231], v[112:115]
    s_mov_b32 s42, 448512
    v_cvt_pk_bf16_f32 v222, v250, v222
    v_cvt_pk_bf16_f32 v220, v252, v249
    v_mfma_f32_16x16x32_bf16 v[116:119], a[236:239], v[228:231], v[116:119]
    ds_read_b128 v[228:231], v253 offset:6240
    v_lshlrev_b32 v248, 16, v219
    v_mfma_f32_16x16x32_bf16 v[116:119], a[248:251], v[232:235], v[116:119]
    s_waitcnt vmcnt(12)
    v_lshlrev_b32 v249, 16, v221
    v_lshlrev_b32 v250, 16, v223
    v_mfma_f32_16x16x32_bf16 v[96:99], a[252:255], v[232:235], v[96:99]
    buffer_load_dwordx4 a[216:219], v254, s[8:11], s42 offen offset:0 sc1
    v_mfma_f32_16x16x32_bf16 v[100:103], v[240:243], v[232:235], v[100:103]
    v_lshlrev_b32 v251, 16, v225
    v_and_b32 v219, s22, v219
    v_mfma_f32_16x16x32_bf16 v[104:107], v[244:247], v[232:235], v[104:107]
    v_and_b32 v221, s22, v221
    v_and_b32 v223, s22, v223
    v_mfma_f32_16x16x32_bf16 v[120:123], a[228:231], v[232:235], v[120:123]
    s_waitcnt lgkmcnt(1)
    v_and_b32 v225, s22, v225
    v_lshlrev_b32 v252, 16, v217
    v_mfma_f32_16x16x32_bf16 v[120:123], a[240:243], v[236:239], v[120:123]
    buffer_load_dwordx4 a[220:223], v254, s[8:11], s42 offen offset:1024 sc1
    v_mfma_f32_16x16x32_bf16 v[124:127], a[244:247], v[236:239], v[124:127]
    v_and_b32 v217, s22, v217
    v_fmac_f32 v252, s25, v251
    v_mfma_f32_16x16x32_bf16 v[124:127], a[232:235], v[232:235], v[124:127]
    v_fmac_f32 v217, s25, v225
    v_fmac_f32 v252, s28, v249
    v_mfma_f32_16x16x32_bf16 v[128:131], a[236:239], v[232:235], v[128:131]
    ds_read_b128 v[232:235], v253 offset:8064
    v_fmac_f32 v217, s28, v221
    v_mfma_f32_16x16x32_bf16 v[128:131], a[248:251], v[236:239], v[128:131]
    buffer_load_dwordx4 a[224:227], v254, s[8:11], s42 offen offset:2048 sc1
    v_mfma_f32_16x16x32_bf16 v[108:111], a[252:255], v[236:239], v[108:111]
    v_cvt_pk_bf16_f32 v217, v252, v217
    v_lshlrev_b32 v252, 16, v227
    v_mfma_f32_16x16x32_bf16 v[112:115], v[240:243], v[236:239], v[112:115]
    v_and_b32 v215, 0x7fff, v255
    v_and_b32 v227, s22, v227
    v_mfma_f32_16x16x32_bf16 v[116:119], v[244:247], v[236:239], v[116:119]
    buffer_load_dwordx2 v[204:205], v215, s[4:7], s16 offen offset:640
    v_mfma_f32_16x16x32_bf16 v[132:135], a[228:231], v[236:239], v[132:135]
    s_waitcnt lgkmcnt(1)
    v_fmac_f32 v252, s29, v248
    v_fmac_f32 v227, s29, v219
    v_mfma_f32_16x16x32_bf16 v[132:135], a[240:243], v[228:231], v[132:135]
    v_fmac_f32 v252, s23, v250
    v_fmac_f32 v227, s23, v223
    v_mfma_f32_16x16x32_bf16 v[136:139], a[244:247], v[228:231], v[136:139]
    v_cvt_pk_bf16_f32 v227, v252, v227
    v_fma_f32 v252, v249, s24, v251
    v_mfma_f32_16x16x32_bf16 v[136:139], a[232:235], v[236:239], v[136:139]
    v_fmac_f32 v251, -4.0, v249
    v_fma_f32 v249, v248, s24, v250
    v_mfma_f32_16x16x32_bf16 v[140:143], a[236:239], v[236:239], v[140:143]
    ds_read_b128 v[236:239], v253 offset:7808
    v_fmac_f32 v250, -4.0, v248
    v_mfma_f32_16x16x32_bf16 v[140:143], a[248:251], v[228:231], v[140:143]
    buffer_load_dwordx2 v[206:207], v215, s[4:7], s17 offen offset:640
    v_mfma_f32_16x16x32_bf16 v[120:123], a[252:255], v[228:231], v[120:123]
    v_fma_f32 v248, v250, s26, v251
    v_fmac_f32 v251, s27, v250
    v_mfma_f32_16x16x32_bf16 v[124:127], v[240:243], v[228:231], v[124:127]
    v_fma_f32 v250, v249, 2.0, v252
    v_fmac_f32 v252, -2.0, v249
    v_mfma_f32_16x16x32_bf16 v[128:131], v[244:247], v[228:231], v[128:131]
    v_fma_f32 v249, v221, s24, v225
    v_fmac_f32 v225, -4.0, v221
    v_mfma_f32_16x16x32_bf16 v[144:147], a[228:231], v[228:231], v[144:147]
    s_waitcnt lgkmcnt(1)
    v_fma_f32 v221, v219, s24, v223
    v_fmac_f32 v223, -4.0, v219
    v_mfma_f32_16x16x32_bf16 v[144:147], a[240:243], v[232:235], v[144:147]
    buffer_load_dwordx2 v[208:209], v215, s[4:7], s18 offen offset:640
    v_mfma_f32_16x16x32_bf16 v[148:151], a[244:247], v[232:235], v[148:151]
    v_fma_f32 v219, v223, s26, v225
    v_fmac_f32 v225, s27, v223
    v_mfma_f32_16x16x32_bf16 v[148:151], a[232:235], v[228:231], v[148:151]
    v_fma_f32 v223, v221, 2.0, v249
    v_fmac_f32 v249, -2.0, v221
    v_mfma_f32_16x16x32_bf16 v[152:155], a[236:239], v[228:231], v[152:155]
    ds_read_b128 v[228:231], v253 offset:7552
    v_cvt_pk_bf16_f32 v219, v248, v219
    v_mfma_f32_16x16x32_bf16 v[152:155], a[248:251], v[232:235], v[152:155]
    v_cvt_pk_bf16_f32 v225, v251, v225
    v_cvt_pk_bf16_f32 v223, v250, v223
    v_mfma_f32_16x16x32_bf16 v[132:135], a[252:255], v[232:235], v[132:135]
    buffer_load_dwordx2 v[210:211], v215, s[4:7], s19 offen offset:640
    v_mfma_f32_16x16x32_bf16 v[136:139], v[240:243], v[232:235], v[136:139]
    v_cvt_pk_bf16_f32 v221, v252, v249
    v_lshrrev_b32 v252, 15, v255
    v_mfma_f32_16x16x32_bf16 v[140:143], v[244:247], v[232:235], v[140:143]
    ds_write_b64 v252, v[218:219] offset:8320
    v_mfma_f32_16x16x32_bf16 v[156:159], a[228:231], v[232:235], v[156:159]
    s_waitcnt lgkmcnt(2)
    v_lshrrev_b32 v218, 15, v255
    v_mfma_f32_16x16x32_bf16 v[156:159], a[240:243], v[236:239], v[156:159]
    ds_write_b64 v218, v[224:225] offset:10400
    v_mfma_f32_16x16x32_bf16 v[160:163], a[244:247], v[236:239], v[160:163]
    buffer_load_dwordx2 v[212:213], v215, s[4:7], s20 offen offset:640
    v_mfma_f32_16x16x32_bf16 v[160:163], a[232:235], v[232:235], v[160:163]
    ds_write_b64 v218, v[222:223] offset:12480
    v_mfma_f32_16x16x32_bf16 v[164:167], a[236:239], v[232:235], v[164:167]
    ds_read_b128 v[232:235], v253 offset:7296
    s_waitcnt vmcnt(14)
    v_mfma_f32_16x16x32_bf16 v[164:167], a[248:251], v[236:239], v[164:167]
    ds_write_b64 v218, v[216:217] offset:18720
    v_mfma_f32_16x16x32_bf16 v[144:147], a[252:255], v[236:239], v[144:147]
    v_lshlrev_b32 v248, 16, v194
    v_lshlrev_b32 v249, 16, v196
    v_mfma_f32_16x16x32_bf16 v[148:151], v[240:243], v[236:239], v[148:151]
pad4:
    s_cbranch_vccnz pad8
    buffer_load_dwordx2 v[214:215], v215, s[4:7], s21 offen offset:640
    v_mfma_f32_16x16x32_bf16 v[152:155], v[244:247], v[236:239], v[152:155]
    ds_write_b64 v218, v[226:227] offset:27040
    v_mfma_f32_16x16x32_bf16 v[168:171], a[228:231], v[236:239], v[168:171]
    s_waitcnt lgkmcnt(6)
    v_lshlrev_b32 v250, 16, v198
    v_lshlrev_b32 v251, 16, v200
    v_mfma_f32_16x16x32_bf16 v[168:171], a[240:243], v[228:231], v[168:171]
    ds_write_b64 v218, v[220:221] offset:31200
    v_mfma_f32_16x16x32_bf16 v[172:175], a[244:247], v[228:231], v[172:175]
    v_and_b32 v194, s22, v194
    v_and_b32 v196, s22, v196
    v_mfma_f32_16x16x32_bf16 v[172:175], a[232:235], v[236:239], v[172:175]
    v_and_b32 v198, s22, v198
    v_and_b32 v200, s22, v200
    v_mfma_f32_16x16x32_bf16 v[176:179], a[236:239], v[236:239], v[176:179]
    ds_read_b128 v[236:239], v253 offset:7024
    v_lshlrev_b32 v252, 16, v192
    v_mfma_f32_16x16x32_bf16 v[176:179], a[248:251], v[228:231], v[176:179]
    s_mov_b32 s42, 479232
    v_and_b32 v192, s22, v192
    v_fmac_f32 v252, s25, v251
    v_mfma_f32_16x16x32_bf16 v[156:159], a[252:255], v[228:231], v[156:159]
    v_fmac_f32 v192, s25, v200
    v_fmac_f32 v252, s28, v249
    v_mfma_f32_16x16x32_bf16 v[160:163], v[240:243], v[228:231], v[160:163]
    v_fmac_f32 v192, s28, v196
    v_cvt_pk_bf16_f32 v192, v252, v192
    v_mfma_f32_16x16x32_bf16 v[164:167], v[244:247], v[228:231], v[164:167]
    s_waitcnt lgkmcnt(4)
    v_lshlrev_b32 v252, 16, v202
    v_and_b32 v202, s22, v202
    v_mfma_f32_16x16x32_bf16 v[180:183], a[228:231], v[228:231], v[180:183]
    buffer_load_dwordx4 a[228:231], v254, s[8:11], s42 offen offset:0 sc1
    v_mfma_f32_16x16x32_bf16 v[184:187], a[232:235], v[228:231], v[184:187]
    s_waitcnt lgkmcnt(0)
    v_fmac_f32 v252, s29, v248
    v_fmac_f32 v202, s29, v194
    v_mfma_f32_16x16x32_bf16 v[188:191], a[236:239], v[228:231], v[188:191]
    s_barrier
    v_mfma_f32_16x16x32_bf16 v[180:183], a[240:243], v[232:235], v[180:183]
    ds_read_b128 v[228:231], v253 offset:9360
    v_fmac_f32 v252, s23, v250
    v_mfma_f32_16x16x32_bf16 v[184:187], a[244:247], v[232:235], v[184:187]
    buffer_load_dwordx4 a[232:235], v254, s[8:11], s42 offen offset:1024 sc1
    v_mfma_f32_16x16x32_bf16 v[188:191], a[248:251], v[232:235], v[188:191]
    v_fmac_f32 v202, s23, v198
    v_cvt_pk_bf16_f32 v202, v252, v202
    v_mfma_f32_16x16x32_bf16 v[168:171], a[252:255], v[232:235], v[168:171]
    v_fma_f32 v252, v249, s24, v251
    v_fmac_f32 v251, -4.0, v249
    v_mfma_f32_16x16x32_bf16 v[172:175], v[240:243], v[232:235], v[172:175]
    buffer_load_dwordx4 a[236:239], v254, s[8:11], s42 offen offset:2048 sc1
    v_mfma_f32_16x16x32_bf16 v[176:179], v[244:247], v[232:235], v[176:179]
    ds_read_b128 v[232:235], v253 offset:9088
    v_fma_f32 v249, v248, s24, v250
    v_mfma_f32_16x16x32_bf16 v[180:183], a[252:255], v[236:239], v[180:183]
    s_mov_b32 s42, 482304
    v_fmac_f32 v250, -4.0, v248
    v_fma_f32 v248, v250, s26, v251
    v_mfma_f32_16x16x32_bf16 v[184:187], v[240:243], v[236:239], v[184:187]
    s_waitcnt vmcnt(15) lgkmcnt(1)
    v_fmac_f32 v251, s27, v250
    v_fma_f32 v250, v249, 2.0, v252
    v_mfma_f32_16x16x32_bf16 v[188:191], v[244:247], v[236:239], v[188:191]
    ds_read_b128 v[236:239], v253 offset:8832
    v_fmac_f32 v252, -2.0, v249
sub12:
    v_mfma_f32_16x16x32_bf16 a[0:3], a[192:195], v[228:231], a[0:3]
    buffer_load_dwordx4 a[240:243], v254, s[8:11], s42 offen offset:0 sc1
    v_mfma_f32_16x16x32_bf16 a[4:7], a[196:199], v[228:231], a[4:7]
    s_waitcnt vmcnt(13) lgkmcnt(1)
    v_fma_f32 v249, v196, s24, v200
    v_fmac_f32 v200, -4.0, v196
    v_mfma_f32_16x16x32_bf16 a[8:11], a[200:203], v[228:231], a[8:11]
    ds_read_b128 v[228:231], v253 offset:8576
    v_fma_f32 v196, v194, s24, v198
    v_mfma_f32_16x16x32_bf16 a[0:3], a[204:207], v[232:235], a[0:3]
    v_fmac_f32 v198, -4.0, v194
    v_fma_f32 v194, v198, s26, v200
    v_mfma_f32_16x16x32_bf16 a[4:7], a[208:211], v[232:235], a[4:7]
    buffer_load_dwordx4 a[244:247], v254, s[8:11], s42 offen offset:1024 sc1
    v_mfma_f32_16x16x32_bf16 a[8:11], a[212:215], v[232:235], a[8:11]
    v_fmac_f32 v200, s27, v198
    v_fma_f32 v198, v196, 2.0, v249
    v_mfma_f32_16x16x32_bf16 a[12:15], a[192:195], v[232:235], a[12:15]
    s_waitcnt lgkmcnt(1)
    v_fmac_f32 v249, -2.0, v196
    v_cvt_pk_bf16_f32 v194, v248, v194
    v_mfma_f32_16x16x32_bf16 a[12:15], a[204:207], v[236:239], a[12:15]
    v_cvt_pk_bf16_f32 v200, v251, v200
    v_cvt_pk_bf16_f32 v198, v250, v198
    v_mfma_f32_16x16x32_bf16 a[16:19], a[208:211], v[236:239], a[16:19]
    buffer_load_dwordx4 a[248:251], v254, s[8:11], s42 offen offset:2048 sc1
    v_mfma_f32_16x16x32_bf16 a[16:19], a[196:199], v[232:235], a[16:19]
    s_mov_b32 s42, 485376
    v_cvt_pk_bf16_f32 v196, v252, v249
    v_lshlrev_b32 v248, 16, v195
    v_mfma_f32_16x16x32_bf16 a[20:23], a[200:203], v[232:235], a[20:23]
    ds_read_b128 v[232:235], v253 offset:8320
    v_lshlrev_b32 v249, 16, v197
    v_mfma_f32_16x16x32_bf16 a[20:23], a[212:215], v[236:239], a[20:23]
    s_waitcnt vmcnt(12)
    v_lshlrev_b32 v250, 16, v199
    v_lshlrev_b32 v251, 16, v201
    v_mfma_f32_16x16x32_bf16 a[0:3], a[216:219], v[236:239], a[0:3]
    buffer_load_dwordx4 a[252:255], v254, s[8:11], s42 offen offset:0 sc1
    v_mfma_f32_16x16x32_bf16 a[4:7], a[220:223], v[236:239], a[4:7]
    v_and_b32 v195, s22, v195
    v_and_b32 v197, s22, v197
    v_mfma_f32_16x16x32_bf16 a[8:11], a[224:227], v[236:239], a[8:11]
    v_and_b32 v199, s22, v199
    v_and_b32 v201, s22, v201
    v_mfma_f32_16x16x32_bf16 a[24:27], a[192:195], v[236:239], a[24:27]
    s_waitcnt lgkmcnt(1)
    v_lshlrev_b32 v252, 16, v193
    v_and_b32 v193, s22, v193
    v_mfma_f32_16x16x32_bf16 a[24:27], a[204:207], v[228:231], a[24:27]
    buffer_load_dwordx4 v[240:243], v254, s[8:11], s42 offen offset:1024 sc1
    v_mfma_f32_16x16x32_bf16 a[28:31], a[208:211], v[228:231], a[28:31]
    v_fmac_f32 v252, s25, v251
    v_fmac_f32 v193, s25, v201
    v_mfma_f32_16x16x32_bf16 a[28:31], a[196:199], v[236:239], a[28:31]
    v_fmac_f32 v252, s28, v249
    v_fmac_f32 v193, s28, v197
    v_mfma_f32_16x16x32_bf16 a[32:35], a[200:203], v[236:239], a[32:35]
    ds_read_b128 v[236:239], v253 offset:10144
    v_cvt_pk_bf16_f32 v193, v252, v193
    v_mfma_f32_16x16x32_bf16 a[32:35], a[212:215], v[228:231], a[32:35]
    buffer_load_dwordx4 v[244:247], v254, s[8:11], s42 offen offset:2048 sc1
    v_mfma_f32_16x16x32_bf16 a[12:15], a[216:219], v[228:231], a[12:15]
    v_lshlrev_b32 v252, 16, v203
    v_and_b32 v203, s22, v203
    v_mfma_f32_16x16x32_bf16 a[16:19], a[220:223], v[228:231], a[16:19]
    v_and_b32 v227, 0x7fff, v255
    v_fmac_f32 v252, s29, v248
    v_mfma_f32_16x16x32_bf16 a[20:23], a[224:227], v[228:231], a[20:23]
    buffer_load_dwordx2 v[216:217], v227, s[4:7], s16 offen offset:1024
    v_mfma_f32_16x16x32_bf16 a[36:39], a[192:195], v[228:231], a[36:39]
    s_waitcnt lgkmcnt(1)
    v_fmac_f32 v203, s29, v195
    v_fmac_f32 v252, s23, v250
    v_mfma_f32_16x16x32_bf16 a[36:39], a[204:207], v[232:235], a[36:39]
    v_fmac_f32 v203, s23, v199
    v_cvt_pk_bf16_f32 v203, v252, v203
    v_mfma_f32_16x16x32_bf16 a[40:43], a[208:211], v[232:235], a[40:43]
    v_fma_f32 v252, v249, s24, v251
    v_fmac_f32 v251, -4.0, v249
    v_mfma_f32_16x16x32_bf16 a[40:43], a[196:199], v[228:231], a[40:43]
    v_fma_f32 v249, v248, s24, v250
    v_fmac_f32 v250, -4.0, v248
    v_mfma_f32_16x16x32_bf16 a[44:47], a[200:203], v[228:231], a[44:47]
    ds_read_b128 v[228:231], v253 offset:9888
    v_fma_f32 v248, v250, s26, v251
    v_mfma_f32_16x16x32_bf16 a[44:47], a[212:215], v[232:235], a[44:47]
    buffer_load_dwordx2 v[218:219], v227, s[4:7], s17 offen offset:1024
    v_mfma_f32_16x16x32_bf16 a[24:27], a[216:219], v[232:235], a[24:27]
    v_fmac_f32 v251, s27, v250
    v_fma_f32 v250, v249, 2.0, v252
    v_mfma_f32_16x16x32_bf16 a[28:31], a[220:223], v[232:235], a[28:31]
    v_fmac_f32 v252, -2.0, v249
    v_fma_f32 v249, v197, s24, v201
    v_mfma_f32_16x16x32_bf16 a[32:35], a[224:227], v[232:235], a[32:35]
    v_fmac_f32 v201, -4.0, v197
    v_fma_f32 v197, v195, s24, v199
    v_mfma_f32_16x16x32_bf16 a[48:51], a[192:195], v[232:235], a[48:51]
    s_waitcnt lgkmcnt(1)
    v_fmac_f32 v199, -4.0, v195
    v_fma_f32 v195, v199, s26, v201
    v_mfma_f32_16x16x32_bf16 a[48:51], a[204:207], v[236:239], a[48:51]
    buffer_load_dwordx2 v[220:221], v227, s[4:7], s18 offen offset:1024
    v_mfma_f32_16x16x32_bf16 a[52:55], a[208:211], v[236:239], a[52:55]
    v_fmac_f32 v201, s27, v199
    v_fma_f32 v199, v197, 2.0, v249
    v_mfma_f32_16x16x32_bf16 a[52:55], a[196:199], v[232:235], a[52:55]
    v_fmac_f32 v249, -2.0, v197
    v_cvt_pk_bf16_f32 v195, v248, v195
    v_mfma_f32_16x16x32_bf16 a[56:59], a[200:203], v[232:235], a[56:59]
    ds_read_b128 v[232:235], v253 offset:9632
    v_cvt_pk_bf16_f32 v201, v251, v201
    v_mfma_f32_16x16x32_bf16 a[56:59], a[212:215], v[236:239], a[56:59]
    v_cvt_pk_bf16_f32 v199, v250, v199
    v_cvt_pk_bf16_f32 v197, v252, v249
    v_mfma_f32_16x16x32_bf16 a[36:39], a[216:219], v[236:239], a[36:39]
    buffer_load_dwordx2 v[222:223], v227, s[4:7], s19 offen offset:1024
    v_mfma_f32_16x16x32_bf16 a[40:43], a[220:223], v[236:239], a[40:43]
    v_lshrrev_b32 v252, 15, v255
    v_mfma_f32_16x16x32_bf16 a[44:47], a[224:227], v[236:239], a[44:47]
    ds_write_b64 v252, v[194:195] offset:768
    v_mfma_f32_16x16x32_bf16 a[60:63], a[192:195], v[236:239], a[60:63]
    s_waitcnt lgkmcnt(2)
    v_lshrrev_b32 v194, 15, v255
    v_mfma_f32_16x16x32_bf16 a[60:63], a[204:207], v[228:231], a[60:63]
    ds_write_b64 v194, v[200:201] offset:2848
    v_mfma_f32_16x16x32_bf16 a[64:67], a[208:211], v[228:231], a[64:67]
    buffer_load_dwordx2 v[224:225], v227, s[4:7], s20 offen offset:1024
    v_mfma_f32_16x16x32_bf16 a[64:67], a[196:199], v[236:239], a[64:67]
    ds_write_b64 v194, v[198:199] offset:4928
    v_mfma_f32_16x16x32_bf16 a[68:71], a[200:203], v[236:239], a[68:71]
    ds_read_b128 v[236:239], v253 offset:9376
    s_waitcnt vmcnt(14)
    v_mfma_f32_16x16x32_bf16 a[68:71], a[212:215], v[228:231], a[68:71]
    ds_write_b64 v194, v[192:193] offset:21568
    v_mfma_f32_16x16x32_bf16 a[48:51], a[216:219], v[228:231], a[48:51]
    v_lshlrev_b32 v248, 16, v206
    v_lshlrev_b32 v249, 16, v208
    v_mfma_f32_16x16x32_bf16 a[52:55], a[220:223], v[228:231], a[52:55]
    buffer_load_dwordx2 v[226:227], v227, s[4:7], s21 offen offset:1024
    v_mfma_f32_16x16x32_bf16 a[56:59], a[224:227], v[228:231], a[56:59]
    ds_write_b64 v194, v[202:203] offset:29888
    v_mfma_f32_16x16x32_bf16 a[72:75], a[192:195], v[228:231], a[72:75]
    s_waitcnt lgkmcnt(6)
    v_lshlrev_b32 v250, 16, v210
    v_lshlrev_b32 v251, 16, v212
    v_mfma_f32_16x16x32_bf16 a[72:75], a[204:207], v[232:235], a[72:75]
    ds_write_b64 v194, v[196:197] offset:7008
    v_mfma_f32_16x16x32_bf16 a[76:79], a[208:211], v[232:235], a[76:79]
    v_and_b32 v206, s22, v206
    v_and_b32 v208, s22, v208
    v_mfma_f32_16x16x32_bf16 a[76:79], a[196:199], v[228:231], a[76:79]
    v_and_b32 v210, s22, v210
    v_and_b32 v212, s22, v212
    v_mfma_f32_16x16x32_bf16 a[80:83], a[200:203], v[228:231], a[80:83]
    ds_read_b128 v[228:231], v253 offset:9104
    v_lshlrev_b32 v252, 16, v204
    v_mfma_f32_16x16x32_bf16 a[80:83], a[212:215], v[232:235], a[80:83]
    s_mov_b32 s42, 516096
    v_and_b32 v204, s22, v204
    v_fmac_f32 v252, s25, v251
    v_mfma_f32_16x16x32_bf16 a[60:63], a[216:219], v[232:235], a[60:63]
    v_fmac_f32 v204, s25, v212
    v_fmac_f32 v252, s28, v249
    v_mfma_f32_16x16x32_bf16 a[64:67], a[220:223], v[232:235], a[64:67]
    v_fmac_f32 v204, s28, v208
    v_cvt_pk_bf16_f32 v204, v252, v204
    v_mfma_f32_16x16x32_bf16 a[68:71], a[224:227], v[232:235], a[68:71]
    v_lshlrev_b32 v252, 16, v214
    v_and_b32 v214, s22, v214
    v_mfma_f32_16x16x32_bf16 a[84:87], a[192:195], v[232:235], a[84:87]
    buffer_load_dwordx4 a[192:195], v254, s[8:11], s42 offen offset:0 sc1
    v_mfma_f32_16x16x32_bf16 a[88:91], a[196:199], v[232:235], a[88:91]
    v_fmac_f32 v252, s29, v248
    v_fmac_f32 v214, s29, v206
    v_mfma_f32_16x16x32_bf16 a[92:95], a[200:203], v[232:235], a[92:95]
    s_waitcnt lgkmcnt(4)
    v_fmac_f32 v252, s23, v250
    v_fmac_f32 v214, s23, v210
    v_mfma_f32_16x16x32_bf16 a[84:87], a[204:207], v[236:239], a[84:87]
    ds_read_b128 v[232:235], v253 offset:11440
    v_cvt_pk_bf16_f32 v214, v252, v214
    v_mfma_f32_16x16x32_bf16 a[88:91], a[208:211], v[236:239], a[88:91]
    buffer_load_dwordx4 a[196:199], v254, s[8:11], s42 offen offset:1024 sc1
    v_mfma_f32_16x16x32_bf16 a[92:95], a[212:215], v[236:239], a[92:95]
    v_fma_f32 v252, v249, s24, v251
    v_fmac_f32 v251, -4.0, v249
    v_mfma_f32_16x16x32_bf16 a[72:75], a[216:219], v[236:239], a[72:75]
    s_waitcnt lgkmcnt(1)
    v_fma_f32 v249, v248, s24, v250
    v_fmac_f32 v250, -4.0, v248
    v_mfma_f32_16x16x32_bf16 a[76:79], a[220:223], v[236:239], a[76:79]
    buffer_load_dwordx4 a[200:203], v254, s[8:11], s42 offen offset:2048 sc1
    v_mfma_f32_16x16x32_bf16 a[80:83], a[224:227], v[236:239], a[80:83]
    ds_read_b128 v[236:239], v253 offset:11168
    v_fma_f32 v248, v250, s26, v251
    v_mfma_f32_16x16x32_bf16 a[84:87], a[216:219], v[228:231], a[84:87]
    s_mov_b32 s42, 519168
    v_fmac_f32 v251, s27, v250
    v_fma_f32 v250, v249, 2.0, v252
    v_mfma_f32_16x16x32_bf16 a[88:91], a[220:223], v[228:231], a[88:91]
    s_waitcnt vmcnt(15) lgkmcnt(1)
    v_fmac_f32 v252, -2.0, v249
    v_fma_f32 v249, v208, s24, v212
    v_mfma_f32_16x16x32_bf16 a[92:95], a[224:227], v[228:231], a[92:95]
    ds_read_b128 v[228:231], v253 offset:10912
    v_fmac_f32 v212, -4.0, v208
sub13:
    v_mfma_f32_16x16x32_bf16 a[96:99], a[228:231], v[232:235], a[96:99]
    buffer_load_dwordx4 a[204:207], v254, s[8:11], s42 offen offset:0 sc1
    v_mfma_f32_16x16x32_bf16 a[100:103], a[232:235], v[232:235], a[100:103]
    s_waitcnt vmcnt(13) lgkmcnt(1)
    v_fma_f32 v208, v206, s24, v210
    v_fmac_f32 v210, -4.0, v206
    v_mfma_f32_16x16x32_bf16 a[104:107], a[236:239], v[232:235], a[104:107]
    ds_read_b128 v[232:235], v253 offset:10656
    v_fma_f32 v206, v210, s26, v212
    v_mfma_f32_16x16x32_bf16 a[96:99], a[240:243], v[236:239], a[96:99]
    v_fmac_f32 v212, s27, v210
    v_fma_f32 v210, v208, 2.0, v249
    v_mfma_f32_16x16x32_bf16 a[100:103], a[244:247], v[236:239], a[100:103]
    buffer_load_dwordx4 a[208:211], v254, s[8:11], s42 offen offset:1024 sc1
    v_mfma_f32_16x16x32_bf16 a[104:107], a[248:251], v[236:239], a[104:107]
    v_fmac_f32 v249, -2.0, v208
    v_cvt_pk_bf16_f32 v206, v248, v206
    v_mfma_f32_16x16x32_bf16 a[108:111], a[228:231], v[236:239], a[108:111]
    s_waitcnt lgkmcnt(1)
    v_cvt_pk_bf16_f32 v212, v251, v212
    v_cvt_pk_bf16_f32 v210, v250, v210
    v_mfma_f32_16x16x32_bf16 a[108:111], a[240:243], v[228:231], a[108:111]
    v_cvt_pk_bf16_f32 v208, v252, v249
    v_lshlrev_b32 v248, 16, v207
    v_mfma_f32_16x16x32_bf16 a[112:115], a[244:247], v[228:231], a[112:115]
    buffer_load_dwordx4 a[212:215], v254, s[8:11], s42 offen offset:2048 sc1
    v_mfma_f32_16x16x32_bf16 a[112:115], a[232:235], v[236:239], a[112:115]
    s_mov_b32 s42, 522240
    v_lshlrev_b32 v249, 16, v209
    v_lshlrev_b32 v250, 16, v211
    v_mfma_f32_16x16x32_bf16 a[116:119], a[236:239], v[236:239], a[116:119]
    ds_read_b128 v[236:239], v253 offset:10400
    v_lshlrev_b32 v251, 16, v213
    v_mfma_f32_16x16x32_bf16 a[116:119], a[248:251], v[228:231], a[116:119]
    s_waitcnt vmcnt(12)
    v_and_b32 v207, s22, v207
    v_and_b32 v209, s22, v209
    v_mfma_f32_16x16x32_bf16 a[96:99], a[252:255], v[228:231], a[96:99]
    buffer_load_dwordx4 a[216:219], v254, s[8:11], s42 offen offset:0 sc1
    v_mfma_f32_16x16x32_bf16 a[100:103], v[240:243], v[228:231], a[100:103]
    v_and_b32 v211, s22, v211
    v_and_b32 v213, s22, v213
    v_mfma_f32_16x16x32_bf16 a[104:107], v[244:247], v[228:231], a[104:107]
    v_lshlrev_b32 v252, 16, v205
    v_and_b32 v205, s22, v205
    v_mfma_f32_16x16x32_bf16 a[120:123], a[228:231], v[228:231], a[120:123]
    s_waitcnt lgkmcnt(1)
    v_fmac_f32 v252, s25, v251
    v_fmac_f32 v205, s25, v213
    v_mfma_f32_16x16x32_bf16 a[120:123], a[240:243], v[232:235], a[120:123]
    buffer_load_dwordx4 a[220:223], v254, s[8:11], s42 offen offset:1024 sc1
    v_mfma_f32_16x16x32_bf16 a[124:127], a[244:247], v[232:235], a[124:127]
    v_fmac_f32 v252, s28, v249
    v_fmac_f32 v205, s28, v209
    v_mfma_f32_16x16x32_bf16 a[124:127], a[232:235], v[228:231], a[124:127]
    v_cvt_pk_bf16_f32 v205, v252, v205
    v_lshlrev_b32 v252, 16, v215
    v_mfma_f32_16x16x32_bf16 a[128:131], a[236:239], v[228:231], a[128:131]
    ds_read_b128 v[228:231], v253 offset:12224
    v_and_b32 v215, s22, v215
    v_mfma_f32_16x16x32_bf16 a[128:131], a[248:251], v[232:235], a[128:131]
    buffer_load_dwordx4 a[224:227], v254, s[8:11], s42 offen offset:2048 sc1
    v_mfma_f32_16x16x32_bf16 a[108:111], a[252:255], v[232:235], a[108:111]
    v_fmac_f32 v252, s29, v248
    v_fmac_f32 v215, s29, v207
    v_mfma_f32_16x16x32_bf16 a[112:115], v[240:243], v[232:235], a[112:115]
    v_and_b32 v203, 0x7fff, v255
    v_fmac_f32 v252, s23, v250
    v_mfma_f32_16x16x32_bf16 a[116:119], v[244:247], v[232:235], a[116:119]
    buffer_load_dwordx2 v[192:193], v203, s[4:7], s16 offen offset:1408
    v_mfma_f32_16x16x32_bf16 a[132:135], a[228:231], v[232:235], a[132:135]
    s_waitcnt lgkmcnt(1)
    v_fmac_f32 v215, s23, v211
    v_cvt_pk_bf16_f32 v215, v252, v215
    v_mfma_f32_16x16x32_bf16 a[132:135], a[240:243], v[236:239], a[132:135]
    v_fma_f32 v252, v249, s24, v251
    v_fmac_f32 v251, -4.0, v249
    v_mfma_f32_16x16x32_bf16 a[136:139], a[244:247], v[236:239], a[136:139]
    v_fma_f32 v249, v248, s24, v250
    v_fmac_f32 v250, -4.0, v248
    v_mfma_f32_16x16x32_bf16 a[136:139], a[232:235], v[232:235], a[136:139]
    v_fma_f32 v248, v250, s26, v251
    v_fmac_f32 v251, s27, v250
    v_mfma_f32_16x16x32_bf16 a[140:143], a[236:239], v[232:235], a[140:143]
    ds_read_b128 v[232:235], v253 offset:11968
    v_fma_f32 v250, v249, 2.0, v252
    v_mfma_f32_16x16x32_bf16 a[140:143], a[248:251], v[236:239], a[140:143]
    buffer_load_dwordx2 v[194:195], v203, s[4:7], s17 offen offset:1408
    v_mfma_f32_16x16x32_bf16 a[120:123], a[252:255], v[236:239], a[120:123]
    v_fmac_f32 v252, -2.0, v249
    v_fma_f32 v249, v209, s24, v213
    v_mfma_f32_16x16x32_bf16 a[124:127], v[240:243], v[236:239], a[124:127]
    v_fmac_f32 v213, -4.0, v209
    v_fma_f32 v209, v207, s24, v211
    v_mfma_f32_16x16x32_bf16 a[128:131], v[244:247], v[236:239], a[128:131]
    v_fmac_f32 v211, -4.0, v207
    v_fma_f32 v207, v211, s26, v213
    v_mfma_f32_16x16x32_bf16 a[144:147], a[228:231], v[236:239], a[144:147]
    s_waitcnt lgkmcnt(1)
    v_fmac_f32 v213, s27, v211
    v_fma_f32 v211, v209, 2.0, v249
    v_mfma_f32_16x16x32_bf16 a[144:147], a[240:243], v[228:231], a[144:147]
    buffer_load_dwordx2 v[196:197], v203, s[4:7], s18 offen offset:1408
    v_mfma_f32_16x16x32_bf16 a[148:151], a[244:247], v[228:231], a[148:151]
    v_fmac_f32 v249, -2.0, v209
    v_cvt_pk_bf16_f32 v207, v248, v207
    v_mfma_f32_16x16x32_bf16 a[148:151], a[232:235], v[236:239], a[148:151]
    v_cvt_pk_bf16_f32 v213, v251, v213
    v_cvt_pk_bf16_f32 v211, v250, v211
    v_mfma_f32_16x16x32_bf16 a[152:155], a[236:239], v[236:239], a[152:155]
    ds_read_b128 v[236:239], v253 offset:11712
    v_cvt_pk_bf16_f32 v209, v252, v249
    v_mfma_f32_16x16x32_bf16 a[152:155], a[248:251], v[228:231], a[152:155]
    v_lshrrev_b32 v252, 15, v255
    v_mfma_f32_16x16x32_bf16 a[132:135], a[252:255], v[228:231], a[132:135]
    buffer_load_dwordx2 v[198:199], v203, s[4:7], s19 offen offset:1408
    v_mfma_f32_16x16x32_bf16 a[136:139], v[240:243], v[228:231], a[136:139]
    ds_write_b64 v252, v[206:207] offset:512
    v_mfma_f32_16x16x32_bf16 a[140:143], v[244:247], v[228:231], a[140:143]
    v_lshrrev_b32 v206, 15, v255
    v_mfma_f32_16x16x32_bf16 a[156:159], a[228:231], v[228:231], a[156:159]
    s_waitcnt lgkmcnt(2)
    v_mfma_f32_16x16x32_bf16 a[156:159], a[240:243], v[232:235], a[156:159]
    ds_write_b64 v206, v[212:213] offset:2592
    v_mfma_f32_16x16x32_bf16 a[160:163], a[244:247], v[232:235], a[160:163]
    buffer_load_dwordx2 v[200:201], v203, s[4:7], s20 offen offset:1408
    v_mfma_f32_16x16x32_bf16 a[160:163], a[232:235], v[228:231], a[160:163]
    ds_write_b64 v206, v[210:211] offset:4672
    v_mfma_f32_16x16x32_bf16 a[164:167], a[236:239], v[228:231], a[164:167]
    ds_read_b128 v[228:231], v253 offset:11456
    s_waitcnt vmcnt(14)
    v_mfma_f32_16x16x32_bf16 a[164:167], a[248:251], v[232:235], a[164:167]
    ds_write_b64 v206, v[204:205] offset:21312
    v_mfma_f32_16x16x32_bf16 a[144:147], a[252:255], v[232:235], a[144:147]
    v_lshlrev_b32 v248, 16, v218
    v_lshlrev_b32 v249, 16, v220
    v_mfma_f32_16x16x32_bf16 a[148:151], v[240:243], v[232:235], a[148:151]
    buffer_load_dwordx2 v[202:203], v203, s[4:7], s21 offen offset:1408
    v_mfma_f32_16x16x32_bf16 a[152:155], v[244:247], v[232:235], a[152:155]
    ds_write_b64 v206, v[214:215] offset:29632
    v_mfma_f32_16x16x32_bf16 a[168:171], a[228:231], v[232:235], a[168:171]
    s_waitcnt lgkmcnt(6)
    v_lshlrev_b32 v250, 16, v222
    v_lshlrev_b32 v251, 16, v224
    v_mfma_f32_16x16x32_bf16 a[168:171], a[240:243], v[236:239], a[168:171]
    ds_write_b64 v206, v[208:209] offset:6752
    v_mfma_f32_16x16x32_bf16 a[172:175], a[244:247], v[236:239], a[172:175]
    ds_read_b128 v[204:207], v253 offset:40288
    s_mov_b32 s45, 472974346
    v_mfma_f32_16x16x32_bf16 a[172:175], a[232:235], v[232:235], a[172:175]
    v_bfe_u32 v208, v254, 5, 3
    v_mul_u32_u24 v209, 5, v208
    v_mfma_f32_16x16x32_bf16 a[176:179], a[236:239], v[232:235], a[176:179]
    ds_read_b128 v[232:235], v253 offset:11184
    v_bfe_u32 v209, s45, v209, 5
    v_mfma_f32_16x16x32_bf16 a[176:179], a[248:251], v[236:239], a[176:179]
    s_mov_b32 s42, 552960
    v_mul_u32_u24 v209, 65, v209
    v_sub_u32 v209, v209, v208
    v_mfma_f32_16x16x32_bf16 a[156:159], a[252:255], v[236:239], a[156:159]
    v_lshl_add_u32 v208, v209, 5, v253
    s_waitcnt lgkmcnt(1)
    v_mfma_f32_16x16x32_bf16 a[160:163], v[240:243], v[236:239], a[160:163]
    s_mov_b64 exec, s[46:47]
    ds_write_b128 v208, v[204:207] offset:1024
    s_mov_b64 exec, -1
    v_mfma_f32_16x16x32_bf16 a[164:167], v[244:247], v[236:239], a[164:167]
    v_and_b32 v218, s22, v218
    v_and_b32 v220, s22, v220
    v_mfma_f32_16x16x32_bf16 a[180:183], a[228:231], v[236:239], a[180:183]
    buffer_load_dwordx4 a[228:231], v254, s[8:11], s42 offen offset:0 sc1
    v_mfma_f32_16x16x32_bf16 a[184:187], a[232:235], v[236:239], a[184:187]
    v_and_b32 v222, s22, v222
    v_and_b32 v224, s22, v224
    v_mfma_f32_16x16x32_bf16 a[188:191], a[236:239], v[236:239], a[188:191]
    v_lshlrev_b32 v252, 16, v216
    v_and_b32 v216, s22, v216
    v_mfma_f32_16x16x32_bf16 a[180:183], a[240:243], v[228:231], a[180:183]
    ds_read_b128 v[236:239], v253 offset:13520
    v_fmac_f32 v252, s25, v251
    v_mfma_f32_16x16x32_bf16 a[184:187], a[244:247], v[228:231], a[184:187]
    buffer_load_dwordx4 a[232:235], v254, s[8:11], s42 offen offset:1024 sc1
    v_mfma_f32_16x16x32_bf16 a[188:191], a[248:251], v[228:231], a[188:191]
    v_fmac_f32 v216, s25, v224
    v_fmac_f32 v252, s28, v249
    v_mfma_f32_16x16x32_bf16 a[168:171], a[252:255], v[228:231], a[168:171]
    s_waitcnt lgkmcnt(2)
    v_fmac_f32 v216, s28, v220
    v_cvt_pk_bf16_f32 v216, v252, v216
    v_mfma_f32_16x16x32_bf16 a[172:175], v[240:243], v[228:231], a[172:175]
    buffer_load_dwordx4 a[236:239], v254, s[8:11], s42 offen offset:2048 sc1
    v_mfma_f32_16x16x32_bf16 a[176:179], v[244:247], v[228:231], a[176:179]
    ds_read_b128 v[228:231], v253 offset:13248
    v_lshlrev_b32 v252, 16, v226
    v_mfma_f32_16x16x32_bf16 a[180:183], a[252:255], v[232:235], a[180:183]
    s_mov_b32 s42, 556032
    v_and_b32 v226, s22, v226
    v_fmac_f32 v252, s29, v248
    v_mfma_f32_16x16x32_bf16 a[184:187], v[240:243], v[232:235], a[184:187]
    s_waitcnt vmcnt(15) lgkmcnt(1)
    v_fmac_f32 v226, s29, v218
    v_fmac_f32 v252, s23, v250
    v_mfma_f32_16x16x32_bf16 a[188:191], v[244:247], v[232:235], a[188:191]
    ds_read_b128 v[232:235], v253 offset:12992
    v_fmac_f32 v226, s23, v222
sub14:
    v_mfma_f32_16x16x32_bf16 v[0:3], a[192:195], v[236:239], v[0:3]
    buffer_load_dwordx4 a[240:243], v254, s[8:11], s42 offen offset:0 sc1
    v_mfma_f32_16x16x32_bf16 v[4:7], a[196:199], v[236:239], v[4:7]
    s_waitcnt vmcnt(13) lgkmcnt(1)
    v_cvt_pk_bf16_f32 v226, v252, v226
    v_fma_f32 v252, v249, s24, v251
    v_mfma_f32_16x16x32_bf16 v[8:11], a[200:203], v[236:239], v[8:11]
    ds_read_b128 v[236:239], v253 offset:12736
    v_fmac_f32 v251, -4.0, v249
    v_mfma_f32_16x16x32_bf16 v[0:3], a[204:207], v[228:231], v[0:3]
    v_fma_f32 v249, v248, s24, v250
    v_fmac_f32 v250, -4.0, v248
    v_mfma_f32_16x16x32_bf16 v[4:7], a[208:211], v[228:231], v[4:7]
    buffer_load_dwordx4 a[244:247], v254, s[8:11], s42 offen offset:1024 sc1
    v_mfma_f32_16x16x32_bf16 v[8:11], a[212:215], v[228:231], v[8:11]
    v_fma_f32 v248, v250, s26, v251
    v_fmac_f32 v251, s27, v250
    v_mfma_f32_16x16x32_bf16 v[12:15], a[192:195], v[228:231], v[12:15]
    s_waitcnt lgkmcnt(1)
    v_fma_f32 v250, v249, 2.0, v252
    v_fmac_f32 v252, -2.0, v249
    v_mfma_f32_16x16x32_bf16 v[12:15], a[204:207], v[232:235], v[12:15]
    v_fma_f32 v249, v220, s24, v224
    v_fmac_f32 v224, -4.0, v220
    v_mfma_f32_16x16x32_bf16 v[16:19], a[208:211], v[232:235], v[16:19]
    buffer_load_dwordx4 a[248:251], v254, s[8:11], s42 offen offset:2048 sc1
    v_mfma_f32_16x16x32_bf16 v[16:19], a[196:199], v[228:231], v[16:19]
    s_mov_b32 s42, 559104
    v_fma_f32 v220, v218, s24, v222
    v_fmac_f32 v222, -4.0, v218
    v_mfma_f32_16x16x32_bf16 v[20:23], a[200:203], v[228:231], v[20:23]
    ds_read_b128 v[228:231], v253 offset:12480
    v_fma_f32 v218, v222, s26, v224
    v_mfma_f32_16x16x32_bf16 v[20:23], a[212:215], v[232:235], v[20:23]
    s_waitcnt vmcnt(12)
    v_fmac_f32 v224, s27, v222
    v_fma_f32 v222, v220, 2.0, v249
    v_mfma_f32_16x16x32_bf16 v[0:3], a[216:219], v[232:235], v[0:3]
    buffer_load_dwordx4 a[252:255], v254, s[8:11], s42 offen offset:0 sc1
    v_mfma_f32_16x16x32_bf16 v[4:7], a[220:223], v[232:235], v[4:7]
    v_fmac_f32 v249, -2.0, v220
    v_cvt_pk_bf16_f32 v218, v248, v218
    v_mfma_f32_16x16x32_bf16 v[8:11], a[224:227], v[232:235], v[8:11]
    v_cvt_pk_bf16_f32 v224, v251, v224
    v_cvt_pk_bf16_f32 v222, v250, v222
    v_mfma_f32_16x16x32_bf16 v[24:27], a[192:195], v[232:235], v[24:27]
    s_waitcnt lgkmcnt(1)
    v_cvt_pk_bf16_f32 v220, v252, v249
    v_lshlrev_b32 v248, 16, v219
    v_mfma_f32_16x16x32_bf16 v[24:27], a[204:207], v[236:239], v[24:27]
    buffer_load_dwordx4 v[240:243], v254, s[8:11], s42 offen offset:1024 sc1
    v_mfma_f32_16x16x32_bf16 v[28:31], a[208:211], v[236:239], v[28:31]
    v_lshlrev_b32 v249, 16, v221
    v_lshlrev_b32 v250, 16, v223
    v_mfma_f32_16x16x32_bf16 v[28:31], a[196:199], v[232:235], v[28:31]
    v_lshlrev_b32 v251, 16, v225
    v_and_b32 v219, s22, v219
    v_mfma_f32_16x16x32_bf16 v[32:35], a[200:203], v[232:235], v[32:35]
    ds_read_b128 v[232:235], v253 offset:14304
    v_and_b32 v221, s22, v221
    v_mfma_f32_16x16x32_bf16 v[32:35], a[212:215], v[236:239], v[32:35]
    buffer_load_dwordx4 v[244:247], v254, s[8:11], s42 offen offset:2048 sc1
    v_mfma_f32_16x16x32_bf16 v[12:15], a[216:219], v[236:239], v[12:15]
    v_and_b32 v223, s22, v223
    v_and_b32 v225, s22, v225
    v_mfma_f32_16x16x32_bf16 v[16:19], a[220:223], v[236:239], v[16:19]
    v_and_b32 v215, 0x7fff, v255
    v_lshlrev_b32 v252, 16, v217
    v_mfma_f32_16x16x32_bf16 v[20:23], a[224:227], v[236:239], v[20:23]
    buffer_load_dwordx2 v[204:205], v215, s[4:7], s16 offen offset:320
    v_mfma_f32_16x16x32_bf16 v[36:39], a[192:195], v[236:239], v[36:39]
    s_waitcnt lgkmcnt(1)
    v_and_b32 v217, s22, v217
    v_fmac_f32 v252, s25, v251
    v_mfma_f32_16x16x32_bf16 v[36:39], a[204:207], v[228:231], v[36:39]
    v_fmac_f32 v217, s25, v225
    v_fmac_f32 v252, s28, v249
    v_mfma_f32_16x16x32_bf16 v[40:43], a[208:211], v[228:231], v[40:43]
    v_fmac_f32 v217, s28, v221
    v_cvt_pk_bf16_f32 v217, v252, v217
    v_mfma_f32_16x16x32_bf16 v[40:43], a[196:199], v[236:239], v[40:43]
    v_lshlrev_b32 v252, 16, v227
    v_and_b32 v227, s22, v227
    v_mfma_f32_16x16x32_bf16 v[44:47], a[200:203], v[236:239], v[44:47]
    ds_read_b128 v[236:239], v253 offset:14048
    v_fmac_f32 v252, s29, v248
    v_mfma_f32_16x16x32_bf16 v[44:47], a[212:215], v[228:231], v[44:47]
    buffer_load_dwordx2 v[206:207], v215, s[4:7], s17 offen offset:320
    v_mfma_f32_16x16x32_bf16 v[24:27], a[216:219], v[228:231], v[24:27]
    v_fmac_f32 v227, s29, v219
    v_fmac_f32 v252, s23, v250
    v_mfma_f32_16x16x32_bf16 v[28:31], a[220:223], v[228:231], v[28:31]
    v_fmac_f32 v227, s23, v223
    v_cvt_pk_bf16_f32 v227, v252, v227
    v_mfma_f32_16x16x32_bf16 v[32:35], a[224:227], v[228:231], v[32:35]
    v_fma_f32 v252, v249, s24, v251
    v_fmac_f32 v251, -4.0, v249
    v_mfma_f32_16x16x32_bf16 v[48:51], a[192:195], v[228:231], v[48:51]
    s_waitcnt lgkmcnt(1)
    v_fma_f32 v249, v248, s24, v250
    v_fmac_f32 v250, -4.0, v248
    v_mfma_f32_16x16x32_bf16 v[48:51], a[204:207], v[232:235], v[48:51]
    buffer_load_dwordx2 v[208:209], v215, s[4:7], s18 offen offset:320
    v_mfma_f32_16x16x32_bf16 v[52:55], a[208:211], v[232:235], v[52:55]
    v_fma_f32 v248, v250, s26, v251
    v_fmac_f32 v251, s27, v250
    v_mfma_f32_16x16x32_bf16 v[52:55], a[196:199], v[228:231], v[52:55]
    v_fma_f32 v250, v249, 2.0, v252
    v_fmac_f32 v252, -2.0, v249
    v_mfma_f32_16x16x32_bf16 v[56:59], a[200:203], v[228:231], v[56:59]
    ds_read_b128 v[228:231], v253 offset:13792
    v_fma_f32 v249, v221, s24, v225
    v_mfma_f32_16x16x32_bf16 v[56:59], a[212:215], v[232:235], v[56:59]
    v_fmac_f32 v225, -4.0, v221
    v_fma_f32 v221, v219, s24, v223
    v_mfma_f32_16x16x32_bf16 v[36:39], a[216:219], v[232:235], v[36:39]
    buffer_load_dwordx2 v[210:211], v215, s[4:7], s19 offen offset:320
    v_mfma_f32_16x16x32_bf16 v[40:43], a[220:223], v[232:235], v[40:43]
    v_fmac_f32 v223, -4.0, v219
    v_fma_f32 v219, v223, s26, v225
    v_mfma_f32_16x16x32_bf16 v[44:47], a[224:227], v[232:235], v[44:47]
    v_fmac_f32 v225, s27, v223
    v_fma_f32 v223, v221, 2.0, v249
    v_mfma_f32_16x16x32_bf16 v[60:63], a[192:195], v[232:235], v[60:63]
    s_waitcnt lgkmcnt(1)
    v_fmac_f32 v249, -2.0, v221
    v_cvt_pk_bf16_f32 v219, v248, v219
    v_mfma_f32_16x16x32_bf16 v[60:63], a[204:207], v[236:239], v[60:63]
    v_cvt_pk_bf16_f32 v225, v251, v225
    v_cvt_pk_bf16_f32 v223, v250, v223
    v_mfma_f32_16x16x32_bf16 v[64:67], a[208:211], v[236:239], v[64:67]
    buffer_load_dwordx2 v[212:213], v215, s[4:7], s20 offen offset:320
    v_mfma_f32_16x16x32_bf16 v[64:67], a[196:199], v[232:235], v[64:67]
    v_cvt_pk_bf16_f32 v221, v252, v249
    v_lshrrev_b32 v252, 15, v255
    v_mfma_f32_16x16x32_bf16 v[68:71], a[200:203], v[232:235], v[68:71]
    ds_read_b128 v[232:235], v253 offset:13536
    v_mfma_f32_16x16x32_bf16 v[68:71], a[212:215], v[236:239], v[68:71]
pad5:
    s_cbranch_vccnz pad9
    ds_write_b64 v252, v[218:219] offset:256
    v_mfma_f32_16x16x32_bf16 v[48:51], a[216:219], v[236:239], v[48:51]
    s_waitcnt vmcnt(14)
    v_lshrrev_b32 v218, 15, v255
    v_lshlrev_b32 v248, 16, v194
    v_mfma_f32_16x16x32_bf16 v[52:55], a[220:223], v[236:239], v[52:55]
    buffer_load_dwordx2 v[214:215], v215, s[4:7], s21 offen offset:320
    v_mfma_f32_16x16x32_bf16 v[56:59], a[224:227], v[236:239], v[56:59]
    ds_write_b64 v218, v[224:225] offset:2336
    v_mfma_f32_16x16x32_bf16 v[72:75], a[192:195], v[236:239], v[72:75]
    s_waitcnt lgkmcnt(3)
    v_lshlrev_b32 v249, 16, v196
    v_lshlrev_b32 v250, 16, v198
    v_mfma_f32_16x16x32_bf16 v[72:75], a[204:207], v[228:231], v[72:75]
    ds_write_b64 v218, v[222:223] offset:4416
    v_mfma_f32_16x16x32_bf16 v[76:79], a[208:211], v[228:231], v[76:79]
    v_lshlrev_b32 v251, 16, v200
    v_and_b32 v194, s22, v194
    v_mfma_f32_16x16x32_bf16 v[76:79], a[196:199], v[236:239], v[76:79]
    ds_write_b64 v218, v[216:217] offset:21056
    v_mfma_f32_16x16x32_bf16 v[80:83], a[200:203], v[236:239], v[80:83]
    ds_read_b128 v[236:239], v253 offset:13264
    v_and_b32 v196, s22, v196
    v_mfma_f32_16x16x32_bf16 v[80:83], a[212:215], v[228:231], v[80:83]
    s_mov_b32 s42, 589824
    v_and_b32 v198, s22, v198
    v_and_b32 v200, s22, v200
    v_mfma_f32_16x16x32_bf16 v[60:63], a[216:219], v[228:231], v[60:63]
    ds_write_b64 v218, v[226:227] offset:29376
    v_mfma_f32_16x16x32_bf16 v[64:67], a[220:223], v[228:231], v[64:67]
    v_lshlrev_b32 v252, 16, v192
    v_and_b32 v192, s22, v192
    v_mfma_f32_16x16x32_bf16 v[68:71], a[224:227], v[228:231], v[68:71]
    ds_write_b64 v218, v[220:221] offset:6496
    v_mfma_f32_16x16x32_bf16 v[84:87], a[192:195], v[228:231], v[84:87]
    buffer_load_dwordx4 a[192:195], v254, s[8:11], s42 offen offset:0 sc1
    v_mfma_f32_16x16x32_bf16 v[88:91], a[196:199], v[228:231], v[88:91]
    v_fmac_f32 v252, s25, v251
    v_fmac_f32 v192, s25, v200
    v_mfma_f32_16x16x32_bf16 v[92:95], a[200:203], v[228:231], v[92:95]
    s_waitcnt lgkmcnt(7)
    v_fmac_f32 v252, s28, v249
    v_fmac_f32 v192, s28, v196
    v_mfma_f32_16x16x32_bf16 v[84:87], a[204:207], v[232:235], v[84:87]
    ds_read_b128 v[228:231], v253 offset:32240
    v_cvt_pk_bf16_f32 v192, v252, v192
    v_mfma_f32_16x16x32_bf16 v[88:91], a[208:211], v[232:235], v[88:91]
    buffer_load_dwordx4 a[196:199], v254, s[8:11], s42 offen offset:1024 sc1
    v_mfma_f32_16x16x32_bf16 v[92:95], a[212:215], v[232:235], v[92:95]
    v_lshlrev_b32 v252, 16, v202
    v_and_b32 v202, s22, v202
    v_mfma_f32_16x16x32_bf16 v[72:75], a[216:219], v[232:235], v[72:75]
    s_waitcnt lgkmcnt(3)
    v_fmac_f32 v252, s29, v248
    v_fmac_f32 v202, s29, v194
    v_mfma_f32_16x16x32_bf16 v[76:79], a[220:223], v[232:235], v[76:79]
    buffer_load_dwordx4 a[200:203], v254, s[8:11], s42 offen offset:2048 sc1
    v_mfma_f32_16x16x32_bf16 v[80:83], a[224:227], v[232:235], v[80:83]
    ds_read_b128 v[232:235], v253 offset:31968
    v_fmac_f32 v252, s23, v250
    v_mfma_f32_16x16x32_bf16 v[84:87], a[216:219], v[236:239], v[84:87]
    s_mov_b32 s42, 592896
    v_fmac_f32 v202, s23, v198
    v_cvt_pk_bf16_f32 v202, v252, v202
    v_mfma_f32_16x16x32_bf16 v[88:91], a[220:223], v[236:239], v[88:91]
    s_waitcnt vmcnt(15) lgkmcnt(1)
    v_fma_f32 v252, v249, s24, v251
    v_fmac_f32 v251, -4.0, v249
    v_mfma_f32_16x16x32_bf16 v[92:95], a[224:227], v[236:239], v[92:95]
    ds_read_b128 v[236:239], v253 offset:31712
    v_fma_f32 v249, v248, s24, v250
sub15:
    v_mfma_f32_16x16x32_bf16 v[96:99], a[228:231], v[228:231], v[96:99]
    buffer_load_dwordx4 a[204:207], v254, s[8:11], s42 offen offset:0 sc1
    v_mfma_f32_16x16x32_bf16 v[100:103], a[232:235], v[228:231], v[100:103]
    s_waitcnt vmcnt(13) lgkmcnt(1)
    v_fmac_f32 v250, -4.0, v248
    v_fma_f32 v248, v250, s26, v251
    v_mfma_f32_16x16x32_bf16 v[104:107], a[236:239], v[228:231], v[104:107]
    ds_read_b128 v[228:231], v253 offset:31456
    v_fmac_f32 v251, s27, v250
    v_mfma_f32_16x16x32_bf16 v[96:99], a[240:243], v[232:235], v[96:99]
    v_fma_f32 v250, v249, 2.0, v252
    v_fmac_f32 v252, -2.0, v249
    v_mfma_f32_16x16x32_bf16 v[100:103], a[244:247], v[232:235], v[100:103]
    buffer_load_dwordx4 a[208:211], v254, s[8:11], s42 offen offset:1024 sc1
    v_mfma_f32_16x16x32_bf16 v[104:107], a[248:251], v[232:235], v[104:107]
    v_fma_f32 v249, v196, s24, v200
    v_fmac_f32 v200, -4.0, v196
    v_mfma_f32_16x16x32_bf16 v[108:111], a[228:231], v[232:235], v[108:111]
    s_waitcnt lgkmcnt(1)
    v_fma_f32 v196, v194, s24, v198
    v_fmac_f32 v198, -4.0, v194
    v_mfma_f32_16x16x32_bf16 v[108:111], a[240:243], v[236:239], v[108:111]
    v_fma_f32 v194, v198, s26, v200
    v_fmac_f32 v200, s27, v198
    v_mfma_f32_16x16x32_bf16 v[112:115], a[244:247], v[236:239], v[112:115]
    buffer_load_dwordx4 a[212:215], v254, s[8:11], s42 offen offset:2048 sc1
    v_mfma_f32_16x16x32_bf16 v[112:115], a[232:235], v[232:235], v[112:115]
    s_mov_b32 s42, 595968
    v_fma_f32 v198, v196, 2.0, v249
    v_fmac_f32 v249, -2.0, v196
    v_mfma_f32_16x16x32_bf16 v[116:119], a[236:239], v[232:235], v[116:119]
    ds_read_b128 v[232:235], v253 offset:31200
    v_cvt_pk_bf16_f32 v194, v248, v194
    v_mfma_f32_16x16x32_bf16 v[116:119], a[248:251], v[236:239], v[116:119]
    s_waitcnt vmcnt(12)
    v_cvt_pk_bf16_f32 v200, v251, v200
    v_cvt_pk_bf16_f32 v198, v250, v198
    v_mfma_f32_16x16x32_bf16 v[96:99], a[252:255], v[236:239], v[96:99]
    buffer_load_dwordx4 a[216:219], v254, s[8:11], s42 offen offset:0 sc1
    v_mfma_f32_16x16x32_bf16 v[100:103], v[240:243], v[236:239], v[100:103]
    v_cvt_pk_bf16_f32 v196, v252, v249
    v_lshlrev_b32 v248, 16, v195
    v_mfma_f32_16x16x32_bf16 v[104:107], v[244:247], v[236:239], v[104:107]
    v_lshlrev_b32 v249, 16, v197
    v_lshlrev_b32 v250, 16, v199
    v_mfma_f32_16x16x32_bf16 v[120:123], a[228:231], v[236:239], v[120:123]
    s_waitcnt lgkmcnt(1)
    v_lshlrev_b32 v251, 16, v201
    v_and_b32 v195, s22, v195
    v_mfma_f32_16x16x32_bf16 v[120:123], a[240:243], v[228:231], v[120:123]
    buffer_load_dwordx4 a[220:223], v254, s[8:11], s42 offen offset:1024 sc1
    v_mfma_f32_16x16x32_bf16 v[124:127], a[244:247], v[228:231], v[124:127]
    v_and_b32 v197, s22, v197
    v_and_b32 v199, s22, v199
    v_mfma_f32_16x16x32_bf16 v[124:127], a[232:235], v[236:239], v[124:127]
    v_and_b32 v201, s22, v201
    v_lshlrev_b32 v252, 16, v193
    v_mfma_f32_16x16x32_bf16 v[128:131], a[236:239], v[236:239], v[128:131]
    ds_read_b128 v[236:239], v253 offset:33024
    v_and_b32 v193, s22, v193
    v_mfma_f32_16x16x32_bf16 v[128:131], a[248:251], v[228:231], v[128:131]
    buffer_load_dwordx4 a[224:227], v254, s[8:11], s42 offen offset:2048 sc1
    v_mfma_f32_16x16x32_bf16 v[108:111], a[252:255], v[228:231], v[108:111]
    v_fmac_f32 v252, s25, v251
    v_fmac_f32 v193, s25, v201
    v_mfma_f32_16x16x32_bf16 v[112:115], v[240:243], v[228:231], v[112:115]
    v_and_b32 v227, 0x7fff, v255
    v_fmac_f32 v252, s28, v249
    v_mfma_f32_16x16x32_bf16 v[116:119], v[244:247], v[228:231], v[116:119]
    buffer_load_dwordx2 v[216:217], v227, s[4:7], s16 offen offset:704
    v_mfma_f32_16x16x32_bf16 v[132:135], a[228:231], v[228:231], v[132:135]
    s_waitcnt lgkmcnt(1)
    v_fmac_f32 v193, s28, v197
    v_cvt_pk_bf16_f32 v193, v252, v193
    v_mfma_f32_16x16x32_bf16 v[132:135], a[240:243], v[232:235], v[132:135]
    v_lshlrev_b32 v252, 16, v203
    v_and_b32 v203, s22, v203
    v_mfma_f32_16x16x32_bf16 v[136:139], a[244:247], v[232:235], v[136:139]
    v_fmac_f32 v252, s29, v248
    v_fmac_f32 v203, s29, v195
    v_mfma_f32_16x16x32_bf16 v[136:139], a[232:235], v[228:231], v[136:139]
    v_fmac_f32 v252, s23, v250
    v_fmac_f32 v203, s23, v199
    v_mfma_f32_16x16x32_bf16 v[140:143], a[236:239], v[228:231], v[140:143]
    ds_read_b128 v[228:231], v253 offset:32768
    v_cvt_pk_bf16_f32 v203, v252, v203
    v_mfma_f32_16x16x32_bf16 v[140:143], a[248:251], v[232:235], v[140:143]
    buffer_load_dwordx2 v[218:219], v227, s[4:7], s17 offen offset:704
    v_mfma_f32_16x16x32_bf16 v[120:123], a[252:255], v[232:235], v[120:123]
    v_fma_f32 v252, v249, s24, v251
    v_fmac_f32 v251, -4.0, v249
    v_mfma_f32_16x16x32_bf16 v[124:127], v[240:243], v[232:235], v[124:127]
    v_fma_f32 v249, v248, s24, v250
    v_fmac_f32 v250, -4.0, v248
    v_mfma_f32_16x16x32_bf16 v[128:131], v[244:247], v[232:235], v[128:131]
    v_fma_f32 v248, v250, s26, v251
    v_fmac_f32 v251, s27, v250
    v_mfma_f32_16x16x32_bf16 v[144:147], a[228:231], v[232:235], v[144:147]
    s_waitcnt lgkmcnt(1)
    v_fma_f32 v250, v249, 2.0, v252
    v_fmac_f32 v252, -2.0, v249
    v_mfma_f32_16x16x32_bf16 v[144:147], a[240:243], v[236:239], v[144:147]
    buffer_load_dwordx2 v[220:221], v227, s[4:7], s18 offen offset:704
    v_mfma_f32_16x16x32_bf16 v[148:151], a[244:247], v[236:239], v[148:151]
    v_fma_f32 v249, v197, s24, v201
    v_fmac_f32 v201, -4.0, v197
    v_mfma_f32_16x16x32_bf16 v[148:151], a[232:235], v[232:235], v[148:151]
    v_fma_f32 v197, v195, s24, v199
    v_fmac_f32 v199, -4.0, v195
    v_mfma_f32_16x16x32_bf16 v[152:155], a[236:239], v[232:235], v[152:155]
    ds_read_b128 v[232:235], v253 offset:32512
    v_fma_f32 v195, v199, s26, v201
    v_mfma_f32_16x16x32_bf16 v[152:155], a[248:251], v[236:239], v[152:155]
    v_fmac_f32 v201, s27, v199
    v_fma_f32 v199, v197, 2.0, v249
    v_mfma_f32_16x16x32_bf16 v[132:135], a[252:255], v[236:239], v[132:135]
    buffer_load_dwordx2 v[222:223], v227, s[4:7], s19 offen offset:704
    v_mfma_f32_16x16x32_bf16 v[136:139], v[240:243], v[236:239], v[136:139]
    v_fmac_f32 v249, -2.0, v197
    v_cvt_pk_bf16_f32 v195, v248, v195
    v_mfma_f32_16x16x32_bf16 v[140:143], v[244:247], v[236:239], v[140:143]
    v_cvt_pk_bf16_f32 v201, v251, v201
    v_cvt_pk_bf16_f32 v199, v250, v199
    v_mfma_f32_16x16x32_bf16 v[156:159], a[228:231], v[236:239], v[156:159]
    s_waitcnt lgkmcnt(1)
    v_cvt_pk_bf16_f32 v197, v252, v249
    v_lshrrev_b32 v252, 15, v255
    v_mfma_f32_16x16x32_bf16 v[156:159], a[240:243], v[228:231], v[156:159]
    ds_write_b64 v252, v[194:195] offset:0
    v_mfma_f32_16x16x32_bf16 v[160:163], a[244:247], v[228:231], v[160:163]
    buffer_load_dwordx2 v[224:225], v227, s[4:7], s20 offen offset:704
    v_mfma_f32_16x16x32_bf16 v[160:163], a[232:235], v[236:239], v[160:163]
    v_lshrrev_b32 v194, 15, v255
    v_mfma_f32_16x16x32_bf16 v[164:167], a[236:239], v[236:239], v[164:167]
    ds_read_b128 v[236:239], v253 offset:32256
    s_waitcnt vmcnt(14)
    v_mfma_f32_16x16x32_bf16 v[164:167], a[248:251], v[228:231], v[164:167]
    ds_write_b64 v194, v[200:201] offset:2080
    v_mfma_f32_16x16x32_bf16 v[144:147], a[252:255], v[228:231], v[144:147]
    v_lshlrev_b32 v248, 16, v206
    v_lshlrev_b32 v249, 16, v208
    v_mfma_f32_16x16x32_bf16 v[148:151], v[240:243], v[228:231], v[148:151]
    buffer_load_dwordx2 v[226:227], v227, s[4:7], s21 offen offset:704
    v_mfma_f32_16x16x32_bf16 v[152:155], v[244:247], v[228:231], v[152:155]
    ds_write_b64 v194, v[198:199] offset:4160
    v_mfma_f32_16x16x32_bf16 v[168:171], a[228:231], v[228:231], v[168:171]
    s_waitcnt lgkmcnt(4)
    v_lshlrev_b32 v250, 16, v210
    v_lshlrev_b32 v251, 16, v212
    v_mfma_f32_16x16x32_bf16 v[168:171], a[240:243], v[232:235], v[168:171]
    ds_write_b64 v194, v[192:193] offset:20800
    v_mfma_f32_16x16x32_bf16 v[172:175], a[244:247], v[232:235], v[172:175]
    v_and_b32 v206, s22, v206
    v_and_b32 v208, s22, v208
    v_mfma_f32_16x16x32_bf16 v[172:175], a[232:235], v[228:231], v[172:175]
    ds_write_b64 v194, v[202:203] offset:29120
    v_mfma_f32_16x16x32_bf16 v[176:179], a[236:239], v[228:231], v[176:179]
    ds_read_b128 v[228:231], v253 offset:31984
    v_and_b32 v210, s22, v210
    v_mfma_f32_16x16x32_bf16 v[176:179], a[248:251], v[232:235], v[176:179]
    s_mov_b32 s42, 626688
    v_and_b32 v212, s22, v212
    v_lshlrev_b32 v252, 16, v204
    v_mfma_f32_16x16x32_bf16 v[156:159], a[252:255], v[232:235], v[156:159]
    ds_write_b64 v194, v[196:197] offset:6240
    v_mfma_f32_16x16x32_bf16 v[160:163], v[240:243], v[232:235], v[160:163]
    v_and_b32 v204, s22, v204
    v_fmac_f32 v252, s25, v251
    v_mfma_f32_16x16x32_bf16 v[164:167], v[244:247], v[232:235], v[164:167]
    s_waitcnt lgkmcnt(6)
    v_fmac_f32 v204, s25, v212
    v_fmac_f32 v252, s28, v249
    v_fmac_f32 v204, s28, v208
    v_mfma_f32_16x16x32_bf16 v[180:183], a[228:231], v[232:235], v[180:183]
    buffer_load_dwordx4 a[228:231], v254, s[8:11], s42 offen offset:0 sc1
    v_mfma_f32_16x16x32_bf16 v[184:187], a[232:235], v[232:235], v[184:187]
    s_waitcnt lgkmcnt(0)
    v_cvt_pk_bf16_f32 v204, v252, v204
    v_lshlrev_b32 v252, 16, v214
    v_mfma_f32_16x16x32_bf16 v[188:191], a[236:239], v[232:235], v[188:191]
    s_barrier
    v_mfma_f32_16x16x32_bf16 v[180:183], a[240:243], v[236:239], v[180:183]
    ds_read_b128 v[232:235], v253 offset:1040
    v_and_b32 v214, s22, v214
    v_mfma_f32_16x16x32_bf16 v[184:187], a[244:247], v[236:239], v[184:187]
    buffer_load_dwordx4 a[232:235], v254, s[8:11], s42 offen offset:1024 sc1
    v_mfma_f32_16x16x32_bf16 v[188:191], a[248:251], v[236:239], v[188:191]
    v_fmac_f32 v252, s29, v248
    v_fmac_f32 v214, s29, v206
    v_mfma_f32_16x16x32_bf16 v[168:171], a[252:255], v[236:239], v[168:171]
    v_fmac_f32 v252, s23, v250
    v_fmac_f32 v214, s23, v210
    v_mfma_f32_16x16x32_bf16 v[172:175], v[240:243], v[236:239], v[172:175]
    buffer_load_dwordx4 a[236:239], v254, s[8:11], s42 offen offset:2048 sc1
    v_mfma_f32_16x16x32_bf16 v[176:179], v[244:247], v[236:239], v[176:179]
    ds_read_b128 v[236:239], v253 offset:768
    v_cvt_pk_bf16_f32 v214, v252, v214
    v_mfma_f32_16x16x32_bf16 v[180:183], a[252:255], v[228:231], v[180:183]
    s_mov_b32 s42, 629760
    v_fma_f32 v252, v249, s24, v251
    v_fmac_f32 v251, -4.0, v249
    v_mfma_f32_16x16x32_bf16 v[184:187], v[240:243], v[228:231], v[184:187]
    s_waitcnt vmcnt(15) lgkmcnt(1)
    v_fma_f32 v249, v248, s24, v250
    v_fmac_f32 v250, -4.0, v248
    v_mfma_f32_16x16x32_bf16 v[188:191], v[244:247], v[228:231], v[188:191]
    ds_read_b128 v[228:231], v253 offset:512
    v_fma_f32 v248, v250, s26, v251
sub16:
    v_mfma_f32_16x16x32_bf16 a[0:3], a[192:195], v[232:235], a[0:3]
    buffer_load_dwordx4 a[240:243], v254, s[8:11], s42 offen offset:0 sc1
    v_mfma_f32_16x16x32_bf16 a[4:7], a[196:199], v[232:235], a[4:7]
    s_waitcnt vmcnt(13) lgkmcnt(1)
    v_fmac_f32 v251, s27, v250
    v_fma_f32 v250, v249, 2.0, v252
    v_mfma_f32_16x16x32_bf16 a[8:11], a[200:203], v[232:235], a[8:11]
    ds_read_b128 v[232:235], v253 offset:256
    v_fmac_f32 v252, -2.0, v249
    v_mfma_f32_16x16x32_bf16 a[0:3], a[204:207], v[236:239], a[0:3]
    v_fma_f32 v249, v208, s24, v212
    v_fmac_f32 v212, -4.0, v208
    v_mfma_f32_16x16x32_bf16 a[4:7], a[208:211], v[236:239], a[4:7]
    buffer_load_dwordx4 a[244:247], v254, s[8:11], s42 offen offset:1024 sc1
    v_mfma_f32_16x16x32_bf16 a[8:11], a[212:215], v[236:239], a[8:11]
    v_fma_f32 v208, v206, s24, v210
    v_fmac_f32 v210, -4.0, v206
    v_mfma_f32_16x16x32_bf16 a[12:15], a[192:195], v[236:239], a[12:15]
    s_waitcnt lgkmcnt(1)
    v_fma_f32 v206, v210, s26, v212
    v_fmac_f32 v212, s27, v210
    v_mfma_f32_16x16x32_bf16 a[12:15], a[204:207], v[228:231], a[12:15]
    v_fma_f32 v210, v208, 2.0, v249
    v_fmac_f32 v249, -2.0, v208
    v_cvt_pk_bf16_f32 v206, v248, v206
    v_mfma_f32_16x16x32_bf16 a[16:19], a[208:211], v[228:231], a[16:19]
    buffer_load_dwordx4 a[248:251], v254, s[8:11], s42 offen offset:2048 sc1
    v_mfma_f32_16x16x32_bf16 a[16:19], a[196:199], v[236:239], a[16:19]
    s_mov_b32 s42, 632832
    v_cvt_pk_bf16_f32 v212, v251, v212
    v_cvt_pk_bf16_f32 v210, v250, v210
    v_mfma_f32_16x16x32_bf16 a[20:23], a[200:203], v[236:239], a[20:23]
    ds_read_b128 v[236:239], v253 offset:0
    v_cvt_pk_bf16_f32 v208, v252, v249
    v_mfma_f32_16x16x32_bf16 a[20:23], a[212:215], v[228:231], a[20:23]
    s_waitcnt vmcnt(12)
    v_lshlrev_b32 v248, 16, v207
    v_lshlrev_b32 v249, 16, v209
    v_mfma_f32_16x16x32_bf16 a[0:3], a[216:219], v[228:231], a[0:3]
    buffer_load_dwordx4 a[252:255], v254, s[8:11], s42 offen offset:0 sc1
    v_mfma_f32_16x16x32_bf16 a[4:7], a[220:223], v[228:231], a[4:7]
    v_lshlrev_b32 v250, 16, v211
    v_lshlrev_b32 v251, 16, v213
    v_mfma_f32_16x16x32_bf16 a[8:11], a[224:227], v[228:231], a[8:11]
    v_and_b32 v207, s22, v207
    v_and_b32 v209, s22, v209
    v_mfma_f32_16x16x32_bf16 a[24:27], a[192:195], v[228:231], a[24:27]
    s_waitcnt lgkmcnt(1)
    v_and_b32 v211, s22, v211
    v_and_b32 v213, s22, v213
    v_mfma_f32_16x16x32_bf16 a[24:27], a[204:207], v[232:235], a[24:27]
    buffer_load_dwordx4 v[240:243], v254, s[8:11], s42 offen offset:1024 sc1
    v_mfma_f32_16x16x32_bf16 a[28:31], a[208:211], v[232:235], a[28:31]
    v_lshlrev_b32 v252, 16, v205
    v_and_b32 v205, s22, v205
    v_mfma_f32_16x16x32_bf16 a[28:31], a[196:199], v[228:231], a[28:31]
    v_fmac_f32 v252, s25, v251
    v_fmac_f32 v205, s25, v213
    v_mfma_f32_16x16x32_bf16 a[32:35], a[200:203], v[228:231], a[32:35]
    ds_read_b128 v[228:231], v253 offset:1824
    v_fmac_f32 v252, s28, v249
    v_mfma_f32_16x16x32_bf16 a[32:35], a[212:215], v[232:235], a[32:35]
    buffer_load_dwordx4 v[244:247], v254, s[8:11], s42 offen offset:2048 sc1
    v_mfma_f32_16x16x32_bf16 a[12:15], a[216:219], v[232:235], a[12:15]
    v_fmac_f32 v205, s28, v209
    v_cvt_pk_bf16_f32 v205, v252, v205
    v_mfma_f32_16x16x32_bf16 a[16:19], a[220:223], v[232:235], a[16:19]
    v_and_b32 v203, 0x7fff, v255
    v_lshlrev_b32 v252, 16, v215
    v_mfma_f32_16x16x32_bf16 a[20:23], a[224:227], v[232:235], a[20:23]
    buffer_load_dwordx2 v[192:193], v203, s[4:7], s16 offen offset:1088
    v_mfma_f32_16x16x32_bf16 a[36:39], a[192:195], v[232:235], a[36:39]
    s_waitcnt lgkmcnt(1)
    v_and_b32 v215, s22, v215
    v_fmac_f32 v252, s29, v248
    v_mfma_f32_16x16x32_bf16 a[36:39], a[204:207], v[236:239], a[36:39]
    v_fmac_f32 v215, s29, v207
    v_fmac_f32 v252, s23, v250
    v_mfma_f32_16x16x32_bf16 a[40:43], a[208:211], v[236:239], a[40:43]
    v_fmac_f32 v215, s23, v211
    v_cvt_pk_bf16_f32 v215, v252, v215
    v_mfma_f32_16x16x32_bf16 a[40:43], a[196:199], v[232:235], a[40:43]
    v_fma_f32 v252, v249, s24, v251
    v_fmac_f32 v251, -4.0, v249
    v_fma_f32 v249, v248, s24, v250
    v_mfma_f32_16x16x32_bf16 a[44:47], a[200:203], v[232:235], a[44:47]
    ds_read_b128 v[232:235], v253 offset:1568
    v_fmac_f32 v250, -4.0, v248
    v_mfma_f32_16x16x32_bf16 a[44:47], a[212:215], v[236:239], a[44:47]
    buffer_load_dwordx2 v[194:195], v203, s[4:7], s17 offen offset:1088
    v_mfma_f32_16x16x32_bf16 a[24:27], a[216:219], v[236:239], a[24:27]
    v_fma_f32 v248, v250, s26, v251
    v_fmac_f32 v251, s27, v250
    v_mfma_f32_16x16x32_bf16 a[28:31], a[220:223], v[236:239], a[28:31]
    v_fma_f32 v250, v249, 2.0, v252
    v_fmac_f32 v252, -2.0, v249
    v_mfma_f32_16x16x32_bf16 a[32:35], a[224:227], v[236:239], a[32:35]
    v_fma_f32 v249, v209, s24, v213
    v_fmac_f32 v213, -4.0, v209
    v_mfma_f32_16x16x32_bf16 a[48:51], a[192:195], v[236:239], a[48:51]
    s_waitcnt lgkmcnt(1)
    v_fma_f32 v209, v207, s24, v211
    v_fmac_f32 v211, -4.0, v207
    v_mfma_f32_16x16x32_bf16 a[48:51], a[204:207], v[228:231], a[48:51]
    buffer_load_dwordx2 v[196:197], v203, s[4:7], s18 offen offset:1088
    v_mfma_f32_16x16x32_bf16 a[52:55], a[208:211], v[228:231], a[52:55]
    v_fma_f32 v207, v211, s26, v213
    v_fmac_f32 v213, s27, v211
    v_mfma_f32_16x16x32_bf16 a[52:55], a[196:199], v[236:239], a[52:55]
    v_fma_f32 v211, v209, 2.0, v249
    v_fmac_f32 v249, -2.0, v209
    v_mfma_f32_16x16x32_bf16 a[56:59], a[200:203], v[236:239], a[56:59]
    ds_read_b128 v[236:239], v253 offset:1312
    v_cvt_pk_bf16_f32 v207, v248, v207
    v_mfma_f32_16x16x32_bf16 a[56:59], a[212:215], v[228:231], a[56:59]
    v_cvt_pk_bf16_f32 v213, v251, v213
    v_cvt_pk_bf16_f32 v211, v250, v211
    v_mfma_f32_16x16x32_bf16 a[36:39], a[216:219], v[228:231], a[36:39]
    buffer_load_dwordx2 v[198:199], v203, s[4:7], s19 offen offset:1088
    v_mfma_f32_16x16x32_bf16 a[40:43], a[220:223], v[228:231], a[40:43]
    v_cvt_pk_bf16_f32 v209, v252, v249
    v_lshrrev_b32 v252, 15, v255
    v_mfma_f32_16x16x32_bf16 a[44:47], a[224:227], v[228:231], a[44:47]
    ds_write_b64 v252, v[206:207] offset:9088
    v_mfma_f32_16x16x32_bf16 a[60:63], a[192:195], v[228:231], a[60:63]
    s_waitcnt lgkmcnt(2)
    v_lshrrev_b32 v206, 15, v255
    v_mfma_f32_16x16x32_bf16 a[60:63], a[204:207], v[232:235], a[60:63]
    ds_write_b64 v206, v[212:213] offset:11168
    v_mfma_f32_16x16x32_bf16 a[64:67], a[208:211], v[232:235], a[64:67]
    buffer_load_dwordx2 v[200:201], v203, s[4:7], s20 offen offset:1088
    v_mfma_f32_16x16x32_bf16 a[64:67], a[196:199], v[228:231], a[64:67]
    ds_write_b64 v206, v[210:211] offset:13248
    v_mfma_f32_16x16x32_bf16 a[68:71], a[200:203], v[228:231], a[68:71]
    ds_read_b128 v[228:231], v253 offset:1056
    s_waitcnt vmcnt(14)
    v_mfma_f32_16x16x32_bf16 a[68:71], a[212:215], v[232:235], a[68:71]
    ds_write_b64 v206, v[204:205] offset:23648
    v_lshlrev_b32 v248, 16, v218
    v_mfma_f32_16x16x32_bf16 a[48:51], a[216:219], v[232:235], a[48:51]
    v_lshlrev_b32 v249, 16, v220
    v_lshlrev_b32 v250, 16, v222
    v_mfma_f32_16x16x32_bf16 a[52:55], a[220:223], v[232:235], a[52:55]
    buffer_load_dwordx2 v[202:203], v203, s[4:7], s21 offen offset:1088
    v_mfma_f32_16x16x32_bf16 a[56:59], a[224:227], v[232:235], a[56:59]
    ds_write_b64 v206, v[214:215] offset:31968
    v_mfma_f32_16x16x32_bf16 a[72:75], a[192:195], v[232:235], a[72:75]
    s_waitcnt lgkmcnt(6)
    v_lshlrev_b32 v251, 16, v224
    v_and_b32 v218, s22, v218
    v_mfma_f32_16x16x32_bf16 a[72:75], a[204:207], v[236:239], a[72:75]
    v_and_b32 v220, s22, v220
    v_and_b32 v222, s22, v222
    v_mfma_f32_16x16x32_bf16 a[76:79], a[208:211], v[236:239], a[76:79]
    v_and_b32 v224, s22, v224
    v_lshlrev_b32 v252, 16, v216
    v_mfma_f32_16x16x32_bf16 a[76:79], a[196:199], v[232:235], a[76:79]
    v_and_b32 v216, s22, v216
    v_fmac_f32 v252, s25, v251
    v_mfma_f32_16x16x32_bf16 a[80:83], a[200:203], v[232:235], a[80:83]
    ds_read_b128 v[232:235], v253 offset:784
    v_fmac_f32 v216, s25, v224
    v_mfma_f32_16x16x32_bf16 a[80:83], a[212:215], v[236:239], a[80:83]
    s_mov_b32 s42, 663552
    v_fmac_f32 v252, s28, v249
    v_fmac_f32 v216, s28, v220
    v_mfma_f32_16x16x32_bf16 a[60:63], a[216:219], v[236:239], a[60:63]
    v_cvt_pk_bf16_f32 v216, v252, v216
    v_lshlrev_b32 v252, 16, v226
    v_mfma_f32_16x16x32_bf16 a[64:67], a[220:223], v[236:239], a[64:67]
    v_and_b32 v226, s22, v226
    v_fmac_f32 v252, s29, v248
    v_mfma_f32_16x16x32_bf16 a[68:71], a[224:227], v[236:239], a[68:71]
    s_waitcnt lgkmcnt(3)
    v_fmac_f32 v226, s29, v218
    v_fmac_f32 v252, s23, v250
    v_mfma_f32_16x16x32_bf16 a[84:87], a[192:195], v[236:239], a[84:87]
    buffer_load_dwordx4 a[192:195], v254, s[8:11], s42 offen offset:0 sc1
    v_mfma_f32_16x16x32_bf16 a[88:91], a[196:199], v[236:239], a[88:91]
    s_waitcnt lgkmcnt(0)
    v_fmac_f32 v226, s23, v222
    v_cvt_pk_bf16_f32 v226, v252, v226
    v_mfma_f32_16x16x32_bf16 a[92:95], a[200:203], v[236:239], a[92:95]
    s_barrier
    v_mfma_f32_16x16x32_bf16 a[84:87], a[204:207], v[228:231], a[84:87]
    ds_read_b128 v[236:239], v253 offset:3120
    v_fma_f32 v252, v249, s24, v251
    v_mfma_f32_16x16x32_bf16 a[88:91], a[208:211], v[228:231], a[88:91]
    buffer_load_dwordx4 a[196:199], v254, s[8:11], s42 offen offset:1024 sc1
    v_mfma_f32_16x16x32_bf16 a[92:95], a[212:215], v[228:231], a[92:95]
    ds_write_b64 v206, v[208:209] offset:768
    v_mfma_f32_16x16x32_bf16 a[72:75], a[216:219], v[228:231], a[72:75]
    v_fmac_f32 v251, -4.0, v249
    v_fma_f32 v249, v248, s24, v250
    v_mfma_f32_16x16x32_bf16 a[76:79], a[220:223], v[228:231], a[76:79]
    buffer_load_dwordx4 a[200:203], v254, s[8:11], s42 offen offset:2048 sc1
    v_fmac_f32 v250, -4.0, v248
    v_mfma_f32_16x16x32_bf16 a[80:83], a[224:227], v[228:231], a[80:83]
    ds_read_b128 v[228:231], v253 offset:2848
    v_fma_f32 v248, v250, s26, v251
    v_mfma_f32_16x16x32_bf16 a[84:87], a[216:219], v[232:235], a[84:87]
    s_mov_b32 s42, 666624
    v_fmac_f32 v251, s27, v250
    v_fma_f32 v250, v249, 2.0, v252
    v_mfma_f32_16x16x32_bf16 a[88:91], a[220:223], v[232:235], a[88:91]
    s_waitcnt vmcnt(15) lgkmcnt(2)
    v_fmac_f32 v252, -2.0, v249
    v_fma_f32 v249, v220, s24, v224
    v_mfma_f32_16x16x32_bf16 a[92:95], a[224:227], v[232:235], a[92:95]
    ds_read_b128 v[232:235], v253 offset:2592
    v_fmac_f32 v224, -4.0, v220
sub17:
    v_mfma_f32_16x16x32_bf16 a[96:99], a[228:231], v[236:239], a[96:99]
    buffer_load_dwordx4 a[204:207], v254, s[8:11], s42 offen offset:0 sc1
    v_mfma_f32_16x16x32_bf16 a[100:103], a[232:235], v[236:239], a[100:103]
    s_waitcnt vmcnt(13) lgkmcnt(1)
    v_fma_f32 v220, v218, s24, v222
    v_fmac_f32 v222, -4.0, v218
    v_mfma_f32_16x16x32_bf16 a[104:107], a[236:239], v[236:239], a[104:107]
    ds_read_b128 v[236:239], v253 offset:2336
    v_fma_f32 v218, v222, s26, v224
    v_mfma_f32_16x16x32_bf16 a[96:99], a[240:243], v[228:231], a[96:99]
    v_fmac_f32 v224, s27, v222
    v_fma_f32 v222, v220, 2.0, v249
    v_mfma_f32_16x16x32_bf16 a[100:103], a[244:247], v[228:231], a[100:103]
    buffer_load_dwordx4 a[208:211], v254, s[8:11], s42 offen offset:1024 sc1
    v_mfma_f32_16x16x32_bf16 a[104:107], a[248:251], v[228:231], a[104:107]
    v_fmac_f32 v249, -2.0, v220
    v_cvt_pk_bf16_f32 v218, v248, v218
    v_mfma_f32_16x16x32_bf16 a[108:111], a[228:231], v[228:231], a[108:111]
    s_waitcnt lgkmcnt(1)
    v_cvt_pk_bf16_f32 v224, v251, v224
    v_cvt_pk_bf16_f32 v222, v250, v222
    v_mfma_f32_16x16x32_bf16 a[108:111], a[240:243], v[232:235], a[108:111]
    v_cvt_pk_bf16_f32 v220, v252, v249
    v_lshlrev_b32 v248, 16, v219
    v_mfma_f32_16x16x32_bf16 a[112:115], a[244:247], v[232:235], a[112:115]
    buffer_load_dwordx4 a[212:215], v254, s[8:11], s42 offen offset:2048 sc1
    v_mfma_f32_16x16x32_bf16 a[112:115], a[232:235], v[228:231], a[112:115]
    s_mov_b32 s42, 669696
    v_lshlrev_b32 v249, 16, v221
    v_lshlrev_b32 v250, 16, v223
    v_mfma_f32_16x16x32_bf16 a[116:119], a[236:239], v[228:231], a[116:119]
    ds_read_b128 v[228:231], v253 offset:2080
    v_lshlrev_b32 v251, 16, v225
    v_mfma_f32_16x16x32_bf16 a[116:119], a[248:251], v[232:235], a[116:119]
    s_waitcnt vmcnt(12)
    v_and_b32 v219, s22, v219
    v_and_b32 v221, s22, v221
    v_mfma_f32_16x16x32_bf16 a[96:99], a[252:255], v[232:235], a[96:99]
    buffer_load_dwordx4 a[216:219], v254, s[8:11], s42 offen offset:0 sc1
    v_mfma_f32_16x16x32_bf16 a[100:103], v[240:243], v[232:235], a[100:103]
    v_and_b32 v223, s22, v223
    v_and_b32 v225, s22, v225
    v_mfma_f32_16x16x32_bf16 a[104:107], v[244:247], v[232:235], a[104:107]
    v_lshlrev_b32 v252, 16, v217
    v_and_b32 v217, s22, v217
    v_mfma_f32_16x16x32_bf16 a[120:123], a[228:231], v[232:235], a[120:123]
    s_waitcnt lgkmcnt(1)
    v_fmac_f32 v252, s25, v251
    v_fmac_f32 v217, s25, v225
    v_fmac_f32 v252, s28, v249
    v_mfma_f32_16x16x32_bf16 a[120:123], a[240:243], v[236:239], a[120:123]
    buffer_load_dwordx4 a[220:223], v254, s[8:11], s42 offen offset:1024 sc1
    v_mfma_f32_16x16x32_bf16 a[124:127], a[244:247], v[236:239], a[124:127]
    v_fmac_f32 v217, s28, v221
    v_cvt_pk_bf16_f32 v217, v252, v217
    v_mfma_f32_16x16x32_bf16 a[124:127], a[232:235], v[232:235], a[124:127]
    v_lshlrev_b32 v252, 16, v227
    v_and_b32 v227, s22, v227
    v_mfma_f32_16x16x32_bf16 a[128:131], a[236:239], v[232:235], a[128:131]
    ds_read_b128 v[232:235], v253 offset:3904
    v_fmac_f32 v252, s29, v248
    v_mfma_f32_16x16x32_bf16 a[128:131], a[248:251], v[236:239], a[128:131]
    buffer_load_dwordx4 a[224:227], v254, s[8:11], s42 offen offset:2048 sc1
    v_mfma_f32_16x16x32_bf16 a[108:111], a[252:255], v[236:239], a[108:111]
    v_fmac_f32 v227, s29, v219
    v_fmac_f32 v252, s23, v250
    v_mfma_f32_16x16x32_bf16 a[112:115], v[240:243], v[236:239], a[112:115]
    v_and_b32 v215, 0x7fff, v255
    v_fmac_f32 v227, s23, v223
    v_mfma_f32_16x16x32_bf16 a[116:119], v[244:247], v[236:239], a[116:119]
    buffer_load_dwordx2 v[204:205], v215, s[4:7], s16 offen offset:1472
    v_mfma_f32_16x16x32_bf16 a[132:135], a[228:231], v[236:239], a[132:135]
    s_waitcnt lgkmcnt(1)
    v_cvt_pk_bf16_f32 v227, v252, v227
    v_fma_f32 v252, v249, s24, v251
    v_mfma_f32_16x16x32_bf16 a[132:135], a[240:243], v[228:231], a[132:135]
    v_fmac_f32 v251, -4.0, v249
    v_fma_f32 v249, v248, s24, v250
    v_mfma_f32_16x16x32_bf16 a[136:139], a[244:247], v[228:231], a[136:139]
    v_fmac_f32 v250, -4.0, v248
    v_fma_f32 v248, v250, s26, v251
    v_mfma_f32_16x16x32_bf16 a[136:139], a[232:235], v[236:239], a[136:139]
    v_fmac_f32 v251, s27, v250
    v_fma_f32 v250, v249, 2.0, v252
    v_mfma_f32_16x16x32_bf16 a[140:143], a[236:239], v[236:239], a[140:143]
    ds_read_b128 v[236:239], v253 offset:3648
    v_fmac_f32 v252, -2.0, v249
    v_mfma_f32_16x16x32_bf16 a[140:143], a[248:251], v[228:231], a[140:143]
    buffer_load_dwordx2 v[206:207], v215, s[4:7], s17 offen offset:1472
    v_mfma_f32_16x16x32_bf16 a[120:123], a[252:255], v[228:231], a[120:123]
    v_fma_f32 v249, v221, s24, v225
    v_fmac_f32 v225, -4.0, v221
    v_mfma_f32_16x16x32_bf16 a[124:127], v[240:243], v[228:231], a[124:127]
    v_fma_f32 v221, v219, s24, v223
    v_fmac_f32 v223, -4.0, v219
    v_mfma_f32_16x16x32_bf16 a[128:131], v[244:247], v[228:231], a[128:131]
    v_fma_f32 v219, v223, s26, v225
    v_fmac_f32 v225, s27, v223
    v_mfma_f32_16x16x32_bf16 a[144:147], a[228:231], v[228:231], a[144:147]
    s_waitcnt lgkmcnt(1)
    v_fma_f32 v223, v221, 2.0, v249
    v_fmac_f32 v249, -2.0, v221
    v_mfma_f32_16x16x32_bf16 a[144:147], a[240:243], v[232:235], a[144:147]
    buffer_load_dwordx2 v[208:209], v215, s[4:7], s18 offen offset:1472
    v_mfma_f32_16x16x32_bf16 a[148:151], a[244:247], v[232:235], a[148:151]
    v_cvt_pk_bf16_f32 v219, v248, v219
    v_cvt_pk_bf16_f32 v225, v251, v225
    v_cvt_pk_bf16_f32 v223, v250, v223
    v_mfma_f32_16x16x32_bf16 a[148:151], a[232:235], v[228:231], a[148:151]
    v_cvt_pk_bf16_f32 v221, v252, v249
    v_lshrrev_b32 v252, 15, v255
    v_mfma_f32_16x16x32_bf16 a[152:155], a[236:239], v[228:231], a[152:155]
    ds_read_b128 v[228:231], v253 offset:3392
    v_mfma_f32_16x16x32_bf16 a[152:155], a[248:251], v[232:235], a[152:155]
    ds_write_b64 v252, v[218:219] offset:8832
    v_mfma_f32_16x16x32_bf16 a[132:135], a[252:255], v[232:235], a[132:135]
    buffer_load_dwordx2 v[210:211], v215, s[4:7], s19 offen offset:1472
    v_mfma_f32_16x16x32_bf16 a[136:139], v[240:243], v[232:235], a[136:139]
    v_lshrrev_b32 v218, 15, v255
    v_mfma_f32_16x16x32_bf16 a[140:143], v[244:247], v[232:235], a[140:143]
    ds_write_b64 v218, v[224:225] offset:10912
    v_mfma_f32_16x16x32_bf16 a[156:159], a[228:231], v[232:235], a[156:159]
    s_waitcnt lgkmcnt(3)
    v_mfma_f32_16x16x32_bf16 a[156:159], a[240:243], v[236:239], a[156:159]
    ds_write_b64 v218, v[222:223] offset:12992
    v_mfma_f32_16x16x32_bf16 a[160:163], a[244:247], v[236:239], a[160:163]
    buffer_load_dwordx2 v[212:213], v215, s[4:7], s20 offen offset:1472
    v_mfma_f32_16x16x32_bf16 a[160:163], a[232:235], v[232:235], a[160:163]
pad6:
    s_cbranch_vccnz pad10
    ds_write_b64 v218, v[216:217] offset:23392
    v_mfma_f32_16x16x32_bf16 a[164:167], a[236:239], v[232:235], a[164:167]
    ds_read_b128 v[232:235], v253 offset:3136
    s_waitcnt vmcnt(14)
    v_mfma_f32_16x16x32_bf16 a[164:167], a[248:251], v[236:239], a[164:167]
    ds_write_b64 v218, v[226:227] offset:31712
    v_mfma_f32_16x16x32_bf16 a[144:147], a[252:255], v[236:239], a[144:147]
    v_lshlrev_b32 v248, 16, v194
    v_lshlrev_b32 v249, 16, v196
    v_mfma_f32_16x16x32_bf16 a[148:151], v[240:243], v[236:239], a[148:151]
    buffer_load_dwordx2 v[214:215], v215, s[4:7], s21 offen offset:1472
    v_mfma_f32_16x16x32_bf16 a[152:155], v[244:247], v[236:239], a[152:155]
    s_add_u32 s49, s49, 8
    v_lshlrev_b32 v250, 16, v198
    v_lshlrev_b32 v251, 16, v200
    v_mfma_f32_16x16x32_bf16 a[168:171], a[228:231], v[236:239], a[168:171]
    s_waitcnt lgkmcnt(6)
    v_and_b32 v194, s22, v194
    v_and_b32 v196, s22, v196
    v_mfma_f32_16x16x32_bf16 a[168:171], a[240:243], v[228:231], a[168:171]
    ds_write_b64 v218, v[220:221] offset:512
    v_mfma_f32_16x16x32_bf16 a[172:175], a[244:247], v[228:231], a[172:175]
    s_cmp_eq_u32 s39, 1
    s_cselect_b32 s49, 128, s49
    s_cselect_b32 s36, 2130706432, 0
    v_mfma_f32_16x16x32_bf16 a[172:175], a[232:235], v[236:239], a[172:175]
    ds_read_b128 v[216:219], v253 offset:40480
    s_mov_b32 s45, 503518347
    v_mfma_f32_16x16x32_bf16 a[176:179], a[236:239], v[236:239], a[176:179]
    ds_read_b128 v[236:239], v253 offset:2864
    v_bfe_u32 v220, v254, 5, 3
    v_and_b32 v198, s22, v198
    v_mfma_f32_16x16x32_bf16 a[176:179], a[248:251], v[228:231], a[176:179]
    s_mov_b32 s42, 700416
    s_mul_i32 s43, s49, 786432
    v_mul_u32_u24 v221, 5, v220
    v_mfma_f32_16x16x32_bf16 a[156:159], a[252:255], v[228:231], a[156:159]
    v_bfe_u32 v221, s45, v221, 5
    v_mul_u32_u24 v221, 65, v221
    v_mfma_f32_16x16x32_bf16 a[160:163], v[240:243], v[228:231], a[160:163]
    v_sub_u32 v221, v221, v220
    v_lshl_add_u32 v220, v221, 5, v253
    v_mfma_f32_16x16x32_bf16 a[164:167], v[244:247], v[228:231], a[164:167]
    s_add_u32 s43, s43, s53
    s_waitcnt lgkmcnt(1)
    v_and_b32 v200, s22, v200
    v_mfma_f32_16x16x32_bf16 a[180:183], a[228:231], v[228:231], a[180:183]
    buffer_load_dwordx4 a[228:231], v254, s[8:11], s42 offen offset:0 sc1
    v_mfma_f32_16x16x32_bf16 a[184:187], a[232:235], v[228:231], a[184:187]
    s_mov_b64 exec, s[46:47]
    ds_write_b128 v220, v[216:219] offset:1024
    s_mov_b64 exec, -1
    v_mfma_f32_16x16x32_bf16 a[188:191], a[236:239], v[228:231], a[188:191]
    v_lshlrev_b32 v252, 16, v192
    v_and_b32 v192, s22, v192
    v_mfma_f32_16x16x32_bf16 a[180:183], a[240:243], v[232:235], a[180:183]
    ds_read_b128 v[228:231], v253 offset:5200
    v_fmac_f32 v252, s25, v251
    v_mfma_f32_16x16x32_bf16 a[184:187], a[244:247], v[232:235], a[184:187]
    buffer_load_dwordx4 a[232:235], v254, s[8:11], s42 offen offset:1024 sc1
    v_mfma_f32_16x16x32_bf16 a[188:191], a[248:251], v[232:235], a[188:191]
    s_cmp_ge_u32 s49, 128
    s_cselect_b32 s43, 2130706432, s43
    v_fmac_f32 v192, s25, v200
    v_mfma_f32_16x16x32_bf16 a[168:171], a[252:255], v[232:235], a[168:171]
    s_waitcnt lgkmcnt(2)
    s_sub_u32 s16, s43, 196608
    v_fmac_f32 v252, s28, v249
    v_mfma_f32_16x16x32_bf16 a[172:175], v[240:243], v[232:235], a[172:175]
    buffer_load_dwordx4 a[236:239], v254, s[8:11], s42 offen offset:2048 sc1
    v_mfma_f32_16x16x32_bf16 a[176:179], v[244:247], v[232:235], a[176:179]
    ds_read_b128 v[232:235], v253 offset:4928
    v_fmac_f32 v192, s28, v196
    v_mfma_f32_16x16x32_bf16 a[180:183], a[252:255], v[236:239], a[180:183]
    s_mov_b32 s42, 703488
    v_cvt_pk_bf16_f32 v192, v252, v192
    v_lshlrev_b32 v252, 16, v202
    v_mfma_f32_16x16x32_bf16 a[184:187], v[240:243], v[236:239], a[184:187]
    s_waitcnt vmcnt(15) lgkmcnt(1)
    v_and_b32 v202, s22, v202
    v_fmac_f32 v252, s29, v248
    v_mfma_f32_16x16x32_bf16 a[188:191], v[244:247], v[236:239], a[188:191]
    ds_read_b128 v[236:239], v253 offset:4672
    v_fmac_f32 v202, s29, v194
sub18:
    v_mfma_f32_16x16x32_bf16 v[0:3], a[192:195], v[228:231], v[0:3]
    buffer_load_dwordx4 a[240:243], v254, s[8:11], s42 offen offset:0 sc1
    v_mfma_f32_16x16x32_bf16 v[4:7], a[196:199], v[228:231], v[4:7]
    s_waitcnt vmcnt(13) lgkmcnt(1)
    v_fmac_f32 v252, s23, v250
    v_fmac_f32 v202, s23, v198
    v_mfma_f32_16x16x32_bf16 v[8:11], a[200:203], v[228:231], v[8:11]
    ds_read_b128 v[228:231], v253 offset:4416
    v_cvt_pk_bf16_f32 v202, v252, v202
    v_mfma_f32_16x16x32_bf16 v[0:3], a[204:207], v[232:235], v[0:3]
    s_cmp_eq_u32 s49, 0
    s_cselect_b32 s16, 2130706432, s16
    s_mov_b32 s17, s43
    v_fma_f32 v252, v249, s24, v251
    v_mfma_f32_16x16x32_bf16 v[4:7], a[208:211], v[232:235], v[4:7]
    buffer_load_dwordx4 a[244:247], v254, s[8:11], s42 offen offset:1024 sc1
    v_mfma_f32_16x16x32_bf16 v[8:11], a[212:215], v[232:235], v[8:11]
    s_add_u32 s18, s43, 196608
    v_fmac_f32 v251, -4.0, v249
    v_fma_f32 v249, v248, s24, v250
    v_mfma_f32_16x16x32_bf16 v[12:15], a[192:195], v[232:235], v[12:15]
    s_waitcnt lgkmcnt(1)
    v_fmac_f32 v250, -4.0, v248
    v_fma_f32 v248, v250, s26, v251
    v_mfma_f32_16x16x32_bf16 v[12:15], a[204:207], v[236:239], v[12:15]
    s_add_u32 s19, s43, 393216
    v_fmac_f32 v251, s27, v250
    v_fma_f32 v250, v249, 2.0, v252
    v_mfma_f32_16x16x32_bf16 v[16:19], a[208:211], v[236:239], v[16:19]
    buffer_load_dwordx4 a[248:251], v254, s[8:11], s42 offen offset:2048 sc1
    v_mfma_f32_16x16x32_bf16 v[16:19], a[196:199], v[232:235], v[16:19]
    s_mov_b32 s42, 706560
    v_fmac_f32 v252, -2.0, v249
    v_fma_f32 v249, v196, s24, v200
    v_mfma_f32_16x16x32_bf16 v[20:23], a[200:203], v[232:235], v[20:23]
    ds_read_b128 v[232:235], v253 offset:4160
    v_fmac_f32 v200, -4.0, v196
    v_mfma_f32_16x16x32_bf16 v[20:23], a[212:215], v[236:239], v[20:23]
    s_waitcnt vmcnt(12)
    s_add_u32 s20, s43, 589824
    v_fma_f32 v196, v194, s24, v198
    v_mfma_f32_16x16x32_bf16 v[0:3], a[216:219], v[236:239], v[0:3]
    buffer_load_dwordx4 a[252:255], v254, s[8:11], s42 offen offset:0 sc1
    v_mfma_f32_16x16x32_bf16 v[4:7], a[220:223], v[236:239], v[4:7]
    v_fmac_f32 v198, -4.0, v194
    v_fma_f32 v194, v198, s26, v200
    v_mfma_f32_16x16x32_bf16 v[8:11], a[224:227], v[236:239], v[8:11]
    s_add_u32 s21, s43, 786432
    v_fmac_f32 v200, s27, v198
    v_fma_f32 v198, v196, 2.0, v249
    v_mfma_f32_16x16x32_bf16 v[24:27], a[192:195], v[236:239], v[24:27]
    s_waitcnt lgkmcnt(1)
    v_fmac_f32 v249, -2.0, v196
    v_cvt_pk_bf16_f32 v194, v248, v194
    v_mfma_f32_16x16x32_bf16 v[24:27], a[204:207], v[228:231], v[24:27]
    buffer_load_dwordx4 v[240:243], v254, s[8:11], s42 offen offset:1024 sc1
    v_mfma_f32_16x16x32_bf16 v[28:31], a[208:211], v[228:231], v[28:31]
    s_add_u32 s100, s43, s101
    v_cvt_pk_bf16_f32 v200, v251, v200
    v_cvt_pk_bf16_f32 v198, v250, v198
    v_mfma_f32_16x16x32_bf16 v[28:31], a[196:199], v[236:239], v[28:31]
    v_cvt_pk_bf16_f32 v196, v252, v249
    v_lshlrev_b32 v248, 16, v195
    v_mfma_f32_16x16x32_bf16 v[32:35], a[200:203], v[236:239], v[32:35]
    ds_read_b128 v[236:239], v253 offset:5984
    v_lshlrev_b32 v249, 16, v197
    v_mfma_f32_16x16x32_bf16 v[32:35], a[212:215], v[228:231], v[32:35]
    buffer_load_dwordx4 v[244:247], v254, s[8:11], s42 offen offset:2048 sc1
    v_mfma_f32_16x16x32_bf16 v[12:15], a[216:219], v[228:231], v[12:15]
    v_lshlrev_b32 v250, 16, v199
    v_lshlrev_b32 v251, 16, v201
    v_mfma_f32_16x16x32_bf16 v[16:19], a[220:223], v[228:231], v[16:19]
    v_and_b32 v224, 0x1f0, v254
    v_mul_u32_u24 v224, 96, v224
    v_mfma_f32_16x16x32_bf16 v[20:23], a[224:227], v[228:231], v[20:23]
    buffer_load_dword v224, v224, s[4:7], s100 offen offset:0
    v_and_b32 v195, s22, v195
    v_mfma_f32_16x16x32_bf16 v[36:39], a[192:195], v[228:231], v[36:39]
    s_waitcnt lgkmcnt(1)
    v_and_b32 v227, 0xf0, v254
    v_lshrrev_b32 v227, 1, v227
    v_mfma_f32_16x16x32_bf16 v[36:39], a[204:207], v[232:235], v[36:39]
    v_add_u32 v227, s52, v227
    v_mov_b32 v226, s54
    v_mfma_f32_16x16x32_bf16 v[40:43], a[208:211], v[232:235], v[40:43]
    v_mov_b32 v225, s55
    v_cndmask_b32 v226, v226, v225, s[56:57]
    v_mfma_f32_16x16x32_bf16 v[40:43], a[196:199], v[228:231], v[40:43]
    v_add_u32 v227, v227, v226
    s_sub_u32 s45, s16, s50
    v_mfma_f32_16x16x32_bf16 v[44:47], a[200:203], v[228:231], v[44:47]
    ds_read_b128 v[228:231], v253 offset:5728
    v_and_b32 v197, s22, v197
    v_mfma_f32_16x16x32_bf16 v[44:47], a[212:215], v[232:235], v[44:47]
    buffer_load_dwordx2 v[216:217], v227, s[4:7], s45 offen
    v_mfma_f32_16x16x32_bf16 v[24:27], a[216:219], v[232:235], v[24:27]
    s_sub_u32 s45, s17, s50
    v_and_b32 v199, s22, v199
    v_and_b32 v201, s22, v201
    v_mfma_f32_16x16x32_bf16 v[28:31], a[220:223], v[232:235], v[28:31]
    v_lshlrev_b32 v252, 16, v193
    v_and_b32 v193, s22, v193
    v_mfma_f32_16x16x32_bf16 v[32:35], a[224:227], v[232:235], v[32:35]
    v_fmac_f32 v252, s25, v251
    v_fmac_f32 v193, s25, v201
    v_mfma_f32_16x16x32_bf16 v[48:51], a[192:195], v[232:235], v[48:51]
    s_waitcnt lgkmcnt(1)
    v_fmac_f32 v252, s28, v249
    v_fmac_f32 v193, s28, v197
    v_mfma_f32_16x16x32_bf16 v[48:51], a[204:207], v[236:239], v[48:51]
    buffer_load_dwordx2 v[218:219], v227, s[4:7], s45 offen
    v_mfma_f32_16x16x32_bf16 v[52:55], a[208:211], v[236:239], v[52:55]
    s_sub_u32 s45, s18, s50
    v_cvt_pk_bf16_f32 v193, v252, v193
    v_lshlrev_b32 v252, 16, v203
    v_mfma_f32_16x16x32_bf16 v[52:55], a[196:199], v[232:235], v[52:55]
    v_and_b32 v203, s22, v203
    v_fmac_f32 v252, s29, v248
    v_mfma_f32_16x16x32_bf16 v[56:59], a[200:203], v[232:235], v[56:59]
    ds_read_b128 v[232:235], v253 offset:5472
    v_fmac_f32 v203, s29, v195
    v_mfma_f32_16x16x32_bf16 v[56:59], a[212:215], v[236:239], v[56:59]
    v_fmac_f32 v252, s23, v250
    v_fmac_f32 v203, s23, v199
    v_mfma_f32_16x16x32_bf16 v[36:39], a[216:219], v[236:239], v[36:39]
    buffer_load_dwordx2 v[220:221], v227, s[4:7], s45 offen
    v_mfma_f32_16x16x32_bf16 v[40:43], a[220:223], v[236:239], v[40:43]
    s_sub_u32 s45, s19, s50
    v_cvt_pk_bf16_f32 v203, v252, v203
    v_fma_f32 v252, v249, s24, v251
    v_mfma_f32_16x16x32_bf16 v[44:47], a[224:227], v[236:239], v[44:47]
    v_fmac_f32 v251, -4.0, v249
    v_fma_f32 v249, v248, s24, v250
    v_mfma_f32_16x16x32_bf16 v[60:63], a[192:195], v[236:239], v[60:63]
    s_waitcnt lgkmcnt(1)
    v_fmac_f32 v250, -4.0, v248
    v_fma_f32 v248, v250, s26, v251
    v_mfma_f32_16x16x32_bf16 v[60:63], a[204:207], v[228:231], v[60:63]
    v_fmac_f32 v251, s27, v250
    v_fma_f32 v250, v249, 2.0, v252
    v_fmac_f32 v252, -2.0, v249
    v_mfma_f32_16x16x32_bf16 v[64:67], a[208:211], v[228:231], v[64:67]
    buffer_load_dwordx2 v[222:223], v227, s[4:7], s45 offen
    v_mfma_f32_16x16x32_bf16 v[64:67], a[196:199], v[236:239], v[64:67]
    s_sub_u32 s45, s20, s50
    v_fma_f32 v249, v197, s24, v201
    v_fmac_f32 v201, -4.0, v197
    v_mfma_f32_16x16x32_bf16 v[68:71], a[200:203], v[236:239], v[68:71]
    ds_read_b128 v[236:239], v253 offset:5216
    v_fma_f32 v197, v195, s24, v199
    v_mfma_f32_16x16x32_bf16 v[68:71], a[212:215], v[228:231], v[68:71]
    v_fmac_f32 v199, -4.0, v195
    v_fma_f32 v195, v199, s26, v201
    v_mfma_f32_16x16x32_bf16 v[48:51], a[216:219], v[228:231], v[48:51]
    v_fmac_f32 v201, s27, v199
    v_fma_f32 v199, v197, 2.0, v249
    v_mfma_f32_16x16x32_bf16 v[52:55], a[220:223], v[228:231], v[52:55]
    buffer_load_dwordx2 v[224:225], v227, s[4:7], s45 offen
    v_mfma_f32_16x16x32_bf16 v[56:59], a[224:227], v[228:231], v[56:59]
    s_sub_u32 s45, s21, s50
    v_fmac_f32 v249, -2.0, v197
    v_cvt_pk_bf16_f32 v195, v248, v195
    v_mfma_f32_16x16x32_bf16 v[72:75], a[192:195], v[228:231], v[72:75]
    s_waitcnt lgkmcnt(1)
    v_cvt_pk_bf16_f32 v201, v251, v201
    v_cvt_pk_bf16_f32 v199, v250, v199
    v_mfma_f32_16x16x32_bf16 v[72:75], a[204:207], v[232:235], v[72:75]
    v_cvt_pk_bf16_f32 v197, v252, v249
    v_lshrrev_b32 v252, 15, v255
    v_mfma_f32_16x16x32_bf16 v[76:79], a[208:211], v[232:235], v[76:79]
    ds_write_b64 v252, v[194:195] offset:8576
    v_mfma_f32_16x16x32_bf16 v[76:79], a[196:199], v[228:231], v[76:79]
    buffer_load_dwordx2 v[226:227], v227, s[4:7], s45 offen
    v_mfma_f32_16x16x32_bf16 v[80:83], a[200:203], v[228:231], v[80:83]
    ds_read_b128 v[228:231], v253 offset:4944
    v_lshrrev_b32 v194, 15, v255
    v_mfma_f32_16x16x32_bf16 v[80:83], a[212:215], v[232:235], v[80:83]
    s_mov_b32 s42, 737280
    s_waitcnt vmcnt(16)
    v_lshlrev_b32 v248, 16, v206
    v_mfma_f32_16x16x32_bf16 v[60:63], a[216:219], v[232:235], v[60:63]
    ds_write_b64 v194, v[200:201] offset:10656
    v_mfma_f32_16x16x32_bf16 v[64:67], a[220:223], v[232:235], v[64:67]
    v_lshlrev_b32 v249, 16, v208
    v_lshlrev_b32 v250, 16, v210
    v_mfma_f32_16x16x32_bf16 v[68:71], a[224:227], v[232:235], v[68:71]
    ds_write_b64 v194, v[198:199] offset:12736
    v_mfma_f32_16x16x32_bf16 v[84:87], a[192:195], v[232:235], v[84:87]
    buffer_load_dwordx4 a[192:195], v254, s[8:11], s42 offen offset:0 sc1
    v_mfma_f32_16x16x32_bf16 v[88:91], a[196:199], v[232:235], v[88:91]
    ds_write_b64 v194, v[192:193] offset:23136
    v_mfma_f32_16x16x32_bf16 v[92:95], a[200:203], v[232:235], v[92:95]
    s_waitcnt lgkmcnt(5)
    v_lshlrev_b32 v251, 16, v212
    v_and_b32 v206, s22, v206
    v_mfma_f32_16x16x32_bf16 v[84:87], a[204:207], v[236:239], v[84:87]
    ds_read_b128 v[232:235], v253 offset:7280
    v_and_b32 v208, s22, v208
    v_and_b32 v210, s22, v210
    v_mfma_f32_16x16x32_bf16 v[88:91], a[208:211], v[236:239], v[88:91]
    buffer_load_dwordx4 a[196:199], v254, s[8:11], s42 offen offset:1024 sc1
    v_mfma_f32_16x16x32_bf16 v[92:95], a[212:215], v[236:239], v[92:95]
    ds_write_b64 v194, v[202:203] offset:31456
    v_mfma_f32_16x16x32_bf16 v[72:75], a[216:219], v[236:239], v[72:75]
    s_waitcnt lgkmcnt(5)
    v_and_b32 v212, s22, v212
    v_lshlrev_b32 v252, 16, v204
    v_mfma_f32_16x16x32_bf16 v[76:79], a[220:223], v[236:239], v[76:79]
    buffer_load_dwordx4 a[200:203], v254, s[8:11], s42 offen offset:2048 sc1
    v_mfma_f32_16x16x32_bf16 v[80:83], a[224:227], v[236:239], v[80:83]
    ds_read_b128 v[236:239], v253 offset:7008
    v_and_b32 v204, s22, v204
    v_mfma_f32_16x16x32_bf16 v[84:87], a[216:219], v[228:231], v[84:87]
    s_mov_b32 s42, 740352
    v_fmac_f32 v252, s25, v251
    v_fmac_f32 v204, s25, v212
    v_mfma_f32_16x16x32_bf16 v[88:91], a[220:223], v[228:231], v[88:91]
    s_waitcnt vmcnt(16) lgkmcnt(2)
    v_fmac_f32 v252, s28, v249
    v_fmac_f32 v204, s28, v208
    v_mfma_f32_16x16x32_bf16 v[92:95], a[224:227], v[228:231], v[92:95]
    ds_read_b128 v[228:231], v253 offset:6752
    v_cvt_pk_bf16_f32 v204, v252, v204
sub19:
    v_mfma_f32_16x16x32_bf16 v[96:99], a[228:231], v[232:235], v[96:99]
    buffer_load_dwordx4 a[204:207], v254, s[8:11], s42 offen offset:0 sc1
    v_mfma_f32_16x16x32_bf16 v[100:103], a[232:235], v[232:235], v[100:103]
    s_waitcnt vmcnt(14) lgkmcnt(1)
    v_lshlrev_b32 v252, 16, v214
    v_and_b32 v214, s22, v214
    v_mfma_f32_16x16x32_bf16 v[104:107], a[236:239], v[232:235], v[104:107]
    ds_read_b128 v[232:235], v253 offset:6496
    v_fmac_f32 v252, s29, v248
    v_mfma_f32_16x16x32_bf16 v[96:99], a[240:243], v[236:239], v[96:99]
    ds_write_b64 v194, v[196:197] offset:256
    v_mfma_f32_16x16x32_bf16 v[100:103], a[244:247], v[236:239], v[100:103]
    buffer_load_dwordx4 a[208:211], v254, s[8:11], s42 offen offset:1024 sc1
    v_mfma_f32_16x16x32_bf16 v[104:107], a[248:251], v[236:239], v[104:107]
    v_fmac_f32 v214, s29, v206
    v_fmac_f32 v252, s23, v250
    v_mfma_f32_16x16x32_bf16 v[108:111], a[228:231], v[236:239], v[108:111]
    s_waitcnt lgkmcnt(2)
    v_fmac_f32 v214, s23, v210
    v_cvt_pk_bf16_f32 v214, v252, v214
    v_mfma_f32_16x16x32_bf16 v[108:111], a[240:243], v[228:231], v[108:111]
    v_fma_f32 v252, v249, s24, v251
    v_fmac_f32 v251, -4.0, v249
    v_mfma_f32_16x16x32_bf16 v[112:115], a[244:247], v[228:231], v[112:115]
    buffer_load_dwordx4 a[212:215], v254, s[8:11], s42 offen offset:2048 sc1
    v_mfma_f32_16x16x32_bf16 v[112:115], a[232:235], v[236:239], v[112:115]
    s_mov_b32 s42, 743424
    v_fma_f32 v249, v248, s24, v250
    v_fmac_f32 v250, -4.0, v248
    v_mfma_f32_16x16x32_bf16 v[116:119], a[236:239], v[236:239], v[116:119]
    ds_read_b128 v[236:239], v253 offset:6240
    v_fma_f32 v248, v250, s26, v251
    v_mfma_f32_16x16x32_bf16 v[116:119], a[248:251], v[228:231], v[116:119]
    s_waitcnt vmcnt(13)
    v_fmac_f32 v251, s27, v250
    v_fma_f32 v250, v249, 2.0, v252
    v_fmac_f32 v252, -2.0, v249
    v_mfma_f32_16x16x32_bf16 v[96:99], a[252:255], v[228:231], v[96:99]
    buffer_load_dwordx4 a[216:219], v254, s[8:11], s42 offen offset:0 sc1
    v_mfma_f32_16x16x32_bf16 v[100:103], v[240:243], v[228:231], v[100:103]
    v_fma_f32 v249, v208, s24, v212
    v_fmac_f32 v212, -4.0, v208
    v_mfma_f32_16x16x32_bf16 v[104:107], v[244:247], v[228:231], v[104:107]
    v_fma_f32 v208, v206, s24, v210
    v_fmac_f32 v210, -4.0, v206
    v_mfma_f32_16x16x32_bf16 v[120:123], a[228:231], v[228:231], v[120:123]
    s_waitcnt lgkmcnt(2)
    v_fma_f32 v206, v210, s26, v212
    v_fmac_f32 v212, s27, v210
    v_mfma_f32_16x16x32_bf16 v[120:123], a[240:243], v[232:235], v[120:123]
    buffer_load_dwordx4 a[220:223], v254, s[8:11], s42 offen offset:1024 sc1
    v_mfma_f32_16x16x32_bf16 v[124:127], a[244:247], v[232:235], v[124:127]
    v_fma_f32 v210, v208, 2.0, v249
    v_fmac_f32 v249, -2.0, v208
    v_mfma_f32_16x16x32_bf16 v[124:127], a[232:235], v[228:231], v[124:127]
    v_cvt_pk_bf16_f32 v206, v248, v206
    v_cvt_pk_bf16_f32 v212, v251, v212
    v_mfma_f32_16x16x32_bf16 v[128:131], a[236:239], v[228:231], v[128:131]
    ds_read_b128 v[228:231], v253 offset:8064
    v_cvt_pk_bf16_f32 v210, v250, v210
    v_mfma_f32_16x16x32_bf16 v[128:131], a[248:251], v[232:235], v[128:131]
    buffer_load_dwordx4 a[224:227], v254, s[8:11], s42 offen offset:2048 sc1
    v_mfma_f32_16x16x32_bf16 v[108:111], a[252:255], v[232:235], v[108:111]
    v_cvt_pk_bf16_f32 v208, v252, v249
    v_lshlrev_b32 v248, 16, v207
    v_mfma_f32_16x16x32_bf16 v[112:115], v[240:243], v[232:235], v[112:115]
    v_lshlrev_b32 v249, 16, v209
    v_lshlrev_b32 v250, 16, v211
    v_mfma_f32_16x16x32_bf16 v[116:119], v[244:247], v[232:235], v[116:119]
    v_lshlrev_b32 v251, 16, v213
    v_and_b32 v207, s22, v207
    v_mfma_f32_16x16x32_bf16 v[132:135], a[228:231], v[232:235], v[132:135]
    s_waitcnt lgkmcnt(1)
    v_and_b32 v209, s22, v209
    v_and_b32 v211, s22, v211
    v_mfma_f32_16x16x32_bf16 v[132:135], a[240:243], v[236:239], v[132:135]
    v_and_b32 v213, s22, v213
    v_lshlrev_b32 v252, 16, v205
    v_mfma_f32_16x16x32_bf16 v[136:139], a[244:247], v[236:239], v[136:139]
    v_and_b32 v205, s22, v205
    v_fmac_f32 v252, s25, v251
    v_mfma_f32_16x16x32_bf16 v[136:139], a[232:235], v[232:235], v[136:139]
    v_fmac_f32 v205, s25, v213
    v_fmac_f32 v252, s28, v249
    v_mfma_f32_16x16x32_bf16 v[140:143], a[236:239], v[232:235], v[140:143]
    ds_read_b128 v[232:235], v253 offset:7808
    v_fmac_f32 v205, s28, v209
    v_mfma_f32_16x16x32_bf16 v[140:143], a[248:251], v[236:239], v[140:143]
    v_cvt_pk_bf16_f32 v205, v252, v205
    v_lshlrev_b32 v252, 16, v215
    v_mfma_f32_16x16x32_bf16 v[120:123], a[252:255], v[236:239], v[120:123]
    v_and_b32 v215, s22, v215
    v_fmac_f32 v252, s29, v248
    v_mfma_f32_16x16x32_bf16 v[124:127], v[240:243], v[236:239], v[124:127]
    v_fmac_f32 v215, s29, v207
    v_fmac_f32 v252, s23, v250
    v_fmac_f32 v215, s23, v211
    v_mfma_f32_16x16x32_bf16 v[128:131], v[244:247], v[236:239], v[128:131]
    v_cvt_pk_bf16_f32 v215, v252, v215
    v_fma_f32 v252, v249, s24, v251
    v_mfma_f32_16x16x32_bf16 v[144:147], a[228:231], v[236:239], v[144:147]
    s_waitcnt lgkmcnt(1)
    v_fmac_f32 v251, -4.0, v249
    v_fma_f32 v249, v248, s24, v250
    v_mfma_f32_16x16x32_bf16 v[144:147], a[240:243], v[228:231], v[144:147]
    v_fmac_f32 v250, -4.0, v248
    v_fma_f32 v248, v250, s26, v251
    v_mfma_f32_16x16x32_bf16 v[148:151], a[244:247], v[228:231], v[148:151]
    v_fmac_f32 v251, s27, v250
    v_fma_f32 v250, v249, 2.0, v252
    v_mfma_f32_16x16x32_bf16 v[148:151], a[232:235], v[236:239], v[148:151]
    v_fmac_f32 v252, -2.0, v249
    v_fma_f32 v249, v209, s24, v213
    v_mfma_f32_16x16x32_bf16 v[152:155], a[236:239], v[236:239], v[152:155]
    ds_read_b128 v[236:239], v253 offset:7552
    v_fmac_f32 v213, -4.0, v209
    v_mfma_f32_16x16x32_bf16 v[152:155], a[248:251], v[228:231], v[152:155]
    v_fma_f32 v209, v207, s24, v211
    v_fmac_f32 v211, -4.0, v207
    v_mfma_f32_16x16x32_bf16 v[132:135], a[252:255], v[228:231], v[132:135]
    v_fma_f32 v207, v211, s26, v213
    v_fmac_f32 v213, s27, v211
    v_mfma_f32_16x16x32_bf16 v[136:139], v[240:243], v[228:231], v[136:139]
    v_fma_f32 v211, v209, 2.0, v249
    v_fmac_f32 v249, -2.0, v209
    v_mfma_f32_16x16x32_bf16 v[140:143], v[244:247], v[228:231], v[140:143]
    v_cvt_pk_bf16_f32 v207, v248, v207
    v_cvt_pk_bf16_f32 v213, v251, v213
    v_mfma_f32_16x16x32_bf16 v[156:159], a[228:231], v[228:231], v[156:159]
    s_waitcnt lgkmcnt(1)
    v_cvt_pk_bf16_f32 v211, v250, v211
    v_cvt_pk_bf16_f32 v209, v252, v249
    v_mfma_f32_16x16x32_bf16 v[156:159], a[240:243], v[232:235], v[156:159]
    v_lshrrev_b32 v252, 15, v255
    v_mfma_f32_16x16x32_bf16 v[160:163], a[244:247], v[232:235], v[160:163]
    ds_write_b64 v252, v[206:207] offset:8320
    v_mfma_f32_16x16x32_bf16 v[160:163], a[232:235], v[228:231], v[160:163]
    v_lshrrev_b32 v206, 15, v255
    v_mfma_f32_16x16x32_bf16 v[164:167], a[236:239], v[228:231], v[164:167]
    ds_read_b128 v[228:231], v253 offset:7296
    v_mfma_f32_16x16x32_bf16 v[164:167], a[248:251], v[232:235], v[164:167]
    ds_write_b64 v206, v[212:213] offset:10400
    v_mfma_f32_16x16x32_bf16 v[144:147], a[252:255], v[232:235], v[144:147]
    v_mfma_f32_16x16x32_bf16 v[148:151], v[240:243], v[232:235], v[148:151]
    ds_write_b64 v206, v[210:211] offset:12480
    v_mfma_f32_16x16x32_bf16 v[152:155], v[244:247], v[232:235], v[152:155]
    s_waitcnt vmcnt(9)
    v_lshlrev_b32 v248, 16, v218
    v_lshlrev_b32 v249, 16, v220
    v_mfma_f32_16x16x32_bf16 v[168:171], a[228:231], v[232:235], v[168:171]
    s_waitcnt lgkmcnt(4)
    v_lshlrev_b32 v250, 16, v222
    v_lshlrev_b32 v251, 16, v224
    v_mfma_f32_16x16x32_bf16 v[168:171], a[240:243], v[236:239], v[168:171]
    ds_write_b64 v206, v[204:205] offset:22880
    v_mfma_f32_16x16x32_bf16 v[172:175], a[244:247], v[236:239], v[172:175]
    v_and_b32 v218, s22, v218
    v_and_b32 v220, s22, v220
    v_mfma_f32_16x16x32_bf16 v[172:175], a[232:235], v[232:235], v[172:175]
    ds_write_b64 v206, v[214:215] offset:31200
    v_mfma_f32_16x16x32_bf16 v[176:179], a[236:239], v[232:235], v[176:179]
    ds_read_b128 v[232:235], v253 offset:7024
    v_and_b32 v222, s22, v222
    v_mfma_f32_16x16x32_bf16 v[176:179], a[248:251], v[236:239], v[176:179]
    s_mov_b32 s42, 774144
    v_and_b32 v224, s22, v224
    v_lshlrev_b32 v252, 16, v216
    v_mfma_f32_16x16x32_bf16 v[156:159], a[252:255], v[236:239], v[156:159]
    ds_write_b64 v206, v[208:209] offset:0
    v_mfma_f32_16x16x32_bf16 v[160:163], v[240:243], v[236:239], v[160:163]
    v_and_b32 v216, s22, v216
    v_fmac_f32 v252, s25, v251
    v_mfma_f32_16x16x32_bf16 v[164:167], v[244:247], v[236:239], v[164:167]
    s_waitcnt lgkmcnt(6)
    v_fmac_f32 v216, s25, v224
    v_fmac_f32 v252, s28, v249
    v_mfma_f32_16x16x32_bf16 v[180:183], a[228:231], v[236:239], v[180:183]
    buffer_load_dwordx4 a[228:231], v254, s[8:11], s42 offen offset:0 sc1
    v_mfma_f32_16x16x32_bf16 v[184:187], a[232:235], v[236:239], v[184:187]
    s_waitcnt lgkmcnt(0)
    v_fmac_f32 v216, s28, v220
    v_cvt_pk_bf16_f32 v216, v252, v216
    v_mfma_f32_16x16x32_bf16 v[188:191], a[236:239], v[236:239], v[188:191]
    s_barrier
    v_mfma_f32_16x16x32_bf16 v[180:183], a[240:243], v[228:231], v[180:183]
    ds_read_b128 v[236:239], v253 offset:9360
    v_lshlrev_b32 v252, 16, v226
    v_mfma_f32_16x16x32_bf16 v[184:187], a[244:247], v[228:231], v[184:187]
    buffer_load_dwordx4 a[232:235], v254, s[8:11], s42 offen offset:1024 sc1
    v_mfma_f32_16x16x32_bf16 v[188:191], a[248:251], v[228:231], v[188:191]
    v_and_b32 v226, s22, v226
    v_fmac_f32 v252, s29, v248
    v_mfma_f32_16x16x32_bf16 v[168:171], a[252:255], v[228:231], v[168:171]
    v_fmac_f32 v226, s29, v218
    v_fmac_f32 v252, s23, v250
    v_mfma_f32_16x16x32_bf16 v[172:175], v[240:243], v[228:231], v[172:175]
    buffer_load_dwordx4 a[236:239], v254, s[8:11], s42 offen offset:2048 sc1
    v_mfma_f32_16x16x32_bf16 v[176:179], v[244:247], v[228:231], v[176:179]
    ds_read_b128 v[228:231], v253 offset:9088
    v_fmac_f32 v226, s23, v222
    v_mfma_f32_16x16x32_bf16 v[180:183], a[252:255], v[232:235], v[180:183]
    s_mov_b32 s42, 777216
    v_cvt_pk_bf16_f32 v226, v252, v226
    v_fma_f32 v252, v249, s24, v251
    v_mfma_f32_16x16x32_bf16 v[184:187], v[240:243], v[232:235], v[184:187]
    s_waitcnt vmcnt(9) lgkmcnt(1)
    v_fmac_f32 v251, -4.0, v249
    v_fma_f32 v249, v248, s24, v250
    v_mfma_f32_16x16x32_bf16 v[188:191], v[244:247], v[232:235], v[188:191]
    ds_read_b128 v[232:235], v253 offset:8832
    v_fmac_f32 v250, -4.0, v248
sub20:
    v_mfma_f32_16x16x32_bf16 a[0:3], a[192:195], v[236:239], a[0:3]
    buffer_load_dwordx4 a[240:243], v254, s[8:11], s42 offen offset:0 sc1
    v_mfma_f32_16x16x32_bf16 a[4:7], a[196:199], v[236:239], a[4:7]
    s_waitcnt vmcnt(7) lgkmcnt(1)
    v_fma_f32 v248, v250, s26, v251
    v_fmac_f32 v251, s27, v250
    v_mfma_f32_16x16x32_bf16 a[8:11], a[200:203], v[236:239], a[8:11]
    ds_read_b128 v[236:239], v253 offset:8576
    v_fma_f32 v250, v249, 2.0, v252
    v_mfma_f32_16x16x32_bf16 a[0:3], a[204:207], v[228:231], a[0:3]
    v_fmac_f32 v252, -2.0, v249
    v_fma_f32 v249, v220, s24, v224
    v_mfma_f32_16x16x32_bf16 a[4:7], a[208:211], v[228:231], a[4:7]
    buffer_load_dwordx4 a[244:247], v254, s[8:11], s42 offen offset:1024 sc1
    v_mfma_f32_16x16x32_bf16 a[8:11], a[212:215], v[228:231], a[8:11]
    v_fmac_f32 v224, -4.0, v220
    v_fma_f32 v220, v218, s24, v222
    v_mfma_f32_16x16x32_bf16 a[12:15], a[192:195], v[228:231], a[12:15]
    s_waitcnt lgkmcnt(1)
    v_fmac_f32 v222, -4.0, v218
    v_fma_f32 v218, v222, s26, v224
    v_mfma_f32_16x16x32_bf16 a[12:15], a[204:207], v[232:235], a[12:15]
    v_fmac_f32 v224, s27, v222
    v_fma_f32 v222, v220, 2.0, v249
    v_mfma_f32_16x16x32_bf16 a[16:19], a[208:211], v[232:235], a[16:19]
    buffer_load_dwordx4 a[248:251], v254, s[8:11], s42 offen offset:2048 sc1
    v_mfma_f32_16x16x32_bf16 a[16:19], a[196:199], v[228:231], a[16:19]
    s_mov_b32 s42, 780288
    v_fmac_f32 v249, -2.0, v220
    v_cvt_pk_bf16_f32 v218, v248, v218
    v_mfma_f32_16x16x32_bf16 a[20:23], a[200:203], v[228:231], a[20:23]
    ds_read_b128 v[228:231], v253 offset:8320
    v_cvt_pk_bf16_f32 v224, v251, v224
    v_mfma_f32_16x16x32_bf16 a[20:23], a[212:215], v[232:235], a[20:23]
    s_waitcnt vmcnt(6)
    v_cvt_pk_bf16_f32 v222, v250, v222
    v_cvt_pk_bf16_f32 v220, v252, v249
    v_mfma_f32_16x16x32_bf16 a[0:3], a[216:219], v[232:235], a[0:3]
    buffer_load_dwordx4 a[252:255], v254, s[8:11], s42 offen offset:0 sc1
    v_mfma_f32_16x16x32_bf16 a[4:7], a[220:223], v[232:235], a[4:7]
    v_lshlrev_b32 v248, 16, v219
    v_lshlrev_b32 v249, 16, v221
    v_mfma_f32_16x16x32_bf16 a[8:11], a[224:227], v[232:235], a[8:11]
    v_lshlrev_b32 v250, 16, v223
    v_lshlrev_b32 v251, 16, v225
    v_mfma_f32_16x16x32_bf16 a[24:27], a[192:195], v[232:235], a[24:27]
    s_waitcnt lgkmcnt(1)
    v_and_b32 v219, s22, v219
    v_and_b32 v221, s22, v221
    v_mfma_f32_16x16x32_bf16 a[24:27], a[204:207], v[236:239], a[24:27]
    buffer_load_dwordx4 v[240:243], v254, s[8:11], s42 offen offset:1024 sc1
    v_mfma_f32_16x16x32_bf16 a[28:31], a[208:211], v[236:239], a[28:31]
    v_and_b32 v223, s22, v223
    v_and_b32 v225, s22, v225
    v_mfma_f32_16x16x32_bf16 a[28:31], a[196:199], v[232:235], a[28:31]
    v_lshlrev_b32 v252, 16, v217
    v_and_b32 v217, s22, v217
    v_mfma_f32_16x16x32_bf16 a[32:35], a[200:203], v[232:235], a[32:35]
    ds_read_b128 v[232:235], v253 offset:10144
    v_fmac_f32 v252, s25, v251
    v_mfma_f32_16x16x32_bf16 a[32:35], a[212:215], v[236:239], a[32:35]
    buffer_load_dwordx4 v[244:247], v254, s[8:11], s42 offen offset:2048 sc1
    v_mfma_f32_16x16x32_bf16 a[12:15], a[216:219], v[236:239], a[12:15]
    v_fmac_f32 v217, s25, v225
    v_fmac_f32 v252, s28, v249
    v_mfma_f32_16x16x32_bf16 a[16:19], a[220:223], v[236:239], a[16:19]
    v_and_b32 v192, 0x1f0, v254
    v_mul_u32_u24 v192, 96, v192
    v_mfma_f32_16x16x32_bf16 a[20:23], a[224:227], v[236:239], a[20:23]
    buffer_load_dword v192, v192, s[4:7], s100 offen offset:384
    v_mfma_f32_16x16x32_bf16 a[36:39], a[192:195], v[236:239], a[36:39]
    s_waitcnt lgkmcnt(1)
    v_fmac_f32 v217, s28, v221
    v_cvt_pk_bf16_f32 v217, v252, v217
    v_mfma_f32_16x16x32_bf16 a[36:39], a[204:207], v[228:231], a[36:39]
    v_lshlrev_b32 v252, 16, v227
    v_and_b32 v227, s22, v227
    v_mfma_f32_16x16x32_bf16 a[40:43], a[208:211], v[228:231], a[40:43]
    v_fmac_f32 v252, s29, v248
    v_fmac_f32 v227, s29, v219
    v_mfma_f32_16x16x32_bf16 a[40:43], a[196:199], v[236:239], a[40:43]
    v_fmac_f32 v252, s23, v250
    v_fmac_f32 v227, s23, v223
    v_mfma_f32_16x16x32_bf16 a[44:47], a[200:203], v[236:239], a[44:47]
    ds_read_b128 v[236:239], v253 offset:9888
    v_cvt_pk_bf16_f32 v227, v252, v227
    v_mfma_f32_16x16x32_bf16 a[44:47], a[212:215], v[228:231], a[44:47]
    v_fma_f32 v252, v249, s24, v251
    v_fmac_f32 v251, -4.0, v249
    v_mfma_f32_16x16x32_bf16 a[24:27], a[216:219], v[228:231], a[24:27]
    v_fma_f32 v249, v248, s24, v250
    v_fmac_f32 v250, -4.0, v248
    v_mfma_f32_16x16x32_bf16 a[28:31], a[220:223], v[228:231], a[28:31]
    v_fma_f32 v248, v250, s26, v251
    v_fmac_f32 v251, s27, v250
    v_mfma_f32_16x16x32_bf16 a[32:35], a[224:227], v[228:231], a[32:35]
    v_fma_f32 v250, v249, 2.0, v252
    v_fmac_f32 v252, -2.0, v249
    v_mfma_f32_16x16x32_bf16 a[48:51], a[192:195], v[228:231], a[48:51]
    s_waitcnt lgkmcnt(1)
    v_fma_f32 v249, v221, s24, v225
    v_fmac_f32 v225, -4.0, v221
    v_mfma_f32_16x16x32_bf16 a[48:51], a[204:207], v[232:235], a[48:51]
    v_fma_f32 v221, v219, s24, v223
    v_fmac_f32 v223, -4.0, v219
    v_mfma_f32_16x16x32_bf16 a[52:55], a[208:211], v[232:235], a[52:55]
    v_fma_f32 v219, v223, s26, v225
    v_fmac_f32 v225, s27, v223
    v_mfma_f32_16x16x32_bf16 a[52:55], a[196:199], v[228:231], a[52:55]
pad7:
    s_cbranch_vccnz pad11
    v_fma_f32 v223, v221, 2.0, v249
    v_fmac_f32 v249, -2.0, v221
    v_mfma_f32_16x16x32_bf16 a[56:59], a[200:203], v[228:231], a[56:59]
    ds_read_b128 v[228:231], v253 offset:9632
    v_cvt_pk_bf16_f32 v219, v248, v219
    v_mfma_f32_16x16x32_bf16 a[56:59], a[212:215], v[232:235], a[56:59]
    v_cvt_pk_bf16_f32 v225, v251, v225
    v_cvt_pk_bf16_f32 v223, v250, v223
    v_mfma_f32_16x16x32_bf16 a[36:39], a[216:219], v[232:235], a[36:39]
    v_cvt_pk_bf16_f32 v221, v252, v249
    v_and_b32 v248, 0xf0, v254
    v_mfma_f32_16x16x32_bf16 a[40:43], a[220:223], v[232:235], a[40:43]
    v_lshrrev_b32 v248, 1, v248
    v_add_u32 v248, s52, v248
    v_mfma_f32_16x16x32_bf16 a[44:47], a[224:227], v[232:235], a[44:47]
    v_and_b32 v252, 8, v248
    v_lshrrev_b32 v249, 6, v248
    v_mfma_f32_16x16x32_bf16 a[60:63], a[192:195], v[232:235], a[60:63]
    s_waitcnt lgkmcnt(1)
    v_mul_u32_u24 v249, 192, v249
    v_add_u32 v252, v252, v249
    v_mfma_f32_16x16x32_bf16 a[60:63], a[204:207], v[236:239], a[60:63]
    v_bfe_u32 v249, v248, 4, 2
    v_mul_u32_u24 v249, 40704, v249
    v_mfma_f32_16x16x32_bf16 a[64:67], a[208:211], v[236:239], a[64:67]
    v_add_u32 v252, v252, v249
    v_and_b32 v249, 32, v248
    v_mfma_f32_16x16x32_bf16 a[64:67], a[196:199], v[232:235], a[64:67]
    v_lshl_add_u32 v252, v249, 1, v252
    v_bfe_u32 v249, v254, 8, 1
    v_mfma_f32_16x16x32_bf16 a[68:71], a[200:203], v[232:235], a[68:71]
    ds_read_b128 v[232:235], v253 offset:9376
    v_lshl_add_u32 v252, v249, 4, v252
    v_mfma_f32_16x16x32_bf16 a[68:71], a[212:215], v[236:239], a[68:71]
    v_mov_b32 v249, 123328
    v_cndmask_b32 v252, v249, v252, s[58:59]
    v_mfma_f32_16x16x32_bf16 a[48:51], a[216:219], v[236:239], a[48:51]
    ds_write_b64 v252, v[216:217] offset:39520
    v_mfma_f32_16x16x32_bf16 a[52:55], a[220:223], v[236:239], a[52:55]
    v_mfma_f32_16x16x32_bf16 a[56:59], a[224:227], v[236:239], a[56:59]
    ds_write_b64 v252, v[218:219] offset:39552
    v_mfma_f32_16x16x32_bf16 a[72:75], a[192:195], v[236:239], a[72:75]
    s_waitcnt lgkmcnt(3)
    v_mfma_f32_16x16x32_bf16 a[72:75], a[204:207], v[228:231], a[72:75]
    ds_write_b64 v252, v[224:225] offset:39584
    v_mfma_f32_16x16x32_bf16 a[76:79], a[208:211], v[228:231], a[76:79]
    v_mfma_f32_16x16x32_bf16 a[76:79], a[196:199], v[236:239], a[76:79]
    ds_write_b64 v252, v[222:223] offset:39616
    v_mfma_f32_16x16x32_bf16 a[80:83], a[200:203], v[236:239], a[80:83]
    ds_read_b128 v[236:239], v253 offset:9104
    v_mfma_f32_16x16x32_bf16 a[80:83], a[212:215], v[228:231], a[80:83]
    s_mov_b32 s42, 811008
    v_mfma_f32_16x16x32_bf16 a[60:63], a[216:219], v[228:231], a[60:63]
    ds_write_b64 v252, v[220:221] offset:39648
    v_mfma_f32_16x16x32_bf16 a[64:67], a[220:223], v[228:231], a[64:67]
    v_mfma_f32_16x16x32_bf16 a[68:71], a[224:227], v[228:231], a[68:71]
    ds_write_b64 v252, v[226:227] offset:39680
    v_mfma_f32_16x16x32_bf16 a[84:87], a[192:195], v[228:231], a[84:87]
    buffer_load_dwordx4 a[192:195], v254, s[8:11], s42 offen offset:0 sc1
    v_mfma_f32_16x16x32_bf16 a[88:91], a[196:199], v[228:231], a[88:91]
    v_mfma_f32_16x16x32_bf16 a[92:95], a[200:203], v[228:231], a[92:95]
    s_waitcnt lgkmcnt(7)
    v_mfma_f32_16x16x32_bf16 a[84:87], a[204:207], v[232:235], a[84:87]
    ds_read_b128 v[228:231], v253 offset:11440
    v_mfma_f32_16x16x32_bf16 a[88:91], a[208:211], v[232:235], a[88:91]
    buffer_load_dwordx4 a[196:199], v254, s[8:11], s42 offen offset:1024 sc1
    v_mfma_f32_16x16x32_bf16 a[92:95], a[212:215], v[232:235], a[92:95]
    v_mfma_f32_16x16x32_bf16 a[72:75], a[216:219], v[232:235], a[72:75]
    s_waitcnt lgkmcnt(3)
    v_mfma_f32_16x16x32_bf16 a[76:79], a[220:223], v[232:235], a[76:79]
    buffer_load_dwordx4 a[200:203], v254, s[8:11], s42 offen offset:2048 sc1
    v_mfma_f32_16x16x32_bf16 a[80:83], a[224:227], v[232:235], a[80:83]
    ds_read_b128 v[232:235], v253 offset:11168
    v_mfma_f32_16x16x32_bf16 a[84:87], a[216:219], v[236:239], a[84:87]
    s_mov_b32 s42, 814080
    v_mfma_f32_16x16x32_bf16 a[88:91], a[220:223], v[236:239], a[88:91]
    s_waitcnt vmcnt(10) lgkmcnt(1)
    v_mfma_f32_16x16x32_bf16 a[92:95], a[224:227], v[236:239], a[92:95]
    ds_read_b128 v[236:239], v253 offset:10912
sub21:
    v_mfma_f32_16x16x32_bf16 a[96:99], a[228:231], v[228:231], a[96:99]
    buffer_load_dwordx4 a[204:207], v254, s[8:11], s42 offen offset:0 sc1
    v_mfma_f32_16x16x32_bf16 a[100:103], a[232:235], v[228:231], a[100:103]
    s_waitcnt vmcnt(8) lgkmcnt(1)
    v_mfma_f32_16x16x32_bf16 a[104:107], a[236:239], v[228:231], a[104:107]
    ds_read_b128 v[228:231], v253 offset:10656
    v_bfe_u32 v251, v254, 6, 2
    v_mfma_f32_16x16x32_bf16 a[96:99], a[240:243], v[232:235], a[96:99]
    v_mul_u32_u24 v248, 40704, v251
    v_and_b32 v251, 0x80, v254
    v_mfma_f32_16x16x32_bf16 a[100:103], a[244:247], v[232:235], a[100:103]
    buffer_load_dwordx4 a[208:211], v254, s[8:11], s42 offen offset:1024 sc1
    v_mfma_f32_16x16x32_bf16 a[104:107], a[248:251], v[232:235], a[104:107]
    v_lshrrev_b32 v251, 1, v251
    v_add_u32 v248, v248, v251
    v_mfma_f32_16x16x32_bf16 a[108:111], a[228:231], v[232:235], a[108:111]
    s_waitcnt lgkmcnt(1)
    v_and_b32 v251, 0x40, v254
    v_lshrrev_b32 v251, 2, v251
    v_mfma_f32_16x16x32_bf16 a[108:111], a[240:243], v[236:239], a[108:111]
    v_add_u32 v248, v248, v251
    v_bfe_u32 v251, v254, 4, 2
    v_mfma_f32_16x16x32_bf16 a[112:115], a[244:247], v[236:239], a[112:115]
    buffer_load_dwordx4 a[212:215], v254, s[8:11], s42 offen offset:2048 sc1
    v_mfma_f32_16x16x32_bf16 a[112:115], a[232:235], v[232:235], a[112:115]
    s_mov_b32 s42, 817152
    v_mul_u32_u24 v251, 3104, v251
    v_add_u32 v248, v248, v251
    v_mfma_f32_16x16x32_bf16 a[116:119], a[236:239], v[232:235], a[116:119]
    ds_read_b128 v[232:235], v253 offset:10400
    v_add_u32 v248, s52, v248
    v_mfma_f32_16x16x32_bf16 a[116:119], a[248:251], v[236:239], a[116:119]
    s_waitcnt vmcnt(7)
    v_lshrrev_b32 v251, 8, v254
    v_lshl_add_u32 v249, v251, 3, v248
    v_mfma_f32_16x16x32_bf16 a[96:99], a[252:255], v[236:239], a[96:99]
    buffer_load_dwordx4 a[216:219], v254, s[8:11], s42 offen offset:0 sc1
    v_mfma_f32_16x16x32_bf16 a[100:103], v[240:243], v[236:239], a[100:103]
    v_lshl_add_u32 v248, v251, 4, v248
    v_add_u32 v250, s51, v254
    v_mfma_f32_16x16x32_bf16 a[104:107], v[244:247], v[236:239], a[104:107]
    v_accvgpr_read_b32 v204, a0
    v_accvgpr_read_b32 v205, a1
    v_mfma_f32_16x16x32_bf16 a[120:123], a[228:231], v[236:239], a[120:123]
    s_waitcnt lgkmcnt(1)
    v_accvgpr_read_b32 v206, a2
    v_accvgpr_read_b32 v207, a3
    v_mfma_f32_16x16x32_bf16 a[120:123], a[240:243], v[228:231], a[120:123]
    buffer_load_dwordx4 a[220:223], v254, s[8:11], s42 offen offset:1024 sc1
    v_mfma_f32_16x16x32_bf16 a[124:127], a[244:247], v[228:231], a[124:127]
    v_mfma_f32_16x16x32_bf16 a[124:127], a[232:235], v[236:239], a[124:127]
    v_accvgpr_read_b32 v208, a96
    v_accvgpr_read_b32 v209, a97
    v_mfma_f32_16x16x32_bf16 a[128:131], a[236:239], v[236:239], a[128:131]
    ds_read_b128 v[236:239], v253 offset:12224
    v_accvgpr_read_b32 v210, a98
    v_mfma_f32_16x16x32_bf16 a[128:131], a[248:251], v[228:231], a[128:131]
    buffer_load_dwordx4 a[224:227], v254, s[8:11], s42 offen offset:2048 sc1
    v_mfma_f32_16x16x32_bf16 a[108:111], a[252:255], v[228:231], a[108:111]
    v_accvgpr_read_b32 v211, a99
    v_add_f32 v212, v204, v208
    v_mfma_f32_16x16x32_bf16 a[112:115], v[240:243], v[228:231], a[112:115]
    v_and_b32 v193, 0x1f0, v254
    v_mul_u32_u24 v193, 96, v193
    v_mfma_f32_16x16x32_bf16 a[116:119], v[244:247], v[228:231], a[116:119]
    buffer_load_dword v193, v193, s[4:7], s100 offen offset:768
    v_mfma_f32_16x16x32_bf16 a[132:135], a[228:231], v[228:231], a[132:135]
    s_waitcnt lgkmcnt(1)
    v_add_f32 v213, v205, v209
    v_add_f32 v214, v206, v210
    v_mfma_f32_16x16x32_bf16 a[132:135], a[240:243], v[232:235], a[132:135]
    v_add_f32 v215, v207, v211
    v_sub_f32 v204, v204, v208
    v_mfma_f32_16x16x32_bf16 a[136:139], a[244:247], v[232:235], a[136:139]
    v_sub_f32 v205, v205, v209
    v_sub_f32 v206, v206, v210
    v_mfma_f32_16x16x32_bf16 a[136:139], a[232:235], v[228:231], a[136:139]
    v_sub_f32 v207, v207, v211
    v_accvgpr_write_b32 a0, v212
    v_mfma_f32_16x16x32_bf16 a[140:143], a[236:239], v[228:231], a[140:143]
    ds_read_b128 v[228:231], v253 offset:11968
    v_accvgpr_write_b32 a1, v213
    v_mfma_f32_16x16x32_bf16 a[140:143], a[248:251], v[232:235], a[140:143]
    v_accvgpr_write_b32 a2, v214
    v_accvgpr_write_b32 a3, v215
    v_mfma_f32_16x16x32_bf16 a[120:123], a[252:255], v[232:235], a[120:123]
    v_accvgpr_write_b32 a96, v204
    v_accvgpr_write_b32 a97, v205
    v_mfma_f32_16x16x32_bf16 a[124:127], v[240:243], v[232:235], a[124:127]
    v_accvgpr_write_b32 a98, v206
    v_accvgpr_write_b32 a99, v207
    v_mfma_f32_16x16x32_bf16 a[128:131], v[244:247], v[232:235], a[128:131]
    v_accvgpr_read_b32 v204, a4
    v_accvgpr_read_b32 v205, a5
    v_mfma_f32_16x16x32_bf16 a[144:147], a[228:231], v[232:235], a[144:147]
    s_waitcnt lgkmcnt(1)
    v_accvgpr_read_b32 v206, a6
    v_accvgpr_read_b32 v207, a7
    v_mfma_f32_16x16x32_bf16 a[144:147], a[240:243], v[236:239], a[144:147]
    v_accvgpr_read_b32 v208, a100
    v_accvgpr_read_b32 v209, a101
    v_mfma_f32_16x16x32_bf16 a[148:151], a[244:247], v[236:239], a[148:151]
    v_accvgpr_read_b32 v210, a102
    v_accvgpr_read_b32 v211, a103
    v_mfma_f32_16x16x32_bf16 a[148:151], a[232:235], v[232:235], a[148:151]
    v_add_f32 v212, v204, v208
    v_add_f32 v213, v205, v209
    v_mfma_f32_16x16x32_bf16 a[152:155], a[236:239], v[232:235], a[152:155]
    ds_read_b128 v[232:235], v253 offset:11712
    v_add_f32 v214, v206, v210
    v_mfma_f32_16x16x32_bf16 a[152:155], a[248:251], v[236:239], a[152:155]
    v_add_f32 v215, v207, v211
    v_sub_f32 v204, v204, v208
    v_mfma_f32_16x16x32_bf16 a[132:135], a[252:255], v[236:239], a[132:135]
    v_sub_f32 v205, v205, v209
    v_sub_f32 v206, v206, v210
    v_mfma_f32_16x16x32_bf16 a[136:139], v[240:243], v[236:239], a[136:139]
    v_sub_f32 v207, v207, v211
    v_accvgpr_write_b32 a4, v212
    v_mfma_f32_16x16x32_bf16 a[140:143], v[244:247], v[236:239], a[140:143]
    v_accvgpr_write_b32 a5, v213
    v_accvgpr_write_b32 a6, v214
    v_mfma_f32_16x16x32_bf16 a[156:159], a[228:231], v[236:239], a[156:159]
    s_waitcnt lgkmcnt(1)
    v_accvgpr_write_b32 a7, v215
    v_accvgpr_write_b32 a100, v204
    v_mfma_f32_16x16x32_bf16 a[156:159], a[240:243], v[228:231], a[156:159]
    v_accvgpr_write_b32 a101, v205
    v_accvgpr_write_b32 a102, v206
    v_mfma_f32_16x16x32_bf16 a[160:163], a[244:247], v[228:231], a[160:163]
    v_accvgpr_write_b32 a103, v207
    v_accvgpr_read_b32 v204, a8
    v_mfma_f32_16x16x32_bf16 a[160:163], a[232:235], v[236:239], a[160:163]
    v_accvgpr_read_b32 v205, a9
    v_accvgpr_read_b32 v206, a10
    v_mfma_f32_16x16x32_bf16 a[164:167], a[236:239], v[236:239], a[164:167]
    ds_read_b128 v[236:239], v253 offset:11456
    v_accvgpr_read_b32 v207, a11
    v_mfma_f32_16x16x32_bf16 a[164:167], a[248:251], v[228:231], a[164:167]
    v_accvgpr_read_b32 v208, a104
    v_accvgpr_read_b32 v209, a105
    v_mfma_f32_16x16x32_bf16 a[144:147], a[252:255], v[228:231], a[144:147]
    v_accvgpr_read_b32 v210, a106
    v_accvgpr_read_b32 v211, a107
    v_mfma_f32_16x16x32_bf16 a[148:151], v[240:243], v[228:231], a[148:151]
    v_add_f32 v212, v204, v208
    v_add_f32 v213, v205, v209
    v_mfma_f32_16x16x32_bf16 a[152:155], v[244:247], v[228:231], a[152:155]
    v_add_f32 v214, v206, v210
    v_add_f32 v215, v207, v211
    v_mfma_f32_16x16x32_bf16 a[168:171], a[228:231], v[228:231], a[168:171]
    s_waitcnt lgkmcnt(1)
    v_sub_f32 v204, v204, v208
    v_sub_f32 v205, v205, v209
    v_mfma_f32_16x16x32_bf16 a[168:171], a[240:243], v[232:235], a[168:171]
    v_sub_f32 v206, v206, v210
    v_sub_f32 v207, v207, v211
    v_mfma_f32_16x16x32_bf16 a[172:175], a[244:247], v[232:235], a[172:175]
    v_accvgpr_write_b32 a8, v212
    v_accvgpr_write_b32 a9, v213
    v_mfma_f32_16x16x32_bf16 a[172:175], a[232:235], v[228:231], a[172:175]
    v_accvgpr_write_b32 a10, v214
    v_accvgpr_write_b32 a11, v215
    v_mfma_f32_16x16x32_bf16 a[176:179], a[236:239], v[228:231], a[176:179]
    ds_read_b128 v[228:231], v253 offset:11184
    v_accvgpr_write_b32 a104, v204
    v_mfma_f32_16x16x32_bf16 a[176:179], a[248:251], v[232:235], a[176:179]
    s_mov_b32 s42, 847872
    v_accvgpr_write_b32 a105, v205
    v_accvgpr_write_b32 a106, v206
    v_mfma_f32_16x16x32_bf16 a[156:159], a[252:255], v[232:235], a[156:159]
    v_accvgpr_write_b32 a107, v207
    v_accvgpr_read_b32 v204, a12
    v_mfma_f32_16x16x32_bf16 a[160:163], v[240:243], v[232:235], a[160:163]
    v_accvgpr_read_b32 v205, a13
    v_accvgpr_read_b32 v206, a14
    v_mfma_f32_16x16x32_bf16 a[164:167], v[244:247], v[232:235], a[164:167]
    v_accvgpr_read_b32 v207, a15
    v_accvgpr_read_b32 v208, a108
    v_mfma_f32_16x16x32_bf16 a[180:183], a[228:231], v[232:235], a[180:183]
    buffer_load_dwordx4 a[228:231], v254, s[8:11], s42 offen offset:0 sc1
    v_mfma_f32_16x16x32_bf16 a[184:187], a[232:235], v[232:235], a[184:187]
    v_accvgpr_read_b32 v209, a109
    v_accvgpr_read_b32 v210, a110
    v_mfma_f32_16x16x32_bf16 a[188:191], a[236:239], v[232:235], a[188:191]
    s_waitcnt lgkmcnt(1)
    v_accvgpr_read_b32 v211, a111
    v_add_f32 v212, v204, v208
    v_mfma_f32_16x16x32_bf16 a[180:183], a[240:243], v[236:239], a[180:183]
    ds_read_b128 v[232:235], v253 offset:13520
    v_add_f32 v213, v205, v209
    v_mfma_f32_16x16x32_bf16 a[184:187], a[244:247], v[236:239], a[184:187]
    buffer_load_dwordx4 a[232:235], v254, s[8:11], s42 offen offset:1024 sc1
    v_mfma_f32_16x16x32_bf16 a[188:191], a[248:251], v[236:239], a[188:191]
    v_add_f32 v214, v206, v210
    v_add_f32 v215, v207, v211
    v_mfma_f32_16x16x32_bf16 a[168:171], a[252:255], v[236:239], a[168:171]
    s_waitcnt lgkmcnt(1)
    v_sub_f32 v204, v204, v208
    v_sub_f32 v205, v205, v209
    v_mfma_f32_16x16x32_bf16 a[172:175], v[240:243], v[236:239], a[172:175]
    buffer_load_dwordx4 a[236:239], v254, s[8:11], s42 offen offset:2048 sc1
    v_mfma_f32_16x16x32_bf16 a[176:179], v[244:247], v[236:239], a[176:179]
    ds_read_b128 v[236:239], v253 offset:13248
    v_sub_f32 v206, v206, v210
    v_mfma_f32_16x16x32_bf16 a[180:183], a[252:255], v[228:231], a[180:183]
    s_mov_b32 s42, 850944
    v_sub_f32 v207, v207, v211
    v_accvgpr_write_b32 a12, v212
    v_mfma_f32_16x16x32_bf16 a[184:187], v[240:243], v[228:231], a[184:187]
    s_waitcnt vmcnt(10) lgkmcnt(1)
    v_accvgpr_write_b32 a13, v213
    v_accvgpr_write_b32 a14, v214
    v_mfma_f32_16x16x32_bf16 a[188:191], v[244:247], v[228:231], a[188:191]
    ds_read_b128 v[228:231], v253 offset:12992
    v_accvgpr_write_b32 a15, v215
sub22:
    v_mfma_f32_16x16x32_bf16 v[0:3], a[192:195], v[232:235], v[0:3]
    buffer_load_dwordx4 a[240:243], v254, s[8:11], s42 offen offset:0 sc1
    v_mfma_f32_16x16x32_bf16 v[4:7], a[196:199], v[232:235], v[4:7]
    s_waitcnt vmcnt(8) lgkmcnt(1)
    v_accvgpr_write_b32 a108, v204
    v_accvgpr_write_b32 a109, v205
    v_mfma_f32_16x16x32_bf16 v[8:11], a[200:203], v[232:235], v[8:11]
    ds_read_b128 v[232:235], v253 offset:12736
    v_accvgpr_write_b32 a110, v206
    v_mfma_f32_16x16x32_bf16 v[0:3], a[204:207], v[236:239], v[0:3]
    v_accvgpr_write_b32 a111, v207
    v_accvgpr_read_b32 v204, a16
    v_mfma_f32_16x16x32_bf16 v[4:7], a[208:211], v[236:239], v[4:7]
    buffer_load_dwordx4 a[244:247], v254, s[8:11], s42 offen offset:1024 sc1
    v_mfma_f32_16x16x32_bf16 v[8:11], a[212:215], v[236:239], v[8:11]
    v_accvgpr_read_b32 v205, a17
    v_accvgpr_read_b32 v206, a18
    v_mfma_f32_16x16x32_bf16 v[12:15], a[192:195], v[236:239], v[12:15]
    s_waitcnt lgkmcnt(1)
    v_accvgpr_read_b32 v207, a19
    v_accvgpr_read_b32 v208, a112
    v_mfma_f32_16x16x32_bf16 v[12:15], a[204:207], v[228:231], v[12:15]
    v_accvgpr_read_b32 v209, a113
    v_accvgpr_read_b32 v210, a114
    v_mfma_f32_16x16x32_bf16 v[16:19], a[208:211], v[228:231], v[16:19]
    buffer_load_dwordx4 a[248:251], v254, s[8:11], s42 offen offset:2048 sc1
    v_mfma_f32_16x16x32_bf16 v[16:19], a[196:199], v[236:239], v[16:19]
    s_mov_b32 s42, 854016
    v_accvgpr_read_b32 v211, a115
    v_add_f32 v212, v204, v208
    v_mfma_f32_16x16x32_bf16 v[20:23], a[200:203], v[236:239], v[20:23]
    ds_read_b128 v[236:239], v253 offset:12480
    v_add_f32 v213, v205, v209
    v_mfma_f32_16x16x32_bf16 v[20:23], a[212:215], v[228:231], v[20:23]
    s_waitcnt vmcnt(7)
    v_add_f32 v214, v206, v210
    v_add_f32 v215, v207, v211
    v_mfma_f32_16x16x32_bf16 v[0:3], a[216:219], v[228:231], v[0:3]
    buffer_load_dwordx4 a[252:255], v254, s[8:11], s42 offen offset:0 sc1
    v_mfma_f32_16x16x32_bf16 v[4:7], a[220:223], v[228:231], v[4:7]
    v_sub_f32 v204, v204, v208
    v_sub_f32 v205, v205, v209
    v_mfma_f32_16x16x32_bf16 v[8:11], a[224:227], v[228:231], v[8:11]
    v_sub_f32 v206, v206, v210
    v_sub_f32 v207, v207, v211
    v_mfma_f32_16x16x32_bf16 v[24:27], a[192:195], v[228:231], v[24:27]
    s_waitcnt lgkmcnt(1)
    v_accvgpr_write_b32 a16, v212
    v_accvgpr_write_b32 a17, v213
    v_mfma_f32_16x16x32_bf16 v[24:27], a[204:207], v[232:235], v[24:27]
    buffer_load_dwordx4 v[240:243], v254, s[8:11], s42 offen offset:1024 sc1
    v_mfma_f32_16x16x32_bf16 v[28:31], a[208:211], v[232:235], v[28:31]
    v_accvgpr_write_b32 a18, v214
    v_accvgpr_write_b32 a19, v215
    v_mfma_f32_16x16x32_bf16 v[28:31], a[196:199], v[228:231], v[28:31]
    v_accvgpr_write_b32 a112, v204
    v_accvgpr_write_b32 a113, v205
    v_mfma_f32_16x16x32_bf16 v[32:35], a[200:203], v[228:231], v[32:35]
    ds_read_b128 v[228:231], v253 offset:14304
    v_accvgpr_write_b32 a114, v206
    v_mfma_f32_16x16x32_bf16 v[32:35], a[212:215], v[232:235], v[32:35]
    buffer_load_dwordx4 v[244:247], v254, s[8:11], s42 offen offset:2048 sc1
    v_mfma_f32_16x16x32_bf16 v[12:15], a[216:219], v[232:235], v[12:15]
    v_accvgpr_write_b32 a115, v207
    v_accvgpr_read_b32 v204, a20
    v_mfma_f32_16x16x32_bf16 v[16:19], a[220:223], v[232:235], v[16:19]
    v_accvgpr_read_b32 v205, a21
    v_accvgpr_read_b32 v206, a22
    v_mfma_f32_16x16x32_bf16 v[20:23], a[224:227], v[232:235], v[20:23]
    v_accvgpr_read_b32 v207, a23
    v_accvgpr_read_b32 v208, a116
    v_mfma_f32_16x16x32_bf16 v[36:39], a[192:195], v[232:235], v[36:39]
    s_waitcnt lgkmcnt(1)
    v_accvgpr_read_b32 v209, a117
    v_accvgpr_read_b32 v210, a118
    v_mfma_f32_16x16x32_bf16 v[36:39], a[204:207], v[236:239], v[36:39]
    v_accvgpr_read_b32 v211, a119
    v_add_f32 v212, v204, v208
    v_mfma_f32_16x16x32_bf16 v[40:43], a[208:211], v[236:239], v[40:43]
    v_add_f32 v213, v205, v209
    v_add_f32 v214, v206, v210
    v_mfma_f32_16x16x32_bf16 v[40:43], a[196:199], v[232:235], v[40:43]
    v_add_f32 v215, v207, v211
    v_sub_f32 v204, v204, v208
    v_mfma_f32_16x16x32_bf16 v[44:47], a[200:203], v[232:235], v[44:47]
    ds_read_b128 v[232:235], v253 offset:14048
    v_sub_f32 v205, v205, v209
    v_mfma_f32_16x16x32_bf16 v[44:47], a[212:215], v[236:239], v[44:47]
    v_sub_f32 v206, v206, v210
    v_sub_f32 v207, v207, v211
    v_mfma_f32_16x16x32_bf16 v[24:27], a[216:219], v[236:239], v[24:27]
    v_accvgpr_write_b32 a20, v212
    v_accvgpr_write_b32 a21, v213
    v_mfma_f32_16x16x32_bf16 v[28:31], a[220:223], v[236:239], v[28:31]
    v_accvgpr_write_b32 a22, v214
    v_accvgpr_write_b32 a23, v215
    v_mfma_f32_16x16x32_bf16 v[32:35], a[224:227], v[236:239], v[32:35]
    v_accvgpr_write_b32 a116, v204
    v_accvgpr_write_b32 a117, v205
    v_mfma_f32_16x16x32_bf16 v[48:51], a[192:195], v[236:239], v[48:51]
    s_waitcnt lgkmcnt(1)
    v_accvgpr_write_b32 a118, v206
    v_accvgpr_write_b32 a119, v207
    v_mfma_f32_16x16x32_bf16 v[48:51], a[204:207], v[228:231], v[48:51]
    v_accvgpr_read_b32 v204, a24
    v_accvgpr_read_b32 v205, a25
    v_mfma_f32_16x16x32_bf16 v[52:55], a[208:211], v[228:231], v[52:55]
    v_accvgpr_read_b32 v206, a26
    v_accvgpr_read_b32 v207, a27
    v_mfma_f32_16x16x32_bf16 v[52:55], a[196:199], v[236:239], v[52:55]
    v_accvgpr_read_b32 v208, a120
    v_accvgpr_read_b32 v209, a121
    v_mfma_f32_16x16x32_bf16 v[56:59], a[200:203], v[236:239], v[56:59]
    ds_read_b128 v[236:239], v253 offset:13792
    v_accvgpr_read_b32 v210, a122
    v_mfma_f32_16x16x32_bf16 v[56:59], a[212:215], v[228:231], v[56:59]
    v_accvgpr_read_b32 v211, a123
    v_add_f32 v212, v204, v208
    v_mfma_f32_16x16x32_bf16 v[36:39], a[216:219], v[228:231], v[36:39]
    v_add_f32 v213, v205, v209
    v_add_f32 v214, v206, v210
    v_mfma_f32_16x16x32_bf16 v[40:43], a[220:223], v[228:231], v[40:43]
    v_add_f32 v215, v207, v211
    v_sub_f32 v204, v204, v208
    v_mfma_f32_16x16x32_bf16 v[44:47], a[224:227], v[228:231], v[44:47]
    v_sub_f32 v205, v205, v209
    v_sub_f32 v206, v206, v210
    v_mfma_f32_16x16x32_bf16 v[60:63], a[192:195], v[228:231], v[60:63]
    s_waitcnt lgkmcnt(1)
    v_sub_f32 v207, v207, v211
    v_accvgpr_write_b32 a24, v212
    v_mfma_f32_16x16x32_bf16 v[60:63], a[204:207], v[232:235], v[60:63]
    v_accvgpr_write_b32 a25, v213
    v_accvgpr_write_b32 a26, v214
    v_mfma_f32_16x16x32_bf16 v[64:67], a[208:211], v[232:235], v[64:67]
    v_accvgpr_write_b32 a27, v215
    v_accvgpr_write_b32 a120, v204
    v_mfma_f32_16x16x32_bf16 v[64:67], a[196:199], v[228:231], v[64:67]
    v_accvgpr_write_b32 a121, v205
    v_accvgpr_write_b32 a122, v206
    v_mfma_f32_16x16x32_bf16 v[68:71], a[200:203], v[228:231], v[68:71]
    ds_read_b128 v[228:231], v253 offset:13536
    v_accvgpr_write_b32 a123, v207
    v_mfma_f32_16x16x32_bf16 v[68:71], a[212:215], v[232:235], v[68:71]
    v_accvgpr_read_b32 v204, a84
    v_accvgpr_read_b32 v205, a85
    v_mfma_f32_16x16x32_bf16 v[48:51], a[216:219], v[232:235], v[48:51]
    v_accvgpr_read_b32 v206, a86
    v_accvgpr_read_b32 v207, a87
    v_mfma_f32_16x16x32_bf16 v[52:55], a[220:223], v[232:235], v[52:55]
    v_accvgpr_read_b32 v208, a180
    v_accvgpr_read_b32 v209, a181
    v_mfma_f32_16x16x32_bf16 v[56:59], a[224:227], v[232:235], v[56:59]
    v_accvgpr_read_b32 v210, a182
    v_accvgpr_read_b32 v211, a183
    v_mfma_f32_16x16x32_bf16 v[72:75], a[192:195], v[232:235], v[72:75]
    s_waitcnt lgkmcnt(1)
    v_add_f32 v212, v204, v208
    v_add_f32 v213, v205, v209
    v_mfma_f32_16x16x32_bf16 v[72:75], a[204:207], v[236:239], v[72:75]
    v_add_f32 v214, v206, v210
    v_add_f32 v215, v207, v211
    v_mfma_f32_16x16x32_bf16 v[76:79], a[208:211], v[236:239], v[76:79]
    v_sub_f32 v204, v204, v208
    v_sub_f32 v205, v205, v209
    v_mfma_f32_16x16x32_bf16 v[76:79], a[196:199], v[232:235], v[76:79]
    v_sub_f32 v206, v206, v210
    v_sub_f32 v207, v207, v211
    v_mfma_f32_16x16x32_bf16 v[80:83], a[200:203], v[232:235], v[80:83]
    ds_read_b128 v[232:235], v253 offset:13264
    v_accvgpr_write_b32 a84, v212
    v_mfma_f32_16x16x32_bf16 v[80:83], a[212:215], v[236:239], v[80:83]
    s_mov_b32 s42, 921600
    v_accvgpr_write_b32 a85, v213
    v_accvgpr_write_b32 a86, v214
    v_mfma_f32_16x16x32_bf16 v[60:63], a[216:219], v[236:239], v[60:63]
    v_accvgpr_write_b32 a87, v215
    v_accvgpr_write_b32 a180, v204
    v_mfma_f32_16x16x32_bf16 v[64:67], a[220:223], v[236:239], v[64:67]
    v_accvgpr_write_b32 a181, v205
    v_accvgpr_write_b32 a182, v206
    v_mfma_f32_16x16x32_bf16 v[68:71], a[224:227], v[236:239], v[68:71]
    v_accvgpr_write_b32 a183, v207
    v_accvgpr_read_b32 v204, a88
    v_mfma_f32_16x16x32_bf16 v[84:87], a[192:195], v[236:239], v[84:87]
    buffer_load_dwordx4 a[192:195], v254, s[8:11], s42 offen offset:0 sc1
    v_mfma_f32_16x16x32_bf16 v[88:91], a[196:199], v[236:239], v[88:91]
    v_accvgpr_read_b32 v205, a89
    v_accvgpr_read_b32 v206, a90
    v_mfma_f32_16x16x32_bf16 v[92:95], a[200:203], v[236:239], v[92:95]
    s_waitcnt lgkmcnt(1)
    v_accvgpr_read_b32 v207, a91
    v_accvgpr_read_b32 v208, a184
    v_mfma_f32_16x16x32_bf16 v[84:87], a[204:207], v[228:231], v[84:87]
    ds_read_b128 v[236:239], v253 offset:1040
    v_accvgpr_read_b32 v209, a185
    v_mfma_f32_16x16x32_bf16 v[88:91], a[208:211], v[228:231], v[88:91]
    buffer_load_dwordx4 a[196:199], v254, s[8:11], s42 offen offset:1024 sc1
    v_mfma_f32_16x16x32_bf16 v[92:95], a[212:215], v[228:231], v[92:95]
    v_accvgpr_read_b32 v210, a186
    v_accvgpr_read_b32 v211, a187
    v_mfma_f32_16x16x32_bf16 v[72:75], a[216:219], v[228:231], v[72:75]
    s_waitcnt lgkmcnt(1)
    v_add_f32 v212, v204, v208
    v_add_f32 v213, v205, v209
    v_mfma_f32_16x16x32_bf16 v[76:79], a[220:223], v[228:231], v[76:79]
    buffer_load_dwordx4 a[200:203], v254, s[8:11], s42 offen offset:2048 sc1
    v_mfma_f32_16x16x32_bf16 v[80:83], a[224:227], v[228:231], v[80:83]
    ds_read_b128 v[228:231], v253 offset:768
    v_add_f32 v214, v206, v210
    v_mfma_f32_16x16x32_bf16 v[84:87], a[216:219], v[232:235], v[84:87]
    s_mov_b32 s42, 924672
    v_add_f32 v215, v207, v211
    v_sub_f32 v204, v204, v208
    v_mfma_f32_16x16x32_bf16 v[88:91], a[220:223], v[232:235], v[88:91]
    s_waitcnt vmcnt(9) lgkmcnt(1)
    v_sub_f32 v205, v205, v209
    v_sub_f32 v206, v206, v210
    v_mfma_f32_16x16x32_bf16 v[92:95], a[224:227], v[232:235], v[92:95]
    ds_read_b128 v[232:235], v253 offset:512
    v_sub_f32 v207, v207, v211
sub23:
    v_mfma_f32_16x16x32_bf16 v[96:99], a[228:231], v[236:239], v[96:99]
    buffer_load_dwordx4 a[204:207], v254, s[8:11], s42 offen offset:0 sc1
    v_mfma_f32_16x16x32_bf16 v[100:103], a[232:235], v[236:239], v[100:103]
    s_waitcnt vmcnt(7) lgkmcnt(1)
    v_accvgpr_write_b32 a88, v212
    v_accvgpr_write_b32 a89, v213
    v_mfma_f32_16x16x32_bf16 v[104:107], a[236:239], v[236:239], v[104:107]
    ds_read_b128 v[236:239], v253 offset:256
    v_accvgpr_write_b32 a90, v214
    v_mfma_f32_16x16x32_bf16 v[96:99], a[240:243], v[228:231], v[96:99]
    v_accvgpr_write_b32 a91, v215
    v_accvgpr_write_b32 a184, v204
    v_mfma_f32_16x16x32_bf16 v[100:103], a[244:247], v[228:231], v[100:103]
    buffer_load_dwordx4 a[208:211], v254, s[8:11], s42 offen offset:1024 sc1
    v_mfma_f32_16x16x32_bf16 v[104:107], a[248:251], v[228:231], v[104:107]
    v_accvgpr_write_b32 a185, v205
    v_accvgpr_write_b32 a186, v206
    v_mfma_f32_16x16x32_bf16 v[108:111], a[228:231], v[228:231], v[108:111]
    s_waitcnt lgkmcnt(1)
    v_accvgpr_write_b32 a187, v207
    v_accvgpr_read_b32 v204, a92
    v_mfma_f32_16x16x32_bf16 v[108:111], a[240:243], v[232:235], v[108:111]
    v_accvgpr_read_b32 v205, a93
    v_accvgpr_read_b32 v206, a94
    v_mfma_f32_16x16x32_bf16 v[112:115], a[244:247], v[232:235], v[112:115]
    buffer_load_dwordx4 a[212:215], v254, s[8:11], s42 offen offset:2048 sc1
    v_mfma_f32_16x16x32_bf16 v[112:115], a[232:235], v[228:231], v[112:115]
    s_mov_b32 s42, 927744
    v_accvgpr_read_b32 v207, a95
    v_accvgpr_read_b32 v208, a188
    v_mfma_f32_16x16x32_bf16 v[116:119], a[236:239], v[228:231], v[116:119]
    ds_read_b128 v[228:231], v253 offset:0
    v_accvgpr_read_b32 v209, a189
    v_mfma_f32_16x16x32_bf16 v[116:119], a[248:251], v[232:235], v[116:119]
    s_waitcnt vmcnt(6)
    v_accvgpr_read_b32 v210, a190
    v_accvgpr_read_b32 v211, a191
    v_mfma_f32_16x16x32_bf16 v[96:99], a[252:255], v[232:235], v[96:99]
    buffer_load_dwordx4 a[216:219], v254, s[8:11], s42 offen offset:0 sc1
    v_mfma_f32_16x16x32_bf16 v[100:103], v[240:243], v[232:235], v[100:103]
    v_add_f32 v212, v204, v208
    v_add_f32 v213, v205, v209
    v_mfma_f32_16x16x32_bf16 v[104:107], v[244:247], v[232:235], v[104:107]
    v_add_f32 v214, v206, v210
    v_add_f32 v215, v207, v211
    v_mfma_f32_16x16x32_bf16 v[120:123], a[228:231], v[232:235], v[120:123]
    s_waitcnt lgkmcnt(1)
    v_sub_f32 v204, v204, v208
    v_sub_f32 v205, v205, v209
    v_mfma_f32_16x16x32_bf16 v[120:123], a[240:243], v[236:239], v[120:123]
    buffer_load_dwordx4 a[220:223], v254, s[8:11], s42 offen offset:1024 sc1
    v_mfma_f32_16x16x32_bf16 v[124:127], a[244:247], v[236:239], v[124:127]
    v_sub_f32 v206, v206, v210
    v_sub_f32 v207, v207, v211
    v_mfma_f32_16x16x32_bf16 v[124:127], a[232:235], v[232:235], v[124:127]
    v_accvgpr_write_b32 a92, v212
    v_accvgpr_write_b32 a93, v213
    v_mfma_f32_16x16x32_bf16 v[128:131], a[236:239], v[232:235], v[128:131]
pad8:
    s_cbranch_vccnz pad12
    ds_read_b128 v[232:235], v253 offset:1824
    v_accvgpr_write_b32 a94, v214
    v_mfma_f32_16x16x32_bf16 v[128:131], a[248:251], v[236:239], v[128:131]
    buffer_load_dwordx4 a[224:227], v254, s[8:11], s42 offen offset:2048 sc1
    v_mfma_f32_16x16x32_bf16 v[108:111], a[252:255], v[236:239], v[108:111]
    v_accvgpr_write_b32 a95, v215
    v_accvgpr_write_b32 a188, v204
    v_mfma_f32_16x16x32_bf16 v[112:115], v[240:243], v[236:239], v[112:115]
    v_and_b32 v252, 0x1f0, v254
    v_mul_u32_u24 v252, 96, v252
    v_mfma_f32_16x16x32_bf16 v[116:119], v[244:247], v[236:239], v[116:119]
    buffer_load_dword v252, v252, s[4:7], s100 offen offset:1152
    v_mfma_f32_16x16x32_bf16 v[132:135], a[228:231], v[236:239], v[132:135]
    s_waitcnt lgkmcnt(1)
    v_accvgpr_write_b32 a189, v205
    v_accvgpr_write_b32 a190, v206
    v_mfma_f32_16x16x32_bf16 v[132:135], a[240:243], v[228:231], v[132:135]
    v_accvgpr_write_b32 a191, v207
    v_accvgpr_read_b32 v204, a0
    v_mfma_f32_16x16x32_bf16 v[136:139], a[244:247], v[228:231], v[136:139]
    v_accvgpr_read_b32 v205, a1
    v_accvgpr_read_b32 v206, a2
    v_mfma_f32_16x16x32_bf16 v[136:139], a[232:235], v[236:239], v[136:139]
    v_accvgpr_read_b32 v207, a3
    v_add_f32 v208, v0, v96
    v_mfma_f32_16x16x32_bf16 v[140:143], a[236:239], v[236:239], v[140:143]
    ds_read_b128 v[236:239], v253 offset:1568
    v_add_f32 v209, v1, v97
    v_mfma_f32_16x16x32_bf16 v[140:143], a[248:251], v[228:231], v[140:143]
    v_add_f32 v210, v2, v98
    v_add_f32 v211, v3, v99
    v_mfma_f32_16x16x32_bf16 v[120:123], a[252:255], v[228:231], v[120:123]
    v_sub_f32 v96, v0, v96
    v_sub_f32 v97, v1, v97
    v_mfma_f32_16x16x32_bf16 v[124:127], v[240:243], v[228:231], v[124:127]
    v_sub_f32 v98, v2, v98
    v_sub_f32 v99, v3, v99
    v_mfma_f32_16x16x32_bf16 v[128:131], v[244:247], v[228:231], v[128:131]
    v_fma_f32 v0, v208, s31, v204
    v_fma_f32 v1, v209, s31, v205
    v_mfma_f32_16x16x32_bf16 v[144:147], a[228:231], v[228:231], v[144:147]
    s_waitcnt lgkmcnt(1)
    v_fma_f32 v2, v210, s31, v206
    v_fma_f32 v3, v211, s31, v207
    v_mfma_f32_16x16x32_bf16 v[144:147], a[240:243], v[232:235], v[144:147]
    v_fmac_f32 v208, s30, v204
    v_fmac_f32 v209, s30, v205
    v_mfma_f32_16x16x32_bf16 v[148:151], a[244:247], v[232:235], v[148:151]
    v_fmac_f32 v210, s30, v206
    v_fmac_f32 v211, s30, v207
    v_mfma_f32_16x16x32_bf16 v[148:151], a[232:235], v[228:231], v[148:151]
    v_cvt_pk_bf16_f32 v194, v208, v209
    v_cvt_pk_bf16_f32 v195, v210, v211
    v_mfma_f32_16x16x32_bf16 v[152:155], a[236:239], v[228:231], v[152:155]
    ds_read_b128 v[228:231], v253 offset:1312
    v_accvgpr_read_b32 v204, a4
    v_mfma_f32_16x16x32_bf16 v[152:155], a[248:251], v[232:235], v[152:155]
    v_accvgpr_read_b32 v205, a5
    v_accvgpr_read_b32 v206, a6
    v_mfma_f32_16x16x32_bf16 v[132:135], a[252:255], v[232:235], v[132:135]
    v_accvgpr_read_b32 v207, a7
    v_add_f32 v208, v4, v100
    v_mfma_f32_16x16x32_bf16 v[136:139], v[240:243], v[232:235], v[136:139]
    v_add_f32 v209, v5, v101
    v_add_f32 v210, v6, v102
    v_mfma_f32_16x16x32_bf16 v[140:143], v[244:247], v[232:235], v[140:143]
    v_add_f32 v211, v7, v103
    v_sub_f32 v100, v4, v100
    v_mfma_f32_16x16x32_bf16 v[156:159], a[228:231], v[232:235], v[156:159]
    s_waitcnt lgkmcnt(1)
    v_sub_f32 v101, v5, v101
    v_sub_f32 v102, v6, v102
    v_mfma_f32_16x16x32_bf16 v[156:159], a[240:243], v[236:239], v[156:159]
    v_sub_f32 v103, v7, v103
    v_fma_f32 v4, v208, s31, v204
    v_mfma_f32_16x16x32_bf16 v[160:163], a[244:247], v[236:239], v[160:163]
    v_fma_f32 v5, v209, s31, v205
    v_fma_f32 v6, v210, s31, v206
    v_mfma_f32_16x16x32_bf16 v[160:163], a[232:235], v[232:235], v[160:163]
    v_fma_f32 v7, v211, s31, v207
    v_fmac_f32 v208, s30, v204
    v_mfma_f32_16x16x32_bf16 v[164:167], a[236:239], v[232:235], v[164:167]
    ds_read_b128 v[232:235], v253 offset:1056
    v_fmac_f32 v209, s30, v205
    v_mfma_f32_16x16x32_bf16 v[164:167], a[248:251], v[236:239], v[164:167]
    v_fmac_f32 v210, s30, v206
    v_fmac_f32 v211, s30, v207
    v_mfma_f32_16x16x32_bf16 v[144:147], a[252:255], v[236:239], v[144:147]
    v_cvt_pk_bf16_f32 v196, v208, v209
    v_cvt_pk_bf16_f32 v197, v210, v211
    v_mfma_f32_16x16x32_bf16 v[148:151], v[240:243], v[236:239], v[148:151]
    v_accvgpr_read_b32 v204, a8
    v_accvgpr_read_b32 v205, a9
    v_mfma_f32_16x16x32_bf16 v[152:155], v[244:247], v[236:239], v[152:155]
    v_accvgpr_read_b32 v206, a10
    v_accvgpr_read_b32 v207, a11
    v_mfma_f32_16x16x32_bf16 v[168:171], a[228:231], v[236:239], v[168:171]
    s_waitcnt lgkmcnt(1)
    v_add_f32 v208, v8, v104
    v_add_f32 v209, v9, v105
    v_mfma_f32_16x16x32_bf16 v[168:171], a[240:243], v[228:231], v[168:171]
    v_add_f32 v210, v10, v106
    v_add_f32 v211, v11, v107
    v_mfma_f32_16x16x32_bf16 v[172:175], a[244:247], v[228:231], v[172:175]
    v_sub_f32 v104, v8, v104
    v_sub_f32 v105, v9, v105
    v_mfma_f32_16x16x32_bf16 v[172:175], a[232:235], v[236:239], v[172:175]
    v_sub_f32 v106, v10, v106
    v_sub_f32 v107, v11, v107
    v_mfma_f32_16x16x32_bf16 v[176:179], a[236:239], v[236:239], v[176:179]
    ds_read_b128 v[236:239], v253 offset:784
    v_fma_f32 v8, v208, s31, v204
    v_mfma_f32_16x16x32_bf16 v[176:179], a[248:251], v[228:231], v[176:179]
    s_mov_b32 s42, 958464
    v_fma_f32 v9, v209, s31, v205
    v_fma_f32 v10, v210, s31, v206
    v_mfma_f32_16x16x32_bf16 v[156:159], a[252:255], v[228:231], v[156:159]
    v_fma_f32 v11, v211, s31, v207
    v_fmac_f32 v208, s30, v204
    v_mfma_f32_16x16x32_bf16 v[160:163], v[240:243], v[228:231], v[160:163]
    v_fmac_f32 v209, s30, v205
    v_fmac_f32 v210, s30, v206
    v_mfma_f32_16x16x32_bf16 v[164:167], v[244:247], v[228:231], v[164:167]
    s_waitcnt lgkmcnt(1)
    v_fmac_f32 v211, s30, v207
    v_cvt_pk_bf16_f32 v198, v208, v209
    v_mfma_f32_16x16x32_bf16 v[180:183], a[228:231], v[228:231], v[180:183]
    buffer_load_dwordx4 a[228:231], v254, s[8:11], s42 offen offset:0 sc1
    v_mfma_f32_16x16x32_bf16 v[184:187], a[232:235], v[228:231], v[184:187]
    s_waitcnt lgkmcnt(0)
    v_cvt_pk_bf16_f32 v199, v210, v211
    v_mfma_f32_16x16x32_bf16 v[188:191], a[236:239], v[228:231], v[188:191]
    s_barrier
    v_mfma_f32_16x16x32_bf16 v[180:183], a[240:243], v[232:235], v[180:183]
    ds_read_b128 v[228:231], v253 offset:15600
    v_mfma_f32_16x16x32_bf16 v[184:187], a[244:247], v[232:235], v[184:187]
    buffer_load_dwordx4 a[232:235], v254, s[8:11], s42 offen offset:1024 sc1
    v_mfma_f32_16x16x32_bf16 v[188:191], a[248:251], v[232:235], v[188:191]
    v_mfma_f32_16x16x32_bf16 v[168:171], a[252:255], v[232:235], v[168:171]
    v_mfma_f32_16x16x32_bf16 v[172:175], v[240:243], v[232:235], v[172:175]
    buffer_load_dwordx4 a[236:239], v254, s[8:11], s42 offen offset:2048 sc1
    v_mfma_f32_16x16x32_bf16 v[176:179], v[244:247], v[232:235], v[176:179]
    ds_read_b128 v[232:235], v253 offset:15328
    v_mfma_f32_16x16x32_bf16 v[180:183], a[252:255], v[236:239], v[180:183]
    s_mov_b32 s42, 961536
    v_mfma_f32_16x16x32_bf16 v[184:187], v[240:243], v[236:239], v[184:187]
    s_waitcnt vmcnt(10) lgkmcnt(1)
    v_mfma_f32_16x16x32_bf16 v[188:191], v[244:247], v[236:239], v[188:191]
    ds_read_b128 v[236:239], v253 offset:15072
    s_nop 0
    ds_write_b128 v248, v[194:197] offset:0
    v_accvgpr_read_b32 v204, a12
    v_accvgpr_read_b32 v205, a13
    v_accvgpr_read_b32 v206, a14
    v_accvgpr_read_b32 v207, a15
    v_pk_add_f32 v[208:209], v[12:13], v[108:109]
    v_pk_add_f32 v[210:211], v[14:15], v[110:111]
    v_pk_add_f32 v[108:109], v[12:13], v[108:109] neg_lo:[0,1] neg_hi:[0,1]
    v_pk_add_f32 v[110:111], v[14:15], v[110:111] neg_lo:[0,1] neg_hi:[0,1]
    v_pk_fma_f32 v[12:13], v[208:209], s[30:31], v[204:205] op_sel:[0,1,0]
    v_pk_fma_f32 v[14:15], v[210:211], s[30:31], v[206:207] op_sel:[0,1,0]
    v_pk_fma_f32 v[204:205], v[204:205], s[30:31], v[208:209] op_sel_hi:[1,0,1]
    v_pk_fma_f32 v[206:207], v[206:207], s[30:31], v[210:211] op_sel_hi:[1,0,1]
    v_cvt_pk_bf16_f32 v220, v204, v205
    v_cvt_pk_bf16_f32 v221, v206, v207
    ds_write_b64 v249, v[198:199] offset:64
    v_accvgpr_read_b32 v212, a16
    v_accvgpr_read_b32 v213, a17
    v_accvgpr_read_b32 v214, a18
    v_accvgpr_read_b32 v215, a19
    v_pk_add_f32 v[216:217], v[16:17], v[112:113]
    v_pk_add_f32 v[218:219], v[18:19], v[114:115]
    v_pk_add_f32 v[112:113], v[16:17], v[112:113] neg_lo:[0,1] neg_hi:[0,1]
    v_pk_add_f32 v[114:115], v[18:19], v[114:115] neg_lo:[0,1] neg_hi:[0,1]
    v_pk_fma_f32 v[16:17], v[216:217], s[30:31], v[212:213] op_sel:[0,1,0]
    v_pk_fma_f32 v[18:19], v[218:219], s[30:31], v[214:215] op_sel:[0,1,0]
    v_pk_fma_f32 v[212:213], v[212:213], s[30:31], v[216:217] op_sel_hi:[1,0,1]
    v_pk_fma_f32 v[214:215], v[214:215], s[30:31], v[218:219] op_sel_hi:[1,0,1]
    v_cvt_pk_bf16_f32 v222, v212, v213
    v_cvt_pk_bf16_f32 v223, v214, v215
    ds_write_b128 v248, v[220:223] offset:384
    v_accvgpr_read_b32 v204, a20
    v_accvgpr_read_b32 v205, a21
    v_accvgpr_read_b32 v206, a22
    v_accvgpr_read_b32 v207, a23
    v_pk_add_f32 v[208:209], v[20:21], v[116:117]
    v_pk_add_f32 v[210:211], v[22:23], v[118:119]
    v_pk_add_f32 v[116:117], v[20:21], v[116:117] neg_lo:[0,1] neg_hi:[0,1]
    v_pk_add_f32 v[118:119], v[22:23], v[118:119] neg_lo:[0,1] neg_hi:[0,1]
    v_pk_fma_f32 v[20:21], v[208:209], s[30:31], v[204:205] op_sel:[0,1,0]
    v_pk_fma_f32 v[22:23], v[210:211], s[30:31], v[206:207] op_sel:[0,1,0]
    v_pk_fma_f32 v[204:205], v[204:205], s[30:31], v[208:209] op_sel_hi:[1,0,1]
    v_pk_fma_f32 v[206:207], v[206:207], s[30:31], v[210:211] op_sel_hi:[1,0,1]
    v_cvt_pk_bf16_f32 v224, v204, v205
    v_cvt_pk_bf16_f32 v225, v206, v207
    v_accvgpr_read_b32 v204, a24
    v_accvgpr_read_b32 v205, a25
    v_accvgpr_read_b32 v206, a26
    v_accvgpr_read_b32 v207, a27
    v_pk_add_f32 v[208:209], v[24:25], v[120:121]
    v_pk_add_f32 v[210:211], v[26:27], v[122:123]
    v_pk_add_f32 v[120:121], v[24:25], v[120:121] neg_lo:[0,1] neg_hi:[0,1]
    v_pk_add_f32 v[122:123], v[26:27], v[122:123] neg_lo:[0,1] neg_hi:[0,1]
    v_pk_fma_f32 v[24:25], v[208:209], s[30:31], v[204:205] op_sel:[0,1,0]
    v_pk_fma_f32 v[26:27], v[210:211], s[30:31], v[206:207] op_sel:[0,1,0]
    v_pk_fma_f32 v[204:205], v[204:205], s[30:31], v[208:209] op_sel_hi:[1,0,1]
    v_pk_fma_f32 v[206:207], v[206:207], s[30:31], v[210:211] op_sel_hi:[1,0,1]
    v_cvt_pk_bf16_f32 v194, v204, v205
    v_cvt_pk_bf16_f32 v195, v206, v207
    ds_write_b64 v249, v[224:225] offset:448
    v_accvgpr_read_b32 v212, a28
    v_accvgpr_read_b32 v213, a29
    v_accvgpr_read_b32 v214, a30
    v_accvgpr_read_b32 v215, a31
    v_accvgpr_read_b32 v216, a124
    v_accvgpr_read_b32 v217, a125
    v_accvgpr_read_b32 v218, a126
    v_accvgpr_read_b32 v219, a127
    v_pk_add_f32 v[212:213], v[212:213], v[216:217]
    v_pk_add_f32 v[214:215], v[214:215], v[218:219]
    v_pk_add_f32 v[216:217], v[28:29], v[124:125]
    v_pk_add_f32 v[218:219], v[30:31], v[126:127]
    v_pk_add_f32 v[124:125], v[28:29], v[124:125] neg_lo:[0,1] neg_hi:[0,1]
    v_pk_add_f32 v[126:127], v[30:31], v[126:127] neg_lo:[0,1] neg_hi:[0,1]
    v_pk_fma_f32 v[28:29], v[216:217], s[30:31], v[212:213] op_sel:[0,1,0]
    v_pk_fma_f32 v[30:31], v[218:219], s[30:31], v[214:215] op_sel:[0,1,0]
    v_pk_fma_f32 v[212:213], v[212:213], s[30:31], v[216:217] op_sel_hi:[1,0,1]
    v_pk_fma_f32 v[214:215], v[214:215], s[30:31], v[218:219] op_sel_hi:[1,0,1]
    v_cvt_pk_bf16_f32 v196, v212, v213
    v_cvt_pk_bf16_f32 v197, v214, v215
    ds_write_b128 v248, v[194:197] offset:768
    v_accvgpr_read_b32 v204, a32
    v_accvgpr_read_b32 v205, a33
    v_accvgpr_read_b32 v206, a34
    v_accvgpr_read_b32 v207, a35
    v_accvgpr_read_b32 v208, a128
    v_accvgpr_read_b32 v209, a129
    v_accvgpr_read_b32 v210, a130
    v_accvgpr_read_b32 v211, a131
    v_pk_add_f32 v[204:205], v[204:205], v[208:209]
    v_pk_add_f32 v[206:207], v[206:207], v[210:211]
    v_pk_add_f32 v[208:209], v[32:33], v[128:129]
    v_pk_add_f32 v[210:211], v[34:35], v[130:131]
    v_pk_add_f32 v[128:129], v[32:33], v[128:129] neg_lo:[0,1] neg_hi:[0,1]
    v_pk_add_f32 v[130:131], v[34:35], v[130:131] neg_lo:[0,1] neg_hi:[0,1]
    v_pk_fma_f32 v[32:33], v[208:209], s[30:31], v[204:205] op_sel:[0,1,0]
    v_pk_fma_f32 v[34:35], v[210:211], s[30:31], v[206:207] op_sel:[0,1,0]
    v_pk_fma_f32 v[204:205], v[204:205], s[30:31], v[208:209] op_sel_hi:[1,0,1]
    v_pk_fma_f32 v[206:207], v[206:207], s[30:31], v[210:211] op_sel_hi:[1,0,1]
    v_cvt_pk_bf16_f32 v198, v204, v205
    v_cvt_pk_bf16_f32 v199, v206, v207
    v_accvgpr_read_b32 v204, a36
    v_accvgpr_read_b32 v205, a37
    v_accvgpr_read_b32 v206, a38
    v_accvgpr_read_b32 v207, a39
    v_accvgpr_read_b32 v208, a132
    v_accvgpr_read_b32 v209, a133
    v_accvgpr_read_b32 v210, a134
    v_accvgpr_read_b32 v211, a135
    v_pk_add_f32 v[204:205], v[204:205], v[208:209]
    v_pk_add_f32 v[206:207], v[206:207], v[210:211]
    v_pk_add_f32 v[208:209], v[36:37], v[132:133]
    v_pk_add_f32 v[210:211], v[38:39], v[134:135]
    v_pk_add_f32 v[132:133], v[36:37], v[132:133] neg_lo:[0,1] neg_hi:[0,1]
    v_pk_add_f32 v[134:135], v[38:39], v[134:135] neg_lo:[0,1] neg_hi:[0,1]
    v_pk_fma_f32 v[36:37], v[208:209], s[30:31], v[204:205] op_sel:[0,1,0]
    v_pk_fma_f32 v[38:39], v[210:211], s[30:31], v[206:207] op_sel:[0,1,0]
    v_pk_fma_f32 v[204:205], v[204:205], s[30:31], v[208:209] op_sel_hi:[1,0,1]
    v_pk_fma_f32 v[206:207], v[206:207], s[30:31], v[210:211] op_sel_hi:[1,0,1]
    v_cvt_pk_bf16_f32 v220, v204, v205
    v_cvt_pk_bf16_f32 v221, v206, v207
    ds_write_b64 v249, v[198:199] offset:832
    v_accvgpr_read_b32 v212, a40
    v_accvgpr_read_b32 v213, a41
    v_accvgpr_read_b32 v214, a42
    v_accvgpr_read_b32 v215, a43
    v_accvgpr_read_b32 v216, a136
    v_accvgpr_read_b32 v217, a137
    v_accvgpr_read_b32 v218, a138
    v_accvgpr_read_b32 v219, a139
    v_pk_add_f32 v[212:213], v[212:213], v[216:217]
    v_pk_add_f32 v[214:215], v[214:215], v[218:219]
    v_pk_add_f32 v[216:217], v[40:41], v[136:137]
    v_pk_add_f32 v[218:219], v[42:43], v[138:139]
    v_pk_add_f32 v[136:137], v[40:41], v[136:137] neg_lo:[0,1] neg_hi:[0,1]
    v_pk_add_f32 v[138:139], v[42:43], v[138:139] neg_lo:[0,1] neg_hi:[0,1]
    v_pk_fma_f32 v[40:41], v[216:217], s[30:31], v[212:213] op_sel:[0,1,0]
    v_pk_fma_f32 v[42:43], v[218:219], s[30:31], v[214:215] op_sel:[0,1,0]
    v_pk_fma_f32 v[212:213], v[212:213], s[30:31], v[216:217] op_sel_hi:[1,0,1]
    v_pk_fma_f32 v[214:215], v[214:215], s[30:31], v[218:219] op_sel_hi:[1,0,1]
    v_cvt_pk_bf16_f32 v222, v212, v213
    v_cvt_pk_bf16_f32 v223, v214, v215
    ds_write_b128 v248, v[220:223] offset:1152
    v_accvgpr_read_b32 v204, a44
    v_accvgpr_read_b32 v205, a45
    v_accvgpr_read_b32 v206, a46
    v_accvgpr_read_b32 v207, a47
    v_accvgpr_read_b32 v208, a140
    v_accvgpr_read_b32 v209, a141
    v_accvgpr_read_b32 v210, a142
    v_accvgpr_read_b32 v211, a143
    v_pk_add_f32 v[204:205], v[204:205], v[208:209]
    v_pk_add_f32 v[206:207], v[206:207], v[210:211]
    v_pk_add_f32 v[208:209], v[44:45], v[140:141]
    v_pk_add_f32 v[210:211], v[46:47], v[142:143]
    v_pk_add_f32 v[140:141], v[44:45], v[140:141] neg_lo:[0,1] neg_hi:[0,1]
    v_pk_add_f32 v[142:143], v[46:47], v[142:143] neg_lo:[0,1] neg_hi:[0,1]
    v_pk_fma_f32 v[44:45], v[208:209], s[30:31], v[204:205] op_sel:[0,1,0]
    v_pk_fma_f32 v[46:47], v[210:211], s[30:31], v[206:207] op_sel:[0,1,0]
    v_pk_fma_f32 v[204:205], v[204:205], s[30:31], v[208:209] op_sel_hi:[1,0,1]
    v_pk_fma_f32 v[206:207], v[206:207], s[30:31], v[210:211] op_sel_hi:[1,0,1]
    v_cvt_pk_bf16_f32 v224, v204, v205
    v_cvt_pk_bf16_f32 v225, v206, v207
    v_accvgpr_read_b32 v204, a48
    v_accvgpr_read_b32 v205, a49
    v_accvgpr_read_b32 v206, a50
    v_accvgpr_read_b32 v207, a51
    v_accvgpr_read_b32 v208, a144
    v_accvgpr_read_b32 v209, a145
    v_accvgpr_read_b32 v210, a146
    v_accvgpr_read_b32 v211, a147
    v_pk_add_f32 v[204:205], v[204:205], v[208:209]
    v_pk_add_f32 v[206:207], v[206:207], v[210:211]
    v_pk_add_f32 v[208:209], v[48:49], v[144:145]
    v_pk_add_f32 v[210:211], v[50:51], v[146:147]
    v_pk_add_f32 v[144:145], v[48:49], v[144:145] neg_lo:[0,1] neg_hi:[0,1]
    v_pk_add_f32 v[146:147], v[50:51], v[146:147] neg_lo:[0,1] neg_hi:[0,1]
    v_pk_fma_f32 v[48:49], v[208:209], s[30:31], v[204:205] op_sel:[0,1,0]
    v_pk_fma_f32 v[50:51], v[210:211], s[30:31], v[206:207] op_sel:[0,1,0]
    v_pk_fma_f32 v[204:205], v[204:205], s[30:31], v[208:209] op_sel_hi:[1,0,1]
    v_pk_fma_f32 v[206:207], v[206:207], s[30:31], v[210:211] op_sel_hi:[1,0,1]
    v_cvt_pk_bf16_f32 v194, v204, v205
    v_cvt_pk_bf16_f32 v195, v206, v207
    ds_write_b64 v249, v[224:225] offset:1216
    v_accvgpr_read_b32 v212, a52
    v_accvgpr_read_b32 v213, a53
    v_accvgpr_read_b32 v214, a54
    v_accvgpr_read_b32 v215, a55
    v_accvgpr_read_b32 v216, a148
    v_accvgpr_read_b32 v217, a149
    v_accvgpr_read_b32 v218, a150
    v_accvgpr_read_b32 v219, a151
    v_pk_add_f32 v[212:213], v[212:213], v[216:217]
    v_pk_add_f32 v[214:215], v[214:215], v[218:219]
    v_pk_add_f32 v[216:217], v[52:53], v[148:149]
    v_pk_add_f32 v[218:219], v[54:55], v[150:151]
    v_pk_add_f32 v[148:149], v[52:53], v[148:149] neg_lo:[0,1] neg_hi:[0,1]
    v_pk_add_f32 v[150:151], v[54:55], v[150:151] neg_lo:[0,1] neg_hi:[0,1]
    v_pk_fma_f32 v[52:53], v[216:217], s[30:31], v[212:213] op_sel:[0,1,0]
    v_pk_fma_f32 v[54:55], v[218:219], s[30:31], v[214:215] op_sel:[0,1,0]
    v_pk_fma_f32 v[212:213], v[212:213], s[30:31], v[216:217] op_sel_hi:[1,0,1]
    v_pk_fma_f32 v[214:215], v[214:215], s[30:31], v[218:219] op_sel_hi:[1,0,1]
    v_cvt_pk_bf16_f32 v196, v212, v213
    v_cvt_pk_bf16_f32 v197, v214, v215
    ds_write_b128 v248, v[194:197] offset:1536
    v_accvgpr_read_b32 v204, a56
    v_accvgpr_read_b32 v205, a57
    v_accvgpr_read_b32 v206, a58
    v_accvgpr_read_b32 v207, a59
    v_accvgpr_read_b32 v208, a152
    v_accvgpr_read_b32 v209, a153
    v_accvgpr_read_b32 v210, a154
    v_accvgpr_read_b32 v211, a155
    v_pk_add_f32 v[204:205], v[204:205], v[208:209]
    v_pk_add_f32 v[206:207], v[206:207], v[210:211]
    v_pk_add_f32 v[208:209], v[56:57], v[152:153]
    v_pk_add_f32 v[210:211], v[58:59], v[154:155]
    v_pk_add_f32 v[152:153], v[56:57], v[152:153] neg_lo:[0,1] neg_hi:[0,1]
    v_pk_add_f32 v[154:155], v[58:59], v[154:155] neg_lo:[0,1] neg_hi:[0,1]
    v_pk_fma_f32 v[56:57], v[208:209], s[30:31], v[204:205] op_sel:[0,1,0]
    v_pk_fma_f32 v[58:59], v[210:211], s[30:31], v[206:207] op_sel:[0,1,0]
    v_pk_fma_f32 v[204:205], v[204:205], s[30:31], v[208:209] op_sel_hi:[1,0,1]
    v_pk_fma_f32 v[206:207], v[206:207], s[30:31], v[210:211] op_sel_hi:[1,0,1]
    v_cvt_pk_bf16_f32 v198, v204, v205
    v_cvt_pk_bf16_f32 v199, v206, v207
    v_accvgpr_read_b32 v204, a60
    v_accvgpr_read_b32 v205, a61
    v_accvgpr_read_b32 v206, a62
    v_accvgpr_read_b32 v207, a63
    v_accvgpr_read_b32 v208, a156
    v_accvgpr_read_b32 v209, a157
    v_accvgpr_read_b32 v210, a158
    v_accvgpr_read_b32 v211, a159
    v_pk_add_f32 v[204:205], v[204:205], v[208:209]
    v_pk_add_f32 v[206:207], v[206:207], v[210:211]
    v_pk_add_f32 v[208:209], v[60:61], v[156:157]
    v_pk_add_f32 v[210:211], v[62:63], v[158:159]
    v_pk_add_f32 v[156:157], v[60:61], v[156:157] neg_lo:[0,1] neg_hi:[0,1]
    v_pk_add_f32 v[158:159], v[62:63], v[158:159] neg_lo:[0,1] neg_hi:[0,1]
    v_pk_fma_f32 v[60:61], v[208:209], s[30:31], v[204:205] op_sel:[0,1,0]
    v_pk_fma_f32 v[62:63], v[210:211], s[30:31], v[206:207] op_sel:[0,1,0]
    v_pk_fma_f32 v[204:205], v[204:205], s[30:31], v[208:209] op_sel_hi:[1,0,1]
    v_pk_fma_f32 v[206:207], v[206:207], s[30:31], v[210:211] op_sel_hi:[1,0,1]
    v_cvt_pk_bf16_f32 v220, v204, v205
    v_cvt_pk_bf16_f32 v221, v206, v207
    ds_write_b64 v249, v[198:199] offset:1600
    v_accvgpr_read_b32 v212, a64
    v_accvgpr_read_b32 v213, a65
    v_accvgpr_read_b32 v214, a66
    v_accvgpr_read_b32 v215, a67
    v_accvgpr_read_b32 v216, a160
    v_accvgpr_read_b32 v217, a161
    v_accvgpr_read_b32 v218, a162
    v_accvgpr_read_b32 v219, a163
    v_pk_add_f32 v[212:213], v[212:213], v[216:217]
    v_pk_add_f32 v[214:215], v[214:215], v[218:219]
    v_pk_add_f32 v[216:217], v[64:65], v[160:161]
    v_pk_add_f32 v[218:219], v[66:67], v[162:163]
    v_pk_add_f32 v[160:161], v[64:65], v[160:161] neg_lo:[0,1] neg_hi:[0,1]
    v_pk_add_f32 v[162:163], v[66:67], v[162:163] neg_lo:[0,1] neg_hi:[0,1]
    v_pk_fma_f32 v[64:65], v[216:217], s[30:31], v[212:213] op_sel:[0,1,0]
    v_pk_fma_f32 v[66:67], v[218:219], s[30:31], v[214:215] op_sel:[0,1,0]
    v_pk_fma_f32 v[212:213], v[212:213], s[30:31], v[216:217] op_sel_hi:[1,0,1]
    v_pk_fma_f32 v[214:215], v[214:215], s[30:31], v[218:219] op_sel_hi:[1,0,1]
    v_cvt_pk_bf16_f32 v222, v212, v213
    v_cvt_pk_bf16_f32 v223, v214, v215
    ds_write_b128 v248, v[220:223] offset:1920
    v_accvgpr_read_b32 v204, a68
    v_accvgpr_read_b32 v205, a69
    v_accvgpr_read_b32 v206, a70
    v_accvgpr_read_b32 v207, a71
    v_accvgpr_read_b32 v208, a164
    v_accvgpr_read_b32 v209, a165
    v_accvgpr_read_b32 v210, a166
    v_accvgpr_read_b32 v211, a167
    v_pk_add_f32 v[204:205], v[204:205], v[208:209]
    v_pk_add_f32 v[206:207], v[206:207], v[210:211]
    v_pk_add_f32 v[208:209], v[68:69], v[164:165]
    v_pk_add_f32 v[210:211], v[70:71], v[166:167]
    v_pk_add_f32 v[164:165], v[68:69], v[164:165] neg_lo:[0,1] neg_hi:[0,1]
    v_pk_add_f32 v[166:167], v[70:71], v[166:167] neg_lo:[0,1] neg_hi:[0,1]
    v_pk_fma_f32 v[68:69], v[208:209], s[30:31], v[204:205] op_sel:[0,1,0]
    v_pk_fma_f32 v[70:71], v[210:211], s[30:31], v[206:207] op_sel:[0,1,0]
    v_pk_fma_f32 v[204:205], v[204:205], s[30:31], v[208:209] op_sel_hi:[1,0,1]
    v_pk_fma_f32 v[206:207], v[206:207], s[30:31], v[210:211] op_sel_hi:[1,0,1]
    v_cvt_pk_bf16_f32 v224, v204, v205
    v_cvt_pk_bf16_f32 v225, v206, v207
    v_accvgpr_read_b32 v204, a72
    v_accvgpr_read_b32 v205, a73
    v_accvgpr_read_b32 v206, a74
    v_accvgpr_read_b32 v207, a75
    v_accvgpr_read_b32 v208, a168
    v_accvgpr_read_b32 v209, a169
    v_accvgpr_read_b32 v210, a170
    v_accvgpr_read_b32 v211, a171
    v_pk_add_f32 v[204:205], v[204:205], v[208:209]
    v_pk_add_f32 v[206:207], v[206:207], v[210:211]
    v_pk_add_f32 v[208:209], v[72:73], v[168:169]
    v_pk_add_f32 v[210:211], v[74:75], v[170:171]
    v_pk_add_f32 v[168:169], v[72:73], v[168:169] neg_lo:[0,1] neg_hi:[0,1]
    v_pk_add_f32 v[170:171], v[74:75], v[170:171] neg_lo:[0,1] neg_hi:[0,1]
    v_pk_fma_f32 v[72:73], v[208:209], s[30:31], v[204:205] op_sel:[0,1,0]
    v_pk_fma_f32 v[74:75], v[210:211], s[30:31], v[206:207] op_sel:[0,1,0]
    v_pk_fma_f32 v[204:205], v[204:205], s[30:31], v[208:209] op_sel_hi:[1,0,1]
    v_pk_fma_f32 v[206:207], v[206:207], s[30:31], v[210:211] op_sel_hi:[1,0,1]
    v_cvt_pk_bf16_f32 v194, v204, v205
    v_cvt_pk_bf16_f32 v195, v206, v207
    ds_write_b64 v249, v[224:225] offset:1984
    v_accvgpr_read_b32 v212, a76
    v_accvgpr_read_b32 v213, a77
    v_accvgpr_read_b32 v214, a78
    v_accvgpr_read_b32 v215, a79
    v_accvgpr_read_b32 v216, a172
    v_accvgpr_read_b32 v217, a173
    v_accvgpr_read_b32 v218, a174
    v_accvgpr_read_b32 v219, a175
    v_pk_add_f32 v[212:213], v[212:213], v[216:217]
    v_pk_add_f32 v[214:215], v[214:215], v[218:219]
    v_pk_add_f32 v[216:217], v[76:77], v[172:173]
    v_pk_add_f32 v[218:219], v[78:79], v[174:175]
    v_pk_add_f32 v[172:173], v[76:77], v[172:173] neg_lo:[0,1] neg_hi:[0,1]
    v_pk_add_f32 v[174:175], v[78:79], v[174:175] neg_lo:[0,1] neg_hi:[0,1]
    v_pk_fma_f32 v[76:77], v[216:217], s[30:31], v[212:213] op_sel:[0,1,0]
    v_pk_fma_f32 v[78:79], v[218:219], s[30:31], v[214:215] op_sel:[0,1,0]
    v_pk_fma_f32 v[212:213], v[212:213], s[30:31], v[216:217] op_sel_hi:[1,0,1]
    v_pk_fma_f32 v[214:215], v[214:215], s[30:31], v[218:219] op_sel_hi:[1,0,1]
    v_cvt_pk_bf16_f32 v196, v212, v213
    v_cvt_pk_bf16_f32 v197, v214, v215
    ds_write_b128 v248, v[194:197] offset:2304
    v_accvgpr_read_b32 v204, a80
    v_accvgpr_read_b32 v205, a81
    v_accvgpr_read_b32 v206, a82
    v_accvgpr_read_b32 v207, a83
    v_accvgpr_read_b32 v208, a176
    v_accvgpr_read_b32 v209, a177
    v_accvgpr_read_b32 v210, a178
    v_accvgpr_read_b32 v211, a179
    v_pk_add_f32 v[204:205], v[204:205], v[208:209]
    v_pk_add_f32 v[206:207], v[206:207], v[210:211]
    v_pk_add_f32 v[208:209], v[80:81], v[176:177]
    v_pk_add_f32 v[210:211], v[82:83], v[178:179]
    v_pk_add_f32 v[176:177], v[80:81], v[176:177] neg_lo:[0,1] neg_hi:[0,1]
    v_pk_add_f32 v[178:179], v[82:83], v[178:179] neg_lo:[0,1] neg_hi:[0,1]
    v_pk_fma_f32 v[80:81], v[208:209], s[30:31], v[204:205] op_sel:[0,1,0]
    v_pk_fma_f32 v[82:83], v[210:211], s[30:31], v[206:207] op_sel:[0,1,0]
    v_pk_fma_f32 v[204:205], v[204:205], s[30:31], v[208:209] op_sel_hi:[1,0,1]
    v_pk_fma_f32 v[206:207], v[206:207], s[30:31], v[210:211] op_sel_hi:[1,0,1]
    v_cvt_pk_bf16_f32 v198, v204, v205
    v_cvt_pk_bf16_f32 v199, v206, v207
    ds_write_b64 v249, v[198:199] offset:2368
    s_waitcnt lgkmcnt(0)
    s_barrier
sub24:
    v_mfma_f32_16x16x32_bf16 v[0:3], a[192:195], v[228:231], v[0:3]
    buffer_load_dwordx4 a[240:243], v254, s[8:11], s42 offen offset:0 sc1
    v_mfma_f32_16x16x32_bf16 v[4:7], a[196:199], v[228:231], v[4:7]
    s_waitcnt vmcnt(8)
    v_accvgpr_read_b32 v204, a84
    v_accvgpr_read_b32 v205, a85
    v_mfma_f32_16x16x32_bf16 v[8:11], a[200:203], v[228:231], v[8:11]
    ds_read_b128 v[228:231], v253 offset:14816
    v_accvgpr_read_b32 v206, a86
    v_mfma_f32_16x16x32_bf16 v[0:3], a[204:207], v[232:235], v[0:3]
    ds_read_b128 v[212:215], v250 offset:0
    v_accvgpr_read_b32 v207, a87
    v_mfma_f32_16x16x32_bf16 v[4:7], a[208:211], v[232:235], v[4:7]
    buffer_load_dwordx4 a[244:247], v254, s[8:11], s42 offen offset:1024 sc1
    v_mfma_f32_16x16x32_bf16 v[8:11], a[212:215], v[232:235], v[8:11]
    ds_read_b128 v[216:219], v250 offset:3104
    v_add_f32 v208, v84, v180
    v_mfma_f32_16x16x32_bf16 v[12:15], a[192:195], v[232:235], v[12:15]
    v_add_f32 v209, v85, v181
    v_add_f32 v210, v86, v182
    v_mfma_f32_16x16x32_bf16 v[12:15], a[204:207], v[236:239], v[12:15]
    ds_read_b128 v[220:223], v250 offset:6208
    s_add_u32 s44, s40, 393216
    v_mfma_f32_16x16x32_bf16 v[16:19], a[208:211], v[236:239], v[16:19]
    buffer_load_dwordx4 a[248:251], v254, s[8:11], s42 offen offset:2048 sc1
    v_mfma_f32_16x16x32_bf16 v[16:19], a[196:199], v[232:235], v[16:19]
    s_mov_b32 s42, 964608
    v_add_f32 v211, v87, v183
    v_sub_f32 v180, v84, v180
    v_mfma_f32_16x16x32_bf16 v[20:23], a[200:203], v[232:235], v[20:23]
    ds_read_b128 v[232:235], v253 offset:14560
    v_sub_f32 v181, v85, v181
    v_mfma_f32_16x16x32_bf16 v[20:23], a[212:215], v[236:239], v[20:23]
    s_waitcnt vmcnt(7)
    s_waitcnt lgkmcnt(3)
    v_sub_f32 v182, v86, v182
    v_mfma_f32_16x16x32_bf16 v[0:3], a[216:219], v[236:239], v[0:3]
    buffer_load_dwordx4 a[252:255], v254, s[8:11], s42 offen offset:0 sc1
    v_mfma_f32_16x16x32_bf16 v[4:7], a[220:223], v[236:239], v[4:7]
pad9:
    s_cbranch_vccnz pad13
    ds_read_b128 v[224:227], v250 offset:9312
    v_sub_f32 v183, v87, v183
    v_mfma_f32_16x16x32_bf16 v[8:11], a[224:227], v[236:239], v[8:11]
    v_fma_f32 v84, v208, s31, v204
    v_fma_f32 v85, v209, s31, v205
    v_mfma_f32_16x16x32_bf16 v[24:27], a[192:195], v[236:239], v[24:27]
    v_fma_f32 v86, v210, s31, v206
    v_fma_f32 v87, v211, s31, v207
    v_mfma_f32_16x16x32_bf16 v[24:27], a[204:207], v[228:231], v[24:27]
    buffer_load_dwordx4 v[240:243], v254, s[8:11], s42 offen offset:1024 sc1
    v_mfma_f32_16x16x32_bf16 v[28:31], a[208:211], v[228:231], v[28:31]
    v_fmac_f32 v208, s30, v204
    v_fmac_f32 v209, s30, v205
    v_mfma_f32_16x16x32_bf16 v[28:31], a[196:199], v[236:239], v[28:31]
    v_fmac_f32 v210, s30, v206
    v_fmac_f32 v211, s30, v207
    v_mfma_f32_16x16x32_bf16 v[32:35], a[200:203], v[236:239], v[32:35]
    ds_read_b128 v[236:239], v253 offset:16384
    v_cvt_pk_bf16_f32 v192, v208, v209
    v_mfma_f32_16x16x32_bf16 v[32:35], a[212:215], v[228:231], v[32:35]
    buffer_load_dwordx4 v[244:247], v254, s[8:11], s42 offen offset:2048 sc1
    v_mfma_f32_16x16x32_bf16 v[12:15], a[216:219], v[228:231], v[12:15]
    v_cvt_pk_bf16_f32 v193, v210, v211
    v_accvgpr_read_b32 v204, a88
    v_mfma_f32_16x16x32_bf16 v[16:19], a[220:223], v[228:231], v[16:19]
    v_accvgpr_read_b32 v205, a89
    v_accvgpr_read_b32 v206, a90
    v_mfma_f32_16x16x32_bf16 v[20:23], a[224:227], v[228:231], v[20:23]
    buffer_store_dwordx4 v[212:215], v254, s[12:15], s44 offen nt
    s_add_u32 s44, s40, 396288
    s_waitcnt lgkmcnt(4)
    v_mfma_f32_16x16x32_bf16 v[36:39], a[192:195], v[228:231], v[36:39]
    s_waitcnt lgkmcnt(2)
    v_accvgpr_read_b32 v207, a91
    v_add_f32 v208, v88, v184
    v_mfma_f32_16x16x32_bf16 v[36:39], a[204:207], v[232:235], v[36:39]
    v_add_f32 v209, v89, v185
    v_add_f32 v210, v90, v186
    v_mfma_f32_16x16x32_bf16 v[40:43], a[208:211], v[232:235], v[40:43]
    v_add_f32 v211, v91, v187
    v_sub_f32 v184, v88, v184
    v_mfma_f32_16x16x32_bf16 v[40:43], a[196:199], v[228:231], v[40:43]
    buffer_store_dwordx4 v[216:219], v254, s[12:15], s44 offen nt
    v_sub_f32 v185, v89, v185
    v_sub_f32 v186, v90, v186
    v_mfma_f32_16x16x32_bf16 v[44:47], a[200:203], v[228:231], v[44:47]
    ds_read_b128 v[228:231], v253 offset:16128
    v_sub_f32 v187, v91, v187
    v_mfma_f32_16x16x32_bf16 v[44:47], a[212:215], v[232:235], v[44:47]
    ds_read_b128 v[212:215], v250 offset:1024
    v_fma_f32 v88, v208, s31, v204
    v_mfma_f32_16x16x32_bf16 v[24:27], a[216:219], v[232:235], v[24:27]
    ds_read_b128 v[216:219], v250 offset:4128
    v_fma_f32 v89, v209, s31, v205
    v_mfma_f32_16x16x32_bf16 v[28:31], a[220:223], v[232:235], v[28:31]
    s_add_u32 s44, s40, 399360
    v_fma_f32 v90, v210, s31, v206
    v_fma_f32 v91, v211, s31, v207
    v_mfma_f32_16x16x32_bf16 v[32:35], a[224:227], v[232:235], v[32:35]
    v_fmac_f32 v208, s30, v204
    v_fmac_f32 v209, s30, v205
    v_mfma_f32_16x16x32_bf16 v[48:51], a[192:195], v[232:235], v[48:51]
    s_waitcnt lgkmcnt(3)
    v_fmac_f32 v210, s30, v206
    v_fmac_f32 v211, s30, v207
    v_mfma_f32_16x16x32_bf16 v[48:51], a[204:207], v[236:239], v[48:51]
    v_cvt_pk_bf16_f32 v194, v208, v209
    v_cvt_pk_bf16_f32 v195, v210, v211
    v_mfma_f32_16x16x32_bf16 v[52:55], a[208:211], v[236:239], v[52:55]
    v_accvgpr_read_b32 v204, a92
    v_accvgpr_read_b32 v205, a93
    v_mfma_f32_16x16x32_bf16 v[52:55], a[196:199], v[232:235], v[52:55]
    v_accvgpr_read_b32 v206, a94
    v_accvgpr_read_b32 v207, a95
    v_mfma_f32_16x16x32_bf16 v[56:59], a[200:203], v[232:235], v[56:59]
    ds_read_b128 v[232:235], v253 offset:15872
    v_add_f32 v208, v92, v188
    v_mfma_f32_16x16x32_bf16 v[56:59], a[212:215], v[236:239], v[56:59]
    v_add_f32 v209, v93, v189
    v_add_f32 v210, v94, v190
    v_mfma_f32_16x16x32_bf16 v[36:39], a[216:219], v[236:239], v[36:39]
    buffer_store_dwordx4 v[220:223], v254, s[12:15], s44 offen nt
    v_add_f32 v211, v95, v191
    v_sub_f32 v188, v92, v188
    v_mfma_f32_16x16x32_bf16 v[40:43], a[220:223], v[236:239], v[40:43]
    v_sub_f32 v189, v93, v189
    v_sub_f32 v190, v94, v190
    v_mfma_f32_16x16x32_bf16 v[44:47], a[224:227], v[236:239], v[44:47]
    v_sub_f32 v191, v95, v191
    v_fma_f32 v92, v208, s31, v204
    v_mfma_f32_16x16x32_bf16 v[60:63], a[192:195], v[236:239], v[60:63]
    s_waitcnt lgkmcnt(3)
    v_fma_f32 v93, v209, s31, v205
    v_fma_f32 v94, v210, s31, v206
    v_mfma_f32_16x16x32_bf16 v[60:63], a[204:207], v[228:231], v[60:63]
    s_add_u32 s44, s40, 402432
    v_fma_f32 v95, v211, s31, v207
    v_fmac_f32 v208, s30, v204
    v_mfma_f32_16x16x32_bf16 v[64:67], a[208:211], v[228:231], v[64:67]
    v_fmac_f32 v209, s30, v205
    v_fmac_f32 v210, s30, v206
    v_mfma_f32_16x16x32_bf16 v[64:67], a[196:199], v[236:239], v[64:67]
    v_fmac_f32 v211, s30, v207
    v_cvt_pk_bf16_f32 v196, v208, v209
    v_mfma_f32_16x16x32_bf16 v[68:71], a[200:203], v[236:239], v[68:71]
    ds_read_b128 v[236:239], v253 offset:15616
    v_cvt_pk_bf16_f32 v197, v210, v211
    v_mfma_f32_16x16x32_bf16 v[68:71], a[212:215], v[228:231], v[68:71]
    v_accvgpr_read_b32 v204, a96
    v_accvgpr_read_b32 v205, a97
    v_mfma_f32_16x16x32_bf16 v[48:51], a[216:219], v[228:231], v[48:51]
    ds_write_b64 v249, v[196:197] offset:2752
    v_mfma_f32_16x16x32_bf16 v[52:55], a[220:223], v[228:231], v[52:55]
    v_accvgpr_read_b32 v206, a98
    v_accvgpr_read_b32 v207, a99
    v_mfma_f32_16x16x32_bf16 v[56:59], a[224:227], v[228:231], v[56:59]
    ds_write_b128 v248, v[192:195] offset:2688
    v_mfma_f32_16x16x32_bf16 v[72:75], a[192:195], v[228:231], v[72:75]
    s_waitcnt lgkmcnt(3)
    v_fma_f32 v208, v204, s34, v96 div:2
    v_fma_f32 v209, v205, s34, v97 div:2
    v_fma_f32 v210, v206, s34, v98 div:2
    v_mfma_f32_16x16x32_bf16 v[72:75], a[204:207], v[232:235], v[72:75]
    buffer_store_dwordx4 v[224:227], v254, s[12:15], s44 offen nt
    v_fma_f32 v211, v207, s34, v99 div:2
    v_fma_f32 v96, v204, s35, v96 mul:2
    v_mfma_f32_16x16x32_bf16 v[76:79], a[208:211], v[232:235], v[76:79]
    v_fma_f32 v97, v205, s35, v97 mul:2
    v_fma_f32 v98, v206, s35, v98 mul:2
    v_mfma_f32_16x16x32_bf16 v[76:79], a[196:199], v[228:231], v[76:79]
    v_fma_f32 v99, v207, s35, v99 mul:2
    v_cvt_pk_bf16_f32 v198, v208, v209
    v_mfma_f32_16x16x32_bf16 v[80:83], a[200:203], v[228:231], v[80:83]
    ds_read_b128 v[228:231], v253 offset:15344
    v_cvt_pk_bf16_f32 v199, v210, v211
    v_mfma_f32_16x16x32_bf16 v[80:83], a[212:215], v[232:235], v[80:83]
    s_mov_b32 s42, 995328
    v_accvgpr_write_b32 a0, v198
    v_accvgpr_write_b32 a1, v199
    v_mfma_f32_16x16x32_bf16 v[60:63], a[216:219], v[232:235], v[60:63]
    v_accvgpr_read_b32 v204, a100
    v_accvgpr_read_b32 v205, a101
    v_mfma_f32_16x16x32_bf16 v[64:67], a[220:223], v[232:235], v[64:67]
    v_accvgpr_read_b32 v206, a102
    v_accvgpr_read_b32 v207, a103
    v_mfma_f32_16x16x32_bf16 v[68:71], a[224:227], v[232:235], v[68:71]
    s_waitcnt lgkmcnt(3)
    v_fma_f32 v208, v204, s34, v100 div:2
    v_fma_f32 v209, v205, s34, v101 div:2
    v_mfma_f32_16x16x32_bf16 v[84:87], a[192:195], v[232:235], v[84:87]
    buffer_load_dwordx4 a[192:195], v254, s[8:11], s42 offen offset:0 sc1
    v_mfma_f32_16x16x32_bf16 v[88:91], a[196:199], v[232:235], v[88:91]
    s_waitcnt lgkmcnt(0)
    v_fma_f32 v210, v206, s34, v102 div:2
    v_fma_f32 v211, v207, s34, v103 div:2
    v_mfma_f32_16x16x32_bf16 v[92:95], a[200:203], v[232:235], v[92:95]
    s_barrier
    v_mfma_f32_16x16x32_bf16 v[84:87], a[204:207], v[236:239], v[84:87]
    ds_read_b128 v[232:235], v253 offset:17680
    v_fma_f32 v100, v204, s35, v100 mul:2
    v_mfma_f32_16x16x32_bf16 v[88:91], a[208:211], v[236:239], v[88:91]
    buffer_load_dwordx4 a[196:199], v254, s[8:11], s42 offen offset:1024 sc1
    v_mfma_f32_16x16x32_bf16 v[92:95], a[212:215], v[236:239], v[92:95]
    v_fma_f32 v101, v205, s35, v101 mul:2
    v_fma_f32 v102, v206, s35, v102 mul:2
    v_mfma_f32_16x16x32_bf16 v[72:75], a[216:219], v[236:239], v[72:75]
    v_fma_f32 v103, v207, s35, v103 mul:2
    v_cvt_pk_bf16_f32 v200, v208, v209
    v_mfma_f32_16x16x32_bf16 v[76:79], a[220:223], v[236:239], v[76:79]
    buffer_load_dwordx4 a[200:203], v254, s[8:11], s42 offen offset:2048 sc1
    v_mfma_f32_16x16x32_bf16 v[80:83], a[224:227], v[236:239], v[80:83]
    ds_read_b128 v[236:239], v253 offset:17408
    v_cvt_pk_bf16_f32 v201, v210, v211
    v_mfma_f32_16x16x32_bf16 v[84:87], a[216:219], v[228:231], v[84:87]
    s_mov_b32 s42, 998400
    v_accvgpr_write_b32 a2, v200
    v_accvgpr_write_b32 a3, v201
    v_mfma_f32_16x16x32_bf16 v[88:91], a[220:223], v[228:231], v[88:91]
    s_waitcnt vmcnt(13) lgkmcnt(1)
    v_accvgpr_read_b32 v204, a104
    v_accvgpr_read_b32 v205, a105
    v_mfma_f32_16x16x32_bf16 v[92:95], a[224:227], v[228:231], v[92:95]
    ds_read_b128 v[228:231], v253 offset:17152
    v_accvgpr_read_b32 v206, a106
    v_accvgpr_read_b32 v207, a107
sub25:
    v_mfma_f32_16x16x32_bf16 v[0:3], a[228:231], v[232:235], v[0:3]
    buffer_load_dwordx4 a[204:207], v254, s[8:11], s42 offen offset:0 sc1
    v_mfma_f32_16x16x32_bf16 v[4:7], a[232:235], v[232:235], v[4:7]
    s_waitcnt vmcnt(11) lgkmcnt(1)
    v_fma_f32 v208, v204, s34, v104 div:2
    v_fma_f32 v209, v205, s34, v105 div:2
    v_mfma_f32_16x16x32_bf16 v[8:11], a[236:239], v[232:235], v[8:11]
    ds_read_b128 v[232:235], v253 offset:16896
    v_fma_f32 v210, v206, s34, v106 div:2
    v_mfma_f32_16x16x32_bf16 v[0:3], a[240:243], v[236:239], v[0:3]
    v_fma_f32 v211, v207, s34, v107 div:2
    v_fma_f32 v104, v204, s35, v104 mul:2
    v_mfma_f32_16x16x32_bf16 v[4:7], a[244:247], v[236:239], v[4:7]
    buffer_load_dwordx4 a[208:211], v254, s[8:11], s42 offen offset:1024 sc1
    v_mfma_f32_16x16x32_bf16 v[8:11], a[248:251], v[236:239], v[8:11]
    v_fma_f32 v105, v205, s35, v105 mul:2
    v_fma_f32 v106, v206, s35, v106 mul:2
    v_mfma_f32_16x16x32_bf16 v[12:15], a[228:231], v[236:239], v[12:15]
    s_waitcnt lgkmcnt(1)
    s_add_u32 s44, s40, 394240
    v_fma_f32 v107, v207, s35, v107 mul:2
    v_mfma_f32_16x16x32_bf16 v[12:15], a[240:243], v[228:231], v[12:15]
    v_cvt_pk_bf16_f32 v202, v208, v209
    v_cvt_pk_bf16_f32 v203, v210, v211
    v_mfma_f32_16x16x32_bf16 v[16:19], a[244:247], v[228:231], v[16:19]
    buffer_load_dwordx4 a[212:215], v254, s[8:11], s42 offen offset:2048 sc1
    v_mfma_f32_16x16x32_bf16 v[16:19], a[232:235], v[236:239], v[16:19]
    s_mov_b32 s42, 1001472
    v_accvgpr_write_b32 a4, v202
    v_accvgpr_write_b32 a5, v203
    v_mfma_f32_16x16x32_bf16 v[20:23], a[236:239], v[236:239], v[20:23]
    ds_read_b128 v[236:239], v253 offset:16640
    v_accvgpr_read_b32 v204, a108
    v_mfma_f32_16x16x32_bf16 v[20:23], a[248:251], v[228:231], v[20:23]
    s_waitcnt vmcnt(10)
    v_accvgpr_read_b32 v205, a109
    v_mfma_f32_16x16x32_bf16 v[0:3], a[252:255], v[228:231], v[0:3]
    buffer_load_dwordx4 a[216:219], v254, s[8:11], s42 offen offset:0 sc1
    v_mfma_f32_16x16x32_bf16 v[4:7], v[240:243], v[228:231], v[4:7]
    v_accvgpr_read_b32 v206, a110
    v_accvgpr_read_b32 v207, a111
    v_mfma_f32_16x16x32_bf16 v[8:11], v[244:247], v[228:231], v[8:11]
    v_fma_f32 v208, v204, s34, v108 div:2
    v_fma_f32 v209, v205, s34, v109 div:2
    v_mfma_f32_16x16x32_bf16 v[24:27], a[228:231], v[228:231], v[24:27]
    s_waitcnt lgkmcnt(1)
    v_fma_f32 v210, v206, s34, v110 div:2
    v_fma_f32 v211, v207, s34, v111 div:2
    v_mfma_f32_16x16x32_bf16 v[24:27], a[240:243], v[232:235], v[24:27]
    buffer_load_dwordx4 a[220:223], v254, s[8:11], s42 offen offset:1024 sc1
    v_mfma_f32_16x16x32_bf16 v[28:31], a[244:247], v[232:235], v[28:31]
    v_fma_f32 v108, v204, s35, v108 mul:2
    v_fma_f32 v109, v205, s35, v109 mul:2
    v_mfma_f32_16x16x32_bf16 v[28:31], a[232:235], v[228:231], v[28:31]
    v_fma_f32 v110, v206, s35, v110 mul:2
    v_fma_f32 v111, v207, s35, v111 mul:2
    v_mfma_f32_16x16x32_bf16 v[32:35], a[236:239], v[228:231], v[32:35]
    ds_read_b128 v[228:231], v253 offset:18464
    v_cvt_pk_bf16_f32 v192, v208, v209
    v_cvt_pk_bf16_f32 v193, v210, v211
    v_mfma_f32_16x16x32_bf16 v[32:35], a[248:251], v[232:235], v[32:35]
    buffer_load_dwordx4 a[224:227], v254, s[8:11], s42 offen offset:2048 sc1
    v_mfma_f32_16x16x32_bf16 v[12:15], a[252:255], v[232:235], v[12:15]
    ds_read_b128 a[84:87], v250 offset:7232
    v_accvgpr_write_b32 a12, v192
    v_mfma_f32_16x16x32_bf16 v[16:19], v[240:243], v[232:235], v[16:19]
    v_accvgpr_write_b32 a13, v193
    v_accvgpr_read_b32 v204, a112
    v_mfma_f32_16x16x32_bf16 v[20:23], v[244:247], v[232:235], v[20:23]
    buffer_store_dwordx4 v[212:215], v254, s[12:15], s44 offen nt
    s_add_u32 s44, s40, 397312
    v_accvgpr_read_b32 v205, a113
    v_mfma_f32_16x16x32_bf16 v[36:39], a[228:231], v[232:235], v[36:39]
    s_waitcnt lgkmcnt(2)
    v_accvgpr_read_b32 v206, a114
    v_accvgpr_read_b32 v207, a115
    v_mfma_f32_16x16x32_bf16 v[36:39], a[240:243], v[236:239], v[36:39]
    v_fma_f32 v208, v204, s34, v112 div:2
    v_fma_f32 v209, v205, s34, v113 div:2
    v_mfma_f32_16x16x32_bf16 v[40:43], a[244:247], v[236:239], v[40:43]
    ds_read_b128 a[88:91], v250 offset:10336
    v_mfma_f32_16x16x32_bf16 v[40:43], a[232:235], v[232:235], v[40:43]
    v_fma_f32 v210, v206, s34, v114 div:2
    v_fma_f32 v211, v207, s34, v115 div:2
    v_mfma_f32_16x16x32_bf16 v[44:47], a[236:239], v[232:235], v[44:47]
    ds_read_b128 v[232:235], v253 offset:18208
    v_fma_f32 v112, v204, s35, v112 mul:2
    v_mfma_f32_16x16x32_bf16 v[44:47], a[248:251], v[236:239], v[44:47]
    v_fma_f32 v113, v205, s35, v113 mul:2
    v_fma_f32 v114, v206, s35, v114 mul:2
    v_mfma_f32_16x16x32_bf16 v[24:27], a[252:255], v[236:239], v[24:27]
    v_fma_f32 v115, v207, s35, v115 mul:2
    v_cvt_pk_bf16_f32 v194, v208, v209
    v_mfma_f32_16x16x32_bf16 v[28:31], v[240:243], v[236:239], v[28:31]
    buffer_store_dwordx4 v[216:219], v254, s[12:15], s44 offen nt
    v_cvt_pk_bf16_f32 v195, v210, v211
    v_accvgpr_write_b32 a14, v194
    v_mfma_f32_16x16x32_bf16 v[32:35], v[244:247], v[236:239], v[32:35]
    v_accvgpr_write_b32 a15, v195
    v_accvgpr_read_b32 v204, a116
    v_mfma_f32_16x16x32_bf16 v[48:51], a[228:231], v[236:239], v[48:51]
    s_waitcnt lgkmcnt(3)
    v_accvgpr_read_b32 v205, a117
    v_accvgpr_read_b32 v206, a118
    v_mfma_f32_16x16x32_bf16 v[48:51], a[240:243], v[228:231], v[48:51]
    ds_read_b128 a[92:95], v250 offset:2048
    v_accvgpr_read_b32 v207, a119
    v_mfma_f32_16x16x32_bf16 v[52:55], a[244:247], v[228:231], v[52:55]
    v_fma_f32 v208, v204, s34, v116 div:2
    v_fma_f32 v209, v205, s34, v117 div:2
    v_mfma_f32_16x16x32_bf16 v[52:55], a[232:235], v[236:239], v[52:55]
    v_fma_f32 v210, v206, s34, v118 div:2
    v_fma_f32 v211, v207, s34, v119 div:2
    v_mfma_f32_16x16x32_bf16 v[56:59], a[236:239], v[236:239], v[56:59]
    ds_read_b128 v[236:239], v253 offset:17952
    s_add_u32 s44, s40, 400384
    v_mfma_f32_16x16x32_bf16 v[56:59], a[248:251], v[228:231], v[56:59]
    v_fma_f32 v116, v204, s35, v116 mul:2
    v_fma_f32 v117, v205, s35, v117 mul:2
    v_mfma_f32_16x16x32_bf16 v[36:39], a[252:255], v[228:231], v[36:39]
    ds_read_b128 a[96:99], v250 offset:5152
    v_fma_f32 v118, v206, s35, v118 mul:2
    v_fma_f32 v119, v207, s35, v119 mul:2
    v_mfma_f32_16x16x32_bf16 v[40:43], v[240:243], v[228:231], v[40:43]
    v_cvt_pk_bf16_f32 v196, v208, v209
    v_cvt_pk_bf16_f32 v197, v210, v211
    v_mfma_f32_16x16x32_bf16 v[44:47], v[244:247], v[228:231], v[44:47]
    v_accvgpr_write_b32 a16, v196
    v_accvgpr_write_b32 a17, v197
    v_mfma_f32_16x16x32_bf16 v[60:63], a[228:231], v[228:231], v[60:63]
    s_waitcnt lgkmcnt(3)
    v_accvgpr_read_b32 v204, a120
    v_mfma_f32_16x16x32_bf16 v[60:63], a[240:243], v[232:235], v[60:63]
    v_accvgpr_read_b32 v205, a121
    v_accvgpr_read_b32 v206, a122
    v_mfma_f32_16x16x32_bf16 v[64:67], a[244:247], v[232:235], v[64:67]
    v_accvgpr_read_b32 v207, a123
    v_fma_f32 v208, v204, s34, v120 div:2
    v_mfma_f32_16x16x32_bf16 v[64:67], a[232:235], v[228:231], v[64:67]
    v_fma_f32 v209, v205, s34, v121 div:2
    v_fma_f32 v210, v206, s34, v122 div:2
    v_mfma_f32_16x16x32_bf16 v[68:71], a[236:239], v[228:231], v[68:71]
    ds_read_b128 v[228:231], v253 offset:17696
    v_fma_f32 v211, v207, s34, v123 div:2
    v_mfma_f32_16x16x32_bf16 v[68:71], a[248:251], v[232:235], v[68:71]
    ds_read_b128 a[100:103], v250 offset:8256
    v_fma_f32 v120, v204, s35, v120 mul:2
    v_mfma_f32_16x16x32_bf16 v[48:51], a[252:255], v[232:235], v[48:51]
    buffer_store_dwordx4 a[84:87], v254, s[12:15], s44 offen nt
    v_fma_f32 v121, v205, s35, v121 mul:2
    v_fma_f32 v122, v206, s35, v122 mul:2
    v_mfma_f32_16x16x32_bf16 v[52:55], v[240:243], v[232:235], v[52:55]
    v_fma_f32 v123, v207, s35, v123 mul:2
    v_cvt_pk_bf16_f32 v198, v208, v209
    v_mfma_f32_16x16x32_bf16 v[56:59], v[244:247], v[232:235], v[56:59]
    v_cvt_pk_bf16_f32 v199, v210, v211
    v_accvgpr_read_b32 v204, a28
    v_mfma_f32_16x16x32_bf16 v[72:75], a[228:231], v[232:235], v[72:75]
    s_waitcnt lgkmcnt(3)
    v_accvgpr_read_b32 v205, a29
    v_accvgpr_read_b32 v206, a30
    v_mfma_f32_16x16x32_bf16 v[72:75], a[240:243], v[236:239], v[72:75]
    ds_read_b128 a[104:107], v250 offset:11360
    s_add_u32 s44, s40, 403456
    v_mfma_f32_16x16x32_bf16 v[76:79], a[244:247], v[236:239], v[76:79]
    v_accvgpr_read_b32 v207, a31
    v_accvgpr_read_b32 v208, a124
    v_mfma_f32_16x16x32_bf16 v[76:79], a[232:235], v[232:235], v[76:79]
    v_accvgpr_read_b32 v209, a125
    v_accvgpr_read_b32 v210, a126
    v_mfma_f32_16x16x32_bf16 v[80:83], a[236:239], v[232:235], v[80:83]
    ds_read_b128 v[232:235], v253 offset:17424
    v_accvgpr_read_b32 v211, a127
    v_mfma_f32_16x16x32_bf16 v[80:83], a[248:251], v[236:239], v[80:83]
    s_mov_b32 s42, 1032192
    v_sub_f32 v204, v204, v208
    v_sub_f32 v205, v205, v209
    v_mfma_f32_16x16x32_bf16 v[60:63], a[252:255], v[236:239], v[60:63]
    v_sub_f32 v206, v206, v210
    v_sub_f32 v207, v207, v211
    v_mfma_f32_16x16x32_bf16 v[64:67], v[240:243], v[236:239], v[64:67]
    v_fma_f32 v208, v204, s34, v124 div:2
    v_fma_f32 v209, v205, s34, v125 div:2
    v_mfma_f32_16x16x32_bf16 v[68:71], v[244:247], v[236:239], v[68:71]
    s_waitcnt lgkmcnt(3)
    v_fma_f32 v210, v206, s34, v126 div:2
    v_fma_f32 v211, v207, s34, v127 div:2
    v_fma_f32 v124, v204, s35, v124 mul:2
    v_mfma_f32_16x16x32_bf16 v[84:87], a[228:231], v[236:239], v[84:87]
    buffer_load_dwordx4 a[228:231], v254, s[8:11], s42 offen offset:0 sc1
    v_mfma_f32_16x16x32_bf16 v[88:91], a[232:235], v[236:239], v[88:91]
    s_waitcnt lgkmcnt(0)
    v_fma_f32 v125, v205, s35, v125 mul:2
    v_fma_f32 v126, v206, s35, v126 mul:2
    v_mfma_f32_16x16x32_bf16 v[92:95], a[236:239], v[236:239], v[92:95]
    s_barrier
    v_mfma_f32_16x16x32_bf16 v[84:87], a[240:243], v[228:231], v[84:87]
    ds_read_b128 v[236:239], v253 offset:19760
    v_fma_f32 v127, v207, s35, v127 mul:2
    v_mfma_f32_16x16x32_bf16 v[88:91], a[244:247], v[228:231], v[88:91]
    buffer_load_dwordx4 a[232:235], v254, s[8:11], s42 offen offset:1024 sc1
    v_mfma_f32_16x16x32_bf16 v[92:95], a[248:251], v[228:231], v[92:95]
    ds_write_b128 v248, a[0:3] offset:0
    v_mfma_f32_16x16x32_bf16 v[72:75], a[252:255], v[228:231], v[72:75]
    v_cvt_pk_bf16_f32 v200, v208, v209
    v_cvt_pk_bf16_f32 v201, v210, v211
    v_mfma_f32_16x16x32_bf16 v[76:79], v[240:243], v[228:231], v[76:79]
    buffer_load_dwordx4 a[236:239], v254, s[8:11], s42 offen offset:2048 sc1
    v_mfma_f32_16x16x32_bf16 v[80:83], v[244:247], v[228:231], v[80:83]
    ds_read_b128 v[228:231], v253 offset:19488
    v_accvgpr_read_b32 v204, a32
    v_mfma_f32_16x16x32_bf16 v[84:87], a[252:255], v[232:235], v[84:87]
    s_mov_b32 s42, 1035264
    v_accvgpr_read_b32 v205, a33
    v_accvgpr_read_b32 v206, a34
    v_mfma_f32_16x16x32_bf16 v[88:91], v[240:243], v[232:235], v[88:91]
    s_waitcnt vmcnt(12) lgkmcnt(2)
    v_accvgpr_read_b32 v207, a35
    v_accvgpr_read_b32 v208, a128
    v_mfma_f32_16x16x32_bf16 v[92:95], v[244:247], v[232:235], v[92:95]
    ds_read_b128 v[232:235], v253 offset:19232
    v_accvgpr_read_b32 v209, a129
sub26:
    v_mfma_f32_16x16x32_bf16 v[0:3], a[192:195], v[236:239], v[0:3]
    buffer_load_dwordx4 a[240:243], v254, s[8:11], s42 offen offset:0 sc1
    v_mfma_f32_16x16x32_bf16 v[4:7], a[196:199], v[236:239], v[4:7]
    s_waitcnt vmcnt(10) lgkmcnt(1)
    v_accvgpr_read_b32 v210, a130
    v_accvgpr_read_b32 v211, a131
    v_mfma_f32_16x16x32_bf16 v[8:11], a[200:203], v[236:239], v[8:11]
    ds_read_b128 v[236:239], v253 offset:18976
    v_sub_f32 v204, v204, v208
    v_mfma_f32_16x16x32_bf16 v[0:3], a[204:207], v[228:231], v[0:3]
    ds_write_b64 v249, a[4:5] offset:64
    v_mfma_f32_16x16x32_bf16 v[4:7], a[208:211], v[228:231], v[4:7]
    buffer_load_dwordx4 a[244:247], v254, s[8:11], s42 offen offset:1024 sc1
    v_mfma_f32_16x16x32_bf16 v[8:11], a[212:215], v[228:231], v[8:11]
    ds_write_b128 v248, v[198:201] offset:768
    v_mfma_f32_16x16x32_bf16 v[12:15], a[192:195], v[228:231], v[12:15]
    s_waitcnt lgkmcnt(3)
    v_sub_f32 v205, v205, v209
    v_sub_f32 v206, v206, v210
    v_mfma_f32_16x16x32_bf16 v[12:15], a[204:207], v[232:235], v[12:15]
    v_sub_f32 v207, v207, v211
    v_fma_f32 v208, v204, s34, v128 div:2
    v_fma_f32 v209, v205, s34, v129 div:2
    v_mfma_f32_16x16x32_bf16 v[16:19], a[208:211], v[232:235], v[16:19]
    buffer_load_dwordx4 a[248:251], v254, s[8:11], s42 offen offset:2048 sc1
    v_mfma_f32_16x16x32_bf16 v[16:19], a[196:199], v[228:231], v[16:19]
    s_mov_b32 s42, 1038336
    v_fma_f32 v210, v206, s34, v130 div:2
    v_fma_f32 v211, v207, s34, v131 div:2
    v_mfma_f32_16x16x32_bf16 v[20:23], a[200:203], v[228:231], v[20:23]
    ds_read_b128 v[228:231], v253 offset:18720
    v_fma_f32 v128, v204, s35, v128 mul:2
    v_mfma_f32_16x16x32_bf16 v[20:23], a[212:215], v[232:235], v[20:23]
    s_waitcnt vmcnt(9)
    v_fma_f32 v129, v205, s35, v129 mul:2
    v_fma_f32 v130, v206, s35, v130 mul:2
    v_mfma_f32_16x16x32_bf16 v[0:3], a[216:219], v[232:235], v[0:3]
    buffer_load_dwordx4 a[252:255], v254, s[8:11], s42 offen offset:0 sc1
    v_mfma_f32_16x16x32_bf16 v[4:7], a[220:223], v[232:235], v[4:7]
    ds_write_b128 v248, a[12:15] offset:384
    v_mfma_f32_16x16x32_bf16 v[8:11], a[224:227], v[232:235], v[8:11]
    v_fma_f32 v131, v207, s35, v131 mul:2
    v_cvt_pk_bf16_f32 v202, v208, v209
    v_mfma_f32_16x16x32_bf16 v[24:27], a[192:195], v[232:235], v[24:27]
    s_waitcnt lgkmcnt(4)
    v_cvt_pk_bf16_f32 v203, v210, v211
    v_accvgpr_read_b32 v204, a36
    v_mfma_f32_16x16x32_bf16 v[24:27], a[204:207], v[236:239], v[24:27]
    buffer_load_dwordx4 v[240:243], v254, s[8:11], s42 offen offset:1024 sc1
    v_mfma_f32_16x16x32_bf16 v[28:31], a[208:211], v[236:239], v[28:31]
    ds_write_b64 v249, v[202:203] offset:832
    v_mfma_f32_16x16x32_bf16 v[28:31], a[196:199], v[232:235], v[28:31]
    v_accvgpr_read_b32 v205, a37
    v_accvgpr_read_b32 v206, a38
    v_mfma_f32_16x16x32_bf16 v[32:35], a[200:203], v[232:235], v[32:35]
    ds_read_b128 v[232:235], v253 offset:20544
    v_accvgpr_read_b32 v207, a39
    v_mfma_f32_16x16x32_bf16 v[32:35], a[212:215], v[236:239], v[32:35]
    buffer_load_dwordx4 v[244:247], v254, s[8:11], s42 offen offset:2048 sc1
    v_mfma_f32_16x16x32_bf16 v[12:15], a[216:219], v[236:239], v[12:15]
    ds_write_b64 v249, a[16:17] offset:448
    v_mfma_f32_16x16x32_bf16 v[16:19], a[220:223], v[236:239], v[16:19]
    v_accvgpr_read_b32 v208, a132
    v_accvgpr_read_b32 v209, a133
    v_mfma_f32_16x16x32_bf16 v[20:23], a[224:227], v[236:239], v[20:23]
    buffer_store_dwordx4 a[88:91], v254, s[12:15], s44 offen nt
    s_add_u32 s44, s40, 395264
    v_mfma_f32_16x16x32_bf16 v[36:39], a[192:195], v[236:239], v[36:39]
    s_waitcnt lgkmcnt(4)
    v_accvgpr_read_b32 v210, a134
    v_accvgpr_read_b32 v211, a135
    v_mfma_f32_16x16x32_bf16 v[36:39], a[204:207], v[228:231], v[36:39]
    v_sub_f32 v204, v204, v208
    v_sub_f32 v205, v205, v209
    v_mfma_f32_16x16x32_bf16 v[40:43], a[208:211], v[228:231], v[40:43]
    buffer_store_dwordx4 a[92:95], v254, s[12:15], s44 offen nt
    s_add_u32 s44, s40, 398336
    v_mfma_f32_16x16x32_bf16 v[40:43], a[196:199], v[236:239], v[40:43]
    v_sub_f32 v206, v206, v210
    v_sub_f32 v207, v207, v211
    v_fma_f32 v208, v204, s34, v132 div:2
    v_mfma_f32_16x16x32_bf16 v[44:47], a[200:203], v[236:239], v[44:47]
    ds_read_b128 v[236:239], v253 offset:20288
    v_fma_f32 v209, v205, s34, v133 div:2
    v_mfma_f32_16x16x32_bf16 v[44:47], a[212:215], v[228:231], v[44:47]
    buffer_store_dwordx4 a[96:99], v254, s[12:15], s44 offen nt
    s_add_u32 s44, s40, 401408
    v_fma_f32 v210, v206, s34, v134 div:2
    v_mfma_f32_16x16x32_bf16 v[24:27], a[216:219], v[228:231], v[24:27]
    v_fma_f32 v211, v207, s34, v135 div:2
    v_fma_f32 v132, v204, s35, v132 mul:2
    v_mfma_f32_16x16x32_bf16 v[28:31], a[220:223], v[228:231], v[28:31]
    v_fma_f32 v133, v205, s35, v133 mul:2
    v_fma_f32 v134, v206, s35, v134 mul:2
    v_mfma_f32_16x16x32_bf16 v[32:35], a[224:227], v[228:231], v[32:35]
    v_fma_f32 v135, v207, s35, v135 mul:2
    v_cvt_pk_bf16_f32 v192, v208, v209
    v_mfma_f32_16x16x32_bf16 v[48:51], a[192:195], v[228:231], v[48:51]
    s_waitcnt lgkmcnt(2)
    v_cvt_pk_bf16_f32 v193, v210, v211
    v_accvgpr_read_b32 v204, a40
    v_mfma_f32_16x16x32_bf16 v[48:51], a[204:207], v[232:235], v[48:51]
    v_accvgpr_read_b32 v205, a41
    v_accvgpr_read_b32 v206, a42
    v_mfma_f32_16x16x32_bf16 v[52:55], a[208:211], v[232:235], v[52:55]
    v_accvgpr_read_b32 v207, a43
    v_accvgpr_read_b32 v208, a136
    v_mfma_f32_16x16x32_bf16 v[52:55], a[196:199], v[228:231], v[52:55]
    v_accvgpr_read_b32 v209, a137
    v_accvgpr_read_b32 v210, a138
    v_mfma_f32_16x16x32_bf16 v[56:59], a[200:203], v[228:231], v[56:59]
    ds_read_b128 v[228:231], v253 offset:20032
    v_accvgpr_read_b32 v211, a139
    v_mfma_f32_16x16x32_bf16 v[56:59], a[212:215], v[232:235], v[56:59]
    buffer_store_dwordx4 a[100:103], v254, s[12:15], s44 offen nt
    v_sub_f32 v204, v204, v208
    v_sub_f32 v205, v205, v209
    v_mfma_f32_16x16x32_bf16 v[36:39], a[216:219], v[232:235], v[36:39]
    v_sub_f32 v206, v206, v210
    v_sub_f32 v207, v207, v211
    v_mfma_f32_16x16x32_bf16 v[40:43], a[220:223], v[232:235], v[40:43]
    v_fma_f32 v208, v204, s34, v136 div:2
    v_fma_f32 v209, v205, s34, v137 div:2
    v_mfma_f32_16x16x32_bf16 v[44:47], a[224:227], v[232:235], v[44:47]
    v_fma_f32 v210, v206, s34, v138 div:2
    v_fma_f32 v211, v207, s34, v139 div:2
    v_mfma_f32_16x16x32_bf16 v[60:63], a[192:195], v[232:235], v[60:63]
    s_waitcnt lgkmcnt(1)
    s_add_u32 s44, s40, 404480
    v_fma_f32 v136, v204, s35, v136 mul:2
    v_mfma_f32_16x16x32_bf16 v[60:63], a[204:207], v[236:239], v[60:63]
    v_fma_f32 v137, v205, s35, v137 mul:2
    v_fma_f32 v138, v206, s35, v138 mul:2
    v_mfma_f32_16x16x32_bf16 v[64:67], a[208:211], v[236:239], v[64:67]
    v_fma_f32 v139, v207, s35, v139 mul:2
    v_cvt_pk_bf16_f32 v194, v208, v209
    v_mfma_f32_16x16x32_bf16 v[64:67], a[196:199], v[232:235], v[64:67]
    v_cvt_pk_bf16_f32 v195, v210, v211
    v_accvgpr_read_b32 v204, a44
    v_mfma_f32_16x16x32_bf16 v[68:71], a[200:203], v[232:235], v[68:71]
pad10:
    s_cbranch_vccnz warm_ret
    ds_read_b128 v[232:235], v253 offset:19776
    v_accvgpr_read_b32 v205, a45
    v_mfma_f32_16x16x32_bf16 v[68:71], a[212:215], v[236:239], v[68:71]
    v_accvgpr_read_b32 v206, a46
    v_accvgpr_read_b32 v207, a47
    v_accvgpr_read_b32 v208, a140
    v_mfma_f32_16x16x32_bf16 v[48:51], a[216:219], v[236:239], v[48:51]
    ds_write_b128 v248, v[192:195] offset:1152
    v_mfma_f32_16x16x32_bf16 v[52:55], a[220:223], v[236:239], v[52:55]
    v_accvgpr_read_b32 v209, a141
    v_accvgpr_read_b32 v210, a142
    v_mfma_f32_16x16x32_bf16 v[56:59], a[224:227], v[236:239], v[56:59]
    v_accvgpr_read_b32 v211, a143
    v_sub_f32 v204, v204, v208
    v_mfma_f32_16x16x32_bf16 v[72:75], a[192:195], v[236:239], v[72:75]
    s_waitcnt lgkmcnt(2)
    v_sub_f32 v205, v205, v209
    v_sub_f32 v206, v206, v210
    v_mfma_f32_16x16x32_bf16 v[72:75], a[204:207], v[228:231], v[72:75]
    v_sub_f32 v207, v207, v211
    v_fma_f32 v208, v204, s34, v140 div:2
    v_mfma_f32_16x16x32_bf16 v[76:79], a[208:211], v[228:231], v[76:79]
    buffer_store_dwordx4 a[104:107], v254, s[12:15], s44 offen nt
    v_fma_f32 v209, v205, s34, v141 div:2
    v_fma_f32 v210, v206, s34, v142 div:2
    v_mfma_f32_16x16x32_bf16 v[76:79], a[196:199], v[236:239], v[76:79]
    v_fma_f32 v211, v207, s34, v143 div:2
    v_fma_f32 v140, v204, s35, v140 mul:2
    v_mfma_f32_16x16x32_bf16 v[80:83], a[200:203], v[236:239], v[80:83]
    ds_read_b128 v[236:239], v253 offset:19504
    v_fma_f32 v141, v205, s35, v141 mul:2
    v_mfma_f32_16x16x32_bf16 v[80:83], a[212:215], v[228:231], v[80:83]
    s_mov_b32 s42, 1069056
    v_fma_f32 v142, v206, s35, v142 mul:2
    v_fma_f32 v143, v207, s35, v143 mul:2
    v_mfma_f32_16x16x32_bf16 v[60:63], a[216:219], v[228:231], v[60:63]
    v_cvt_pk_bf16_f32 v196, v208, v209
    v_cvt_pk_bf16_f32 v197, v210, v211
    v_mfma_f32_16x16x32_bf16 v[64:67], a[220:223], v[228:231], v[64:67]
    ds_write_b64 v249, v[196:197] offset:1216
    v_mfma_f32_16x16x32_bf16 v[68:71], a[224:227], v[228:231], v[68:71]
    s_waitcnt lgkmcnt(3)
    v_accvgpr_read_b32 v204, a48
    v_accvgpr_read_b32 v205, a49
    v_mfma_f32_16x16x32_bf16 v[84:87], a[192:195], v[228:231], v[84:87]
    buffer_load_dwordx4 a[192:195], v254, s[8:11], s42 offen offset:0 sc1
    v_mfma_f32_16x16x32_bf16 v[88:91], a[196:199], v[228:231], v[88:91]
    s_waitcnt lgkmcnt(0)
    v_accvgpr_read_b32 v206, a50
    v_accvgpr_read_b32 v207, a51
    v_mfma_f32_16x16x32_bf16 v[92:95], a[200:203], v[228:231], v[92:95]
    s_barrier
    v_mfma_f32_16x16x32_bf16 v[84:87], a[204:207], v[232:235], v[84:87]
    ds_read_b128 v[228:231], v253 offset:21840
    v_accvgpr_read_b32 v208, a144
    v_mfma_f32_16x16x32_bf16 v[88:91], a[208:211], v[232:235], v[88:91]
    buffer_load_dwordx4 a[196:199], v254, s[8:11], s42 offen offset:1024 sc1
    v_mfma_f32_16x16x32_bf16 v[92:95], a[212:215], v[232:235], v[92:95]
    ds_read_b128 a[108:111], v250 offset:0
    v_accvgpr_read_b32 v209, a145
    v_mfma_f32_16x16x32_bf16 v[72:75], a[216:219], v[232:235], v[72:75]
    v_accvgpr_read_b32 v210, a146
    v_accvgpr_read_b32 v211, a147
    v_mfma_f32_16x16x32_bf16 v[76:79], a[220:223], v[232:235], v[76:79]
    buffer_load_dwordx4 a[200:203], v254, s[8:11], s42 offen offset:2048 sc1
    v_sub_f32 v204, v204, v208
    v_mfma_f32_16x16x32_bf16 v[80:83], a[224:227], v[232:235], v[80:83]
    ds_read_b128 v[232:235], v253 offset:21568
    v_sub_f32 v205, v205, v209
    v_mfma_f32_16x16x32_bf16 v[84:87], a[216:219], v[236:239], v[84:87]
    s_mov_b32 s42, 1072128
    v_sub_f32 v206, v206, v210
    v_sub_f32 v207, v207, v211
    v_mfma_f32_16x16x32_bf16 v[88:91], a[220:223], v[236:239], v[88:91]
    s_waitcnt vmcnt(14) lgkmcnt(2)
    v_fma_f32 v208, v204, s34, v144 div:2
    v_fma_f32 v209, v205, s34, v145 div:2
    v_mfma_f32_16x16x32_bf16 v[92:95], a[224:227], v[236:239], v[92:95]
    ds_read_b128 v[236:239], v253 offset:21312
    v_fma_f32 v210, v206, s34, v146 div:2
sub27:
    v_mfma_f32_16x16x32_bf16 v[0:3], a[228:231], v[228:231], v[0:3]
    buffer_load_dwordx4 a[204:207], v254, s[8:11], s42 offen offset:0 sc1
    v_mfma_f32_16x16x32_bf16 v[4:7], a[232:235], v[228:231], v[4:7]
    s_waitcnt vmcnt(12) lgkmcnt(1)
    s_add_u32 s44, s40, 196608
    v_fma_f32 v211, v207, s34, v147 div:2
    v_mfma_f32_16x16x32_bf16 v[8:11], a[236:239], v[228:231], v[8:11]
    ds_read_b128 v[228:231], v253 offset:21056
    v_fma_f32 v144, v204, s35, v144 mul:2
    v_mfma_f32_16x16x32_bf16 v[0:3], a[240:243], v[232:235], v[0:3]
    ds_read_b128 a[112:115], v250 offset:3104
    v_fma_f32 v145, v205, s35, v145 mul:2
    v_mfma_f32_16x16x32_bf16 v[4:7], a[244:247], v[232:235], v[4:7]
    buffer_load_dwordx4 a[208:211], v254, s[8:11], s42 offen offset:1024 sc1
    v_mfma_f32_16x16x32_bf16 v[8:11], a[248:251], v[232:235], v[8:11]
    v_fma_f32 v146, v206, s35, v146 mul:2
    v_fma_f32 v147, v207, s35, v147 mul:2
    v_mfma_f32_16x16x32_bf16 v[12:15], a[228:231], v[232:235], v[12:15]
    s_waitcnt lgkmcnt(2)
    v_cvt_pk_bf16_f32 v198, v208, v209
    v_cvt_pk_bf16_f32 v199, v210, v211
    v_mfma_f32_16x16x32_bf16 v[12:15], a[240:243], v[236:239], v[12:15]
    v_accvgpr_read_b32 v204, a52
    v_accvgpr_read_b32 v205, a53
    v_mfma_f32_16x16x32_bf16 v[16:19], a[244:247], v[236:239], v[16:19]
    buffer_load_dwordx4 a[212:215], v254, s[8:11], s42 offen offset:2048 sc1
    v_mfma_f32_16x16x32_bf16 v[16:19], a[232:235], v[232:235], v[16:19]
    s_mov_b32 s42, 1075200
    v_accvgpr_read_b32 v206, a54
    v_mfma_f32_16x16x32_bf16 v[20:23], a[236:239], v[232:235], v[20:23]
    ds_read_b128 v[232:235], v253 offset:20800
    v_accvgpr_read_b32 v207, a55
    v_mfma_f32_16x16x32_bf16 v[20:23], a[248:251], v[236:239], v[20:23]
    s_waitcnt vmcnt(11)
    v_accvgpr_read_b32 v208, a148
    v_accvgpr_read_b32 v209, a149
    v_mfma_f32_16x16x32_bf16 v[0:3], a[252:255], v[236:239], v[0:3]
    buffer_load_dwordx4 a[216:219], v254, s[8:11], s42 offen offset:0 sc1
    v_mfma_f32_16x16x32_bf16 v[4:7], v[240:243], v[236:239], v[4:7]
    ds_read_b128 a[116:119], v250 offset:6208
    v_accvgpr_read_b32 v210, a150
    v_mfma_f32_16x16x32_bf16 v[8:11], v[244:247], v[236:239], v[8:11]
    v_accvgpr_read_b32 v211, a151
    v_sub_f32 v204, v204, v208
    v_mfma_f32_16x16x32_bf16 v[24:27], a[228:231], v[236:239], v[24:27]
    s_waitcnt lgkmcnt(3)
    v_sub_f32 v205, v205, v209
    v_sub_f32 v206, v206, v210
    v_sub_f32 v207, v207, v211
    v_mfma_f32_16x16x32_bf16 v[24:27], a[240:243], v[228:231], v[24:27]
    buffer_load_dwordx4 a[220:223], v254, s[8:11], s42 offen offset:1024 sc1
    v_mfma_f32_16x16x32_bf16 v[28:31], a[244:247], v[228:231], v[28:31]
    v_fma_f32 v208, v204, s34, v148 div:2
    v_fma_f32 v209, v205, s34, v149 div:2
    v_mfma_f32_16x16x32_bf16 v[28:31], a[232:235], v[236:239], v[28:31]
    v_fma_f32 v210, v206, s34, v150 div:2
    v_fma_f32 v211, v207, s34, v151 div:2
    v_mfma_f32_16x16x32_bf16 v[32:35], a[236:239], v[236:239], v[32:35]
    ds_read_b128 v[236:239], v253 offset:22624
    v_fma_f32 v148, v204, s35, v148 mul:2
    v_mfma_f32_16x16x32_bf16 v[32:35], a[248:251], v[228:231], v[32:35]
    buffer_load_dwordx4 a[224:227], v254, s[8:11], s42 offen offset:2048 sc1
    v_mfma_f32_16x16x32_bf16 v[12:15], a[252:255], v[228:231], v[12:15]
    ds_read_b128 a[120:123], v250 offset:9312
    v_fma_f32 v149, v205, s35, v149 mul:2
    v_mfma_f32_16x16x32_bf16 v[16:19], v[240:243], v[228:231], v[16:19]
    v_fma_f32 v150, v206, s35, v150 mul:2
    v_fma_f32 v151, v207, s35, v151 mul:2
    v_mfma_f32_16x16x32_bf16 v[20:23], v[244:247], v[228:231], v[20:23]
    buffer_store_dwordx4 a[108:111], v254, s[12:15], s44 offen nt
    s_add_u32 s44, s40, 199680
    v_cvt_pk_bf16_f32 v200, v208, v209
    v_mfma_f32_16x16x32_bf16 v[36:39], a[228:231], v[228:231], v[36:39]
    s_waitcnt lgkmcnt(3)
    v_cvt_pk_bf16_f32 v201, v210, v211
    v_accvgpr_read_b32 v204, a56
    v_mfma_f32_16x16x32_bf16 v[36:39], a[240:243], v[232:235], v[36:39]
    ds_write_b128 v248, v[198:201] offset:1536
    v_mfma_f32_16x16x32_bf16 v[40:43], a[244:247], v[232:235], v[40:43]
    v_accvgpr_read_b32 v205, a57
    v_accvgpr_read_b32 v206, a58
    v_mfma_f32_16x16x32_bf16 v[40:43], a[232:235], v[228:231], v[40:43]
    v_accvgpr_read_b32 v207, a59
    v_accvgpr_read_b32 v208, a152
    v_mfma_f32_16x16x32_bf16 v[44:47], a[236:239], v[228:231], v[44:47]
    ds_read_b128 v[228:231], v253 offset:22368
    v_accvgpr_read_b32 v209, a153
    v_mfma_f32_16x16x32_bf16 v[44:47], a[248:251], v[232:235], v[44:47]
    v_accvgpr_read_b32 v210, a154
    v_accvgpr_read_b32 v211, a155
    v_mfma_f32_16x16x32_bf16 v[24:27], a[252:255], v[232:235], v[24:27]
    v_sub_f32 v204, v204, v208
    v_sub_f32 v205, v205, v209
    v_mfma_f32_16x16x32_bf16 v[28:31], v[240:243], v[232:235], v[28:31]
    v_sub_f32 v206, v206, v210
    v_sub_f32 v207, v207, v211
    v_mfma_f32_16x16x32_bf16 v[32:35], v[244:247], v[232:235], v[32:35]
    v_fma_f32 v208, v204, s34, v152 div:2
    v_fma_f32 v209, v205, s34, v153 div:2
    v_mfma_f32_16x16x32_bf16 v[48:51], a[228:231], v[232:235], v[48:51]
    s_waitcnt lgkmcnt(3)
    v_fma_f32 v210, v206, s34, v154 div:2
    v_fma_f32 v211, v207, s34, v155 div:2
    v_mfma_f32_16x16x32_bf16 v[48:51], a[240:243], v[236:239], v[48:51]
    v_fma_f32 v152, v204, s35, v152 mul:2
    v_fma_f32 v153, v205, s35, v153 mul:2
    v_mfma_f32_16x16x32_bf16 v[52:55], a[244:247], v[236:239], v[52:55]
    v_fma_f32 v154, v206, s35, v154 mul:2
    v_fma_f32 v155, v207, s35, v155 mul:2
    v_cvt_pk_bf16_f32 v202, v208, v209
    v_mfma_f32_16x16x32_bf16 v[52:55], a[232:235], v[232:235], v[52:55]
    v_cvt_pk_bf16_f32 v203, v210, v211
    v_accvgpr_read_b32 v204, a60
    v_mfma_f32_16x16x32_bf16 v[56:59], a[236:239], v[232:235], v[56:59]
    ds_read_b128 v[232:235], v253 offset:22112
    v_accvgpr_read_b32 v205, a61
    v_mfma_f32_16x16x32_bf16 v[56:59], a[248:251], v[236:239], v[56:59]
    buffer_store_dwordx4 a[112:115], v254, s[12:15], s44 offen nt
    v_accvgpr_read_b32 v206, a62
    v_accvgpr_read_b32 v207, a63
    v_mfma_f32_16x16x32_bf16 v[36:39], a[252:255], v[236:239], v[36:39]
    ds_write_b64 v249, v[202:203] offset:1600
    v_mfma_f32_16x16x32_bf16 v[40:43], v[240:243], v[236:239], v[40:43]
    v_accvgpr_read_b32 v208, a156
    v_accvgpr_read_b32 v209, a157
    v_mfma_f32_16x16x32_bf16 v[44:47], v[244:247], v[236:239], v[44:47]
    v_accvgpr_read_b32 v210, a158
    v_accvgpr_read_b32 v211, a159
    v_mfma_f32_16x16x32_bf16 v[60:63], a[228:231], v[236:239], v[60:63]
    s_waitcnt lgkmcnt(2)
    v_sub_f32 v204, v204, v208
    v_sub_f32 v205, v205, v209
    v_mfma_f32_16x16x32_bf16 v[60:63], a[240:243], v[228:231], v[60:63]
    v_sub_f32 v206, v206, v210
    v_sub_f32 v207, v207, v211
    v_mfma_f32_16x16x32_bf16 v[64:67], a[244:247], v[228:231], v[64:67]
    v_fma_f32 v208, v204, s34, v156 div:2
    v_fma_f32 v209, v205, s34, v157 div:2
    v_mfma_f32_16x16x32_bf16 v[64:67], a[232:235], v[236:239], v[64:67]
    s_add_u32 s44, s40, 202752
    v_fma_f32 v210, v206, s34, v158 div:2
    v_fma_f32 v211, v207, s34, v159 div:2
    v_mfma_f32_16x16x32_bf16 v[68:71], a[236:239], v[236:239], v[68:71]
    ds_read_b128 v[236:239], v253 offset:21856
    v_fma_f32 v156, v204, s35, v156 mul:2
    v_mfma_f32_16x16x32_bf16 v[68:71], a[248:251], v[228:231], v[68:71]
    v_fma_f32 v157, v205, s35, v157 mul:2
    v_fma_f32 v158, v206, s35, v158 mul:2
    v_mfma_f32_16x16x32_bf16 v[48:51], a[252:255], v[228:231], v[48:51]
    v_fma_f32 v159, v207, s35, v159 mul:2
    v_cvt_pk_bf16_f32 v192, v208, v209
    v_mfma_f32_16x16x32_bf16 v[52:55], v[240:243], v[228:231], v[52:55]
    v_cvt_pk_bf16_f32 v193, v210, v211
    v_accvgpr_read_b32 v204, a64
    v_mfma_f32_16x16x32_bf16 v[56:59], v[244:247], v[228:231], v[56:59]
    v_accvgpr_read_b32 v205, a65
    v_accvgpr_read_b32 v206, a66
    v_mfma_f32_16x16x32_bf16 v[72:75], a[228:231], v[228:231], v[72:75]
    s_waitcnt lgkmcnt(2)
    v_accvgpr_read_b32 v207, a67
    v_accvgpr_read_b32 v208, a160
    v_mfma_f32_16x16x32_bf16 v[72:75], a[240:243], v[232:235], v[72:75]
    v_accvgpr_read_b32 v209, a161
    v_accvgpr_read_b32 v210, a162
    v_mfma_f32_16x16x32_bf16 v[76:79], a[244:247], v[232:235], v[76:79]
    v_accvgpr_read_b32 v211, a163
    v_sub_f32 v204, v204, v208
    v_mfma_f32_16x16x32_bf16 v[76:79], a[232:235], v[228:231], v[76:79]
    v_sub_f32 v205, v205, v209
    v_sub_f32 v206, v206, v210
    v_mfma_f32_16x16x32_bf16 v[80:83], a[236:239], v[228:231], v[80:83]
    ds_read_b128 v[228:231], v253 offset:21584
    v_sub_f32 v207, v207, v211
    v_fma_f32 v208, v204, s34, v160 div:2
    v_mfma_f32_16x16x32_bf16 v[80:83], a[248:251], v[232:235], v[80:83]
    s_mov_b32 s42, 884736
    v_fma_f32 v209, v205, s34, v161 div:2
    v_fma_f32 v210, v206, s34, v162 div:2
    v_mfma_f32_16x16x32_bf16 v[60:63], a[252:255], v[232:235], v[60:63]
    v_fma_f32 v211, v207, s34, v163 div:2
    v_fma_f32 v160, v204, s35, v160 mul:2
    v_mfma_f32_16x16x32_bf16 v[64:67], v[240:243], v[232:235], v[64:67]
    v_fma_f32 v161, v205, s35, v161 mul:2
    v_fma_f32 v162, v206, s35, v162 mul:2
    v_mfma_f32_16x16x32_bf16 v[68:71], v[244:247], v[232:235], v[68:71]
    v_fma_f32 v163, v207, s35, v163 mul:2
    v_cvt_pk_bf16_f32 v194, v208, v209
    v_mfma_f32_16x16x32_bf16 v[84:87], a[228:231], v[232:235], v[84:87]
    buffer_load_dwordx4 a[228:231], v254, s[8:11], s42 offen offset:0 sc1
    v_mfma_f32_16x16x32_bf16 v[88:91], a[232:235], v[232:235], v[88:91]
    v_cvt_pk_bf16_f32 v195, v210, v211
    v_accvgpr_read_b32 v204, a68
    v_mfma_f32_16x16x32_bf16 v[92:95], a[236:239], v[232:235], v[92:95]
    s_waitcnt lgkmcnt(1)
    v_accvgpr_read_b32 v205, a69
    v_accvgpr_read_b32 v206, a70
    v_mfma_f32_16x16x32_bf16 v[84:87], a[240:243], v[236:239], v[84:87]
    ds_read_b128 v[232:235], v253 offset:23920
    v_accvgpr_read_b32 v207, a71
    v_mfma_f32_16x16x32_bf16 v[88:91], a[244:247], v[236:239], v[88:91]
    buffer_load_dwordx4 a[232:235], v254, s[8:11], s42 offen offset:1024 sc1
    v_mfma_f32_16x16x32_bf16 v[92:95], a[248:251], v[236:239], v[92:95]
    ds_write_b128 v248, v[192:195] offset:1920
    v_mfma_f32_16x16x32_bf16 v[72:75], a[252:255], v[236:239], v[72:75]
    s_waitcnt lgkmcnt(2)
    v_accvgpr_read_b32 v208, a164
    v_accvgpr_read_b32 v209, a165
    v_mfma_f32_16x16x32_bf16 v[76:79], v[240:243], v[236:239], v[76:79]
    buffer_load_dwordx4 a[236:239], v254, s[8:11], s42 offen offset:2048 sc1
    v_mfma_f32_16x16x32_bf16 v[80:83], v[244:247], v[236:239], v[80:83]
    ds_read_b128 v[236:239], v253 offset:23648
    v_accvgpr_read_b32 v210, a166
    v_mfma_f32_16x16x32_bf16 v[84:87], a[252:255], v[228:231], v[84:87]
    s_mov_b32 s42, 887808
    v_accvgpr_read_b32 v211, a167
    v_sub_f32 v204, v204, v208
    v_mfma_f32_16x16x32_bf16 v[88:91], v[240:243], v[228:231], v[88:91]
    s_waitcnt vmcnt(11) lgkmcnt(2)
    v_sub_f32 v205, v205, v209
    v_sub_f32 v206, v206, v210
    v_mfma_f32_16x16x32_bf16 v[92:95], v[244:247], v[228:231], v[92:95]
    ds_read_b128 v[228:231], v253 offset:23392
    v_sub_f32 v207, v207, v211
sub28:
    v_mfma_f32_16x16x32_bf16 v[0:3], a[192:195], v[232:235], v[0:3]
    buffer_load_dwordx4 a[240:243], v254, s[8:11], s42 offen offset:0 sc1
    v_mfma_f32_16x16x32_bf16 v[4:7], a[196:199], v[232:235], v[4:7]
    s_waitcnt vmcnt(9) lgkmcnt(1)
    v_fma_f32 v208, v204, s34, v164 div:2
    v_fma_f32 v209, v205, s34, v165 div:2
    v_mfma_f32_16x16x32_bf16 v[8:11], a[200:203], v[232:235], v[8:11]
    ds_read_b128 v[232:235], v253 offset:23136
    v_fma_f32 v210, v206, s34, v166 div:2
    v_mfma_f32_16x16x32_bf16 v[0:3], a[204:207], v[236:239], v[0:3]
    v_fma_f32 v211, v207, s34, v167 div:2
    v_fma_f32 v164, v204, s35, v164 mul:2
    v_fma_f32 v165, v205, s35, v165 mul:2
    v_mfma_f32_16x16x32_bf16 v[4:7], a[208:211], v[236:239], v[4:7]
    buffer_load_dwordx4 a[244:247], v254, s[8:11], s42 offen offset:1024 sc1
    v_mfma_f32_16x16x32_bf16 v[8:11], a[212:215], v[236:239], v[8:11]
    v_fma_f32 v166, v206, s35, v166 mul:2
    v_fma_f32 v167, v207, s35, v167 mul:2
    v_mfma_f32_16x16x32_bf16 v[12:15], a[192:195], v[236:239], v[12:15]
    s_waitcnt lgkmcnt(1)
    v_cvt_pk_bf16_f32 v196, v208, v209
    v_cvt_pk_bf16_f32 v197, v210, v211
    v_mfma_f32_16x16x32_bf16 v[12:15], a[204:207], v[228:231], v[12:15]
    ds_write_b64 v249, v[196:197] offset:1984
    v_mfma_f32_16x16x32_bf16 v[16:19], a[208:211], v[228:231], v[16:19]
    buffer_load_dwordx4 a[248:251], v254, s[8:11], s42 offen offset:2048 sc1
    v_mfma_f32_16x16x32_bf16 v[16:19], a[196:199], v[236:239], v[16:19]
    s_mov_b32 s42, 890880
    v_accvgpr_read_b32 v204, a72
    v_accvgpr_read_b32 v205, a73
    v_mfma_f32_16x16x32_bf16 v[20:23], a[200:203], v[236:239], v[20:23]
    ds_read_b128 v[236:239], v253 offset:22880
    v_accvgpr_read_b32 v206, a74
    v_mfma_f32_16x16x32_bf16 v[20:23], a[212:215], v[228:231], v[20:23]
    s_waitcnt vmcnt(8)
    v_accvgpr_read_b32 v207, a75
    v_accvgpr_read_b32 v208, a168
    v_mfma_f32_16x16x32_bf16 v[0:3], a[216:219], v[228:231], v[0:3]
    buffer_load_dwordx4 a[252:255], v254, s[8:11], s42 offen offset:0 sc1
    v_mfma_f32_16x16x32_bf16 v[4:7], a[220:223], v[228:231], v[4:7]
    v_accvgpr_read_b32 v209, a169
    v_accvgpr_read_b32 v210, a170
    v_mfma_f32_16x16x32_bf16 v[8:11], a[224:227], v[228:231], v[8:11]
    v_accvgpr_read_b32 v211, a171
    v_sub_f32 v204, v204, v208
    v_mfma_f32_16x16x32_bf16 v[24:27], a[192:195], v[228:231], v[24:27]
    s_waitcnt lgkmcnt(2)
    v_sub_f32 v205, v205, v209
    v_sub_f32 v206, v206, v210
    v_mfma_f32_16x16x32_bf16 v[24:27], a[204:207], v[232:235], v[24:27]
    buffer_load_dwordx4 v[240:243], v254, s[8:11], s42 offen offset:1024 sc1
    v_mfma_f32_16x16x32_bf16 v[28:31], a[208:211], v[232:235], v[28:31]
    v_sub_f32 v207, v207, v211
    v_fma_f32 v208, v204, s34, v168 div:2
    v_mfma_f32_16x16x32_bf16 v[28:31], a[196:199], v[228:231], v[28:31]
    v_fma_f32 v209, v205, s34, v169 div:2
    v_fma_f32 v210, v206, s34, v170 div:2
    v_mfma_f32_16x16x32_bf16 v[32:35], a[200:203], v[228:231], v[32:35]
    ds_read_b128 v[228:231], v253 offset:24704
    v_fma_f32 v211, v207, s34, v171 div:2
    v_mfma_f32_16x16x32_bf16 v[32:35], a[212:215], v[232:235], v[32:35]
    buffer_load_dwordx4 v[244:247], v254, s[8:11], s42 offen offset:2048 sc1
    v_mfma_f32_16x16x32_bf16 v[12:15], a[216:219], v[232:235], v[12:15]
    v_fma_f32 v168, v204, s35, v168 mul:2
    v_fma_f32 v169, v205, s35, v169 mul:2
    v_mfma_f32_16x16x32_bf16 v[16:19], a[220:223], v[232:235], v[16:19]
    v_fma_f32 v170, v206, s35, v170 mul:2
    v_fma_f32 v171, v207, s35, v171 mul:2
    v_mfma_f32_16x16x32_bf16 v[20:23], a[224:227], v[232:235], v[20:23]
    buffer_store_dwordx4 a[116:119], v254, s[12:15], s44 offen nt
    s_add_u32 s44, s40, 205824
    v_cvt_pk_bf16_f32 v198, v208, v209
    v_mfma_f32_16x16x32_bf16 v[36:39], a[192:195], v[232:235], v[36:39]
    s_waitcnt lgkmcnt(1)
    v_cvt_pk_bf16_f32 v199, v210, v211
    v_accvgpr_read_b32 v204, a76
    v_mfma_f32_16x16x32_bf16 v[36:39], a[204:207], v[236:239], v[36:39]
    v_accvgpr_read_b32 v205, a77
    v_accvgpr_read_b32 v206, a78
    v_mfma_f32_16x16x32_bf16 v[40:43], a[208:211], v[236:239], v[40:43]
    buffer_store_dwordx4 a[120:123], v254, s[12:15], s44 offen nt
    s_add_u32 s44, s40, 197632
    v_accvgpr_read_b32 v207, a79
    v_mfma_f32_16x16x32_bf16 v[40:43], a[196:199], v[232:235], v[40:43]
    v_accvgpr_read_b32 v208, a172
    v_accvgpr_read_b32 v209, a173
    v_mfma_f32_16x16x32_bf16 v[44:47], a[200:203], v[232:235], v[44:47]
    ds_read_b128 v[232:235], v253 offset:24448
    v_accvgpr_read_b32 v210, a174
    v_mfma_f32_16x16x32_bf16 v[44:47], a[212:215], v[236:239], v[44:47]
    v_accvgpr_read_b32 v211, a175
    v_sub_f32 v204, v204, v208
    v_mfma_f32_16x16x32_bf16 v[24:27], a[216:219], v[236:239], v[24:27]
    v_sub_f32 v205, v205, v209
    v_sub_f32 v206, v206, v210
    v_mfma_f32_16x16x32_bf16 v[28:31], a[220:223], v[236:239], v[28:31]
    v_sub_f32 v207, v207, v211
    v_fma_f32 v208, v204, s34, v172 div:2
    v_mfma_f32_16x16x32_bf16 v[32:35], a[224:227], v[236:239], v[32:35]
    v_fma_f32 v209, v205, s34, v173 div:2
    v_fma_f32 v210, v206, s34, v174 div:2
    v_mfma_f32_16x16x32_bf16 v[48:51], a[192:195], v[236:239], v[48:51]
    s_waitcnt lgkmcnt(1)
    v_fma_f32 v211, v207, s34, v175 div:2
    v_fma_f32 v172, v204, s35, v172 mul:2
    v_mfma_f32_16x16x32_bf16 v[48:51], a[204:207], v[228:231], v[48:51]
    v_fma_f32 v173, v205, s35, v173 mul:2
    v_fma_f32 v174, v206, s35, v174 mul:2
    v_mfma_f32_16x16x32_bf16 v[52:55], a[208:211], v[228:231], v[52:55]
    v_fma_f32 v175, v207, s35, v175 mul:2
    v_cvt_pk_bf16_f32 v200, v208, v209
    v_mfma_f32_16x16x32_bf16 v[52:55], a[196:199], v[236:239], v[52:55]
    v_cvt_pk_bf16_f32 v201, v210, v211
    v_accvgpr_read_b32 v204, a80
    v_mfma_f32_16x16x32_bf16 v[56:59], a[200:203], v[236:239], v[56:59]
    ds_read_b128 v[236:239], v253 offset:24192
    v_accvgpr_read_b32 v205, a81
    v_mfma_f32_16x16x32_bf16 v[56:59], a[212:215], v[228:231], v[56:59]
    ds_write_b128 v248, v[198:201] offset:2304
    v_mfma_f32_16x16x32_bf16 v[36:39], a[216:219], v[228:231], v[36:39]
    v_accvgpr_read_b32 v206, a82
    v_accvgpr_read_b32 v207, a83
    v_mfma_f32_16x16x32_bf16 v[40:43], a[220:223], v[228:231], v[40:43]
    v_accvgpr_read_b32 v208, a176
    v_accvgpr_read_b32 v209, a177
    v_mfma_f32_16x16x32_bf16 v[44:47], a[224:227], v[228:231], v[44:47]
    v_accvgpr_read_b32 v210, a178
    v_accvgpr_read_b32 v211, a179
    v_mfma_f32_16x16x32_bf16 v[60:63], a[192:195], v[228:231], v[60:63]
    s_waitcnt lgkmcnt(2)
    v_sub_f32 v204, v204, v208
    v_sub_f32 v205, v205, v209
    v_mfma_f32_16x16x32_bf16 v[60:63], a[204:207], v[232:235], v[60:63]
    v_sub_f32 v206, v206, v210
    v_sub_f32 v207, v207, v211
    v_fma_f32 v208, v204, s34, v176 div:2
    v_mfma_f32_16x16x32_bf16 v[64:67], a[208:211], v[232:235], v[64:67]
    v_fma_f32 v209, v205, s34, v177 div:2
    v_fma_f32 v210, v206, s34, v178 div:2
    v_mfma_f32_16x16x32_bf16 v[64:67], a[196:199], v[228:231], v[64:67]
    v_fma_f32 v211, v207, s34, v179 div:2
    v_fma_f32 v176, v204, s35, v176 mul:2
    v_mfma_f32_16x16x32_bf16 v[68:71], a[200:203], v[228:231], v[68:71]
    ds_read_b128 v[228:231], v253 offset:23936
    v_fma_f32 v177, v205, s35, v177 mul:2
    v_mfma_f32_16x16x32_bf16 v[68:71], a[212:215], v[232:235], v[68:71]
    v_fma_f32 v178, v206, s35, v178 mul:2
    v_fma_f32 v179, v207, s35, v179 mul:2
    v_mfma_f32_16x16x32_bf16 v[48:51], a[216:219], v[232:235], v[48:51]
    v_cvt_pk_bf16_f32 v202, v208, v209
    v_cvt_pk_bf16_f32 v203, v210, v211
    v_mfma_f32_16x16x32_bf16 v[52:55], a[220:223], v[232:235], v[52:55]
    ds_write_b64 v249, v[202:203] offset:2368
    v_mfma_f32_16x16x32_bf16 v[56:59], a[224:227], v[232:235], v[56:59]
    v_accvgpr_read_b32 v204, a180
    v_accvgpr_read_b32 v205, a181
    v_mfma_f32_16x16x32_bf16 v[72:75], a[192:195], v[232:235], v[72:75]
    s_waitcnt lgkmcnt(3)
    v_accvgpr_read_b32 v206, a182
    v_accvgpr_read_b32 v207, a183
    v_mfma_f32_16x16x32_bf16 v[72:75], a[204:207], v[236:239], v[72:75]
    v_fma_f32 v208, v204, s34, v180 div:2
    v_fma_f32 v209, v205, s34, v181 div:2
    v_mfma_f32_16x16x32_bf16 v[76:79], a[208:211], v[236:239], v[76:79]
    v_fma_f32 v210, v206, s34, v182 div:2
    v_fma_f32 v211, v207, s34, v183 div:2
    v_mfma_f32_16x16x32_bf16 v[76:79], a[196:199], v[232:235], v[76:79]
    v_fma_f32 v180, v204, s35, v180 mul:2
    v_fma_f32 v181, v205, s35, v181 mul:2
    v_mfma_f32_16x16x32_bf16 v[80:83], a[200:203], v[232:235], v[80:83]
    ds_read_b128 v[232:235], v253 offset:23664
    v_fma_f32 v182, v206, s35, v182 mul:2
    v_mfma_f32_16x16x32_bf16 v[80:83], a[212:215], v[236:239], v[80:83]
    s_mov_b32 s42, 1105920
    v_fma_f32 v183, v207, s35, v183 mul:2
    v_cvt_pk_bf16_f32 v192, v208, v209
    v_mfma_f32_16x16x32_bf16 v[60:63], a[216:219], v[236:239], v[60:63]
    v_cvt_pk_bf16_f32 v193, v210, v211
    v_accvgpr_read_b32 v204, a184
    v_mfma_f32_16x16x32_bf16 v[64:67], a[220:223], v[236:239], v[64:67]
    v_accvgpr_read_b32 v205, a185
    v_accvgpr_read_b32 v206, a186
    v_mfma_f32_16x16x32_bf16 v[68:71], a[224:227], v[236:239], v[68:71]
    s_waitcnt lgkmcnt(2)
    v_accvgpr_read_b32 v207, a187
    v_fma_f32 v208, v204, s34, v184 div:2
    v_mfma_f32_16x16x32_bf16 v[84:87], a[192:195], v[236:239], v[84:87]
    buffer_load_dwordx4 a[192:195], v254, s[8:11], s42 offen offset:0 sc1
    v_mfma_f32_16x16x32_bf16 v[88:91], a[196:199], v[236:239], v[88:91]
    s_waitcnt lgkmcnt(0)
    v_fma_f32 v209, v205, s34, v185 div:2
    v_fma_f32 v210, v206, s34, v186 div:2
    v_mfma_f32_16x16x32_bf16 v[92:95], a[200:203], v[236:239], v[92:95]
    s_barrier
    v_mfma_f32_16x16x32_bf16 v[84:87], a[204:207], v[228:231], v[84:87]
    ds_read_b128 v[236:239], v253 offset:34320
    v_fma_f32 v211, v207, s34, v187 div:2
    v_fma_f32 v184, v204, s35, v184 mul:2
    v_mfma_f32_16x16x32_bf16 v[88:91], a[208:211], v[228:231], v[88:91]
    buffer_load_dwordx4 a[196:199], v254, s[8:11], s42 offen offset:1024 sc1
    v_mfma_f32_16x16x32_bf16 v[92:95], a[212:215], v[228:231], v[92:95]
    ds_read_b128 a[124:127], v250 offset:1024
    v_fma_f32 v185, v205, s35, v185 mul:2
    v_mfma_f32_16x16x32_bf16 v[72:75], a[216:219], v[228:231], v[72:75]
    v_fma_f32 v186, v206, s35, v186 mul:2
    v_fma_f32 v187, v207, s35, v187 mul:2
    v_mfma_f32_16x16x32_bf16 v[76:79], a[220:223], v[228:231], v[76:79]
    buffer_load_dwordx4 a[200:203], v254, s[8:11], s42 offen offset:2048 sc1
    v_mfma_f32_16x16x32_bf16 v[80:83], a[224:227], v[228:231], v[80:83]
    ds_read_b128 v[228:231], v253 offset:34048
    v_cvt_pk_bf16_f32 v194, v208, v209
    v_mfma_f32_16x16x32_bf16 v[84:87], a[216:219], v[232:235], v[84:87]
    s_mov_b32 s42, 1108992
    v_cvt_pk_bf16_f32 v195, v210, v211
    v_accvgpr_read_b32 v204, a188
    v_mfma_f32_16x16x32_bf16 v[88:91], a[220:223], v[232:235], v[88:91]
    s_waitcnt vmcnt(11) lgkmcnt(2)
    s_waitcnt lgkmcnt(1)
    v_accvgpr_read_b32 v205, a189
    v_mfma_f32_16x16x32_bf16 v[92:95], a[224:227], v[232:235], v[92:95]
    ds_read_b128 v[232:235], v253 offset:33792
    v_accvgpr_read_b32 v206, a190
sub29:
    v_mfma_f32_16x16x32_bf16 v[0:3], a[228:231], v[236:239], v[0:3]
    buffer_load_dwordx4 a[204:207], v254, s[8:11], s42 offen offset:0 sc1
    v_mfma_f32_16x16x32_bf16 v[4:7], a[232:235], v[236:239], v[4:7]
    s_waitcnt vmcnt(9) lgkmcnt(1)
    v_accvgpr_read_b32 v207, a191
    v_fma_f32 v208, v204, s34, v188 div:2
    v_mfma_f32_16x16x32_bf16 v[8:11], a[236:239], v[236:239], v[8:11]
    ds_read_b128 v[236:239], v253 offset:33536
    v_fma_f32 v209, v205, s34, v189 div:2
    v_mfma_f32_16x16x32_bf16 v[0:3], a[240:243], v[228:231], v[0:3]
    ds_read_b128 a[128:131], v250 offset:4128
    v_fma_f32 v210, v206, s34, v190 div:2
    v_mfma_f32_16x16x32_bf16 v[4:7], a[244:247], v[228:231], v[4:7]
    buffer_load_dwordx4 a[208:211], v254, s[8:11], s42 offen offset:1024 sc1
    v_mfma_f32_16x16x32_bf16 v[8:11], a[248:251], v[228:231], v[8:11]
    ds_write_b128 v248, v[192:195] offset:2688
    v_mfma_f32_16x16x32_bf16 v[12:15], a[228:231], v[228:231], v[12:15]
    s_waitcnt lgkmcnt(3)
    v_fma_f32 v211, v207, s34, v191 div:2
    v_fma_f32 v188, v204, s35, v188 mul:2
    v_mfma_f32_16x16x32_bf16 v[12:15], a[240:243], v[232:235], v[12:15]
    ds_read_b128 a[132:135], v250 offset:7232
    v_fma_f32 v189, v205, s35, v189 mul:2
    v_mfma_f32_16x16x32_bf16 v[16:19], a[244:247], v[232:235], v[16:19]
pad11:
    s_cbranch_vccnz warm_ret
    buffer_load_dwordx4 a[212:215], v254, s[8:11], s42 offen offset:2048 sc1
    v_mfma_f32_16x16x32_bf16 v[16:19], a[232:235], v[228:231], v[16:19]
    s_mov_b32 s42, 1112064
    v_fma_f32 v190, v206, s35, v190 mul:2
    v_fma_f32 v191, v207, s35, v191 mul:2
    v_mfma_f32_16x16x32_bf16 v[20:23], a[236:239], v[228:231], v[20:23]
    ds_read_b128 v[228:231], v253 offset:33280
    v_cvt_pk_bf16_f32 v196, v208, v209
    v_mfma_f32_16x16x32_bf16 v[20:23], a[248:251], v[232:235], v[20:23]
    s_waitcnt vmcnt(8)
    v_cvt_pk_bf16_f32 v197, v210, v211
    v_mfma_f32_16x16x32_bf16 v[0:3], a[252:255], v[232:235], v[0:3]
    buffer_load_dwordx4 a[216:219], v254, s[8:11], s42 offen offset:0 sc1
    v_mfma_f32_16x16x32_bf16 v[4:7], v[240:243], v[232:235], v[4:7]
    ds_read_b128 a[136:139], v250 offset:10336
    v_mfma_f32_16x16x32_bf16 v[8:11], v[244:247], v[232:235], v[8:11]
    buffer_store_dwordx4 a[124:127], v254, s[12:15], s44 offen nt
    s_add_u32 s44, s40, 200704
    s_waitcnt lgkmcnt(4)
    v_mfma_f32_16x16x32_bf16 v[24:27], a[228:231], v[232:235], v[24:27]
    v_mfma_f32_16x16x32_bf16 v[24:27], a[240:243], v[236:239], v[24:27]
    buffer_load_dwordx4 a[220:223], v254, s[8:11], s42 offen offset:1024 sc1
    v_mfma_f32_16x16x32_bf16 v[28:31], a[244:247], v[236:239], v[28:31]
    ds_write_b64 v249, v[196:197] offset:2752
    v_mfma_f32_16x16x32_bf16 v[28:31], a[232:235], v[232:235], v[28:31]
    buffer_store_dwordx4 a[128:131], v254, s[12:15], s44 offen nt
    s_add_u32 s44, s40, 203776
    s_waitcnt lgkmcnt(3)
    v_mfma_f32_16x16x32_bf16 v[32:35], a[236:239], v[232:235], v[32:35]
    ds_read_b128 v[232:235], v253 offset:35104
    v_mfma_f32_16x16x32_bf16 v[32:35], a[248:251], v[236:239], v[32:35]
    buffer_load_dwordx4 a[224:227], v254, s[8:11], s42 offen offset:2048 sc1
    v_mfma_f32_16x16x32_bf16 v[12:15], a[252:255], v[236:239], v[12:15]
    v_cvt_pk_bf16_f32 v8, v8, v9
    v_cvt_pk_bf16_f32 v9, v10, v11
    v_mfma_f32_16x16x32_bf16 v[16:19], v[240:243], v[236:239], v[16:19]
    buffer_store_dwordx4 a[132:135], v254, s[12:15], s44 offen nt
    v_and_b32 v227, 0x7fff, v255
    s_add_u32 s44, s40, 206848
    v_mfma_f32_16x16x32_bf16 v[20:23], v[244:247], v[236:239], v[20:23]
    buffer_load_dwordx2 v[216:217], v227, s[4:7], s16 offen offset:0
    v_mfma_f32_16x16x32_bf16 v[36:39], a[228:231], v[236:239], v[36:39]
    s_waitcnt lgkmcnt(3)
    s_waitcnt lgkmcnt(2)
    v_cvt_pk_bf16_f32 v0, v0, v1
    v_mfma_f32_16x16x32_bf16 v[36:39], a[240:243], v[228:231], v[36:39]
    ds_write_b64 v249, v[8:9] offset:12544
    v_mfma_f32_16x16x32_bf16 v[40:43], a[244:247], v[228:231], v[40:43]
    v_cvt_pk_bf16_f32 v1, v2, v3
    v_cvt_pk_bf16_f32 v2, v4, v5
    v_mfma_f32_16x16x32_bf16 v[40:43], a[232:235], v[236:239], v[40:43]
    v_cvt_pk_bf16_f32 v3, v6, v7
    v_mov_b32 v4, v248
    v_mfma_f32_16x16x32_bf16 v[44:47], a[236:239], v[236:239], v[44:47]
    ds_read_b128 v[236:239], v253 offset:34848
    v_mov_b32 v5, v249
    v_mfma_f32_16x16x32_bf16 v[44:47], a[248:251], v[228:231], v[44:47]
    buffer_load_dwordx2 v[218:219], v227, s[4:7], s17 offen offset:0
    v_mfma_f32_16x16x32_bf16 v[24:27], a[252:255], v[228:231], v[24:27]
    ds_write_b128 v248, v[0:3] offset:12480
    v_mfma_f32_16x16x32_bf16 v[28:31], v[240:243], v[228:231], v[28:31]
    v_mov_b32 v6, v250
    v_cvt_pk_bf16_f32 v20, v20, v21
    v_mfma_f32_16x16x32_bf16 v[32:35], v[244:247], v[228:231], v[32:35]
    v_cvt_pk_bf16_f32 v21, v22, v23
    v_cvt_pk_bf16_f32 v12, v12, v13
    v_mfma_f32_16x16x32_bf16 v[48:51], a[228:231], v[228:231], v[48:51]
    s_waitcnt lgkmcnt(3)
    v_cvt_pk_bf16_f32 v13, v14, v15
    v_cvt_pk_bf16_f32 v14, v16, v17
    v_mfma_f32_16x16x32_bf16 v[48:51], a[240:243], v[232:235], v[48:51]
    buffer_load_dwordx2 v[220:221], v227, s[4:7], s18 offen offset:0
    v_mfma_f32_16x16x32_bf16 v[52:55], a[244:247], v[232:235], v[52:55]
    ds_write_b64 v5, v[20:21] offset:12928
    v_mfma_f32_16x16x32_bf16 v[52:55], a[232:235], v[228:231], v[52:55]
    v_cvt_pk_bf16_f32 v15, v18, v19
    v_mfma_f32_16x16x32_bf16 v[56:59], a[236:239], v[228:231], v[56:59]
    ds_read_b128 v[228:231], v253 offset:34592
    v_mfma_f32_16x16x32_bf16 v[56:59], a[248:251], v[232:235], v[56:59]
    ds_write_b128 v4, v[12:15] offset:12864
    v_mfma_f32_16x16x32_bf16 v[36:39], a[252:255], v[232:235], v[36:39]
    buffer_load_dwordx2 v[222:223], v227, s[4:7], s19 offen offset:0
    v_mfma_f32_16x16x32_bf16 v[40:43], v[240:243], v[232:235], v[40:43]
    v_cvt_pk_bf16_f32 v32, v32, v33
    v_cvt_pk_bf16_f32 v33, v34, v35
    v_mfma_f32_16x16x32_bf16 v[44:47], v[244:247], v[232:235], v[44:47]
    v_cvt_pk_bf16_f32 v24, v24, v25
    v_cvt_pk_bf16_f32 v25, v26, v27
    v_mfma_f32_16x16x32_bf16 v[60:63], a[228:231], v[232:235], v[60:63]
    s_waitcnt lgkmcnt(4)
    v_cvt_pk_bf16_f32 v26, v28, v29
    v_cvt_pk_bf16_f32 v27, v30, v31
    v_mfma_f32_16x16x32_bf16 v[60:63], a[240:243], v[236:239], v[60:63]
    ds_write_b64 v5, v[32:33] offset:13312
    v_mfma_f32_16x16x32_bf16 v[64:67], a[244:247], v[236:239], v[64:67]
    buffer_load_dwordx2 v[224:225], v227, s[4:7], s20 offen offset:0
    v_mfma_f32_16x16x32_bf16 v[64:67], a[232:235], v[232:235], v[64:67]
    ds_write_b128 v4, v[24:27] offset:13248
    v_mfma_f32_16x16x32_bf16 v[68:71], a[236:239], v[232:235], v[68:71]
    ds_read_b128 v[232:235], v253 offset:34336
    v_mfma_f32_16x16x32_bf16 v[68:71], a[248:251], v[236:239], v[68:71]
    v_cvt_pk_bf16_f32 v44, v44, v45
    v_cvt_pk_bf16_f32 v45, v46, v47
    v_mfma_f32_16x16x32_bf16 v[48:51], a[252:255], v[236:239], v[48:51]
    v_cvt_pk_bf16_f32 v36, v36, v37
    v_cvt_pk_bf16_f32 v37, v38, v39
    v_mfma_f32_16x16x32_bf16 v[52:55], v[240:243], v[236:239], v[52:55]
    buffer_load_dwordx2 v[226:227], v227, s[4:7], s21 offen offset:0
    v_mfma_f32_16x16x32_bf16 v[56:59], v[244:247], v[236:239], v[56:59]
    ds_write_b64 v5, v[44:45] offset:13696
    v_mfma_f32_16x16x32_bf16 v[72:75], a[228:231], v[236:239], v[72:75]
    s_waitcnt lgkmcnt(5)
    v_cvt_pk_bf16_f32 v38, v40, v41
    v_cvt_pk_bf16_f32 v39, v42, v43
    v_mfma_f32_16x16x32_bf16 v[72:75], a[240:243], v[228:231], v[72:75]
    ds_write_b128 v4, v[36:39] offset:13632
    v_mfma_f32_16x16x32_bf16 v[76:79], a[244:247], v[228:231], v[76:79]
    v_mfma_f32_16x16x32_bf16 v[76:79], a[232:235], v[236:239], v[76:79]
    buffer_store_dwordx4 a[136:139], v254, s[12:15], s44 offen nt
    s_add_u32 s44, s40, 198656
    v_mfma_f32_16x16x32_bf16 v[80:83], a[236:239], v[236:239], v[80:83]
    ds_read_b128 v[236:239], v253 offset:34064
    v_mfma_f32_16x16x32_bf16 v[80:83], a[248:251], v[228:231], v[80:83]
    s_mov_b32 s42, 1142784
    v_cvt_pk_bf16_f32 v56, v56, v57
    v_cvt_pk_bf16_f32 v57, v58, v59
    v_mfma_f32_16x16x32_bf16 v[60:63], a[252:255], v[228:231], v[60:63]
    v_cvt_pk_bf16_f32 v48, v48, v49
    v_cvt_pk_bf16_f32 v49, v50, v51
    v_mfma_f32_16x16x32_bf16 v[64:67], v[240:243], v[228:231], v[64:67]
    ds_write_b64 v5, v[56:57] offset:14080
    v_mfma_f32_16x16x32_bf16 v[68:71], v[244:247], v[228:231], v[68:71]
    s_waitcnt lgkmcnt(4)
    v_cvt_pk_bf16_f32 v50, v52, v53
    v_cvt_pk_bf16_f32 v51, v54, v55
    v_mfma_f32_16x16x32_bf16 v[84:87], a[228:231], v[228:231], v[84:87]
    buffer_load_dwordx4 a[228:231], v254, s[8:11], s42 offen offset:0 sc1
    v_mfma_f32_16x16x32_bf16 v[88:91], a[232:235], v[228:231], v[88:91]
    s_waitcnt lgkmcnt(0)
    v_mfma_f32_16x16x32_bf16 v[92:95], a[236:239], v[228:231], v[92:95]
    s_barrier
    v_mfma_f32_16x16x32_bf16 v[84:87], a[240:243], v[232:235], v[84:87]
    ds_read_b128 v[228:231], v253 offset:36400
    v_mfma_f32_16x16x32_bf16 v[88:91], a[244:247], v[232:235], v[88:91]
    buffer_load_dwordx4 a[232:235], v254, s[8:11], s42 offen offset:1024 sc1
    v_mfma_f32_16x16x32_bf16 v[92:95], a[248:251], v[232:235], v[92:95]
    ds_read_b128 a[140:143], v6 offset:2048
    v_cvt_pk_bf16_f32 v68, v68, v69
    v_mfma_f32_16x16x32_bf16 v[72:75], a[252:255], v[232:235], v[72:75]
    v_cvt_pk_bf16_f32 v69, v70, v71
    v_cvt_pk_bf16_f32 v60, v60, v61
    v_mfma_f32_16x16x32_bf16 v[76:79], v[240:243], v[232:235], v[76:79]
    buffer_load_dwordx4 a[236:239], v254, s[8:11], s42 offen offset:2048 sc1
    v_mfma_f32_16x16x32_bf16 v[80:83], v[244:247], v[232:235], v[80:83]
    ds_read_b128 v[232:235], v253 offset:36128
    v_cvt_pk_bf16_f32 v61, v62, v63
    v_mfma_f32_16x16x32_bf16 v[84:87], a[252:255], v[236:239], v[84:87]
    s_mov_b32 s42, 1145856
    v_cvt_pk_bf16_f32 v62, v64, v65
    v_cvt_pk_bf16_f32 v63, v66, v67
    v_mfma_f32_16x16x32_bf16 v[88:91], v[240:243], v[236:239], v[88:91]
    s_waitcnt vmcnt(19) lgkmcnt(2)
    s_waitcnt lgkmcnt(1)
    v_mfma_f32_16x16x32_bf16 v[92:95], v[244:247], v[236:239], v[92:95]
    ds_read_b128 v[236:239], v253 offset:35872
sub30:
    v_mfma_f32_16x16x32_bf16 v[96:99], a[192:195], v[228:231], v[96:99]
    buffer_load_dwordx4 a[240:243], v254, s[8:11], s42 offen offset:0 sc1
    v_mfma_f32_16x16x32_bf16 v[100:103], a[196:199], v[228:231], v[100:103]
    s_waitcnt vmcnt(17) lgkmcnt(1)
    v_mfma_f32_16x16x32_bf16 v[104:107], a[200:203], v[228:231], v[104:107]
    ds_read_b128 v[228:231], v253 offset:35616
    v_cvt_pk_bf16_f32 v80, v80, v81
    v_mfma_f32_16x16x32_bf16 v[96:99], a[204:207], v[232:235], v[96:99]
    ds_read_b128 a[144:147], v6 offset:5152
    v_cvt_pk_bf16_f32 v81, v82, v83
    v_mfma_f32_16x16x32_bf16 v[100:103], a[208:211], v[232:235], v[100:103]
    buffer_load_dwordx4 a[244:247], v254, s[8:11], s42 offen offset:1024 sc1
    v_mfma_f32_16x16x32_bf16 v[104:107], a[212:215], v[232:235], v[104:107]
    ds_write_b128 v4, v[48:51] offset:14016
    v_mfma_f32_16x16x32_bf16 v[108:111], a[192:195], v[232:235], v[108:111]
    s_waitcnt lgkmcnt(3)
    v_cvt_pk_bf16_f32 v72, v72, v73
    v_cvt_pk_bf16_f32 v73, v74, v75
    v_mfma_f32_16x16x32_bf16 v[108:111], a[204:207], v[236:239], v[108:111]
    v_cvt_pk_bf16_f32 v74, v76, v77
    v_cvt_pk_bf16_f32 v75, v78, v79
    v_mfma_f32_16x16x32_bf16 v[112:115], a[208:211], v[236:239], v[112:115]
    buffer_load_dwordx4 a[248:251], v254, s[8:11], s42 offen offset:2048 sc1
    v_mfma_f32_16x16x32_bf16 v[112:115], a[196:199], v[232:235], v[112:115]
    s_mov_b32 s42, 1148928
    v_cvt_pk_bf16_f32 v92, v92, v93
    v_cvt_pk_bf16_f32 v93, v94, v95
    v_mfma_f32_16x16x32_bf16 v[116:119], a[200:203], v[232:235], v[116:119]
    ds_read_b128 v[232:235], v253 offset:35360
    v_cvt_pk_bf16_f32 v84, v84, v85
    v_mfma_f32_16x16x32_bf16 v[116:119], a[212:215], v[236:239], v[116:119]
    s_waitcnt vmcnt(14)
    v_cvt_pk_bf16_f32 v85, v86, v87
    v_cvt_pk_bf16_f32 v86, v88, v89
    v_mfma_f32_16x16x32_bf16 v[96:99], a[216:219], v[236:239], v[96:99]
    buffer_load_dwordx4 a[252:255], v254, s[8:11], s42 offen offset:0 sc1
    v_mfma_f32_16x16x32_bf16 v[100:103], a[220:223], v[236:239], v[100:103]
    ds_read_b128 a[148:151], v6 offset:8256
    v_cvt_pk_bf16_f32 v87, v90, v91
    v_mfma_f32_16x16x32_bf16 v[104:107], a[224:227], v[236:239], v[104:107]
    buffer_store_dwordx4 a[140:143], v254, s[12:15], s44 offen nt
    s_add_u32 s44, s40, 201728
    s_waitcnt lgkmcnt(3)
    v_mfma_f32_16x16x32_bf16 v[120:123], a[192:195], v[236:239], v[120:123]
    v_mfma_f32_16x16x32_bf16 v[120:123], a[204:207], v[228:231], v[120:123]
    buffer_load_dwordx4 v[240:243], v254, s[8:11], s42 offen offset:1024 sc1
    v_mfma_f32_16x16x32_bf16 v[124:127], a[208:211], v[228:231], v[124:127]
    ds_write_b64 v5, v[68:69] offset:14464
    v_mfma_f32_16x16x32_bf16 v[124:127], a[196:199], v[236:239], v[124:127]
    buffer_store_dwordx4 a[144:147], v254, s[12:15], s44 offen nt
    s_add_u32 s44, s40, 204800
    s_waitcnt lgkmcnt(1)
    v_mfma_f32_16x16x32_bf16 v[128:131], a[200:203], v[236:239], v[128:131]
    ds_read_b128 v[236:239], v253 offset:37184
    v_mfma_f32_16x16x32_bf16 v[128:131], a[212:215], v[228:231], v[128:131]
    buffer_load_dwordx4 v[244:247], v254, s[8:11], s42 offen offset:2048 sc1
    v_mfma_f32_16x16x32_bf16 v[108:111], a[216:219], v[228:231], v[108:111]
    ds_read_b128 a[152:155], v6 offset:11360
    v_mfma_f32_16x16x32_bf16 v[112:115], a[220:223], v[228:231], v[112:115]
    buffer_store_dwordx4 a[148:151], v254, s[12:15], s44 offen nt
    v_and_b32 v203, 0x7fff, v255
    v_mfma_f32_16x16x32_bf16 v[116:119], a[224:227], v[228:231], v[116:119]
    buffer_load_dwordx2 v[192:193], v203, s[4:7], s16 offen offset:384
    v_mfma_f32_16x16x32_bf16 v[132:135], a[192:195], v[228:231], v[132:135]
    v_mfma_f32_16x16x32_bf16 v[132:135], a[204:207], v[232:235], v[132:135]
    ds_write_b128 v4, v[60:63] offset:14400
    v_mfma_f32_16x16x32_bf16 v[136:139], a[208:211], v[232:235], v[136:139]
    s_waitcnt vmcnt(14)
    v_lshlrev_b32 v248, 16, v218
    v_lshlrev_b32 v249, 16, v220
    v_mfma_f32_16x16x32_bf16 v[136:139], a[196:199], v[228:231], v[136:139]
    s_add_u32 s44, s40, 207872
    v_lshlrev_b32 v250, 16, v222
    v_lshlrev_b32 v251, 16, v224
    v_mfma_f32_16x16x32_bf16 v[140:143], a[200:203], v[228:231], v[140:143]
    ds_read_b128 v[228:231], v253 offset:36928
    v_and_b32 v218, s22, v218
    v_mfma_f32_16x16x32_bf16 v[140:143], a[212:215], v[232:235], v[140:143]
    buffer_load_dwordx2 v[194:195], v203, s[4:7], s17 offen offset:384
    v_mfma_f32_16x16x32_bf16 v[120:123], a[216:219], v[232:235], v[120:123]
    ds_write_b64 v5, v[80:81] offset:14848
    v_mfma_f32_16x16x32_bf16 v[124:127], a[220:223], v[232:235], v[124:127]
    v_and_b32 v220, s22, v220
    v_and_b32 v222, s22, v222
    v_mfma_f32_16x16x32_bf16 v[128:131], a[224:227], v[232:235], v[128:131]
    ds_write_b128 v4, v[72:75] offset:14784
    v_mfma_f32_16x16x32_bf16 v[144:147], a[192:195], v[232:235], v[144:147]
    s_waitcnt lgkmcnt(5)
    v_and_b32 v224, s22, v224
    v_lshlrev_b32 v252, 16, v216
    v_mfma_f32_16x16x32_bf16 v[144:147], a[204:207], v[236:239], v[144:147]
    buffer_load_dwordx2 v[196:197], v203, s[4:7], s18 offen offset:384
    v_mfma_f32_16x16x32_bf16 v[148:151], a[208:211], v[236:239], v[148:151]
    s_waitcnt lgkmcnt(4)
    v_and_b32 v216, s22, v216
    v_fmac_f32 v252, s25, v251
    v_mfma_f32_16x16x32_bf16 v[148:151], a[196:199], v[232:235], v[148:151]
    ds_write_b64 v5, v[92:93] offset:15232
    v_mfma_f32_16x16x32_bf16 v[152:155], a[200:203], v[232:235], v[152:155]
    ds_read_b128 v[232:235], v253 offset:36672
    v_fmac_f32 v216, s25, v224
    v_mfma_f32_16x16x32_bf16 v[152:155], a[212:215], v[236:239], v[152:155]
    ds_write_b128 v4, v[84:87] offset:15168
    v_mfma_f32_16x16x32_bf16 v[132:135], a[216:219], v[236:239], v[132:135]
    buffer_load_dwordx2 v[198:199], v203, s[4:7], s19 offen offset:384
    v_mfma_f32_16x16x32_bf16 v[136:139], a[220:223], v[236:239], v[136:139]
    v_fmac_f32 v252, s28, v249
    v_fmac_f32 v216, s28, v220
    v_mfma_f32_16x16x32_bf16 v[140:143], a[224:227], v[236:239], v[140:143]
    v_cvt_pk_bf16_f32 v216, v252, v216
    v_lshlrev_b32 v252, 16, v226
    v_mfma_f32_16x16x32_bf16 v[156:159], a[192:195], v[236:239], v[156:159]
    s_waitcnt lgkmcnt(5)
    v_and_b32 v226, s22, v226
    v_fmac_f32 v252, s29, v248
    v_mfma_f32_16x16x32_bf16 v[156:159], a[204:207], v[228:231], v[156:159]
    v_fmac_f32 v226, s29, v218
    v_fmac_f32 v252, s23, v250
    v_mfma_f32_16x16x32_bf16 v[160:163], a[208:211], v[228:231], v[160:163]
    buffer_load_dwordx2 v[200:201], v203, s[4:7], s20 offen offset:384
    v_mfma_f32_16x16x32_bf16 v[160:163], a[196:199], v[236:239], v[160:163]
    v_fmac_f32 v226, s23, v222
    v_cvt_pk_bf16_f32 v226, v252, v226
    v_mfma_f32_16x16x32_bf16 v[164:167], a[200:203], v[236:239], v[164:167]
    ds_read_b128 v[236:239], v253 offset:36416
    v_fma_f32 v252, v249, s24, v251
    v_mfma_f32_16x16x32_bf16 v[164:167], a[212:215], v[228:231], v[164:167]
    v_fmac_f32 v251, -4.0, v249
    v_fma_f32 v249, v248, s24, v250
    v_mfma_f32_16x16x32_bf16 v[144:147], a[216:219], v[228:231], v[144:147]
    v_fmac_f32 v250, -4.0, v248
    v_fma_f32 v248, v250, s26, v251
    v_mfma_f32_16x16x32_bf16 v[148:151], a[220:223], v[228:231], v[148:151]
    buffer_load_dwordx2 v[202:203], v203, s[4:7], s21 offen offset:384
    v_mfma_f32_16x16x32_bf16 v[152:155], a[224:227], v[228:231], v[152:155]
    v_fmac_f32 v251, s27, v250
    v_fma_f32 v250, v249, 2.0, v252
    v_mfma_f32_16x16x32_bf16 v[168:171], a[192:195], v[228:231], v[168:171]
    s_waitcnt lgkmcnt(2)
    v_fmac_f32 v252, -2.0, v249
    v_fma_f32 v249, v220, s24, v224
    v_mfma_f32_16x16x32_bf16 v[168:171], a[204:207], v[232:235], v[168:171]
    v_fmac_f32 v224, -4.0, v220
    v_fma_f32 v220, v218, s24, v222
    v_mfma_f32_16x16x32_bf16 v[172:175], a[208:211], v[232:235], v[172:175]
    v_fmac_f32 v222, -4.0, v218
    v_fma_f32 v218, v222, s26, v224
    v_mfma_f32_16x16x32_bf16 v[172:175], a[196:199], v[228:231], v[172:175]
    buffer_store_dwordx4 a[152:155], v254, s[12:15], s44 offen nt
    v_fmac_f32 v224, s27, v222
    v_fma_f32 v222, v220, 2.0, v249
    v_mfma_f32_16x16x32_bf16 v[176:179], a[200:203], v[228:231], v[176:179]
    ds_read_b128 v[228:231], v253 offset:36144
    v_fmac_f32 v249, -2.0, v220
    v_mfma_f32_16x16x32_bf16 v[176:179], a[212:215], v[232:235], v[176:179]
    s_mov_b32 s42, 1179648
    v_cvt_pk_bf16_f32 v218, v248, v218
    v_cvt_pk_bf16_f32 v224, v251, v224
    v_mfma_f32_16x16x32_bf16 v[156:159], a[216:219], v[232:235], v[156:159]
    v_cvt_pk_bf16_f32 v222, v250, v222
    v_cvt_pk_bf16_f32 v220, v252, v249
    v_mfma_f32_16x16x32_bf16 v[160:163], a[220:223], v[232:235], v[160:163]
    v_lshlrev_b32 v248, 16, v219
    v_lshlrev_b32 v249, 16, v221
    v_mfma_f32_16x16x32_bf16 v[164:167], a[224:227], v[232:235], v[164:167]
    s_waitcnt lgkmcnt(1)
    v_lshlrev_b32 v250, 16, v223
    v_lshlrev_b32 v251, 16, v225
    v_mfma_f32_16x16x32_bf16 v[180:183], a[192:195], v[232:235], v[180:183]
    buffer_load_dwordx4 a[192:195], v254, s[8:11], s42 offen offset:0 sc1
    v_mfma_f32_16x16x32_bf16 v[184:187], a[196:199], v[232:235], v[184:187]
    s_waitcnt lgkmcnt(0)
    v_and_b32 v219, s22, v219
    v_and_b32 v221, s22, v221
    v_mfma_f32_16x16x32_bf16 v[188:191], a[200:203], v[232:235], v[188:191]
    s_barrier
    v_mfma_f32_16x16x32_bf16 v[180:183], a[204:207], v[236:239], v[180:183]
    ds_read_b128 v[232:235], v253 offset:38480
    v_and_b32 v223, s22, v223
    v_mfma_f32_16x16x32_bf16 v[184:187], a[208:211], v[236:239], v[184:187]
    buffer_load_dwordx4 a[196:199], v254, s[8:11], s42 offen offset:1024 sc1
    v_mfma_f32_16x16x32_bf16 v[188:191], a[212:215], v[236:239], v[188:191]
    ds_read_b128 a[0:3], v6 offset:12480
    v_and_b32 v225, s22, v225
    v_mfma_f32_16x16x32_bf16 v[168:171], a[216:219], v[236:239], v[168:171]
    v_lshlrev_b32 v252, 16, v217
    v_and_b32 v217, s22, v217
    v_mfma_f32_16x16x32_bf16 v[172:175], a[220:223], v[236:239], v[172:175]
    buffer_load_dwordx4 a[200:203], v254, s[8:11], s42 offen offset:2048 sc1
    v_mfma_f32_16x16x32_bf16 v[176:179], a[224:227], v[236:239], v[176:179]
    ds_read_b128 v[236:239], v253 offset:38208
    v_fmac_f32 v252, s25, v251
    v_mfma_f32_16x16x32_bf16 v[180:183], a[216:219], v[228:231], v[180:183]
    s_mov_b32 s42, 1182720
    v_fmac_f32 v217, s25, v225
    v_fmac_f32 v252, s28, v249
    v_mfma_f32_16x16x32_bf16 v[184:187], a[220:223], v[228:231], v[184:187]
    s_waitcnt vmcnt(19) lgkmcnt(2)
    v_fmac_f32 v217, s28, v221
    v_cvt_pk_bf16_f32 v217, v252, v217
    v_mfma_f32_16x16x32_bf16 v[188:191], a[224:227], v[228:231], v[188:191]
    ds_read_b128 v[228:231], v253 offset:37952
    v_lshlrev_b32 v252, 16, v227
sub31:
    v_mfma_f32_16x16x32_bf16 v[96:99], a[228:231], v[232:235], v[96:99]
    buffer_load_dwordx4 a[204:207], v254, s[8:11], s42 offen offset:0 sc1
    v_mfma_f32_16x16x32_bf16 v[100:103], a[232:235], v[232:235], v[100:103]
    s_waitcnt vmcnt(17) lgkmcnt(1)
    v_and_b32 v227, s22, v227
    v_fmac_f32 v252, s29, v248
    v_mfma_f32_16x16x32_bf16 v[104:107], a[236:239], v[232:235], v[104:107]
    ds_read_b128 v[232:235], v253 offset:37696
    v_fmac_f32 v227, s29, v219
    v_mfma_f32_16x16x32_bf16 v[96:99], a[240:243], v[236:239], v[96:99]
    v_fmac_f32 v252, s23, v250
    v_fmac_f32 v227, s23, v223
    v_mfma_f32_16x16x32_bf16 v[100:103], a[244:247], v[236:239], v[100:103]
    buffer_load_dwordx4 a[208:211], v254, s[8:11], s42 offen offset:1024 sc1
    v_mfma_f32_16x16x32_bf16 v[104:107], a[248:251], v[236:239], v[104:107]
    v_cvt_pk_bf16_f32 v227, v252, v227
    v_fma_f32 v252, v249, s24, v251
    v_mfma_f32_16x16x32_bf16 v[108:111], a[228:231], v[236:239], v[108:111]
    s_waitcnt lgkmcnt(1)
    v_fmac_f32 v251, -4.0, v249
    v_fma_f32 v249, v248, s24, v250
    v_mfma_f32_16x16x32_bf16 v[108:111], a[240:243], v[228:231], v[108:111]
    ds_read_b128 a[4:7], v6 offset:13504
    v_fmac_f32 v250, -4.0, v248
    v_mfma_f32_16x16x32_bf16 v[112:115], a[244:247], v[228:231], v[112:115]
    buffer_load_dwordx4 a[212:215], v254, s[8:11], s42 offen offset:2048 sc1
    v_mfma_f32_16x16x32_bf16 v[112:115], a[232:235], v[236:239], v[112:115]
    s_mov_b32 s42, 1185792
    s_add_u32 s44, s40, 0
    v_fma_f32 v248, v250, s26, v251
    v_mfma_f32_16x16x32_bf16 v[116:119], a[236:239], v[236:239], v[116:119]
    ds_read_b128 v[236:239], v253 offset:37440
    v_fmac_f32 v251, s27, v250
    v_mfma_f32_16x16x32_bf16 v[116:119], a[248:251], v[228:231], v[116:119]
    s_waitcnt vmcnt(14)
    v_fma_f32 v250, v249, 2.0, v252
    v_fmac_f32 v252, -2.0, v249
    v_mfma_f32_16x16x32_bf16 v[96:99], a[252:255], v[228:231], v[96:99]
    buffer_load_dwordx4 a[216:219], v254, s[8:11], s42 offen offset:0 sc1
    v_mfma_f32_16x16x32_bf16 v[100:103], v[240:243], v[228:231], v[100:103]
    v_fma_f32 v249, v221, s24, v225
    v_fmac_f32 v225, -4.0, v221
    v_mfma_f32_16x16x32_bf16 v[104:107], v[244:247], v[228:231], v[104:107]
    v_fma_f32 v221, v219, s24, v223
    v_mfma_f32_16x16x32_bf16 v[120:123], a[228:231], v[228:231], v[120:123]
    s_waitcnt lgkmcnt(2)
    v_fmac_f32 v223, -4.0, v219
    v_fma_f32 v219, v223, s26, v225
    v_mfma_f32_16x16x32_bf16 v[120:123], a[240:243], v[232:235], v[120:123]
    buffer_load_dwordx4 a[220:223], v254, s[8:11], s42 offen offset:1024 sc1
    v_mfma_f32_16x16x32_bf16 v[124:127], a[244:247], v[232:235], v[124:127]
    v_fmac_f32 v225, s27, v223
    v_fma_f32 v223, v221, 2.0, v249
    v_mfma_f32_16x16x32_bf16 v[124:127], a[232:235], v[228:231], v[124:127]
    v_fmac_f32 v249, -2.0, v221
    v_cvt_pk_bf16_f32 v219, v248, v219
    v_mfma_f32_16x16x32_bf16 v[128:131], a[236:239], v[228:231], v[128:131]
    ds_read_b128 v[228:231], v253 offset:39264
    v_cvt_pk_bf16_f32 v225, v251, v225
    v_mfma_f32_16x16x32_bf16 v[128:131], a[248:251], v[232:235], v[128:131]
    buffer_load_dwordx4 a[224:227], v254, s[8:11], s42 offen offset:2048 sc1
    v_mfma_f32_16x16x32_bf16 v[108:111], a[252:255], v[232:235], v[108:111]
    ds_read_b128 a[8:11], v6 offset:14528
    v_cvt_pk_bf16_f32 v223, v250, v223
    v_mfma_f32_16x16x32_bf16 v[112:115], v[240:243], v[232:235], v[112:115]
    buffer_store_dwordx4 a[0:3], v254, s[12:15], s44 offen nt
    v_and_b32 v215, 0x7fff, v255
    v_cvt_pk_bf16_f32 v221, v252, v249
    v_mfma_f32_16x16x32_bf16 v[116:119], v[244:247], v[232:235], v[116:119]
    buffer_load_dwordx2 v[204:205], v215, s[4:7], s16 offen offset:768
    v_mfma_f32_16x16x32_bf16 v[132:135], a[228:231], v[232:235], v[132:135]
    s_waitcnt lgkmcnt(2)
    v_lshrrev_b32 v252, 15, v255
    v_mfma_f32_16x16x32_bf16 v[132:135], a[240:243], v[236:239], v[132:135]
    ds_write_b64 v252, v[218:219] offset:768
    v_mfma_f32_16x16x32_bf16 v[136:139], a[244:247], v[236:239], v[136:139]
    s_waitcnt vmcnt(12)
    v_lshrrev_b32 v218, 15, v255
    v_lshlrev_b32 v248, 16, v194
    v_mfma_f32_16x16x32_bf16 v[136:139], a[232:235], v[232:235], v[136:139]
    ds_write_b64 v218, v[224:225] offset:2848
    v_mfma_f32_16x16x32_bf16 v[140:143], a[236:239], v[232:235], v[140:143]
    ds_read_b128 v[232:235], v253 offset:39008
    s_add_u32 s44, s40, 1024
    v_mfma_f32_16x16x32_bf16 v[140:143], a[248:251], v[236:239], v[140:143]
    buffer_load_dwordx2 v[206:207], v215, s[4:7], s17 offen offset:768
    v_mfma_f32_16x16x32_bf16 v[120:123], a[252:255], v[236:239], v[120:123]
    ds_write_b64 v218, v[222:223] offset:4928
    v_mfma_f32_16x16x32_bf16 v[124:127], v[240:243], v[236:239], v[124:127]
    v_lshlrev_b32 v249, 16, v196
    v_lshlrev_b32 v250, 16, v198
    v_mfma_f32_16x16x32_bf16 v[128:131], v[244:247], v[236:239], v[128:131]
    ds_write_b64 v218, v[216:217] offset:34048
    v_mfma_f32_16x16x32_bf16 v[144:147], a[228:231], v[236:239], v[144:147]
    s_waitcnt lgkmcnt(6)
    v_lshlrev_b32 v251, 16, v200
    v_and_b32 v194, s22, v194
    v_mfma_f32_16x16x32_bf16 v[144:147], a[240:243], v[228:231], v[144:147]
    buffer_load_dwordx2 v[208:209], v215, s[4:7], s18 offen offset:768
    v_mfma_f32_16x16x32_bf16 v[148:151], a[244:247], v[228:231], v[148:151]
    ds_read_b128 a[12:15], v6 offset:15584
    v_mfma_f32_16x16x32_bf16 v[148:151], a[232:235], v[236:239], v[148:151]
    ds_write_b64 v218, v[226:227] offset:36128
    v_mfma_f32_16x16x32_bf16 v[152:155], a[236:239], v[236:239], v[152:155]
    ds_read_b128 v[236:239], v253 offset:38752
    v_and_b32 v196, s22, v196
    v_mfma_f32_16x16x32_bf16 v[152:155], a[248:251], v[228:231], v[152:155]
    ds_write_b64 v218, v[220:221] offset:7008
    v_mfma_f32_16x16x32_bf16 v[132:135], a[252:255], v[228:231], v[132:135]
    buffer_load_dwordx2 v[210:211], v215, s[4:7], s19 offen offset:768
    v_mfma_f32_16x16x32_bf16 v[136:139], v[240:243], v[228:231], v[136:139]
    v_and_b32 v198, s22, v198
    v_and_b32 v200, s22, v200
    v_mfma_f32_16x16x32_bf16 v[140:143], v[244:247], v[228:231], v[140:143]
    v_lshlrev_b32 v252, 16, v192
    v_and_b32 v192, s22, v192
    v_mfma_f32_16x16x32_bf16 v[156:159], a[228:231], v[228:231], v[156:159]
    s_waitcnt lgkmcnt(6)
    v_fmac_f32 v252, s25, v251
    v_fmac_f32 v192, s25, v200
    v_mfma_f32_16x16x32_bf16 v[156:159], a[240:243], v[232:235], v[156:159]
    v_fmac_f32 v252, s28, v249
    v_fmac_f32 v192, s28, v196
    v_mfma_f32_16x16x32_bf16 v[160:163], a[244:247], v[232:235], v[160:163]
    buffer_load_dwordx2 v[212:213], v215, s[4:7], s20 offen offset:768
    v_mfma_f32_16x16x32_bf16 v[160:163], a[232:235], v[228:231], v[160:163]
    v_cvt_pk_bf16_f32 v192, v252, v192
    v_lshlrev_b32 v252, 16, v202
    v_mfma_f32_16x16x32_bf16 v[164:167], a[236:239], v[228:231], v[164:167]
    ds_read_b128 v[228:231], v253 offset:38496
    v_and_b32 v202, s22, v202
    v_mfma_f32_16x16x32_bf16 v[164:167], a[248:251], v[232:235], v[164:167]
    v_fmac_f32 v252, s29, v248
    v_fmac_f32 v202, s29, v194
    v_mfma_f32_16x16x32_bf16 v[144:147], a[252:255], v[232:235], v[144:147]
    ds_read_b128 a[16:19], v6 offset:16608
    v_fmac_f32 v252, s23, v250
    v_mfma_f32_16x16x32_bf16 v[148:151], v[240:243], v[232:235], v[148:151]
    buffer_load_dwordx2 v[214:215], v215, s[4:7], s21 offen offset:768
    v_mfma_f32_16x16x32_bf16 v[152:155], v[244:247], v[232:235], v[152:155]
    v_fmac_f32 v202, s23, v198
    v_cvt_pk_bf16_f32 v202, v252, v202
    v_mfma_f32_16x16x32_bf16 v[168:171], a[228:231], v[232:235], v[168:171]
    s_waitcnt lgkmcnt(3)
    v_fma_f32 v252, v249, s24, v251
    v_fmac_f32 v251, -4.0, v249
    v_mfma_f32_16x16x32_bf16 v[168:171], a[240:243], v[236:239], v[168:171]
    v_fma_f32 v249, v248, s24, v250
    v_fmac_f32 v250, -4.0, v248
    v_mfma_f32_16x16x32_bf16 v[172:175], a[244:247], v[236:239], v[172:175]
    v_fma_f32 v248, v250, s26, v251
    v_fmac_f32 v251, s27, v250
    v_mfma_f32_16x16x32_bf16 v[172:175], a[232:235], v[232:235], v[172:175]
    buffer_store_dwordx4 a[4:7], v254, s[12:15], s44 offen nt
    s_add_u32 s44, s40, 2048
    v_fma_f32 v250, v249, 2.0, v252
    v_mfma_f32_16x16x32_bf16 v[176:179], a[236:239], v[232:235], v[176:179]
    ds_read_b128 v[232:235], v253 offset:38224
    v_fmac_f32 v252, -2.0, v249
    v_mfma_f32_16x16x32_bf16 v[176:179], a[248:251], v[236:239], v[176:179]
    s_mov_b32 s42, 1216512
    v_fma_f32 v249, v196, s24, v200
    v_mfma_f32_16x16x32_bf16 v[156:159], a[252:255], v[236:239], v[156:159]
    v_fmac_f32 v200, -4.0, v196
    v_fma_f32 v196, v194, s24, v198
    v_mfma_f32_16x16x32_bf16 v[160:163], v[240:243], v[236:239], v[160:163]
    v_fmac_f32 v198, -4.0, v194
    v_fma_f32 v194, v198, s26, v200
    v_mfma_f32_16x16x32_bf16 v[164:167], v[244:247], v[236:239], v[164:167]
    v_fmac_f32 v200, s27, v198
    v_fma_f32 v198, v196, 2.0, v249
    v_mfma_f32_16x16x32_bf16 v[180:183], a[228:231], v[236:239], v[180:183]
    buffer_load_dwordx4 a[228:231], v254, s[8:11], s42 offen offset:0 sc1
    v_mfma_f32_16x16x32_bf16 v[184:187], a[232:235], v[236:239], v[184:187]
    v_fmac_f32 v249, -2.0, v196
    v_cvt_pk_bf16_f32 v194, v248, v194
    v_mfma_f32_16x16x32_bf16 v[188:191], a[236:239], v[236:239], v[188:191]
    s_waitcnt lgkmcnt(2)
    v_cvt_pk_bf16_f32 v200, v251, v200
    v_cvt_pk_bf16_f32 v198, v250, v198
    v_mfma_f32_16x16x32_bf16 v[180:183], a[240:243], v[228:231], v[180:183]
    ds_read_b128 v[236:239], v253 offset:26000
    v_cvt_pk_bf16_f32 v196, v252, v249
    v_mfma_f32_16x16x32_bf16 v[184:187], a[244:247], v[228:231], v[184:187]
    buffer_load_dwordx4 a[232:235], v254, s[8:11], s42 offen offset:1024 sc1
    v_mfma_f32_16x16x32_bf16 v[188:191], a[248:251], v[228:231], v[188:191]
    ds_read_b128 a[20:23], v6 offset:17632
    v_lshlrev_b32 v248, 16, v195
    v_mfma_f32_16x16x32_bf16 v[168:171], a[252:255], v[228:231], v[168:171]
    s_waitcnt lgkmcnt(2)
    v_lshlrev_b32 v249, 16, v197
    v_lshlrev_b32 v250, 16, v199
    v_mfma_f32_16x16x32_bf16 v[172:175], v[240:243], v[228:231], v[172:175]
    buffer_load_dwordx4 a[236:239], v254, s[8:11], s42 offen offset:2048 sc1
    v_mfma_f32_16x16x32_bf16 v[176:179], v[244:247], v[228:231], v[176:179]
    ds_read_b128 v[228:231], v253 offset:25728
    v_lshlrev_b32 v251, 16, v201
    v_mfma_f32_16x16x32_bf16 v[180:183], a[252:255], v[232:235], v[180:183]
    s_mov_b32 s42, 1219584
    v_and_b32 v195, s22, v195
    v_and_b32 v197, s22, v197
    v_mfma_f32_16x16x32_bf16 v[184:187], v[240:243], v[232:235], v[184:187]
    s_waitcnt vmcnt(17) lgkmcnt(2)
    v_and_b32 v199, s22, v199
    v_and_b32 v201, s22, v201
    v_mfma_f32_16x16x32_bf16 v[188:191], v[244:247], v[232:235], v[188:191]
    ds_read_b128 v[232:235], v253 offset:25472
    v_lshlrev_b32 v252, 16, v193
sub32:
    v_mfma_f32_16x16x32_bf16 v[96:99], a[192:195], v[236:239], v[96:99]
    buffer_load_dwordx4 a[240:243], v254, s[8:11], s42 offen offset:0 sc1
    v_mfma_f32_16x16x32_bf16 v[100:103], a[196:199], v[236:239], v[100:103]
pad12:
    s_cbranch_vccnz warm_ret
    s_waitcnt vmcnt(15) lgkmcnt(1)
    v_and_b32 v193, s22, v193
    v_fmac_f32 v252, s25, v251
    v_mfma_f32_16x16x32_bf16 v[104:107], a[200:203], v[236:239], v[104:107]
    ds_read_b128 v[236:239], v253 offset:25216
    v_fmac_f32 v193, s25, v201
    v_mfma_f32_16x16x32_bf16 v[96:99], a[204:207], v[228:231], v[96:99]
    v_fmac_f32 v252, s28, v249
    v_fmac_f32 v193, s28, v197
    v_mfma_f32_16x16x32_bf16 v[100:103], a[208:211], v[228:231], v[100:103]
    buffer_load_dwordx4 a[244:247], v254, s[8:11], s42 offen offset:1024 sc1
    v_mfma_f32_16x16x32_bf16 v[104:107], a[212:215], v[228:231], v[104:107]
    ds_read_b128 a[24:27], v6 offset:18688
    v_cvt_pk_bf16_f32 v193, v252, v193
    v_mfma_f32_16x16x32_bf16 v[108:111], a[192:195], v[228:231], v[108:111]
    s_waitcnt lgkmcnt(2)
    v_lshlrev_b32 v252, 16, v203
    v_and_b32 v203, s22, v203
    v_mfma_f32_16x16x32_bf16 v[108:111], a[204:207], v[232:235], v[108:111]
    v_fmac_f32 v252, s29, v248
    v_fmac_f32 v203, s29, v195
    v_mfma_f32_16x16x32_bf16 v[112:115], a[208:211], v[232:235], v[112:115]
    buffer_load_dwordx4 a[248:251], v254, s[8:11], s42 offen offset:2048 sc1
    v_mfma_f32_16x16x32_bf16 v[112:115], a[196:199], v[228:231], v[112:115]
    s_mov_b32 s42, 1222656
    v_fmac_f32 v252, s23, v250
    v_fmac_f32 v203, s23, v199
    v_mfma_f32_16x16x32_bf16 v[116:119], a[200:203], v[228:231], v[116:119]
    ds_read_b128 v[228:231], v253 offset:24960
    v_cvt_pk_bf16_f32 v203, v252, v203
    v_mfma_f32_16x16x32_bf16 v[116:119], a[212:215], v[232:235], v[116:119]
    s_waitcnt vmcnt(14)
    v_fma_f32 v252, v249, s24, v251
    v_fmac_f32 v251, -4.0, v249
    v_mfma_f32_16x16x32_bf16 v[96:99], a[216:219], v[232:235], v[96:99]
    buffer_load_dwordx4 a[252:255], v254, s[8:11], s42 offen offset:0 sc1
    v_mfma_f32_16x16x32_bf16 v[100:103], a[220:223], v[232:235], v[100:103]
    v_fma_f32 v249, v248, s24, v250
    v_fmac_f32 v250, -4.0, v248
    v_mfma_f32_16x16x32_bf16 v[104:107], a[224:227], v[232:235], v[104:107]
    buffer_store_dwordx4 a[8:11], v254, s[12:15], s44 offen nt
    s_add_u32 s44, s40, 3072
    v_mfma_f32_16x16x32_bf16 v[120:123], a[192:195], v[232:235], v[120:123]
    s_waitcnt lgkmcnt(2)
    v_fma_f32 v248, v250, s26, v251
    v_fmac_f32 v251, s27, v250
    v_mfma_f32_16x16x32_bf16 v[120:123], a[204:207], v[236:239], v[120:123]
    buffer_load_dwordx4 v[240:243], v254, s[8:11], s42 offen offset:1024 sc1
    v_mfma_f32_16x16x32_bf16 v[124:127], a[208:211], v[236:239], v[124:127]
    v_fma_f32 v250, v249, 2.0, v252
    v_fmac_f32 v252, -2.0, v249
    v_mfma_f32_16x16x32_bf16 v[124:127], a[196:199], v[232:235], v[124:127]
    buffer_store_dwordx4 a[12:15], v254, s[12:15], s44 offen nt
    v_fma_f32 v249, v197, s24, v201
    v_fmac_f32 v201, -4.0, v197
    v_mfma_f32_16x16x32_bf16 v[128:131], a[200:203], v[232:235], v[128:131]
    ds_read_b128 v[232:235], v253 offset:26784
    s_add_u32 s44, s40, 4096
    v_mfma_f32_16x16x32_bf16 v[128:131], a[212:215], v[236:239], v[128:131]
    buffer_load_dwordx4 v[244:247], v254, s[8:11], s42 offen offset:2048 sc1
    v_mfma_f32_16x16x32_bf16 v[108:111], a[216:219], v[236:239], v[108:111]
    ds_read_b128 a[28:31], v6 offset:19712
    v_fma_f32 v197, v195, s24, v199
    v_mfma_f32_16x16x32_bf16 v[112:115], a[220:223], v[236:239], v[112:115]
    v_and_b32 v227, 0x7fff, v255
    v_fmac_f32 v199, -4.0, v195
    v_mfma_f32_16x16x32_bf16 v[116:119], a[224:227], v[236:239], v[116:119]
    buffer_load_dwordx2 v[216:217], v227, s[4:7], s16 offen offset:1152
    v_mfma_f32_16x16x32_bf16 v[132:135], a[192:195], v[236:239], v[132:135]
    s_waitcnt lgkmcnt(2)
    v_fma_f32 v195, v199, s26, v201
    v_fmac_f32 v201, s27, v199
    v_mfma_f32_16x16x32_bf16 v[132:135], a[204:207], v[228:231], v[132:135]
    v_fma_f32 v199, v197, 2.0, v249
    v_fmac_f32 v249, -2.0, v197
    v_mfma_f32_16x16x32_bf16 v[136:139], a[208:211], v[228:231], v[136:139]
    v_cvt_pk_bf16_f32 v195, v248, v195
    v_cvt_pk_bf16_f32 v201, v251, v201
    v_mfma_f32_16x16x32_bf16 v[136:139], a[196:199], v[236:239], v[136:139]
    v_cvt_pk_bf16_f32 v199, v250, v199
    v_cvt_pk_bf16_f32 v197, v252, v249
    v_mfma_f32_16x16x32_bf16 v[140:143], a[200:203], v[236:239], v[140:143]
    ds_read_b128 v[236:239], v253 offset:26528
    v_lshrrev_b32 v252, 15, v255
    v_mfma_f32_16x16x32_bf16 v[140:143], a[212:215], v[228:231], v[140:143]
    buffer_load_dwordx2 v[218:219], v227, s[4:7], s17 offen offset:1152
    v_mfma_f32_16x16x32_bf16 v[120:123], a[216:219], v[228:231], v[120:123]
    ds_write_b64 v252, v[194:195] offset:512
    v_mfma_f32_16x16x32_bf16 v[124:127], a[220:223], v[228:231], v[124:127]
    s_waitcnt vmcnt(14)
    v_lshrrev_b32 v194, 15, v255
    v_lshlrev_b32 v248, 16, v206
    v_mfma_f32_16x16x32_bf16 v[128:131], a[224:227], v[228:231], v[128:131]
    ds_write_b64 v194, v[200:201] offset:2592
    v_mfma_f32_16x16x32_bf16 v[144:147], a[192:195], v[228:231], v[144:147]
    s_waitcnt lgkmcnt(4)
    v_lshlrev_b32 v249, 16, v208
    v_lshlrev_b32 v250, 16, v210
    v_mfma_f32_16x16x32_bf16 v[144:147], a[204:207], v[232:235], v[144:147]
    buffer_load_dwordx2 v[220:221], v227, s[4:7], s18 offen offset:1152
    v_mfma_f32_16x16x32_bf16 v[148:151], a[208:211], v[232:235], v[148:151]
    ds_read_b128 a[32:35], v6 offset:20736
    v_lshlrev_b32 v251, 16, v212
    v_mfma_f32_16x16x32_bf16 v[148:151], a[196:199], v[228:231], v[148:151]
    ds_write_b64 v194, v[198:199] offset:4672
    v_mfma_f32_16x16x32_bf16 v[152:155], a[200:203], v[228:231], v[152:155]
    ds_read_b128 v[228:231], v253 offset:26272
    v_and_b32 v206, s22, v206
    v_mfma_f32_16x16x32_bf16 v[152:155], a[212:215], v[232:235], v[152:155]
    ds_write_b64 v194, v[192:193] offset:33792
    v_mfma_f32_16x16x32_bf16 v[132:135], a[216:219], v[232:235], v[132:135]
    buffer_load_dwordx2 v[222:223], v227, s[4:7], s19 offen offset:1152
    v_mfma_f32_16x16x32_bf16 v[136:139], a[220:223], v[232:235], v[136:139]
    ds_write_b64 v194, v[202:203] offset:35872
    v_mfma_f32_16x16x32_bf16 v[140:143], a[224:227], v[232:235], v[140:143]
    v_and_b32 v208, s22, v208
    v_and_b32 v210, s22, v210
    v_mfma_f32_16x16x32_bf16 v[156:159], a[192:195], v[232:235], v[156:159]
    s_waitcnt lgkmcnt(7)
    v_and_b32 v212, s22, v212
    v_lshlrev_b32 v252, 16, v204
    v_mfma_f32_16x16x32_bf16 v[156:159], a[204:207], v[236:239], v[156:159]
    ds_write_b64 v194, v[196:197] offset:6752
    v_mfma_f32_16x16x32_bf16 v[160:163], a[208:211], v[236:239], v[160:163]
    buffer_load_dwordx2 v[224:225], v227, s[4:7], s20 offen offset:1152
    v_mfma_f32_16x16x32_bf16 v[160:163], a[196:199], v[232:235], v[160:163]
    ds_read_b128 v[192:195], v253 offset:39520
    s_mov_b32 s45, 573637648
    v_mfma_f32_16x16x32_bf16 v[164:167], a[200:203], v[232:235], v[164:167]
    ds_read_b128 v[232:235], v253 offset:26016
    v_bfe_u32 v196, v254, 5, 3
    v_mfma_f32_16x16x32_bf16 v[164:167], a[212:215], v[236:239], v[164:167]
    ds_read_b128 a[36:39], v6 offset:21792
    v_mul_u32_u24 v197, 5, v196
    v_mfma_f32_16x16x32_bf16 v[144:147], a[216:219], v[236:239], v[144:147]
    v_bfe_u32 v197, s45, v197, 5
    v_mul_u32_u24 v197, 65, v197
    v_mfma_f32_16x16x32_bf16 v[148:151], a[220:223], v[236:239], v[148:151]
    buffer_load_dwordx2 v[226:227], v227, s[4:7], s21 offen offset:1152
    v_mfma_f32_16x16x32_bf16 v[152:155], a[224:227], v[236:239], v[152:155]
    v_sub_u32 v197, v197, v196
    v_lshl_add_u32 v196, v197, 5, v253
    v_mfma_f32_16x16x32_bf16 v[168:171], a[192:195], v[236:239], v[168:171]
    s_waitcnt lgkmcnt(6)
    s_waitcnt lgkmcnt(2)
    v_and_b32 v204, s22, v204
    v_mfma_f32_16x16x32_bf16 v[168:171], a[204:207], v[228:231], v[168:171]
    s_mov_b64 exec, s[46:47]
    ds_write_b128 v196, v[192:195] offset:1024
    s_mov_b64 exec, -1
    v_mfma_f32_16x16x32_bf16 v[172:175], a[208:211], v[228:231], v[172:175]
    v_fmac_f32 v252, s25, v251
    v_fmac_f32 v204, s25, v212
    v_mfma_f32_16x16x32_bf16 v[172:175], a[196:199], v[236:239], v[172:175]
    buffer_store_dwordx4 a[16:19], v254, s[12:15], s44 offen nt
    s_add_u32 s44, s40, 5120
    v_mfma_f32_16x16x32_bf16 v[176:179], a[200:203], v[236:239], v[176:179]
    ds_read_b128 v[236:239], v253 offset:25744
    v_fmac_f32 v252, s28, v249
    v_mfma_f32_16x16x32_bf16 v[176:179], a[212:215], v[228:231], v[176:179]
    s_mov_b32 s42, 1253376
    v_fmac_f32 v204, s28, v208
    v_cvt_pk_bf16_f32 v204, v252, v204
    v_mfma_f32_16x16x32_bf16 v[156:159], a[216:219], v[228:231], v[156:159]
    buffer_store_dwordx4 a[20:23], v254, s[12:15], s44 offen nt
    v_lshlrev_b32 v252, 16, v214
    v_and_b32 v214, s22, v214
    v_mfma_f32_16x16x32_bf16 v[160:163], a[220:223], v[228:231], v[160:163]
    v_fmac_f32 v252, s29, v248
    v_fmac_f32 v214, s29, v206
    v_mfma_f32_16x16x32_bf16 v[164:167], a[224:227], v[228:231], v[164:167]
    v_fmac_f32 v252, s23, v250
    v_fmac_f32 v214, s23, v210
    v_mfma_f32_16x16x32_bf16 v[180:183], a[192:195], v[228:231], v[180:183]
    buffer_load_dwordx4 a[96:99], v254, s[8:11], s42 offen offset:0 sc1
    v_mfma_f32_16x16x32_bf16 v[184:187], a[196:199], v[228:231], v[184:187]
    ds_read_b128 a[40:43], v6 offset:22816
    s_add_u32 s44, s40, 6144
    v_mfma_f32_16x16x32_bf16 v[188:191], a[200:203], v[228:231], v[188:191]
    s_waitcnt lgkmcnt(4)
    v_cvt_pk_bf16_f32 v214, v252, v214
    v_fma_f32 v252, v249, s24, v251
    v_mfma_f32_16x16x32_bf16 v[180:183], a[204:207], v[232:235], v[180:183]
    ds_read_b128 v[228:231], v253 offset:28080
    v_fmac_f32 v251, -4.0, v249
    v_mfma_f32_16x16x32_bf16 v[184:187], a[208:211], v[232:235], v[184:187]
    buffer_load_dwordx4 a[100:103], v254, s[8:11], s42 offen offset:1024 sc1
    v_mfma_f32_16x16x32_bf16 v[188:191], a[212:215], v[232:235], v[188:191]
    v_fma_f32 v249, v248, s24, v250
    v_fmac_f32 v250, -4.0, v248
    v_mfma_f32_16x16x32_bf16 v[168:171], a[216:219], v[232:235], v[168:171]
    s_waitcnt lgkmcnt(2)
    v_fma_f32 v248, v250, s26, v251
    v_fmac_f32 v251, s27, v250
    v_mfma_f32_16x16x32_bf16 v[172:175], a[220:223], v[232:235], v[172:175]
    buffer_load_dwordx4 a[104:107], v254, s[8:11], s42 offen offset:2048 sc1
    v_mfma_f32_16x16x32_bf16 v[176:179], a[224:227], v[232:235], v[176:179]
    ds_read_b128 v[232:235], v253 offset:27808
    v_mfma_f32_16x16x32_bf16 v[180:183], a[216:219], v[236:239], v[180:183]
    s_mov_b32 s42, 1256448
    v_fma_f32 v250, v249, 2.0, v252
    v_fmac_f32 v252, -2.0, v249
    v_mfma_f32_16x16x32_bf16 v[184:187], a[220:223], v[236:239], v[184:187]
    s_waitcnt vmcnt(19) lgkmcnt(1)
    v_fma_f32 v249, v208, s24, v212
    v_fmac_f32 v212, -4.0, v208
    v_mfma_f32_16x16x32_bf16 v[188:191], a[224:227], v[236:239], v[188:191]
    ds_read_b128 v[236:239], v253 offset:27552
    v_fma_f32 v208, v206, s24, v210
sub33:
    v_mfma_f32_16x16x32_bf16 v[96:99], a[228:231], v[228:231], v[96:99]
    buffer_load_dwordx4 a[108:111], v254, s[8:11], s42 offen offset:0 sc1
    v_mfma_f32_16x16x32_bf16 v[100:103], a[232:235], v[228:231], v[100:103]
    s_waitcnt vmcnt(17) lgkmcnt(1)
    v_fmac_f32 v210, -4.0, v206
    v_fma_f32 v206, v210, s26, v212
    v_mfma_f32_16x16x32_bf16 v[104:107], a[236:239], v[228:231], v[104:107]
    ds_read_b128 v[228:231], v253 offset:27296
    v_fmac_f32 v212, s27, v210
    v_mfma_f32_16x16x32_bf16 v[96:99], a[240:243], v[232:235], v[96:99]
    ds_read_b128 a[44:47], v6 offset:23840
    v_fma_f32 v210, v208, 2.0, v249
    v_mfma_f32_16x16x32_bf16 v[100:103], a[244:247], v[232:235], v[100:103]
    buffer_load_dwordx4 a[112:115], v254, s[8:11], s42 offen offset:1024 sc1
    v_mfma_f32_16x16x32_bf16 v[104:107], a[248:251], v[232:235], v[104:107]
    v_fmac_f32 v249, -2.0, v208
    v_cvt_pk_bf16_f32 v206, v248, v206
    v_mfma_f32_16x16x32_bf16 v[108:111], a[228:231], v[232:235], v[108:111]
    s_waitcnt lgkmcnt(2)
    v_cvt_pk_bf16_f32 v212, v251, v212
    v_cvt_pk_bf16_f32 v210, v250, v210
    v_mfma_f32_16x16x32_bf16 v[108:111], a[240:243], v[236:239], v[108:111]
    v_cvt_pk_bf16_f32 v208, v252, v249
    v_lshlrev_b32 v248, 16, v207
    v_mfma_f32_16x16x32_bf16 v[112:115], a[244:247], v[236:239], v[112:115]
    buffer_load_dwordx4 a[116:119], v254, s[8:11], s42 offen offset:2048 sc1
    v_mfma_f32_16x16x32_bf16 v[112:115], a[232:235], v[232:235], v[112:115]
    s_mov_b32 s42, 1259520
    v_lshlrev_b32 v249, 16, v209
    v_lshlrev_b32 v250, 16, v211
    v_mfma_f32_16x16x32_bf16 v[116:119], a[236:239], v[232:235], v[116:119]
    ds_read_b128 v[232:235], v253 offset:27040
    v_lshlrev_b32 v251, 16, v213
    v_mfma_f32_16x16x32_bf16 v[116:119], a[248:251], v[236:239], v[116:119]
    s_waitcnt vmcnt(14)
    v_and_b32 v207, s22, v207
    v_and_b32 v209, s22, v209
    v_mfma_f32_16x16x32_bf16 v[96:99], a[252:255], v[236:239], v[96:99]
    buffer_load_dwordx4 a[120:123], v254, s[8:11], s42 offen offset:0 sc1
    v_mfma_f32_16x16x32_bf16 v[100:103], v[240:243], v[236:239], v[100:103]
    v_and_b32 v211, s22, v211
    v_and_b32 v213, s22, v213
    v_mfma_f32_16x16x32_bf16 v[104:107], v[244:247], v[236:239], v[104:107]
    buffer_store_dwordx4 a[24:27], v254, s[12:15], s44 offen nt
    s_add_u32 s44, s40, 7168
    v_lshlrev_b32 v252, 16, v205
    v_mfma_f32_16x16x32_bf16 v[120:123], a[228:231], v[236:239], v[120:123]
    s_waitcnt lgkmcnt(2)
    v_and_b32 v205, s22, v205
    v_fmac_f32 v252, s25, v251
    v_mfma_f32_16x16x32_bf16 v[120:123], a[240:243], v[228:231], v[120:123]
    buffer_load_dwordx4 a[124:127], v254, s[8:11], s42 offen offset:1024 sc1
    v_mfma_f32_16x16x32_bf16 v[124:127], a[244:247], v[228:231], v[124:127]
    v_fmac_f32 v205, s25, v213
    v_fmac_f32 v252, s28, v249
    v_mfma_f32_16x16x32_bf16 v[124:127], a[232:235], v[236:239], v[124:127]
    v_fmac_f32 v205, s28, v209
    v_cvt_pk_bf16_f32 v205, v252, v205
    v_mfma_f32_16x16x32_bf16 v[128:131], a[236:239], v[236:239], v[128:131]
    ds_read_b128 v[236:239], v253 offset:28864
    v_lshlrev_b32 v252, 16, v215
    v_mfma_f32_16x16x32_bf16 v[128:131], a[248:251], v[228:231], v[128:131]
    buffer_load_dwordx4 a[128:131], v254, s[8:11], s42 offen offset:2048 sc1
    v_mfma_f32_16x16x32_bf16 v[108:111], a[252:255], v[228:231], v[108:111]
    s_mov_b32 s42, 1290240
    v_and_b32 v215, s22, v215
    v_fmac_f32 v252, s29, v248
    v_mfma_f32_16x16x32_bf16 v[112:115], v[240:243], v[228:231], v[112:115]
    v_fmac_f32 v215, s29, v207
    v_fmac_f32 v252, s23, v250
    v_mfma_f32_16x16x32_bf16 v[116:119], v[244:247], v[228:231], v[116:119]
    s_waitcnt lgkmcnt(1)
    v_fmac_f32 v215, s23, v211
    v_cvt_pk_bf16_f32 v215, v252, v215
    v_mfma_f32_16x16x32_bf16 v[132:135], a[228:231], v[228:231], v[132:135]
    buffer_load_dwordx4 a[132:135], v254, s[8:11], s42 offen offset:0 sc1
    v_mfma_f32_16x16x32_bf16 v[132:135], a[240:243], v[232:235], v[132:135]
    ds_read_b128 a[48:51], v253 offset:30160
    v_fma_f32 v252, v249, s24, v251
    v_mfma_f32_16x16x32_bf16 v[136:139], a[244:247], v[232:235], v[136:139]
    v_fmac_f32 v251, -4.0, v249
    v_fma_f32 v249, v248, s24, v250
    v_mfma_f32_16x16x32_bf16 v[136:139], a[232:235], v[228:231], v[136:139]
    buffer_load_dwordx4 a[136:139], v254, s[8:11], s42 offen offset:1024 sc1
    v_mfma_f32_16x16x32_bf16 v[140:143], a[236:239], v[228:231], v[140:143]
    ds_read_b128 v[228:231], v253 offset:28608
    v_fmac_f32 v250, -4.0, v248
    v_mfma_f32_16x16x32_bf16 v[140:143], a[248:251], v[232:235], v[140:143]
    ds_read_b128 a[64:67], v253 offset:32240
    v_fma_f32 v248, v250, s26, v251
    v_mfma_f32_16x16x32_bf16 v[120:123], a[252:255], v[232:235], v[120:123]
    s_waitcnt lgkmcnt(3)
    v_fmac_f32 v251, s27, v250
    v_fma_f32 v250, v249, 2.0, v252
    v_mfma_f32_16x16x32_bf16 v[124:127], v[240:243], v[232:235], v[124:127]
    buffer_load_dwordx4 a[140:143], v254, s[8:11], s42 offen offset:2048 sc1
    v_mfma_f32_16x16x32_bf16 v[128:131], v[244:247], v[232:235], v[128:131]
    s_mov_b32 s42, 1293312
    v_fmac_f32 v252, -2.0, v249
    v_fma_f32 v249, v209, s24, v213
    v_mfma_f32_16x16x32_bf16 v[144:147], a[228:231], v[232:235], v[144:147]
    ds_read_b128 a[52:55], v253 offset:29888
    v_fmac_f32 v213, -4.0, v209
    v_mfma_f32_16x16x32_bf16 v[144:147], a[240:243], v[236:239], v[144:147]
    v_fma_f32 v209, v207, s24, v211
    v_fmac_f32 v211, -4.0, v207
    v_mfma_f32_16x16x32_bf16 v[148:151], a[244:247], v[236:239], v[148:151]
    buffer_load_dwordx4 a[144:147], v254, s[8:11], s42 offen offset:0 sc1
    v_mfma_f32_16x16x32_bf16 v[148:151], a[232:235], v[232:235], v[148:151]
    v_fma_f32 v207, v211, s26, v213
    v_fmac_f32 v213, s27, v211
    v_mfma_f32_16x16x32_bf16 v[152:155], a[236:239], v[232:235], v[152:155]
    ds_read_b128 v[232:235], v253 offset:28352
    v_fma_f32 v211, v209, 2.0, v249
    v_mfma_f32_16x16x32_bf16 v[152:155], a[248:251], v[236:239], v[152:155]
    ds_read_b128 a[68:71], v253 offset:31968
    v_fmac_f32 v249, -2.0, v209
    v_mfma_f32_16x16x32_bf16 v[132:135], a[252:255], v[236:239], v[132:135]
    buffer_load_dwordx4 a[148:151], v254, s[8:11], s42 offen offset:1024 sc1
    v_mfma_f32_16x16x32_bf16 v[136:139], v[240:243], v[236:239], v[136:139]
    v_cvt_pk_bf16_f32 v207, v248, v207
    v_cvt_pk_bf16_f32 v213, v251, v213
    v_mfma_f32_16x16x32_bf16 v[140:143], v[244:247], v[236:239], v[140:143]
    s_waitcnt lgkmcnt(4)
    v_cvt_pk_bf16_f32 v211, v250, v211
    v_cvt_pk_bf16_f32 v209, v252, v249
    v_mfma_f32_16x16x32_bf16 v[156:159], a[228:231], v[236:239], v[156:159]
    ds_read_b128 a[56:59], v253 offset:29632
    v_lshrrev_b32 v252, 15, v255
    v_mfma_f32_16x16x32_bf16 v[156:159], a[240:243], v[228:231], v[156:159]
    buffer_load_dwordx4 a[152:155], v254, s[8:11], s42 offen offset:2048 sc1
    v_mfma_f32_16x16x32_bf16 v[160:163], a[244:247], v[228:231], v[160:163]
    s_mov_b32 s42, 1296384
    v_mfma_f32_16x16x32_bf16 v[160:163], a[232:235], v[236:239], v[160:163]
    ds_write_b64 v252, v[206:207] offset:256
    s_waitcnt vmcnt(18)
    v_mfma_f32_16x16x32_bf16 v[164:167], a[236:239], v[236:239], v[164:167]
    ds_read_b128 v[236:239], v253 offset:28096
    v_lshrrev_b32 v206, 15, v255
    v_mfma_f32_16x16x32_bf16 v[164:167], a[248:251], v[228:231], v[164:167]
    buffer_load_dwordx4 a[156:159], v254, s[8:11], s42 offen offset:0 sc1
    v_mfma_f32_16x16x32_bf16 v[144:147], a[252:255], v[228:231], v[144:147]
    ds_read_b128 a[72:75], v253 offset:31712
    v_lshlrev_b32 v248, 16, v218
    v_mfma_f32_16x16x32_bf16 v[148:151], v[240:243], v[228:231], v[148:151]
    ds_write_b64 v206, v[212:213] offset:2336
    v_lshlrev_b32 v249, 16, v220
    v_mfma_f32_16x16x32_bf16 v[152:155], v[244:247], v[228:231], v[152:155]
    s_waitcnt lgkmcnt(6)
    v_lshlrev_b32 v250, 16, v222
    v_lshlrev_b32 v251, 16, v224
    v_mfma_f32_16x16x32_bf16 v[168:171], a[228:231], v[228:231], v[168:171]
    buffer_load_dwordx4 a[160:163], v254, s[8:11], s42 offen offset:1024 sc1
    v_mfma_f32_16x16x32_bf16 v[168:171], a[240:243], v[232:235], v[168:171]
    ds_read_b128 a[60:63], v253 offset:29376
    v_and_b32 v218, s22, v218
    v_mfma_f32_16x16x32_bf16 v[172:175], a[244:247], v[232:235], v[172:175]
    ds_write_b64 v206, v[210:211] offset:4416
    v_and_b32 v220, s22, v220
    v_mfma_f32_16x16x32_bf16 v[172:175], a[232:235], v[228:231], v[172:175]
    buffer_store_dwordx4 a[28:31], v254, s[12:15], s44 offen nt
    s_add_u32 s44, s40, 8192
    v_mfma_f32_16x16x32_bf16 v[176:179], a[236:239], v[228:231], v[176:179]
    ds_read_b128 v[228:231], v253 offset:27824
    v_and_b32 v222, s22, v222
    v_mfma_f32_16x16x32_bf16 v[176:179], a[248:251], v[232:235], v[176:179]
    buffer_load_dwordx4 a[164:167], v254, s[8:11], s42 offen offset:2048 sc1
    v_and_b32 v224, s22, v224
    v_mfma_f32_16x16x32_bf16 v[156:159], a[252:255], v[232:235], v[156:159]
    s_add_u32 s42, s36, 0
    v_lshlrev_b32 v252, 16, v216
    v_and_b32 v216, s22, v216
    v_mfma_f32_16x16x32_bf16 v[160:163], v[240:243], v[232:235], v[160:163]
    ds_read_b128 a[76:79], v253 offset:31456
    v_fmac_f32 v252, s25, v251
    v_mfma_f32_16x16x32_bf16 v[164:167], v[244:247], v[232:235], v[164:167]
    s_waitcnt lgkmcnt(6)
    v_fmac_f32 v216, s25, v224
    v_fmac_f32 v252, s28, v249
    v_mfma_f32_16x16x32_bf16 v[180:183], a[228:231], v[232:235], v[180:183]
    buffer_load_dwordx4 a[192:195], v254, s[8:11], s42 offen offset:0 sc1
    v_fmac_f32 v216, s28, v220
    v_mfma_f32_16x16x32_bf16 v[184:187], a[232:235], v[232:235], v[184:187]
    s_waitcnt lgkmcnt(0)
    v_cvt_pk_bf16_f32 v216, v252, v216
    v_lshlrev_b32 v252, 16, v226
    v_mfma_f32_16x16x32_bf16 v[188:191], a[236:239], v[232:235], v[188:191]
    s_barrier
    v_mfma_f32_16x16x32_bf16 v[180:183], a[240:243], v[236:239], v[180:183]
    ds_write_b64 v206, v[204:205] offset:33536
    v_and_b32 v226, s22, v226
    v_mfma_f32_16x16x32_bf16 v[184:187], a[244:247], v[236:239], v[184:187]
    buffer_load_dwordx4 a[196:199], v254, s[8:11], s42 offen offset:1024 sc1
    v_mfma_f32_16x16x32_bf16 v[188:191], a[248:251], v[236:239], v[188:191]
    ds_write_b64 v206, v[214:215] offset:35616
    v_mfma_f32_16x16x32_bf16 v[168:171], a[252:255], v[236:239], v[168:171]
    v_fmac_f32 v252, s29, v248
    v_fmac_f32 v226, s29, v218
    v_mfma_f32_16x16x32_bf16 v[172:175], v[240:243], v[236:239], v[172:175]
    buffer_load_dwordx4 a[200:203], v254, s[8:11], s42 offen offset:2048 sc1
    v_fmac_f32 v252, s23, v250
    v_mfma_f32_16x16x32_bf16 v[176:179], v[244:247], v[236:239], v[176:179]
    s_add_u32 s42, s36, 3072
    v_fmac_f32 v226, s23, v222
    v_cvt_pk_bf16_f32 v226, v252, v226
    v_mfma_f32_16x16x32_bf16 v[180:183], a[252:255], v[228:231], v[180:183]
    ds_write_b64 v206, v[208:209] offset:6496
    v_mfma_f32_16x16x32_bf16 v[184:187], v[240:243], v[228:231], v[184:187]
    v_fma_f32 v252, v249, s24, v251
    v_fmac_f32 v251, -4.0, v249
    v_mfma_f32_16x16x32_bf16 v[188:191], v[244:247], v[228:231], v[188:191]
    s_waitcnt vmcnt(17)
    v_fma_f32 v249, v248, s24, v250
    v_fmac_f32 v250, -4.0, v248
    v_fma_f32 v248, v250, s26, v251
sub34:
    v_mfma_f32_16x16x32_bf16 v[96:99], a[96:99], a[48:51], v[96:99]
    buffer_load_dwordx4 a[204:207], v254, s[8:11], s42 offen offset:0 sc1
    v_mfma_f32_16x16x32_bf16 v[96:99], a[108:111], a[52:55], v[96:99]
    s_waitcnt vmcnt(14)
    v_fmac_f32 v251, s27, v250
    v_fma_f32 v250, v249, 2.0, v252
    v_mfma_f32_16x16x32_bf16 v[96:99], a[120:123], a[56:59], v[96:99]
    v_fmac_f32 v252, -2.0, v249
    v_fma_f32 v249, v220, s24, v224
    v_fmac_f32 v224, -4.0, v220
    v_mfma_f32_16x16x32_bf16 v[100:103], a[124:127], a[56:59], v[100:103]
    v_fma_f32 v220, v218, s24, v222
    v_fmac_f32 v222, -4.0, v218
    v_mfma_f32_16x16x32_bf16 v[100:103], a[112:115], a[52:55], v[100:103]
    buffer_load_dwordx4 a[208:211], v254, s[8:11], s42 offen offset:1024 sc1
    v_mfma_f32_16x16x32_bf16 v[100:103], a[100:103], a[48:51], v[100:103]
    v_fma_f32 v218, v222, s26, v224
    v_fmac_f32 v224, s27, v222
    v_mfma_f32_16x16x32_bf16 v[104:107], a[104:107], a[48:51], v[104:107]
    ds_read_b128 a[48:51], v253 offset:29120
    v_fma_f32 v222, v220, 2.0, v249
    v_fmac_f32 v249, -2.0, v220
    v_mfma_f32_16x16x32_bf16 v[104:107], a[116:119], a[52:55], v[104:107]
    v_cvt_pk_bf16_f32 v218, v248, v218
    v_cvt_pk_bf16_f32 v224, v251, v224
    v_mfma_f32_16x16x32_bf16 v[104:107], a[128:131], a[56:59], v[104:107]
    buffer_load_dwordx4 a[212:215], v254, s[8:11], s42 offen offset:2048 sc1
    v_mfma_f32_16x16x32_bf16 v[108:111], a[96:99], a[52:55], v[108:111]
    s_add_u32 s42, s36, 6144
    v_cvt_pk_bf16_f32 v222, v250, v222
    v_cvt_pk_bf16_f32 v220, v252, v249
    v_mfma_f32_16x16x32_bf16 v[108:111], a[108:111], a[56:59], v[108:111]
    v_lshlrev_b32 v248, 16, v219
    v_lshlrev_b32 v249, 16, v221
    v_lshlrev_b32 v250, 16, v223
    v_mfma_f32_16x16x32_bf16 v[108:111], a[120:123], a[60:63], v[108:111]
    v_lshlrev_b32 v251, 16, v225
    v_and_b32 v219, s22, v219
    v_mfma_f32_16x16x32_bf16 v[112:115], a[124:127], a[60:63], v[112:115]
    buffer_load_dwordx4 a[216:219], v254, s[8:11], s42 offen offset:0 sc1
    v_mfma_f32_16x16x32_bf16 v[112:115], a[112:115], a[56:59], v[112:115]
    v_and_b32 v221, s22, v221
    v_and_b32 v223, s22, v223
    v_and_b32 v225, s22, v225
    v_mfma_f32_16x16x32_bf16 v[112:115], a[100:103], a[52:55], v[112:115]
    buffer_store_dwordx4 a[32:35], v254, s[12:15], s44 offen nt
    s_add_u32 s44, s40, 9216
    v_mfma_f32_16x16x32_bf16 v[116:119], a[104:107], a[52:55], v[116:119]
    ds_read_b128 a[52:55], v253 offset:30944
    v_lshlrev_b32 v252, 16, v217
    v_mfma_f32_16x16x32_bf16 v[116:119], a[116:119], a[56:59], v[116:119]
    buffer_load_dwordx4 a[220:223], v254, s[8:11], s42 offen offset:1024 sc1
    v_mfma_f32_16x16x32_bf16 v[116:119], a[128:131], a[60:63], v[116:119]
    s_waitcnt vmcnt(16)
    v_and_b32 v217, s22, v217
    v_fmac_f32 v252, s25, v251
    v_fmac_f32 v217, s25, v225
    v_mfma_f32_16x16x32_bf16 v[96:99], a[132:135], a[64:67], v[96:99]
    s_waitcnt vmcnt(13)
    v_fmac_f32 v252, s28, v249
    v_fmac_f32 v217, s28, v221
    v_mfma_f32_16x16x32_bf16 v[96:99], a[144:147], a[68:71], v[96:99]
    s_waitcnt vmcnt(9)
    v_cvt_pk_bf16_f32 v217, v252, v217
    v_lshlrev_b32 v252, 16, v227
    v_mfma_f32_16x16x32_bf16 v[96:99], a[156:159], a[72:75], v[96:99]
    buffer_load_dwordx4 a[224:227], v254, s[8:11], s42 offen offset:2048 sc1
    v_mfma_f32_16x16x32_bf16 v[100:103], a[160:163], a[72:75], v[100:103]
    v_and_b32 v227, s22, v227
    v_fmac_f32 v252, s29, v248
    v_fmac_f32 v227, s29, v219
    v_mfma_f32_16x16x32_bf16 v[100:103], a[148:151], a[68:71], v[100:103]
    buffer_store_dwordx4 a[36:39], v254, s[12:15], s44 offen nt
    v_and_b32 v203, 0x7fff, v255
    s_add_u32 s44, s40, 10240
    v_mfma_f32_16x16x32_bf16 v[100:103], a[136:139], a[64:67], v[100:103]
    buffer_load_dwordx2 v[192:193], v203, s[4:7], s16 offen offset:64
    v_mfma_f32_16x16x32_bf16 v[104:107], a[140:143], a[64:67], v[104:107]
    ds_read_b128 a[64:67], v253 offset:31200
    v_fmac_f32 v252, s23, v250
    v_mfma_f32_16x16x32_bf16 v[104:107], a[152:155], a[68:71], v[104:107]
    v_fmac_f32 v227, s23, v223
    v_cvt_pk_bf16_f32 v227, v252, v227
    v_mfma_f32_16x16x32_bf16 v[104:107], a[164:167], a[72:75], v[104:107]
    v_fma_f32 v252, v249, s24, v251
    v_fmac_f32 v251, -4.0, v249
    v_mfma_f32_16x16x32_bf16 v[108:111], a[132:135], a[68:71], v[108:111]
    v_fma_f32 v249, v248, s24, v250
    v_fmac_f32 v250, -4.0, v248
    v_mfma_f32_16x16x32_bf16 v[108:111], a[144:147], a[72:75], v[108:111]
    v_fma_f32 v248, v250, s26, v251
    v_fmac_f32 v251, s27, v250
    v_fma_f32 v250, v249, 2.0, v252
    v_mfma_f32_16x16x32_bf16 v[108:111], a[156:159], a[76:79], v[108:111]
    buffer_load_dwordx2 v[194:195], v203, s[4:7], s17 offen offset:64
    v_mfma_f32_16x16x32_bf16 v[112:115], a[160:163], a[76:79], v[112:115]
    v_fmac_f32 v252, -2.0, v249
    v_fma_f32 v249, v221, s24, v225
    v_mfma_f32_16x16x32_bf16 v[112:115], a[148:151], a[72:75], v[112:115]
    v_cvt_pk_bf16_f32 v96, v96, v97
    v_cvt_pk_bf16_f32 v97, v98, v99
    v_fmac_f32 v225, -4.0, v221
    v_mfma_f32_16x16x32_bf16 v[112:115], a[136:139], a[68:71], v[112:115]
    v_cvt_pk_bf16_f32 v98, v100, v101
    v_cvt_pk_bf16_f32 v99, v102, v103
    v_mfma_f32_16x16x32_bf16 v[116:119], a[140:143], a[68:71], v[116:119]
    ds_read_b128 a[68:71], v253 offset:33024
    v_fma_f32 v221, v219, s24, v223
    v_mfma_f32_16x16x32_bf16 v[116:119], a[152:155], a[72:75], v[116:119]
    buffer_load_dwordx2 v[196:197], v203, s[4:7], s18 offen offset:64
    v_mfma_f32_16x16x32_bf16 v[116:119], a[164:167], a[76:79], v[116:119]
    ds_write_b128 v4, v[96:99] offset:16640
    v_fmac_f32 v223, -4.0, v219
    v_mfma_f32_16x16x32_bf16 v[120:123], a[96:99], a[56:59], v[120:123]
    v_fma_f32 v219, v223, s26, v225
    v_fmac_f32 v225, s27, v223
    v_mfma_f32_16x16x32_bf16 v[120:123], a[108:111], a[60:63], v[120:123]
    s_waitcnt lgkmcnt(4)
    v_cvt_pk_bf16_f32 v104, v104, v105
    v_cvt_pk_bf16_f32 v105, v106, v107
    v_mfma_f32_16x16x32_bf16 v[120:123], a[120:123], a[48:51], v[120:123]
    v_fma_f32 v223, v221, 2.0, v249
    v_fmac_f32 v249, -2.0, v221
    v_mfma_f32_16x16x32_bf16 v[120:123], a[132:135], a[72:75], v[120:123]
    buffer_load_dwordx2 v[198:199], v203, s[4:7], s19 offen offset:64
    v_cvt_pk_bf16_f32 v219, v248, v219
    v_mfma_f32_16x16x32_bf16 v[120:123], a[144:147], a[76:79], v[120:123]
    s_waitcnt lgkmcnt(2)
    v_cvt_pk_bf16_f32 v108, v108, v109
    v_cvt_pk_bf16_f32 v109, v110, v111
    v_mfma_f32_16x16x32_bf16 v[120:123], a[156:159], a[64:67], v[120:123]
    ds_write_b64 v5, v[104:105] offset:16704
    v_mfma_f32_16x16x32_bf16 v[124:127], a[160:163], a[64:67], v[124:127]
    v_cvt_pk_bf16_f32 v110, v112, v113
    v_cvt_pk_bf16_f32 v111, v114, v115
    v_cvt_pk_bf16_f32 v225, v251, v225
    v_mfma_f32_16x16x32_bf16 v[124:127], a[148:151], a[76:79], v[124:127]
    ds_write_b128 v4, v[108:111] offset:17024
    v_mfma_f32_16x16x32_bf16 v[124:127], a[136:139], a[72:75], v[124:127]
    buffer_load_dwordx2 v[200:201], v203, s[4:7], s20 offen offset:64
    v_mfma_f32_16x16x32_bf16 v[124:127], a[124:127], a[48:51], v[124:127]
    v_cvt_pk_bf16_f32 v223, v250, v223
    v_cvt_pk_bf16_f32 v221, v252, v249
    v_mfma_f32_16x16x32_bf16 v[124:127], a[112:115], a[60:63], v[124:127]
    v_cvt_pk_bf16_f32 v116, v116, v117
    v_cvt_pk_bf16_f32 v117, v118, v119
    v_lshrrev_b32 v252, 15, v255
    v_mfma_f32_16x16x32_bf16 v[124:127], a[100:103], a[56:59], v[124:127]
    ds_write_b64 v5, v[116:117] offset:17088
    v_mfma_f32_16x16x32_bf16 v[128:131], a[104:107], a[56:59], v[128:131]
    ds_read_b128 a[56:59], v253 offset:30688
    v_mfma_f32_16x16x32_bf16 v[128:131], a[116:119], a[60:63], v[128:131]
    buffer_load_dwordx2 v[202:203], v203, s[4:7], s21 offen offset:64
    v_mfma_f32_16x16x32_bf16 v[128:131], a[128:131], a[48:51], v[128:131]
    ds_write_b64 v252, v[218:219] offset:0
    v_mfma_f32_16x16x32_bf16 v[128:131], a[140:143], a[72:75], v[128:131]
    ds_read_b128 a[72:75], v253 offset:32768
    v_lshrrev_b32 v218, 15, v255
    v_mfma_f32_16x16x32_bf16 v[128:131], a[152:155], a[76:79], v[128:131]
    ds_write_b64 v218, v[224:225] offset:2080
    v_mfma_f32_16x16x32_bf16 v[128:131], a[164:167], a[64:67], v[128:131]
    v_mfma_f32_16x16x32_bf16 v[132:135], a[96:99], a[60:63], v[132:135]
    buffer_store_dwordx4 a[40:43], v254, s[12:15], s44 offen nt
    s_add_u32 s44, s40, 11264
    v_mfma_f32_16x16x32_bf16 v[132:135], a[108:111], a[48:51], v[132:135]
    v_cvt_pk_bf16_f32 v120, v120, v121
    v_cvt_pk_bf16_f32 v121, v122, v123
    v_mfma_f32_16x16x32_bf16 v[132:135], a[120:123], a[52:55], v[132:135]
    s_add_u32 s42, s36, 36864
    v_cvt_pk_bf16_f32 v122, v124, v125
    v_cvt_pk_bf16_f32 v123, v126, v127
    v_mfma_f32_16x16x32_bf16 v[132:135], a[132:135], a[76:79], v[132:135]
    buffer_store_dwordx4 a[44:47], v254, s[12:15], s44 offen nt
    v_mfma_f32_16x16x32_bf16 v[132:135], a[144:147], a[64:67], v[132:135]
pad13:
    s_cbranch_vccnz warm_ret
    s_waitcnt lgkmcnt(8)
    v_mfma_f32_16x16x32_bf16 v[132:135], a[156:159], a[68:71], v[132:135]
    ds_write_b128 v4, v[120:123] offset:17408
    v_mfma_f32_16x16x32_bf16 v[136:139], a[160:163], a[68:71], v[136:139]
    buffer_load_dwordx4 a[228:231], v254, s[8:11], s42 offen offset:0 sc1
    v_mfma_f32_16x16x32_bf16 v[136:139], a[148:151], a[64:67], v[136:139]
    v_cvt_pk_bf16_f32 v128, v128, v129
    v_cvt_pk_bf16_f32 v129, v130, v131
    v_mfma_f32_16x16x32_bf16 v[136:139], a[136:139], a[76:79], v[136:139]
    v_mfma_f32_16x16x32_bf16 v[136:139], a[124:127], a[52:55], v[136:139]
    ds_write_b64 v5, v[128:129] offset:17472
    v_mfma_f32_16x16x32_bf16 v[136:139], a[112:115], a[48:51], v[136:139]
    buffer_load_dwordx4 a[232:235], v254, s[8:11], s42 offen offset:1024 sc1
    v_mfma_f32_16x16x32_bf16 v[136:139], a[100:103], a[60:63], v[136:139]
    ds_write_b64 v218, v[222:223] offset:4160
    v_mfma_f32_16x16x32_bf16 v[140:143], a[104:107], a[60:63], v[140:143]
    ds_read_b128 a[60:63], v253 offset:30432
    v_mfma_f32_16x16x32_bf16 v[140:143], a[116:119], a[48:51], v[140:143]
    buffer_load_dwordx4 a[236:239], v254, s[8:11], s42 offen offset:2048 sc1
    v_mfma_f32_16x16x32_bf16 v[140:143], a[128:131], a[52:55], v[140:143]
    s_add_u32 s42, s36, 39936
    v_mfma_f32_16x16x32_bf16 v[140:143], a[140:143], a[76:79], v[140:143]
    s_waitcnt lgkmcnt(0)
    v_mfma_f32_16x16x32_bf16 v[140:143], a[152:155], a[64:67], v[140:143]
    s_barrier
    v_mfma_f32_16x16x32_bf16 v[140:143], a[164:167], a[68:71], v[140:143]
    ds_read_b128 a[76:79], v253 offset:32512
    s_add_u32 s44, s40, 589824
sub35:
    v_mfma_f32_16x16x32_bf16 v[144:147], a[96:99], a[48:51], v[144:147]
    buffer_load_dwordx4 a[240:243], v254, s[8:11], s42 offen offset:0 sc1
    v_mfma_f32_16x16x32_bf16 v[144:147], a[108:111], a[52:55], v[144:147]
    v_cvt_pk_bf16_f32 v132, v132, v133
    v_cvt_pk_bf16_f32 v133, v134, v135
    v_mfma_f32_16x16x32_bf16 v[144:147], a[120:123], a[56:59], v[144:147]
    ds_read_b128 v[96:99], v6 offset:16640
    v_cvt_pk_bf16_f32 v134, v136, v137
    v_cvt_pk_bf16_f32 v135, v138, v139
    v_mfma_f32_16x16x32_bf16 v[144:147], a[132:135], a[64:67], v[144:147]
    v_mfma_f32_16x16x32_bf16 v[144:147], a[144:147], a[68:71], v[144:147]
    buffer_load_dwordx4 a[244:247], v254, s[8:11], s42 offen offset:1024 sc1
    v_mfma_f32_16x16x32_bf16 v[144:147], a[156:159], a[72:75], v[144:147]
    ds_write_b128 v4, v[132:135] offset:17792
    v_mfma_f32_16x16x32_bf16 v[148:151], a[160:163], a[72:75], v[148:151]
    v_mfma_f32_16x16x32_bf16 v[148:151], a[148:151], a[68:71], v[148:151]
    ds_read_b128 v[100:103], v6 offset:19744
    v_cvt_pk_bf16_f32 v140, v140, v141
    v_cvt_pk_bf16_f32 v141, v142, v143
    v_mfma_f32_16x16x32_bf16 v[148:151], a[136:139], a[64:67], v[148:151]
    buffer_load_dwordx4 a[248:251], v254, s[8:11], s42 offen offset:2048 sc1
    v_mfma_f32_16x16x32_bf16 v[148:151], a[124:127], a[56:59], v[148:151]
    s_add_u32 s42, s36, 43008
    s_waitcnt lgkmcnt(2)
    v_mfma_f32_16x16x32_bf16 v[148:151], a[112:115], a[52:55], v[148:151]
    ds_write_b64 v5, v[140:141] offset:17856
    v_mfma_f32_16x16x32_bf16 v[148:151], a[100:103], a[48:51], v[148:151]
    ds_read_b128 v[104:107], v6 offset:22848
    v_mfma_f32_16x16x32_bf16 v[152:155], a[104:107], a[48:51], v[152:155]
    buffer_load_dwordx4 a[252:255], v254, s[8:11], s42 offen offset:0 sc1
    v_mfma_f32_16x16x32_bf16 v[152:155], a[116:119], a[52:55], v[152:155]
    ds_read_b128 a[48:51], v253 offset:30176
    v_mfma_f32_16x16x32_bf16 v[152:155], a[128:131], a[56:59], v[152:155]
    buffer_store_dwordx4 v[96:99], v254, s[12:15], s44 offen nt
    s_add_u32 s44, s40, 592896
    s_waitcnt lgkmcnt(3)
    v_mfma_f32_16x16x32_bf16 v[152:155], a[140:143], a[64:67], v[152:155]
    ds_read_b128 a[64:67], v253 offset:32256
    v_mfma_f32_16x16x32_bf16 v[152:155], a[152:155], a[68:71], v[152:155]
    buffer_load_dwordx4 v[240:243], v254, s[8:11], s42 offen offset:1024 sc1
    v_mfma_f32_16x16x32_bf16 v[152:155], a[164:167], a[72:75], v[152:155]
    ds_read_b128 v[108:111], v6 offset:25952
    v_mfma_f32_16x16x32_bf16 v[156:159], a[96:99], a[52:55], v[156:159]
    buffer_store_dwordx4 v[100:103], v254, s[12:15], s44 offen nt
    s_add_u32 s44, s40, 595968
    v_mfma_f32_16x16x32_bf16 v[156:159], a[108:111], a[56:59], v[156:159]
    v_cvt_pk_bf16_f32 v144, v144, v145
    v_cvt_pk_bf16_f32 v145, v146, v147
    v_mfma_f32_16x16x32_bf16 v[156:159], a[120:123], a[60:63], v[156:159]
    buffer_load_dwordx4 v[244:247], v254, s[8:11], s42 offen offset:2048 sc1
    v_mfma_f32_16x16x32_bf16 v[156:159], a[132:135], a[68:71], v[156:159]
    s_waitcnt lgkmcnt(3)
    v_cvt_pk_bf16_f32 v146, v148, v149
    v_cvt_pk_bf16_f32 v147, v150, v151
    v_mfma_f32_16x16x32_bf16 v[156:159], a[144:147], a[72:75], v[156:159]
    v_and_b32 v215, 0x7fff, v255
    v_mfma_f32_16x16x32_bf16 v[156:159], a[156:159], a[76:79], v[156:159]
    buffer_load_dwordx2 v[204:205], v215, s[4:7], s16 offen offset:448
    v_mfma_f32_16x16x32_bf16 v[160:163], a[160:163], a[76:79], v[160:163]
    ds_write_b128 v4, v[144:147] offset:18176
    v_mfma_f32_16x16x32_bf16 v[160:163], a[148:151], a[72:75], v[160:163]
    v_cvt_pk_bf16_f32 v152, v152, v153
    v_cvt_pk_bf16_f32 v153, v154, v155
    v_mfma_f32_16x16x32_bf16 v[160:163], a[136:139], a[68:71], v[160:163]
    v_mfma_f32_16x16x32_bf16 v[160:163], a[124:127], a[60:63], v[160:163]
    v_mfma_f32_16x16x32_bf16 v[160:163], a[112:115], a[56:59], v[160:163]
    buffer_load_dwordx2 v[206:207], v215, s[4:7], s17 offen offset:448
    v_mfma_f32_16x16x32_bf16 v[160:163], a[100:103], a[52:55], v[160:163]
    ds_write_b64 v5, v[152:153] offset:18240
    v_mfma_f32_16x16x32_bf16 v[164:167], a[104:107], a[52:55], v[164:167]
    ds_read_b128 a[52:55], v253 offset:29904
    v_mfma_f32_16x16x32_bf16 v[164:167], a[116:119], a[56:59], v[164:167]
    ds_write_b64 v218, v[216:217] offset:33280
    v_mfma_f32_16x16x32_bf16 v[164:167], a[128:131], a[60:63], v[164:167]
    v_mfma_f32_16x16x32_bf16 v[164:167], a[140:143], a[68:71], v[164:167]
    ds_read_b128 a[68:71], v253 offset:31984
    v_mfma_f32_16x16x32_bf16 v[164:167], a[152:155], a[72:75], v[164:167]
    buffer_load_dwordx2 v[208:209], v215, s[4:7], s18 offen offset:448
    v_mfma_f32_16x16x32_bf16 v[164:167], a[164:167], a[76:79], v[164:167]
    ds_write_b64 v218, v[226:227] offset:35360
    v_mfma_f32_16x16x32_bf16 v[168:171], a[96:99], a[56:59], v[168:171]
    v_mfma_f32_16x16x32_bf16 v[168:171], a[108:111], a[60:63], v[168:171]
    s_waitcnt lgkmcnt(8)
    v_cvt_pk_bf16_f32 v156, v156, v157
    v_cvt_pk_bf16_f32 v157, v158, v159
    v_mfma_f32_16x16x32_bf16 v[168:171], a[120:123], a[48:51], v[168:171]
    v_cvt_pk_bf16_f32 v158, v160, v161
    v_cvt_pk_bf16_f32 v159, v162, v163
    v_mfma_f32_16x16x32_bf16 v[168:171], a[132:135], a[72:75], v[168:171]
    buffer_load_dwordx2 v[210:211], v215, s[4:7], s19 offen offset:448
    v_mfma_f32_16x16x32_bf16 v[168:171], a[144:147], a[76:79], v[168:171]
    s_waitcnt lgkmcnt(7)
    v_mfma_f32_16x16x32_bf16 v[168:171], a[156:159], a[64:67], v[168:171]
    ds_write_b128 v4, v[156:159] offset:18560
    v_mfma_f32_16x16x32_bf16 v[172:175], a[160:163], a[64:67], v[172:175]
    v_mfma_f32_16x16x32_bf16 v[172:175], a[148:151], a[76:79], v[172:175]
    v_cvt_pk_bf16_f32 v164, v164, v165
    v_cvt_pk_bf16_f32 v165, v166, v167
    v_mfma_f32_16x16x32_bf16 v[172:175], a[136:139], a[72:75], v[172:175]
    buffer_load_dwordx2 v[212:213], v215, s[4:7], s20 offen offset:448
    v_mfma_f32_16x16x32_bf16 v[172:175], a[124:127], a[48:51], v[172:175]
    ds_write_b64 v5, v[164:165] offset:18624
    v_mfma_f32_16x16x32_bf16 v[172:175], a[112:115], a[60:63], v[172:175]
    v_mfma_f32_16x16x32_bf16 v[172:175], a[100:103], a[56:59], v[172:175]
    ds_write_b64 v218, v[220:221] offset:6240
    v_mfma_f32_16x16x32_bf16 v[176:179], a[104:107], a[56:59], v[176:179]
    v_mfma_f32_16x16x32_bf16 v[176:179], a[116:119], a[60:63], v[176:179]
    buffer_load_dwordx2 v[214:215], v215, s[4:7], s21 offen offset:448
    v_mfma_f32_16x16x32_bf16 v[176:179], a[128:131], a[48:51], v[176:179]
    s_waitcnt lgkmcnt(0)
    v_mfma_f32_16x16x32_bf16 v[176:179], a[140:143], a[72:75], v[176:179]
    s_barrier
    v_mfma_f32_16x16x32_bf16 v[176:179], a[152:155], a[76:79], v[176:179]
    ds_read_b128 v[228:231], v253 offset:1040
    v_mfma_f32_16x16x32_bf16 v[176:179], a[164:167], a[64:67], v[176:179]
    ds_read_b128 v[232:235], v253 offset:768
    v_mfma_f32_16x16x32_bf16 v[180:183], a[96:99], a[60:63], v[180:183]
    ds_read_b128 v[236:239], v253 offset:512
    v_mfma_f32_16x16x32_bf16 v[180:183], a[108:111], a[48:51], v[180:183]
    v_cvt_pk_bf16_f32 v168, v168, v169
    v_cvt_pk_bf16_f32 v169, v170, v171
    v_mfma_f32_16x16x32_bf16 v[180:183], a[120:123], a[52:55], v[180:183]
    buffer_store_dwordx4 v[104:107], v254, s[12:15], s44 offen nt
    v_cvt_pk_bf16_f32 v170, v172, v173
    v_cvt_pk_bf16_f32 v171, v174, v175
    v_mfma_f32_16x16x32_bf16 v[180:183], a[132:135], a[76:79], v[180:183]
    ds_write_b128 v4, v[168:171] offset:18944
    v_mfma_f32_16x16x32_bf16 v[180:183], a[144:147], a[64:67], v[180:183]
    s_add_u32 s44, s40, 599040
    v_mfma_f32_16x16x32_bf16 v[180:183], a[156:159], a[68:71], v[180:183]
    ds_read_b128 v[112:115], v6 offset:17664
    v_mfma_f32_16x16x32_bf16 v[184:187], a[160:163], a[68:71], v[184:187]
    ds_read_b128 v[116:119], v6 offset:20768
    v_mfma_f32_16x16x32_bf16 v[184:187], a[148:151], a[64:67], v[184:187]
    buffer_store_dwordx4 v[108:111], v254, s[12:15], s44 offen nt
    v_cvt_pk_bf16_f32 v176, v176, v177
    v_cvt_pk_bf16_f32 v177, v178, v179
    v_mfma_f32_16x16x32_bf16 v[184:187], a[136:139], a[76:79], v[184:187]
    ds_write_b64 v5, v[176:177] offset:19008
    v_mfma_f32_16x16x32_bf16 v[184:187], a[124:127], a[52:55], v[184:187]
    ds_read_b128 v[120:123], v6 offset:23872
    s_add_u32 s44, s40, 590848
    v_mfma_f32_16x16x32_bf16 v[184:187], a[112:115], a[48:51], v[184:187]
    ds_read_b128 v[124:127], v6 offset:26976
    s_waitcnt lgkmcnt(4)
    v_mfma_f32_16x16x32_bf16 v[184:187], a[100:103], a[60:63], v[184:187]
    buffer_store_dwordx4 v[112:115], v254, s[12:15], s44 offen nt
    s_add_u32 s44, s40, 593920
    s_waitcnt lgkmcnt(3)
    v_mfma_f32_16x16x32_bf16 v[188:191], a[104:107], a[60:63], v[188:191]
    buffer_store_dwordx4 v[116:119], v254, s[12:15], s44 offen nt
    s_add_u32 s44, s40, 596992
    v_mfma_f32_16x16x32_bf16 v[188:191], a[116:119], a[48:51], v[188:191]
    v_mfma_f32_16x16x32_bf16 v[188:191], a[128:131], a[52:55], v[188:191]
    s_waitcnt lgkmcnt(1)
    v_mfma_f32_16x16x32_bf16 v[188:191], a[140:143], a[76:79], v[188:191]
    buffer_store_dwordx4 v[120:123], v254, s[12:15], s44 offen nt
    s_add_u32 s44, s40, 600064
    s_waitcnt lgkmcnt(0)
    v_mfma_f32_16x16x32_bf16 v[188:191], a[152:155], a[64:67], v[188:191]
    buffer_store_dwordx4 v[124:127], v254, s[12:15], s44 offen nt
    v_mfma_f32_16x16x32_bf16 v[188:191], a[164:167], a[68:71], v[188:191]
    s_waitcnt vmcnt(39)
    s_add_u32 s41, s40, 589824
    s_add_u32 s40, s40, 6291456
    s_add_u32 s39, s39, 1
    s_cmp_lt_u32 s39, 2
    s_cbranch_scc1 blk_loop
    s_nop 3
    v_cvt_pk_bf16_f32 v180, v180, v181
    v_cvt_pk_bf16_f32 v181, v182, v183
    v_cvt_pk_bf16_f32 v182, v184, v185
    v_cvt_pk_bf16_f32 v183, v186, v187
    ds_write_b128 v4, v[180:183] offset:19328
    v_cvt_pk_bf16_f32 v188, v188, v189
    v_cvt_pk_bf16_f32 v189, v190, v191
    ds_write_b64 v5, v[188:189] offset:19392
    s_waitcnt lgkmcnt(0)
    s_barrier
    ds_read_b128 v[32:35], v6 offset:18688
    ds_read_b128 v[36:39], v6 offset:21792
    ds_read_b128 v[40:43], v6 offset:24896
    ds_read_b128 v[44:47], v6 offset:28000
    s_add_u32 s44, s41, 2048
    s_waitcnt lgkmcnt(3)
    buffer_store_dwordx4 v[32:35], v254, s[12:15], s44 offen nt
    s_add_u32 s44, s41, 5120
    s_waitcnt lgkmcnt(2)
    buffer_store_dwordx4 v[36:39], v254, s[12:15], s44 offen nt
    s_add_u32 s44, s41, 8192
    s_waitcnt lgkmcnt(1)
    buffer_store_dwordx4 v[40:43], v254, s[12:15], s44 offen nt
    s_add_u32 s44, s41, 11264
    s_waitcnt lgkmcnt(0)
    buffer_store_dwordx4 v[44:47], v254, s[12:15], s44 offen nt
main_done:
    s_endpgm
code_end:
wt_loop:
    s_mul_i32 s73, s70, 43691
    s_lshr_b32 s73, s73, 17
    s_mul_i32 s74, s73, 3
    s_sub_u32 s74, s70, s74
    s_mul_i32 s75, s73, 43691
    s_lshr_b32 s75, s75, 17
    s_mul_i32 s76, s75, 3
    s_sub_u32 s76, s73, s76
    v_and_b32 v101, 15, v2
    v_lshrrev_b32 v102, 4, v2
    v_and_b32 v103, 12, v101
    s_lshl_b32 s78, s74, 2
    s_cmp_lt_u32 s74, 2
    s_cselect_b32 s77, 1, 0
    s_cselect_b32 s78, s78, 32
    v_mul_u32_u24 v103, s77, v103
    v_add_u32 v103, v103, v101
    v_add_u32 v103, s78, v103
    v_lshl_add_u32 v103, v103, 1, s52
    v_mul_u32_u24 v104, 3072, v102
    v_add_u32 v103, v103, v104
    s_mul_i32 s79, s76, 73728
    s_mul_i32 s80, s75, 12288
    s_add_u32 s79, s79, s80
    s_add_u32 s80, s79, 221184
    s_add_u32 s81, s79, 442368
    buffer_load_ushort v110, v103, s[60:63], s79 offen offset:0
    buffer_load_ushort v111, v103, s[60:63], s79 offen offset:384
    buffer_load_ushort v112, v103, s[60:63], s79 offen offset:768
    buffer_load_ushort v113, v103, s[60:63], s79 offen offset:1152
    buffer_load_ushort v114, v103, s[60:63], s79 offen offset:1536
    buffer_load_ushort v115, v103, s[60:63], s79 offen offset:1920
    buffer_load_ushort v116, v103, s[60:63], s79 offen offset:2304
    buffer_load_ushort v117, v103, s[60:63], s79 offen offset:2688
    buffer_load_ushort v118, v103, s[60:63], s80 offen offset:0
    buffer_load_ushort v119, v103, s[60:63], s80 offen offset:384
    buffer_load_ushort v120, v103, s[60:63], s80 offen offset:768
    buffer_load_ushort v121, v103, s[60:63], s80 offen offset:1152
    buffer_load_ushort v122, v103, s[60:63], s80 offen offset:1536
    buffer_load_ushort v123, v103, s[60:63], s80 offen offset:1920
    buffer_load_ushort v124, v103, s[60:63], s80 offen offset:2304
    buffer_load_ushort v125, v103, s[60:63], s80 offen offset:2688
    buffer_load_ushort v126, v103, s[60:63], s81 offen offset:0
    buffer_load_ushort v127, v103, s[60:63], s81 offen offset:384
    buffer_load_ushort v128, v103, s[60:63], s81 offen offset:768
    buffer_load_ushort v129, v103, s[60:63], s81 offen offset:1152
    buffer_load_ushort v130, v103, s[60:63], s81 offen offset:1536
    buffer_load_ushort v131, v103, s[60:63], s81 offen offset:1920
    buffer_load_ushort v132, v103, s[60:63], s81 offen offset:2304
    buffer_load_ushort v133, v103, s[60:63], s81 offen offset:2688
    s_mul_i32 s82, s76, 3072
    s_lshl_b32 s83, s74, 10
    s_add_u32 s82, s82, s83
    s_mul_i32 s83, s75, 36864
    s_lshl_b32 s84, s83, 2
    s_add_u32 s83, s83, s82
    s_add_u32 s84, s84, s82
    s_waitcnt vmcnt(0)
    v_lshlrev_b32 v110, 16, v110
    v_lshlrev_b32 v111, 16, v111
    v_lshlrev_b32 v112, 16, v112
    v_lshlrev_b32 v113, 16, v113
    v_lshlrev_b32 v114, 16, v114
    v_lshlrev_b32 v115, 16, v115
    v_lshlrev_b32 v116, 16, v116
    v_lshlrev_b32 v117, 16, v117
    v_lshlrev_b32 v118, 16, v118
    v_lshlrev_b32 v119, 16, v119
    v_lshlrev_b32 v120, 16, v120
    v_lshlrev_b32 v121, 16, v121
    v_lshlrev_b32 v122, 16, v122
    v_lshlrev_b32 v123, 16, v123
    v_lshlrev_b32 v124, 16, v124
    v_lshlrev_b32 v125, 16, v125
    v_lshlrev_b32 v126, 16, v126
    v_lshlrev_b32 v127, 16, v127
    v_lshlrev_b32 v128, 16, v128
    v_lshlrev_b32 v129, 16, v129
    v_lshlrev_b32 v130, 16, v130
    v_lshlrev_b32 v131, 16, v131
    v_lshlrev_b32 v132, 16, v132
    v_lshlrev_b32 v133, 16, v133
    v_mul_f32 v136, 0xbedba55c, v110
    v_fmac_f32 v136, 0xbe0afea5, v126
    v_fmamk_f32 v144, v118, 0xbe771a08, v136
    v_fmac_f32 v136, 0x3e771a08, v118
    v_mul_f32 v137, 0xbedba55c, v111
    v_fmac_f32 v137, 0xbe0afea5, v127
    v_fmamk_f32 v145, v119, 0xbe771a08, v137
    v_fmac_f32 v137, 0x3e771a08, v119
    v_mul_f32 v138, 0xbedba55c, v112
    v_fmac_f32 v138, 0xbe0afea5, v128
    v_fmamk_f32 v146, v120, 0xbe771a08, v138
    v_fmac_f32 v138, 0x3e771a08, v120
    v_mul_f32 v139, 0xbedba55c, v113
    v_fmac_f32 v139, 0xbe0afea5, v129
    v_fmamk_f32 v147, v121, 0xbe771a08, v139
    v_fmac_f32 v139, 0x3e771a08, v121
    v_mul_f32 v140, 0xbedba55c, v114
    v_fmac_f32 v140, 0xbe0afea5, v130
    v_fmamk_f32 v148, v122, 0xbe771a08, v140
    v_fmac_f32 v140, 0x3e771a08, v122
    v_mul_f32 v141, 0xbedba55c, v115
    v_fmac_f32 v141, 0xbe0afea5, v131
    v_fmamk_f32 v149, v123, 0xbe771a08, v141
    v_fmac_f32 v141, 0x3e771a08, v123
    v_mul_f32 v142, 0xbedba55c, v116
    v_fmac_f32 v142, 0xbe0afea5, v132
    v_fmamk_f32 v150, v124, 0xbe771a08, v142
    v_fmac_f32 v142, 0x3e771a08, v124
    v_mul_f32 v143, 0xbedba55c, v117
    v_fmac_f32 v143, 0xbe0afea5, v133
    v_fmamk_f32 v151, v125, 0xbe771a08, v143
    v_fmac_f32 v143, 0x3e771a08, v125
    v_cvt_pk_bf16_f32 v156, v144, v145
    v_cvt_pk_bf16_f32 v157, v146, v147
    v_cvt_pk_bf16_f32 v158, v148, v149
    v_cvt_pk_bf16_f32 v159, v150, v151
    s_add_u32 s85, s84, 0
    buffer_store_dwordx4 v[156:159], v254, s[8:11], s85 offen sc1
    v_cvt_pk_bf16_f32 v160, v136, v137
    v_cvt_pk_bf16_f32 v161, v138, v139
    v_cvt_pk_bf16_f32 v162, v140, v141
    v_cvt_pk_bf16_f32 v163, v142, v143
    s_add_u32 s85, s84, 36864
    buffer_store_dwordx4 v[160:163], v254, s[8:11], s85 offen sc1
    v_mul_f32 v136, 0x3e0afea5, v110
    v_fmac_f32 v136, 0x3f0afea5, v126
    v_fmamk_f32 v144, v118, 0x3e8afea5, v136
    v_fmac_f32 v136, 0xbe8afea5, v118
    v_mul_f32 v137, 0x3e0afea5, v111
    v_fmac_f32 v137, 0x3f0afea5, v127
    v_fmamk_f32 v145, v119, 0x3e8afea5, v137
    v_fmac_f32 v137, 0xbe8afea5, v119
    v_mul_f32 v138, 0x3e0afea5, v112
    v_fmac_f32 v138, 0x3f0afea5, v128
    v_fmamk_f32 v146, v120, 0x3e8afea5, v138
    v_fmac_f32 v138, 0xbe8afea5, v120
    v_mul_f32 v139, 0x3e0afea5, v113
    v_fmac_f32 v139, 0x3f0afea5, v129
    v_fmamk_f32 v147, v121, 0x3e8afea5, v139
    v_fmac_f32 v139, 0xbe8afea5, v121
    v_mul_f32 v140, 0x3e0afea5, v114
    v_fmac_f32 v140, 0x3f0afea5, v130
    v_fmamk_f32 v148, v122, 0x3e8afea5, v140
    v_fmac_f32 v140, 0xbe8afea5, v122
    v_mul_f32 v141, 0x3e0afea5, v115
    v_fmac_f32 v141, 0x3f0afea5, v131
    v_fmamk_f32 v149, v123, 0x3e8afea5, v141
    v_fmac_f32 v141, 0xbe8afea5, v123
    v_mul_f32 v142, 0x3e0afea5, v116
    v_fmac_f32 v142, 0x3f0afea5, v132
    v_fmamk_f32 v150, v124, 0x3e8afea5, v142
    v_fmac_f32 v142, 0xbe8afea5, v124
    v_mul_f32 v143, 0x3e0afea5, v117
    v_fmac_f32 v143, 0x3f0afea5, v133
    v_fmamk_f32 v151, v125, 0x3e8afea5, v143
    v_fmac_f32 v143, 0xbe8afea5, v125
    v_cvt_pk_bf16_f32 v164, v144, v145
    v_cvt_pk_bf16_f32 v165, v146, v147
    v_cvt_pk_bf16_f32 v166, v148, v149
    v_cvt_pk_bf16_f32 v167, v150, v151
    s_add_u32 s85, s84, 73728
    buffer_store_dwordx4 v[164:167], v254, s[8:11], s85 offen sc1
    v_cvt_pk_bf16_f32 v168, v136, v137
    v_cvt_pk_bf16_f32 v169, v138, v139
    v_cvt_pk_bf16_f32 v170, v140, v141
    v_cvt_pk_bf16_f32 v171, v142, v143
    s_add_u32 s85, s84, 110592
    buffer_store_dwordx4 v[168:171], v254, s[8:11], s85 offen sc1
    v_cvt_pk_bf16_f32 v152, v110, v111
    v_cvt_pk_bf16_f32 v153, v112, v113
    v_cvt_pk_bf16_f32 v154, v114, v115
    v_cvt_pk_bf16_f32 v155, v116, v117
    s_add_u32 s85, s83, 884736
    buffer_store_dwordx4 v[152:155], v254, s[8:11], s85 offen sc1
    v_cvt_pk_bf16_f32 v172, v126, v127
    v_cvt_pk_bf16_f32 v173, v128, v129
    v_cvt_pk_bf16_f32 v174, v130, v131
    v_cvt_pk_bf16_f32 v175, v132, v133
    s_add_u32 s85, s83, 1105920
    buffer_store_dwordx4 v[172:175], v254, s[8:11], s85 offen sc1
    s_add_u32 s70, s70, 1
    s_cmp_lt_u32 s70, 54
    s_cbranch_scc1 wt_loop
    s_waitcnt vmcnt(0)
    s_branch u_ready
.section .rodata,"a"
.p2align 6
.amdhsa_kernel standalone__winograd__vision_kernel
  .amdhsa_next_free_vgpr 512
  .amdhsa_next_free_sgpr 102
  .amdhsa_accum_offset 256
  .amdhsa_group_segment_fixed_size 0
  .amdhsa_kernarg_size 40
  .amdhsa_user_sgpr_count 2
  .amdhsa_user_sgpr_kernarg_segment_ptr 1
  .amdhsa_system_sgpr_workgroup_id_x 1
  .amdhsa_ieee_mode 0
.end_amdhsa_kernel
```

```asm
; @launch grid=(256,1,1) block=(256,1,1) lds=163840
.amdgcn_target "amdgcn-amd-amdhsa--gfx950"
.text
.globl standalone__winograd__vision_kernel
.p2align 8
.type standalone__winograd__vision_kernel,@function
standalone__winograd__vision_kernel:
    s_cmp_ge_u32 s2, 256
    s_cbranch_scc1 main_done
    s_load_dwordx4 s[4:7], s[0:1], 0
    s_load_dwordx4 s[12:15], s[0:1], 16
    s_load_dwordx2 s[8:9], s[0:1], 32
    s_getpc_b64 s[92:93]
pcref:
    v_and_b32 v70, 3, v0
    v_lshrrev_b32 v71, 6, v0
    v_lshl_add_u32 v70, v70, 7, v71
    s_lshr_b32 s94, s2, 3
    s_lshl_b32 s94, s94, 2
    v_add_lshl_u32 v70, v70, s94, 7
    v_min_u32 v70, code_end-pcref-4, v70
    v_add_co_u32 v72, vcc, s92, v70
    v_mov_b32 v73, s93
    s_nop 0
    v_addc_co_u32 v73, vcc, 0, v73, vcc
    global_load_dword v76, v[72:73], off
    v_lshrrev_b32 v1, 6, v0
    v_and_b32 v2, 63, v0
    v_readfirstlane_b32 s38, v1
    v_lshlrev_b32 v254, 4, v2
    v_mov_b32 v98, 0
    v_lshrrev_b32 v3, 3, v2
    v_and_b32 v4, 7, v2
    v_mul_u32_u24 v5, 3072, v3
    v_lshl_add_u32 v255, v4, 3, v5
    s_lshr_b32 s44, s2, 3
    s_and_b32 s48, s44, 3
    s_lshr_b32 s44, s44, 2
    s_and_b32 s49, s2, 7
    s_lshl_b32 s49, s49, 4
    s_add_u32 s49, s49, s44
    s_and_b32 s90, s38, 1
    s_lshr_b32 s91, s38, 1
    s_mul_i32 s50, s90, 24576
    s_mul_i32 s45, s91, 1536
    s_add_u32 s50, s50, s45
    s_mul_i32 s101, s38, 196608
    s_sub_u32 s101, s101, s50
    s_mul_i32 s53, s48, 49152
    s_add_u32 s53, s53, s50
    s_mul_i32 s43, s49, 786432
    s_add_u32 s43, s43, s53
    s_cmp_ge_u32 s49, 128
    s_cselect_b32 s43, 2130706432, s43
    s_sub_u32 s16, s43, 196608
    s_cmp_eq_u32 s49, 0
    s_cselect_b32 s16, 2130706432, s16
    s_mov_b32 s17, s43
    s_add_u32 s18, s43, 196608
    s_add_u32 s19, s43, 393216
    s_add_u32 s20, s43, 589824
    s_add_u32 s21, s43, 786432
    s_add_u32 s100, s43, s101
    s_mul_i32 s52, s38, 96
    s_mul_i32 s44, s38, 9216
    s_mov_b32 s70, s2
    v_mov_b32 v80, v255
    s_mul_i32 s73, s70, 43691
    s_lshr_b32 s73, s73, 17
    s_mul_i32 s74, s73, 3
    s_sub_u32 s74, s70, s74
    s_mul_i32 s75, s73, 43691
    s_lshr_b32 s75, s75, 17
    s_mul_i32 s76, s75, 3
    s_sub_u32 s76, s73, s76
    v_and_b32 v101, 15, v2
    v_lshrrev_b32 v102, 4, v2
    v_and_b32 v103, 12, v101
    s_lshl_b32 s78, s74, 2
    s_cmp_lt_u32 s74, 2
    s_cselect_b32 s77, 1, 0
    s_cselect_b32 s78, s78, 32
    v_mul_u32_u24 v103, s77, v103
    v_add_u32 v103, v103, v101
    v_add_u32 v103, s78, v103
    v_lshl_add_u32 v103, v103, 1, s52
    v_mul_u32_u24 v104, 3072, v102
    v_add_u32 v103, v103, v104
    s_mul_i32 s79, s76, 73728
    s_mul_i32 s80, s75, 12288
    s_add_u32 s79, s79, s80
    s_add_u32 s80, s79, 221184
    s_add_u32 s81, s79, 442368
    s_waitcnt lgkmcnt(0)
    s_mov_b32 s60, s6
    s_and_b32 s61, s7, 0xffff
    s_mov_b32 s62, 663552
    s_mov_b32 s63, 0x20000
    s_and_b32 s5, s5, 0xffff
    s_mov_b32 s6, 100663296
    s_mov_b32 s7, 0x20000
    s_add_u32 s8, s8, s44
    s_addc_u32 s9, s9, 0
    s_and_b32 s9, s9, 0xffff
    s_mov_b32 s10, 1299456
    s_mov_b32 s11, 0x20000
    s_mov_b32 s64, s14
    s_and_b32 s65, s15, 0xffff
    s_mov_b32 s66, 256
    s_mov_b32 s67, 0x20000
    s_mov_b64 s[68:69], s[14:15]
    s_cmp_lt_u32 s2, 54
    s_cbranch_scc1 wt_path
    buffer_load_dwordx2 v[8:9], v80, s[4:7], s16 offen offset:0
    buffer_load_dwordx2 v[10:11], v80, s[4:7], s17 offen offset:0
    buffer_load_dwordx2 v[12:13], v80, s[4:7], s18 offen offset:0
    buffer_load_dwordx2 v[14:15], v80, s[4:7], s19 offen offset:0
    buffer_load_dwordx2 v[16:17], v80, s[4:7], s20 offen offset:0
    buffer_load_dwordx2 v[18:19], v80, s[4:7], s21 offen offset:0
    buffer_load_dwordx2 v[20:21], v80, s[4:7], s16 offen offset:384
    buffer_load_dwordx2 v[22:23], v80, s[4:7], s17 offen offset:384
    buffer_load_dwordx2 v[24:25], v80, s[4:7], s18 offen offset:384
    buffer_load_dwordx2 v[26:27], v80, s[4:7], s19 offen offset:384
    buffer_load_dwordx2 v[28:29], v80, s[4:7], s20 offen offset:384
    buffer_load_dwordx2 v[30:31], v80, s[4:7], s21 offen offset:384
    s_branch wt_join
wt_path:
    buffer_load_ushort v110, v103, s[60:63], s79 offen offset:0
    buffer_load_ushort v111, v103, s[60:63], s79 offen offset:384
    buffer_load_ushort v112, v103, s[60:63], s79 offen offset:768
    buffer_load_ushort v113, v103, s[60:63], s79 offen offset:1152
    buffer_load_ushort v114, v103, s[60:63], s79 offen offset:1536
    buffer_load_ushort v115, v103, s[60:63], s79 offen offset:1920
    buffer_load_ushort v116, v103, s[60:63], s79 offen offset:2304
    buffer_load_ushort v117, v103, s[60:63], s79 offen offset:2688
    buffer_load_ushort v118, v103, s[60:63], s80 offen offset:0
    buffer_load_ushort v119, v103, s[60:63], s80 offen offset:384
    buffer_load_ushort v120, v103, s[60:63], s80 offen offset:768
    buffer_load_ushort v121, v103, s[60:63], s80 offen offset:1152
    buffer_load_ushort v122, v103, s[60:63], s80 offen offset:1536
    buffer_load_ushort v123, v103, s[60:63], s80 offen offset:1920
    buffer_load_ushort v124, v103, s[60:63], s80 offen offset:2304
    buffer_load_ushort v125, v103, s[60:63], s80 offen offset:2688
    buffer_load_ushort v126, v103, s[60:63], s81 offen offset:0
    buffer_load_ushort v127, v103, s[60:63], s81 offen offset:384
    buffer_load_ushort v128, v103, s[60:63], s81 offen offset:768
    buffer_load_ushort v129, v103, s[60:63], s81 offen offset:1152
    buffer_load_ushort v130, v103, s[60:63], s81 offen offset:1536
    buffer_load_ushort v131, v103, s[60:63], s81 offen offset:1920
    buffer_load_ushort v132, v103, s[60:63], s81 offen offset:2304
    buffer_load_ushort v133, v103, s[60:63], s81 offen offset:2688
    s_mul_i32 s82, s76, 3072
    s_lshl_b32 s83, s74, 10
    s_add_u32 s82, s82, s83
    s_mul_i32 s83, s75, 36864
    s_lshl_b32 s84, s83, 2
    s_add_u32 s83, s83, s82
    s_add_u32 s84, s84, s82
    s_waitcnt vmcnt(0)
    v_lshlrev_b32 v110, 16, v110
    v_lshlrev_b32 v111, 16, v111
    v_lshlrev_b32 v112, 16, v112
    v_lshlrev_b32 v113, 16, v113
    v_lshlrev_b32 v114, 16, v114
    v_lshlrev_b32 v115, 16, v115
    v_lshlrev_b32 v116, 16, v116
    v_lshlrev_b32 v117, 16, v117
    v_lshlrev_b32 v118, 16, v118
    v_lshlrev_b32 v119, 16, v119
    v_lshlrev_b32 v120, 16, v120
    v_lshlrev_b32 v121, 16, v121
    v_lshlrev_b32 v122, 16, v122
    v_lshlrev_b32 v123, 16, v123
    v_lshlrev_b32 v124, 16, v124
    v_lshlrev_b32 v125, 16, v125
    v_lshlrev_b32 v126, 16, v126
    v_lshlrev_b32 v127, 16, v127
    v_lshlrev_b32 v128, 16, v128
    v_lshlrev_b32 v129, 16, v129
    v_lshlrev_b32 v130, 16, v130
    v_lshlrev_b32 v131, 16, v131
    v_lshlrev_b32 v132, 16, v132
    v_lshlrev_b32 v133, 16, v133
    v_mul_f32 v136, 0xbedba55c, v110
    v_fmac_f32 v136, 0xbe0afea5, v126
    v_fmamk_f32 v144, v118, 0xbe771a08, v136
    v_fmac_f32 v136, 0x3e771a08, v118
    v_mul_f32 v137, 0xbedba55c, v111
    v_fmac_f32 v137, 0xbe0afea5, v127
    v_fmamk_f32 v145, v119, 0xbe771a08, v137
    v_fmac_f32 v137, 0x3e771a08, v119
    v_mul_f32 v138, 0xbedba55c, v112
    v_fmac_f32 v138, 0xbe0afea5, v128
    v_fmamk_f32 v146, v120, 0xbe771a08, v138
    v_fmac_f32 v138, 0x3e771a08, v120
    v_mul_f32 v139, 0xbedba55c, v113
    v_fmac_f32 v139, 0xbe0afea5, v129
    v_fmamk_f32 v147, v121, 0xbe771a08, v139
    v_fmac_f32 v139, 0x3e771a08, v121
    v_mul_f32 v140, 0xbedba55c, v114
    v_fmac_f32 v140, 0xbe0afea5, v130
    v_fmamk_f32 v148, v122, 0xbe771a08, v140
    v_fmac_f32 v140, 0x3e771a08, v122
    v_mul_f32 v141, 0xbedba55c, v115
    v_fmac_f32 v141, 0xbe0afea5, v131
    v_fmamk_f32 v149, v123, 0xbe771a08, v141
    v_fmac_f32 v141, 0x3e771a08, v123
    v_mul_f32 v142, 0xbedba55c, v116
    v_fmac_f32 v142, 0xbe0afea5, v132
    v_fmamk_f32 v150, v124, 0xbe771a08, v142
    v_fmac_f32 v142, 0x3e771a08, v124
    v_mul_f32 v143, 0xbedba55c, v117
    v_fmac_f32 v143, 0xbe0afea5, v133
    v_fmamk_f32 v151, v125, 0xbe771a08, v143
    v_fmac_f32 v143, 0x3e771a08, v125
    v_cvt_pk_bf16_f32 v156, v144, v145
    v_cvt_pk_bf16_f32 v157, v146, v147
    v_cvt_pk_bf16_f32 v158, v148, v149
    v_cvt_pk_bf16_f32 v159, v150, v151
    s_add_u32 s85, s84, 0
    buffer_store_dwordx4 v[156:159], v254, s[8:11], s85 offen sc1
    v_cvt_pk_bf16_f32 v160, v136, v137
    v_cvt_pk_bf16_f32 v161, v138, v139
    v_cvt_pk_bf16_f32 v162, v140, v141
    v_cvt_pk_bf16_f32 v163, v142, v143
    s_add_u32 s85, s84, 36864
    buffer_store_dwordx4 v[160:163], v254, s[8:11], s85 offen sc1
    v_mul_f32 v136, 0x3e0afea5, v110
    v_fmac_f32 v136, 0x3f0afea5, v126
    v_fmamk_f32 v144, v118, 0x3e8afea5, v136
    v_fmac_f32 v136, 0xbe8afea5, v118
    v_mul_f32 v137, 0x3e0afea5, v111
    v_fmac_f32 v137, 0x3f0afea5, v127
    v_fmamk_f32 v145, v119, 0x3e8afea5, v137
    v_fmac_f32 v137, 0xbe8afea5, v119
    v_mul_f32 v138, 0x3e0afea5, v112
    v_fmac_f32 v138, 0x3f0afea5, v128
    v_fmamk_f32 v146, v120, 0x3e8afea5, v138
    v_fmac_f32 v138, 0xbe8afea5, v120
    v_mul_f32 v139, 0x3e0afea5, v113
    v_fmac_f32 v139, 0x3f0afea5, v129
    v_fmamk_f32 v147, v121, 0x3e8afea5, v139
    v_fmac_f32 v139, 0xbe8afea5, v121
    v_mul_f32 v140, 0x3e0afea5, v114
    v_fmac_f32 v140, 0x3f0afea5, v130
    v_fmamk_f32 v148, v122, 0x3e8afea5, v140
    v_fmac_f32 v140, 0xbe8afea5, v122
    v_mul_f32 v141, 0x3e0afea5, v115
    v_fmac_f32 v141, 0x3f0afea5, v131
    v_fmamk_f32 v149, v123, 0x3e8afea5, v141
    v_fmac_f32 v141, 0xbe8afea5, v123
    v_mul_f32 v142, 0x3e0afea5, v116
    v_fmac_f32 v142, 0x3f0afea5, v132
    v_fmamk_f32 v150, v124, 0x3e8afea5, v142
    v_fmac_f32 v142, 0xbe8afea5, v124
    v_mul_f32 v143, 0x3e0afea5, v117
    v_fmac_f32 v143, 0x3f0afea5, v133
    v_fmamk_f32 v151, v125, 0x3e8afea5, v143
    v_fmac_f32 v143, 0xbe8afea5, v125
    v_cvt_pk_bf16_f32 v164, v144, v145
    v_cvt_pk_bf16_f32 v165, v146, v147
    v_cvt_pk_bf16_f32 v166, v148, v149
    v_cvt_pk_bf16_f32 v167, v150, v151
    s_add_u32 s85, s84, 73728
    buffer_store_dwordx4 v[164:167], v254, s[8:11], s85 offen sc1
    v_cvt_pk_bf16_f32 v168, v136, v137
    v_cvt_pk_bf16_f32 v169, v138, v139
    v_cvt_pk_bf16_f32 v170, v140, v141
    v_cvt_pk_bf16_f32 v171, v142, v143
    s_add_u32 s85, s84, 110592
    buffer_store_dwordx4 v[168:171], v254, s[8:11], s85 offen sc1
    v_cvt_pk_bf16_f32 v152, v110, v111
    v_cvt_pk_bf16_f32 v153, v112, v113
    v_cvt_pk_bf16_f32 v154, v114, v115
    v_cvt_pk_bf16_f32 v155, v116, v117
    s_add_u32 s85, s83, 884736
    buffer_store_dwordx4 v[152:155], v254, s[8:11], s85 offen sc1
    v_cvt_pk_bf16_f32 v172, v126, v127
    v_cvt_pk_bf16_f32 v173, v128, v129
    v_cvt_pk_bf16_f32 v174, v130, v131
    v_cvt_pk_bf16_f32 v175, v132, v133
    s_add_u32 s85, s83, 1105920
    buffer_store_dwordx4 v[172:175], v254, s[8:11], s85 offen sc1
    buffer_load_dwordx2 v[8:9], v80, s[4:7], s16 offen offset:0
    buffer_load_dwordx2 v[10:11], v80, s[4:7], s17 offen offset:0
    buffer_load_dwordx2 v[12:13], v80, s[4:7], s18 offen offset:0
    buffer_load_dwordx2 v[14:15], v80, s[4:7], s19 offen offset:0
    buffer_load_dwordx2 v[16:17], v80, s[4:7], s20 offen offset:0
    buffer_load_dwordx2 v[18:19], v80, s[4:7], s21 offen offset:0
wt_join:
    s_and_b32 s13, s13, 0xffff
    s_mov_b32 s14, 100663296
    s_mov_b32 s15, 0x20000
    v_lshrrev_b32 v5, 4, v2
    v_mul_u32_u24 v6, 40704, v5
    v_lshrrev_b32 v5, 1, v5
    v_lshl_add_u32 v6, v5, 6, v6
    v_and_b32 v5, 0xf0, v254
    v_add_u32 v253, v6, v5
    v_lshrrev_b32 v6, 1, v4
    v_mul_u32_u24 v7, 40704, v6
    v_lshrrev_b32 v6, 1, v6
    v_lshl_add_u32 v7, v6, 6, v7
    v_and_b32 v6, 1, v2
    v_lshl_add_u32 v7, v6, 3, v7
    v_lshl_add_u32 v7, v3, 4, v7
    s_lshl_b32 s44, s90, 7
    s_mul_i32 s45, s91, 1056
    s_add_u32 s44, s44, s45
    v_add_u32 v7, s44, v7
    v_lshl_or_b32 v255, v7, 15, v255
    s_mul_i32 s51, s38, 40704
    s_lshl_b32 s45, s91, 6
    s_add_u32 s51, s51, s45
    s_lshl_b32 s45, s90, 4
    s_add_u32 s51, s51, s45
    s_mul_i32 s40, s49, 786432
    s_mul_i32 s45, s48, 49152
    s_add_u32 s40, s40, s45
    s_mul_i32 s45, s38, 12288
    s_add_u32 s40, s40, s45
    s_mov_b32 s41, 2130706432
    s_mov_b32 s39, 0
    s_mov_b32 s36, 0
    s_lshl_b32 s45, s38, 4
    s_mov_b32 s46, 0xfff
    s_mov_b32 s47, 0
    s_lshl_b64 s[46:47], s[46:47], s45
    s_mov_b32 s58, 0x0fff0fff
    s_mov_b32 s59, 0
    s_mov_b32 s23, 0xc08a2000
    s_mov_b32 s24, 0xbea20000
    s_mov_b32 s25, 0x3f4a4588
    s_mov_b32 s26, 0x3f100000
    s_mov_b32 s27, 0xbf100000
    s_mov_b32 s28, 0xc05a4588
    s_mov_b32 s29, 0x3fa20000
    s_mov_b32 s30, 0x3ea20000
    s_mov_b32 s31, 0x3e800000
    s_mov_b32 s34, 0x3f900000
    s_mov_b32 s35, 0x3db64000
    s_mov_b32 s22, 0xffff0000
    v_bfe_u32 v6, v254, 6, 2
    v_mul_u32_u24 v4, 40704, v6
    v_and_b32 v6, 0x80, v254
    v_lshrrev_b32 v6, 1, v6
    v_add_u32 v4, v4, v6
    v_and_b32 v6, 0x40, v254
    v_lshrrev_b32 v6, 2, v6
    v_add_u32 v4, v4, v6
    v_bfe_u32 v6, v254, 4, 2
    v_mul_u32_u24 v6, 3104, v6
    v_add_u32 v4, v4, v6
    v_add_u32 v4, s52, v4
    v_lshrrev_b32 v6, 8, v254
    v_lshl_add_u32 v5, v6, 3, v4
    v_lshl_add_u32 v4, v6, 4, v4
    v_add_u32 v6, s51, v254
    v_mov_b32 v192, 0
    v_mov_b32 v193, 0
    v_mov_b32 v203, 0
    v_mov_b32 v215, 0
    v_mov_b32 v224, 0
    v_mov_b32 v227, 0
    v_mov_b32 v252, 0
    s_mov_b32 s42, 0
    s_cmp_gt_u32 s48, 0
    s_cselect_b32 s45, 384, 0
    s_cselect_b32 s55, 0, 2130706432
    s_add_u32 s50, s50, s45
    s_add_u32 s54, s45, 49152
    s_cmp_eq_u32 s48, 3
    s_cselect_b32 s54, 2130706432, s54
    s_mov_b32 s56, 0xffff0000
    s_mov_b32 s57, 0
    s_cmp_ge_u32 s2, 54
    s_cbranch_scc1 pub_skip
    s_branch do_warm
wt_ret:
    s_mov_b32 s87, 1
    s_cmp_lg_u32 s38, 0
    s_waitcnt vmcnt(0)
    s_barrier
    s_cbranch_scc1 wt_pub
    s_atomic_add s87, s[68:69], 0 glc
    s_waitcnt lgkmcnt(0)
    s_cmp_lg_u32 s87, 53
    s_cbranch_scc1 wt_pub
    s_atomic_add s87, s[68:69], 128
wt_pub:
    buffer_load_dwordx2 v[20:21], v80, s[4:7], s16 offen offset:384
    buffer_load_dwordx2 v[22:23], v80, s[4:7], s17 offen offset:384
    buffer_load_dwordx2 v[24:25], v80, s[4:7], s18 offen offset:384
    buffer_load_dwordx2 v[26:27], v80, s[4:7], s19 offen offset:384
    buffer_load_dwordx2 v[28:29], v80, s[4:7], s20 offen offset:384
    buffer_load_dwordx2 v[30:31], v80, s[4:7], s21 offen offset:384
pub_skip:
    v_and_b32 v67, 0xf0, v254
    v_lshrrev_b32 v67, 1, v67
    v_add_u32 v67, s52, v67
    v_mov_b32 v66, s54
    v_mov_b32 v65, s55
    v_cndmask_b32 v66, v66, v65, s[56:57]
    v_add_u32 v67, v67, v66
    s_sub_u32 s45, s16, s50
    buffer_load_dwordx2 v[56:57], v67, s[4:7], s45 offen
    s_sub_u32 s45, s17, s50
    buffer_load_dwordx2 v[58:59], v67, s[4:7], s45 offen
    s_sub_u32 s45, s18, s50
    buffer_load_dwordx2 v[60:61], v67, s[4:7], s45 offen
    s_sub_u32 s45, s19, s50
    buffer_load_dwordx2 v[62:63], v67, s[4:7], s45 offen
    s_sub_u32 s45, s20, s50
    buffer_load_dwordx2 v[64:65], v67, s[4:7], s45 offen
    s_sub_u32 s45, s21, s50
    buffer_load_dwordx2 v[66:67], v67, s[4:7], s45 offen
    buffer_load_dwordx2 v[32:33], v80, s[4:7], s16 offen offset:768
    buffer_load_dwordx2 v[34:35], v80, s[4:7], s17 offen offset:768
    buffer_load_dwordx2 v[36:37], v80, s[4:7], s18 offen offset:768
    buffer_load_dwordx2 v[38:39], v80, s[4:7], s19 offen offset:768
    buffer_load_dwordx2 v[40:41], v80, s[4:7], s20 offen offset:768
    buffer_load_dwordx2 v[42:43], v80, s[4:7], s21 offen offset:768
    buffer_load_dwordx2 v[44:45], v80, s[4:7], s16 offen offset:1152
    buffer_load_dwordx2 v[46:47], v80, s[4:7], s17 offen offset:1152
    buffer_load_dwordx2 v[48:49], v80, s[4:7], s18 offen offset:1152
    buffer_load_dwordx2 v[50:51], v80, s[4:7], s19 offen offset:1152
    buffer_load_dwordx2 v[52:53], v80, s[4:7], s20 offen offset:1152
    buffer_load_dwordx2 v[54:55], v80, s[4:7], s21 offen offset:1152
    s_waitcnt vmcnt(24)
    v_lshlrev_b32 v176, 16, v8
    v_and_b32 v177, s22, v8
    v_lshlrev_b32 v178, 16, v10
    v_and_b32 v179, s22, v10
    v_lshlrev_b32 v180, 16, v12
    v_and_b32 v181, s22, v12
    v_lshlrev_b32 v182, 16, v14
    v_and_b32 v183, s22, v14
    v_lshlrev_b32 v184, 16, v16
    v_and_b32 v185, s22, v16
    v_lshlrev_b32 v186, 16, v18
    v_and_b32 v187, s22, v18
    v_pk_fma_f32 v[176:177], v[184:185], s[24:25], v[176:177] op_sel:[0,1,0]
    v_pk_fma_f32 v[186:187], v[178:179], s[28:29], v[186:187] op_sel:[0,1,0]
    v_pk_fma_f32 v[176:177], v[180:181], s[28:29], v[176:177] op_sel_hi:[1,0,1]
    v_pk_fma_f32 v[186:187], v[182:183], s[22:23], v[186:187] op_sel:[0,1,0]
    v_pk_fma_f32 v[188:189], v[180:181], s[24:25], v[184:185] op_sel_hi:[1,0,1]
    v_pk_fma_f32 v[184:185], v[180:181], -4.0, v[184:185] op_sel_hi:[1,0,1]
    v_pk_fma_f32 v[180:181], v[178:179], s[24:25], v[182:183] op_sel_hi:[1,0,1]
    v_pk_fma_f32 v[182:183], v[178:179], -4.0, v[182:183] op_sel_hi:[1,0,1]
    v_pk_fma_f32 v[178:179], v[182:183], s[26:27], v[184:185] op_sel_hi:[1,0,1]
    v_pk_fma_f32 v[184:185], v[182:183], s[26:27], v[184:185] op_sel:[0,1,0]
    v_pk_fma_f32 v[182:183], v[180:181], 2.0, v[188:189] op_sel_hi:[1,0,1]
    v_pk_fma_f32 v[180:181], v[180:181], -2.0, v[188:189] op_sel_hi:[1,0,1]
    v_cvt_pk_bf16_f32 v8, v176, v177
    v_cvt_pk_bf16_f32 v10, v178, v179
    v_cvt_pk_bf16_f32 v12, v180, v181
    v_cvt_pk_bf16_f32 v14, v182, v183
    v_cvt_pk_bf16_f32 v16, v184, v185
    v_cvt_pk_bf16_f32 v18, v186, v187
    v_lshlrev_b32 v176, 16, v9
    v_and_b32 v177, s22, v9
    v_lshlrev_b32 v178, 16, v11
    v_and_b32 v179, s22, v11
    v_lshlrev_b32 v180, 16, v13
    v_and_b32 v181, s22, v13
    v_lshlrev_b32 v182, 16, v15
    v_and_b32 v183, s22, v15
    v_lshlrev_b32 v184, 16, v17
    v_and_b32 v185, s22, v17
    v_lshlrev_b32 v186, 16, v19
    v_and_b32 v187, s22, v19
    v_pk_fma_f32 v[176:177], v[184:185], s[24:25], v[176:177] op_sel:[0,1,0]
    v_pk_fma_f32 v[186:187], v[178:179], s[28:29], v[186:187] op_sel:[0,1,0]
    v_pk_fma_f32 v[176:177], v[180:181], s[28:29], v[176:177] op_sel_hi:[1,0,1]
    v_pk_fma_f32 v[186:187], v[182:183], s[22:23], v[186:187] op_sel:[0,1,0]
    v_pk_fma_f32 v[188:189], v[180:181], s[24:25], v[184:185] op_sel_hi:[1,0,1]
    v_pk_fma_f32 v[184:185], v[180:181], -4.0, v[184:185] op_sel_hi:[1,0,1]
    v_pk_fma_f32 v[180:181], v[178:179], s[24:25], v[182:183] op_sel_hi:[1,0,1]
    v_pk_fma_f32 v[182:183], v[178:179], -4.0, v[182:183] op_sel_hi:[1,0,1]
    v_pk_fma_f32 v[178:179], v[182:183], s[26:27], v[184:185] op_sel_hi:[1,0,1]
    v_pk_fma_f32 v[184:185], v[182:183], s[26:27], v[184:185] op_sel:[0,1,0]
    v_pk_fma_f32 v[182:183], v[180:181], 2.0, v[188:189] op_sel_hi:[1,0,1]
    v_pk_fma_f32 v[180:181], v[180:181], -2.0, v[188:189] op_sel_hi:[1,0,1]
    v_cvt_pk_bf16_f32 v9, v176, v177
    v_cvt_pk_bf16_f32 v11, v178, v179
    v_cvt_pk_bf16_f32 v13, v180, v181
    v_cvt_pk_bf16_f32 v15, v182, v183
    v_cvt_pk_bf16_f32 v17, v184, v185
    v_cvt_pk_bf16_f32 v19, v186, v187
    v_lshrrev_b32 v252, 15, v255
    ds_write_b64 v252, v[8:9] offset:34048
    ds_write_b64 v252, v[10:11] offset:768
    ds_write_b64 v252, v[16:17] offset:2848
    ds_write_b64 v252, v[14:15] offset:4928
    ds_write_b64 v252, v[12:13] offset:7008
    ds_write_b64 v252, v[18:19] offset:36128
    s_waitcnt vmcnt(18)
    v_lshlrev_b32 v176, 16, v20
    v_and_b32 v177, s22, v20
    v_lshlrev_b32 v178, 16, v22
    v_and_b32 v179, s22, v22
    v_lshlrev_b32 v180, 16, v24
    v_and_b32 v181, s22, v24
    v_lshlrev_b32 v182, 16, v26
    v_and_b32 v183, s22, v26
    v_lshlrev_b32 v184, 16, v28
    v_and_b32 v185, s22, v28
    v_lshlrev_b32 v186, 16, v30
    v_and_b32 v187, s22, v30
    v_pk_fma_f32 v[176:177], v[184:185], s[24:25], v[176:177] op_sel:[0,1,0]
    v_pk_fma_f32 v[186:187], v[178:179], s[28:29], v[186:187] op_sel:[0,1,0]
    v_pk_fma_f32 v[176:177], v[180:181], s[28:29], v[176:177] op_sel_hi:[1,0,1]
    v_pk_fma_f32 v[186:187], v[182:183], s[22:23], v[186:187] op_sel:[0,1,0]
    v_pk_fma_f32 v[188:189], v[180:181], s[24:25], v[184:185] op_sel_hi:[1,0,1]
    v_pk_fma_f32 v[184:185], v[180:181], -4.0, v[184:185] op_sel_hi:[1,0,1]
    v_pk_fma_f32 v[180:181], v[178:179], s[24:25], v[182:183] op_sel_hi:[1,0,1]
    v_pk_fma_f32 v[182:183], v[178:179], -4.0, v[182:183] op_sel_hi:[1,0,1]
    v_pk_fma_f32 v[178:179], v[182:183], s[26:27], v[184:185] op_sel_hi:[1,0,1]
    v_pk_fma_f32 v[184:185], v[182:183], s[26:27], v[184:185] op_sel:[0,1,0]
    v_pk_fma_f32 v[182:183], v[180:181], 2.0, v[188:189] op_sel_hi:[1,0,1]
    v_pk_fma_f32 v[180:181], v[180:181], -2.0, v[188:189] op_sel_hi:[1,0,1]
    v_cvt_pk_bf16_f32 v20, v176, v177
    v_cvt_pk_bf16_f32 v22, v178, v179
    v_cvt_pk_bf16_f32 v24, v180, v181
    v_cvt_pk_bf16_f32 v26, v182, v183
    v_cvt_pk_bf16_f32 v28, v184, v185
    v_cvt_pk_bf16_f32 v30, v186, v187
    v_lshlrev_b32 v176, 16, v21
    v_and_b32 v177, s22, v21
    v_lshlrev_b32 v178, 16, v23
    v_and_b32 v179, s22, v23
    v_lshlrev_b32 v180, 16, v25
    v_and_b32 v181, s22, v25
    v_lshlrev_b32 v182, 16, v27
    v_and_b32 v183, s22, v27
    v_lshlrev_b32 v184, 16, v29
    v_and_b32 v185, s22, v29
    v_lshlrev_b32 v186, 16, v31
    v_and_b32 v187, s22, v31
    v_pk_fma_f32 v[176:177], v[184:185], s[24:25], v[176:177] op_sel:[0,1,0]
    v_pk_fma_f32 v[186:187], v[178:179], s[28:29], v[186:187] op_sel:[0,1,0]
    v_pk_fma_f32 v[176:177], v[180:181], s[28:29], v[176:177] op_sel_hi:[1,0,1]
    v_pk_fma_f32 v[186:187], v[182:183], s[22:23], v[186:187] op_sel:[0,1,0]
    v_pk_fma_f32 v[188:189], v[180:181], s[24:25], v[184:185] op_sel_hi:[1,0,1]
    v_pk_fma_f32 v[184:185], v[180:181], -4.0, v[184:185] op_sel_hi:[1,0,1]
    v_pk_fma_f32 v[180:181], v[178:179], s[24:25], v[182:183] op_sel_hi:[1,0,1]
    v_pk_fma_f32 v[182:183], v[178:179], -4.0, v[182:183] op_sel_hi:[1,0,1]
    v_pk_fma_f32 v[178:179], v[182:183], s[26:27], v[184:185] op_sel_hi:[1,0,1]
    v_pk_fma_f32 v[184:185], v[182:183], s[26:27], v[184:185] op_sel:[0,1,0]
    v_pk_fma_f32 v[182:183], v[180:181], 2.0, v[188:189] op_sel_hi:[1,0,1]
    v_pk_fma_f32 v[180:181], v[180:181], -2.0, v[188:189] op_sel_hi:[1,0,1]
    v_cvt_pk_bf16_f32 v21, v176, v177
    v_cvt_pk_bf16_f32 v23, v178, v179
    v_cvt_pk_bf16_f32 v25, v180, v181
    v_cvt_pk_bf16_f32 v27, v182, v183
    v_cvt_pk_bf16_f32 v29, v184, v185
    v_cvt_pk_bf16_f32 v31, v186, v187
    v_lshrrev_b32 v252, 15, v255
    ds_write_b64 v252, v[20:21] offset:33792
    ds_write_b64 v252, v[22:23] offset:512
    ds_write_b64 v252, v[28:29] offset:2592
    ds_write_b64 v252, v[26:27] offset:4672
    ds_write_b64 v252, v[24:25] offset:6752
    ds_write_b64 v252, v[30:31] offset:35872
    s_waitcnt vmcnt(12)
    v_lshlrev_b32 v176, 16, v56
    v_and_b32 v177, s22, v56
    v_lshlrev_b32 v178, 16, v58
    v_and_b32 v179, s22, v58
    v_lshlrev_b32 v180, 16, v60
    v_and_b32 v181, s22, v60
    v_lshlrev_b32 v182, 16, v62
    v_and_b32 v183, s22, v62
    v_lshlrev_b32 v184, 16, v64
    v_and_b32 v185, s22, v64
    v_lshlrev_b32 v186, 16, v66
    v_and_b32 v187, s22, v66
    v_pk_fma_f32 v[176:177], v[184:185], s[24:25], v[176:177] op_sel:[0,1,0]
    v_pk_fma_f32 v[186:187], v[178:179], s[28:29], v[186:187] op_sel:[0,1,0]
    v_pk_fma_f32 v[176:177], v[180:181], s[28:29], v[176:177] op_sel_hi:[1,0,1]
    v_pk_fma_f32 v[186:187], v[182:183], s[22:23], v[186:187] op_sel:[0,1,0]
    v_pk_fma_f32 v[188:189], v[180:181], s[24:25], v[184:185] op_sel_hi:[1,0,1]
    v_pk_fma_f32 v[184:185], v[180:181], -4.0, v[184:185] op_sel_hi:[1,0,1]
    v_pk_fma_f32 v[180:181], v[178:179], s[24:25], v[182:183] op_sel_hi:[1,0,1]
    v_pk_fma_f32 v[182:183], v[178:179], -4.0, v[182:183] op_sel_hi:[1,0,1]
    v_pk_fma_f32 v[178:179], v[182:183], s[26:27], v[184:185] op_sel_hi:[1,0,1]
    v_pk_fma_f32 v[184:185], v[182:183], s[26:27], v[184:185] op_sel:[0,1,0]
    v_pk_fma_f32 v[182:183], v[180:181], 2.0, v[188:189] op_sel_hi:[1,0,1]
    v_pk_fma_f32 v[180:181], v[180:181], -2.0, v[188:189] op_sel_hi:[1,0,1]
    v_cvt_pk_bf16_f32 v56, v176, v177
    v_cvt_pk_bf16_f32 v58, v178, v179
    v_cvt_pk_bf16_f32 v60, v180, v181
    v_cvt_pk_bf16_f32 v62, v182, v183
    v_cvt_pk_bf16_f32 v64, v184, v185
    v_cvt_pk_bf16_f32 v66, v186, v187
    v_lshlrev_b32 v176, 16, v57
    v_and_b32 v177, s22, v57
    v_lshlrev_b32 v178, 16, v59
    v_and_b32 v179, s22, v59
    v_lshlrev_b32 v180, 16, v61
    v_and_b32 v181, s22, v61
    v_lshlrev_b32 v182, 16, v63
    v_and_b32 v183, s22, v63
    v_lshlrev_b32 v184, 16, v65
    v_and_b32 v185, s22, v65
    v_lshlrev_b32 v186, 16, v67
    v_and_b32 v187, s22, v67
    v_pk_fma_f32 v[176:177], v[184:185], s[24:25], v[176:177] op_sel:[0,1,0]
    v_pk_fma_f32 v[186:187], v[178:179], s[28:29], v[186:187] op_sel:[0,1,0]
    v_pk_fma_f32 v[176:177], v[180:181], s[28:29], v[176:177] op_sel_hi:[1,0,1]
    v_pk_fma_f32 v[186:187], v[182:183], s[22:23], v[186:187] op_sel:[0,1,0]
    v_pk_fma_f32 v[188:189], v[180:181], s[24:25], v[184:185] op_sel_hi:[1,0,1]
    v_pk_fma_f32 v[184:185], v[180:181], -4.0, v[184:185] op_sel_hi:[1,0,1]
    v_pk_fma_f32 v[180:181], v[178:179], s[24:25], v[182:183] op_sel_hi:[1,0,1]
    v_pk_fma_f32 v[182:183], v[178:179], -4.0, v[182:183] op_sel_hi:[1,0,1]
    v_pk_fma_f32 v[178:179], v[182:183], s[26:27], v[184:185] op_sel_hi:[1,0,1]
    v_pk_fma_f32 v[184:185], v[182:183], s[26:27], v[184:185] op_sel:[0,1,0]
    v_pk_fma_f32 v[182:183], v[180:181], 2.0, v[188:189] op_sel_hi:[1,0,1]
    v_pk_fma_f32 v[180:181], v[180:181], -2.0, v[188:189] op_sel_hi:[1,0,1]
    v_cvt_pk_bf16_f32 v57, v176, v177
    v_cvt_pk_bf16_f32 v59, v178, v179
    v_cvt_pk_bf16_f32 v61, v180, v181
    v_cvt_pk_bf16_f32 v63, v182, v183
    v_cvt_pk_bf16_f32 v65, v184, v185
    v_cvt_pk_bf16_f32 v67, v186, v187
    v_and_b32 v248, 0xf0, v254
    v_lshrrev_b32 v248, 1, v248
    v_add_u32 v248, s52, v248
    v_and_b32 v252, 8, v248
    v_lshrrev_b32 v249, 6, v248
    v_mul_u32_u24 v249, 192, v249
    v_cmp_eq_u32 s[92:93], 0, v249
    v_add_u32 v252, v252, v249
    v_bfe_u32 v249, v248, 4, 2
    v_mul_u32_u24 v249, 40704, v249
    v_add_u32 v252, v252, v249
    v_and_b32 v249, 32, v248
    v_lshl_add_u32 v252, v249, 1, v252
    v_bfe_u32 v249, v254, 8, 1
    v_lshl_add_u32 v252, v249, 4, v252
    v_mov_b32 v249, 123328
    v_cndmask_b32 v252, v249, v252, s[58:59]
    ds_write_b64 v252, v[56:57] offset:39520
    ds_write_b64 v252, v[58:59] offset:39552
    ds_write_b64 v252, v[64:65] offset:39584
    ds_write_b64 v252, v[62:63] offset:39616
    ds_write_b64 v252, v[60:61] offset:39648
    ds_write_b64 v252, v[66:67] offset:39680
    s_and_b64 exec, s[92:93], s[58:59]
    ds_write_b64 v252, v[56:57] offset:34304
    ds_write_b64 v252, v[58:59] offset:1024
    ds_write_b64 v252, v[64:65] offset:3104
    ds_write_b64 v252, v[62:63] offset:5184
    ds_write_b64 v252, v[60:61] offset:7264
    ds_write_b64 v252, v[66:67] offset:36384
    s_mov_b64 exec, -1
    v_and_b32 v203, 0x7fff, v255
    buffer_load_dwordx2 v[192:193], v203, s[4:7], s16 offen offset:64
    buffer_load_dwordx2 v[194:195], v203, s[4:7], s17 offen offset:64
    buffer_load_dwordx2 v[196:197], v203, s[4:7], s18 offen offset:64
    buffer_load_dwordx2 v[198:199], v203, s[4:7], s19 offen offset:64
    buffer_load_dwordx2 v[200:201], v203, s[4:7], s20 offen offset:64
    buffer_load_dwordx2 v[202:203], v203, s[4:7], s21 offen offset:64
    v_and_b32 v215, 0x7fff, v255
    buffer_load_dwordx2 v[204:205], v215, s[4:7], s16 offen offset:448
    buffer_load_dwordx2 v[206:207], v215, s[4:7], s17 offen offset:448
    buffer_load_dwordx2 v[208:209], v215, s[4:7], s18 offen offset:448
    buffer_load_dwordx2 v[210:211], v215, s[4:7], s19 offen offset:448
    buffer_load_dwordx2 v[212:213], v215, s[4:7], s20 offen offset:448
    buffer_load_dwordx2 v[214:215], v215, s[4:7], s21 offen offset:448
    s_waitcnt vmcnt(18)
    v_lshlrev_b32 v176, 16, v32
    v_and_b32 v177, s22, v32
    v_lshlrev_b32 v178, 16, v34
    v_and_b32 v179, s22, v34
    v_lshlrev_b32 v180, 16, v36
    v_and_b32 v181, s22, v36
    v_lshlrev_b32 v182, 16, v38
    v_and_b32 v183, s22, v38
    v_lshlrev_b32 v184, 16, v40
    v_and_b32 v185, s22, v40
    v_lshlrev_b32 v186, 16, v42
    v_and_b32 v187, s22, v42
    v_pk_fma_f32 v[176:177], v[184:185], s[24:25], v[176:177] op_sel:[0,1,0]
    v_pk_fma_f32 v[186:187], v[178:179], s[28:29], v[186:187] op_sel:[0,1,0]
    v_pk_fma_f32 v[176:177], v[180:181], s[28:29], v[176:177] op_sel_hi:[1,0,1]
    v_pk_fma_f32 v[186:187], v[182:183], s[22:23], v[186:187] op_sel:[0,1,0]
    v_pk_fma_f32 v[188:189], v[180:181], s[24:25], v[184:185] op_sel_hi:[1,0,1]
    v_pk_fma_f32 v[184:185], v[180:181], -4.0, v[184:185] op_sel_hi:[1,0,1]
    v_pk_fma_f32 v[180:181], v[178:179], s[24:25], v[182:183] op_sel_hi:[1,0,1]
    v_pk_fma_f32 v[182:183], v[178:179], -4.0, v[182:183] op_sel_hi:[1,0,1]
    v_pk_fma_f32 v[178:179], v[182:183], s[26:27], v[184:185] op_sel_hi:[1,0,1]
    v_pk_fma_f32 v[184:185], v[182:183], s[26:27], v[184:185] op_sel:[0,1,0]
    v_pk_fma_f32 v[182:183], v[180:181], 2.0, v[188:189] op_sel_hi:[1,0,1]
    v_pk_fma_f32 v[180:181], v[180:181], -2.0, v[188:189] op_sel_hi:[1,0,1]
    v_cvt_pk_bf16_f32 v32, v176, v177
    v_cvt_pk_bf16_f32 v34, v178, v179
    v_cvt_pk_bf16_f32 v36, v180, v181
    v_cvt_pk_bf16_f32 v38, v182, v183
    v_cvt_pk_bf16_f32 v40, v184, v185
    v_cvt_pk_bf16_f32 v42, v186, v187
    v_lshlrev_b32 v176, 16, v33
    v_and_b32 v177, s22, v33
    v_lshlrev_b32 v178, 16, v35
    v_and_b32 v179, s22, v35
    v_lshlrev_b32 v180, 16, v37
    v_and_b32 v181, s22, v37
    v_lshlrev_b32 v182, 16, v39
    v_and_b32 v183, s22, v39
    v_lshlrev_b32 v184, 16, v41
    v_and_b32 v185, s22, v41
    v_lshlrev_b32 v186, 16, v43
    v_and_b32 v187, s22, v43
    v_pk_fma_f32 v[176:177], v[184:185], s[24:25], v[176:177] op_sel:[0,1,0]
    v_pk_fma_f32 v[186:187], v[178:179], s[28:29], v[186:187] op_sel:[0,1,0]
    v_pk_fma_f32 v[176:177], v[180:181], s[28:29], v[176:177] op_sel_hi:[1,0,1]
    v_pk_fma_f32 v[186:187], v[182:183], s[22:23], v[186:187] op_sel:[0,1,0]
    v_pk_fma_f32 v[188:189], v[180:181], s[24:25], v[184:185] op_sel_hi:[1,0,1]
    v_pk_fma_f32 v[184:185], v[180:181], -4.0, v[184:185] op_sel_hi:[1,0,1]
    v_pk_fma_f32 v[180:181], v[178:179], s[24:25], v[182:183] op_sel_hi:[1,0,1]
    v_pk_fma_f32 v[182:183], v[178:179], -4.0, v[182:183] op_sel_hi:[1,0,1]
    v_pk_fma_f32 v[178:179], v[182:183], s[26:27], v[184:185] op_sel_hi:[1,0,1]
    v_pk_fma_f32 v[184:185], v[182:183], s[26:27], v[184:185] op_sel:[0,1,0]
    v_pk_fma_f32 v[182:183], v[180:181], 2.0, v[188:189] op_sel_hi:[1,0,1]
    v_pk_fma_f32 v[180:181], v[180:181], -2.0, v[188:189] op_sel_hi:[1,0,1]
    v_cvt_pk_bf16_f32 v33, v176, v177
    v_cvt_pk_bf16_f32 v35, v178, v179
    v_cvt_pk_bf16_f32 v37, v180, v181
    v_cvt_pk_bf16_f32 v39, v182, v183
    v_cvt_pk_bf16_f32 v41, v184, v185
    v_cvt_pk_bf16_f32 v43, v186, v187
    v_lshrrev_b32 v252, 15, v255
    ds_write_b64 v252, v[32:33] offset:33536
    ds_write_b64 v252, v[34:35] offset:256
    ds_write_b64 v252, v[40:41] offset:2336
    ds_write_b64 v252, v[38:39] offset:4416
    ds_write_b64 v252, v[36:37] offset:6496
    ds_write_b64 v252, v[42:43] offset:35616
    s_waitcnt vmcnt(12)
    v_lshlrev_b32 v176, 16, v44
    v_and_b32 v177, s22, v44
    v_lshlrev_b32 v178, 16, v46
    v_and_b32 v179, s22, v46
    v_lshlrev_b32 v180, 16, v48
    v_and_b32 v181, s22, v48
    v_lshlrev_b32 v182, 16, v50
    v_and_b32 v183, s22, v50
    v_lshlrev_b32 v184, 16, v52
    v_and_b32 v185, s22, v52
    v_lshlrev_b32 v186, 16, v54
    v_and_b32 v187, s22, v54
    v_pk_fma_f32 v[176:177], v[184:185], s[24:25], v[176:177] op_sel:[0,1,0]
    v_pk_fma_f32 v[186:187], v[178:179], s[28:29], v[186:187] op_sel:[0,1,0]
    v_pk_fma_f32 v[176:177], v[180:181], s[28:29], v[176:177] op_sel_hi:[1,0,1]
    v_pk_fma_f32 v[186:187], v[182:183], s[22:23], v[186:187] op_sel:[0,1,0]
    v_pk_fma_f32 v[188:189], v[180:181], s[24:25], v[184:185] op_sel_hi:[1,0,1]
    v_pk_fma_f32 v[184:185], v[180:181], -4.0, v[184:185] op_sel_hi:[1,0,1]
    v_pk_fma_f32 v[180:181], v[178:179], s[24:25], v[182:183] op_sel_hi:[1,0,1]
    v_pk_fma_f32 v[182:183], v[178:179], -4.0, v[182:183] op_sel_hi:[1,0,1]
    v_pk_fma_f32 v[178:179], v[182:183], s[26:27], v[184:185] op_sel_hi:[1,0,1]
    v_pk_fma_f32 v[184:185], v[182:183], s[26:27], v[184:185] op_sel:[0,1,0]
    v_pk_fma_f32 v[182:183], v[180:181], 2.0, v[188:189] op_sel_hi:[1,0,1]
    v_pk_fma_f32 v[180:181], v[180:181], -2.0, v[188:189] op_sel_hi:[1,0,1]
    v_cvt_pk_bf16_f32 v44, v176, v177
    v_cvt_pk_bf16_f32 v46, v178, v179
    v_cvt_pk_bf16_f32 v48, v180, v181
    v_cvt_pk_bf16_f32 v50, v182, v183
    v_cvt_pk_bf16_f32 v52, v184, v185
    v_cvt_pk_bf16_f32 v54, v186, v187
    v_lshlrev_b32 v176, 16, v45
    v_and_b32 v177, s22, v45
    v_lshlrev_b32 v178, 16, v47
    v_and_b32 v179, s22, v47
    v_lshlrev_b32 v180, 16, v49
    v_and_b32 v181, s22, v49
    v_lshlrev_b32 v182, 16, v51
    v_and_b32 v183, s22, v51
    v_lshlrev_b32 v184, 16, v53
    v_and_b32 v185, s22, v53
    v_lshlrev_b32 v186, 16, v55
    v_and_b32 v187, s22, v55
    v_pk_fma_f32 v[176:177], v[184:185], s[24:25], v[176:177] op_sel:[0,1,0]
    v_pk_fma_f32 v[186:187], v[178:179], s[28:29], v[186:187] op_sel:[0,1,0]
    v_pk_fma_f32 v[176:177], v[180:181], s[28:29], v[176:177] op_sel_hi:[1,0,1]
    v_pk_fma_f32 v[186:187], v[182:183], s[22:23], v[186:187] op_sel:[0,1,0]
    v_pk_fma_f32 v[188:189], v[180:181], s[24:25], v[184:185] op_sel_hi:[1,0,1]
    v_pk_fma_f32 v[184:185], v[180:181], -4.0, v[184:185] op_sel_hi:[1,0,1]
    v_pk_fma_f32 v[180:181], v[178:179], s[24:25], v[182:183] op_sel_hi:[1,0,1]
    v_pk_fma_f32 v[182:183], v[178:179], -4.0, v[182:183] op_sel_hi:[1,0,1]
    v_pk_fma_f32 v[178:179], v[182:183], s[26:27], v[184:185] op_sel_hi:[1,0,1]
    v_pk_fma_f32 v[184:185], v[182:183], s[26:27], v[184:185] op_sel:[0,1,0]
    v_pk_fma_f32 v[182:183], v[180:181], 2.0, v[188:189] op_sel_hi:[1,0,1]
    v_pk_fma_f32 v[180:181], v[180:181], -2.0, v[188:189] op_sel_hi:[1,0,1]
    v_cvt_pk_bf16_f32 v45, v176, v177
    v_cvt_pk_bf16_f32 v47, v178, v179
    v_cvt_pk_bf16_f32 v49, v180, v181
    v_cvt_pk_bf16_f32 v51, v182, v183
    v_cvt_pk_bf16_f32 v53, v184, v185
    v_cvt_pk_bf16_f32 v55, v186, v187
    v_lshrrev_b32 v252, 15, v255
    ds_write_b64 v252, v[44:45] offset:33280
    ds_write_b64 v252, v[46:47] offset:0
    ds_write_b64 v252, v[52:53] offset:2080
    ds_write_b64 v252, v[50:51] offset:4160
    ds_write_b64 v252, v[48:49] offset:6240
    ds_write_b64 v252, v[54:55] offset:35360
    buffer_load_dword v97, v98, s[64:67], 0 offen offset:128 sc1
no_poll:
    s_cmp_lt_u32 s2, 54
    s_cbranch_scc1 warm_done
do_warm:
    s_mov_b64 vcc, -1
    s_cmp_eq_u32 s38, 0
    s_cbranch_scc1 pad0
    s_cmp_eq_u32 s38, 1
    s_cbranch_scc1 pad1
    s_cmp_eq_u32 s38, 2
    s_cbranch_scc1 pad2
    s_branch pad3
warm_ret:
    s_mov_b64 vcc, 0
    s_cmp_lt_u32 s2, 54
    s_cbranch_scc1 wt_ret
warm_done:
    s_mov_b32 s86, 0
    s_waitcnt vmcnt(0)
poll_loop:
    v_readfirstlane_b32 s87, v97
    s_add_u32 s86, s86, 1
    s_cmp_lg_u32 s87, 0
    s_cbranch_scc1 u_ready
    buffer_load_dword v97, v98, s[64:67], 0 offen offset:128 sc1
    s_cmp_lt_u32 s86, 512
    s_waitcnt vmcnt(0)
    s_cbranch_scc1 poll_loop
    s_mov_b32 s70, 0
    s_branch wt_loop
u_ready:
    s_mov_b32 s42, 0
    buffer_load_dwordx4 a[192:195], v254, s[8:11], s42 offen offset:0 sc1
    buffer_load_dwordx4 a[196:199], v254, s[8:11], s42 offen offset:1024 sc1
    buffer_load_dwordx4 a[200:203], v254, s[8:11], s42 offen offset:2048 sc1
    s_mov_b32 s42, 3072
    buffer_load_dwordx4 a[204:207], v254, s[8:11], s42 offen offset:0 sc1
    buffer_load_dwordx4 a[208:211], v254, s[8:11], s42 offen offset:1024 sc1
    buffer_load_dwordx4 a[212:215], v254, s[8:11], s42 offen offset:2048 sc1
    s_mov_b32 s42, 6144
    buffer_load_dwordx4 a[216:219], v254, s[8:11], s42 offen offset:0 sc1
    buffer_load_dwordx4 a[220:223], v254, s[8:11], s42 offen offset:1024 sc1
    buffer_load_dwordx4 a[224:227], v254, s[8:11], s42 offen offset:2048 sc1
    s_mov_b32 s42, 36864
    buffer_load_dwordx4 a[228:231], v254, s[8:11], s42 offen offset:0 sc1
    buffer_load_dwordx4 a[232:235], v254, s[8:11], s42 offen offset:1024 sc1
    buffer_load_dwordx4 a[236:239], v254, s[8:11], s42 offen offset:2048 sc1
    s_mov_b32 s42, 39936
    buffer_load_dwordx4 a[240:243], v254, s[8:11], s42 offen offset:0 sc1
    buffer_load_dwordx4 a[244:247], v254, s[8:11], s42 offen offset:1024 sc1
    buffer_load_dwordx4 a[248:251], v254, s[8:11], s42 offen offset:2048 sc1
    s_mov_b32 s42, 43008
    buffer_load_dwordx4 a[252:255], v254, s[8:11], s42 offen offset:0 sc1
    buffer_load_dwordx4 v[240:243], v254, s[8:11], s42 offen offset:1024 sc1
    buffer_load_dwordx4 v[244:247], v254, s[8:11], s42 offen offset:2048 sc1
u_done:
    s_waitcnt lgkmcnt(0)
    s_barrier
    ds_read_b128 v[228:231], v253 offset:1040
    ds_read_b128 v[232:235], v253 offset:768
    ds_read_b128 v[236:239], v253 offset:512
    s_waitcnt vmcnt(9) lgkmcnt(0)
    s_branch blk_loop
.p2align 12
blk_loop:
sub0:
    v_mfma_f32_16x16x32_bf16 a[0:3], a[192:195], v[228:231], 0
pad0:
    s_cbranch_vccnz pad4
    s_add_u32 s44, s41, 7168
    s_waitcnt vmcnt(22)
    v_lshlrev_b32 v248, 16, v194
    v_mfma_f32_16x16x32_bf16 a[4:7], a[196:199], v[228:231], 0
    v_cvt_pk_bf16_f32 v180, v180, v181
    v_cvt_pk_bf16_f32 v181, v182, v183
    v_mfma_f32_16x16x32_bf16 a[8:11], a[200:203], v[228:231], 0
    ds_read_b128 v[228:231], v253 offset:256
    v_cvt_pk_bf16_f32 v182, v184, v185
    v_mfma_f32_16x16x32_bf16 a[8:11], a[212:215], v[232:235], a[8:11]
    s_waitcnt lgkmcnt(2)
    buffer_store_dwordx4 v[120:123], v254, s[12:15], s44 offen nt
    s_add_u32 s44, s41, 10240
    v_cvt_pk_bf16_f32 v183, v186, v187
    v_mfma_f32_16x16x32_bf16 a[4:7], a[208:211], v[232:235], a[4:7]
    ds_write_b128 v4, v[180:183] offset:19328
    v_mfma_f32_16x16x32_bf16 a[0:3], a[204:207], v[232:235], a[0:3]
    v_lshlrev_b32 v249, 16, v196
    v_lshlrev_b32 v250, 16, v198
    v_mfma_f32_16x16x32_bf16 a[0:3], a[216:219], v[236:239], a[0:3]
    s_waitcnt lgkmcnt(2)
    buffer_store_dwordx4 v[124:127], v254, s[12:15], s44 offen nt
    v_lshlrev_b32 v251, 16, v200
    v_and_b32 v194, s22, v194
    v_and_b32 v196, s22, v196
    v_mfma_f32_16x16x32_bf16 a[4:7], a[220:223], v[236:239], a[4:7]
    v_cvt_pk_bf16_f32 v188, v188, v189
    v_cvt_pk_bf16_f32 v189, v190, v191
    v_mfma_f32_16x16x32_bf16 a[8:11], a[224:227], v[236:239], a[8:11]
    ds_write_b64 v5, v[188:189] offset:19392
    v_mfma_f32_16x16x32_bf16 a[12:15], a[192:195], v[232:235], 0
    v_and_b32 v198, s22, v198
    v_and_b32 v200, s22, v200
    v_mfma_f32_16x16x32_bf16 a[12:15], a[204:207], v[236:239], a[12:15]
    s_waitcnt lgkmcnt(2)
    v_lshlrev_b32 v252, 16, v192
    v_and_b32 v192, s22, v192
    v_mfma_f32_16x16x32_bf16 a[12:15], a[216:219], v[228:231], a[12:15]
    v_fmac_f32 v252, s25, v251
    v_fmac_f32 v192, s25, v200
    v_mfma_f32_16x16x32_bf16 a[16:19], a[220:223], v[228:231], 0
    v_fmac_f32 v252, s28, v249
    v_fmac_f32 v192, s28, v196
    v_mfma_f32_16x16x32_bf16 a[16:19], a[208:211], v[236:239], a[16:19]
    v_cvt_pk_bf16_f32 v192, v252, v192
    v_lshlrev_b32 v252, 16, v202
    v_and_b32 v202, s22, v202
    v_mfma_f32_16x16x32_bf16 a[16:19], a[196:199], v[232:235], a[16:19]
    v_fmac_f32 v252, s29, v248
    v_fmac_f32 v202, s29, v194
    v_mfma_f32_16x16x32_bf16 a[20:23], a[200:203], v[232:235], 0
    ds_read_b128 v[232:235], v253 offset:0
    v_fmac_f32 v252, s23, v250
    v_mfma_f32_16x16x32_bf16 a[20:23], a[212:215], v[236:239], a[20:23]
    s_waitcnt lgkmcnt(0)
    v_fmac_f32 v202, s23, v198
    v_cvt_pk_bf16_f32 v202, v252, v202
    v_mfma_f32_16x16x32_bf16 a[20:23], a[224:227], v[228:231], a[20:23]
    s_barrier
    v_mfma_f32_16x16x32_bf16 a[24:27], a[192:195], v[236:239], 0
    ds_read_b128 v[128:131], v6 offset:18688
    v_fma_f32 v252, v249, s24, v251
    v_mfma_f32_16x16x32_bf16 a[24:27], a[204:207], v[228:231], a[24:27]
    v_fmac_f32 v251, -4.0, v249
    v_fma_f32 v249, v248, s24, v250
    v_fmac_f32 v250, -4.0, v248
    v_mfma_f32_16x16x32_bf16 a[24:27], a[216:219], v[232:235], a[24:27]
    v_fma_f32 v248, v250, s26, v251
    v_fmac_f32 v251, s27, v250
    v_mfma_f32_16x16x32_bf16 a[28:31], a[220:223], v[232:235], 0
    v_fma_f32 v250, v249, 2.0, v252
    v_fmac_f32 v252, -2.0, v249
    v_mfma_f32_16x16x32_bf16 a[28:31], a[208:211], v[228:231], a[28:31]
    v_fma_f32 v249, v196, s24, v200
    v_fmac_f32 v200, -4.0, v196
    v_mfma_f32_16x16x32_bf16 a[28:31], a[196:199], v[236:239], a[28:31]
    s_add_u32 s44, s41, 2048
    v_fma_f32 v196, v194, s24, v198
    v_fmac_f32 v198, -4.0, v194
    v_mfma_f32_16x16x32_bf16 a[32:35], a[200:203], v[236:239], 0
    ds_read_b128 v[236:239], v253 offset:1824
    v_fma_f32 v194, v198, s26, v200
    v_mfma_f32_16x16x32_bf16 a[32:35], a[212:215], v[228:231], a[32:35]
    v_fmac_f32 v200, s27, v198
    v_fma_f32 v198, v196, 2.0, v249
    v_mfma_f32_16x16x32_bf16 a[32:35], a[224:227], v[232:235], a[32:35]
    v_fmac_f32 v249, -2.0, v196
    v_cvt_pk_bf16_f32 v194, v248, v194
    v_cvt_pk_bf16_f32 v200, v251, v200
    v_mfma_f32_16x16x32_bf16 a[36:39], a[192:195], v[228:231], 0
    v_and_b32 v227, 0x7fff, v255
    v_cvt_pk_bf16_f32 v198, v250, v198
    v_mfma_f32_16x16x32_bf16 a[36:39], a[204:207], v[232:235], a[36:39]
    s_waitcnt lgkmcnt(0)
    v_cvt_pk_bf16_f32 v196, v252, v249
    v_lshlrev_b32 v248, 16, v195
    v_mfma_f32_16x16x32_bf16 a[36:39], a[216:219], v[236:239], a[36:39]
    buffer_load_dwordx2 v[216:217], v227, s[4:7], s16 offen offset:832
    v_mfma_f32_16x16x32_bf16 a[40:43], a[220:223], v[236:239], 0
    ds_read_b128 v[132:135], v6 offset:21792
    v_mfma_f32_16x16x32_bf16 a[40:43], a[208:211], v[232:235], a[40:43]
    v_lshlrev_b32 v249, 16, v197
    v_lshlrev_b32 v250, 16, v199
    v_mfma_f32_16x16x32_bf16 a[40:43], a[196:199], v[228:231], a[40:43]
    v_lshlrev_b32 v251, 16, v201
    v_and_b32 v195, s22, v195
    v_mfma_f32_16x16x32_bf16 a[44:47], a[200:203], v[228:231], 0
    ds_read_b128 v[228:231], v253 offset:1568
    v_and_b32 v197, s22, v197
    v_and_b32 v199, s22, v199
    v_mfma_f32_16x16x32_bf16 a[44:47], a[212:215], v[232:235], a[44:47]
    buffer_load_dwordx2 v[218:219], v227, s[4:7], s17 offen offset:832
    v_mfma_f32_16x16x32_bf16 a[44:47], a[224:227], v[236:239], a[44:47]
    v_and_b32 v201, s22, v201
    v_lshlrev_b32 v252, 16, v193
    v_mfma_f32_16x16x32_bf16 a[48:51], a[192:195], v[232:235], 0
    v_and_b32 v193, s22, v193
    v_fmac_f32 v252, s25, v251
    v_mfma_f32_16x16x32_bf16 a[48:51], a[204:207], v[236:239], a[48:51]
    s_waitcnt lgkmcnt(0)
    v_fmac_f32 v193, s25, v201
    v_fmac_f32 v252, s28, v249
    v_mfma_f32_16x16x32_bf16 a[48:51], a[216:219], v[228:231], a[48:51]
    buffer_load_dwordx2 v[220:221], v227, s[4:7], s18 offen offset:832
    v_mfma_f32_16x16x32_bf16 a[52:55], a[220:223], v[228:231], 0
    ds_read_b128 v[136:139], v6 offset:24896
    v_fmac_f32 v193, s28, v197
    v_cvt_pk_bf16_f32 v193, v252, v193
    v_mfma_f32_16x16x32_bf16 a[52:55], a[208:211], v[236:239], a[52:55]
    v_lshlrev_b32 v252, 16, v203
    v_and_b32 v203, s22, v203
    v_mfma_f32_16x16x32_bf16 a[52:55], a[196:199], v[232:235], a[52:55]
    v_fmac_f32 v252, s29, v248
    v_fmac_f32 v203, s29, v195
    v_mfma_f32_16x16x32_bf16 a[56:59], a[200:203], v[232:235], 0
    ds_read_b128 v[232:235], v253 offset:1312
    v_fmac_f32 v252, s23, v250
    v_mfma_f32_16x16x32_bf16 a[56:59], a[212:215], v[236:239], a[56:59]
    buffer_load_dwordx2 v[222:223], v227, s[4:7], s19 offen offset:832
    v_mfma_f32_16x16x32_bf16 a[56:59], a[224:227], v[228:231], a[56:59]
    v_fmac_f32 v203, s23, v199
    v_cvt_pk_bf16_f32 v203, v252, v203
    v_mfma_f32_16x16x32_bf16 a[60:63], a[192:195], v[236:239], 0
    v_fma_f32 v252, v249, s24, v251
    v_fmac_f32 v251, -4.0, v249
    v_mfma_f32_16x16x32_bf16 a[60:63], a[204:207], v[228:231], a[60:63]
    s_waitcnt lgkmcnt(0)
    v_fma_f32 v249, v248, s24, v250
    v_fmac_f32 v250, -4.0, v248
    v_fma_f32 v248, v250, s26, v251
    v_mfma_f32_16x16x32_bf16 a[60:63], a[216:219], v[232:235], a[60:63]
    buffer_load_dwordx2 v[224:225], v227, s[4:7], s20 offen offset:832
    v_mfma_f32_16x16x32_bf16 a[64:67], a[220:223], v[232:235], 0
    v_fmac_f32 v251, s27, v250
    v_fma_f32 v250, v249, 2.0, v252
    v_mfma_f32_16x16x32_bf16 a[64:67], a[208:211], v[228:231], a[64:67]
    ds_read_b128 v[140:143], v6 offset:28000
    v_fmac_f32 v252, -2.0, v249
    v_mfma_f32_16x16x32_bf16 a[64:67], a[196:199], v[236:239], a[64:67]
    v_fma_f32 v249, v197, s24, v201
    v_fmac_f32 v201, -4.0, v197
    v_mfma_f32_16x16x32_bf16 a[68:71], a[200:203], v[236:239], 0
    ds_read_b128 v[236:239], v253 offset:1056
    v_fma_f32 v197, v195, s24, v199
    v_mfma_f32_16x16x32_bf16 a[68:71], a[212:215], v[228:231], a[68:71]
    buffer_load_dwordx2 v[226:227], v227, s[4:7], s21 offen offset:832
    v_mfma_f32_16x16x32_bf16 a[68:71], a[224:227], v[232:235], a[68:71]
    v_fmac_f32 v199, -4.0, v195
    v_fma_f32 v195, v199, s26, v201
    v_fmac_f32 v201, s27, v199
    v_mfma_f32_16x16x32_bf16 a[72:75], a[192:195], v[228:231], 0
    buffer_store_dwordx4 v[128:131], v254, s[12:15], s44 offen nt
    s_add_u32 s44, s41, 5120
    v_mfma_f32_16x16x32_bf16 a[72:75], a[204:207], v[232:235], a[72:75]
    s_waitcnt lgkmcnt(0)
    v_fma_f32 v199, v197, 2.0, v249
    v_fmac_f32 v249, -2.0, v197
    v_mfma_f32_16x16x32_bf16 a[72:75], a[216:219], v[236:239], a[72:75]
    v_cvt_pk_bf16_f32 v195, v248, v195
    v_cvt_pk_bf16_f32 v201, v251, v201
    v_mfma_f32_16x16x32_bf16 a[76:79], a[220:223], v[236:239], 0
    buffer_store_dwordx4 v[132:135], v254, s[12:15], s44 offen nt
    v_cvt_pk_bf16_f32 v199, v250, v199
    v_cvt_pk_bf16_f32 v197, v252, v249
    v_mfma_f32_16x16x32_bf16 a[76:79], a[208:211], v[232:235], a[76:79]
    v_lshrrev_b32 v252, 15, v255
    v_mfma_f32_16x16x32_bf16 a[76:79], a[196:199], v[228:231], a[76:79]
    ds_write_b64 v252, v[194:195] offset:9088
    s_waitcnt vmcnt(14)
    v_mfma_f32_16x16x32_bf16 a[80:83], a[200:203], v[228:231], 0
    ds_read_b128 v[228:231], v253 offset:784
    v_lshrrev_b32 v194, 15, v255
    v_mfma_f32_16x16x32_bf16 a[80:83], a[212:215], v[232:235], a[80:83]
    ds_write_b64 v194, v[200:201] offset:11168
    v_mfma_f32_16x16x32_bf16 a[80:83], a[224:227], v[236:239], a[80:83]
    s_mov_b32 s42, 73728
    s_add_u32 s44, s41, 8192
    v_lshlrev_b32 v248, 16, v206
    v_mfma_f32_16x16x32_bf16 a[84:87], a[192:195], v[232:235], 0
    ds_write_b64 v194, v[198:199] offset:13248
    v_mfma_f32_16x16x32_bf16 a[88:91], a[196:199], v[232:235], 0
    v_lshlrev_b32 v249, 16, v208
    v_lshlrev_b32 v250, 16, v210
    v_mfma_f32_16x16x32_bf16 a[92:95], a[200:203], v[232:235], 0
    ds_read_b128 v[232:235], v253 offset:3120
    v_lshlrev_b32 v251, 16, v212
    v_mfma_f32_16x16x32_bf16 a[92:95], a[212:215], v[236:239], a[92:95]
    buffer_load_dwordx4 a[192:195], v254, s[8:11], s42 offen offset:0 sc1
    v_and_b32 v206, s22, v206
    v_mfma_f32_16x16x32_bf16 a[88:91], a[208:211], v[236:239], a[88:91]
    s_waitcnt lgkmcnt(3)
    v_and_b32 v208, s22, v208
    v_and_b32 v210, s22, v210
    v_mfma_f32_16x16x32_bf16 a[84:87], a[204:207], v[236:239], a[84:87]
    ds_read_b128 v[236:239], v253 offset:2848
    v_mfma_f32_16x16x32_bf16 a[84:87], a[216:219], v[228:231], a[84:87]
    buffer_load_dwordx4 a[196:199], v254, s[8:11], s42 offen offset:1024 sc1
    v_mfma_f32_16x16x32_bf16 a[88:91], a[220:223], v[228:231], a[88:91]
    s_waitcnt vmcnt(12) lgkmcnt(1)
    v_and_b32 v212, s22, v212
    v_lshlrev_b32 v252, 16, v204
    v_mfma_f32_16x16x32_bf16 a[92:95], a[224:227], v[228:231], a[92:95]
    ds_read_b128 v[228:231], v253 offset:2592
    v_and_b32 v204, s22, v204
sub1:
    v_mfma_f32_16x16x32_bf16 a[96:99], a[228:231], v[232:235], 0
    buffer_load_dwordx4 a[200:203], v254, s[8:11], s42 offen offset:2048 sc1
    v_mfma_f32_16x16x32_bf16 a[100:103], a[232:235], v[232:235], 0
    s_mov_b32 s42, 76800
    v_fmac_f32 v252, s25, v251
    v_fmac_f32 v204, s25, v212
    v_fmac_f32 v252, s28, v249
    v_mfma_f32_16x16x32_bf16 a[104:107], a[236:239], v[232:235], 0
    ds_read_b128 v[232:235], v253 offset:2336
    s_waitcnt vmcnt(13)
    s_waitcnt lgkmcnt(2)
    v_mfma_f32_16x16x32_bf16 a[104:107], a[248:251], v[236:239], a[104:107]
    ds_write_b64 v194, v[192:193] offset:15328
    v_mfma_f32_16x16x32_bf16 a[100:103], a[244:247], v[236:239], a[100:103]
    buffer_load_dwordx4 a[204:207], v254, s[8:11], s42 offen offset:0 sc1
    v_mfma_f32_16x16x32_bf16 a[96:99], a[240:243], v[236:239], a[96:99]
    s_waitcnt vmcnt(14) lgkmcnt(2)
    v_fmac_f32 v204, s28, v208
    v_cvt_pk_bf16_f32 v204, v252, v204
    v_mfma_f32_16x16x32_bf16 a[96:99], a[252:255], v[228:231], a[96:99]
    buffer_store_dwordx4 v[136:139], v254, s[12:15], s44 offen nt
    v_lshlrev_b32 v252, 16, v214
    v_and_b32 v214, s22, v214
    v_mfma_f32_16x16x32_bf16 a[100:103], v[240:243], v[228:231], a[100:103]
    ds_write_b64 v194, v[202:203] offset:38208
    v_fmac_f32 v252, s29, v248
    v_mfma_f32_16x16x32_bf16 a[104:107], v[244:247], v[228:231], a[104:107]
    buffer_load_dwordx4 a[208:211], v254, s[8:11], s42 offen offset:1024 sc1
    v_mfma_f32_16x16x32_bf16 a[108:111], a[228:231], v[236:239], 0
    s_add_u32 s44, s41, 11264
    v_fmac_f32 v214, s29, v206
    v_fmac_f32 v252, s23, v250
    v_mfma_f32_16x16x32_bf16 a[108:111], a[240:243], v[228:231], a[108:111]
    s_waitcnt lgkmcnt(2)
    v_fmac_f32 v214, s23, v210
    v_cvt_pk_bf16_f32 v214, v252, v214
    v_mfma_f32_16x16x32_bf16 a[108:111], a[252:255], v[232:235], a[108:111]
    ds_write_b64 v194, v[196:197] offset:31968
    v_mfma_f32_16x16x32_bf16 a[112:115], v[240:243], v[232:235], 0
    buffer_load_dwordx4 a[212:215], v254, s[8:11], s42 offen offset:2048 sc1
    v_mfma_f32_16x16x32_bf16 a[112:115], a[244:247], v[228:231], a[112:115]
    s_mov_b32 s42, 79872
    v_fma_f32 v252, v249, s24, v251
    v_fmac_f32 v251, -4.0, v249
    v_mfma_f32_16x16x32_bf16 a[112:115], a[232:235], v[236:239], a[112:115]
    v_fma_f32 v249, v248, s24, v250
    v_fmac_f32 v250, -4.0, v248
    v_fma_f32 v248, v250, s26, v251
    v_mfma_f32_16x16x32_bf16 a[116:119], a[236:239], v[236:239], 0
    ds_read_b128 v[236:239], v253 offset:2080
    v_fmac_f32 v251, s27, v250
    v_mfma_f32_16x16x32_bf16 a[116:119], a[248:251], v[228:231], a[116:119]
    buffer_load_dwordx4 a[216:219], v254, s[8:11], s42 offen offset:0 sc1
    v_mfma_f32_16x16x32_bf16 a[116:119], v[244:247], v[232:235], a[116:119]
    v_fma_f32 v250, v249, 2.0, v252
    v_fmac_f32 v252, -2.0, v249
    v_mfma_f32_16x16x32_bf16 a[120:123], a[228:231], v[228:231], 0
    v_fma_f32 v249, v208, s24, v212
    v_fmac_f32 v212, -4.0, v208
    v_mfma_f32_16x16x32_bf16 a[120:123], a[240:243], v[232:235], a[120:123]
    s_waitcnt lgkmcnt(0)
    v_fma_f32 v208, v206, s24, v210
    v_fmac_f32 v210, -4.0, v206
    v_mfma_f32_16x16x32_bf16 a[120:123], a[252:255], v[236:239], a[120:123]
    v_fma_f32 v206, v210, s26, v212
    v_fmac_f32 v212, s27, v210
    v_mfma_f32_16x16x32_bf16 a[124:127], v[240:243], v[236:239], 0
    buffer_load_dwordx4 a[220:223], v254, s[8:11], s42 offen offset:1024 sc1
    v_fma_f32 v210, v208, 2.0, v249
    v_mfma_f32_16x16x32_bf16 a[124:127], a[244:247], v[232:235], a[124:127]
    v_fmac_f32 v249, -2.0, v208
    v_cvt_pk_bf16_f32 v206, v248, v206
    v_mfma_f32_16x16x32_bf16 a[124:127], a[232:235], v[228:231], a[124:127]
    v_cvt_pk_bf16_f32 v212, v251, v212
    v_cvt_pk_bf16_f32 v210, v250, v210
    v_mfma_f32_16x16x32_bf16 a[128:131], a[236:239], v[228:231], 0
    ds_read_b128 v[228:231], v253 offset:3904
    v_cvt_pk_bf16_f32 v208, v252, v249
    v_mfma_f32_16x16x32_bf16 a[128:131], a[248:251], v[232:235], a[128:131]
    buffer_load_dwordx4 a[224:227], v254, s[8:11], s42 offen offset:2048 sc1
    v_mfma_f32_16x16x32_bf16 a[128:131], v[244:247], v[236:239], a[128:131]
    v_lshlrev_b32 v248, 16, v207
    v_lshlrev_b32 v249, 16, v209
    v_mfma_f32_16x16x32_bf16 a[132:135], a[228:231], v[232:235], 0
    buffer_store_dwordx4 v[140:143], v254, s[12:15], s44 offen nt
    v_and_b32 v203, 0x7fff, v255
    v_lshlrev_b32 v250, 16, v211
    v_lshlrev_b32 v251, 16, v213
    v_mfma_f32_16x16x32_bf16 a[132:135], a[240:243], v[236:239], a[132:135]
    s_waitcnt lgkmcnt(0)
    v_and_b32 v207, s22, v207
    v_and_b32 v209, s22, v209
    v_mfma_f32_16x16x32_bf16 a[132:135], a[252:255], v[228:231], a[132:135]
    buffer_load_dwordx2 v[192:193], v203, s[4:7], s16 offen offset:1216
    v_mfma_f32_16x16x32_bf16 a[136:139], v[240:243], v[228:231], 0
    v_and_b32 v211, s22, v211
    v_and_b32 v213, s22, v213
    v_mfma_f32_16x16x32_bf16 a[136:139], a[244:247], v[236:239], a[136:139]
    v_lshlrev_b32 v252, 16, v205
    v_and_b32 v205, s22, v205
    v_mfma_f32_16x16x32_bf16 a[136:139], a[232:235], v[232:235], a[136:139]
    v_fmac_f32 v252, s25, v251
    v_fmac_f32 v205, s25, v213
    v_mfma_f32_16x16x32_bf16 a[140:143], a[236:239], v[232:235], 0
    ds_read_b128 v[232:235], v253 offset:3648
    v_fmac_f32 v252, s28, v249
    v_mfma_f32_16x16x32_bf16 a[140:143], a[248:251], v[236:239], a[140:143]
    buffer_load_dwordx2 v[194:195], v203, s[4:7], s17 offen offset:1216
    v_fmac_f32 v205, s28, v209
    v_mfma_f32_16x16x32_bf16 a[140:143], v[244:247], v[228:231], a[140:143]
    v_cvt_pk_bf16_f32 v205, v252, v205
    v_lshlrev_b32 v252, 16, v215
    v_mfma_f32_16x16x32_bf16 a[144:147], a[228:231], v[236:239], 0
    v_and_b32 v215, s22, v215
    v_fmac_f32 v252, s29, v248
    v_mfma_f32_16x16x32_bf16 a[144:147], a[240:243], v[228:231], a[144:147]
    s_waitcnt lgkmcnt(0)
    v_fmac_f32 v215, s29, v207
    v_fmac_f32 v252, s23, v250
    v_mfma_f32_16x16x32_bf16 a[144:147], a[252:255], v[232:235], a[144:147]
    buffer_load_dwordx2 v[196:197], v203, s[4:7], s18 offen offset:1216
    v_mfma_f32_16x16x32_bf16 a[148:151], v[240:243], v[232:235], 0
    v_fmac_f32 v215, s23, v211
    v_cvt_pk_bf16_f32 v215, v252, v215
    v_mfma_f32_16x16x32_bf16 a[148:151], a[244:247], v[228:231], a[148:151]
    v_fma_f32 v252, v249, s24, v251
    v_fmac_f32 v251, -4.0, v249
    v_mfma_f32_16x16x32_bf16 a[148:151], a[232:235], v[236:239], a[148:151]
    v_fma_f32 v249, v248, s24, v250
    v_fmac_f32 v250, -4.0, v248
    v_fma_f32 v248, v250, s26, v251
    v_mfma_f32_16x16x32_bf16 a[152:155], a[236:239], v[236:239], 0
    ds_read_b128 v[236:239], v253 offset:3392
    v_fmac_f32 v251, s27, v250
    v_mfma_f32_16x16x32_bf16 a[152:155], a[248:251], v[228:231], a[152:155]
    buffer_load_dwordx2 v[198:199], v203, s[4:7], s19 offen offset:1216
    v_mfma_f32_16x16x32_bf16 a[152:155], v[244:247], v[232:235], a[152:155]
    v_fma_f32 v250, v249, 2.0, v252
    v_fmac_f32 v252, -2.0, v249
    v_mfma_f32_16x16x32_bf16 a[156:159], a[228:231], v[228:231], 0
    v_fma_f32 v249, v209, s24, v213
    v_fmac_f32 v213, -4.0, v209
    v_mfma_f32_16x16x32_bf16 a[156:159], a[240:243], v[232:235], a[156:159]
    s_waitcnt lgkmcnt(0)
    v_fma_f32 v209, v207, s24, v211
    v_fmac_f32 v211, -4.0, v207
    v_mfma_f32_16x16x32_bf16 a[156:159], a[252:255], v[236:239], a[156:159]
    buffer_load_dwordx2 v[200:201], v203, s[4:7], s20 offen offset:1216
    v_fma_f32 v207, v211, s26, v213
    v_mfma_f32_16x16x32_bf16 a[160:163], v[240:243], v[236:239], 0
    v_fmac_f32 v213, s27, v211
    v_fma_f32 v211, v209, 2.0, v249
    v_mfma_f32_16x16x32_bf16 a[160:163], a[244:247], v[232:235], a[160:163]
    v_fmac_f32 v249, -2.0, v209
    v_cvt_pk_bf16_f32 v207, v248, v207
    v_mfma_f32_16x16x32_bf16 a[160:163], a[232:235], v[228:231], a[160:163]
    v_cvt_pk_bf16_f32 v213, v251, v213
    v_cvt_pk_bf16_f32 v211, v250, v211
    v_mfma_f32_16x16x32_bf16 a[164:167], a[236:239], v[228:231], 0
    ds_read_b128 v[228:231], v253 offset:3136
    v_cvt_pk_bf16_f32 v209, v252, v249
    v_mfma_f32_16x16x32_bf16 a[164:167], a[248:251], v[232:235], a[164:167]
    buffer_load_dwordx2 v[202:203], v203, s[4:7], s21 offen offset:1216
    v_mfma_f32_16x16x32_bf16 a[164:167], v[244:247], v[236:239], a[164:167]
    v_lshrrev_b32 v252, 15, v255
    v_mfma_f32_16x16x32_bf16 a[168:171], a[228:231], v[232:235], 0
    ds_write_b64 v252, v[206:207] offset:8832
    s_waitcnt vmcnt(19)
    v_mfma_f32_16x16x32_bf16 a[168:171], a[240:243], v[236:239], a[168:171]
    s_waitcnt lgkmcnt(1)
    v_lshrrev_b32 v206, 15, v255
    v_lshlrev_b32 v248, 16, v218
    v_mfma_f32_16x16x32_bf16 a[168:171], a[252:255], v[228:231], a[168:171]
    ds_write_b64 v206, v[212:213] offset:10912
    v_mfma_f32_16x16x32_bf16 a[172:175], v[240:243], v[228:231], 0
    v_lshlrev_b32 v249, 16, v220
    v_lshlrev_b32 v250, 16, v222
    v_mfma_f32_16x16x32_bf16 a[172:175], a[244:247], v[236:239], a[172:175]
    ds_write_b64 v206, v[210:211] offset:12992
    v_mfma_f32_16x16x32_bf16 a[172:175], a[232:235], v[232:235], a[172:175]
    v_lshlrev_b32 v251, 16, v224
    v_and_b32 v218, s22, v218
    v_mfma_f32_16x16x32_bf16 a[176:179], a[236:239], v[232:235], 0
    ds_read_b128 v[232:235], v253 offset:2864
    v_and_b32 v220, s22, v220
    v_mfma_f32_16x16x32_bf16 a[176:179], a[248:251], v[236:239], a[176:179]
    ds_write_b64 v206, v[204:205] offset:15072
    v_and_b32 v222, s22, v222
    v_mfma_f32_16x16x32_bf16 a[176:179], v[244:247], v[228:231], a[176:179]
    s_mov_b32 s42, 110592
    v_and_b32 v224, s22, v224
    v_lshlrev_b32 v252, 16, v216
    v_mfma_f32_16x16x32_bf16 a[180:183], a[228:231], v[236:239], 0
    ds_write_b64 v206, v[214:215] offset:37952
    v_mfma_f32_16x16x32_bf16 a[184:187], a[232:235], v[236:239], 0
    v_and_b32 v216, s22, v216
    v_fmac_f32 v252, s25, v251
    v_mfma_f32_16x16x32_bf16 a[188:191], a[236:239], v[236:239], 0
    ds_read_b128 v[236:239], v253 offset:5200
    v_fmac_f32 v216, s25, v224
    v_mfma_f32_16x16x32_bf16 a[188:191], a[248:251], v[228:231], a[188:191]
    buffer_load_dwordx4 a[228:231], v254, s[8:11], s42 offen offset:0 sc1
    v_mfma_f32_16x16x32_bf16 a[184:187], a[244:247], v[228:231], a[184:187]
    s_waitcnt lgkmcnt(3)
    v_fmac_f32 v252, s28, v249
    v_fmac_f32 v216, s28, v220
    v_cvt_pk_bf16_f32 v216, v252, v216
    v_mfma_f32_16x16x32_bf16 a[180:183], a[240:243], v[228:231], a[180:183]
    ds_read_b128 v[228:231], v253 offset:4928
    v_lshlrev_b32 v252, 16, v226
    v_mfma_f32_16x16x32_bf16 a[180:183], a[252:255], v[232:235], a[180:183]
    buffer_load_dwordx4 a[232:235], v254, s[8:11], s42 offen offset:1024 sc1
    v_mfma_f32_16x16x32_bf16 a[184:187], v[240:243], v[232:235], a[184:187]
    s_waitcnt vmcnt(16) lgkmcnt(1)
    v_and_b32 v226, s22, v226
    v_fmac_f32 v252, s29, v248
    v_mfma_f32_16x16x32_bf16 a[188:191], v[244:247], v[232:235], a[188:191]
    ds_read_b128 v[232:235], v253 offset:4672
    v_fmac_f32 v226, s29, v218
sub2:
    v_mfma_f32_16x16x32_bf16 v[0:3], a[192:195], v[236:239], 0
    buffer_load_dwordx4 a[236:239], v254, s[8:11], s42 offen offset:2048 sc1
    v_mfma_f32_16x16x32_bf16 v[4:7], a[196:199], v[236:239], 0
    s_mov_b32 s42, 113664
    v_fmac_f32 v252, s23, v250
    v_fmac_f32 v226, s23, v222
    v_mfma_f32_16x16x32_bf16 v[8:11], a[200:203], v[236:239], 0
    ds_read_b128 v[236:239], v253 offset:4416
    s_waitcnt vmcnt(13)
    s_waitcnt lgkmcnt(2)
    v_mfma_f32_16x16x32_bf16 v[8:11], a[212:215], v[228:231], v[8:11]
    ds_write_b64 v206, v[208:209] offset:31712
    v_mfma_f32_16x16x32_bf16 v[4:7], a[208:211], v[228:231], v[4:7]
    buffer_load_dwordx4 a[240:243], v254, s[8:11], s42 offen offset:0 sc1
    v_mfma_f32_16x16x32_bf16 v[0:3], a[204:207], v[228:231], v[0:3]
    s_waitcnt vmcnt(11) lgkmcnt(2)
    v_cvt_pk_bf16_f32 v226, v252, v226
    v_fma_f32 v252, v249, s24, v251
    v_mfma_f32_16x16x32_bf16 v[0:3], a[216:219], v[232:235], v[0:3]
    ds_read_b128 v[204:207], v253 offset:39712
    s_mov_b32 s45, 619910279
    v_mfma_f32_16x16x32_bf16 v[4:7], a[220:223], v[232:235], v[4:7]
    v_bfe_u32 v208, v254, 5, 3
    v_mul_u32_u24 v209, 5, v208
    v_mfma_f32_16x16x32_bf16 v[8:11], a[224:227], v[232:235], v[8:11]
    buffer_load_dwordx4 a[244:247], v254, s[8:11], s42 offen offset:1024 sc1
    v_mfma_f32_16x16x32_bf16 v[12:15], a[192:195], v[228:231], 0
    v_bfe_u32 v209, s45, v209, 5
    v_mul_u32_u24 v209, 65, v209
    v_fmac_f32 v251, -4.0, v249
    v_mfma_f32_16x16x32_bf16 v[12:15], a[204:207], v[232:235], v[12:15]
    s_waitcnt lgkmcnt(2)
    v_sub_u32 v209, v209, v208
    v_lshl_add_u32 v208, v209, 5, v253
    v_mfma_f32_16x16x32_bf16 v[12:15], a[216:219], v[236:239], v[12:15]
    s_waitcnt lgkmcnt(0)
    v_fma_f32 v249, v248, s24, v250
    v_fmac_f32 v250, -4.0, v248
    v_mfma_f32_16x16x32_bf16 v[16:19], a[220:223], v[236:239], 0
    buffer_load_dwordx4 a[248:251], v254, s[8:11], s42 offen offset:2048 sc1
    v_mfma_f32_16x16x32_bf16 v[16:19], a[208:211], v[232:235], v[16:19]
    s_mov_b32 s42, 116736
    v_fma_f32 v248, v250, s26, v251
    v_fmac_f32 v251, s27, v250
    v_mfma_f32_16x16x32_bf16 v[16:19], a[196:199], v[228:231], v[16:19]
    s_mov_b64 exec, s[46:47]
    ds_write_b128 v208, v[204:207] offset:1024
    s_mov_b64 exec, -1
    v_mfma_f32_16x16x32_bf16 v[20:23], a[200:203], v[228:231], 0
    ds_read_b128 v[228:231], v253 offset:4160
    v_fma_f32 v250, v249, 2.0, v252
    v_fmac_f32 v252, -2.0, v249
    v_mfma_f32_16x16x32_bf16 v[20:23], a[212:215], v[232:235], v[20:23]
    buffer_load_dwordx4 a[252:255], v254, s[8:11], s42 offen offset:0 sc1
    v_mfma_f32_16x16x32_bf16 v[20:23], a[224:227], v[236:239], v[20:23]
    v_fma_f32 v249, v220, s24, v224
    v_fmac_f32 v224, -4.0, v220
    v_mfma_f32_16x16x32_bf16 v[24:27], a[192:195], v[232:235], 0
    v_fma_f32 v220, v218, s24, v222
    v_fmac_f32 v222, -4.0, v218
    v_mfma_f32_16x16x32_bf16 v[24:27], a[204:207], v[236:239], v[24:27]
    s_waitcnt lgkmcnt(0)
    v_fma_f32 v218, v222, s26, v224
    v_fmac_f32 v224, s27, v222
    v_mfma_f32_16x16x32_bf16 v[24:27], a[216:219], v[228:231], v[24:27]
    v_fma_f32 v222, v220, 2.0, v249
    v_fmac_f32 v249, -2.0, v220
    v_mfma_f32_16x16x32_bf16 v[28:31], a[220:223], v[228:231], 0
    buffer_load_dwordx4 v[240:243], v254, s[8:11], s42 offen offset:1024 sc1
    v_mfma_f32_16x16x32_bf16 v[28:31], a[208:211], v[236:239], v[28:31]
    v_cvt_pk_bf16_f32 v218, v248, v218
    v_cvt_pk_bf16_f32 v224, v251, v224
    v_cvt_pk_bf16_f32 v222, v250, v222
    v_mfma_f32_16x16x32_bf16 v[28:31], a[196:199], v[232:235], v[28:31]
    v_cvt_pk_bf16_f32 v220, v252, v249
    v_lshlrev_b32 v248, 16, v219
    v_mfma_f32_16x16x32_bf16 v[32:35], a[200:203], v[232:235], 0
    ds_read_b128 v[232:235], v253 offset:5984
    v_lshlrev_b32 v249, 16, v221
    v_mfma_f32_16x16x32_bf16 v[32:35], a[212:215], v[236:239], v[32:35]
    buffer_load_dwordx4 v[244:247], v254, s[8:11], s42 offen offset:2048 sc1
    v_mfma_f32_16x16x32_bf16 v[32:35], a[224:227], v[228:231], v[32:35]
    v_lshlrev_b32 v250, 16, v223
    v_lshlrev_b32 v251, 16, v225
    v_mfma_f32_16x16x32_bf16 v[36:39], a[192:195], v[236:239], 0
    v_and_b32 v215, 0x7fff, v255
    v_and_b32 v219, s22, v219
    v_mfma_f32_16x16x32_bf16 v[36:39], a[204:207], v[228:231], v[36:39]
    s_waitcnt lgkmcnt(0)
    v_and_b32 v221, s22, v221
    v_and_b32 v223, s22, v223
    v_mfma_f32_16x16x32_bf16 v[36:39], a[216:219], v[232:235], v[36:39]
    buffer_load_dwordx2 v[204:205], v215, s[4:7], s16 offen offset:128
    v_and_b32 v225, s22, v225
    v_mfma_f32_16x16x32_bf16 v[40:43], a[220:223], v[232:235], 0
    v_lshlrev_b32 v252, 16, v217
    v_and_b32 v217, s22, v217
    v_mfma_f32_16x16x32_bf16 v[40:43], a[208:211], v[228:231], v[40:43]
    v_fmac_f32 v252, s25, v251
    v_fmac_f32 v217, s25, v225
    v_mfma_f32_16x16x32_bf16 v[40:43], a[196:199], v[236:239], v[40:43]
    v_fmac_f32 v252, s28, v249
    v_fmac_f32 v217, s28, v221
    v_mfma_f32_16x16x32_bf16 v[44:47], a[200:203], v[236:239], 0
    ds_read_b128 v[236:239], v253 offset:5728
    v_cvt_pk_bf16_f32 v217, v252, v217
    v_mfma_f32_16x16x32_bf16 v[44:47], a[212:215], v[228:231], v[44:47]
    buffer_load_dwordx2 v[206:207], v215, s[4:7], s17 offen offset:128
    v_mfma_f32_16x16x32_bf16 v[44:47], a[224:227], v[232:235], v[44:47]
    v_lshlrev_b32 v252, 16, v227
    v_and_b32 v227, s22, v227
    v_fmac_f32 v252, s29, v248
    v_mfma_f32_16x16x32_bf16 v[48:51], a[192:195], v[228:231], 0
    v_fmac_f32 v227, s29, v219
    v_fmac_f32 v252, s23, v250
    v_mfma_f32_16x16x32_bf16 v[48:51], a[204:207], v[232:235], v[48:51]
    s_waitcnt lgkmcnt(0)
    v_fmac_f32 v227, s23, v223
    v_cvt_pk_bf16_f32 v227, v252, v227
    v_mfma_f32_16x16x32_bf16 v[48:51], a[216:219], v[236:239], v[48:51]
    buffer_load_dwordx2 v[208:209], v215, s[4:7], s18 offen offset:128
    v_mfma_f32_16x16x32_bf16 v[52:55], a[220:223], v[236:239], 0
    v_fma_f32 v252, v249, s24, v251
    v_fmac_f32 v251, -4.0, v249
    v_mfma_f32_16x16x32_bf16 v[52:55], a[208:211], v[232:235], v[52:55]
    v_fma_f32 v249, v248, s24, v250
    v_fmac_f32 v250, -4.0, v248
    v_mfma_f32_16x16x32_bf16 v[52:55], a[196:199], v[228:231], v[52:55]
    v_fma_f32 v248, v250, s26, v251
    v_fmac_f32 v251, s27, v250
    v_mfma_f32_16x16x32_bf16 v[56:59], a[200:203], v[228:231], 0
    ds_read_b128 v[228:231], v253 offset:5472
    v_fma_f32 v250, v249, 2.0, v252
    v_fmac_f32 v252, -2.0, v249
    v_mfma_f32_16x16x32_bf16 v[56:59], a[212:215], v[232:235], v[56:59]
    buffer_load_dwordx2 v[210:211], v215, s[4:7], s19 offen offset:128
    v_mfma_f32_16x16x32_bf16 v[56:59], a[224:227], v[236:239], v[56:59]
    v_fma_f32 v249, v221, s24, v225
    v_fmac_f32 v225, -4.0, v221
    v_mfma_f32_16x16x32_bf16 v[60:63], a[192:195], v[232:235], 0
    v_fma_f32 v221, v219, s24, v223
    v_fmac_f32 v223, -4.0, v219
    v_mfma_f32_16x16x32_bf16 v[60:63], a[204:207], v[236:239], v[60:63]
    s_waitcnt lgkmcnt(0)
    v_fma_f32 v219, v223, s26, v225
    v_fmac_f32 v225, s27, v223
    v_mfma_f32_16x16x32_bf16 v[60:63], a[216:219], v[228:231], v[60:63]
    buffer_load_dwordx2 v[212:213], v215, s[4:7], s20 offen offset:128
    v_mfma_f32_16x16x32_bf16 v[64:67], a[220:223], v[228:231], 0
    v_fma_f32 v223, v221, 2.0, v249
    v_fmac_f32 v249, -2.0, v221
    v_mfma_f32_16x16x32_bf16 v[64:67], a[208:211], v[236:239], v[64:67]
    v_cvt_pk_bf16_f32 v219, v248, v219
    v_cvt_pk_bf16_f32 v225, v251, v225
    v_cvt_pk_bf16_f32 v223, v250, v223
    v_mfma_f32_16x16x32_bf16 v[64:67], a[196:199], v[232:235], v[64:67]
    v_cvt_pk_bf16_f32 v221, v252, v249
    v_lshrrev_b32 v252, 15, v255
    v_mfma_f32_16x16x32_bf16 v[68:71], a[200:203], v[232:235], 0
    ds_read_b128 v[232:235], v253 offset:5216
    v_mfma_f32_16x16x32_bf16 v[68:71], a[212:215], v[236:239], v[68:71]
    buffer_load_dwordx2 v[214:215], v215, s[4:7], s21 offen offset:128
    v_mfma_f32_16x16x32_bf16 v[68:71], a[224:227], v[228:231], v[68:71]
    ds_write_b64 v252, v[218:219] offset:8576
    v_mfma_f32_16x16x32_bf16 v[72:75], a[192:195], v[236:239], 0
    s_waitcnt vmcnt(15)
    v_lshrrev_b32 v218, 15, v255
    v_lshlrev_b32 v248, 16, v194
    v_mfma_f32_16x16x32_bf16 v[72:75], a[204:207], v[228:231], v[72:75]
    s_waitcnt lgkmcnt(1)
    v_lshlrev_b32 v249, 16, v196
    v_lshlrev_b32 v250, 16, v198
    v_lshlrev_b32 v251, 16, v200
    v_mfma_f32_16x16x32_bf16 v[72:75], a[216:219], v[232:235], v[72:75]
    ds_write_b64 v218, v[224:225] offset:10656
    v_mfma_f32_16x16x32_bf16 v[76:79], a[220:223], v[232:235], 0
    v_and_b32 v194, s22, v194
    v_and_b32 v196, s22, v196
    v_mfma_f32_16x16x32_bf16 v[76:79], a[208:211], v[228:231], v[76:79]
pad1:
    s_cbranch_vccnz pad5
    ds_write_b64 v218, v[222:223] offset:12736
    v_mfma_f32_16x16x32_bf16 v[76:79], a[196:199], v[236:239], v[76:79]
    v_and_b32 v198, s22, v198
    v_and_b32 v200, s22, v200
    v_mfma_f32_16x16x32_bf16 v[80:83], a[200:203], v[236:239], 0
    ds_read_b128 v[236:239], v253 offset:4944
    v_lshlrev_b32 v252, 16, v192
    v_mfma_f32_16x16x32_bf16 v[80:83], a[212:215], v[228:231], v[80:83]
    ds_write_b64 v218, v[216:217] offset:14816
    v_mfma_f32_16x16x32_bf16 v[80:83], a[224:227], v[232:235], v[80:83]
    s_mov_b32 s42, 147456
    v_and_b32 v192, s22, v192
    v_fmac_f32 v252, s25, v251
    v_fmac_f32 v192, s25, v200
    v_mfma_f32_16x16x32_bf16 v[84:87], a[192:195], v[228:231], 0
    ds_write_b64 v218, v[226:227] offset:37696
    v_mfma_f32_16x16x32_bf16 v[88:91], a[196:199], v[228:231], 0
    v_fmac_f32 v252, s28, v249
    v_fmac_f32 v192, s28, v196
    v_mfma_f32_16x16x32_bf16 v[92:95], a[200:203], v[228:231], 0
    ds_read_b128 v[228:231], v253 offset:7280
    v_cvt_pk_bf16_f32 v192, v252, v192
    v_mfma_f32_16x16x32_bf16 v[92:95], a[212:215], v[232:235], v[92:95]
    buffer_load_dwordx4 a[192:195], v254, s[8:11], s42 offen offset:0 sc1
    v_mfma_f32_16x16x32_bf16 v[88:91], a[208:211], v[232:235], v[88:91]
    s_waitcnt lgkmcnt(3)
    v_lshlrev_b32 v252, 16, v202
    v_and_b32 v202, s22, v202
    v_mfma_f32_16x16x32_bf16 v[84:87], a[204:207], v[232:235], v[84:87]
    ds_read_b128 v[232:235], v253 offset:7008
    v_fmac_f32 v252, s29, v248
    v_mfma_f32_16x16x32_bf16 v[84:87], a[216:219], v[236:239], v[84:87]
    buffer_load_dwordx4 a[196:199], v254, s[8:11], s42 offen offset:1024 sc1
    v_fmac_f32 v202, s29, v194
    v_mfma_f32_16x16x32_bf16 v[88:91], a[220:223], v[236:239], v[88:91]
    s_waitcnt vmcnt(14) lgkmcnt(1)
    v_fmac_f32 v252, s23, v250
    v_fmac_f32 v202, s23, v198
    v_mfma_f32_16x16x32_bf16 v[92:95], a[224:227], v[236:239], v[92:95]
    ds_read_b128 v[236:239], v253 offset:6752
    v_cvt_pk_bf16_f32 v202, v252, v202
sub3:
    v_mfma_f32_16x16x32_bf16 v[96:99], a[228:231], v[228:231], 0
    buffer_load_dwordx4 a[200:203], v254, s[8:11], s42 offen offset:2048 sc1
    v_mfma_f32_16x16x32_bf16 v[100:103], a[232:235], v[228:231], 0
    s_mov_b32 s42, 150528
    v_fma_f32 v252, v249, s24, v251
    v_fmac_f32 v251, -4.0, v249
    v_mfma_f32_16x16x32_bf16 v[104:107], a[236:239], v[228:231], 0
    ds_read_b128 v[228:231], v253 offset:6496
    s_waitcnt vmcnt(12)
    s_waitcnt lgkmcnt(2)
    v_mfma_f32_16x16x32_bf16 v[104:107], a[248:251], v[232:235], v[104:107]
    ds_write_b64 v218, v[220:221] offset:31456
    v_fma_f32 v249, v248, s24, v250
    v_mfma_f32_16x16x32_bf16 v[100:103], a[244:247], v[232:235], v[100:103]
    buffer_load_dwordx4 a[204:207], v254, s[8:11], s42 offen offset:0 sc1
    v_mfma_f32_16x16x32_bf16 v[96:99], a[240:243], v[232:235], v[96:99]
    s_waitcnt vmcnt(10) lgkmcnt(2)
    v_fmac_f32 v250, -4.0, v248
    v_fma_f32 v248, v250, s26, v251
    v_mfma_f32_16x16x32_bf16 v[96:99], a[252:255], v[236:239], v[96:99]
    v_fmac_f32 v251, s27, v250
    v_fma_f32 v250, v249, 2.0, v252
    v_mfma_f32_16x16x32_bf16 v[100:103], v[240:243], v[236:239], v[100:103]
    v_fmac_f32 v252, -2.0, v249
    v_fma_f32 v249, v196, s24, v200
    v_mfma_f32_16x16x32_bf16 v[104:107], v[244:247], v[236:239], v[104:107]
    buffer_load_dwordx4 a[208:211], v254, s[8:11], s42 offen offset:1024 sc1
    v_mfma_f32_16x16x32_bf16 v[108:111], a[228:231], v[232:235], 0
    v_fmac_f32 v200, -4.0, v196
    v_fma_f32 v196, v194, s24, v198
    v_mfma_f32_16x16x32_bf16 v[108:111], a[240:243], v[236:239], v[108:111]
    s_waitcnt lgkmcnt(1)
    v_fmac_f32 v198, -4.0, v194
    v_fma_f32 v194, v198, s26, v200
    v_fmac_f32 v200, s27, v198
    v_mfma_f32_16x16x32_bf16 v[108:111], a[252:255], v[228:231], v[108:111]
    v_fma_f32 v198, v196, 2.0, v249
    v_fmac_f32 v249, -2.0, v196
    v_mfma_f32_16x16x32_bf16 v[112:115], v[240:243], v[228:231], 0
    buffer_load_dwordx4 a[212:215], v254, s[8:11], s42 offen offset:2048 sc1
    v_mfma_f32_16x16x32_bf16 v[112:115], a[244:247], v[236:239], v[112:115]
    s_mov_b32 s42, 153600
    v_cvt_pk_bf16_f32 v194, v248, v194
    v_cvt_pk_bf16_f32 v200, v251, v200
    v_mfma_f32_16x16x32_bf16 v[112:115], a[232:235], v[232:235], v[112:115]
    v_cvt_pk_bf16_f32 v198, v250, v198
    v_cvt_pk_bf16_f32 v196, v252, v249
    v_mfma_f32_16x16x32_bf16 v[116:119], a[236:239], v[232:235], 0
    ds_read_b128 v[232:235], v253 offset:6240
    v_lshlrev_b32 v248, 16, v195
    v_mfma_f32_16x16x32_bf16 v[116:119], a[248:251], v[236:239], v[116:119]
    buffer_load_dwordx4 a[216:219], v254, s[8:11], s42 offen offset:0 sc1
    v_mfma_f32_16x16x32_bf16 v[116:119], v[244:247], v[228:231], v[116:119]
    v_lshlrev_b32 v249, 16, v197
    v_lshlrev_b32 v250, 16, v199
    v_lshlrev_b32 v251, 16, v201
    v_mfma_f32_16x16x32_bf16 v[120:123], a[228:231], v[236:239], 0
    v_and_b32 v195, s22, v195
    v_and_b32 v197, s22, v197
    v_mfma_f32_16x16x32_bf16 v[120:123], a[240:243], v[228:231], v[120:123]
    s_waitcnt lgkmcnt(0)
    v_and_b32 v199, s22, v199
    v_and_b32 v201, s22, v201
    v_mfma_f32_16x16x32_bf16 v[120:123], a[252:255], v[232:235], v[120:123]
    v_lshlrev_b32 v252, 16, v193
    v_and_b32 v193, s22, v193
    v_mfma_f32_16x16x32_bf16 v[124:127], v[240:243], v[232:235], 0
    buffer_load_dwordx4 a[220:223], v254, s[8:11], s42 offen offset:1024 sc1
    v_mfma_f32_16x16x32_bf16 v[124:127], a[244:247], v[228:231], v[124:127]
    v_fmac_f32 v252, s25, v251
    v_fmac_f32 v193, s25, v201
    v_mfma_f32_16x16x32_bf16 v[124:127], a[232:235], v[236:239], v[124:127]
    v_fmac_f32 v252, s28, v249
    v_fmac_f32 v193, s28, v197
    v_cvt_pk_bf16_f32 v193, v252, v193
    v_mfma_f32_16x16x32_bf16 v[128:131], a[236:239], v[236:239], 0
    ds_read_b128 v[236:239], v253 offset:8064
    v_lshlrev_b32 v252, 16, v203
    v_mfma_f32_16x16x32_bf16 v[128:131], a[248:251], v[228:231], v[128:131]
    buffer_load_dwordx4 a[224:227], v254, s[8:11], s42 offen offset:2048 sc1
    v_mfma_f32_16x16x32_bf16 v[128:131], v[244:247], v[232:235], v[128:131]
    v_and_b32 v203, s22, v203
    v_fmac_f32 v252, s29, v248
    v_mfma_f32_16x16x32_bf16 v[132:135], a[228:231], v[228:231], 0
    v_and_b32 v227, 0x7fff, v255
    v_fmac_f32 v203, s29, v195
    v_mfma_f32_16x16x32_bf16 v[132:135], a[240:243], v[232:235], v[132:135]
    s_waitcnt lgkmcnt(0)
    v_fmac_f32 v252, s23, v250
    v_fmac_f32 v203, s23, v199
    v_mfma_f32_16x16x32_bf16 v[132:135], a[252:255], v[236:239], v[132:135]
    buffer_load_dwordx2 v[216:217], v227, s[4:7], s16 offen offset:512
    v_mfma_f32_16x16x32_bf16 v[136:139], v[240:243], v[236:239], 0
    v_cvt_pk_bf16_f32 v203, v252, v203
    v_fma_f32 v252, v249, s24, v251
    v_fmac_f32 v251, -4.0, v249
    v_mfma_f32_16x16x32_bf16 v[136:139], a[244:247], v[232:235], v[136:139]
    v_fma_f32 v249, v248, s24, v250
    v_fmac_f32 v250, -4.0, v248
    v_mfma_f32_16x16x32_bf16 v[136:139], a[232:235], v[228:231], v[136:139]
    v_fma_f32 v248, v250, s26, v251
    v_fmac_f32 v251, s27, v250
    v_mfma_f32_16x16x32_bf16 v[140:143], a[236:239], v[228:231], 0
    ds_read_b128 v[228:231], v253 offset:7808
    v_fma_f32 v250, v249, 2.0, v252
    v_mfma_f32_16x16x32_bf16 v[140:143], a[248:251], v[232:235], v[140:143]
    buffer_load_dwordx2 v[218:219], v227, s[4:7], s17 offen offset:512
    v_mfma_f32_16x16x32_bf16 v[140:143], v[244:247], v[236:239], v[140:143]
    v_fmac_f32 v252, -2.0, v249
    v_fma_f32 v249, v197, s24, v201
    v_mfma_f32_16x16x32_bf16 v[144:147], a[228:231], v[232:235], 0
    v_fmac_f32 v201, -4.0, v197
    v_fma_f32 v197, v195, s24, v199
    v_mfma_f32_16x16x32_bf16 v[144:147], a[240:243], v[236:239], v[144:147]
    s_waitcnt lgkmcnt(0)
    v_fmac_f32 v199, -4.0, v195
    v_fma_f32 v195, v199, s26, v201
    v_fmac_f32 v201, s27, v199
    v_mfma_f32_16x16x32_bf16 v[144:147], a[252:255], v[228:231], v[144:147]
    buffer_load_dwordx2 v[220:221], v227, s[4:7], s18 offen offset:512
    v_mfma_f32_16x16x32_bf16 v[148:151], v[240:243], v[228:231], 0
    v_fma_f32 v199, v197, 2.0, v249
    v_fmac_f32 v249, -2.0, v197
    v_mfma_f32_16x16x32_bf16 v[148:151], a[244:247], v[236:239], v[148:151]
    v_cvt_pk_bf16_f32 v195, v248, v195
    v_cvt_pk_bf16_f32 v201, v251, v201
    v_mfma_f32_16x16x32_bf16 v[148:151], a[232:235], v[232:235], v[148:151]
    v_cvt_pk_bf16_f32 v199, v250, v199
    v_cvt_pk_bf16_f32 v197, v252, v249
    v_mfma_f32_16x16x32_bf16 v[152:155], a[236:239], v[232:235], 0
    ds_read_b128 v[232:235], v253 offset:7552
    v_lshrrev_b32 v252, 15, v255
    v_mfma_f32_16x16x32_bf16 v[152:155], a[248:251], v[236:239], v[152:155]
    buffer_load_dwordx2 v[222:223], v227, s[4:7], s19 offen offset:512
    v_mfma_f32_16x16x32_bf16 v[152:155], v[244:247], v[228:231], v[152:155]
    ds_write_b64 v252, v[194:195] offset:8320
    v_mfma_f32_16x16x32_bf16 v[156:159], a[228:231], v[236:239], 0
    v_lshrrev_b32 v194, 15, v255
    v_mfma_f32_16x16x32_bf16 v[156:159], a[240:243], v[228:231], v[156:159]
    s_waitcnt lgkmcnt(1)
    s_waitcnt vmcnt(13)
    v_lshlrev_b32 v248, 16, v206
    v_mfma_f32_16x16x32_bf16 v[156:159], a[252:255], v[232:235], v[156:159]
    buffer_load_dwordx2 v[224:225], v227, s[4:7], s20 offen offset:512
    v_mfma_f32_16x16x32_bf16 v[160:163], v[240:243], v[232:235], 0
    ds_write_b64 v194, v[200:201] offset:10400
    v_mfma_f32_16x16x32_bf16 v[160:163], a[244:247], v[228:231], v[160:163]
    v_lshlrev_b32 v249, 16, v208
    v_lshlrev_b32 v250, 16, v210
    v_mfma_f32_16x16x32_bf16 v[160:163], a[232:235], v[236:239], v[160:163]
    ds_write_b64 v194, v[198:199] offset:12480
    v_mfma_f32_16x16x32_bf16 v[164:167], a[236:239], v[236:239], 0
    ds_read_b128 v[236:239], v253 offset:7296
    v_lshlrev_b32 v251, 16, v212
    v_mfma_f32_16x16x32_bf16 v[164:167], a[248:251], v[228:231], v[164:167]
    buffer_load_dwordx2 v[226:227], v227, s[4:7], s21 offen offset:512
    v_mfma_f32_16x16x32_bf16 v[164:167], v[244:247], v[232:235], v[164:167]
    ds_write_b64 v194, v[192:193] offset:14560
    v_mfma_f32_16x16x32_bf16 v[168:171], a[228:231], v[228:231], 0
    v_and_b32 v206, s22, v206
    v_and_b32 v208, s22, v208
    v_mfma_f32_16x16x32_bf16 v[168:171], a[240:243], v[232:235], v[168:171]
    s_waitcnt lgkmcnt(1)
    v_and_b32 v210, s22, v210
    v_and_b32 v212, s22, v212
    v_mfma_f32_16x16x32_bf16 v[168:171], a[252:255], v[236:239], v[168:171]
    ds_write_b64 v194, v[202:203] offset:37440
    v_mfma_f32_16x16x32_bf16 v[172:175], v[240:243], v[236:239], 0
    v_lshlrev_b32 v252, 16, v204
    v_and_b32 v204, s22, v204
    v_mfma_f32_16x16x32_bf16 v[172:175], a[244:247], v[232:235], v[172:175]
    ds_write_b64 v194, v[196:197] offset:31200
    v_mfma_f32_16x16x32_bf16 v[172:175], a[232:235], v[228:231], v[172:175]
    v_fmac_f32 v252, s25, v251
    v_fmac_f32 v204, s25, v212
    v_mfma_f32_16x16x32_bf16 v[176:179], a[236:239], v[228:231], 0
    ds_read_b128 v[228:231], v253 offset:7024
    v_fmac_f32 v252, s28, v249
    v_mfma_f32_16x16x32_bf16 v[176:179], a[248:251], v[232:235], v[176:179]
    v_fmac_f32 v204, s28, v208
    v_cvt_pk_bf16_f32 v204, v252, v204
    v_mfma_f32_16x16x32_bf16 v[176:179], v[244:247], v[236:239], v[176:179]
    s_mov_b32 s42, 184320
    v_lshlrev_b32 v252, 16, v214
    v_and_b32 v214, s22, v214
    v_mfma_f32_16x16x32_bf16 v[180:183], a[228:231], v[232:235], 0
    s_waitcnt lgkmcnt(0)
    v_fmac_f32 v252, s29, v248
    v_fmac_f32 v214, s29, v206
    v_fmac_f32 v252, s23, v250
    v_mfma_f32_16x16x32_bf16 v[184:187], a[232:235], v[232:235], 0
    s_barrier
    v_mfma_f32_16x16x32_bf16 v[188:191], a[236:239], v[232:235], 0
    ds_read_b128 v[232:235], v253 offset:9360
    v_fmac_f32 v214, s23, v210
    v_mfma_f32_16x16x32_bf16 v[188:191], a[248:251], v[236:239], v[188:191]
    buffer_load_dwordx4 a[228:231], v254, s[8:11], s42 offen offset:0 sc1
    v_mfma_f32_16x16x32_bf16 v[184:187], a[244:247], v[236:239], v[184:187]
    v_cvt_pk_bf16_f32 v214, v252, v214
    v_fma_f32 v252, v249, s24, v251
    v_mfma_f32_16x16x32_bf16 v[180:183], a[240:243], v[236:239], v[180:183]
    ds_read_b128 v[236:239], v253 offset:9088
    v_fmac_f32 v251, -4.0, v249
    v_mfma_f32_16x16x32_bf16 v[180:183], a[252:255], v[228:231], v[180:183]
    buffer_load_dwordx4 a[232:235], v254, s[8:11], s42 offen offset:1024 sc1
    v_mfma_f32_16x16x32_bf16 v[184:187], v[240:243], v[228:231], v[184:187]
    s_waitcnt vmcnt(14) lgkmcnt(1)
    v_fma_f32 v249, v248, s24, v250
    v_fmac_f32 v250, -4.0, v248
    v_mfma_f32_16x16x32_bf16 v[188:191], v[244:247], v[228:231], v[188:191]
    ds_read_b128 v[228:231], v253 offset:8832
    v_fma_f32 v248, v250, s26, v251
sub4:
    v_mfma_f32_16x16x32_bf16 a[0:3], a[192:195], v[232:235], a[0:3]
    buffer_load_dwordx4 a[236:239], v254, s[8:11], s42 offen offset:2048 sc1
    v_mfma_f32_16x16x32_bf16 a[4:7], a[196:199], v[232:235], a[4:7]
    s_mov_b32 s42, 187392
    v_fmac_f32 v251, s27, v250
    v_fma_f32 v250, v249, 2.0, v252
    v_mfma_f32_16x16x32_bf16 a[8:11], a[200:203], v[232:235], a[8:11]
    ds_read_b128 v[232:235], v253 offset:8576
    s_waitcnt vmcnt(12)
    s_waitcnt lgkmcnt(2)
    v_mfma_f32_16x16x32_bf16 a[8:11], a[212:215], v[236:239], a[8:11]
    v_fmac_f32 v252, -2.0, v249
    v_fma_f32 v249, v208, s24, v212
    v_mfma_f32_16x16x32_bf16 a[4:7], a[208:211], v[236:239], a[4:7]
    buffer_load_dwordx4 a[240:243], v254, s[8:11], s42 offen offset:0 sc1
    v_mfma_f32_16x16x32_bf16 a[0:3], a[204:207], v[236:239], a[0:3]
    s_waitcnt vmcnt(10) lgkmcnt(1)
    v_fmac_f32 v212, -4.0, v208
    v_fma_f32 v208, v206, s24, v210
    v_mfma_f32_16x16x32_bf16 a[0:3], a[216:219], v[228:231], a[0:3]
    v_fmac_f32 v210, -4.0, v206
    v_fma_f32 v206, v210, s26, v212
    v_mfma_f32_16x16x32_bf16 a[4:7], a[220:223], v[228:231], a[4:7]
    v_fmac_f32 v212, s27, v210
    v_fma_f32 v210, v208, 2.0, v249
    v_mfma_f32_16x16x32_bf16 a[8:11], a[224:227], v[228:231], a[8:11]
    buffer_load_dwordx4 a[244:247], v254, s[8:11], s42 offen offset:1024 sc1
    v_mfma_f32_16x16x32_bf16 a[12:15], a[192:195], v[236:239], a[12:15]
    v_fmac_f32 v249, -2.0, v208
    v_cvt_pk_bf16_f32 v206, v248, v206
    v_mfma_f32_16x16x32_bf16 a[12:15], a[204:207], v[228:231], a[12:15]
    s_waitcnt lgkmcnt(0)
    v_cvt_pk_bf16_f32 v212, v251, v212
    v_cvt_pk_bf16_f32 v210, v250, v210
    v_mfma_f32_16x16x32_bf16 a[12:15], a[216:219], v[232:235], a[12:15]
    v_cvt_pk_bf16_f32 v208, v252, v249
    v_lshlrev_b32 v248, 16, v207
    v_mfma_f32_16x16x32_bf16 a[16:19], a[220:223], v[232:235], a[16:19]
    buffer_load_dwordx4 a[248:251], v254, s[8:11], s42 offen offset:2048 sc1
    v_mfma_f32_16x16x32_bf16 a[16:19], a[208:211], v[228:231], a[16:19]
    s_mov_b32 s42, 190464
    v_lshlrev_b32 v249, 16, v209
    v_lshlrev_b32 v250, 16, v211
    v_mfma_f32_16x16x32_bf16 a[16:19], a[196:199], v[236:239], a[16:19]
    v_lshlrev_b32 v251, 16, v213
    v_and_b32 v207, s22, v207
    v_mfma_f32_16x16x32_bf16 a[20:23], a[200:203], v[236:239], a[20:23]
    ds_read_b128 v[236:239], v253 offset:8320
    v_and_b32 v209, s22, v209
    v_mfma_f32_16x16x32_bf16 a[20:23], a[212:215], v[228:231], a[20:23]
    buffer_load_dwordx4 a[252:255], v254, s[8:11], s42 offen offset:0 sc1
    v_mfma_f32_16x16x32_bf16 a[20:23], a[224:227], v[232:235], a[20:23]
    v_and_b32 v211, s22, v211
    v_and_b32 v213, s22, v213
    v_mfma_f32_16x16x32_bf16 a[24:27], a[192:195], v[228:231], a[24:27]
    v_lshlrev_b32 v252, 16, v205
    v_and_b32 v205, s22, v205
    v_mfma_f32_16x16x32_bf16 a[24:27], a[204:207], v[232:235], a[24:27]
    s_waitcnt lgkmcnt(0)
    v_fmac_f32 v252, s25, v251
    v_fmac_f32 v205, s25, v213
    v_mfma_f32_16x16x32_bf16 a[24:27], a[216:219], v[236:239], a[24:27]
    v_fmac_f32 v252, s28, v249
    v_fmac_f32 v205, s28, v209
    v_mfma_f32_16x16x32_bf16 a[28:31], a[220:223], v[236:239], a[28:31]
    buffer_load_dwordx4 v[240:243], v254, s[8:11], s42 offen offset:1024 sc1
    v_mfma_f32_16x16x32_bf16 a[28:31], a[208:211], v[232:235], a[28:31]
    v_cvt_pk_bf16_f32 v205, v252, v205
    v_lshlrev_b32 v252, 16, v215
    v_mfma_f32_16x16x32_bf16 a[28:31], a[196:199], v[228:231], a[28:31]
    v_and_b32 v215, s22, v215
    v_fmac_f32 v252, s29, v248
    v_mfma_f32_16x16x32_bf16 a[32:35], a[200:203], v[228:231], a[32:35]
    ds_read_b128 v[228:231], v253 offset:10144
    v_fmac_f32 v215, s29, v207
    v_mfma_f32_16x16x32_bf16 a[32:35], a[212:215], v[232:235], a[32:35]
    buffer_load_dwordx4 v[244:247], v254, s[8:11], s42 offen offset:2048 sc1
    v_mfma_f32_16x16x32_bf16 a[32:35], a[224:227], v[236:239], a[32:35]
    v_fmac_f32 v252, s23, v250
    v_fmac_f32 v215, s23, v211
    v_mfma_f32_16x16x32_bf16 a[36:39], a[192:195], v[232:235], a[36:39]
    v_and_b32 v203, 0x7fff, v255
    v_cvt_pk_bf16_f32 v215, v252, v215
    v_mfma_f32_16x16x32_bf16 a[36:39], a[204:207], v[236:239], a[36:39]
    s_waitcnt lgkmcnt(0)
    v_fma_f32 v252, v249, s24, v251
    v_fmac_f32 v251, -4.0, v249
    v_mfma_f32_16x16x32_bf16 a[36:39], a[216:219], v[228:231], a[36:39]
    buffer_load_dwordx2 v[192:193], v203, s[4:7], s16 offen offset:896
    v_mfma_f32_16x16x32_bf16 a[40:43], a[220:223], v[228:231], a[40:43]
    v_fma_f32 v249, v248, s24, v250
    v_fmac_f32 v250, -4.0, v248
    v_mfma_f32_16x16x32_bf16 a[40:43], a[208:211], v[236:239], a[40:43]
    v_fma_f32 v248, v250, s26, v251
    v_fmac_f32 v251, s27, v250
    v_fma_f32 v250, v249, 2.0, v252
    v_mfma_f32_16x16x32_bf16 a[40:43], a[196:199], v[232:235], a[40:43]
    v_fmac_f32 v252, -2.0, v249
    v_fma_f32 v249, v209, s24, v213
    v_mfma_f32_16x16x32_bf16 a[44:47], a[200:203], v[232:235], a[44:47]
    ds_read_b128 v[232:235], v253 offset:9888
    v_fmac_f32 v213, -4.0, v209
    v_mfma_f32_16x16x32_bf16 a[44:47], a[212:215], v[236:239], a[44:47]
    buffer_load_dwordx2 v[194:195], v203, s[4:7], s17 offen offset:896
    v_mfma_f32_16x16x32_bf16 a[44:47], a[224:227], v[228:231], a[44:47]
    v_fma_f32 v209, v207, s24, v211
    v_fmac_f32 v211, -4.0, v207
    v_mfma_f32_16x16x32_bf16 a[48:51], a[192:195], v[236:239], a[48:51]
    v_fma_f32 v207, v211, s26, v213
    v_fmac_f32 v213, s27, v211
    v_mfma_f32_16x16x32_bf16 a[48:51], a[204:207], v[228:231], a[48:51]
    s_waitcnt lgkmcnt(0)
    v_fma_f32 v211, v209, 2.0, v249
    v_fmac_f32 v249, -2.0, v209
    v_mfma_f32_16x16x32_bf16 a[48:51], a[216:219], v[232:235], a[48:51]
    buffer_load_dwordx2 v[196:197], v203, s[4:7], s18 offen offset:896
    v_mfma_f32_16x16x32_bf16 a[52:55], a[220:223], v[232:235], a[52:55]
    v_cvt_pk_bf16_f32 v207, v248, v207
    v_cvt_pk_bf16_f32 v213, v251, v213
    v_mfma_f32_16x16x32_bf16 a[52:55], a[208:211], v[228:231], a[52:55]
    v_cvt_pk_bf16_f32 v211, v250, v211
    v_cvt_pk_bf16_f32 v209, v252, v249
    v_mfma_f32_16x16x32_bf16 a[52:55], a[196:199], v[236:239], a[52:55]
    v_lshrrev_b32 v252, 15, v255
    v_mfma_f32_16x16x32_bf16 a[56:59], a[200:203], v[236:239], a[56:59]
    ds_read_b128 v[236:239], v253 offset:9632
    v_mfma_f32_16x16x32_bf16 a[56:59], a[212:215], v[228:231], a[56:59]
    buffer_load_dwordx2 v[198:199], v203, s[4:7], s19 offen offset:896
    v_mfma_f32_16x16x32_bf16 a[56:59], a[224:227], v[232:235], a[56:59]
    ds_write_b64 v252, v[206:207] offset:768
    v_mfma_f32_16x16x32_bf16 a[60:63], a[192:195], v[228:231], a[60:63]
    v_lshrrev_b32 v206, 15, v255
    v_mfma_f32_16x16x32_bf16 a[60:63], a[204:207], v[232:235], a[60:63]
    s_waitcnt lgkmcnt(1)
    s_waitcnt vmcnt(13)
    v_lshlrev_b32 v248, 16, v218
    v_mfma_f32_16x16x32_bf16 a[60:63], a[216:219], v[236:239], a[60:63]
    buffer_load_dwordx2 v[200:201], v203, s[4:7], s20 offen offset:896
    v_mfma_f32_16x16x32_bf16 a[64:67], a[220:223], v[236:239], a[64:67]
    ds_write_b64 v206, v[212:213] offset:2848
    v_mfma_f32_16x16x32_bf16 a[64:67], a[208:211], v[232:235], a[64:67]
    v_lshlrev_b32 v249, 16, v220
    v_lshlrev_b32 v250, 16, v222
    v_mfma_f32_16x16x32_bf16 a[64:67], a[196:199], v[228:231], a[64:67]
    ds_write_b64 v206, v[210:211] offset:4928
    v_mfma_f32_16x16x32_bf16 a[68:71], a[200:203], v[228:231], a[68:71]
    ds_read_b128 v[228:231], v253 offset:9376
    v_lshlrev_b32 v251, 16, v224
    v_mfma_f32_16x16x32_bf16 a[68:71], a[212:215], v[232:235], a[68:71]
    buffer_load_dwordx2 v[202:203], v203, s[4:7], s21 offen offset:896
    v_mfma_f32_16x16x32_bf16 a[68:71], a[224:227], v[236:239], a[68:71]
    ds_write_b64 v206, v[204:205] offset:17408
    v_mfma_f32_16x16x32_bf16 a[72:75], a[192:195], v[232:235], a[72:75]
    v_and_b32 v218, s22, v218
    v_and_b32 v220, s22, v220
    v_mfma_f32_16x16x32_bf16 a[72:75], a[204:207], v[236:239], a[72:75]
    s_waitcnt lgkmcnt(1)
    v_and_b32 v222, s22, v222
    v_and_b32 v224, s22, v224
    v_mfma_f32_16x16x32_bf16 a[72:75], a[216:219], v[228:231], a[72:75]
    ds_write_b64 v206, v[214:215] offset:25728
    v_mfma_f32_16x16x32_bf16 a[76:79], a[220:223], v[228:231], a[76:79]
    v_lshlrev_b32 v252, 16, v216
    v_and_b32 v216, s22, v216
    v_mfma_f32_16x16x32_bf16 a[76:79], a[208:211], v[236:239], a[76:79]
    ds_write_b64 v206, v[208:209] offset:7008
    v_mfma_f32_16x16x32_bf16 a[76:79], a[196:199], v[232:235], a[76:79]
    v_fmac_f32 v252, s25, v251
    v_fmac_f32 v216, s25, v224
    v_mfma_f32_16x16x32_bf16 a[80:83], a[200:203], v[232:235], a[80:83]
    ds_read_b128 v[232:235], v253 offset:9104
    v_fmac_f32 v252, s28, v249
    v_mfma_f32_16x16x32_bf16 a[80:83], a[212:215], v[236:239], a[80:83]
    v_fmac_f32 v216, s28, v220
    v_cvt_pk_bf16_f32 v216, v252, v216
    v_mfma_f32_16x16x32_bf16 a[80:83], a[224:227], v[228:231], a[80:83]
    s_mov_b32 s42, 221184
    v_lshlrev_b32 v252, 16, v226
    v_and_b32 v226, s22, v226
    v_mfma_f32_16x16x32_bf16 a[84:87], a[192:195], v[236:239], a[84:87]
    v_fmac_f32 v252, s29, v248
    v_fmac_f32 v226, s29, v218
    v_mfma_f32_16x16x32_bf16 a[88:91], a[196:199], v[236:239], a[88:91]
    v_fmac_f32 v252, s23, v250
    v_fmac_f32 v226, s23, v222
    v_mfma_f32_16x16x32_bf16 a[92:95], a[200:203], v[236:239], a[92:95]
    ds_read_b128 v[236:239], v253 offset:11440
    v_cvt_pk_bf16_f32 v226, v252, v226
    v_mfma_f32_16x16x32_bf16 a[92:95], a[212:215], v[228:231], a[92:95]
    buffer_load_dwordx4 a[192:195], v254, s[8:11], s42 offen offset:0 sc1
    v_mfma_f32_16x16x32_bf16 a[88:91], a[208:211], v[228:231], a[88:91]
    s_waitcnt lgkmcnt(1)
    v_fma_f32 v252, v249, s24, v251
    v_fmac_f32 v251, -4.0, v249
    v_mfma_f32_16x16x32_bf16 a[84:87], a[204:207], v[228:231], a[84:87]
    ds_read_b128 v[228:231], v253 offset:11168
    v_fma_f32 v249, v248, s24, v250
    v_mfma_f32_16x16x32_bf16 a[84:87], a[216:219], v[232:235], a[84:87]
    buffer_load_dwordx4 a[196:199], v254, s[8:11], s42 offen offset:1024 sc1
    v_mfma_f32_16x16x32_bf16 a[88:91], a[220:223], v[232:235], a[88:91]
    s_waitcnt vmcnt(14) lgkmcnt(1)
    v_fmac_f32 v250, -4.0, v248
    v_fma_f32 v248, v250, s26, v251
    v_mfma_f32_16x16x32_bf16 a[92:95], a[224:227], v[232:235], a[92:95]
    ds_read_b128 v[232:235], v253 offset:10912
    v_fmac_f32 v251, s27, v250
    v_fma_f32 v250, v249, 2.0, v252
sub5:
    v_mfma_f32_16x16x32_bf16 a[96:99], a[228:231], v[236:239], a[96:99]
    buffer_load_dwordx4 a[200:203], v254, s[8:11], s42 offen offset:2048 sc1
    v_mfma_f32_16x16x32_bf16 a[100:103], a[232:235], v[236:239], a[100:103]
    s_mov_b32 s42, 224256
    v_fmac_f32 v252, -2.0, v249
    v_fma_f32 v249, v220, s24, v224
    v_mfma_f32_16x16x32_bf16 a[104:107], a[236:239], v[236:239], a[104:107]
    ds_read_b128 v[236:239], v253 offset:10656
    s_waitcnt vmcnt(12)
    s_waitcnt lgkmcnt(2)
    v_mfma_f32_16x16x32_bf16 a[104:107], a[248:251], v[228:231], a[104:107]
    v_fmac_f32 v224, -4.0, v220
    v_fma_f32 v220, v218, s24, v222
    v_mfma_f32_16x16x32_bf16 a[100:103], a[244:247], v[228:231], a[100:103]
    buffer_load_dwordx4 a[204:207], v254, s[8:11], s42 offen offset:0 sc1
    v_mfma_f32_16x16x32_bf16 a[96:99], a[240:243], v[228:231], a[96:99]
    s_waitcnt vmcnt(10) lgkmcnt(1)
    v_fmac_f32 v222, -4.0, v218
    v_fma_f32 v218, v222, s26, v224
    v_mfma_f32_16x16x32_bf16 a[96:99], a[252:255], v[232:235], a[96:99]
    v_fmac_f32 v224, s27, v222
    v_fma_f32 v222, v220, 2.0, v249
    v_mfma_f32_16x16x32_bf16 a[100:103], v[240:243], v[232:235], a[100:103]
    v_fmac_f32 v249, -2.0, v220
    v_cvt_pk_bf16_f32 v218, v248, v218
    v_mfma_f32_16x16x32_bf16 a[104:107], v[244:247], v[232:235], a[104:107]
    buffer_load_dwordx4 a[208:211], v254, s[8:11], s42 offen offset:1024 sc1
    v_mfma_f32_16x16x32_bf16 a[108:111], a[228:231], v[228:231], a[108:111]
    v_cvt_pk_bf16_f32 v224, v251, v224
    v_cvt_pk_bf16_f32 v222, v250, v222
    v_mfma_f32_16x16x32_bf16 a[108:111], a[240:243], v[232:235], a[108:111]
    s_waitcnt lgkmcnt(0)
    v_cvt_pk_bf16_f32 v220, v252, v249
    v_lshlrev_b32 v248, 16, v219
    v_mfma_f32_16x16x32_bf16 a[108:111], a[252:255], v[236:239], a[108:111]
    v_lshlrev_b32 v249, 16, v221
    v_lshlrev_b32 v250, 16, v223
    v_mfma_f32_16x16x32_bf16 a[112:115], v[240:243], v[236:239], a[112:115]
    buffer_load_dwordx4 a[212:215], v254, s[8:11], s42 offen offset:2048 sc1
    v_mfma_f32_16x16x32_bf16 a[112:115], a[244:247], v[232:235], a[112:115]
    s_mov_b32 s42, 227328
    v_lshlrev_b32 v251, 16, v225
    v_and_b32 v219, s22, v219
    v_mfma_f32_16x16x32_bf16 a[112:115], a[232:235], v[228:231], a[112:115]
    v_and_b32 v221, s22, v221
    v_and_b32 v223, s22, v223
    v_mfma_f32_16x16x32_bf16 a[116:119], a[236:239], v[228:231], a[116:119]
    ds_read_b128 v[228:231], v253 offset:10400
    v_and_b32 v225, s22, v225
    v_mfma_f32_16x16x32_bf16 a[116:119], a[248:251], v[232:235], a[116:119]
    buffer_load_dwordx4 a[216:219], v254, s[8:11], s42 offen offset:0 sc1
    v_mfma_f32_16x16x32_bf16 a[116:119], v[244:247], v[236:239], a[116:119]
    v_lshlrev_b32 v252, 16, v217
    v_and_b32 v217, s22, v217
    v_mfma_f32_16x16x32_bf16 a[120:123], a[228:231], v[232:235], a[120:123]
    v_fmac_f32 v252, s25, v251
    v_fmac_f32 v217, s25, v225
    v_mfma_f32_16x16x32_bf16 a[120:123], a[240:243], v[236:239], a[120:123]
    s_waitcnt lgkmcnt(0)
    v_fmac_f32 v252, s28, v249
    v_fmac_f32 v217, s28, v221
    v_mfma_f32_16x16x32_bf16 a[120:123], a[252:255], v[228:231], a[120:123]
    v_cvt_pk_bf16_f32 v217, v252, v217
    v_lshlrev_b32 v252, 16, v227
    v_mfma_f32_16x16x32_bf16 a[124:127], v[240:243], v[228:231], a[124:127]
    buffer_load_dwordx4 a[220:223], v254, s[8:11], s42 offen offset:1024 sc1
    v_mfma_f32_16x16x32_bf16 a[124:127], a[244:247], v[236:239], a[124:127]
    v_and_b32 v227, s22, v227
    v_fmac_f32 v252, s29, v248
    v_mfma_f32_16x16x32_bf16 a[124:127], a[232:235], v[232:235], a[124:127]
    v_fmac_f32 v227, s29, v219
    v_fmac_f32 v252, s23, v250
    v_mfma_f32_16x16x32_bf16 a[128:131], a[236:239], v[232:235], a[128:131]
    ds_read_b128 v[232:235], v253 offset:12224
    v_fmac_f32 v227, s23, v223
    v_mfma_f32_16x16x32_bf16 a[128:131], a[248:251], v[236:239], a[128:131]
    buffer_load_dwordx4 a[224:227], v254, s[8:11], s42 offen offset:2048 sc1
    v_mfma_f32_16x16x32_bf16 a[128:131], v[244:247], v[228:231], a[128:131]
    v_cvt_pk_bf16_f32 v227, v252, v227
    v_fma_f32 v252, v249, s24, v251
    v_mfma_f32_16x16x32_bf16 a[132:135], a[228:231], v[236:239], a[132:135]
    v_and_b32 v215, 0x7fff, v255
    v_fmac_f32 v251, -4.0, v249
    v_mfma_f32_16x16x32_bf16 a[132:135], a[240:243], v[228:231], a[132:135]
    s_waitcnt lgkmcnt(0)
    v_fma_f32 v249, v248, s24, v250
    v_fmac_f32 v250, -4.0, v248
    v_mfma_f32_16x16x32_bf16 a[132:135], a[252:255], v[232:235], a[132:135]
    buffer_load_dwordx2 v[204:205], v215, s[4:7], s16 offen offset:1280
    v_mfma_f32_16x16x32_bf16 a[136:139], v[240:243], v[232:235], a[136:139]
    v_fma_f32 v248, v250, s26, v251
    v_fmac_f32 v251, s27, v250
    v_mfma_f32_16x16x32_bf16 a[136:139], a[244:247], v[228:231], a[136:139]
    v_fma_f32 v250, v249, 2.0, v252
    v_fmac_f32 v252, -2.0, v249
    v_mfma_f32_16x16x32_bf16 a[136:139], a[232:235], v[236:239], a[136:139]
    v_fma_f32 v249, v221, s24, v225
    v_fmac_f32 v225, -4.0, v221
    v_mfma_f32_16x16x32_bf16 a[140:143], a[236:239], v[236:239], a[140:143]
    ds_read_b128 v[236:239], v253 offset:11968
    v_fma_f32 v221, v219, s24, v223
    v_mfma_f32_16x16x32_bf16 a[140:143], a[248:251], v[228:231], a[140:143]
    buffer_load_dwordx2 v[206:207], v215, s[4:7], s17 offen offset:1280
    v_mfma_f32_16x16x32_bf16 a[140:143], v[244:247], v[232:235], a[140:143]
    v_fmac_f32 v223, -4.0, v219
    v_fma_f32 v219, v223, s26, v225
    v_mfma_f32_16x16x32_bf16 a[144:147], a[228:231], v[228:231], a[144:147]
    v_fmac_f32 v225, s27, v223
    v_fma_f32 v223, v221, 2.0, v249
    v_mfma_f32_16x16x32_bf16 a[144:147], a[240:243], v[232:235], a[144:147]
    s_waitcnt lgkmcnt(0)
    v_fmac_f32 v249, -2.0, v221
    v_cvt_pk_bf16_f32 v219, v248, v219
    v_mfma_f32_16x16x32_bf16 a[144:147], a[252:255], v[236:239], a[144:147]
    buffer_load_dwordx2 v[208:209], v215, s[4:7], s18 offen offset:1280
    v_mfma_f32_16x16x32_bf16 a[148:151], v[240:243], v[236:239], a[148:151]
    v_cvt_pk_bf16_f32 v225, v251, v225
    v_cvt_pk_bf16_f32 v223, v250, v223
    v_cvt_pk_bf16_f32 v221, v252, v249
    v_mfma_f32_16x16x32_bf16 a[148:151], a[244:247], v[232:235], a[148:151]
    v_lshrrev_b32 v252, 15, v255
    v_mfma_f32_16x16x32_bf16 a[148:151], a[232:235], v[228:231], a[148:151]
    ds_write_b64 v252, v[218:219] offset:512
    v_mfma_f32_16x16x32_bf16 a[152:155], a[236:239], v[228:231], a[152:155]
    ds_read_b128 v[228:231], v253 offset:11712
    v_lshrrev_b32 v218, 15, v255
    v_mfma_f32_16x16x32_bf16 a[152:155], a[248:251], v[232:235], a[152:155]
    buffer_load_dwordx2 v[210:211], v215, s[4:7], s19 offen offset:1280
    v_mfma_f32_16x16x32_bf16 a[152:155], v[244:247], v[236:239], a[152:155]
    ds_write_b64 v218, v[224:225] offset:2592
    v_mfma_f32_16x16x32_bf16 a[156:159], a[228:231], v[232:235], a[156:159]
    v_mfma_f32_16x16x32_bf16 a[156:159], a[240:243], v[236:239], a[156:159]
    s_waitcnt lgkmcnt(1)
    s_waitcnt vmcnt(13)
    v_lshlrev_b32 v248, 16, v194
    v_mfma_f32_16x16x32_bf16 a[156:159], a[252:255], v[228:231], a[156:159]
    buffer_load_dwordx2 v[212:213], v215, s[4:7], s20 offen offset:1280
    v_mfma_f32_16x16x32_bf16 a[160:163], v[240:243], v[228:231], a[160:163]
    ds_write_b64 v218, v[222:223] offset:4672
    v_mfma_f32_16x16x32_bf16 a[160:163], a[244:247], v[236:239], a[160:163]
    v_lshlrev_b32 v249, 16, v196
    v_lshlrev_b32 v250, 16, v198
    v_mfma_f32_16x16x32_bf16 a[160:163], a[232:235], v[232:235], a[160:163]
    ds_write_b64 v218, v[216:217] offset:17152
    v_mfma_f32_16x16x32_bf16 a[164:167], a[236:239], v[232:235], a[164:167]
    ds_read_b128 v[232:235], v253 offset:11456
    v_lshlrev_b32 v251, 16, v200
    v_mfma_f32_16x16x32_bf16 a[164:167], a[248:251], v[236:239], a[164:167]
    buffer_load_dwordx2 v[214:215], v215, s[4:7], s21 offen offset:1280
    v_mfma_f32_16x16x32_bf16 a[164:167], v[244:247], v[228:231], a[164:167]
    ds_write_b64 v218, v[226:227] offset:25472
    v_mfma_f32_16x16x32_bf16 a[168:171], a[228:231], v[236:239], a[168:171]
    v_and_b32 v194, s22, v194
    v_and_b32 v196, s22, v196
    v_mfma_f32_16x16x32_bf16 a[168:171], a[240:243], v[228:231], a[168:171]
pad2:
    s_cbranch_vccnz pad6
    s_waitcnt lgkmcnt(1)
    v_and_b32 v198, s22, v198
    v_and_b32 v200, s22, v200
    v_mfma_f32_16x16x32_bf16 a[168:171], a[252:255], v[232:235], a[168:171]
    ds_write_b64 v218, v[220:221] offset:6752
    v_mfma_f32_16x16x32_bf16 a[172:175], v[240:243], v[232:235], a[172:175]
    ds_read_b128 v[216:219], v253 offset:39904
    s_mov_b32 s45, 405865480
    v_mfma_f32_16x16x32_bf16 a[172:175], a[244:247], v[228:231], a[172:175]
    v_bfe_u32 v220, v254, 5, 3
    v_mul_u32_u24 v221, 5, v220
    v_mfma_f32_16x16x32_bf16 a[172:175], a[232:235], v[236:239], a[172:175]
    v_bfe_u32 v221, s45, v221, 5
    v_mul_u32_u24 v221, 65, v221
    v_mfma_f32_16x16x32_bf16 a[176:179], a[236:239], v[236:239], a[176:179]
    ds_read_b128 v[236:239], v253 offset:11184
    v_sub_u32 v221, v221, v220
    v_mfma_f32_16x16x32_bf16 a[176:179], a[248:251], v[228:231], a[176:179]
    v_lshl_add_u32 v220, v221, 5, v253
    s_waitcnt lgkmcnt(1)
    v_mfma_f32_16x16x32_bf16 a[176:179], v[244:247], v[232:235], a[176:179]
    s_mov_b32 s42, 258048
    v_lshlrev_b32 v252, 16, v192
    v_and_b32 v192, s22, v192
    v_mfma_f32_16x16x32_bf16 a[180:183], a[228:231], v[228:231], a[180:183]
    s_mov_b64 exec, s[46:47]
    ds_write_b128 v220, v[216:219] offset:1024
    s_mov_b64 exec, -1
    v_mfma_f32_16x16x32_bf16 a[184:187], a[232:235], v[228:231], a[184:187]
    v_fmac_f32 v252, s25, v251
    v_fmac_f32 v192, s25, v200
    v_mfma_f32_16x16x32_bf16 a[188:191], a[236:239], v[228:231], a[188:191]
    ds_read_b128 v[228:231], v253 offset:13520
    v_fmac_f32 v252, s28, v249
    v_mfma_f32_16x16x32_bf16 a[188:191], a[248:251], v[232:235], a[188:191]
    buffer_load_dwordx4 a[228:231], v254, s[8:11], s42 offen offset:0 sc1
    v_mfma_f32_16x16x32_bf16 a[184:187], a[244:247], v[232:235], a[184:187]
    s_waitcnt lgkmcnt(2)
    v_fmac_f32 v192, s28, v196
    v_cvt_pk_bf16_f32 v192, v252, v192
    v_mfma_f32_16x16x32_bf16 a[180:183], a[240:243], v[232:235], a[180:183]
    ds_read_b128 v[232:235], v253 offset:13248
    v_lshlrev_b32 v252, 16, v202
    v_mfma_f32_16x16x32_bf16 a[180:183], a[252:255], v[236:239], a[180:183]
    buffer_load_dwordx4 a[232:235], v254, s[8:11], s42 offen offset:1024 sc1
    v_mfma_f32_16x16x32_bf16 a[184:187], v[240:243], v[236:239], a[184:187]
    s_waitcnt vmcnt(14) lgkmcnt(1)
    v_and_b32 v202, s22, v202
    v_fmac_f32 v252, s29, v248
    v_mfma_f32_16x16x32_bf16 a[188:191], v[244:247], v[236:239], a[188:191]
    ds_read_b128 v[236:239], v253 offset:12992
    v_fmac_f32 v202, s29, v194
sub6:
    v_mfma_f32_16x16x32_bf16 v[0:3], a[192:195], v[228:231], v[0:3]
    buffer_load_dwordx4 a[236:239], v254, s[8:11], s42 offen offset:2048 sc1
    v_mfma_f32_16x16x32_bf16 v[4:7], a[196:199], v[228:231], v[4:7]
    s_mov_b32 s42, 261120
    v_fmac_f32 v252, s23, v250
    v_fmac_f32 v202, s23, v198
    v_mfma_f32_16x16x32_bf16 v[8:11], a[200:203], v[228:231], v[8:11]
    ds_read_b128 v[228:231], v253 offset:12736
    s_waitcnt vmcnt(12)
    s_waitcnt lgkmcnt(2)
    v_mfma_f32_16x16x32_bf16 v[8:11], a[212:215], v[232:235], v[8:11]
    v_cvt_pk_bf16_f32 v202, v252, v202
    v_fma_f32 v252, v249, s24, v251
    v_mfma_f32_16x16x32_bf16 v[4:7], a[208:211], v[232:235], v[4:7]
    buffer_load_dwordx4 a[240:243], v254, s[8:11], s42 offen offset:0 sc1
    v_mfma_f32_16x16x32_bf16 v[0:3], a[204:207], v[232:235], v[0:3]
    s_waitcnt vmcnt(10) lgkmcnt(1)
    v_fmac_f32 v251, -4.0, v249
    v_fma_f32 v249, v248, s24, v250
    v_mfma_f32_16x16x32_bf16 v[0:3], a[216:219], v[236:239], v[0:3]
    v_fmac_f32 v250, -4.0, v248
    v_fma_f32 v248, v250, s26, v251
    v_mfma_f32_16x16x32_bf16 v[4:7], a[220:223], v[236:239], v[4:7]
    v_fmac_f32 v251, s27, v250
    v_fma_f32 v250, v249, 2.0, v252
    v_fmac_f32 v252, -2.0, v249
    v_mfma_f32_16x16x32_bf16 v[8:11], a[224:227], v[236:239], v[8:11]
    buffer_load_dwordx4 a[244:247], v254, s[8:11], s42 offen offset:1024 sc1
    v_mfma_f32_16x16x32_bf16 v[12:15], a[192:195], v[232:235], v[12:15]
    v_fma_f32 v249, v196, s24, v200
    v_fmac_f32 v200, -4.0, v196
    v_mfma_f32_16x16x32_bf16 v[12:15], a[204:207], v[236:239], v[12:15]
    s_waitcnt lgkmcnt(0)
    v_fma_f32 v196, v194, s24, v198
    v_fmac_f32 v198, -4.0, v194
    v_mfma_f32_16x16x32_bf16 v[12:15], a[216:219], v[228:231], v[12:15]
    v_fma_f32 v194, v198, s26, v200
    v_fmac_f32 v200, s27, v198
    v_mfma_f32_16x16x32_bf16 v[16:19], a[220:223], v[228:231], v[16:19]
    buffer_load_dwordx4 a[248:251], v254, s[8:11], s42 offen offset:2048 sc1
    v_mfma_f32_16x16x32_bf16 v[16:19], a[208:211], v[236:239], v[16:19]
    s_mov_b32 s42, 264192
    v_fma_f32 v198, v196, 2.0, v249
    v_fmac_f32 v249, -2.0, v196
    v_mfma_f32_16x16x32_bf16 v[16:19], a[196:199], v[232:235], v[16:19]
    v_cvt_pk_bf16_f32 v194, v248, v194
    v_cvt_pk_bf16_f32 v200, v251, v200
    v_mfma_f32_16x16x32_bf16 v[20:23], a[200:203], v[232:235], v[20:23]
    ds_read_b128 v[232:235], v253 offset:12480
    v_cvt_pk_bf16_f32 v198, v250, v198
    v_mfma_f32_16x16x32_bf16 v[20:23], a[212:215], v[236:239], v[20:23]
    buffer_load_dwordx4 a[252:255], v254, s[8:11], s42 offen offset:0 sc1
    v_mfma_f32_16x16x32_bf16 v[20:23], a[224:227], v[228:231], v[20:23]
    v_cvt_pk_bf16_f32 v196, v252, v249
    v_lshlrev_b32 v248, 16, v195
    v_mfma_f32_16x16x32_bf16 v[24:27], a[192:195], v[236:239], v[24:27]
    v_lshlrev_b32 v249, 16, v197
    v_lshlrev_b32 v250, 16, v199
    v_mfma_f32_16x16x32_bf16 v[24:27], a[204:207], v[228:231], v[24:27]
    s_waitcnt lgkmcnt(0)
    v_lshlrev_b32 v251, 16, v201
    v_and_b32 v195, s22, v195
    v_mfma_f32_16x16x32_bf16 v[24:27], a[216:219], v[232:235], v[24:27]
    v_and_b32 v197, s22, v197
    v_and_b32 v199, s22, v199
    v_mfma_f32_16x16x32_bf16 v[28:31], a[220:223], v[232:235], v[28:31]
    buffer_load_dwordx4 v[240:243], v254, s[8:11], s42 offen offset:1024 sc1
    v_mfma_f32_16x16x32_bf16 v[28:31], a[208:211], v[228:231], v[28:31]
    v_and_b32 v201, s22, v201
    v_lshlrev_b32 v252, 16, v193
    v_mfma_f32_16x16x32_bf16 v[28:31], a[196:199], v[236:239], v[28:31]
    v_and_b32 v193, s22, v193
    v_fmac_f32 v252, s25, v251
    v_mfma_f32_16x16x32_bf16 v[32:35], a[200:203], v[236:239], v[32:35]
    ds_read_b128 v[236:239], v253 offset:14304
    v_fmac_f32 v193, s25, v201
    v_mfma_f32_16x16x32_bf16 v[32:35], a[212:215], v[228:231], v[32:35]
    buffer_load_dwordx4 v[244:247], v254, s[8:11], s42 offen offset:2048 sc1
    v_mfma_f32_16x16x32_bf16 v[32:35], a[224:227], v[232:235], v[32:35]
    v_fmac_f32 v252, s28, v249
    v_fmac_f32 v193, s28, v197
    v_mfma_f32_16x16x32_bf16 v[36:39], a[192:195], v[228:231], v[36:39]
    v_and_b32 v227, 0x7fff, v255
    v_cvt_pk_bf16_f32 v193, v252, v193
    v_mfma_f32_16x16x32_bf16 v[36:39], a[204:207], v[232:235], v[36:39]
    s_waitcnt lgkmcnt(0)
    v_lshlrev_b32 v252, 16, v203
    v_and_b32 v203, s22, v203
    v_mfma_f32_16x16x32_bf16 v[36:39], a[216:219], v[236:239], v[36:39]
    buffer_load_dwordx2 v[216:217], v227, s[4:7], s16 offen offset:192
    v_mfma_f32_16x16x32_bf16 v[40:43], a[220:223], v[236:239], v[40:43]
    v_fmac_f32 v252, s29, v248
    v_fmac_f32 v203, s29, v195
    v_mfma_f32_16x16x32_bf16 v[40:43], a[208:211], v[232:235], v[40:43]
    v_fmac_f32 v252, s23, v250
    v_fmac_f32 v203, s23, v199
    v_mfma_f32_16x16x32_bf16 v[40:43], a[196:199], v[228:231], v[40:43]
    v_cvt_pk_bf16_f32 v203, v252, v203
    v_fma_f32 v252, v249, s24, v251
    v_mfma_f32_16x16x32_bf16 v[44:47], a[200:203], v[228:231], v[44:47]
    ds_read_b128 v[228:231], v253 offset:14048
    v_fmac_f32 v251, -4.0, v249
    v_mfma_f32_16x16x32_bf16 v[44:47], a[212:215], v[232:235], v[44:47]
    buffer_load_dwordx2 v[218:219], v227, s[4:7], s17 offen offset:192
    v_mfma_f32_16x16x32_bf16 v[44:47], a[224:227], v[236:239], v[44:47]
    v_fma_f32 v249, v248, s24, v250
    v_fmac_f32 v250, -4.0, v248
    v_mfma_f32_16x16x32_bf16 v[48:51], a[192:195], v[232:235], v[48:51]
    v_fma_f32 v248, v250, s26, v251
    v_fmac_f32 v251, s27, v250
    v_mfma_f32_16x16x32_bf16 v[48:51], a[204:207], v[236:239], v[48:51]
    s_waitcnt lgkmcnt(0)
    v_fma_f32 v250, v249, 2.0, v252
    v_fmac_f32 v252, -2.0, v249
    v_mfma_f32_16x16x32_bf16 v[48:51], a[216:219], v[228:231], v[48:51]
    buffer_load_dwordx2 v[220:221], v227, s[4:7], s18 offen offset:192
    v_mfma_f32_16x16x32_bf16 v[52:55], a[220:223], v[228:231], v[52:55]
    v_fma_f32 v249, v197, s24, v201
    v_fmac_f32 v201, -4.0, v197
    v_mfma_f32_16x16x32_bf16 v[52:55], a[208:211], v[236:239], v[52:55]
    v_fma_f32 v197, v195, s24, v199
    v_fmac_f32 v199, -4.0, v195
    v_mfma_f32_16x16x32_bf16 v[52:55], a[196:199], v[232:235], v[52:55]
    v_fma_f32 v195, v199, s26, v201
    v_fmac_f32 v201, s27, v199
    v_mfma_f32_16x16x32_bf16 v[56:59], a[200:203], v[232:235], v[56:59]
    ds_read_b128 v[232:235], v253 offset:13792
    v_fma_f32 v199, v197, 2.0, v249
    v_mfma_f32_16x16x32_bf16 v[56:59], a[212:215], v[236:239], v[56:59]
    buffer_load_dwordx2 v[222:223], v227, s[4:7], s19 offen offset:192
    v_mfma_f32_16x16x32_bf16 v[56:59], a[224:227], v[228:231], v[56:59]
    v_fmac_f32 v249, -2.0, v197
    v_cvt_pk_bf16_f32 v195, v248, v195
    v_mfma_f32_16x16x32_bf16 v[60:63], a[192:195], v[236:239], v[60:63]
    v_cvt_pk_bf16_f32 v201, v251, v201
    v_cvt_pk_bf16_f32 v199, v250, v199
    v_mfma_f32_16x16x32_bf16 v[60:63], a[204:207], v[228:231], v[60:63]
    s_waitcnt lgkmcnt(0)
    v_cvt_pk_bf16_f32 v197, v252, v249
    v_lshrrev_b32 v252, 15, v255
    v_mfma_f32_16x16x32_bf16 v[60:63], a[216:219], v[232:235], v[60:63]
    buffer_load_dwordx2 v[224:225], v227, s[4:7], s20 offen offset:192
    v_mfma_f32_16x16x32_bf16 v[64:67], a[220:223], v[232:235], v[64:67]
    ds_write_b64 v252, v[194:195] offset:256
    v_mfma_f32_16x16x32_bf16 v[64:67], a[208:211], v[228:231], v[64:67]
    s_waitcnt vmcnt(14)
    v_lshrrev_b32 v194, 15, v255
    v_lshlrev_b32 v248, 16, v206
    v_mfma_f32_16x16x32_bf16 v[64:67], a[196:199], v[236:239], v[64:67]
    ds_write_b64 v194, v[200:201] offset:2336
    v_mfma_f32_16x16x32_bf16 v[68:71], a[200:203], v[236:239], v[68:71]
    ds_read_b128 v[236:239], v253 offset:13536
    v_lshlrev_b32 v249, 16, v208
    v_mfma_f32_16x16x32_bf16 v[68:71], a[212:215], v[228:231], v[68:71]
    buffer_load_dwordx2 v[226:227], v227, s[4:7], s21 offen offset:192
    v_mfma_f32_16x16x32_bf16 v[68:71], a[224:227], v[232:235], v[68:71]
    ds_write_b64 v194, v[198:199] offset:4416
    v_mfma_f32_16x16x32_bf16 v[72:75], a[192:195], v[228:231], v[72:75]
    v_lshlrev_b32 v250, 16, v210
    v_lshlrev_b32 v251, 16, v212
    v_mfma_f32_16x16x32_bf16 v[72:75], a[204:207], v[232:235], v[72:75]
    s_waitcnt lgkmcnt(1)
    v_and_b32 v206, s22, v206
    v_and_b32 v208, s22, v208
    v_mfma_f32_16x16x32_bf16 v[72:75], a[216:219], v[236:239], v[72:75]
    ds_write_b64 v194, v[192:193] offset:16896
    v_mfma_f32_16x16x32_bf16 v[76:79], a[220:223], v[236:239], v[76:79]
    v_and_b32 v210, s22, v210
    v_and_b32 v212, s22, v212
    v_mfma_f32_16x16x32_bf16 v[76:79], a[208:211], v[232:235], v[76:79]
    ds_write_b64 v194, v[202:203] offset:25216
    v_mfma_f32_16x16x32_bf16 v[76:79], a[196:199], v[228:231], v[76:79]
    v_lshlrev_b32 v252, 16, v204
    v_and_b32 v204, s22, v204
    v_mfma_f32_16x16x32_bf16 v[80:83], a[200:203], v[228:231], v[80:83]
    ds_read_b128 v[228:231], v253 offset:13264
    v_fmac_f32 v252, s25, v251
    v_mfma_f32_16x16x32_bf16 v[80:83], a[212:215], v[232:235], v[80:83]
    ds_write_b64 v194, v[196:197] offset:6496
    v_mfma_f32_16x16x32_bf16 v[80:83], a[224:227], v[236:239], v[80:83]
    s_mov_b32 s42, 294912
    v_fmac_f32 v204, s25, v212
    v_fmac_f32 v252, s28, v249
    v_mfma_f32_16x16x32_bf16 v[84:87], a[192:195], v[232:235], v[84:87]
    v_fmac_f32 v204, s28, v208
    v_cvt_pk_bf16_f32 v204, v252, v204
    v_mfma_f32_16x16x32_bf16 v[88:91], a[196:199], v[232:235], v[88:91]
    v_lshlrev_b32 v252, 16, v214
    v_and_b32 v214, s22, v214
    v_mfma_f32_16x16x32_bf16 v[92:95], a[200:203], v[232:235], v[92:95]
    ds_read_b128 v[232:235], v253 offset:32240
    v_fmac_f32 v252, s29, v248
    v_mfma_f32_16x16x32_bf16 v[92:95], a[212:215], v[236:239], v[92:95]
    buffer_load_dwordx4 a[192:195], v254, s[8:11], s42 offen offset:0 sc1
    v_mfma_f32_16x16x32_bf16 v[88:91], a[208:211], v[236:239], v[88:91]
    s_waitcnt lgkmcnt(2)
    v_fmac_f32 v214, s29, v206
    v_fmac_f32 v252, s23, v250
    v_mfma_f32_16x16x32_bf16 v[84:87], a[204:207], v[236:239], v[84:87]
    ds_read_b128 v[236:239], v253 offset:31968
    v_fmac_f32 v214, s23, v210
    v_mfma_f32_16x16x32_bf16 v[84:87], a[216:219], v[228:231], v[84:87]
    buffer_load_dwordx4 a[196:199], v254, s[8:11], s42 offen offset:1024 sc1
    v_mfma_f32_16x16x32_bf16 v[88:91], a[220:223], v[228:231], v[88:91]
    s_waitcnt vmcnt(14) lgkmcnt(1)
    v_cvt_pk_bf16_f32 v214, v252, v214
    v_fma_f32 v252, v249, s24, v251
    v_mfma_f32_16x16x32_bf16 v[92:95], a[224:227], v[228:231], v[92:95]
    ds_read_b128 v[228:231], v253 offset:31712
    v_fmac_f32 v251, -4.0, v249
sub7:
    v_mfma_f32_16x16x32_bf16 v[96:99], a[228:231], v[232:235], v[96:99]
    buffer_load_dwordx4 a[200:203], v254, s[8:11], s42 offen offset:2048 sc1
    v_mfma_f32_16x16x32_bf16 v[100:103], a[232:235], v[232:235], v[100:103]
    s_mov_b32 s42, 297984
    v_fma_f32 v249, v248, s24, v250
    v_fmac_f32 v250, -4.0, v248
    v_mfma_f32_16x16x32_bf16 v[104:107], a[236:239], v[232:235], v[104:107]
    ds_read_b128 v[232:235], v253 offset:31456
    s_waitcnt vmcnt(12)
    s_waitcnt lgkmcnt(2)
    v_mfma_f32_16x16x32_bf16 v[104:107], a[248:251], v[236:239], v[104:107]
    v_fma_f32 v248, v250, s26, v251
    v_fmac_f32 v251, s27, v250
    v_mfma_f32_16x16x32_bf16 v[100:103], a[244:247], v[236:239], v[100:103]
    buffer_load_dwordx4 a[204:207], v254, s[8:11], s42 offen offset:0 sc1
    v_mfma_f32_16x16x32_bf16 v[96:99], a[240:243], v[236:239], v[96:99]
    s_waitcnt vmcnt(10) lgkmcnt(1)
    v_fma_f32 v250, v249, 2.0, v252
    v_fmac_f32 v252, -2.0, v249
    v_mfma_f32_16x16x32_bf16 v[96:99], a[252:255], v[228:231], v[96:99]
    v_fma_f32 v249, v208, s24, v212
    v_fmac_f32 v212, -4.0, v208
    v_mfma_f32_16x16x32_bf16 v[100:103], v[240:243], v[228:231], v[100:103]
    v_fma_f32 v208, v206, s24, v210
    v_fmac_f32 v210, -4.0, v206
    v_mfma_f32_16x16x32_bf16 v[104:107], v[244:247], v[228:231], v[104:107]
    buffer_load_dwordx4 a[208:211], v254, s[8:11], s42 offen offset:1024 sc1
    v_mfma_f32_16x16x32_bf16 v[108:111], a[228:231], v[236:239], v[108:111]
    v_fma_f32 v206, v210, s26, v212
    v_fmac_f32 v212, s27, v210
    v_mfma_f32_16x16x32_bf16 v[108:111], a[240:243], v[228:231], v[108:111]
    s_waitcnt lgkmcnt(0)
    v_fma_f32 v210, v208, 2.0, v249
    v_fmac_f32 v249, -2.0, v208
    v_mfma_f32_16x16x32_bf16 v[108:111], a[252:255], v[232:235], v[108:111]
    v_cvt_pk_bf16_f32 v206, v248, v206
    v_cvt_pk_bf16_f32 v212, v251, v212
    v_mfma_f32_16x16x32_bf16 v[112:115], v[240:243], v[232:235], v[112:115]
    buffer_load_dwordx4 a[212:215], v254, s[8:11], s42 offen offset:2048 sc1
    v_mfma_f32_16x16x32_bf16 v[112:115], a[244:247], v[228:231], v[112:115]
    s_mov_b32 s42, 301056
    v_cvt_pk_bf16_f32 v210, v250, v210
    v_cvt_pk_bf16_f32 v208, v252, v249
    v_mfma_f32_16x16x32_bf16 v[112:115], a[232:235], v[236:239], v[112:115]
    v_lshlrev_b32 v248, 16, v207
    v_lshlrev_b32 v249, 16, v209
    v_mfma_f32_16x16x32_bf16 v[116:119], a[236:239], v[236:239], v[116:119]
    ds_read_b128 v[236:239], v253 offset:31200
    v_lshlrev_b32 v250, 16, v211
    v_lshlrev_b32 v251, 16, v213
    v_mfma_f32_16x16x32_bf16 v[116:119], a[248:251], v[228:231], v[116:119]
    buffer_load_dwordx4 a[216:219], v254, s[8:11], s42 offen offset:0 sc1
    v_mfma_f32_16x16x32_bf16 v[116:119], v[244:247], v[232:235], v[116:119]
    v_and_b32 v207, s22, v207
    v_and_b32 v209, s22, v209
    v_mfma_f32_16x16x32_bf16 v[120:123], a[228:231], v[228:231], v[120:123]
    v_and_b32 v211, s22, v211
    v_and_b32 v213, s22, v213
    v_mfma_f32_16x16x32_bf16 v[120:123], a[240:243], v[232:235], v[120:123]
    s_waitcnt lgkmcnt(0)
    v_lshlrev_b32 v252, 16, v205
    v_and_b32 v205, s22, v205
    v_mfma_f32_16x16x32_bf16 v[120:123], a[252:255], v[236:239], v[120:123]
    v_fmac_f32 v252, s25, v251
    v_fmac_f32 v205, s25, v213
    v_mfma_f32_16x16x32_bf16 v[124:127], v[240:243], v[236:239], v[124:127]
    buffer_load_dwordx4 a[220:223], v254, s[8:11], s42 offen offset:1024 sc1
    v_mfma_f32_16x16x32_bf16 v[124:127], a[244:247], v[232:235], v[124:127]
    v_fmac_f32 v252, s28, v249
    v_fmac_f32 v205, s28, v209
    v_mfma_f32_16x16x32_bf16 v[124:127], a[232:235], v[228:231], v[124:127]
    v_cvt_pk_bf16_f32 v205, v252, v205
    v_lshlrev_b32 v252, 16, v215
    v_mfma_f32_16x16x32_bf16 v[128:131], a[236:239], v[228:231], v[128:131]
    ds_read_b128 v[228:231], v253 offset:33024
    v_and_b32 v215, s22, v215
    v_mfma_f32_16x16x32_bf16 v[128:131], a[248:251], v[232:235], v[128:131]
    buffer_load_dwordx4 a[224:227], v254, s[8:11], s42 offen offset:2048 sc1
    v_mfma_f32_16x16x32_bf16 v[128:131], v[244:247], v[236:239], v[128:131]
    v_fmac_f32 v252, s29, v248
    v_fmac_f32 v215, s29, v207
    v_mfma_f32_16x16x32_bf16 v[132:135], a[228:231], v[232:235], v[132:135]
    v_and_b32 v203, 0x7fff, v255
    v_fmac_f32 v252, s23, v250
    v_mfma_f32_16x16x32_bf16 v[132:135], a[240:243], v[236:239], v[132:135]
    s_waitcnt lgkmcnt(0)
    v_fmac_f32 v215, s23, v211
    v_cvt_pk_bf16_f32 v215, v252, v215
    v_mfma_f32_16x16x32_bf16 v[132:135], a[252:255], v[228:231], v[132:135]
    buffer_load_dwordx2 v[192:193], v203, s[4:7], s16 offen offset:576
    v_mfma_f32_16x16x32_bf16 v[136:139], v[240:243], v[228:231], v[136:139]
    v_fma_f32 v252, v249, s24, v251
    v_fmac_f32 v251, -4.0, v249
    v_mfma_f32_16x16x32_bf16 v[136:139], a[244:247], v[236:239], v[136:139]
    v_fma_f32 v249, v248, s24, v250
    v_fmac_f32 v250, -4.0, v248
    v_mfma_f32_16x16x32_bf16 v[136:139], a[232:235], v[232:235], v[136:139]
    v_fma_f32 v248, v250, s26, v251
    v_fmac_f32 v251, s27, v250
    v_mfma_f32_16x16x32_bf16 v[140:143], a[236:239], v[232:235], v[140:143]
    ds_read_b128 v[232:235], v253 offset:32768
    v_fma_f32 v250, v249, 2.0, v252
    v_mfma_f32_16x16x32_bf16 v[140:143], a[248:251], v[236:239], v[140:143]
    buffer_load_dwordx2 v[194:195], v203, s[4:7], s17 offen offset:576
    v_mfma_f32_16x16x32_bf16 v[140:143], v[244:247], v[228:231], v[140:143]
    v_fmac_f32 v252, -2.0, v249
    v_fma_f32 v249, v209, s24, v213
    v_mfma_f32_16x16x32_bf16 v[144:147], a[228:231], v[236:239], v[144:147]
    v_fmac_f32 v213, -4.0, v209
    v_fma_f32 v209, v207, s24, v211
    v_mfma_f32_16x16x32_bf16 v[144:147], a[240:243], v[228:231], v[144:147]
    s_waitcnt lgkmcnt(0)
    v_fmac_f32 v211, -4.0, v207
    v_fma_f32 v207, v211, s26, v213
    v_mfma_f32_16x16x32_bf16 v[144:147], a[252:255], v[232:235], v[144:147]
    buffer_load_dwordx2 v[196:197], v203, s[4:7], s18 offen offset:576
    v_mfma_f32_16x16x32_bf16 v[148:151], v[240:243], v[232:235], v[148:151]
    v_fmac_f32 v213, s27, v211
    v_fma_f32 v211, v209, 2.0, v249
    v_mfma_f32_16x16x32_bf16 v[148:151], a[244:247], v[228:231], v[148:151]
    v_fmac_f32 v249, -2.0, v209
    v_cvt_pk_bf16_f32 v207, v248, v207
    v_mfma_f32_16x16x32_bf16 v[148:151], a[232:235], v[236:239], v[148:151]
    v_cvt_pk_bf16_f32 v213, v251, v213
    v_cvt_pk_bf16_f32 v211, v250, v211
    v_mfma_f32_16x16x32_bf16 v[152:155], a[236:239], v[236:239], v[152:155]
    ds_read_b128 v[236:239], v253 offset:32512
    v_cvt_pk_bf16_f32 v209, v252, v249
    v_mfma_f32_16x16x32_bf16 v[152:155], a[248:251], v[228:231], v[152:155]
    buffer_load_dwordx2 v[198:199], v203, s[4:7], s19 offen offset:576
    v_mfma_f32_16x16x32_bf16 v[152:155], v[244:247], v[232:235], v[152:155]
    v_lshrrev_b32 v252, 15, v255
    v_mfma_f32_16x16x32_bf16 v[156:159], a[228:231], v[228:231], v[156:159]
    ds_write_b64 v252, v[206:207] offset:0
    v_mfma_f32_16x16x32_bf16 v[156:159], a[240:243], v[232:235], v[156:159]
    s_waitcnt lgkmcnt(1)
    v_lshrrev_b32 v206, 15, v255
    s_waitcnt vmcnt(13)
    v_mfma_f32_16x16x32_bf16 v[156:159], a[252:255], v[236:239], v[156:159]
    buffer_load_dwordx2 v[200:201], v203, s[4:7], s20 offen offset:576
    v_mfma_f32_16x16x32_bf16 v[160:163], v[240:243], v[236:239], v[160:163]
    ds_write_b64 v206, v[212:213] offset:2080
    v_mfma_f32_16x16x32_bf16 v[160:163], a[244:247], v[232:235], v[160:163]
    v_lshlrev_b32 v248, 16, v218
    v_lshlrev_b32 v249, 16, v220
    v_mfma_f32_16x16x32_bf16 v[160:163], a[232:235], v[228:231], v[160:163]
    ds_write_b64 v206, v[210:211] offset:4160
    v_mfma_f32_16x16x32_bf16 v[164:167], a[236:239], v[228:231], v[164:167]
    ds_read_b128 v[228:231], v253 offset:32256
    v_lshlrev_b32 v250, 16, v222
    v_mfma_f32_16x16x32_bf16 v[164:167], a[248:251], v[232:235], v[164:167]
    buffer_load_dwordx2 v[202:203], v203, s[4:7], s21 offen offset:576
    v_mfma_f32_16x16x32_bf16 v[164:167], v[244:247], v[236:239], v[164:167]
    ds_write_b64 v206, v[204:205] offset:16640
    v_mfma_f32_16x16x32_bf16 v[168:171], a[228:231], v[232:235], v[168:171]
    v_lshlrev_b32 v251, 16, v224
    v_and_b32 v218, s22, v218
    v_mfma_f32_16x16x32_bf16 v[168:171], a[240:243], v[236:239], v[168:171]
    s_waitcnt lgkmcnt(1)
    v_and_b32 v220, s22, v220
    v_and_b32 v222, s22, v222
    v_and_b32 v224, s22, v224
    v_mfma_f32_16x16x32_bf16 v[168:171], a[252:255], v[228:231], v[168:171]
    ds_write_b64 v206, v[214:215] offset:24960
    v_mfma_f32_16x16x32_bf16 v[172:175], v[240:243], v[228:231], v[172:175]
    v_lshlrev_b32 v252, 16, v216
    v_and_b32 v216, s22, v216
    v_mfma_f32_16x16x32_bf16 v[172:175], a[244:247], v[236:239], v[172:175]
    ds_write_b64 v206, v[208:209] offset:6240
    v_mfma_f32_16x16x32_bf16 v[172:175], a[232:235], v[232:235], v[172:175]
    v_fmac_f32 v252, s25, v251
    v_fmac_f32 v216, s25, v224
    v_mfma_f32_16x16x32_bf16 v[176:179], a[236:239], v[232:235], v[176:179]
    ds_read_b128 v[232:235], v253 offset:31984
    v_fmac_f32 v252, s28, v249
    v_mfma_f32_16x16x32_bf16 v[176:179], a[248:251], v[236:239], v[176:179]
    v_fmac_f32 v216, s28, v220
    v_cvt_pk_bf16_f32 v216, v252, v216
    v_mfma_f32_16x16x32_bf16 v[176:179], v[244:247], v[228:231], v[176:179]
    s_mov_b32 s42, 331776
    v_lshlrev_b32 v252, 16, v226
    v_and_b32 v226, s22, v226
    v_mfma_f32_16x16x32_bf16 v[180:183], a[228:231], v[236:239], v[180:183]
    s_waitcnt lgkmcnt(0)
    v_fmac_f32 v252, s29, v248
    v_fmac_f32 v226, s29, v218
    v_mfma_f32_16x16x32_bf16 v[184:187], a[232:235], v[236:239], v[184:187]
    s_barrier
    v_mfma_f32_16x16x32_bf16 v[188:191], a[236:239], v[236:239], v[188:191]
    ds_read_b128 v[236:239], v253 offset:1040
    v_fmac_f32 v252, s23, v250
    v_mfma_f32_16x16x32_bf16 v[188:191], a[248:251], v[228:231], v[188:191]
    buffer_load_dwordx4 a[228:231], v254, s[8:11], s42 offen offset:0 sc1
    v_mfma_f32_16x16x32_bf16 v[184:187], a[244:247], v[228:231], v[184:187]
    v_fmac_f32 v226, s23, v222
    v_cvt_pk_bf16_f32 v226, v252, v226
    v_mfma_f32_16x16x32_bf16 v[180:183], a[240:243], v[228:231], v[180:183]
    ds_read_b128 v[228:231], v253 offset:768
    v_fma_f32 v252, v249, s24, v251
    v_mfma_f32_16x16x32_bf16 v[180:183], a[252:255], v[232:235], v[180:183]
    buffer_load_dwordx4 a[232:235], v254, s[8:11], s42 offen offset:1024 sc1
    v_mfma_f32_16x16x32_bf16 v[184:187], v[240:243], v[232:235], v[184:187]
    s_waitcnt vmcnt(14) lgkmcnt(1)
    v_fmac_f32 v251, -4.0, v249
    v_fma_f32 v249, v248, s24, v250
    v_mfma_f32_16x16x32_bf16 v[188:191], v[244:247], v[232:235], v[188:191]
    ds_read_b128 v[232:235], v253 offset:512
    v_fmac_f32 v250, -4.0, v248
sub8:
    v_mfma_f32_16x16x32_bf16 a[0:3], a[192:195], v[236:239], a[0:3]
    buffer_load_dwordx4 a[236:239], v254, s[8:11], s42 offen offset:2048 sc1
    v_mfma_f32_16x16x32_bf16 a[4:7], a[196:199], v[236:239], a[4:7]
    s_mov_b32 s42, 334848
    v_fma_f32 v248, v250, s26, v251
    v_fmac_f32 v251, s27, v250
    v_mfma_f32_16x16x32_bf16 a[8:11], a[200:203], v[236:239], a[8:11]
    ds_read_b128 v[236:239], v253 offset:256
    s_waitcnt vmcnt(12)
    s_waitcnt lgkmcnt(2)
    v_mfma_f32_16x16x32_bf16 a[8:11], a[212:215], v[228:231], a[8:11]
    v_fma_f32 v250, v249, 2.0, v252
    v_fmac_f32 v252, -2.0, v249
    v_mfma_f32_16x16x32_bf16 a[4:7], a[208:211], v[228:231], a[4:7]
    buffer_load_dwordx4 a[240:243], v254, s[8:11], s42 offen offset:0 sc1
    v_mfma_f32_16x16x32_bf16 a[0:3], a[204:207], v[228:231], a[0:3]
    s_waitcnt vmcnt(10) lgkmcnt(1)
    v_fma_f32 v249, v220, s24, v224
    v_fmac_f32 v224, -4.0, v220
    v_mfma_f32_16x16x32_bf16 a[0:3], a[216:219], v[232:235], a[0:3]
    v_fma_f32 v220, v218, s24, v222
    v_fmac_f32 v222, -4.0, v218
    v_mfma_f32_16x16x32_bf16 a[4:7], a[220:223], v[232:235], a[4:7]
    v_fma_f32 v218, v222, s26, v224
    v_fmac_f32 v224, s27, v222
    v_mfma_f32_16x16x32_bf16 a[8:11], a[224:227], v[232:235], a[8:11]
    buffer_load_dwordx4 a[244:247], v254, s[8:11], s42 offen offset:1024 sc1
    v_mfma_f32_16x16x32_bf16 a[12:15], a[192:195], v[228:231], a[12:15]
    v_fma_f32 v222, v220, 2.0, v249
    v_fmac_f32 v249, -2.0, v220
    v_mfma_f32_16x16x32_bf16 a[12:15], a[204:207], v[232:235], a[12:15]
    s_waitcnt lgkmcnt(0)
    v_cvt_pk_bf16_f32 v218, v248, v218
    v_cvt_pk_bf16_f32 v224, v251, v224
    v_mfma_f32_16x16x32_bf16 a[12:15], a[216:219], v[236:239], a[12:15]
    v_cvt_pk_bf16_f32 v222, v250, v222
    v_cvt_pk_bf16_f32 v220, v252, v249
    v_mfma_f32_16x16x32_bf16 a[16:19], a[220:223], v[236:239], a[16:19]
    buffer_load_dwordx4 a[248:251], v254, s[8:11], s42 offen offset:2048 sc1
    v_mfma_f32_16x16x32_bf16 a[16:19], a[208:211], v[232:235], a[16:19]
    s_mov_b32 s42, 337920
    v_lshlrev_b32 v248, 16, v219
    v_lshlrev_b32 v249, 16, v221
    v_mfma_f32_16x16x32_bf16 a[16:19], a[196:199], v[228:231], a[16:19]
    v_lshlrev_b32 v250, 16, v223
    v_lshlrev_b32 v251, 16, v225
    v_mfma_f32_16x16x32_bf16 a[20:23], a[200:203], v[228:231], a[20:23]
    ds_read_b128 v[228:231], v253 offset:0
    v_and_b32 v219, s22, v219
    v_mfma_f32_16x16x32_bf16 a[20:23], a[212:215], v[232:235], a[20:23]
    buffer_load_dwordx4 a[252:255], v254, s[8:11], s42 offen offset:0 sc1
    v_mfma_f32_16x16x32_bf16 a[20:23], a[224:227], v[236:239], a[20:23]
    v_and_b32 v221, s22, v221
    v_and_b32 v223, s22, v223
    v_mfma_f32_16x16x32_bf16 a[24:27], a[192:195], v[232:235], a[24:27]
    v_and_b32 v225, s22, v225
    v_lshlrev_b32 v252, 16, v217
    v_mfma_f32_16x16x32_bf16 a[24:27], a[204:207], v[236:239], a[24:27]
    s_waitcnt lgkmcnt(0)
    v_and_b32 v217, s22, v217
    v_fmac_f32 v252, s25, v251
    v_mfma_f32_16x16x32_bf16 a[24:27], a[216:219], v[228:231], a[24:27]
    v_fmac_f32 v217, s25, v225
    v_fmac_f32 v252, s28, v249
    v_mfma_f32_16x16x32_bf16 a[28:31], a[220:223], v[228:231], a[28:31]
    buffer_load_dwordx4 v[240:243], v254, s[8:11], s42 offen offset:1024 sc1
    v_mfma_f32_16x16x32_bf16 a[28:31], a[208:211], v[236:239], a[28:31]
    v_fmac_f32 v217, s28, v221
    v_cvt_pk_bf16_f32 v217, v252, v217
    v_mfma_f32_16x16x32_bf16 a[28:31], a[196:199], v[232:235], a[28:31]
    v_lshlrev_b32 v252, 16, v227
    v_and_b32 v227, s22, v227
    v_fmac_f32 v252, s29, v248
    v_mfma_f32_16x16x32_bf16 a[32:35], a[200:203], v[232:235], a[32:35]
    ds_read_b128 v[232:235], v253 offset:1824
    v_fmac_f32 v227, s29, v219
    v_mfma_f32_16x16x32_bf16 a[32:35], a[212:215], v[236:239], a[32:35]
    buffer_load_dwordx4 v[244:247], v254, s[8:11], s42 offen offset:2048 sc1
    v_mfma_f32_16x16x32_bf16 a[32:35], a[224:227], v[228:231], a[32:35]
    v_fmac_f32 v252, s23, v250
    v_fmac_f32 v227, s23, v223
    v_mfma_f32_16x16x32_bf16 a[36:39], a[192:195], v[236:239], a[36:39]
    v_and_b32 v215, 0x7fff, v255
    v_cvt_pk_bf16_f32 v227, v252, v227
    v_mfma_f32_16x16x32_bf16 a[36:39], a[204:207], v[228:231], a[36:39]
    s_waitcnt lgkmcnt(0)
    v_fma_f32 v252, v249, s24, v251
    v_fmac_f32 v251, -4.0, v249
    v_mfma_f32_16x16x32_bf16 a[36:39], a[216:219], v[232:235], a[36:39]
    buffer_load_dwordx2 v[204:205], v215, s[4:7], s16 offen offset:960
    v_mfma_f32_16x16x32_bf16 a[40:43], a[220:223], v[232:235], a[40:43]
    v_fma_f32 v249, v248, s24, v250
    v_fmac_f32 v250, -4.0, v248
    v_mfma_f32_16x16x32_bf16 a[40:43], a[208:211], v[228:231], a[40:43]
    v_fma_f32 v248, v250, s26, v251
    v_fmac_f32 v251, s27, v250
    v_mfma_f32_16x16x32_bf16 a[40:43], a[196:199], v[236:239], a[40:43]
    v_fma_f32 v250, v249, 2.0, v252
    v_fmac_f32 v252, -2.0, v249
    v_mfma_f32_16x16x32_bf16 a[44:47], a[200:203], v[236:239], a[44:47]
    ds_read_b128 v[236:239], v253 offset:1568
    v_fma_f32 v249, v221, s24, v225
    v_mfma_f32_16x16x32_bf16 a[44:47], a[212:215], v[228:231], a[44:47]
    buffer_load_dwordx2 v[206:207], v215, s[4:7], s17 offen offset:960
    v_mfma_f32_16x16x32_bf16 a[44:47], a[224:227], v[232:235], a[44:47]
    v_fmac_f32 v225, -4.0, v221
    v_fma_f32 v221, v219, s24, v223
    v_mfma_f32_16x16x32_bf16 a[48:51], a[192:195], v[228:231], a[48:51]
    v_fmac_f32 v223, -4.0, v219
    v_fma_f32 v219, v223, s26, v225
    v_mfma_f32_16x16x32_bf16 a[48:51], a[204:207], v[232:235], a[48:51]
    s_waitcnt lgkmcnt(0)
    v_fmac_f32 v225, s27, v223
    v_fma_f32 v223, v221, 2.0, v249
    v_mfma_f32_16x16x32_bf16 a[48:51], a[216:219], v[236:239], a[48:51]
    buffer_load_dwordx2 v[208:209], v215, s[4:7], s18 offen offset:960
    v_mfma_f32_16x16x32_bf16 a[52:55], a[220:223], v[236:239], a[52:55]
    v_fmac_f32 v249, -2.0, v221
    v_cvt_pk_bf16_f32 v219, v248, v219
    v_mfma_f32_16x16x32_bf16 a[52:55], a[208:211], v[232:235], a[52:55]
    v_cvt_pk_bf16_f32 v225, v251, v225
    v_cvt_pk_bf16_f32 v223, v250, v223
    v_mfma_f32_16x16x32_bf16 a[52:55], a[196:199], v[228:231], a[52:55]
    v_cvt_pk_bf16_f32 v221, v252, v249
    v_lshrrev_b32 v252, 15, v255
    v_mfma_f32_16x16x32_bf16 a[56:59], a[200:203], v[228:231], a[56:59]
    ds_read_b128 v[228:231], v253 offset:1312
    v_mfma_f32_16x16x32_bf16 a[56:59], a[212:215], v[232:235], a[56:59]
    buffer_load_dwordx2 v[210:211], v215, s[4:7], s19 offen offset:960
    v_mfma_f32_16x16x32_bf16 a[56:59], a[224:227], v[236:239], a[56:59]
    ds_write_b64 v252, v[218:219] offset:9088
    v_mfma_f32_16x16x32_bf16 a[60:63], a[192:195], v[232:235], a[60:63]
    v_lshrrev_b32 v218, 15, v255
    v_mfma_f32_16x16x32_bf16 a[60:63], a[204:207], v[236:239], a[60:63]
    s_waitcnt lgkmcnt(1)
    s_waitcnt vmcnt(13)
    v_lshlrev_b32 v248, 16, v194
    v_mfma_f32_16x16x32_bf16 a[60:63], a[216:219], v[228:231], a[60:63]
    buffer_load_dwordx2 v[212:213], v215, s[4:7], s20 offen offset:960
    v_mfma_f32_16x16x32_bf16 a[64:67], a[220:223], v[228:231], a[64:67]
    ds_write_b64 v218, v[224:225] offset:11168
    v_mfma_f32_16x16x32_bf16 a[64:67], a[208:211], v[236:239], a[64:67]
    v_lshlrev_b32 v249, 16, v196
    v_lshlrev_b32 v250, 16, v198
    v_mfma_f32_16x16x32_bf16 a[64:67], a[196:199], v[232:235], a[64:67]
    ds_write_b64 v218, v[222:223] offset:13248
    v_mfma_f32_16x16x32_bf16 a[68:71], a[200:203], v[232:235], a[68:71]
    ds_read_b128 v[232:235], v253 offset:1056
    v_lshlrev_b32 v251, 16, v200
    v_mfma_f32_16x16x32_bf16 a[68:71], a[212:215], v[236:239], a[68:71]
pad3:
    s_cbranch_vccnz pad7
    buffer_load_dwordx2 v[214:215], v215, s[4:7], s21 offen offset:960
    v_mfma_f32_16x16x32_bf16 a[68:71], a[224:227], v[228:231], a[68:71]
    ds_write_b64 v218, v[216:217] offset:19488
    v_mfma_f32_16x16x32_bf16 a[72:75], a[192:195], v[236:239], a[72:75]
    v_and_b32 v194, s22, v194
    v_and_b32 v196, s22, v196
    v_mfma_f32_16x16x32_bf16 a[72:75], a[204:207], v[228:231], a[72:75]
    s_waitcnt lgkmcnt(1)
    v_and_b32 v198, s22, v198
    v_and_b32 v200, s22, v200
    v_mfma_f32_16x16x32_bf16 a[72:75], a[216:219], v[232:235], a[72:75]
    ds_write_b64 v218, v[226:227] offset:27808
    v_mfma_f32_16x16x32_bf16 a[76:79], a[220:223], v[232:235], a[76:79]
    v_lshlrev_b32 v252, 16, v192
    v_and_b32 v192, s22, v192
    v_mfma_f32_16x16x32_bf16 a[76:79], a[208:211], v[228:231], a[76:79]
    ds_write_b64 v218, v[220:221] offset:31968
    v_mfma_f32_16x16x32_bf16 a[76:79], a[196:199], v[236:239], a[76:79]
    v_fmac_f32 v252, s25, v251
    v_fmac_f32 v192, s25, v200
    v_mfma_f32_16x16x32_bf16 a[80:83], a[200:203], v[236:239], a[80:83]
    ds_read_b128 v[236:239], v253 offset:784
    v_fmac_f32 v252, s28, v249
    v_mfma_f32_16x16x32_bf16 a[80:83], a[212:215], v[228:231], a[80:83]
    v_fmac_f32 v192, s28, v196
    v_cvt_pk_bf16_f32 v192, v252, v192
    v_mfma_f32_16x16x32_bf16 a[80:83], a[224:227], v[232:235], a[80:83]
    s_mov_b32 s42, 368640
    v_lshlrev_b32 v252, 16, v202
    v_and_b32 v202, s22, v202
    v_mfma_f32_16x16x32_bf16 a[84:87], a[192:195], v[228:231], a[84:87]
    v_fmac_f32 v252, s29, v248
    v_fmac_f32 v202, s29, v194
    v_fmac_f32 v252, s23, v250
    v_mfma_f32_16x16x32_bf16 a[88:91], a[196:199], v[228:231], a[88:91]
    v_fmac_f32 v202, s23, v198
    v_cvt_pk_bf16_f32 v202, v252, v202
    v_mfma_f32_16x16x32_bf16 a[92:95], a[200:203], v[228:231], a[92:95]
    ds_read_b128 v[228:231], v253 offset:3120
    v_fma_f32 v252, v249, s24, v251
    v_mfma_f32_16x16x32_bf16 a[92:95], a[212:215], v[232:235], a[92:95]
    buffer_load_dwordx4 a[192:195], v254, s[8:11], s42 offen offset:0 sc1
    v_mfma_f32_16x16x32_bf16 a[88:91], a[208:211], v[232:235], a[88:91]
    s_waitcnt lgkmcnt(1)
    v_fmac_f32 v251, -4.0, v249
    v_fma_f32 v249, v248, s24, v250
    v_mfma_f32_16x16x32_bf16 a[84:87], a[204:207], v[232:235], a[84:87]
    ds_read_b128 v[232:235], v253 offset:2848
    v_fmac_f32 v250, -4.0, v248
    v_mfma_f32_16x16x32_bf16 a[84:87], a[216:219], v[236:239], a[84:87]
    buffer_load_dwordx4 a[196:199], v254, s[8:11], s42 offen offset:1024 sc1
    v_mfma_f32_16x16x32_bf16 a[88:91], a[220:223], v[236:239], a[88:91]
    s_waitcnt vmcnt(14) lgkmcnt(1)
    v_fma_f32 v248, v250, s26, v251
    v_fmac_f32 v251, s27, v250
    v_mfma_f32_16x16x32_bf16 a[92:95], a[224:227], v[236:239], a[92:95]
    ds_read_b128 v[236:239], v253 offset:2592
    v_fma_f32 v250, v249, 2.0, v252
sub9:
    v_mfma_f32_16x16x32_bf16 a[96:99], a[228:231], v[228:231], a[96:99]
    buffer_load_dwordx4 a[200:203], v254, s[8:11], s42 offen offset:2048 sc1
    v_mfma_f32_16x16x32_bf16 a[100:103], a[232:235], v[228:231], a[100:103]
    s_mov_b32 s42, 371712
    v_fmac_f32 v252, -2.0, v249
    v_fma_f32 v249, v196, s24, v200
    v_mfma_f32_16x16x32_bf16 a[104:107], a[236:239], v[228:231], a[104:107]
    ds_read_b128 v[228:231], v253 offset:2336
    s_waitcnt vmcnt(12)
    s_waitcnt lgkmcnt(2)
    v_mfma_f32_16x16x32_bf16 a[104:107], a[248:251], v[232:235], a[104:107]
    v_fmac_f32 v200, -4.0, v196
    v_fma_f32 v196, v194, s24, v198
    v_mfma_f32_16x16x32_bf16 a[100:103], a[244:247], v[232:235], a[100:103]
    buffer_load_dwordx4 a[204:207], v254, s[8:11], s42 offen offset:0 sc1
    v_mfma_f32_16x16x32_bf16 a[96:99], a[240:243], v[232:235], a[96:99]
    s_waitcnt vmcnt(10) lgkmcnt(1)
    v_fmac_f32 v198, -4.0, v194
    v_fma_f32 v194, v198, s26, v200
    v_mfma_f32_16x16x32_bf16 a[96:99], a[252:255], v[236:239], a[96:99]
    v_fmac_f32 v200, s27, v198
    v_fma_f32 v198, v196, 2.0, v249
    v_mfma_f32_16x16x32_bf16 a[100:103], v[240:243], v[236:239], a[100:103]
    v_fmac_f32 v249, -2.0, v196
    v_cvt_pk_bf16_f32 v194, v248, v194
    v_mfma_f32_16x16x32_bf16 a[104:107], v[244:247], v[236:239], a[104:107]
    buffer_load_dwordx4 a[208:211], v254, s[8:11], s42 offen offset:1024 sc1
    v_mfma_f32_16x16x32_bf16 a[108:111], a[228:231], v[232:235], a[108:111]
    v_cvt_pk_bf16_f32 v200, v251, v200
    v_cvt_pk_bf16_f32 v198, v250, v198
    v_mfma_f32_16x16x32_bf16 a[108:111], a[240:243], v[236:239], a[108:111]
    s_waitcnt lgkmcnt(0)
    v_cvt_pk_bf16_f32 v196, v252, v249
    v_lshlrev_b32 v248, 16, v195
    v_mfma_f32_16x16x32_bf16 a[108:111], a[252:255], v[228:231], a[108:111]
    v_lshlrev_b32 v249, 16, v197
    v_lshlrev_b32 v250, 16, v199
    v_mfma_f32_16x16x32_bf16 a[112:115], v[240:243], v[228:231], a[112:115]
    buffer_load_dwordx4 a[212:215], v254, s[8:11], s42 offen offset:2048 sc1
    v_mfma_f32_16x16x32_bf16 a[112:115], a[244:247], v[236:239], a[112:115]
    s_mov_b32 s42, 374784
    v_lshlrev_b32 v251, 16, v201
    v_and_b32 v195, s22, v195
    v_mfma_f32_16x16x32_bf16 a[112:115], a[232:235], v[232:235], a[112:115]
    v_and_b32 v197, s22, v197
    v_and_b32 v199, s22, v199
    v_mfma_f32_16x16x32_bf16 a[116:119], a[236:239], v[232:235], a[116:119]
    ds_read_b128 v[232:235], v253 offset:2080
    v_and_b32 v201, s22, v201
    v_mfma_f32_16x16x32_bf16 a[116:119], a[248:251], v[236:239], a[116:119]
    buffer_load_dwordx4 a[216:219], v254, s[8:11], s42 offen offset:0 sc1
    v_mfma_f32_16x16x32_bf16 a[116:119], v[244:247], v[228:231], a[116:119]
    v_lshlrev_b32 v252, 16, v193
    v_and_b32 v193, s22, v193
    v_mfma_f32_16x16x32_bf16 a[120:123], a[228:231], v[236:239], a[120:123]
    v_fmac_f32 v252, s25, v251
    v_fmac_f32 v193, s25, v201
    v_mfma_f32_16x16x32_bf16 a[120:123], a[240:243], v[228:231], a[120:123]
    s_waitcnt lgkmcnt(0)
    v_fmac_f32 v252, s28, v249
    v_fmac_f32 v193, s28, v197
    v_mfma_f32_16x16x32_bf16 a[120:123], a[252:255], v[232:235], a[120:123]
    v_cvt_pk_bf16_f32 v193, v252, v193
    v_lshlrev_b32 v252, 16, v203
    v_mfma_f32_16x16x32_bf16 a[124:127], v[240:243], v[232:235], a[124:127]
    buffer_load_dwordx4 a[220:223], v254, s[8:11], s42 offen offset:1024 sc1
    v_mfma_f32_16x16x32_bf16 a[124:127], a[244:247], v[228:231], a[124:127]
    v_and_b32 v203, s22, v203
    v_fmac_f32 v252, s29, v248
    v_mfma_f32_16x16x32_bf16 a[124:127], a[232:235], v[236:239], a[124:127]
    v_fmac_f32 v203, s29, v195
    v_fmac_f32 v252, s23, v250
    v_mfma_f32_16x16x32_bf16 a[128:131], a[236:239], v[236:239], a[128:131]
    ds_read_b128 v[236:239], v253 offset:3904
    v_fmac_f32 v203, s23, v199
    v_mfma_f32_16x16x32_bf16 a[128:131], a[248:251], v[228:231], a[128:131]
    buffer_load_dwordx4 a[224:227], v254, s[8:11], s42 offen offset:2048 sc1
    v_mfma_f32_16x16x32_bf16 a[128:131], v[244:247], v[232:235], a[128:131]
    v_cvt_pk_bf16_f32 v203, v252, v203
    v_fma_f32 v252, v249, s24, v251
    v_mfma_f32_16x16x32_bf16 a[132:135], a[228:231], v[228:231], a[132:135]
    v_and_b32 v227, 0x7fff, v255
    v_fmac_f32 v251, -4.0, v249
    v_mfma_f32_16x16x32_bf16 a[132:135], a[240:243], v[232:235], a[132:135]
    s_waitcnt lgkmcnt(0)
    v_fma_f32 v249, v248, s24, v250
    v_fmac_f32 v250, -4.0, v248
    v_mfma_f32_16x16x32_bf16 a[132:135], a[252:255], v[236:239], a[132:135]
    buffer_load_dwordx2 v[216:217], v227, s[4:7], s16 offen offset:1344
    v_mfma_f32_16x16x32_bf16 a[136:139], v[240:243], v[236:239], a[136:139]
    v_fma_f32 v248, v250, s26, v251
    v_fmac_f32 v251, s27, v250
    v_mfma_f32_16x16x32_bf16 a[136:139], a[244:247], v[232:235], a[136:139]
    v_fma_f32 v250, v249, 2.0, v252
    v_fmac_f32 v252, -2.0, v249
    v_fma_f32 v249, v197, s24, v201
    v_mfma_f32_16x16x32_bf16 a[136:139], a[232:235], v[228:231], a[136:139]
    v_fmac_f32 v201, -4.0, v197
    v_fma_f32 v197, v195, s24, v199
    v_mfma_f32_16x16x32_bf16 a[140:143], a[236:239], v[228:231], a[140:143]
    ds_read_b128 v[228:231], v253 offset:3648
    v_fmac_f32 v199, -4.0, v195
    v_mfma_f32_16x16x32_bf16 a[140:143], a[248:251], v[232:235], a[140:143]
    buffer_load_dwordx2 v[218:219], v227, s[4:7], s17 offen offset:1344
    v_mfma_f32_16x16x32_bf16 a[140:143], v[244:247], v[236:239], a[140:143]
    v_fma_f32 v195, v199, s26, v201
    v_fmac_f32 v201, s27, v199
    v_mfma_f32_16x16x32_bf16 a[144:147], a[228:231], v[232:235], a[144:147]
    v_fma_f32 v199, v197, 2.0, v249
    v_fmac_f32 v249, -2.0, v197
    v_mfma_f32_16x16x32_bf16 a[144:147], a[240:243], v[236:239], a[144:147]
    s_waitcnt lgkmcnt(0)
    v_cvt_pk_bf16_f32 v195, v248, v195
    v_cvt_pk_bf16_f32 v201, v251, v201
    v_mfma_f32_16x16x32_bf16 a[144:147], a[252:255], v[228:231], a[144:147]
    buffer_load_dwordx2 v[220:221], v227, s[4:7], s18 offen offset:1344
    v_mfma_f32_16x16x32_bf16 a[148:151], v[240:243], v[228:231], a[148:151]
    v_cvt_pk_bf16_f32 v199, v250, v199
    v_cvt_pk_bf16_f32 v197, v252, v249
    v_mfma_f32_16x16x32_bf16 a[148:151], a[244:247], v[236:239], a[148:151]
    v_lshrrev_b32 v252, 15, v255
    v_mfma_f32_16x16x32_bf16 a[148:151], a[232:235], v[232:235], a[148:151]
    ds_write_b64 v252, v[194:195] offset:8832
    v_mfma_f32_16x16x32_bf16 a[152:155], a[236:239], v[232:235], a[152:155]
    ds_read_b128 v[232:235], v253 offset:3392
    v_lshrrev_b32 v194, 15, v255
    v_mfma_f32_16x16x32_bf16 a[152:155], a[248:251], v[236:239], a[152:155]
    buffer_load_dwordx2 v[222:223], v227, s[4:7], s19 offen offset:1344
    v_mfma_f32_16x16x32_bf16 a[152:155], v[244:247], v[228:231], a[152:155]
    ds_write_b64 v194, v[200:201] offset:10912
    v_mfma_f32_16x16x32_bf16 a[156:159], a[228:231], v[236:239], a[156:159]
    v_mfma_f32_16x16x32_bf16 a[156:159], a[240:243], v[228:231], a[156:159]
    s_waitcnt lgkmcnt(1)
    s_waitcnt vmcnt(13)
    v_lshlrev_b32 v248, 16, v206
    v_mfma_f32_16x16x32_bf16 a[156:159], a[252:255], v[232:235], a[156:159]
    buffer_load_dwordx2 v[224:225], v227, s[4:7], s20 offen offset:1344
    v_mfma_f32_16x16x32_bf16 a[160:163], v[240:243], v[232:235], a[160:163]
    ds_write_b64 v194, v[198:199] offset:12992
    v_mfma_f32_16x16x32_bf16 a[160:163], a[244:247], v[228:231], a[160:163]
    v_lshlrev_b32 v249, 16, v208
    v_lshlrev_b32 v250, 16, v210
    v_mfma_f32_16x16x32_bf16 a[160:163], a[232:235], v[236:239], a[160:163]
    ds_write_b64 v194, v[192:193] offset:19232
    v_mfma_f32_16x16x32_bf16 a[164:167], a[236:239], v[236:239], a[164:167]
    ds_read_b128 v[236:239], v253 offset:3136
    v_lshlrev_b32 v251, 16, v212
    v_mfma_f32_16x16x32_bf16 a[164:167], a[248:251], v[228:231], a[164:167]
    buffer_load_dwordx2 v[226:227], v227, s[4:7], s21 offen offset:1344
    v_mfma_f32_16x16x32_bf16 a[164:167], v[244:247], v[232:235], a[164:167]
    ds_write_b64 v194, v[202:203] offset:27552
    v_mfma_f32_16x16x32_bf16 a[168:171], a[228:231], v[228:231], a[168:171]
    v_and_b32 v206, s22, v206
    v_and_b32 v208, s22, v208
    v_mfma_f32_16x16x32_bf16 a[168:171], a[240:243], v[232:235], a[168:171]
    s_waitcnt lgkmcnt(1)
    v_and_b32 v210, s22, v210
    v_and_b32 v212, s22, v212
    v_mfma_f32_16x16x32_bf16 a[168:171], a[252:255], v[236:239], a[168:171]
    ds_write_b64 v194, v[196:197] offset:31712
    v_mfma_f32_16x16x32_bf16 a[172:175], v[240:243], v[236:239], a[172:175]
    ds_read_b128 v[192:195], v253 offset:40096
    s_mov_b32 s45, 452138121
    v_mfma_f32_16x16x32_bf16 a[172:175], a[244:247], v[232:235], a[172:175]
    v_bfe_u32 v196, v254, 5, 3
    v_mul_u32_u24 v197, 5, v196
    v_mfma_f32_16x16x32_bf16 a[172:175], a[232:235], v[228:231], a[172:175]
    v_bfe_u32 v197, s45, v197, 5
    v_mul_u32_u24 v197, 65, v197
    v_mfma_f32_16x16x32_bf16 a[176:179], a[236:239], v[228:231], a[176:179]
    ds_read_b128 v[228:231], v253 offset:2864
    v_sub_u32 v197, v197, v196
    v_mfma_f32_16x16x32_bf16 a[176:179], a[248:251], v[232:235], a[176:179]
    v_lshl_add_u32 v196, v197, 5, v253
    s_waitcnt lgkmcnt(1)
    v_mfma_f32_16x16x32_bf16 a[176:179], v[244:247], v[236:239], a[176:179]
    s_mov_b32 s42, 405504
    v_lshlrev_b32 v252, 16, v204
    v_and_b32 v204, s22, v204
    v_mfma_f32_16x16x32_bf16 a[180:183], a[228:231], v[232:235], a[180:183]
    s_mov_b64 exec, s[46:47]
    ds_write_b128 v196, v[192:195] offset:1024
    s_mov_b64 exec, -1
    v_mfma_f32_16x16x32_bf16 a[184:187], a[232:235], v[232:235], a[184:187]
    v_fmac_f32 v252, s25, v251
    v_fmac_f32 v204, s25, v212
    v_mfma_f32_16x16x32_bf16 a[188:191], a[236:239], v[232:235], a[188:191]
    ds_read_b128 v[232:235], v253 offset:5200
    v_fmac_f32 v252, s28, v249
    v_mfma_f32_16x16x32_bf16 a[188:191], a[248:251], v[236:239], a[188:191]
    buffer_load_dwordx4 a[228:231], v254, s[8:11], s42 offen offset:0 sc1
    v_mfma_f32_16x16x32_bf16 a[184:187], a[244:247], v[236:239], a[184:187]
    s_waitcnt lgkmcnt(2)
    v_fmac_f32 v204, s28, v208
    v_cvt_pk_bf16_f32 v204, v252, v204
    v_mfma_f32_16x16x32_bf16 a[180:183], a[240:243], v[236:239], a[180:183]
    ds_read_b128 v[236:239], v253 offset:4928
    v_lshlrev_b32 v252, 16, v214
    v_mfma_f32_16x16x32_bf16 a[180:183], a[252:255], v[228:231], a[180:183]
    buffer_load_dwordx4 a[232:235], v254, s[8:11], s42 offen offset:1024 sc1
    v_mfma_f32_16x16x32_bf16 a[184:187], v[240:243], v[228:231], a[184:187]
    s_waitcnt vmcnt(14) lgkmcnt(1)
    v_and_b32 v214, s22, v214
    v_fmac_f32 v252, s29, v248
    v_mfma_f32_16x16x32_bf16 a[188:191], v[244:247], v[228:231], a[188:191]
    ds_read_b128 v[228:231], v253 offset:4672
    v_fmac_f32 v214, s29, v206
    v_fmac_f32 v252, s23, v250
sub10:
    v_mfma_f32_16x16x32_bf16 v[0:3], a[192:195], v[232:235], v[0:3]
    buffer_load_dwordx4 a[236:239], v254, s[8:11], s42 offen offset:2048 sc1
    v_mfma_f32_16x16x32_bf16 v[4:7], a[196:199], v[232:235], v[4:7]
    s_mov_b32 s42, 408576
    v_fmac_f32 v214, s23, v210
    v_cvt_pk_bf16_f32 v214, v252, v214
    v_mfma_f32_16x16x32_bf16 v[8:11], a[200:203], v[232:235], v[8:11]
    ds_read_b128 v[232:235], v253 offset:4416
    s_waitcnt vmcnt(12)
    s_waitcnt lgkmcnt(2)
    v_mfma_f32_16x16x32_bf16 v[8:11], a[212:215], v[236:239], v[8:11]
    v_fma_f32 v252, v249, s24, v251
    v_fmac_f32 v251, -4.0, v249
    v_mfma_f32_16x16x32_bf16 v[4:7], a[208:211], v[236:239], v[4:7]
    buffer_load_dwordx4 a[240:243], v254, s[8:11], s42 offen offset:0 sc1
    v_mfma_f32_16x16x32_bf16 v[0:3], a[204:207], v[236:239], v[0:3]
    s_waitcnt vmcnt(10) lgkmcnt(1)
    v_fma_f32 v249, v248, s24, v250
    v_fmac_f32 v250, -4.0, v248
    v_mfma_f32_16x16x32_bf16 v[0:3], a[216:219], v[228:231], v[0:3]
    v_fma_f32 v248, v250, s26, v251
    v_fmac_f32 v251, s27, v250
    v_mfma_f32_16x16x32_bf16 v[4:7], a[220:223], v[228:231], v[4:7]
    v_fma_f32 v250, v249, 2.0, v252
    v_fmac_f32 v252, -2.0, v249
    v_mfma_f32_16x16x32_bf16 v[8:11], a[224:227], v[228:231], v[8:11]
    buffer_load_dwordx4 a[244:247], v254, s[8:11], s42 offen offset:1024 sc1
    v_mfma_f32_16x16x32_bf16 v[12:15], a[192:195], v[236:239], v[12:15]
    v_fma_f32 v249, v208, s24, v212
    v_fmac_f32 v212, -4.0, v208
    v_mfma_f32_16x16x32_bf16 v[12:15], a[204:207], v[228:231], v[12:15]
    s_waitcnt lgkmcnt(0)
    v_fma_f32 v208, v206, s24, v210
    v_fmac_f32 v210, -4.0, v206
    v_mfma_f32_16x16x32_bf16 v[12:15], a[216:219], v[232:235], v[12:15]
    v_fma_f32 v206, v210, s26, v212
    v_fmac_f32 v212, s27, v210
    v_mfma_f32_16x16x32_bf16 v[16:19], a[220:223], v[232:235], v[16:19]
    buffer_load_dwordx4 a[248:251], v254, s[8:11], s42 offen offset:2048 sc1
    v_mfma_f32_16x16x32_bf16 v[16:19], a[208:211], v[228:231], v[16:19]
    s_mov_b32 s42, 411648
    v_fma_f32 v210, v208, 2.0, v249
    v_fmac_f32 v249, -2.0, v208
    v_mfma_f32_16x16x32_bf16 v[16:19], a[196:199], v[236:239], v[16:19]
    v_cvt_pk_bf16_f32 v206, v248, v206
    v_cvt_pk_bf16_f32 v212, v251, v212
    v_mfma_f32_16x16x32_bf16 v[20:23], a[200:203], v[236:239], v[20:23]
    ds_read_b128 v[236:239], v253 offset:4160
    v_cvt_pk_bf16_f32 v210, v250, v210
    v_mfma_f32_16x16x32_bf16 v[20:23], a[212:215], v[228:231], v[20:23]
    buffer_load_dwordx4 a[252:255], v254, s[8:11], s42 offen offset:0 sc1
    v_mfma_f32_16x16x32_bf16 v[20:23], a[224:227], v[232:235], v[20:23]
    v_cvt_pk_bf16_f32 v208, v252, v249
    v_lshlrev_b32 v248, 16, v207
    v_mfma_f32_16x16x32_bf16 v[24:27], a[192:195], v[228:231], v[24:27]
    v_lshlrev_b32 v249, 16, v209
    v_lshlrev_b32 v250, 16, v211
    v_mfma_f32_16x16x32_bf16 v[24:27], a[204:207], v[232:235], v[24:27]
    s_waitcnt lgkmcnt(0)
    v_lshlrev_b32 v251, 16, v213
    v_and_b32 v207, s22, v207
    v_mfma_f32_16x16x32_bf16 v[24:27], a[216:219], v[236:239], v[24:27]
    v_and_b32 v209, s22, v209
    v_and_b32 v211, s22, v211
    v_mfma_f32_16x16x32_bf16 v[28:31], a[220:223], v[236:239], v[28:31]
    buffer_load_dwordx4 v[240:243], v254, s[8:11], s42 offen offset:1024 sc1
    v_mfma_f32_16x16x32_bf16 v[28:31], a[208:211], v[232:235], v[28:31]
    v_and_b32 v213, s22, v213
    v_lshlrev_b32 v252, 16, v205
    v_mfma_f32_16x16x32_bf16 v[28:31], a[196:199], v[228:231], v[28:31]
    v_and_b32 v205, s22, v205
    v_fmac_f32 v252, s25, v251
    v_mfma_f32_16x16x32_bf16 v[32:35], a[200:203], v[228:231], v[32:35]
    ds_read_b128 v[228:231], v253 offset:5984
    v_fmac_f32 v205, s25, v213
    v_mfma_f32_16x16x32_bf16 v[32:35], a[212:215], v[232:235], v[32:35]
    buffer_load_dwordx4 v[244:247], v254, s[8:11], s42 offen offset:2048 sc1
    v_mfma_f32_16x16x32_bf16 v[32:35], a[224:227], v[236:239], v[32:35]
    v_fmac_f32 v252, s28, v249
    v_fmac_f32 v205, s28, v209
    v_mfma_f32_16x16x32_bf16 v[36:39], a[192:195], v[232:235], v[36:39]
    v_and_b32 v203, 0x7fff, v255
    v_cvt_pk_bf16_f32 v205, v252, v205
    v_mfma_f32_16x16x32_bf16 v[36:39], a[204:207], v[236:239], v[36:39]
    s_waitcnt lgkmcnt(0)
    v_lshlrev_b32 v252, 16, v215
    v_and_b32 v215, s22, v215
    v_mfma_f32_16x16x32_bf16 v[36:39], a[216:219], v[228:231], v[36:39]
    buffer_load_dwordx2 v[192:193], v203, s[4:7], s16 offen offset:256
    v_mfma_f32_16x16x32_bf16 v[40:43], a[220:223], v[228:231], v[40:43]
    v_fmac_f32 v252, s29, v248
    v_fmac_f32 v215, s29, v207
    v_mfma_f32_16x16x32_bf16 v[40:43], a[208:211], v[236:239], v[40:43]
    v_fmac_f32 v252, s23, v250
    v_fmac_f32 v215, s23, v211
    v_mfma_f32_16x16x32_bf16 v[40:43], a[196:199], v[232:235], v[40:43]
    v_cvt_pk_bf16_f32 v215, v252, v215
    v_fma_f32 v252, v249, s24, v251
    v_mfma_f32_16x16x32_bf16 v[44:47], a[200:203], v[232:235], v[44:47]
    ds_read_b128 v[232:235], v253 offset:5728
    v_fmac_f32 v251, -4.0, v249
    v_mfma_f32_16x16x32_bf16 v[44:47], a[212:215], v[236:239], v[44:47]
    buffer_load_dwordx2 v[194:195], v203, s[4:7], s17 offen offset:256
    v_mfma_f32_16x16x32_bf16 v[44:47], a[224:227], v[228:231], v[44:47]
    v_fma_f32 v249, v248, s24, v250
    v_fmac_f32 v250, -4.0, v248
    v_mfma_f32_16x16x32_bf16 v[48:51], a[192:195], v[236:239], v[48:51]
    v_fma_f32 v248, v250, s26, v251
    v_fmac_f32 v251, s27, v250
    v_mfma_f32_16x16x32_bf16 v[48:51], a[204:207], v[228:231], v[48:51]
    s_waitcnt lgkmcnt(0)
    v_fma_f32 v250, v249, 2.0, v252
    v_fmac_f32 v252, -2.0, v249
    v_mfma_f32_16x16x32_bf16 v[48:51], a[216:219], v[232:235], v[48:51]
    buffer_load_dwordx2 v[196:197], v203, s[4:7], s18 offen offset:256
    v_mfma_f32_16x16x32_bf16 v[52:55], a[220:223], v[232:235], v[52:55]
    v_fma_f32 v249, v209, s24, v213
    v_fmac_f32 v213, -4.0, v209
    v_fma_f32 v209, v207, s24, v211
    v_mfma_f32_16x16x32_bf16 v[52:55], a[208:211], v[228:231], v[52:55]
    v_fmac_f32 v211, -4.0, v207
    v_fma_f32 v207, v211, s26, v213
    v_mfma_f32_16x16x32_bf16 v[52:55], a[196:199], v[236:239], v[52:55]
    v_fmac_f32 v213, s27, v211
    v_fma_f32 v211, v209, 2.0, v249
    v_mfma_f32_16x16x32_bf16 v[56:59], a[200:203], v[236:239], v[56:59]
    ds_read_b128 v[236:239], v253 offset:5472
    v_fmac_f32 v249, -2.0, v209
    v_mfma_f32_16x16x32_bf16 v[56:59], a[212:215], v[228:231], v[56:59]
    buffer_load_dwordx2 v[198:199], v203, s[4:7], s19 offen offset:256
    v_mfma_f32_16x16x32_bf16 v[56:59], a[224:227], v[232:235], v[56:59]
    v_cvt_pk_bf16_f32 v207, v248, v207
    v_cvt_pk_bf16_f32 v213, v251, v213
    v_mfma_f32_16x16x32_bf16 v[60:63], a[192:195], v[228:231], v[60:63]
    v_cvt_pk_bf16_f32 v211, v250, v211
    v_cvt_pk_bf16_f32 v209, v252, v249
    v_mfma_f32_16x16x32_bf16 v[60:63], a[204:207], v[232:235], v[60:63]
    s_waitcnt lgkmcnt(0)
    v_lshrrev_b32 v252, 15, v255
    v_mfma_f32_16x16x32_bf16 v[60:63], a[216:219], v[236:239], v[60:63]
    buffer_load_dwordx2 v[200:201], v203, s[4:7], s20 offen offset:256
    v_mfma_f32_16x16x32_bf16 v[64:67], a[220:223], v[236:239], v[64:67]
    ds_write_b64 v252, v[206:207] offset:8576
    v_mfma_f32_16x16x32_bf16 v[64:67], a[208:211], v[232:235], v[64:67]
    s_waitcnt vmcnt(14)
    v_lshrrev_b32 v206, 15, v255
    v_lshlrev_b32 v248, 16, v218
    v_mfma_f32_16x16x32_bf16 v[64:67], a[196:199], v[228:231], v[64:67]
    ds_write_b64 v206, v[212:213] offset:10656
    v_mfma_f32_16x16x32_bf16 v[68:71], a[200:203], v[228:231], v[68:71]
    ds_read_b128 v[228:231], v253 offset:5216
    v_lshlrev_b32 v249, 16, v220
    v_mfma_f32_16x16x32_bf16 v[68:71], a[212:215], v[232:235], v[68:71]
    buffer_load_dwordx2 v[202:203], v203, s[4:7], s21 offen offset:256
    v_mfma_f32_16x16x32_bf16 v[68:71], a[224:227], v[236:239], v[68:71]
    ds_write_b64 v206, v[210:211] offset:12736
    v_mfma_f32_16x16x32_bf16 v[72:75], a[192:195], v[232:235], v[72:75]
    v_lshlrev_b32 v250, 16, v222
    v_lshlrev_b32 v251, 16, v224
    v_mfma_f32_16x16x32_bf16 v[72:75], a[204:207], v[236:239], v[72:75]
    s_waitcnt lgkmcnt(1)
    v_and_b32 v218, s22, v218
    v_and_b32 v220, s22, v220
    v_mfma_f32_16x16x32_bf16 v[72:75], a[216:219], v[228:231], v[72:75]
    ds_write_b64 v206, v[204:205] offset:18976
    v_mfma_f32_16x16x32_bf16 v[76:79], a[220:223], v[228:231], v[76:79]
    v_and_b32 v222, s22, v222
    v_and_b32 v224, s22, v224
    v_mfma_f32_16x16x32_bf16 v[76:79], a[208:211], v[236:239], v[76:79]
    ds_write_b64 v206, v[214:215] offset:27296
    v_mfma_f32_16x16x32_bf16 v[76:79], a[196:199], v[232:235], v[76:79]
    v_lshlrev_b32 v252, 16, v216
    v_and_b32 v216, s22, v216
    v_mfma_f32_16x16x32_bf16 v[80:83], a[200:203], v[232:235], v[80:83]
    ds_read_b128 v[232:235], v253 offset:4944
    v_fmac_f32 v252, s25, v251
    v_mfma_f32_16x16x32_bf16 v[80:83], a[212:215], v[236:239], v[80:83]
    ds_write_b64 v206, v[208:209] offset:31456
    v_mfma_f32_16x16x32_bf16 v[80:83], a[224:227], v[228:231], v[80:83]
    s_mov_b32 s42, 442368
    v_fmac_f32 v216, s25, v224
    v_fmac_f32 v252, s28, v249
    v_mfma_f32_16x16x32_bf16 v[84:87], a[192:195], v[236:239], v[84:87]
    v_fmac_f32 v216, s28, v220
    v_cvt_pk_bf16_f32 v216, v252, v216
    v_mfma_f32_16x16x32_bf16 v[88:91], a[196:199], v[236:239], v[88:91]
    v_lshlrev_b32 v252, 16, v226
    v_and_b32 v226, s22, v226
    v_mfma_f32_16x16x32_bf16 v[92:95], a[200:203], v[236:239], v[92:95]
    ds_read_b128 v[236:239], v253 offset:7280
    v_fmac_f32 v252, s29, v248
    v_mfma_f32_16x16x32_bf16 v[92:95], a[212:215], v[228:231], v[92:95]
    buffer_load_dwordx4 a[192:195], v254, s[8:11], s42 offen offset:0 sc1
    v_mfma_f32_16x16x32_bf16 v[88:91], a[208:211], v[228:231], v[88:91]
    s_waitcnt lgkmcnt(2)
    v_fmac_f32 v226, s29, v218
    v_fmac_f32 v252, s23, v250
    v_mfma_f32_16x16x32_bf16 v[84:87], a[204:207], v[228:231], v[84:87]
    ds_read_b128 v[228:231], v253 offset:7008
    v_fmac_f32 v226, s23, v222
    v_mfma_f32_16x16x32_bf16 v[84:87], a[216:219], v[232:235], v[84:87]
    buffer_load_dwordx4 a[196:199], v254, s[8:11], s42 offen offset:1024 sc1
    v_mfma_f32_16x16x32_bf16 v[88:91], a[220:223], v[232:235], v[88:91]
    s_waitcnt vmcnt(14) lgkmcnt(1)
    v_cvt_pk_bf16_f32 v226, v252, v226
    v_fma_f32 v252, v249, s24, v251
    v_mfma_f32_16x16x32_bf16 v[92:95], a[224:227], v[232:235], v[92:95]
    ds_read_b128 v[232:235], v253 offset:6752
    v_fmac_f32 v251, -4.0, v249
sub11:
    v_mfma_f32_16x16x32_bf16 v[96:99], a[228:231], v[236:239], v[96:99]
    buffer_load_dwordx4 a[200:203], v254, s[8:11], s42 offen offset:2048 sc1
    v_mfma_f32_16x16x32_bf16 v[100:103], a[232:235], v[236:239], v[100:103]
    s_mov_b32 s42, 445440
    v_fma_f32 v249, v248, s24, v250
    v_fmac_f32 v250, -4.0, v248
    v_mfma_f32_16x16x32_bf16 v[104:107], a[236:239], v[236:239], v[104:107]
    ds_read_b128 v[236:239], v253 offset:6496
    s_waitcnt vmcnt(12)
    s_waitcnt lgkmcnt(2)
    v_mfma_f32_16x16x32_bf16 v[104:107], a[248:251], v[228:231], v[104:107]
    v_fma_f32 v248, v250, s26, v251
    v_fmac_f32 v251, s27, v250
    v_mfma_f32_16x16x32_bf16 v[100:103], a[244:247], v[228:231], v[100:103]
    buffer_load_dwordx4 a[204:207], v254, s[8:11], s42 offen offset:0 sc1
    v_mfma_f32_16x16x32_bf16 v[96:99], a[240:243], v[228:231], v[96:99]
    s_waitcnt vmcnt(10) lgkmcnt(1)
    v_fma_f32 v250, v249, 2.0, v252
    v_fmac_f32 v252, -2.0, v249
    v_mfma_f32_16x16x32_bf16 v[96:99], a[252:255], v[232:235], v[96:99]
    v_fma_f32 v249, v220, s24, v224
    v_fmac_f32 v224, -4.0, v220
    v_mfma_f32_16x16x32_bf16 v[100:103], v[240:243], v[232:235], v[100:103]
    v_fma_f32 v220, v218, s24, v222
    v_fmac_f32 v222, -4.0, v218
    v_fma_f32 v218, v222, s26, v224
    v_mfma_f32_16x16x32_bf16 v[104:107], v[244:247], v[232:235], v[104:107]
    buffer_load_dwordx4 a[208:211], v254, s[8:11], s42 offen offset:1024 sc1
    v_mfma_f32_16x16x32_bf16 v[108:111], a[228:231], v[228:231], v[108:111]
    v_fmac_f32 v224, s27, v222
    v_fma_f32 v222, v220, 2.0, v249
    v_mfma_f32_16x16x32_bf16 v[108:111], a[240:243], v[232:235], v[108:111]
    s_waitcnt lgkmcnt(0)
    v_fmac_f32 v249, -2.0, v220
    v_cvt_pk_bf16_f32 v218, v248, v218
    v_mfma_f32_16x16x32_bf16 v[108:111], a[252:255], v[236:239], v[108:111]
    v_cvt_pk_bf16_f32 v224, v251, v224
    v_cvt_pk_bf16_f32 v222, v250, v222
    v_mfma_f32_16x16x32_bf16 v[112:115], v[240:243], v[236:239], v[112:115]
    buffer_load_dwordx4 a[212:215], v254, s[8:11], s42 offen offset:2048 sc1
    v_mfma_f32_16x16x32_bf16 v[112:115], a[244:247], v[232:235], v[112:115]
    s_mov_b32 s42, 448512
    v_cvt_pk_bf16_f32 v220, v252, v249
    v_lshlrev_b32 v248, 16, v219
    v_mfma_f32_16x16x32_bf16 v[112:115], a[232:235], v[228:231], v[112:115]
    v_lshlrev_b32 v249, 16, v221
    v_lshlrev_b32 v250, 16, v223
    v_mfma_f32_16x16x32_bf16 v[116:119], a[236:239], v[228:231], v[116:119]
    ds_read_b128 v[228:231], v253 offset:6240
    v_lshlrev_b32 v251, 16, v225
    v_mfma_f32_16x16x32_bf16 v[116:119], a[248:251], v[232:235], v[116:119]
    buffer_load_dwordx4 a[216:219], v254, s[8:11], s42 offen offset:0 sc1
    v_mfma_f32_16x16x32_bf16 v[116:119], v[244:247], v[236:239], v[116:119]
    v_and_b32 v219, s22, v219
    v_and_b32 v221, s22, v221
    v_mfma_f32_16x16x32_bf16 v[120:123], a[228:231], v[232:235], v[120:123]
    v_and_b32 v223, s22, v223
    v_and_b32 v225, s22, v225
    v_mfma_f32_16x16x32_bf16 v[120:123], a[240:243], v[236:239], v[120:123]
    s_waitcnt lgkmcnt(0)
    v_lshlrev_b32 v252, 16, v217
    v_and_b32 v217, s22, v217
    v_mfma_f32_16x16x32_bf16 v[120:123], a[252:255], v[228:231], v[120:123]
    v_fmac_f32 v252, s25, v251
    v_fmac_f32 v217, s25, v225
    v_mfma_f32_16x16x32_bf16 v[124:127], v[240:243], v[228:231], v[124:127]
    buffer_load_dwordx4 a[220:223], v254, s[8:11], s42 offen offset:1024 sc1
    v_mfma_f32_16x16x32_bf16 v[124:127], a[244:247], v[236:239], v[124:127]
    v_fmac_f32 v252, s28, v249
    v_fmac_f32 v217, s28, v221
    v_mfma_f32_16x16x32_bf16 v[124:127], a[232:235], v[232:235], v[124:127]
    v_cvt_pk_bf16_f32 v217, v252, v217
    v_lshlrev_b32 v252, 16, v227
    v_mfma_f32_16x16x32_bf16 v[128:131], a[236:239], v[232:235], v[128:131]
    ds_read_b128 v[232:235], v253 offset:8064
    v_and_b32 v227, s22, v227
    v_mfma_f32_16x16x32_bf16 v[128:131], a[248:251], v[236:239], v[128:131]
    buffer_load_dwordx4 a[224:227], v254, s[8:11], s42 offen offset:2048 sc1
    v_mfma_f32_16x16x32_bf16 v[128:131], v[244:247], v[228:231], v[128:131]
    v_fmac_f32 v252, s29, v248
    v_fmac_f32 v227, s29, v219
    v_mfma_f32_16x16x32_bf16 v[132:135], a[228:231], v[236:239], v[132:135]
    v_and_b32 v215, 0x7fff, v255
    v_fmac_f32 v252, s23, v250
    v_mfma_f32_16x16x32_bf16 v[132:135], a[240:243], v[228:231], v[132:135]
    s_waitcnt lgkmcnt(0)
    v_fmac_f32 v227, s23, v223
    v_cvt_pk_bf16_f32 v227, v252, v227
    v_mfma_f32_16x16x32_bf16 v[132:135], a[252:255], v[232:235], v[132:135]
    buffer_load_dwordx2 v[204:205], v215, s[4:7], s16 offen offset:640
    v_mfma_f32_16x16x32_bf16 v[136:139], v[240:243], v[232:235], v[136:139]
    v_fma_f32 v252, v249, s24, v251
    v_fmac_f32 v251, -4.0, v249
    v_mfma_f32_16x16x32_bf16 v[136:139], a[244:247], v[228:231], v[136:139]
    v_fma_f32 v249, v248, s24, v250
    v_fmac_f32 v250, -4.0, v248
    v_mfma_f32_16x16x32_bf16 v[136:139], a[232:235], v[236:239], v[136:139]
    v_fma_f32 v248, v250, s26, v251
    v_fmac_f32 v251, s27, v250
    v_mfma_f32_16x16x32_bf16 v[140:143], a[236:239], v[236:239], v[140:143]
    ds_read_b128 v[236:239], v253 offset:7808
    v_fma_f32 v250, v249, 2.0, v252
    v_mfma_f32_16x16x32_bf16 v[140:143], a[248:251], v[228:231], v[140:143]
    buffer_load_dwordx2 v[206:207], v215, s[4:7], s17 offen offset:640
    v_mfma_f32_16x16x32_bf16 v[140:143], v[244:247], v[232:235], v[140:143]
    v_fmac_f32 v252, -2.0, v249
    v_fma_f32 v249, v221, s24, v225
    v_mfma_f32_16x16x32_bf16 v[144:147], a[228:231], v[228:231], v[144:147]
    v_fmac_f32 v225, -4.0, v221
    v_fma_f32 v221, v219, s24, v223
    v_mfma_f32_16x16x32_bf16 v[144:147], a[240:243], v[232:235], v[144:147]
    s_waitcnt lgkmcnt(0)
    v_fmac_f32 v223, -4.0, v219
    v_fma_f32 v219, v223, s26, v225
    v_mfma_f32_16x16x32_bf16 v[144:147], a[252:255], v[236:239], v[144:147]
    buffer_load_dwordx2 v[208:209], v215, s[4:7], s18 offen offset:640
    v_mfma_f32_16x16x32_bf16 v[148:151], v[240:243], v[236:239], v[148:151]
    v_fmac_f32 v225, s27, v223
    v_fma_f32 v223, v221, 2.0, v249
    v_mfma_f32_16x16x32_bf16 v[148:151], a[244:247], v[232:235], v[148:151]
    v_fmac_f32 v249, -2.0, v221
    v_cvt_pk_bf16_f32 v219, v248, v219
    v_mfma_f32_16x16x32_bf16 v[148:151], a[232:235], v[228:231], v[148:151]
    v_cvt_pk_bf16_f32 v225, v251, v225
    v_cvt_pk_bf16_f32 v223, v250, v223
    v_mfma_f32_16x16x32_bf16 v[152:155], a[236:239], v[228:231], v[152:155]
    ds_read_b128 v[228:231], v253 offset:7552
    v_cvt_pk_bf16_f32 v221, v252, v249
    v_mfma_f32_16x16x32_bf16 v[152:155], a[248:251], v[232:235], v[152:155]
    buffer_load_dwordx2 v[210:211], v215, s[4:7], s19 offen offset:640
    v_mfma_f32_16x16x32_bf16 v[152:155], v[244:247], v[236:239], v[152:155]
    v_lshrrev_b32 v252, 15, v255
    v_mfma_f32_16x16x32_bf16 v[156:159], a[228:231], v[232:235], v[156:159]
    ds_write_b64 v252, v[218:219] offset:8320
    v_mfma_f32_16x16x32_bf16 v[156:159], a[240:243], v[236:239], v[156:159]
    s_waitcnt lgkmcnt(1)
    v_lshrrev_b32 v218, 15, v255
    s_waitcnt vmcnt(13)
    v_mfma_f32_16x16x32_bf16 v[156:159], a[252:255], v[228:231], v[156:159]
    buffer_load_dwordx2 v[212:213], v215, s[4:7], s20 offen offset:640
    v_lshlrev_b32 v248, 16, v194
    v_mfma_f32_16x16x32_bf16 v[160:163], v[240:243], v[228:231], v[160:163]
pad4:
    s_cbranch_vccnz pad8
    ds_write_b64 v218, v[224:225] offset:10400
    v_mfma_f32_16x16x32_bf16 v[160:163], a[244:247], v[236:239], v[160:163]
    v_lshlrev_b32 v249, 16, v196
    v_lshlrev_b32 v250, 16, v198
    v_mfma_f32_16x16x32_bf16 v[160:163], a[232:235], v[232:235], v[160:163]
    ds_write_b64 v218, v[222:223] offset:12480
    v_mfma_f32_16x16x32_bf16 v[164:167], a[236:239], v[232:235], v[164:167]
    ds_read_b128 v[232:235], v253 offset:7296
    v_lshlrev_b32 v251, 16, v200
    v_mfma_f32_16x16x32_bf16 v[164:167], a[248:251], v[236:239], v[164:167]
    buffer_load_dwordx2 v[214:215], v215, s[4:7], s21 offen offset:640
    v_mfma_f32_16x16x32_bf16 v[164:167], v[244:247], v[228:231], v[164:167]
    ds_write_b64 v218, v[216:217] offset:18720
    v_mfma_f32_16x16x32_bf16 v[168:171], a[228:231], v[236:239], v[168:171]
    v_and_b32 v194, s22, v194
    v_and_b32 v196, s22, v196
    v_mfma_f32_16x16x32_bf16 v[168:171], a[240:243], v[228:231], v[168:171]
    s_waitcnt lgkmcnt(1)
    v_and_b32 v198, s22, v198
    v_and_b32 v200, s22, v200
    v_mfma_f32_16x16x32_bf16 v[168:171], a[252:255], v[232:235], v[168:171]
    ds_write_b64 v218, v[226:227] offset:27040
    v_mfma_f32_16x16x32_bf16 v[172:175], v[240:243], v[232:235], v[172:175]
    v_lshlrev_b32 v252, 16, v192
    v_and_b32 v192, s22, v192
    v_mfma_f32_16x16x32_bf16 v[172:175], a[244:247], v[228:231], v[172:175]
    ds_write_b64 v218, v[220:221] offset:31200
    v_mfma_f32_16x16x32_bf16 v[172:175], a[232:235], v[236:239], v[172:175]
    v_fmac_f32 v252, s25, v251
    v_fmac_f32 v192, s25, v200
    v_mfma_f32_16x16x32_bf16 v[176:179], a[236:239], v[236:239], v[176:179]
    ds_read_b128 v[236:239], v253 offset:7024
    v_fmac_f32 v252, s28, v249
    v_mfma_f32_16x16x32_bf16 v[176:179], a[248:251], v[228:231], v[176:179]
    v_fmac_f32 v192, s28, v196
    v_cvt_pk_bf16_f32 v192, v252, v192
    v_mfma_f32_16x16x32_bf16 v[176:179], v[244:247], v[232:235], v[176:179]
    s_mov_b32 s42, 479232
    v_lshlrev_b32 v252, 16, v202
    v_and_b32 v202, s22, v202
    v_mfma_f32_16x16x32_bf16 v[180:183], a[228:231], v[228:231], v[180:183]
    s_waitcnt lgkmcnt(0)
    v_fmac_f32 v252, s29, v248
    v_fmac_f32 v202, s29, v194
    v_mfma_f32_16x16x32_bf16 v[184:187], a[232:235], v[228:231], v[184:187]
    s_barrier
    v_mfma_f32_16x16x32_bf16 v[188:191], a[236:239], v[228:231], v[188:191]
    ds_read_b128 v[228:231], v253 offset:9360
    v_fmac_f32 v252, s23, v250
    v_mfma_f32_16x16x32_bf16 v[188:191], a[248:251], v[232:235], v[188:191]
    buffer_load_dwordx4 a[228:231], v254, s[8:11], s42 offen offset:0 sc1
    v_mfma_f32_16x16x32_bf16 v[184:187], a[244:247], v[232:235], v[184:187]
    v_fmac_f32 v202, s23, v198
    v_cvt_pk_bf16_f32 v202, v252, v202
    v_mfma_f32_16x16x32_bf16 v[180:183], a[240:243], v[232:235], v[180:183]
    ds_read_b128 v[232:235], v253 offset:9088
    v_fma_f32 v252, v249, s24, v251
    v_mfma_f32_16x16x32_bf16 v[180:183], a[252:255], v[236:239], v[180:183]
    buffer_load_dwordx4 a[232:235], v254, s[8:11], s42 offen offset:1024 sc1
    v_mfma_f32_16x16x32_bf16 v[184:187], v[240:243], v[236:239], v[184:187]
    s_waitcnt vmcnt(14) lgkmcnt(1)
    v_fmac_f32 v251, -4.0, v249
    v_fma_f32 v249, v248, s24, v250
    v_mfma_f32_16x16x32_bf16 v[188:191], v[244:247], v[236:239], v[188:191]
    ds_read_b128 v[236:239], v253 offset:8832
    v_fmac_f32 v250, -4.0, v248
sub12:
    v_mfma_f32_16x16x32_bf16 a[0:3], a[192:195], v[228:231], a[0:3]
    buffer_load_dwordx4 a[236:239], v254, s[8:11], s42 offen offset:2048 sc1
    v_mfma_f32_16x16x32_bf16 a[4:7], a[196:199], v[228:231], a[4:7]
    s_mov_b32 s42, 482304
    v_fma_f32 v248, v250, s26, v251
    v_fmac_f32 v251, s27, v250
    v_mfma_f32_16x16x32_bf16 a[8:11], a[200:203], v[228:231], a[8:11]
    ds_read_b128 v[228:231], v253 offset:8576
    s_waitcnt vmcnt(12)
    s_waitcnt lgkmcnt(2)
    v_mfma_f32_16x16x32_bf16 a[8:11], a[212:215], v[232:235], a[8:11]
    v_fma_f32 v250, v249, 2.0, v252
    v_fmac_f32 v252, -2.0, v249
    v_mfma_f32_16x16x32_bf16 a[4:7], a[208:211], v[232:235], a[4:7]
    buffer_load_dwordx4 a[240:243], v254, s[8:11], s42 offen offset:0 sc1
    v_mfma_f32_16x16x32_bf16 a[0:3], a[204:207], v[232:235], a[0:3]
    s_waitcnt vmcnt(10) lgkmcnt(1)
    v_fma_f32 v249, v196, s24, v200
    v_fmac_f32 v200, -4.0, v196
    v_mfma_f32_16x16x32_bf16 a[0:3], a[216:219], v[236:239], a[0:3]
    v_fma_f32 v196, v194, s24, v198
    v_fmac_f32 v198, -4.0, v194
    v_mfma_f32_16x16x32_bf16 a[4:7], a[220:223], v[236:239], a[4:7]
    v_fma_f32 v194, v198, s26, v200
    v_fmac_f32 v200, s27, v198
    v_mfma_f32_16x16x32_bf16 a[8:11], a[224:227], v[236:239], a[8:11]
    buffer_load_dwordx4 a[244:247], v254, s[8:11], s42 offen offset:1024 sc1
    v_mfma_f32_16x16x32_bf16 a[12:15], a[192:195], v[232:235], a[12:15]
    v_fma_f32 v198, v196, 2.0, v249
    v_fmac_f32 v249, -2.0, v196
    v_mfma_f32_16x16x32_bf16 a[12:15], a[204:207], v[236:239], a[12:15]
    s_waitcnt lgkmcnt(0)
    v_cvt_pk_bf16_f32 v194, v248, v194
    v_cvt_pk_bf16_f32 v200, v251, v200
    v_mfma_f32_16x16x32_bf16 a[12:15], a[216:219], v[228:231], a[12:15]
    v_cvt_pk_bf16_f32 v198, v250, v198
    v_cvt_pk_bf16_f32 v196, v252, v249
    v_mfma_f32_16x16x32_bf16 a[16:19], a[220:223], v[228:231], a[16:19]
    buffer_load_dwordx4 a[248:251], v254, s[8:11], s42 offen offset:2048 sc1
    v_mfma_f32_16x16x32_bf16 a[16:19], a[208:211], v[236:239], a[16:19]
    s_mov_b32 s42, 485376
    v_lshlrev_b32 v248, 16, v195
    v_lshlrev_b32 v249, 16, v197
    v_mfma_f32_16x16x32_bf16 a[16:19], a[196:199], v[232:235], a[16:19]
    v_lshlrev_b32 v250, 16, v199
    v_lshlrev_b32 v251, 16, v201
    v_mfma_f32_16x16x32_bf16 a[20:23], a[200:203], v[232:235], a[20:23]
    ds_read_b128 v[232:235], v253 offset:8320
    v_and_b32 v195, s22, v195
    v_and_b32 v197, s22, v197
    v_mfma_f32_16x16x32_bf16 a[20:23], a[212:215], v[236:239], a[20:23]
    buffer_load_dwordx4 a[252:255], v254, s[8:11], s42 offen offset:0 sc1
    v_mfma_f32_16x16x32_bf16 a[20:23], a[224:227], v[228:231], a[20:23]
    v_and_b32 v199, s22, v199
    v_and_b32 v201, s22, v201
    v_mfma_f32_16x16x32_bf16 a[24:27], a[192:195], v[236:239], a[24:27]
    v_lshlrev_b32 v252, 16, v193
    v_and_b32 v193, s22, v193
    v_mfma_f32_16x16x32_bf16 a[24:27], a[204:207], v[228:231], a[24:27]
    s_waitcnt lgkmcnt(0)
    v_fmac_f32 v252, s25, v251
    v_fmac_f32 v193, s25, v201
    v_mfma_f32_16x16x32_bf16 a[24:27], a[216:219], v[232:235], a[24:27]
    v_fmac_f32 v252, s28, v249
    v_fmac_f32 v193, s28, v197
    v_mfma_f32_16x16x32_bf16 a[28:31], a[220:223], v[232:235], a[28:31]
    buffer_load_dwordx4 v[240:243], v254, s[8:11], s42 offen offset:1024 sc1
    v_mfma_f32_16x16x32_bf16 a[28:31], a[208:211], v[228:231], a[28:31]
    v_cvt_pk_bf16_f32 v193, v252, v193
    v_lshlrev_b32 v252, 16, v203
    v_mfma_f32_16x16x32_bf16 a[28:31], a[196:199], v[236:239], a[28:31]
    v_and_b32 v203, s22, v203
    v_fmac_f32 v252, s29, v248
    v_mfma_f32_16x16x32_bf16 a[32:35], a[200:203], v[236:239], a[32:35]
    ds_read_b128 v[236:239], v253 offset:10144
    v_fmac_f32 v203, s29, v195
    v_mfma_f32_16x16x32_bf16 a[32:35], a[212:215], v[228:231], a[32:35]
    buffer_load_dwordx4 v[244:247], v254, s[8:11], s42 offen offset:2048 sc1
    v_mfma_f32_16x16x32_bf16 a[32:35], a[224:227], v[232:235], a[32:35]
    v_fmac_f32 v252, s23, v250
    v_fmac_f32 v203, s23, v199
    v_mfma_f32_16x16x32_bf16 a[36:39], a[192:195], v[228:231], a[36:39]
    v_and_b32 v227, 0x7fff, v255
    v_cvt_pk_bf16_f32 v203, v252, v203
    v_mfma_f32_16x16x32_bf16 a[36:39], a[204:207], v[232:235], a[36:39]
    s_waitcnt lgkmcnt(0)
    v_fma_f32 v252, v249, s24, v251
    v_fmac_f32 v251, -4.0, v249
    v_mfma_f32_16x16x32_bf16 a[36:39], a[216:219], v[236:239], a[36:39]
    buffer_load_dwordx2 v[216:217], v227, s[4:7], s16 offen offset:1024
    v_mfma_f32_16x16x32_bf16 a[40:43], a[220:223], v[236:239], a[40:43]
    v_fma_f32 v249, v248, s24, v250
    v_fmac_f32 v250, -4.0, v248
    v_mfma_f32_16x16x32_bf16 a[40:43], a[208:211], v[232:235], a[40:43]
    v_fma_f32 v248, v250, s26, v251
    v_fmac_f32 v251, s27, v250
    v_mfma_f32_16x16x32_bf16 a[40:43], a[196:199], v[228:231], a[40:43]
    v_fma_f32 v250, v249, 2.0, v252
    v_fmac_f32 v252, -2.0, v249
    v_mfma_f32_16x16x32_bf16 a[44:47], a[200:203], v[228:231], a[44:47]
    ds_read_b128 v[228:231], v253 offset:9888
    v_fma_f32 v249, v197, s24, v201
    v_mfma_f32_16x16x32_bf16 a[44:47], a[212:215], v[232:235], a[44:47]
    buffer_load_dwordx2 v[218:219], v227, s[4:7], s17 offen offset:1024
    v_mfma_f32_16x16x32_bf16 a[44:47], a[224:227], v[236:239], a[44:47]
    v_fmac_f32 v201, -4.0, v197
    v_fma_f32 v197, v195, s24, v199
    v_mfma_f32_16x16x32_bf16 a[48:51], a[192:195], v[232:235], a[48:51]
    v_fmac_f32 v199, -4.0, v195
    v_fma_f32 v195, v199, s26, v201
    v_mfma_f32_16x16x32_bf16 a[48:51], a[204:207], v[236:239], a[48:51]
    s_waitcnt lgkmcnt(0)
    v_fmac_f32 v201, s27, v199
    v_fma_f32 v199, v197, 2.0, v249
    v_mfma_f32_16x16x32_bf16 a[48:51], a[216:219], v[228:231], a[48:51]
    buffer_load_dwordx2 v[220:221], v227, s[4:7], s18 offen offset:1024
    v_mfma_f32_16x16x32_bf16 a[52:55], a[220:223], v[228:231], a[52:55]
    v_fmac_f32 v249, -2.0, v197
    v_cvt_pk_bf16_f32 v195, v248, v195
    v_mfma_f32_16x16x32_bf16 a[52:55], a[208:211], v[236:239], a[52:55]
    v_cvt_pk_bf16_f32 v201, v251, v201
    v_cvt_pk_bf16_f32 v199, v250, v199
    v_mfma_f32_16x16x32_bf16 a[52:55], a[196:199], v[232:235], a[52:55]
    v_cvt_pk_bf16_f32 v197, v252, v249
    v_lshrrev_b32 v252, 15, v255
    v_mfma_f32_16x16x32_bf16 a[56:59], a[200:203], v[232:235], a[56:59]
    ds_read_b128 v[232:235], v253 offset:9632
    v_mfma_f32_16x16x32_bf16 a[56:59], a[212:215], v[236:239], a[56:59]
    buffer_load_dwordx2 v[222:223], v227, s[4:7], s19 offen offset:1024
    v_mfma_f32_16x16x32_bf16 a[56:59], a[224:227], v[228:231], a[56:59]
    ds_write_b64 v252, v[194:195] offset:768
    v_mfma_f32_16x16x32_bf16 a[60:63], a[192:195], v[236:239], a[60:63]
    v_lshrrev_b32 v194, 15, v255
    v_mfma_f32_16x16x32_bf16 a[60:63], a[204:207], v[228:231], a[60:63]
    s_waitcnt lgkmcnt(1)
    s_waitcnt vmcnt(13)
    v_lshlrev_b32 v248, 16, v206
    v_mfma_f32_16x16x32_bf16 a[60:63], a[216:219], v[232:235], a[60:63]
    buffer_load_dwordx2 v[224:225], v227, s[4:7], s20 offen offset:1024
    v_mfma_f32_16x16x32_bf16 a[64:67], a[220:223], v[232:235], a[64:67]
    ds_write_b64 v194, v[200:201] offset:2848
    v_mfma_f32_16x16x32_bf16 a[64:67], a[208:211], v[228:231], a[64:67]
    v_lshlrev_b32 v249, 16, v208
    v_lshlrev_b32 v250, 16, v210
    v_mfma_f32_16x16x32_bf16 a[64:67], a[196:199], v[236:239], a[64:67]
    ds_write_b64 v194, v[198:199] offset:4928
    v_mfma_f32_16x16x32_bf16 a[68:71], a[200:203], v[236:239], a[68:71]
    ds_read_b128 v[236:239], v253 offset:9376
    v_lshlrev_b32 v251, 16, v212
    v_mfma_f32_16x16x32_bf16 a[68:71], a[212:215], v[228:231], a[68:71]
    buffer_load_dwordx2 v[226:227], v227, s[4:7], s21 offen offset:1024
    v_mfma_f32_16x16x32_bf16 a[68:71], a[224:227], v[232:235], a[68:71]
    ds_write_b64 v194, v[192:193] offset:21568
    v_mfma_f32_16x16x32_bf16 a[72:75], a[192:195], v[228:231], a[72:75]
    v_and_b32 v206, s22, v206
    v_and_b32 v208, s22, v208
    v_mfma_f32_16x16x32_bf16 a[72:75], a[204:207], v[232:235], a[72:75]
    s_waitcnt lgkmcnt(1)
    v_and_b32 v210, s22, v210
    v_and_b32 v212, s22, v212
    v_lshlrev_b32 v252, 16, v204
    v_mfma_f32_16x16x32_bf16 a[72:75], a[216:219], v[236:239], a[72:75]
    ds_write_b64 v194, v[202:203] offset:29888
    v_mfma_f32_16x16x32_bf16 a[76:79], a[220:223], v[236:239], a[76:79]
    v_and_b32 v204, s22, v204
    v_fmac_f32 v252, s25, v251
    v_mfma_f32_16x16x32_bf16 a[76:79], a[208:211], v[232:235], a[76:79]
    ds_write_b64 v194, v[196:197] offset:7008
    v_mfma_f32_16x16x32_bf16 a[76:79], a[196:199], v[228:231], a[76:79]
    v_fmac_f32 v204, s25, v212
    v_fmac_f32 v252, s28, v249
    v_mfma_f32_16x16x32_bf16 a[80:83], a[200:203], v[228:231], a[80:83]
    ds_read_b128 v[228:231], v253 offset:9104
    v_fmac_f32 v204, s28, v208
    v_mfma_f32_16x16x32_bf16 a[80:83], a[212:215], v[232:235], a[80:83]
    v_cvt_pk_bf16_f32 v204, v252, v204
    v_lshlrev_b32 v252, 16, v214
    v_mfma_f32_16x16x32_bf16 a[80:83], a[224:227], v[236:239], a[80:83]
    s_mov_b32 s42, 516096
    v_and_b32 v214, s22, v214
    v_fmac_f32 v252, s29, v248
    v_mfma_f32_16x16x32_bf16 a[84:87], a[192:195], v[232:235], a[84:87]
    v_fmac_f32 v214, s29, v206
    v_fmac_f32 v252, s23, v250
    v_mfma_f32_16x16x32_bf16 a[88:91], a[196:199], v[232:235], a[88:91]
    v_fmac_f32 v214, s23, v210
    v_cvt_pk_bf16_f32 v214, v252, v214
    v_mfma_f32_16x16x32_bf16 a[92:95], a[200:203], v[232:235], a[92:95]
    ds_read_b128 v[232:235], v253 offset:11440
    v_fma_f32 v252, v249, s24, v251
    v_mfma_f32_16x16x32_bf16 a[92:95], a[212:215], v[236:239], a[92:95]
    buffer_load_dwordx4 a[192:195], v254, s[8:11], s42 offen offset:0 sc1
    v_mfma_f32_16x16x32_bf16 a[88:91], a[208:211], v[236:239], a[88:91]
    s_waitcnt lgkmcnt(1)
    v_fmac_f32 v251, -4.0, v249
    v_fma_f32 v249, v248, s24, v250
    v_mfma_f32_16x16x32_bf16 a[84:87], a[204:207], v[236:239], a[84:87]
    ds_read_b128 v[236:239], v253 offset:11168
    v_fmac_f32 v250, -4.0, v248
    v_mfma_f32_16x16x32_bf16 a[84:87], a[216:219], v[228:231], a[84:87]
    buffer_load_dwordx4 a[196:199], v254, s[8:11], s42 offen offset:1024 sc1
    v_mfma_f32_16x16x32_bf16 a[88:91], a[220:223], v[228:231], a[88:91]
    s_waitcnt vmcnt(14) lgkmcnt(1)
    v_fma_f32 v248, v250, s26, v251
    v_fmac_f32 v251, s27, v250
    v_mfma_f32_16x16x32_bf16 a[92:95], a[224:227], v[228:231], a[92:95]
    ds_read_b128 v[228:231], v253 offset:10912
    v_fma_f32 v250, v249, 2.0, v252
sub13:
    v_mfma_f32_16x16x32_bf16 a[96:99], a[228:231], v[232:235], a[96:99]
    buffer_load_dwordx4 a[200:203], v254, s[8:11], s42 offen offset:2048 sc1
    v_mfma_f32_16x16x32_bf16 a[100:103], a[232:235], v[232:235], a[100:103]
    s_mov_b32 s42, 519168
    v_fmac_f32 v252, -2.0, v249
    v_fma_f32 v249, v208, s24, v212
    v_mfma_f32_16x16x32_bf16 a[104:107], a[236:239], v[232:235], a[104:107]
    ds_read_b128 v[232:235], v253 offset:10656
    s_waitcnt vmcnt(12)
    s_waitcnt lgkmcnt(2)
    v_mfma_f32_16x16x32_bf16 a[104:107], a[248:251], v[236:239], a[104:107]
    v_fmac_f32 v212, -4.0, v208
    v_fma_f32 v208, v206, s24, v210
    v_mfma_f32_16x16x32_bf16 a[100:103], a[244:247], v[236:239], a[100:103]
    buffer_load_dwordx4 a[204:207], v254, s[8:11], s42 offen offset:0 sc1
    v_mfma_f32_16x16x32_bf16 a[96:99], a[240:243], v[236:239], a[96:99]
    s_waitcnt vmcnt(10) lgkmcnt(1)
    v_fmac_f32 v210, -4.0, v206
    v_fma_f32 v206, v210, s26, v212
    v_mfma_f32_16x16x32_bf16 a[96:99], a[252:255], v[228:231], a[96:99]
    v_fmac_f32 v212, s27, v210
    v_fma_f32 v210, v208, 2.0, v249
    v_mfma_f32_16x16x32_bf16 a[100:103], v[240:243], v[228:231], a[100:103]
    v_fmac_f32 v249, -2.0, v208
    v_cvt_pk_bf16_f32 v206, v248, v206
    v_mfma_f32_16x16x32_bf16 a[104:107], v[244:247], v[228:231], a[104:107]
    buffer_load_dwordx4 a[208:211], v254, s[8:11], s42 offen offset:1024 sc1
    v_mfma_f32_16x16x32_bf16 a[108:111], a[228:231], v[236:239], a[108:111]
    v_cvt_pk_bf16_f32 v212, v251, v212
    v_cvt_pk_bf16_f32 v210, v250, v210
    v_mfma_f32_16x16x32_bf16 a[108:111], a[240:243], v[228:231], a[108:111]
    s_waitcnt lgkmcnt(0)
    v_cvt_pk_bf16_f32 v208, v252, v249
    v_lshlrev_b32 v248, 16, v207
    v_mfma_f32_16x16x32_bf16 a[108:111], a[252:255], v[232:235], a[108:111]
    v_lshlrev_b32 v249, 16, v209
    v_lshlrev_b32 v250, 16, v211
    v_mfma_f32_16x16x32_bf16 a[112:115], v[240:243], v[232:235], a[112:115]
    buffer_load_dwordx4 a[212:215], v254, s[8:11], s42 offen offset:2048 sc1
    v_mfma_f32_16x16x32_bf16 a[112:115], a[244:247], v[228:231], a[112:115]
    s_mov_b32 s42, 522240
    v_lshlrev_b32 v251, 16, v213
    v_and_b32 v207, s22, v207
    v_mfma_f32_16x16x32_bf16 a[112:115], a[232:235], v[236:239], a[112:115]
    v_and_b32 v209, s22, v209
    v_and_b32 v211, s22, v211
    v_mfma_f32_16x16x32_bf16 a[116:119], a[236:239], v[236:239], a[116:119]
    ds_read_b128 v[236:239], v253 offset:10400
    v_and_b32 v213, s22, v213
    v_mfma_f32_16x16x32_bf16 a[116:119], a[248:251], v[228:231], a[116:119]
    buffer_load_dwordx4 a[216:219], v254, s[8:11], s42 offen offset:0 sc1
    v_mfma_f32_16x16x32_bf16 a[116:119], v[244:247], v[232:235], a[116:119]
    v_lshlrev_b32 v252, 16, v205
    v_and_b32 v205, s22, v205
    v_mfma_f32_16x16x32_bf16 a[120:123], a[228:231], v[228:231], a[120:123]
    v_fmac_f32 v252, s25, v251
    v_fmac_f32 v205, s25, v213
    v_mfma_f32_16x16x32_bf16 a[120:123], a[240:243], v[232:235], a[120:123]
    s_waitcnt lgkmcnt(0)
    v_fmac_f32 v252, s28, v249
    v_fmac_f32 v205, s28, v209
    v_mfma_f32_16x16x32_bf16 a[120:123], a[252:255], v[236:239], a[120:123]
    v_cvt_pk_bf16_f32 v205, v252, v205
    v_lshlrev_b32 v252, 16, v215
    v_mfma_f32_16x16x32_bf16 a[124:127], v[240:243], v[236:239], a[124:127]
    buffer_load_dwordx4 a[220:223], v254, s[8:11], s42 offen offset:1024 sc1
    v_mfma_f32_16x16x32_bf16 a[124:127], a[244:247], v[232:235], a[124:127]
    v_and_b32 v215, s22, v215
    v_fmac_f32 v252, s29, v248
    v_mfma_f32_16x16x32_bf16 a[124:127], a[232:235], v[228:231], a[124:127]
    v_fmac_f32 v215, s29, v207
    v_fmac_f32 v252, s23, v250
    v_fmac_f32 v215, s23, v211
    v_mfma_f32_16x16x32_bf16 a[128:131], a[236:239], v[228:231], a[128:131]
    ds_read_b128 v[228:231], v253 offset:12224
    v_cvt_pk_bf16_f32 v215, v252, v215
    v_mfma_f32_16x16x32_bf16 a[128:131], a[248:251], v[232:235], a[128:131]
    buffer_load_dwordx4 a[224:227], v254, s[8:11], s42 offen offset:2048 sc1
    v_mfma_f32_16x16x32_bf16 a[128:131], v[244:247], v[236:239], a[128:131]
    v_fma_f32 v252, v249, s24, v251
    v_fmac_f32 v251, -4.0, v249
    v_mfma_f32_16x16x32_bf16 a[132:135], a[228:231], v[232:235], a[132:135]
    v_and_b32 v203, 0x7fff, v255
    v_fma_f32 v249, v248, s24, v250
    v_mfma_f32_16x16x32_bf16 a[132:135], a[240:243], v[236:239], a[132:135]
    s_waitcnt lgkmcnt(0)
    v_fmac_f32 v250, -4.0, v248
    v_fma_f32 v248, v250, s26, v251
    v_mfma_f32_16x16x32_bf16 a[132:135], a[252:255], v[228:231], a[132:135]
    buffer_load_dwordx2 v[192:193], v203, s[4:7], s16 offen offset:1408
    v_mfma_f32_16x16x32_bf16 a[136:139], v[240:243], v[228:231], a[136:139]
    v_fmac_f32 v251, s27, v250
    v_fma_f32 v250, v249, 2.0, v252
    v_mfma_f32_16x16x32_bf16 a[136:139], a[244:247], v[236:239], a[136:139]
    v_fmac_f32 v252, -2.0, v249
    v_fma_f32 v249, v209, s24, v213
    v_mfma_f32_16x16x32_bf16 a[136:139], a[232:235], v[232:235], a[136:139]
    v_fmac_f32 v213, -4.0, v209
    v_fma_f32 v209, v207, s24, v211
    v_mfma_f32_16x16x32_bf16 a[140:143], a[236:239], v[232:235], a[140:143]
    ds_read_b128 v[232:235], v253 offset:11968
    v_fmac_f32 v211, -4.0, v207
    v_mfma_f32_16x16x32_bf16 a[140:143], a[248:251], v[236:239], a[140:143]
    buffer_load_dwordx2 v[194:195], v203, s[4:7], s17 offen offset:1408
    v_mfma_f32_16x16x32_bf16 a[140:143], v[244:247], v[228:231], a[140:143]
    v_fma_f32 v207, v211, s26, v213
    v_fmac_f32 v213, s27, v211
    v_mfma_f32_16x16x32_bf16 a[144:147], a[228:231], v[236:239], a[144:147]
    v_fma_f32 v211, v209, 2.0, v249
    v_fmac_f32 v249, -2.0, v209
    v_mfma_f32_16x16x32_bf16 a[144:147], a[240:243], v[228:231], a[144:147]
    s_waitcnt lgkmcnt(0)
    v_cvt_pk_bf16_f32 v207, v248, v207
    v_cvt_pk_bf16_f32 v213, v251, v213
    v_mfma_f32_16x16x32_bf16 a[144:147], a[252:255], v[232:235], a[144:147]
    buffer_load_dwordx2 v[196:197], v203, s[4:7], s18 offen offset:1408
    v_mfma_f32_16x16x32_bf16 a[148:151], v[240:243], v[232:235], a[148:151]
    v_cvt_pk_bf16_f32 v211, v250, v211
    v_cvt_pk_bf16_f32 v209, v252, v249
    v_mfma_f32_16x16x32_bf16 a[148:151], a[244:247], v[228:231], a[148:151]
    v_lshrrev_b32 v252, 15, v255
    v_mfma_f32_16x16x32_bf16 a[148:151], a[232:235], v[236:239], a[148:151]
    ds_write_b64 v252, v[206:207] offset:512
    v_mfma_f32_16x16x32_bf16 a[152:155], a[236:239], v[236:239], a[152:155]
    ds_read_b128 v[236:239], v253 offset:11712
    v_lshrrev_b32 v206, 15, v255
    v_mfma_f32_16x16x32_bf16 a[152:155], a[248:251], v[228:231], a[152:155]
    buffer_load_dwordx2 v[198:199], v203, s[4:7], s19 offen offset:1408
    v_mfma_f32_16x16x32_bf16 a[152:155], v[244:247], v[232:235], a[152:155]
    ds_write_b64 v206, v[212:213] offset:2592
    v_mfma_f32_16x16x32_bf16 a[156:159], a[228:231], v[228:231], a[156:159]
    v_mfma_f32_16x16x32_bf16 a[156:159], a[240:243], v[232:235], a[156:159]
    s_waitcnt lgkmcnt(1)
    s_waitcnt vmcnt(13)
    v_lshlrev_b32 v248, 16, v218
    v_mfma_f32_16x16x32_bf16 a[156:159], a[252:255], v[236:239], a[156:159]
    buffer_load_dwordx2 v[200:201], v203, s[4:7], s20 offen offset:1408
    v_mfma_f32_16x16x32_bf16 a[160:163], v[240:243], v[236:239], a[160:163]
    ds_write_b64 v206, v[210:211] offset:4672
    v_mfma_f32_16x16x32_bf16 a[160:163], a[244:247], v[232:235], a[160:163]
    v_lshlrev_b32 v249, 16, v220
    v_lshlrev_b32 v250, 16, v222
    v_mfma_f32_16x16x32_bf16 a[160:163], a[232:235], v[228:231], a[160:163]
    ds_write_b64 v206, v[204:205] offset:21312
    v_mfma_f32_16x16x32_bf16 a[164:167], a[236:239], v[228:231], a[164:167]
    ds_read_b128 v[228:231], v253 offset:11456
    v_lshlrev_b32 v251, 16, v224
    v_mfma_f32_16x16x32_bf16 a[164:167], a[248:251], v[232:235], a[164:167]
    buffer_load_dwordx2 v[202:203], v203, s[4:7], s21 offen offset:1408
    v_mfma_f32_16x16x32_bf16 a[164:167], v[244:247], v[236:239], a[164:167]
    ds_write_b64 v206, v[214:215] offset:29632
    v_mfma_f32_16x16x32_bf16 a[168:171], a[228:231], v[232:235], a[168:171]
    v_and_b32 v218, s22, v218
    v_and_b32 v220, s22, v220
    v_mfma_f32_16x16x32_bf16 a[168:171], a[240:243], v[236:239], a[168:171]
    s_waitcnt lgkmcnt(1)
    v_and_b32 v222, s22, v222
    v_and_b32 v224, s22, v224
    v_mfma_f32_16x16x32_bf16 a[168:171], a[252:255], v[228:231], a[168:171]
    ds_write_b64 v206, v[208:209] offset:6752
    v_mfma_f32_16x16x32_bf16 a[172:175], v[240:243], v[228:231], a[172:175]
    ds_read_b128 v[204:207], v253 offset:40288
    s_mov_b32 s45, 472974346
    v_mfma_f32_16x16x32_bf16 a[172:175], a[244:247], v[236:239], a[172:175]
    v_bfe_u32 v208, v254, 5, 3
    v_mul_u32_u24 v209, 5, v208
    v_mfma_f32_16x16x32_bf16 a[172:175], a[232:235], v[232:235], a[172:175]
    v_bfe_u32 v209, s45, v209, 5
    v_mul_u32_u24 v209, 65, v209
    v_mfma_f32_16x16x32_bf16 a[176:179], a[236:239], v[232:235], a[176:179]
    ds_read_b128 v[232:235], v253 offset:11184
    v_sub_u32 v209, v209, v208
    v_mfma_f32_16x16x32_bf16 a[176:179], a[248:251], v[236:239], a[176:179]
    v_lshl_add_u32 v208, v209, 5, v253
    s_waitcnt lgkmcnt(1)
    v_mfma_f32_16x16x32_bf16 a[176:179], v[244:247], v[228:231], a[176:179]
    s_mov_b32 s42, 552960
    v_lshlrev_b32 v252, 16, v216
    v_and_b32 v216, s22, v216
    v_mfma_f32_16x16x32_bf16 a[180:183], a[228:231], v[236:239], a[180:183]
    s_mov_b64 exec, s[46:47]
    ds_write_b128 v208, v[204:207] offset:1024
    s_mov_b64 exec, -1
    v_fmac_f32 v252, s25, v251
    v_mfma_f32_16x16x32_bf16 a[184:187], a[232:235], v[236:239], a[184:187]
    v_fmac_f32 v216, s25, v224
    v_fmac_f32 v252, s28, v249
    v_mfma_f32_16x16x32_bf16 a[188:191], a[236:239], v[236:239], a[188:191]
    ds_read_b128 v[236:239], v253 offset:13520
    v_fmac_f32 v216, s28, v220
    v_mfma_f32_16x16x32_bf16 a[188:191], a[248:251], v[228:231], a[188:191]
    buffer_load_dwordx4 a[228:231], v254, s[8:11], s42 offen offset:0 sc1
    v_mfma_f32_16x16x32_bf16 a[184:187], a[244:247], v[228:231], a[184:187]
    s_waitcnt lgkmcnt(2)
    v_cvt_pk_bf16_f32 v216, v252, v216
    v_lshlrev_b32 v252, 16, v226
    v_mfma_f32_16x16x32_bf16 a[180:183], a[240:243], v[228:231], a[180:183]
    ds_read_b128 v[228:231], v253 offset:13248
    v_and_b32 v226, s22, v226
    v_mfma_f32_16x16x32_bf16 a[180:183], a[252:255], v[232:235], a[180:183]
    buffer_load_dwordx4 a[232:235], v254, s[8:11], s42 offen offset:1024 sc1
    v_mfma_f32_16x16x32_bf16 a[184:187], v[240:243], v[232:235], a[184:187]
    s_waitcnt vmcnt(14) lgkmcnt(1)
    v_fmac_f32 v252, s29, v248
    v_fmac_f32 v226, s29, v218
    v_mfma_f32_16x16x32_bf16 a[188:191], v[244:247], v[232:235], a[188:191]
    ds_read_b128 v[232:235], v253 offset:12992
    v_fmac_f32 v252, s23, v250
sub14:
    v_mfma_f32_16x16x32_bf16 v[0:3], a[192:195], v[236:239], v[0:3]
    buffer_load_dwordx4 a[236:239], v254, s[8:11], s42 offen offset:2048 sc1
    v_mfma_f32_16x16x32_bf16 v[4:7], a[196:199], v[236:239], v[4:7]
    s_mov_b32 s42, 556032
    v_fmac_f32 v226, s23, v222
    v_cvt_pk_bf16_f32 v226, v252, v226
    v_mfma_f32_16x16x32_bf16 v[8:11], a[200:203], v[236:239], v[8:11]
    ds_read_b128 v[236:239], v253 offset:12736
    s_waitcnt vmcnt(12)
    s_waitcnt lgkmcnt(2)
    v_mfma_f32_16x16x32_bf16 v[8:11], a[212:215], v[228:231], v[8:11]
    v_fma_f32 v252, v249, s24, v251
    v_fmac_f32 v251, -4.0, v249
    v_mfma_f32_16x16x32_bf16 v[4:7], a[208:211], v[228:231], v[4:7]
    buffer_load_dwordx4 a[240:243], v254, s[8:11], s42 offen offset:0 sc1
    v_mfma_f32_16x16x32_bf16 v[0:3], a[204:207], v[228:231], v[0:3]
    s_waitcnt vmcnt(10) lgkmcnt(1)
    v_fma_f32 v249, v248, s24, v250
    v_fmac_f32 v250, -4.0, v248
    v_mfma_f32_16x16x32_bf16 v[0:3], a[216:219], v[232:235], v[0:3]
    v_fma_f32 v248, v250, s26, v251
    v_fmac_f32 v251, s27, v250
    v_mfma_f32_16x16x32_bf16 v[4:7], a[220:223], v[232:235], v[4:7]
    v_fma_f32 v250, v249, 2.0, v252
    v_fmac_f32 v252, -2.0, v249
    v_mfma_f32_16x16x32_bf16 v[8:11], a[224:227], v[232:235], v[8:11]
    buffer_load_dwordx4 a[244:247], v254, s[8:11], s42 offen offset:1024 sc1
    v_mfma_f32_16x16x32_bf16 v[12:15], a[192:195], v[228:231], v[12:15]
    v_fma_f32 v249, v220, s24, v224
    v_fmac_f32 v224, -4.0, v220
    v_mfma_f32_16x16x32_bf16 v[12:15], a[204:207], v[232:235], v[12:15]
    s_waitcnt lgkmcnt(0)
    v_fma_f32 v220, v218, s24, v222
    v_fmac_f32 v222, -4.0, v218
    v_mfma_f32_16x16x32_bf16 v[12:15], a[216:219], v[236:239], v[12:15]
    v_fma_f32 v218, v222, s26, v224
    v_fmac_f32 v224, s27, v222
    v_mfma_f32_16x16x32_bf16 v[16:19], a[220:223], v[236:239], v[16:19]
    buffer_load_dwordx4 a[248:251], v254, s[8:11], s42 offen offset:2048 sc1
    v_mfma_f32_16x16x32_bf16 v[16:19], a[208:211], v[232:235], v[16:19]
    s_mov_b32 s42, 559104
    v_fma_f32 v222, v220, 2.0, v249
    v_fmac_f32 v249, -2.0, v220
    v_mfma_f32_16x16x32_bf16 v[16:19], a[196:199], v[228:231], v[16:19]
    v_cvt_pk_bf16_f32 v218, v248, v218
    v_cvt_pk_bf16_f32 v224, v251, v224
    v_mfma_f32_16x16x32_bf16 v[20:23], a[200:203], v[228:231], v[20:23]
    ds_read_b128 v[228:231], v253 offset:12480
    v_cvt_pk_bf16_f32 v222, v250, v222
    v_mfma_f32_16x16x32_bf16 v[20:23], a[212:215], v[232:235], v[20:23]
    buffer_load_dwordx4 a[252:255], v254, s[8:11], s42 offen offset:0 sc1
    v_mfma_f32_16x16x32_bf16 v[20:23], a[224:227], v[236:239], v[20:23]
    v_cvt_pk_bf16_f32 v220, v252, v249
    v_lshlrev_b32 v248, 16, v219
    v_mfma_f32_16x16x32_bf16 v[24:27], a[192:195], v[232:235], v[24:27]
    v_lshlrev_b32 v249, 16, v221
    v_lshlrev_b32 v250, 16, v223
    v_mfma_f32_16x16x32_bf16 v[24:27], a[204:207], v[236:239], v[24:27]
    s_waitcnt lgkmcnt(0)
    v_lshlrev_b32 v251, 16, v225
    v_and_b32 v219, s22, v219
    v_mfma_f32_16x16x32_bf16 v[24:27], a[216:219], v[228:231], v[24:27]
    v_and_b32 v221, s22, v221
    v_and_b32 v223, s22, v223
    v_mfma_f32_16x16x32_bf16 v[28:31], a[220:223], v[228:231], v[28:31]
    buffer_load_dwordx4 v[240:243], v254, s[8:11], s42 offen offset:1024 sc1
    v_mfma_f32_16x16x32_bf16 v[28:31], a[208:211], v[236:239], v[28:31]
    v_and_b32 v225, s22, v225
    v_lshlrev_b32 v252, 16, v217
    v_mfma_f32_16x16x32_bf16 v[28:31], a[196:199], v[232:235], v[28:31]
    v_and_b32 v217, s22, v217
    v_fmac_f32 v252, s25, v251
    v_mfma_f32_16x16x32_bf16 v[32:35], a[200:203], v[232:235], v[32:35]
    ds_read_b128 v[232:235], v253 offset:14304
    v_fmac_f32 v217, s25, v225
    v_mfma_f32_16x16x32_bf16 v[32:35], a[212:215], v[236:239], v[32:35]
    buffer_load_dwordx4 v[244:247], v254, s[8:11], s42 offen offset:2048 sc1
    v_mfma_f32_16x16x32_bf16 v[32:35], a[224:227], v[228:231], v[32:35]
    v_fmac_f32 v252, s28, v249
    v_fmac_f32 v217, s28, v221
    v_mfma_f32_16x16x32_bf16 v[36:39], a[192:195], v[236:239], v[36:39]
    v_and_b32 v215, 0x7fff, v255
    v_cvt_pk_bf16_f32 v217, v252, v217
    v_mfma_f32_16x16x32_bf16 v[36:39], a[204:207], v[228:231], v[36:39]
    s_waitcnt lgkmcnt(0)
    v_lshlrev_b32 v252, 16, v227
    v_and_b32 v227, s22, v227
    v_mfma_f32_16x16x32_bf16 v[36:39], a[216:219], v[232:235], v[36:39]
    buffer_load_dwordx2 v[204:205], v215, s[4:7], s16 offen offset:320
    v_mfma_f32_16x16x32_bf16 v[40:43], a[220:223], v[232:235], v[40:43]
    v_fmac_f32 v252, s29, v248
    v_fmac_f32 v227, s29, v219
    v_mfma_f32_16x16x32_bf16 v[40:43], a[208:211], v[228:231], v[40:43]
    v_fmac_f32 v252, s23, v250
    v_fmac_f32 v227, s23, v223
    v_cvt_pk_bf16_f32 v227, v252, v227
    v_mfma_f32_16x16x32_bf16 v[40:43], a[196:199], v[236:239], v[40:43]
    v_fma_f32 v252, v249, s24, v251
    v_fmac_f32 v251, -4.0, v249
    v_mfma_f32_16x16x32_bf16 v[44:47], a[200:203], v[236:239], v[44:47]
    ds_read_b128 v[236:239], v253 offset:14048
    v_fma_f32 v249, v248, s24, v250
    v_mfma_f32_16x16x32_bf16 v[44:47], a[212:215], v[228:231], v[44:47]
    buffer_load_dwordx2 v[206:207], v215, s[4:7], s17 offen offset:320
    v_mfma_f32_16x16x32_bf16 v[44:47], a[224:227], v[232:235], v[44:47]
    v_fmac_f32 v250, -4.0, v248
    v_fma_f32 v248, v250, s26, v251
    v_mfma_f32_16x16x32_bf16 v[48:51], a[192:195], v[228:231], v[48:51]
    v_fmac_f32 v251, s27, v250
    v_fma_f32 v250, v249, 2.0, v252
    v_mfma_f32_16x16x32_bf16 v[48:51], a[204:207], v[232:235], v[48:51]
    s_waitcnt lgkmcnt(0)
    v_fmac_f32 v252, -2.0, v249
    v_fma_f32 v249, v221, s24, v225
    v_mfma_f32_16x16x32_bf16 v[48:51], a[216:219], v[236:239], v[48:51]
    buffer_load_dwordx2 v[208:209], v215, s[4:7], s18 offen offset:320
    v_mfma_f32_16x16x32_bf16 v[52:55], a[220:223], v[236:239], v[52:55]
    v_fmac_f32 v225, -4.0, v221
    v_fma_f32 v221, v219, s24, v223
    v_mfma_f32_16x16x32_bf16 v[52:55], a[208:211], v[232:235], v[52:55]
    v_fmac_f32 v223, -4.0, v219
    v_fma_f32 v219, v223, s26, v225
    v_mfma_f32_16x16x32_bf16 v[52:55], a[196:199], v[228:231], v[52:55]
    v_fmac_f32 v225, s27, v223
    v_fma_f32 v223, v221, 2.0, v249
    v_mfma_f32_16x16x32_bf16 v[56:59], a[200:203], v[228:231], v[56:59]
    ds_read_b128 v[228:231], v253 offset:13792
    v_fmac_f32 v249, -2.0, v221
    v_mfma_f32_16x16x32_bf16 v[56:59], a[212:215], v[232:235], v[56:59]
    buffer_load_dwordx2 v[210:211], v215, s[4:7], s19 offen offset:320
    v_mfma_f32_16x16x32_bf16 v[56:59], a[224:227], v[236:239], v[56:59]
    v_cvt_pk_bf16_f32 v219, v248, v219
    v_cvt_pk_bf16_f32 v225, v251, v225
    v_mfma_f32_16x16x32_bf16 v[60:63], a[192:195], v[232:235], v[60:63]
pad5:
    s_cbranch_vccnz pad9
    v_cvt_pk_bf16_f32 v223, v250, v223
    v_cvt_pk_bf16_f32 v221, v252, v249
    v_mfma_f32_16x16x32_bf16 v[60:63], a[204:207], v[236:239], v[60:63]
    s_waitcnt lgkmcnt(0)
    v_lshrrev_b32 v252, 15, v255
    v_mfma_f32_16x16x32_bf16 v[60:63], a[216:219], v[228:231], v[60:63]
    buffer_load_dwordx2 v[212:213], v215, s[4:7], s20 offen offset:320
    v_mfma_f32_16x16x32_bf16 v[64:67], a[220:223], v[228:231], v[64:67]
    ds_write_b64 v252, v[218:219] offset:256
    v_mfma_f32_16x16x32_bf16 v[64:67], a[208:211], v[236:239], v[64:67]
    s_waitcnt vmcnt(14)
    v_lshrrev_b32 v218, 15, v255
    v_lshlrev_b32 v248, 16, v194
    v_mfma_f32_16x16x32_bf16 v[64:67], a[196:199], v[232:235], v[64:67]
    ds_write_b64 v218, v[224:225] offset:2336
    v_mfma_f32_16x16x32_bf16 v[68:71], a[200:203], v[232:235], v[68:71]
    ds_read_b128 v[232:235], v253 offset:13536
    v_lshlrev_b32 v249, 16, v196
    v_mfma_f32_16x16x32_bf16 v[68:71], a[212:215], v[236:239], v[68:71]
    buffer_load_dwordx2 v[214:215], v215, s[4:7], s21 offen offset:320
    v_mfma_f32_16x16x32_bf16 v[68:71], a[224:227], v[228:231], v[68:71]
    ds_write_b64 v218, v[222:223] offset:4416
    v_mfma_f32_16x16x32_bf16 v[72:75], a[192:195], v[236:239], v[72:75]
    v_lshlrev_b32 v250, 16, v198
    v_lshlrev_b32 v251, 16, v200
    v_mfma_f32_16x16x32_bf16 v[72:75], a[204:207], v[228:231], v[72:75]
    s_waitcnt lgkmcnt(1)
    v_and_b32 v194, s22, v194
    v_and_b32 v196, s22, v196
    v_mfma_f32_16x16x32_bf16 v[72:75], a[216:219], v[232:235], v[72:75]
    ds_write_b64 v218, v[216:217] offset:21056
    v_mfma_f32_16x16x32_bf16 v[76:79], a[220:223], v[232:235], v[76:79]
    v_and_b32 v198, s22, v198
    v_and_b32 v200, s22, v200
    v_mfma_f32_16x16x32_bf16 v[76:79], a[208:211], v[228:231], v[76:79]
    ds_write_b64 v218, v[226:227] offset:29376
    v_mfma_f32_16x16x32_bf16 v[76:79], a[196:199], v[236:239], v[76:79]
    v_lshlrev_b32 v252, 16, v192
    v_and_b32 v192, s22, v192
    v_mfma_f32_16x16x32_bf16 v[80:83], a[200:203], v[236:239], v[80:83]
    ds_read_b128 v[236:239], v253 offset:13264
    v_fmac_f32 v252, s25, v251
    v_mfma_f32_16x16x32_bf16 v[80:83], a[212:215], v[228:231], v[80:83]
    ds_write_b64 v218, v[220:221] offset:6496
    v_mfma_f32_16x16x32_bf16 v[80:83], a[224:227], v[232:235], v[80:83]
    s_mov_b32 s42, 589824
    v_fmac_f32 v192, s25, v200
    v_fmac_f32 v252, s28, v249
    v_mfma_f32_16x16x32_bf16 v[84:87], a[192:195], v[228:231], v[84:87]
    v_fmac_f32 v192, s28, v196
    v_cvt_pk_bf16_f32 v192, v252, v192
    v_mfma_f32_16x16x32_bf16 v[88:91], a[196:199], v[228:231], v[88:91]
    v_lshlrev_b32 v252, 16, v202
    v_and_b32 v202, s22, v202
    v_mfma_f32_16x16x32_bf16 v[92:95], a[200:203], v[228:231], v[92:95]
    ds_read_b128 v[228:231], v253 offset:32240
    v_fmac_f32 v252, s29, v248
    v_mfma_f32_16x16x32_bf16 v[92:95], a[212:215], v[232:235], v[92:95]
    buffer_load_dwordx4 a[192:195], v254, s[8:11], s42 offen offset:0 sc1
    v_mfma_f32_16x16x32_bf16 v[88:91], a[208:211], v[232:235], v[88:91]
    s_waitcnt lgkmcnt(2)
    v_fmac_f32 v202, s29, v194
    v_fmac_f32 v252, s23, v250
    v_mfma_f32_16x16x32_bf16 v[84:87], a[204:207], v[232:235], v[84:87]
    ds_read_b128 v[232:235], v253 offset:31968
    v_fmac_f32 v202, s23, v198
    v_mfma_f32_16x16x32_bf16 v[84:87], a[216:219], v[236:239], v[84:87]
    buffer_load_dwordx4 a[196:199], v254, s[8:11], s42 offen offset:1024 sc1
    v_mfma_f32_16x16x32_bf16 v[88:91], a[220:223], v[236:239], v[88:91]
    s_waitcnt vmcnt(14) lgkmcnt(1)
    v_cvt_pk_bf16_f32 v202, v252, v202
    v_fma_f32 v252, v249, s24, v251
    v_mfma_f32_16x16x32_bf16 v[92:95], a[224:227], v[236:239], v[92:95]
    ds_read_b128 v[236:239], v253 offset:31712
    v_fmac_f32 v251, -4.0, v249
    v_fma_f32 v249, v248, s24, v250
sub15:
    v_mfma_f32_16x16x32_bf16 v[96:99], a[228:231], v[228:231], v[96:99]
    buffer_load_dwordx4 a[200:203], v254, s[8:11], s42 offen offset:2048 sc1
    v_mfma_f32_16x16x32_bf16 v[100:103], a[232:235], v[228:231], v[100:103]
    s_mov_b32 s42, 592896
    v_fmac_f32 v250, -4.0, v248
    v_fma_f32 v248, v250, s26, v251
    v_mfma_f32_16x16x32_bf16 v[104:107], a[236:239], v[228:231], v[104:107]
    ds_read_b128 v[228:231], v253 offset:31456
    s_waitcnt vmcnt(12)
    s_waitcnt lgkmcnt(2)
    v_mfma_f32_16x16x32_bf16 v[104:107], a[248:251], v[232:235], v[104:107]
    v_fmac_f32 v251, s27, v250
    v_fma_f32 v250, v249, 2.0, v252
    v_mfma_f32_16x16x32_bf16 v[100:103], a[244:247], v[232:235], v[100:103]
    buffer_load_dwordx4 a[204:207], v254, s[8:11], s42 offen offset:0 sc1
    v_mfma_f32_16x16x32_bf16 v[96:99], a[240:243], v[232:235], v[96:99]
    s_waitcnt vmcnt(10) lgkmcnt(1)
    v_fmac_f32 v252, -2.0, v249
    v_fma_f32 v249, v196, s24, v200
    v_mfma_f32_16x16x32_bf16 v[96:99], a[252:255], v[236:239], v[96:99]
    v_fmac_f32 v200, -4.0, v196
    v_fma_f32 v196, v194, s24, v198
    v_mfma_f32_16x16x32_bf16 v[100:103], v[240:243], v[236:239], v[100:103]
    v_fmac_f32 v198, -4.0, v194
    v_fma_f32 v194, v198, s26, v200
    v_mfma_f32_16x16x32_bf16 v[104:107], v[244:247], v[236:239], v[104:107]
    buffer_load_dwordx4 a[208:211], v254, s[8:11], s42 offen offset:1024 sc1
    v_mfma_f32_16x16x32_bf16 v[108:111], a[228:231], v[232:235], v[108:111]
    v_fmac_f32 v200, s27, v198
    v_fma_f32 v198, v196, 2.0, v249
    v_mfma_f32_16x16x32_bf16 v[108:111], a[240:243], v[236:239], v[108:111]
    s_waitcnt lgkmcnt(0)
    v_fmac_f32 v249, -2.0, v196
    v_cvt_pk_bf16_f32 v194, v248, v194
    v_mfma_f32_16x16x32_bf16 v[108:111], a[252:255], v[228:231], v[108:111]
    v_cvt_pk_bf16_f32 v200, v251, v200
    v_cvt_pk_bf16_f32 v198, v250, v198
    v_mfma_f32_16x16x32_bf16 v[112:115], v[240:243], v[228:231], v[112:115]
    buffer_load_dwordx4 a[212:215], v254, s[8:11], s42 offen offset:2048 sc1
    v_mfma_f32_16x16x32_bf16 v[112:115], a[244:247], v[236:239], v[112:115]
    s_mov_b32 s42, 595968
    v_cvt_pk_bf16_f32 v196, v252, v249
    v_lshlrev_b32 v248, 16, v195
    v_mfma_f32_16x16x32_bf16 v[112:115], a[232:235], v[232:235], v[112:115]
    v_lshlrev_b32 v249, 16, v197
    v_lshlrev_b32 v250, 16, v199
    v_mfma_f32_16x16x32_bf16 v[116:119], a[236:239], v[232:235], v[116:119]
    ds_read_b128 v[232:235], v253 offset:31200
    v_lshlrev_b32 v251, 16, v201
    v_mfma_f32_16x16x32_bf16 v[116:119], a[248:251], v[236:239], v[116:119]
    buffer_load_dwordx4 a[216:219], v254, s[8:11], s42 offen offset:0 sc1
    v_mfma_f32_16x16x32_bf16 v[116:119], v[244:247], v[228:231], v[116:119]
    v_and_b32 v195, s22, v195
    v_and_b32 v197, s22, v197
    v_mfma_f32_16x16x32_bf16 v[120:123], a[228:231], v[236:239], v[120:123]
    v_and_b32 v199, s22, v199
    v_and_b32 v201, s22, v201
    v_mfma_f32_16x16x32_bf16 v[120:123], a[240:243], v[228:231], v[120:123]
    s_waitcnt lgkmcnt(0)
    v_lshlrev_b32 v252, 16, v193
    v_and_b32 v193, s22, v193
    v_mfma_f32_16x16x32_bf16 v[120:123], a[252:255], v[232:235], v[120:123]
    v_fmac_f32 v252, s25, v251
    v_fmac_f32 v193, s25, v201
    v_mfma_f32_16x16x32_bf16 v[124:127], v[240:243], v[232:235], v[124:127]
    buffer_load_dwordx4 a[220:223], v254, s[8:11], s42 offen offset:1024 sc1
    v_mfma_f32_16x16x32_bf16 v[124:127], a[244:247], v[228:231], v[124:127]
    v_fmac_f32 v252, s28, v249
    v_fmac_f32 v193, s28, v197
    v_mfma_f32_16x16x32_bf16 v[124:127], a[232:235], v[236:239], v[124:127]
    v_cvt_pk_bf16_f32 v193, v252, v193
    v_lshlrev_b32 v252, 16, v203
    v_mfma_f32_16x16x32_bf16 v[128:131], a[236:239], v[236:239], v[128:131]
    ds_read_b128 v[236:239], v253 offset:33024
    v_and_b32 v203, s22, v203
    v_mfma_f32_16x16x32_bf16 v[128:131], a[248:251], v[228:231], v[128:131]
    buffer_load_dwordx4 a[224:227], v254, s[8:11], s42 offen offset:2048 sc1
    v_mfma_f32_16x16x32_bf16 v[128:131], v[244:247], v[232:235], v[128:131]
    v_fmac_f32 v252, s29, v248
    v_fmac_f32 v203, s29, v195
    v_mfma_f32_16x16x32_bf16 v[132:135], a[228:231], v[228:231], v[132:135]
    v_and_b32 v227, 0x7fff, v255
    v_fmac_f32 v252, s23, v250
    v_mfma_f32_16x16x32_bf16 v[132:135], a[240:243], v[232:235], v[132:135]
    s_waitcnt lgkmcnt(0)
    v_fmac_f32 v203, s23, v199
    v_cvt_pk_bf16_f32 v203, v252, v203
    v_mfma_f32_16x16x32_bf16 v[132:135], a[252:255], v[236:239], v[132:135]
    buffer_load_dwordx2 v[216:217], v227, s[4:7], s16 offen offset:704
    v_mfma_f32_16x16x32_bf16 v[136:139], v[240:243], v[236:239], v[136:139]
    v_fma_f32 v252, v249, s24, v251
    v_fmac_f32 v251, -4.0, v249
    v_mfma_f32_16x16x32_bf16 v[136:139], a[244:247], v[232:235], v[136:139]
    v_fma_f32 v249, v248, s24, v250
    v_fmac_f32 v250, -4.0, v248
    v_mfma_f32_16x16x32_bf16 v[136:139], a[232:235], v[228:231], v[136:139]
    v_fma_f32 v248, v250, s26, v251
    v_fmac_f32 v251, s27, v250
    v_mfma_f32_16x16x32_bf16 v[140:143], a[236:239], v[228:231], v[140:143]
    ds_read_b128 v[228:231], v253 offset:32768
    v_fma_f32 v250, v249, 2.0, v252
    v_mfma_f32_16x16x32_bf16 v[140:143], a[248:251], v[232:235], v[140:143]
    buffer_load_dwordx2 v[218:219], v227, s[4:7], s17 offen offset:704
    v_mfma_f32_16x16x32_bf16 v[140:143], v[244:247], v[236:239], v[140:143]
    v_fmac_f32 v252, -2.0, v249
    v_fma_f32 v249, v197, s24, v201
    v_mfma_f32_16x16x32_bf16 v[144:147], a[228:231], v[232:235], v[144:147]
    v_fmac_f32 v201, -4.0, v197
    v_fma_f32 v197, v195, s24, v199
    v_mfma_f32_16x16x32_bf16 v[144:147], a[240:243], v[236:239], v[144:147]
    s_waitcnt lgkmcnt(0)
    v_fmac_f32 v199, -4.0, v195
    v_fma_f32 v195, v199, s26, v201
    v_mfma_f32_16x16x32_bf16 v[144:147], a[252:255], v[228:231], v[144:147]
    buffer_load_dwordx2 v[220:221], v227, s[4:7], s18 offen offset:704
    v_mfma_f32_16x16x32_bf16 v[148:151], v[240:243], v[228:231], v[148:151]
    v_fmac_f32 v201, s27, v199
    v_fma_f32 v199, v197, 2.0, v249
    v_fmac_f32 v249, -2.0, v197
    v_mfma_f32_16x16x32_bf16 v[148:151], a[244:247], v[236:239], v[148:151]
    v_cvt_pk_bf16_f32 v195, v248, v195
    v_cvt_pk_bf16_f32 v201, v251, v201
    v_mfma_f32_16x16x32_bf16 v[148:151], a[232:235], v[232:235], v[148:151]
    v_cvt_pk_bf16_f32 v199, v250, v199
    v_cvt_pk_bf16_f32 v197, v252, v249
    v_mfma_f32_16x16x32_bf16 v[152:155], a[236:239], v[232:235], v[152:155]
    ds_read_b128 v[232:235], v253 offset:32512
    v_lshrrev_b32 v252, 15, v255
    v_mfma_f32_16x16x32_bf16 v[152:155], a[248:251], v[236:239], v[152:155]
    buffer_load_dwordx2 v[222:223], v227, s[4:7], s19 offen offset:704
    v_mfma_f32_16x16x32_bf16 v[152:155], v[244:247], v[228:231], v[152:155]
    ds_write_b64 v252, v[194:195] offset:0
    v_mfma_f32_16x16x32_bf16 v[156:159], a[228:231], v[236:239], v[156:159]
    v_lshrrev_b32 v194, 15, v255
    v_mfma_f32_16x16x32_bf16 v[156:159], a[240:243], v[228:231], v[156:159]
    s_waitcnt lgkmcnt(1)
    s_waitcnt vmcnt(13)
    v_lshlrev_b32 v248, 16, v206
    v_mfma_f32_16x16x32_bf16 v[156:159], a[252:255], v[232:235], v[156:159]
    buffer_load_dwordx2 v[224:225], v227, s[4:7], s20 offen offset:704
    v_mfma_f32_16x16x32_bf16 v[160:163], v[240:243], v[232:235], v[160:163]
    ds_write_b64 v194, v[200:201] offset:2080
    v_mfma_f32_16x16x32_bf16 v[160:163], a[244:247], v[228:231], v[160:163]
    v_lshlrev_b32 v249, 16, v208
    v_lshlrev_b32 v250, 16, v210
    v_mfma_f32_16x16x32_bf16 v[160:163], a[232:235], v[236:239], v[160:163]
    ds_write_b64 v194, v[198:199] offset:4160
    v_mfma_f32_16x16x32_bf16 v[164:167], a[236:239], v[236:239], v[164:167]
    ds_read_b128 v[236:239], v253 offset:32256
    v_lshlrev_b32 v251, 16, v212
    v_mfma_f32_16x16x32_bf16 v[164:167], a[248:251], v[228:231], v[164:167]
    buffer_load_dwordx2 v[226:227], v227, s[4:7], s21 offen offset:704
    v_mfma_f32_16x16x32_bf16 v[164:167], v[244:247], v[232:235], v[164:167]
    ds_write_b64 v194, v[192:193] offset:20800
    v_mfma_f32_16x16x32_bf16 v[168:171], a[228:231], v[228:231], v[168:171]
    v_and_b32 v206, s22, v206
    v_and_b32 v208, s22, v208
    v_mfma_f32_16x16x32_bf16 v[168:171], a[240:243], v[232:235], v[168:171]
    s_waitcnt lgkmcnt(1)
    v_and_b32 v210, s22, v210
    v_and_b32 v212, s22, v212
    v_mfma_f32_16x16x32_bf16 v[168:171], a[252:255], v[236:239], v[168:171]
    ds_write_b64 v194, v[202:203] offset:29120
    v_mfma_f32_16x16x32_bf16 v[172:175], v[240:243], v[236:239], v[172:175]
    v_lshlrev_b32 v252, 16, v204
    v_and_b32 v204, s22, v204
    v_mfma_f32_16x16x32_bf16 v[172:175], a[244:247], v[232:235], v[172:175]
    ds_write_b64 v194, v[196:197] offset:6240
    v_mfma_f32_16x16x32_bf16 v[172:175], a[232:235], v[228:231], v[172:175]
    v_fmac_f32 v252, s25, v251
    v_fmac_f32 v204, s25, v212
    v_fmac_f32 v252, s28, v249
    v_mfma_f32_16x16x32_bf16 v[176:179], a[236:239], v[228:231], v[176:179]
    ds_read_b128 v[228:231], v253 offset:31984
    v_fmac_f32 v204, s28, v208
    v_mfma_f32_16x16x32_bf16 v[176:179], a[248:251], v[232:235], v[176:179]
    v_cvt_pk_bf16_f32 v204, v252, v204
    v_lshlrev_b32 v252, 16, v214
    v_mfma_f32_16x16x32_bf16 v[176:179], v[244:247], v[236:239], v[176:179]
    s_mov_b32 s42, 626688
    v_and_b32 v214, s22, v214
    v_fmac_f32 v252, s29, v248
    v_mfma_f32_16x16x32_bf16 v[180:183], a[228:231], v[232:235], v[180:183]
    s_waitcnt lgkmcnt(0)
    v_fmac_f32 v214, s29, v206
    v_fmac_f32 v252, s23, v250
    v_mfma_f32_16x16x32_bf16 v[184:187], a[232:235], v[232:235], v[184:187]
    s_barrier
    v_mfma_f32_16x16x32_bf16 v[188:191], a[236:239], v[232:235], v[188:191]
    ds_read_b128 v[232:235], v253 offset:1040
    v_fmac_f32 v214, s23, v210
    v_mfma_f32_16x16x32_bf16 v[188:191], a[248:251], v[236:239], v[188:191]
    buffer_load_dwordx4 a[228:231], v254, s[8:11], s42 offen offset:0 sc1
    v_mfma_f32_16x16x32_bf16 v[184:187], a[244:247], v[236:239], v[184:187]
    v_cvt_pk_bf16_f32 v214, v252, v214
    v_fma_f32 v252, v249, s24, v251
    v_mfma_f32_16x16x32_bf16 v[180:183], a[240:243], v[236:239], v[180:183]
    ds_read_b128 v[236:239], v253 offset:768
    v_fmac_f32 v251, -4.0, v249
    v_mfma_f32_16x16x32_bf16 v[180:183], a[252:255], v[228:231], v[180:183]
    buffer_load_dwordx4 a[232:235], v254, s[8:11], s42 offen offset:1024 sc1
    v_mfma_f32_16x16x32_bf16 v[184:187], v[240:243], v[228:231], v[184:187]
    s_waitcnt vmcnt(14) lgkmcnt(1)
    v_fma_f32 v249, v248, s24, v250
    v_fmac_f32 v250, -4.0, v248
    v_mfma_f32_16x16x32_bf16 v[188:191], v[244:247], v[228:231], v[188:191]
    ds_read_b128 v[228:231], v253 offset:512
    v_fma_f32 v248, v250, s26, v251
sub16:
    v_mfma_f32_16x16x32_bf16 a[0:3], a[192:195], v[232:235], a[0:3]
    buffer_load_dwordx4 a[236:239], v254, s[8:11], s42 offen offset:2048 sc1
    v_mfma_f32_16x16x32_bf16 a[4:7], a[196:199], v[232:235], a[4:7]
    s_mov_b32 s42, 629760
    v_fmac_f32 v251, s27, v250
    v_fma_f32 v250, v249, 2.0, v252
    v_mfma_f32_16x16x32_bf16 a[8:11], a[200:203], v[232:235], a[8:11]
    ds_read_b128 v[232:235], v253 offset:256
    s_waitcnt vmcnt(12)
    s_waitcnt lgkmcnt(2)
    v_mfma_f32_16x16x32_bf16 a[8:11], a[212:215], v[236:239], a[8:11]
    v_fmac_f32 v252, -2.0, v249
    v_fma_f32 v249, v208, s24, v212
    v_mfma_f32_16x16x32_bf16 a[4:7], a[208:211], v[236:239], a[4:7]
    buffer_load_dwordx4 a[240:243], v254, s[8:11], s42 offen offset:0 sc1
    v_mfma_f32_16x16x32_bf16 a[0:3], a[204:207], v[236:239], a[0:3]
    s_waitcnt vmcnt(10) lgkmcnt(1)
    v_fmac_f32 v212, -4.0, v208
    v_fma_f32 v208, v206, s24, v210
    v_mfma_f32_16x16x32_bf16 a[0:3], a[216:219], v[228:231], a[0:3]
    v_fmac_f32 v210, -4.0, v206
    v_fma_f32 v206, v210, s26, v212
    v_mfma_f32_16x16x32_bf16 a[4:7], a[220:223], v[228:231], a[4:7]
    v_fmac_f32 v212, s27, v210
    v_fma_f32 v210, v208, 2.0, v249
    v_fmac_f32 v249, -2.0, v208
    v_mfma_f32_16x16x32_bf16 a[8:11], a[224:227], v[228:231], a[8:11]
    buffer_load_dwordx4 a[244:247], v254, s[8:11], s42 offen offset:1024 sc1
    v_mfma_f32_16x16x32_bf16 a[12:15], a[192:195], v[236:239], a[12:15]
    v_cvt_pk_bf16_f32 v206, v248, v206
    v_cvt_pk_bf16_f32 v212, v251, v212
    v_mfma_f32_16x16x32_bf16 a[12:15], a[204:207], v[228:231], a[12:15]
    s_waitcnt lgkmcnt(0)
    v_cvt_pk_bf16_f32 v210, v250, v210
    v_cvt_pk_bf16_f32 v208, v252, v249
    v_mfma_f32_16x16x32_bf16 a[12:15], a[216:219], v[232:235], a[12:15]
    v_lshlrev_b32 v248, 16, v207
    v_lshlrev_b32 v249, 16, v209
    v_mfma_f32_16x16x32_bf16 a[16:19], a[220:223], v[232:235], a[16:19]
    buffer_load_dwordx4 a[248:251], v254, s[8:11], s42 offen offset:2048 sc1
    v_mfma_f32_16x16x32_bf16 a[16:19], a[208:211], v[228:231], a[16:19]
    s_mov_b32 s42, 632832
    v_lshlrev_b32 v250, 16, v211
    v_lshlrev_b32 v251, 16, v213
    v_mfma_f32_16x16x32_bf16 a[16:19], a[196:199], v[236:239], a[16:19]
    v_and_b32 v207, s22, v207
    v_and_b32 v209, s22, v209
    v_mfma_f32_16x16x32_bf16 a[20:23], a[200:203], v[236:239], a[20:23]
    ds_read_b128 v[236:239], v253 offset:0
    v_and_b32 v211, s22, v211
    v_mfma_f32_16x16x32_bf16 a[20:23], a[212:215], v[228:231], a[20:23]
    buffer_load_dwordx4 a[252:255], v254, s[8:11], s42 offen offset:0 sc1
    v_mfma_f32_16x16x32_bf16 a[20:23], a[224:227], v[232:235], a[20:23]
    v_and_b32 v213, s22, v213
    v_lshlrev_b32 v252, 16, v205
    v_mfma_f32_16x16x32_bf16 a[24:27], a[192:195], v[228:231], a[24:27]
    v_and_b32 v205, s22, v205
    v_fmac_f32 v252, s25, v251
    v_mfma_f32_16x16x32_bf16 a[24:27], a[204:207], v[232:235], a[24:27]
    s_waitcnt lgkmcnt(0)
    v_fmac_f32 v205, s25, v213
    v_fmac_f32 v252, s28, v249
    v_mfma_f32_16x16x32_bf16 a[24:27], a[216:219], v[236:239], a[24:27]
    v_fmac_f32 v205, s28, v209
    v_cvt_pk_bf16_f32 v205, v252, v205
    v_mfma_f32_16x16x32_bf16 a[28:31], a[220:223], v[236:239], a[28:31]
    buffer_load_dwordx4 v[240:243], v254, s[8:11], s42 offen offset:1024 sc1
    v_mfma_f32_16x16x32_bf16 a[28:31], a[208:211], v[232:235], a[28:31]
    v_lshlrev_b32 v252, 16, v215
    v_and_b32 v215, s22, v215
    v_mfma_f32_16x16x32_bf16 a[28:31], a[196:199], v[228:231], a[28:31]
    v_fmac_f32 v252, s29, v248
    v_fmac_f32 v215, s29, v207
    v_mfma_f32_16x16x32_bf16 a[32:35], a[200:203], v[228:231], a[32:35]
    ds_read_b128 v[228:231], v253 offset:1824
    v_fmac_f32 v252, s23, v250
    v_mfma_f32_16x16x32_bf16 a[32:35], a[212:215], v[232:235], a[32:35]
    buffer_load_dwordx4 v[244:247], v254, s[8:11], s42 offen offset:2048 sc1
    v_mfma_f32_16x16x32_bf16 a[32:35], a[224:227], v[236:239], a[32:35]
    v_fmac_f32 v215, s23, v211
    v_cvt_pk_bf16_f32 v215, v252, v215
    v_mfma_f32_16x16x32_bf16 a[36:39], a[192:195], v[232:235], a[36:39]
    v_and_b32 v203, 0x7fff, v255
    v_fma_f32 v252, v249, s24, v251
    v_fmac_f32 v251, -4.0, v249
    v_mfma_f32_16x16x32_bf16 a[36:39], a[204:207], v[236:239], a[36:39]
    s_waitcnt lgkmcnt(0)
    v_fma_f32 v249, v248, s24, v250
    v_fmac_f32 v250, -4.0, v248
    v_mfma_f32_16x16x32_bf16 a[36:39], a[216:219], v[228:231], a[36:39]
    buffer_load_dwordx2 v[192:193], v203, s[4:7], s16 offen offset:1088
    v_mfma_f32_16x16x32_bf16 a[40:43], a[220:223], v[228:231], a[40:43]
    v_fma_f32 v248, v250, s26, v251
    v_fmac_f32 v251, s27, v250
    v_mfma_f32_16x16x32_bf16 a[40:43], a[208:211], v[236:239], a[40:43]
    v_fma_f32 v250, v249, 2.0, v252
    v_fmac_f32 v252, -2.0, v249
    v_mfma_f32_16x16x32_bf16 a[40:43], a[196:199], v[232:235], a[40:43]
    v_fma_f32 v249, v209, s24, v213
    v_fmac_f32 v213, -4.0, v209
    v_mfma_f32_16x16x32_bf16 a[44:47], a[200:203], v[232:235], a[44:47]
    ds_read_b128 v[232:235], v253 offset:1568
    v_fma_f32 v209, v207, s24, v211
    v_mfma_f32_16x16x32_bf16 a[44:47], a[212:215], v[236:239], a[44:47]
    buffer_load_dwordx2 v[194:195], v203, s[4:7], s17 offen offset:1088
    v_mfma_f32_16x16x32_bf16 a[44:47], a[224:227], v[228:231], a[44:47]
    v_fmac_f32 v211, -4.0, v207
    v_fma_f32 v207, v211, s26, v213
    v_mfma_f32_16x16x32_bf16 a[48:51], a[192:195], v[236:239], a[48:51]
    v_fmac_f32 v213, s27, v211
    v_fma_f32 v211, v209, 2.0, v249
    v_mfma_f32_16x16x32_bf16 a[48:51], a[204:207], v[228:231], a[48:51]
    s_waitcnt lgkmcnt(0)
    v_fmac_f32 v249, -2.0, v209
    v_cvt_pk_bf16_f32 v207, v248, v207
    v_mfma_f32_16x16x32_bf16 a[48:51], a[216:219], v[232:235], a[48:51]
    buffer_load_dwordx2 v[196:197], v203, s[4:7], s18 offen offset:1088
    v_mfma_f32_16x16x32_bf16 a[52:55], a[220:223], v[232:235], a[52:55]
    v_cvt_pk_bf16_f32 v213, v251, v213
    v_cvt_pk_bf16_f32 v211, v250, v211
    v_mfma_f32_16x16x32_bf16 a[52:55], a[208:211], v[228:231], a[52:55]
    v_cvt_pk_bf16_f32 v209, v252, v249
    v_lshrrev_b32 v252, 15, v255
    v_mfma_f32_16x16x32_bf16 a[52:55], a[196:199], v[236:239], a[52:55]
    ds_write_b64 v252, v[206:207] offset:9088
    v_mfma_f32_16x16x32_bf16 a[56:59], a[200:203], v[236:239], a[56:59]
    ds_read_b128 v[236:239], v253 offset:1312
    v_lshrrev_b32 v206, 15, v255
    v_mfma_f32_16x16x32_bf16 a[56:59], a[212:215], v[228:231], a[56:59]
    buffer_load_dwordx2 v[198:199], v203, s[4:7], s19 offen offset:1088
    v_mfma_f32_16x16x32_bf16 a[56:59], a[224:227], v[232:235], a[56:59]
    ds_write_b64 v206, v[212:213] offset:11168
    v_mfma_f32_16x16x32_bf16 a[60:63], a[192:195], v[228:231], a[60:63]
    v_mfma_f32_16x16x32_bf16 a[60:63], a[204:207], v[232:235], a[60:63]
    s_waitcnt lgkmcnt(1)
    s_waitcnt vmcnt(13)
    v_lshlrev_b32 v248, 16, v218
    v_mfma_f32_16x16x32_bf16 a[60:63], a[216:219], v[236:239], a[60:63]
    buffer_load_dwordx2 v[200:201], v203, s[4:7], s20 offen offset:1088
    v_lshlrev_b32 v249, 16, v220
    v_mfma_f32_16x16x32_bf16 a[64:67], a[220:223], v[236:239], a[64:67]
    ds_write_b64 v206, v[210:211] offset:13248
    v_mfma_f32_16x16x32_bf16 a[64:67], a[208:211], v[232:235], a[64:67]
    v_lshlrev_b32 v250, 16, v222
    v_lshlrev_b32 v251, 16, v224
    v_mfma_f32_16x16x32_bf16 a[64:67], a[196:199], v[228:231], a[64:67]
    ds_write_b64 v206, v[204:205] offset:23648
    v_mfma_f32_16x16x32_bf16 a[68:71], a[200:203], v[228:231], a[68:71]
    ds_read_b128 v[228:231], v253 offset:1056
    v_and_b32 v218, s22, v218
    v_mfma_f32_16x16x32_bf16 a[68:71], a[212:215], v[232:235], a[68:71]
    buffer_load_dwordx2 v[202:203], v203, s[4:7], s21 offen offset:1088
    v_mfma_f32_16x16x32_bf16 a[68:71], a[224:227], v[236:239], a[68:71]
    ds_write_b64 v206, v[214:215] offset:31968
    v_mfma_f32_16x16x32_bf16 a[72:75], a[192:195], v[232:235], a[72:75]
    v_and_b32 v220, s22, v220
    v_and_b32 v222, s22, v222
    v_mfma_f32_16x16x32_bf16 a[72:75], a[204:207], v[236:239], a[72:75]
    s_waitcnt lgkmcnt(1)
    v_and_b32 v224, s22, v224
    v_lshlrev_b32 v252, 16, v216
    v_mfma_f32_16x16x32_bf16 a[72:75], a[216:219], v[228:231], a[72:75]
    v_and_b32 v216, s22, v216
    v_fmac_f32 v252, s25, v251
    v_mfma_f32_16x16x32_bf16 a[76:79], a[220:223], v[228:231], a[76:79]
    v_fmac_f32 v216, s25, v224
    v_fmac_f32 v252, s28, v249
    v_mfma_f32_16x16x32_bf16 a[76:79], a[208:211], v[236:239], a[76:79]
    v_fmac_f32 v216, s28, v220
    v_cvt_pk_bf16_f32 v216, v252, v216
    v_mfma_f32_16x16x32_bf16 a[76:79], a[196:199], v[232:235], a[76:79]
    v_lshlrev_b32 v252, 16, v226
    v_and_b32 v226, s22, v226
    v_mfma_f32_16x16x32_bf16 a[80:83], a[200:203], v[232:235], a[80:83]
    ds_read_b128 v[232:235], v253 offset:784
    v_fmac_f32 v252, s29, v248
    v_mfma_f32_16x16x32_bf16 a[80:83], a[212:215], v[236:239], a[80:83]
    v_fmac_f32 v226, s29, v218
    v_fmac_f32 v252, s23, v250
    v_mfma_f32_16x16x32_bf16 a[80:83], a[224:227], v[228:231], a[80:83]
    s_mov_b32 s42, 663552
    v_fmac_f32 v226, s23, v222
    v_cvt_pk_bf16_f32 v226, v252, v226
    v_mfma_f32_16x16x32_bf16 a[84:87], a[192:195], v[236:239], a[84:87]
    s_waitcnt lgkmcnt(0)
    v_fma_f32 v252, v249, s24, v251
    v_fmac_f32 v251, -4.0, v249
    v_mfma_f32_16x16x32_bf16 a[88:91], a[196:199], v[236:239], a[88:91]
    s_barrier
    v_mfma_f32_16x16x32_bf16 a[92:95], a[200:203], v[236:239], a[92:95]
    ds_read_b128 v[236:239], v253 offset:3120
    v_fma_f32 v249, v248, s24, v250
    v_mfma_f32_16x16x32_bf16 a[92:95], a[212:215], v[228:231], a[92:95]
    buffer_load_dwordx4 a[192:195], v254, s[8:11], s42 offen offset:0 sc1
    v_mfma_f32_16x16x32_bf16 a[88:91], a[208:211], v[228:231], a[88:91]
    v_fmac_f32 v250, -4.0, v248
    v_fma_f32 v248, v250, s26, v251
    v_fmac_f32 v251, s27, v250
    v_mfma_f32_16x16x32_bf16 a[84:87], a[204:207], v[228:231], a[84:87]
    ds_read_b128 v[228:231], v253 offset:2848
    v_fma_f32 v250, v249, 2.0, v252
    v_mfma_f32_16x16x32_bf16 a[84:87], a[216:219], v[232:235], a[84:87]
    buffer_load_dwordx4 a[196:199], v254, s[8:11], s42 offen offset:1024 sc1
    v_mfma_f32_16x16x32_bf16 a[88:91], a[220:223], v[232:235], a[88:91]
    s_waitcnt vmcnt(14) lgkmcnt(1)
    v_fmac_f32 v252, -2.0, v249
    v_fma_f32 v249, v220, s24, v224
    v_mfma_f32_16x16x32_bf16 a[92:95], a[224:227], v[232:235], a[92:95]
    ds_read_b128 v[232:235], v253 offset:2592
    v_fmac_f32 v224, -4.0, v220
sub17:
    v_mfma_f32_16x16x32_bf16 a[96:99], a[228:231], v[236:239], a[96:99]
    buffer_load_dwordx4 a[200:203], v254, s[8:11], s42 offen offset:2048 sc1
    v_mfma_f32_16x16x32_bf16 a[100:103], a[232:235], v[236:239], a[100:103]
    s_mov_b32 s42, 666624
    v_fma_f32 v220, v218, s24, v222
    v_fmac_f32 v222, -4.0, v218
    v_mfma_f32_16x16x32_bf16 a[104:107], a[236:239], v[236:239], a[104:107]
    ds_read_b128 v[236:239], v253 offset:2336
    s_waitcnt vmcnt(12)
    s_waitcnt lgkmcnt(2)
    v_mfma_f32_16x16x32_bf16 a[104:107], a[248:251], v[228:231], a[104:107]
    ds_write_b64 v206, v[208:209] offset:768
    v_mfma_f32_16x16x32_bf16 a[100:103], a[244:247], v[228:231], a[100:103]
    buffer_load_dwordx4 a[204:207], v254, s[8:11], s42 offen offset:0 sc1
    v_mfma_f32_16x16x32_bf16 a[96:99], a[240:243], v[228:231], a[96:99]
    s_waitcnt vmcnt(10) lgkmcnt(2)
    v_fma_f32 v218, v222, s26, v224
    v_fmac_f32 v224, s27, v222
    v_mfma_f32_16x16x32_bf16 a[96:99], a[252:255], v[232:235], a[96:99]
    v_fma_f32 v222, v220, 2.0, v249
    v_fmac_f32 v249, -2.0, v220
    v_mfma_f32_16x16x32_bf16 a[100:103], v[240:243], v[232:235], a[100:103]
    v_cvt_pk_bf16_f32 v218, v248, v218
    v_cvt_pk_bf16_f32 v224, v251, v224
    v_mfma_f32_16x16x32_bf16 a[104:107], v[244:247], v[232:235], a[104:107]
    buffer_load_dwordx4 a[208:211], v254, s[8:11], s42 offen offset:1024 sc1
    v_mfma_f32_16x16x32_bf16 a[108:111], a[228:231], v[228:231], a[108:111]
    v_cvt_pk_bf16_f32 v222, v250, v222
    v_cvt_pk_bf16_f32 v220, v252, v249
    v_mfma_f32_16x16x32_bf16 a[108:111], a[240:243], v[232:235], a[108:111]
    s_waitcnt lgkmcnt(1)
    v_lshlrev_b32 v248, 16, v219
    v_lshlrev_b32 v249, 16, v221
    v_mfma_f32_16x16x32_bf16 a[108:111], a[252:255], v[236:239], a[108:111]
    v_lshlrev_b32 v250, 16, v223
    v_lshlrev_b32 v251, 16, v225
    v_mfma_f32_16x16x32_bf16 a[112:115], v[240:243], v[236:239], a[112:115]
    buffer_load_dwordx4 a[212:215], v254, s[8:11], s42 offen offset:2048 sc1
    v_mfma_f32_16x16x32_bf16 a[112:115], a[244:247], v[232:235], a[112:115]
    s_mov_b32 s42, 669696
    v_and_b32 v219, s22, v219
    v_and_b32 v221, s22, v221
    v_mfma_f32_16x16x32_bf16 a[112:115], a[232:235], v[228:231], a[112:115]
    v_and_b32 v223, s22, v223
    v_and_b32 v225, s22, v225
    v_mfma_f32_16x16x32_bf16 a[116:119], a[236:239], v[228:231], a[116:119]
    ds_read_b128 v[228:231], v253 offset:2080
    v_lshlrev_b32 v252, 16, v217
    v_and_b32 v217, s22, v217
    v_mfma_f32_16x16x32_bf16 a[116:119], a[248:251], v[232:235], a[116:119]
    buffer_load_dwordx4 a[216:219], v254, s[8:11], s42 offen offset:0 sc1
    v_mfma_f32_16x16x32_bf16 a[116:119], v[244:247], v[236:239], a[116:119]
    v_fmac_f32 v252, s25, v251
    v_fmac_f32 v217, s25, v225
    v_mfma_f32_16x16x32_bf16 a[120:123], a[228:231], v[232:235], a[120:123]
    v_fmac_f32 v252, s28, v249
    v_fmac_f32 v217, s28, v221
    v_mfma_f32_16x16x32_bf16 a[120:123], a[240:243], v[236:239], a[120:123]
    s_waitcnt lgkmcnt(0)
    v_cvt_pk_bf16_f32 v217, v252, v217
    v_lshlrev_b32 v252, 16, v227
    v_mfma_f32_16x16x32_bf16 a[120:123], a[252:255], v[228:231], a[120:123]
    v_and_b32 v227, s22, v227
    v_fmac_f32 v252, s29, v248
    v_mfma_f32_16x16x32_bf16 a[124:127], v[240:243], v[228:231], a[124:127]
    buffer_load_dwordx4 a[220:223], v254, s[8:11], s42 offen offset:1024 sc1
    v_mfma_f32_16x16x32_bf16 a[124:127], a[244:247], v[236:239], a[124:127]
    v_fmac_f32 v227, s29, v219
    v_fmac_f32 v252, s23, v250
    v_mfma_f32_16x16x32_bf16 a[124:127], a[232:235], v[232:235], a[124:127]
    v_fmac_f32 v227, s23, v223
    v_cvt_pk_bf16_f32 v227, v252, v227
    v_mfma_f32_16x16x32_bf16 a[128:131], a[236:239], v[232:235], a[128:131]
    ds_read_b128 v[232:235], v253 offset:3904
    v_fma_f32 v252, v249, s24, v251
    v_mfma_f32_16x16x32_bf16 a[128:131], a[248:251], v[236:239], a[128:131]
    buffer_load_dwordx4 a[224:227], v254, s[8:11], s42 offen offset:2048 sc1
    v_mfma_f32_16x16x32_bf16 a[128:131], v[244:247], v[228:231], a[128:131]
    v_fmac_f32 v251, -4.0, v249
    v_fma_f32 v249, v248, s24, v250
    v_mfma_f32_16x16x32_bf16 a[132:135], a[228:231], v[236:239], a[132:135]
    v_and_b32 v215, 0x7fff, v255
    v_fmac_f32 v250, -4.0, v248
    v_mfma_f32_16x16x32_bf16 a[132:135], a[240:243], v[228:231], a[132:135]
    s_waitcnt lgkmcnt(0)
    v_fma_f32 v248, v250, s26, v251
    v_fmac_f32 v251, s27, v250
    v_mfma_f32_16x16x32_bf16 a[132:135], a[252:255], v[232:235], a[132:135]
    buffer_load_dwordx2 v[204:205], v215, s[4:7], s16 offen offset:1472
    v_mfma_f32_16x16x32_bf16 a[136:139], v[240:243], v[232:235], a[136:139]
    v_fma_f32 v250, v249, 2.0, v252
    v_fmac_f32 v252, -2.0, v249
    v_mfma_f32_16x16x32_bf16 a[136:139], a[244:247], v[228:231], a[136:139]
    v_fma_f32 v249, v221, s24, v225
    v_fmac_f32 v225, -4.0, v221
    v_mfma_f32_16x16x32_bf16 a[136:139], a[232:235], v[236:239], a[136:139]
    v_fma_f32 v221, v219, s24, v223
    v_fmac_f32 v223, -4.0, v219
    v_mfma_f32_16x16x32_bf16 a[140:143], a[236:239], v[236:239], a[140:143]
    ds_read_b128 v[236:239], v253 offset:3648
    v_fma_f32 v219, v223, s26, v225
    v_mfma_f32_16x16x32_bf16 a[140:143], a[248:251], v[228:231], a[140:143]
    buffer_load_dwordx2 v[206:207], v215, s[4:7], s17 offen offset:1472
    v_mfma_f32_16x16x32_bf16 a[140:143], v[244:247], v[232:235], a[140:143]
    v_fmac_f32 v225, s27, v223
    v_fma_f32 v223, v221, 2.0, v249
    v_fmac_f32 v249, -2.0, v221
    v_mfma_f32_16x16x32_bf16 a[144:147], a[228:231], v[228:231], a[144:147]
    v_cvt_pk_bf16_f32 v219, v248, v219
    v_cvt_pk_bf16_f32 v225, v251, v225
    v_mfma_f32_16x16x32_bf16 a[144:147], a[240:243], v[232:235], a[144:147]
    s_waitcnt lgkmcnt(0)
    v_cvt_pk_bf16_f32 v223, v250, v223
    v_cvt_pk_bf16_f32 v221, v252, v249
    v_mfma_f32_16x16x32_bf16 a[144:147], a[252:255], v[236:239], a[144:147]
    buffer_load_dwordx2 v[208:209], v215, s[4:7], s18 offen offset:1472
    v_mfma_f32_16x16x32_bf16 a[148:151], v[240:243], v[236:239], a[148:151]
    v_lshrrev_b32 v252, 15, v255
    v_mfma_f32_16x16x32_bf16 a[148:151], a[244:247], v[232:235], a[148:151]
    ds_write_b64 v252, v[218:219] offset:8832
    v_mfma_f32_16x16x32_bf16 a[148:151], a[232:235], v[228:231], a[148:151]
    v_lshrrev_b32 v218, 15, v255
    v_mfma_f32_16x16x32_bf16 a[152:155], a[236:239], v[228:231], a[152:155]
    ds_read_b128 v[228:231], v253 offset:3392
    v_mfma_f32_16x16x32_bf16 a[152:155], a[248:251], v[232:235], a[152:155]
pad6:
    s_cbranch_vccnz pad10
    buffer_load_dwordx2 v[210:211], v215, s[4:7], s19 offen offset:1472
    v_mfma_f32_16x16x32_bf16 a[152:155], v[244:247], v[236:239], a[152:155]
    ds_write_b64 v218, v[224:225] offset:10912
    v_mfma_f32_16x16x32_bf16 a[156:159], a[228:231], v[232:235], a[156:159]
    v_mfma_f32_16x16x32_bf16 a[156:159], a[240:243], v[236:239], a[156:159]
    s_waitcnt lgkmcnt(1)
    s_waitcnt vmcnt(13)
    v_lshlrev_b32 v248, 16, v194
    v_mfma_f32_16x16x32_bf16 a[156:159], a[252:255], v[228:231], a[156:159]
    buffer_load_dwordx2 v[212:213], v215, s[4:7], s20 offen offset:1472
    v_mfma_f32_16x16x32_bf16 a[160:163], v[240:243], v[228:231], a[160:163]
    ds_write_b64 v218, v[222:223] offset:12992
    v_mfma_f32_16x16x32_bf16 a[160:163], a[244:247], v[236:239], a[160:163]
    v_lshlrev_b32 v249, 16, v196
    v_lshlrev_b32 v250, 16, v198
    v_mfma_f32_16x16x32_bf16 a[160:163], a[232:235], v[232:235], a[160:163]
    ds_write_b64 v218, v[216:217] offset:23392
    v_mfma_f32_16x16x32_bf16 a[164:167], a[236:239], v[232:235], a[164:167]
    ds_read_b128 v[232:235], v253 offset:3136
    v_lshlrev_b32 v251, 16, v200
    v_mfma_f32_16x16x32_bf16 a[164:167], a[248:251], v[236:239], a[164:167]
    buffer_load_dwordx2 v[214:215], v215, s[4:7], s21 offen offset:1472
    v_mfma_f32_16x16x32_bf16 a[164:167], v[244:247], v[228:231], a[164:167]
    s_add_u32 s49, s49, 8
    v_and_b32 v194, s22, v194
    v_and_b32 v196, s22, v196
    v_mfma_f32_16x16x32_bf16 a[168:171], a[228:231], v[236:239], a[168:171]
    ds_write_b64 v218, v[226:227] offset:31712
    v_mfma_f32_16x16x32_bf16 a[168:171], a[240:243], v[228:231], a[168:171]
    s_waitcnt lgkmcnt(1)
    v_and_b32 v198, s22, v198
    v_and_b32 v200, s22, v200
    v_lshlrev_b32 v252, 16, v192
    v_mfma_f32_16x16x32_bf16 a[168:171], a[252:255], v[232:235], a[168:171]
    s_cmp_eq_u32 s39, 1
    s_cselect_b32 s49, 128, s49
    s_cselect_b32 s36, 2130706432, 0
    v_mfma_f32_16x16x32_bf16 a[172:175], v[240:243], v[232:235], a[172:175]
    ds_write_b64 v218, v[220:221] offset:512
    v_mfma_f32_16x16x32_bf16 a[172:175], a[244:247], v[228:231], a[172:175]
    ds_read_b128 v[216:219], v253 offset:40480
    s_mov_b32 s45, 503518347
    v_mfma_f32_16x16x32_bf16 a[172:175], a[232:235], v[236:239], a[172:175]
    s_mul_i32 s43, s49, 786432
    v_bfe_u32 v220, v254, 5, 3
    v_mul_u32_u24 v221, 5, v220
    v_mfma_f32_16x16x32_bf16 a[176:179], a[236:239], v[236:239], a[176:179]
    ds_read_b128 v[236:239], v253 offset:2864
    v_bfe_u32 v221, s45, v221, 5
    v_mfma_f32_16x16x32_bf16 a[176:179], a[248:251], v[228:231], a[176:179]
    v_mul_u32_u24 v221, 65, v221
    v_sub_u32 v221, v221, v220
    v_mfma_f32_16x16x32_bf16 a[176:179], v[244:247], v[232:235], a[176:179]
    s_mov_b32 s42, 700416
    v_lshl_add_u32 v220, v221, 5, v253
    s_waitcnt lgkmcnt(1)
    v_mfma_f32_16x16x32_bf16 a[180:183], a[228:231], v[228:231], a[180:183]
    s_add_u32 s43, s43, s53
    v_and_b32 v192, s22, v192
    v_fmac_f32 v252, s25, v251
    v_mfma_f32_16x16x32_bf16 a[184:187], a[232:235], v[228:231], a[184:187]
    s_mov_b64 exec, s[46:47]
    ds_write_b128 v220, v[216:219] offset:1024
    s_mov_b64 exec, -1
    v_mfma_f32_16x16x32_bf16 a[188:191], a[236:239], v[228:231], a[188:191]
    ds_read_b128 v[228:231], v253 offset:5200
    v_fmac_f32 v192, s25, v200
    v_mfma_f32_16x16x32_bf16 a[188:191], a[248:251], v[232:235], a[188:191]
    buffer_load_dwordx4 a[228:231], v254, s[8:11], s42 offen offset:0 sc1
    v_mfma_f32_16x16x32_bf16 a[184:187], a[244:247], v[232:235], a[184:187]
    s_waitcnt lgkmcnt(2)
    v_fmac_f32 v252, s28, v249
    v_fmac_f32 v192, s28, v196
    v_mfma_f32_16x16x32_bf16 a[180:183], a[240:243], v[232:235], a[180:183]
    ds_read_b128 v[232:235], v253 offset:4928
    v_cvt_pk_bf16_f32 v192, v252, v192
    v_mfma_f32_16x16x32_bf16 a[180:183], a[252:255], v[236:239], a[180:183]
    buffer_load_dwordx4 a[232:235], v254, s[8:11], s42 offen offset:1024 sc1
    v_mfma_f32_16x16x32_bf16 a[184:187], v[240:243], v[236:239], a[184:187]
    s_waitcnt vmcnt(14) lgkmcnt(1)
    v_lshlrev_b32 v252, 16, v202
    v_and_b32 v202, s22, v202
    v_mfma_f32_16x16x32_bf16 a[188:191], v[244:247], v[236:239], a[188:191]
    ds_read_b128 v[236:239], v253 offset:4672
    v_fmac_f32 v252, s29, v248
sub18:
    v_mfma_f32_16x16x32_bf16 v[0:3], a[192:195], v[228:231], v[0:3]
    buffer_load_dwordx4 a[236:239], v254, s[8:11], s42 offen offset:2048 sc1
    v_mfma_f32_16x16x32_bf16 v[4:7], a[196:199], v[228:231], v[4:7]
    s_mov_b32 s42, 703488
    v_fmac_f32 v202, s29, v194
    v_fmac_f32 v252, s23, v250
    v_mfma_f32_16x16x32_bf16 v[8:11], a[200:203], v[228:231], v[8:11]
    ds_read_b128 v[228:231], v253 offset:4416
    s_waitcnt vmcnt(12)
    s_waitcnt lgkmcnt(2)
    v_mfma_f32_16x16x32_bf16 v[8:11], a[212:215], v[232:235], v[8:11]
    s_cmp_ge_u32 s49, 128
    s_cselect_b32 s43, 2130706432, s43
    s_sub_u32 s16, s43, 196608
    v_fmac_f32 v202, s23, v198
    v_mfma_f32_16x16x32_bf16 v[4:7], a[208:211], v[232:235], v[4:7]
    buffer_load_dwordx4 a[240:243], v254, s[8:11], s42 offen offset:0 sc1
    v_mfma_f32_16x16x32_bf16 v[0:3], a[204:207], v[232:235], v[0:3]
    s_waitcnt vmcnt(10) lgkmcnt(1)
    v_cvt_pk_bf16_f32 v202, v252, v202
    v_fma_f32 v252, v249, s24, v251
    v_mfma_f32_16x16x32_bf16 v[0:3], a[216:219], v[236:239], v[0:3]
    s_cmp_eq_u32 s49, 0
    s_cselect_b32 s16, 2130706432, s16
    s_mov_b32 s17, s43
    v_mfma_f32_16x16x32_bf16 v[4:7], a[220:223], v[236:239], v[4:7]
    v_fmac_f32 v251, -4.0, v249
    v_fma_f32 v249, v248, s24, v250
    v_mfma_f32_16x16x32_bf16 v[8:11], a[224:227], v[236:239], v[8:11]
    buffer_load_dwordx4 a[244:247], v254, s[8:11], s42 offen offset:1024 sc1
    v_mfma_f32_16x16x32_bf16 v[12:15], a[192:195], v[232:235], v[12:15]
    s_add_u32 s18, s43, 196608
    v_fmac_f32 v250, -4.0, v248
    v_fma_f32 v248, v250, s26, v251
    v_mfma_f32_16x16x32_bf16 v[12:15], a[204:207], v[236:239], v[12:15]
    s_waitcnt lgkmcnt(0)
    v_fmac_f32 v251, s27, v250
    v_fma_f32 v250, v249, 2.0, v252
    v_mfma_f32_16x16x32_bf16 v[12:15], a[216:219], v[228:231], v[12:15]
    v_fmac_f32 v252, -2.0, v249
    v_fma_f32 v249, v196, s24, v200
    v_mfma_f32_16x16x32_bf16 v[16:19], a[220:223], v[228:231], v[16:19]
    buffer_load_dwordx4 a[248:251], v254, s[8:11], s42 offen offset:2048 sc1
    v_mfma_f32_16x16x32_bf16 v[16:19], a[208:211], v[236:239], v[16:19]
    s_mov_b32 s42, 706560
    s_add_u32 s19, s43, 393216
    v_fmac_f32 v200, -4.0, v196
    v_mfma_f32_16x16x32_bf16 v[16:19], a[196:199], v[232:235], v[16:19]
    v_fma_f32 v196, v194, s24, v198
    v_fmac_f32 v198, -4.0, v194
    v_mfma_f32_16x16x32_bf16 v[20:23], a[200:203], v[232:235], v[20:23]
    ds_read_b128 v[232:235], v253 offset:4160
    s_add_u32 s20, s43, 589824
    v_mfma_f32_16x16x32_bf16 v[20:23], a[212:215], v[236:239], v[20:23]
    buffer_load_dwordx4 a[252:255], v254, s[8:11], s42 offen offset:0 sc1
    v_mfma_f32_16x16x32_bf16 v[20:23], a[224:227], v[228:231], v[20:23]
    v_fma_f32 v194, v198, s26, v200
    v_fmac_f32 v200, s27, v198
    v_mfma_f32_16x16x32_bf16 v[24:27], a[192:195], v[236:239], v[24:27]
    v_fma_f32 v198, v196, 2.0, v249
    v_fmac_f32 v249, -2.0, v196
    v_mfma_f32_16x16x32_bf16 v[24:27], a[204:207], v[228:231], v[24:27]
    s_waitcnt lgkmcnt(0)
    s_add_u32 s21, s43, 786432
    v_cvt_pk_bf16_f32 v194, v248, v194
    v_mfma_f32_16x16x32_bf16 v[24:27], a[216:219], v[232:235], v[24:27]
    v_cvt_pk_bf16_f32 v200, v251, v200
    v_cvt_pk_bf16_f32 v198, v250, v198
    v_mfma_f32_16x16x32_bf16 v[28:31], a[220:223], v[232:235], v[28:31]
    buffer_load_dwordx4 v[240:243], v254, s[8:11], s42 offen offset:1024 sc1
    v_mfma_f32_16x16x32_bf16 v[28:31], a[208:211], v[228:231], v[28:31]
    s_add_u32 s100, s43, s101
    v_cvt_pk_bf16_f32 v196, v252, v249
    v_lshlrev_b32 v248, 16, v195
    v_mfma_f32_16x16x32_bf16 v[28:31], a[196:199], v[236:239], v[28:31]
    v_lshlrev_b32 v249, 16, v197
    v_lshlrev_b32 v250, 16, v199
    v_lshlrev_b32 v251, 16, v201
    v_mfma_f32_16x16x32_bf16 v[32:35], a[200:203], v[236:239], v[32:35]
    ds_read_b128 v[236:239], v253 offset:5984
    v_and_b32 v195, s22, v195
    v_mfma_f32_16x16x32_bf16 v[32:35], a[212:215], v[228:231], v[32:35]
    buffer_load_dwordx4 v[244:247], v254, s[8:11], s42 offen offset:2048 sc1
    v_mfma_f32_16x16x32_bf16 v[32:35], a[224:227], v[232:235], v[32:35]
    v_and_b32 v197, s22, v197
    v_and_b32 v199, s22, v199
    v_mfma_f32_16x16x32_bf16 v[36:39], a[192:195], v[228:231], v[36:39]
    v_and_b32 v224, 0x1f0, v254
    v_mul_u32_u24 v224, 96, v224
    v_mfma_f32_16x16x32_bf16 v[36:39], a[204:207], v[232:235], v[36:39]
    s_waitcnt lgkmcnt(0)
    v_and_b32 v201, s22, v201
    v_lshlrev_b32 v252, 16, v193
    v_mfma_f32_16x16x32_bf16 v[36:39], a[216:219], v[236:239], v[36:39]
    buffer_load_dword v224, v224, s[4:7], s100 offen offset:0
    v_mfma_f32_16x16x32_bf16 v[40:43], a[220:223], v[236:239], v[40:43]
    v_and_b32 v227, 0xf0, v254
    v_lshrrev_b32 v227, 1, v227
    v_mfma_f32_16x16x32_bf16 v[40:43], a[208:211], v[232:235], v[40:43]
    v_add_u32 v227, s52, v227
    v_mov_b32 v226, s54
    v_mfma_f32_16x16x32_bf16 v[40:43], a[196:199], v[228:231], v[40:43]
    v_mov_b32 v225, s55
    v_cndmask_b32 v226, v226, v225, s[56:57]
    v_mfma_f32_16x16x32_bf16 v[44:47], a[200:203], v[228:231], v[44:47]
    ds_read_b128 v[228:231], v253 offset:5728
    v_add_u32 v227, v227, v226
    v_mfma_f32_16x16x32_bf16 v[44:47], a[212:215], v[232:235], v[44:47]
    s_sub_u32 s45, s16, s50
    v_and_b32 v193, s22, v193
    v_fmac_f32 v252, s25, v251
    v_mfma_f32_16x16x32_bf16 v[44:47], a[224:227], v[236:239], v[44:47]
    buffer_load_dwordx2 v[216:217], v227, s[4:7], s45 offen
    v_mfma_f32_16x16x32_bf16 v[48:51], a[192:195], v[232:235], v[48:51]
    s_sub_u32 s45, s17, s50
    v_fmac_f32 v193, s25, v201
    v_fmac_f32 v252, s28, v249
    v_mfma_f32_16x16x32_bf16 v[48:51], a[204:207], v[236:239], v[48:51]
    s_waitcnt lgkmcnt(0)
    v_fmac_f32 v193, s28, v197
    v_cvt_pk_bf16_f32 v193, v252, v193
    v_mfma_f32_16x16x32_bf16 v[48:51], a[216:219], v[228:231], v[48:51]
    v_lshlrev_b32 v252, 16, v203
    v_and_b32 v203, s22, v203
    v_mfma_f32_16x16x32_bf16 v[52:55], a[220:223], v[228:231], v[52:55]
    buffer_load_dwordx2 v[218:219], v227, s[4:7], s45 offen
    v_mfma_f32_16x16x32_bf16 v[52:55], a[208:211], v[236:239], v[52:55]
    s_sub_u32 s45, s18, s50
    v_fmac_f32 v252, s29, v248
    v_fmac_f32 v203, s29, v195
    v_mfma_f32_16x16x32_bf16 v[52:55], a[196:199], v[232:235], v[52:55]
    v_fmac_f32 v252, s23, v250
    v_fmac_f32 v203, s23, v199
    v_mfma_f32_16x16x32_bf16 v[56:59], a[200:203], v[232:235], v[56:59]
    ds_read_b128 v[232:235], v253 offset:5472
    v_cvt_pk_bf16_f32 v203, v252, v203
    v_mfma_f32_16x16x32_bf16 v[56:59], a[212:215], v[236:239], v[56:59]
    buffer_load_dwordx2 v[220:221], v227, s[4:7], s45 offen
    v_fma_f32 v252, v249, s24, v251
    v_mfma_f32_16x16x32_bf16 v[56:59], a[224:227], v[228:231], v[56:59]
    s_sub_u32 s45, s19, s50
    v_fmac_f32 v251, -4.0, v249
    v_fma_f32 v249, v248, s24, v250
    v_mfma_f32_16x16x32_bf16 v[60:63], a[192:195], v[236:239], v[60:63]
    v_fmac_f32 v250, -4.0, v248
    v_fma_f32 v248, v250, s26, v251
    v_mfma_f32_16x16x32_bf16 v[60:63], a[204:207], v[228:231], v[60:63]
    s_waitcnt lgkmcnt(0)
    v_fmac_f32 v251, s27, v250
    v_fma_f32 v250, v249, 2.0, v252
    v_mfma_f32_16x16x32_bf16 v[60:63], a[216:219], v[232:235], v[60:63]
    buffer_load_dwordx2 v[222:223], v227, s[4:7], s45 offen
    v_mfma_f32_16x16x32_bf16 v[64:67], a[220:223], v[232:235], v[64:67]
    s_sub_u32 s45, s20, s50
    v_fmac_f32 v252, -2.0, v249
    v_fma_f32 v249, v197, s24, v201
    v_mfma_f32_16x16x32_bf16 v[64:67], a[208:211], v[228:231], v[64:67]
    v_fmac_f32 v201, -4.0, v197
    v_fma_f32 v197, v195, s24, v199
    v_mfma_f32_16x16x32_bf16 v[64:67], a[196:199], v[236:239], v[64:67]
    v_fmac_f32 v199, -4.0, v195
    v_fma_f32 v195, v199, s26, v201
    v_mfma_f32_16x16x32_bf16 v[68:71], a[200:203], v[236:239], v[68:71]
    ds_read_b128 v[236:239], v253 offset:5216
    v_fmac_f32 v201, s27, v199
    v_mfma_f32_16x16x32_bf16 v[68:71], a[212:215], v[228:231], v[68:71]
    buffer_load_dwordx2 v[224:225], v227, s[4:7], s45 offen
    v_mfma_f32_16x16x32_bf16 v[68:71], a[224:227], v[232:235], v[68:71]
    s_sub_u32 s45, s21, s50
    v_fma_f32 v199, v197, 2.0, v249
    v_fmac_f32 v249, -2.0, v197
    v_mfma_f32_16x16x32_bf16 v[72:75], a[192:195], v[228:231], v[72:75]
    v_cvt_pk_bf16_f32 v195, v248, v195
    v_cvt_pk_bf16_f32 v201, v251, v201
    v_mfma_f32_16x16x32_bf16 v[72:75], a[204:207], v[232:235], v[72:75]
    s_waitcnt lgkmcnt(0)
    v_cvt_pk_bf16_f32 v199, v250, v199
    v_cvt_pk_bf16_f32 v197, v252, v249
    v_mfma_f32_16x16x32_bf16 v[72:75], a[216:219], v[236:239], v[72:75]
    buffer_load_dwordx2 v[226:227], v227, s[4:7], s45 offen
    v_mfma_f32_16x16x32_bf16 v[76:79], a[220:223], v[236:239], v[76:79]
    v_lshrrev_b32 v252, 15, v255
    v_mfma_f32_16x16x32_bf16 v[76:79], a[208:211], v[232:235], v[76:79]
    ds_write_b64 v252, v[194:195] offset:8576
    v_mfma_f32_16x16x32_bf16 v[76:79], a[196:199], v[228:231], v[76:79]
    s_waitcnt vmcnt(16)
    v_lshrrev_b32 v194, 15, v255
    v_lshlrev_b32 v248, 16, v206
    v_mfma_f32_16x16x32_bf16 v[80:83], a[200:203], v[228:231], v[80:83]
    ds_read_b128 v[228:231], v253 offset:4944
    v_lshlrev_b32 v249, 16, v208
    v_mfma_f32_16x16x32_bf16 v[80:83], a[212:215], v[232:235], v[80:83]
    ds_write_b64 v194, v[200:201] offset:10656
    v_mfma_f32_16x16x32_bf16 v[80:83], a[224:227], v[236:239], v[80:83]
    s_mov_b32 s42, 737280
    v_lshlrev_b32 v250, 16, v210
    v_lshlrev_b32 v251, 16, v212
    v_mfma_f32_16x16x32_bf16 v[84:87], a[192:195], v[232:235], v[84:87]
    ds_write_b64 v194, v[198:199] offset:12736
    v_and_b32 v206, s22, v206
    v_mfma_f32_16x16x32_bf16 v[88:91], a[196:199], v[232:235], v[88:91]
    v_and_b32 v208, s22, v208
    v_and_b32 v210, s22, v210
    v_mfma_f32_16x16x32_bf16 v[92:95], a[200:203], v[232:235], v[92:95]
    ds_read_b128 v[232:235], v253 offset:7280
    v_and_b32 v212, s22, v212
    v_mfma_f32_16x16x32_bf16 v[92:95], a[212:215], v[236:239], v[92:95]
    buffer_load_dwordx4 a[192:195], v254, s[8:11], s42 offen offset:0 sc1
    v_mfma_f32_16x16x32_bf16 v[88:91], a[208:211], v[236:239], v[88:91]
    s_waitcnt lgkmcnt(3)
    v_lshlrev_b32 v252, 16, v204
    v_and_b32 v204, s22, v204
    v_mfma_f32_16x16x32_bf16 v[84:87], a[204:207], v[236:239], v[84:87]
    ds_read_b128 v[236:239], v253 offset:7008
    v_fmac_f32 v252, s25, v251
    v_mfma_f32_16x16x32_bf16 v[84:87], a[216:219], v[228:231], v[84:87]
    buffer_load_dwordx4 a[196:199], v254, s[8:11], s42 offen offset:1024 sc1
    v_mfma_f32_16x16x32_bf16 v[88:91], a[220:223], v[228:231], v[88:91]
    s_waitcnt vmcnt(15) lgkmcnt(1)
    v_fmac_f32 v204, s25, v212
    v_fmac_f32 v252, s28, v249
    v_mfma_f32_16x16x32_bf16 v[92:95], a[224:227], v[228:231], v[92:95]
    ds_read_b128 v[228:231], v253 offset:6752
    v_fmac_f32 v204, s28, v208
sub19:
    v_mfma_f32_16x16x32_bf16 v[96:99], a[228:231], v[232:235], v[96:99]
    buffer_load_dwordx4 a[200:203], v254, s[8:11], s42 offen offset:2048 sc1
    v_mfma_f32_16x16x32_bf16 v[100:103], a[232:235], v[232:235], v[100:103]
    s_mov_b32 s42, 740352
    v_cvt_pk_bf16_f32 v204, v252, v204
    v_lshlrev_b32 v252, 16, v214
    v_mfma_f32_16x16x32_bf16 v[104:107], a[236:239], v[232:235], v[104:107]
    ds_read_b128 v[232:235], v253 offset:6496
    s_waitcnt vmcnt(13)
    s_waitcnt lgkmcnt(2)
    v_mfma_f32_16x16x32_bf16 v[104:107], a[248:251], v[236:239], v[104:107]
    ds_write_b64 v194, v[192:193] offset:23136
    v_mfma_f32_16x16x32_bf16 v[100:103], a[244:247], v[236:239], v[100:103]
    buffer_load_dwordx4 a[204:207], v254, s[8:11], s42 offen offset:0 sc1
    v_mfma_f32_16x16x32_bf16 v[96:99], a[240:243], v[236:239], v[96:99]
    s_waitcnt vmcnt(11) lgkmcnt(2)
    v_and_b32 v214, s22, v214
    v_fmac_f32 v252, s29, v248
    v_mfma_f32_16x16x32_bf16 v[96:99], a[252:255], v[228:231], v[96:99]
    ds_write_b64 v194, v[202:203] offset:31456
    v_mfma_f32_16x16x32_bf16 v[100:103], v[240:243], v[228:231], v[100:103]
    v_fmac_f32 v214, s29, v206
    v_fmac_f32 v252, s23, v250
    v_mfma_f32_16x16x32_bf16 v[104:107], v[244:247], v[228:231], v[104:107]
    buffer_load_dwordx4 a[208:211], v254, s[8:11], s42 offen offset:1024 sc1
    v_mfma_f32_16x16x32_bf16 v[108:111], a[228:231], v[236:239], v[108:111]
    ds_write_b64 v194, v[196:197] offset:256
    v_mfma_f32_16x16x32_bf16 v[108:111], a[240:243], v[228:231], v[108:111]
    s_waitcnt lgkmcnt(3)
    v_fmac_f32 v214, s23, v210
    v_cvt_pk_bf16_f32 v214, v252, v214
    v_mfma_f32_16x16x32_bf16 v[108:111], a[252:255], v[232:235], v[108:111]
    v_fma_f32 v252, v249, s24, v251
    v_fmac_f32 v251, -4.0, v249
    v_fma_f32 v249, v248, s24, v250
    v_mfma_f32_16x16x32_bf16 v[112:115], v[240:243], v[232:235], v[112:115]
    buffer_load_dwordx4 a[212:215], v254, s[8:11], s42 offen offset:2048 sc1
    v_mfma_f32_16x16x32_bf16 v[112:115], a[244:247], v[228:231], v[112:115]
    s_mov_b32 s42, 743424
    v_fmac_f32 v250, -4.0, v248
    v_fma_f32 v248, v250, s26, v251
    v_mfma_f32_16x16x32_bf16 v[112:115], a[232:235], v[236:239], v[112:115]
    v_fmac_f32 v251, s27, v250
    v_fma_f32 v250, v249, 2.0, v252
    v_mfma_f32_16x16x32_bf16 v[116:119], a[236:239], v[236:239], v[116:119]
    ds_read_b128 v[236:239], v253 offset:6240
    v_fmac_f32 v252, -2.0, v249
    v_mfma_f32_16x16x32_bf16 v[116:119], a[248:251], v[228:231], v[116:119]
    buffer_load_dwordx4 a[216:219], v254, s[8:11], s42 offen offset:0 sc1
    v_mfma_f32_16x16x32_bf16 v[116:119], v[244:247], v[232:235], v[116:119]
    v_fma_f32 v249, v208, s24, v212
    v_fmac_f32 v212, -4.0, v208
    v_mfma_f32_16x16x32_bf16 v[120:123], a[228:231], v[228:231], v[120:123]
    v_fma_f32 v208, v206, s24, v210
    v_fmac_f32 v210, -4.0, v206
    v_mfma_f32_16x16x32_bf16 v[120:123], a[240:243], v[232:235], v[120:123]
    s_waitcnt lgkmcnt(0)
    v_fma_f32 v206, v210, s26, v212
    v_fmac_f32 v212, s27, v210
    v_mfma_f32_16x16x32_bf16 v[120:123], a[252:255], v[236:239], v[120:123]
    v_fma_f32 v210, v208, 2.0, v249
    v_fmac_f32 v249, -2.0, v208
    v_mfma_f32_16x16x32_bf16 v[124:127], v[240:243], v[236:239], v[124:127]
    buffer_load_dwordx4 a[220:223], v254, s[8:11], s42 offen offset:1024 sc1
    v_mfma_f32_16x16x32_bf16 v[124:127], a[244:247], v[232:235], v[124:127]
    v_cvt_pk_bf16_f32 v206, v248, v206
    v_cvt_pk_bf16_f32 v212, v251, v212
    v_mfma_f32_16x16x32_bf16 v[124:127], a[232:235], v[228:231], v[124:127]
    v_cvt_pk_bf16_f32 v210, v250, v210
    v_cvt_pk_bf16_f32 v208, v252, v249
    v_mfma_f32_16x16x32_bf16 v[128:131], a[236:239], v[228:231], v[128:131]
    ds_read_b128 v[228:231], v253 offset:8064
    v_lshlrev_b32 v248, 16, v207
    v_mfma_f32_16x16x32_bf16 v[128:131], a[248:251], v[232:235], v[128:131]
    buffer_load_dwordx4 a[224:227], v254, s[8:11], s42 offen offset:2048 sc1
    v_mfma_f32_16x16x32_bf16 v[128:131], v[244:247], v[236:239], v[128:131]
    v_lshlrev_b32 v249, 16, v209
    v_lshlrev_b32 v250, 16, v211
    v_mfma_f32_16x16x32_bf16 v[132:135], a[228:231], v[232:235], v[132:135]
    v_lshlrev_b32 v251, 16, v213
    v_and_b32 v207, s22, v207
    v_mfma_f32_16x16x32_bf16 v[132:135], a[240:243], v[236:239], v[132:135]
    s_waitcnt lgkmcnt(0)
    v_and_b32 v209, s22, v209
    v_and_b32 v211, s22, v211
    v_mfma_f32_16x16x32_bf16 v[132:135], a[252:255], v[228:231], v[132:135]
    v_and_b32 v213, s22, v213
    v_lshlrev_b32 v252, 16, v205
    v_mfma_f32_16x16x32_bf16 v[136:139], v[240:243], v[228:231], v[136:139]
    v_and_b32 v205, s22, v205
    v_fmac_f32 v252, s25, v251
    v_mfma_f32_16x16x32_bf16 v[136:139], a[244:247], v[236:239], v[136:139]
    v_fmac_f32 v205, s25, v213
    v_fmac_f32 v252, s28, v249
    v_fmac_f32 v205, s28, v209
    v_mfma_f32_16x16x32_bf16 v[136:139], a[232:235], v[232:235], v[136:139]
    v_cvt_pk_bf16_f32 v205, v252, v205
    v_lshlrev_b32 v252, 16, v215
    v_mfma_f32_16x16x32_bf16 v[140:143], a[236:239], v[232:235], v[140:143]
    ds_read_b128 v[232:235], v253 offset:7808
    v_and_b32 v215, s22, v215
    v_mfma_f32_16x16x32_bf16 v[140:143], a[248:251], v[236:239], v[140:143]
    v_fmac_f32 v252, s29, v248
    v_fmac_f32 v215, s29, v207
    v_mfma_f32_16x16x32_bf16 v[140:143], v[244:247], v[228:231], v[140:143]
    v_fmac_f32 v252, s23, v250
    v_fmac_f32 v215, s23, v211
    v_mfma_f32_16x16x32_bf16 v[144:147], a[228:231], v[236:239], v[144:147]
    v_cvt_pk_bf16_f32 v215, v252, v215
    v_fma_f32 v252, v249, s24, v251
    v_mfma_f32_16x16x32_bf16 v[144:147], a[240:243], v[228:231], v[144:147]
    s_waitcnt lgkmcnt(0)
    v_fmac_f32 v251, -4.0, v249
    v_fma_f32 v249, v248, s24, v250
    v_mfma_f32_16x16x32_bf16 v[144:147], a[252:255], v[232:235], v[144:147]
    v_fmac_f32 v250, -4.0, v248
    v_fma_f32 v248, v250, s26, v251
    v_mfma_f32_16x16x32_bf16 v[148:151], v[240:243], v[232:235], v[148:151]
    v_fmac_f32 v251, s27, v250
    v_fma_f32 v250, v249, 2.0, v252
    v_mfma_f32_16x16x32_bf16 v[148:151], a[244:247], v[228:231], v[148:151]
    v_fmac_f32 v252, -2.0, v249
    v_fma_f32 v249, v209, s24, v213
    v_mfma_f32_16x16x32_bf16 v[148:151], a[232:235], v[236:239], v[148:151]
    v_fmac_f32 v213, -4.0, v209
    v_fma_f32 v209, v207, s24, v211
    v_mfma_f32_16x16x32_bf16 v[152:155], a[236:239], v[236:239], v[152:155]
    ds_read_b128 v[236:239], v253 offset:7552
    v_fmac_f32 v211, -4.0, v207
    v_mfma_f32_16x16x32_bf16 v[152:155], a[248:251], v[228:231], v[152:155]
    v_fma_f32 v207, v211, s26, v213
    v_fmac_f32 v213, s27, v211
    v_mfma_f32_16x16x32_bf16 v[152:155], v[244:247], v[232:235], v[152:155]
    v_fma_f32 v211, v209, 2.0, v249
    v_fmac_f32 v249, -2.0, v209
    v_mfma_f32_16x16x32_bf16 v[156:159], a[228:231], v[228:231], v[156:159]
    v_cvt_pk_bf16_f32 v207, v248, v207
    v_cvt_pk_bf16_f32 v213, v251, v213
    v_mfma_f32_16x16x32_bf16 v[156:159], a[240:243], v[232:235], v[156:159]
    s_waitcnt lgkmcnt(0)
    v_cvt_pk_bf16_f32 v211, v250, v211
    v_cvt_pk_bf16_f32 v209, v252, v249
    v_mfma_f32_16x16x32_bf16 v[156:159], a[252:255], v[236:239], v[156:159]
    v_lshrrev_b32 v252, 15, v255
    v_mfma_f32_16x16x32_bf16 v[160:163], v[240:243], v[236:239], v[160:163]
    ds_write_b64 v252, v[206:207] offset:8320
    v_mfma_f32_16x16x32_bf16 v[160:163], a[244:247], v[232:235], v[160:163]
    v_lshrrev_b32 v206, 15, v255
    v_mfma_f32_16x16x32_bf16 v[160:163], a[232:235], v[228:231], v[160:163]
    ds_write_b64 v206, v[212:213] offset:10400
    v_mfma_f32_16x16x32_bf16 v[164:167], a[236:239], v[228:231], v[164:167]
    ds_read_b128 v[228:231], v253 offset:7296
    s_waitcnt vmcnt(9)
    v_mfma_f32_16x16x32_bf16 v[164:167], a[248:251], v[232:235], v[164:167]
    ds_write_b64 v206, v[210:211] offset:12480
    v_mfma_f32_16x16x32_bf16 v[164:167], v[244:247], v[236:239], v[164:167]
    v_lshlrev_b32 v248, 16, v218
    v_lshlrev_b32 v249, 16, v220
    v_mfma_f32_16x16x32_bf16 v[168:171], a[228:231], v[232:235], v[168:171]
    ds_write_b64 v206, v[204:205] offset:22880
    v_mfma_f32_16x16x32_bf16 v[168:171], a[240:243], v[236:239], v[168:171]
    s_waitcnt lgkmcnt(2)
    v_lshlrev_b32 v250, 16, v222
    v_lshlrev_b32 v251, 16, v224
    v_mfma_f32_16x16x32_bf16 v[168:171], a[252:255], v[228:231], v[168:171]
    ds_write_b64 v206, v[214:215] offset:31200
    v_mfma_f32_16x16x32_bf16 v[172:175], v[240:243], v[228:231], v[172:175]
    v_and_b32 v218, s22, v218
    v_and_b32 v220, s22, v220
    v_mfma_f32_16x16x32_bf16 v[172:175], a[244:247], v[236:239], v[172:175]
    ds_write_b64 v206, v[208:209] offset:0
    v_mfma_f32_16x16x32_bf16 v[172:175], a[232:235], v[232:235], v[172:175]
    v_and_b32 v222, s22, v222
    v_and_b32 v224, s22, v224
    v_mfma_f32_16x16x32_bf16 v[176:179], a[236:239], v[232:235], v[176:179]
    ds_read_b128 v[232:235], v253 offset:7024
    v_lshlrev_b32 v252, 16, v216
    v_mfma_f32_16x16x32_bf16 v[176:179], a[248:251], v[236:239], v[176:179]
    v_and_b32 v216, s22, v216
    v_fmac_f32 v252, s25, v251
    v_mfma_f32_16x16x32_bf16 v[176:179], v[244:247], v[228:231], v[176:179]
    s_mov_b32 s42, 774144
    v_fmac_f32 v216, s25, v224
    v_fmac_f32 v252, s28, v249
    v_mfma_f32_16x16x32_bf16 v[180:183], a[228:231], v[236:239], v[180:183]
    s_waitcnt lgkmcnt(0)
    v_fmac_f32 v216, s28, v220
    v_cvt_pk_bf16_f32 v216, v252, v216
    v_mfma_f32_16x16x32_bf16 v[184:187], a[232:235], v[236:239], v[184:187]
    s_barrier
    v_mfma_f32_16x16x32_bf16 v[188:191], a[236:239], v[236:239], v[188:191]
    ds_read_b128 v[236:239], v253 offset:9360
    v_lshlrev_b32 v252, 16, v226
    v_mfma_f32_16x16x32_bf16 v[188:191], a[248:251], v[228:231], v[188:191]
    buffer_load_dwordx4 a[228:231], v254, s[8:11], s42 offen offset:0 sc1
    v_mfma_f32_16x16x32_bf16 v[184:187], a[244:247], v[228:231], v[184:187]
    v_and_b32 v226, s22, v226
    v_fmac_f32 v252, s29, v248
    v_mfma_f32_16x16x32_bf16 v[180:183], a[240:243], v[228:231], v[180:183]
    ds_read_b128 v[228:231], v253 offset:9088
    v_fmac_f32 v226, s29, v218
    v_mfma_f32_16x16x32_bf16 v[180:183], a[252:255], v[232:235], v[180:183]
    buffer_load_dwordx4 a[232:235], v254, s[8:11], s42 offen offset:1024 sc1
    v_mfma_f32_16x16x32_bf16 v[184:187], v[240:243], v[232:235], v[184:187]
    s_waitcnt vmcnt(8) lgkmcnt(1)
    v_fmac_f32 v252, s23, v250
    v_fmac_f32 v226, s23, v222
    v_mfma_f32_16x16x32_bf16 v[188:191], v[244:247], v[232:235], v[188:191]
    ds_read_b128 v[232:235], v253 offset:8832
    v_cvt_pk_bf16_f32 v226, v252, v226
sub20:
    v_mfma_f32_16x16x32_bf16 a[0:3], a[192:195], v[236:239], a[0:3]
    buffer_load_dwordx4 a[236:239], v254, s[8:11], s42 offen offset:2048 sc1
    v_mfma_f32_16x16x32_bf16 a[4:7], a[196:199], v[236:239], a[4:7]
    s_mov_b32 s42, 777216
    v_fma_f32 v252, v249, s24, v251
    v_fmac_f32 v251, -4.0, v249
    v_mfma_f32_16x16x32_bf16 a[8:11], a[200:203], v[236:239], a[8:11]
    ds_read_b128 v[236:239], v253 offset:8576
    s_waitcnt vmcnt(6)
    s_waitcnt lgkmcnt(2)
    v_mfma_f32_16x16x32_bf16 a[8:11], a[212:215], v[228:231], a[8:11]
    v_fma_f32 v249, v248, s24, v250
    v_fmac_f32 v250, -4.0, v248
    v_mfma_f32_16x16x32_bf16 a[4:7], a[208:211], v[228:231], a[4:7]
    buffer_load_dwordx4 a[240:243], v254, s[8:11], s42 offen offset:0 sc1
    v_mfma_f32_16x16x32_bf16 a[0:3], a[204:207], v[228:231], a[0:3]
    s_waitcnt vmcnt(4) lgkmcnt(1)
    v_fma_f32 v248, v250, s26, v251
    v_fmac_f32 v251, s27, v250
    v_mfma_f32_16x16x32_bf16 a[0:3], a[216:219], v[232:235], a[0:3]
    v_fma_f32 v250, v249, 2.0, v252
    v_fmac_f32 v252, -2.0, v249
    v_mfma_f32_16x16x32_bf16 a[4:7], a[220:223], v[232:235], a[4:7]
    v_fma_f32 v249, v220, s24, v224
    v_fmac_f32 v224, -4.0, v220
    v_mfma_f32_16x16x32_bf16 a[8:11], a[224:227], v[232:235], a[8:11]
    buffer_load_dwordx4 a[244:247], v254, s[8:11], s42 offen offset:1024 sc1
    v_mfma_f32_16x16x32_bf16 a[12:15], a[192:195], v[228:231], a[12:15]
    v_fma_f32 v220, v218, s24, v222
    v_fmac_f32 v222, -4.0, v218
    v_mfma_f32_16x16x32_bf16 a[12:15], a[204:207], v[232:235], a[12:15]
    s_waitcnt lgkmcnt(0)
    v_fma_f32 v218, v222, s26, v224
    v_fmac_f32 v224, s27, v222
    v_mfma_f32_16x16x32_bf16 a[12:15], a[216:219], v[236:239], a[12:15]
    v_fma_f32 v222, v220, 2.0, v249
    v_fmac_f32 v249, -2.0, v220
    v_mfma_f32_16x16x32_bf16 a[16:19], a[220:223], v[236:239], a[16:19]
    buffer_load_dwordx4 a[248:251], v254, s[8:11], s42 offen offset:2048 sc1
    v_mfma_f32_16x16x32_bf16 a[16:19], a[208:211], v[232:235], a[16:19]
    s_mov_b32 s42, 780288
    v_cvt_pk_bf16_f32 v218, v248, v218
    v_cvt_pk_bf16_f32 v224, v251, v224
    v_mfma_f32_16x16x32_bf16 a[16:19], a[196:199], v[228:231], a[16:19]
    v_cvt_pk_bf16_f32 v222, v250, v222
    v_cvt_pk_bf16_f32 v220, v252, v249
    v_mfma_f32_16x16x32_bf16 a[20:23], a[200:203], v[228:231], a[20:23]
    ds_read_b128 v[228:231], v253 offset:8320
    v_lshlrev_b32 v248, 16, v219
    v_mfma_f32_16x16x32_bf16 a[20:23], a[212:215], v[232:235], a[20:23]
    buffer_load_dwordx4 a[252:255], v254, s[8:11], s42 offen offset:0 sc1
    v_mfma_f32_16x16x32_bf16 a[20:23], a[224:227], v[236:239], a[20:23]
    v_lshlrev_b32 v249, 16, v221
    v_lshlrev_b32 v250, 16, v223
    v_mfma_f32_16x16x32_bf16 a[24:27], a[192:195], v[232:235], a[24:27]
    v_lshlrev_b32 v251, 16, v225
    v_and_b32 v219, s22, v219
    v_mfma_f32_16x16x32_bf16 a[24:27], a[204:207], v[236:239], a[24:27]
    s_waitcnt lgkmcnt(0)
    v_and_b32 v221, s22, v221
    v_and_b32 v223, s22, v223
    v_mfma_f32_16x16x32_bf16 a[24:27], a[216:219], v[228:231], a[24:27]
    v_and_b32 v225, s22, v225
    v_lshlrev_b32 v252, 16, v217
    v_mfma_f32_16x16x32_bf16 a[28:31], a[220:223], v[228:231], a[28:31]
    buffer_load_dwordx4 v[240:243], v254, s[8:11], s42 offen offset:1024 sc1
    v_mfma_f32_16x16x32_bf16 a[28:31], a[208:211], v[236:239], a[28:31]
    v_and_b32 v217, s22, v217
    v_fmac_f32 v252, s25, v251
    v_mfma_f32_16x16x32_bf16 a[28:31], a[196:199], v[232:235], a[28:31]
    v_fmac_f32 v217, s25, v225
    v_fmac_f32 v252, s28, v249
    v_mfma_f32_16x16x32_bf16 a[32:35], a[200:203], v[232:235], a[32:35]
    ds_read_b128 v[232:235], v253 offset:10144
    v_fmac_f32 v217, s28, v221
    v_mfma_f32_16x16x32_bf16 a[32:35], a[212:215], v[236:239], a[32:35]
    buffer_load_dwordx4 v[244:247], v254, s[8:11], s42 offen offset:2048 sc1
    v_mfma_f32_16x16x32_bf16 a[32:35], a[224:227], v[228:231], a[32:35]
    v_cvt_pk_bf16_f32 v217, v252, v217
    v_lshlrev_b32 v252, 16, v227
    v_mfma_f32_16x16x32_bf16 a[36:39], a[192:195], v[236:239], a[36:39]
    v_and_b32 v192, 0x1f0, v254
    v_mul_u32_u24 v192, 96, v192
    v_mfma_f32_16x16x32_bf16 a[36:39], a[204:207], v[228:231], a[36:39]
    s_waitcnt lgkmcnt(0)
    v_and_b32 v227, s22, v227
    v_fmac_f32 v252, s29, v248
    v_mfma_f32_16x16x32_bf16 a[36:39], a[216:219], v[232:235], a[36:39]
    buffer_load_dword v192, v192, s[4:7], s100 offen offset:384
    v_mfma_f32_16x16x32_bf16 a[40:43], a[220:223], v[232:235], a[40:43]
    v_fmac_f32 v227, s29, v219
    v_fmac_f32 v252, s23, v250
    v_mfma_f32_16x16x32_bf16 a[40:43], a[208:211], v[228:231], a[40:43]
    v_fmac_f32 v227, s23, v223
    v_cvt_pk_bf16_f32 v227, v252, v227
    v_mfma_f32_16x16x32_bf16 a[40:43], a[196:199], v[236:239], a[40:43]
    v_fma_f32 v252, v249, s24, v251
    v_fmac_f32 v251, -4.0, v249
    v_mfma_f32_16x16x32_bf16 a[44:47], a[200:203], v[236:239], a[44:47]
    ds_read_b128 v[236:239], v253 offset:9888
    v_fma_f32 v249, v248, s24, v250
    v_mfma_f32_16x16x32_bf16 a[44:47], a[212:215], v[228:231], a[44:47]
    v_fmac_f32 v250, -4.0, v248
    v_fma_f32 v248, v250, s26, v251
    v_mfma_f32_16x16x32_bf16 a[44:47], a[224:227], v[232:235], a[44:47]
pad7:
    s_cbranch_vccnz pad11
    v_fmac_f32 v251, s27, v250
    v_fma_f32 v250, v249, 2.0, v252
    v_mfma_f32_16x16x32_bf16 a[48:51], a[192:195], v[228:231], a[48:51]
    v_fmac_f32 v252, -2.0, v249
    v_fma_f32 v249, v221, s24, v225
    v_mfma_f32_16x16x32_bf16 a[48:51], a[204:207], v[232:235], a[48:51]
    s_waitcnt lgkmcnt(0)
    v_fmac_f32 v225, -4.0, v221
    v_fma_f32 v221, v219, s24, v223
    v_mfma_f32_16x16x32_bf16 a[48:51], a[216:219], v[236:239], a[48:51]
    v_fmac_f32 v223, -4.0, v219
    v_fma_f32 v219, v223, s26, v225
    v_mfma_f32_16x16x32_bf16 a[52:55], a[220:223], v[236:239], a[52:55]
    v_fmac_f32 v225, s27, v223
    v_fma_f32 v223, v221, 2.0, v249
    v_mfma_f32_16x16x32_bf16 a[52:55], a[208:211], v[232:235], a[52:55]
    v_fmac_f32 v249, -2.0, v221
    v_cvt_pk_bf16_f32 v219, v248, v219
    v_mfma_f32_16x16x32_bf16 a[52:55], a[196:199], v[228:231], a[52:55]
    v_cvt_pk_bf16_f32 v225, v251, v225
    v_cvt_pk_bf16_f32 v223, v250, v223
    v_mfma_f32_16x16x32_bf16 a[56:59], a[200:203], v[228:231], a[56:59]
    ds_read_b128 v[228:231], v253 offset:9632
    v_cvt_pk_bf16_f32 v221, v252, v249
    v_mfma_f32_16x16x32_bf16 a[56:59], a[212:215], v[232:235], a[56:59]
    v_and_b32 v248, 0xf0, v254
    v_lshrrev_b32 v248, 1, v248
    v_mfma_f32_16x16x32_bf16 a[56:59], a[224:227], v[236:239], a[56:59]
    v_add_u32 v248, s52, v248
    v_and_b32 v252, 8, v248
    v_mfma_f32_16x16x32_bf16 a[60:63], a[192:195], v[232:235], a[60:63]
    v_lshrrev_b32 v249, 6, v248
    v_mul_u32_u24 v249, 192, v249
    v_mfma_f32_16x16x32_bf16 a[60:63], a[204:207], v[236:239], a[60:63]
    s_waitcnt lgkmcnt(0)
    v_add_u32 v252, v252, v249
    v_bfe_u32 v249, v248, 4, 2
    v_mfma_f32_16x16x32_bf16 a[60:63], a[216:219], v[228:231], a[60:63]
    v_mul_u32_u24 v249, 40704, v249
    v_add_u32 v252, v252, v249
    v_mfma_f32_16x16x32_bf16 a[64:67], a[220:223], v[228:231], a[64:67]
    v_and_b32 v249, 32, v248
    v_lshl_add_u32 v252, v249, 1, v252
    v_mfma_f32_16x16x32_bf16 a[64:67], a[208:211], v[236:239], a[64:67]
    v_bfe_u32 v249, v254, 8, 1
    v_lshl_add_u32 v252, v249, 4, v252
    v_mfma_f32_16x16x32_bf16 a[64:67], a[196:199], v[232:235], a[64:67]
    v_mov_b32 v249, 123328
    v_cndmask_b32 v252, v249, v252, s[58:59]
    v_mfma_f32_16x16x32_bf16 a[68:71], a[200:203], v[232:235], a[68:71]
    ds_read_b128 v[232:235], v253 offset:9376
    v_mfma_f32_16x16x32_bf16 a[68:71], a[212:215], v[236:239], a[68:71]
    ds_write_b64 v252, v[216:217] offset:39520
    v_mfma_f32_16x16x32_bf16 a[68:71], a[224:227], v[228:231], a[68:71]
    v_mfma_f32_16x16x32_bf16 a[72:75], a[192:195], v[236:239], a[72:75]
    ds_write_b64 v252, v[218:219] offset:39552
    v_mfma_f32_16x16x32_bf16 a[72:75], a[204:207], v[228:231], a[72:75]
    s_waitcnt lgkmcnt(2)
    v_mfma_f32_16x16x32_bf16 a[72:75], a[216:219], v[232:235], a[72:75]
    ds_write_b64 v252, v[224:225] offset:39584
    v_mfma_f32_16x16x32_bf16 a[76:79], a[220:223], v[232:235], a[76:79]
    v_mfma_f32_16x16x32_bf16 a[76:79], a[208:211], v[228:231], a[76:79]
    ds_write_b64 v252, v[222:223] offset:39616
    v_mfma_f32_16x16x32_bf16 a[76:79], a[196:199], v[236:239], a[76:79]
    v_mfma_f32_16x16x32_bf16 a[80:83], a[200:203], v[236:239], a[80:83]
    ds_read_b128 v[236:239], v253 offset:9104
    v_mfma_f32_16x16x32_bf16 a[80:83], a[212:215], v[228:231], a[80:83]
    ds_write_b64 v252, v[220:221] offset:39648
    v_mfma_f32_16x16x32_bf16 a[80:83], a[224:227], v[232:235], a[80:83]
    s_mov_b32 s42, 811008
    v_mfma_f32_16x16x32_bf16 a[84:87], a[192:195], v[228:231], a[84:87]
    ds_write_b64 v252, v[226:227] offset:39680
    v_mfma_f32_16x16x32_bf16 a[88:91], a[196:199], v[228:231], a[88:91]
    v_mfma_f32_16x16x32_bf16 a[92:95], a[200:203], v[228:231], a[92:95]
    ds_read_b128 v[228:231], v253 offset:11440
    v_mfma_f32_16x16x32_bf16 a[92:95], a[212:215], v[232:235], a[92:95]
    buffer_load_dwordx4 a[192:195], v254, s[8:11], s42 offen offset:0 sc1
    v_mfma_f32_16x16x32_bf16 a[88:91], a[208:211], v[232:235], a[88:91]
    s_waitcnt lgkmcnt(3)
    v_mfma_f32_16x16x32_bf16 a[84:87], a[204:207], v[232:235], a[84:87]
    ds_read_b128 v[232:235], v253 offset:11168
    v_mfma_f32_16x16x32_bf16 a[84:87], a[216:219], v[236:239], a[84:87]
    buffer_load_dwordx4 a[196:199], v254, s[8:11], s42 offen offset:1024 sc1
    v_mfma_f32_16x16x32_bf16 a[88:91], a[220:223], v[236:239], a[88:91]
    s_waitcnt vmcnt(9) lgkmcnt(1)
    v_mfma_f32_16x16x32_bf16 a[92:95], a[224:227], v[236:239], a[92:95]
    ds_read_b128 v[236:239], v253 offset:10912
sub21:
    v_mfma_f32_16x16x32_bf16 a[96:99], a[228:231], v[228:231], a[96:99]
    buffer_load_dwordx4 a[200:203], v254, s[8:11], s42 offen offset:2048 sc1
    v_mfma_f32_16x16x32_bf16 a[100:103], a[232:235], v[228:231], a[100:103]
    s_mov_b32 s42, 814080
    v_mfma_f32_16x16x32_bf16 a[104:107], a[236:239], v[228:231], a[104:107]
    ds_read_b128 v[228:231], v253 offset:10656
    s_waitcnt vmcnt(7)
    s_waitcnt lgkmcnt(2)
    v_mfma_f32_16x16x32_bf16 a[104:107], a[248:251], v[232:235], a[104:107]
    v_bfe_u32 v251, v254, 6, 2
    v_mul_u32_u24 v248, 40704, v251
    v_mfma_f32_16x16x32_bf16 a[100:103], a[244:247], v[232:235], a[100:103]
    buffer_load_dwordx4 a[204:207], v254, s[8:11], s42 offen offset:0 sc1
    v_mfma_f32_16x16x32_bf16 a[96:99], a[240:243], v[232:235], a[96:99]
    s_waitcnt vmcnt(5) lgkmcnt(1)
    v_and_b32 v251, 0x80, v254
    v_lshrrev_b32 v251, 1, v251
    v_mfma_f32_16x16x32_bf16 a[96:99], a[252:255], v[236:239], a[96:99]
    v_add_u32 v248, v248, v251
    v_and_b32 v251, 0x40, v254
    v_mfma_f32_16x16x32_bf16 a[100:103], v[240:243], v[236:239], a[100:103]
    v_lshrrev_b32 v251, 2, v251
    v_add_u32 v248, v248, v251
    v_mfma_f32_16x16x32_bf16 a[104:107], v[244:247], v[236:239], a[104:107]
    buffer_load_dwordx4 a[208:211], v254, s[8:11], s42 offen offset:1024 sc1
    v_mfma_f32_16x16x32_bf16 a[108:111], a[228:231], v[232:235], a[108:111]
    v_bfe_u32 v251, v254, 4, 2
    v_mul_u32_u24 v251, 3104, v251
    v_mfma_f32_16x16x32_bf16 a[108:111], a[240:243], v[236:239], a[108:111]
    s_waitcnt lgkmcnt(0)
    v_add_u32 v248, v248, v251
    v_add_u32 v248, s52, v248
    v_mfma_f32_16x16x32_bf16 a[108:111], a[252:255], v[228:231], a[108:111]
    v_lshrrev_b32 v251, 8, v254
    v_lshl_add_u32 v249, v251, 3, v248
    v_mfma_f32_16x16x32_bf16 a[112:115], v[240:243], v[228:231], a[112:115]
    buffer_load_dwordx4 a[212:215], v254, s[8:11], s42 offen offset:2048 sc1
    v_mfma_f32_16x16x32_bf16 a[112:115], a[244:247], v[236:239], a[112:115]
    s_mov_b32 s42, 817152
    v_lshl_add_u32 v248, v251, 4, v248
    v_add_u32 v250, s51, v254
    v_mfma_f32_16x16x32_bf16 a[112:115], a[232:235], v[232:235], a[112:115]
    v_accvgpr_read_b32 v204, a0
    v_accvgpr_read_b32 v205, a1
    v_mfma_f32_16x16x32_bf16 a[116:119], a[236:239], v[232:235], a[116:119]
    ds_read_b128 v[232:235], v253 offset:10400
    v_accvgpr_read_b32 v206, a2
    v_mfma_f32_16x16x32_bf16 a[116:119], a[248:251], v[236:239], a[116:119]
    buffer_load_dwordx4 a[216:219], v254, s[8:11], s42 offen offset:0 sc1
    v_mfma_f32_16x16x32_bf16 a[116:119], v[244:247], v[228:231], a[116:119]
    v_accvgpr_read_b32 v207, a3
    v_accvgpr_read_b32 v208, a96
    v_mfma_f32_16x16x32_bf16 a[120:123], a[228:231], v[236:239], a[120:123]
    v_accvgpr_read_b32 v209, a97
    v_accvgpr_read_b32 v210, a98
    v_mfma_f32_16x16x32_bf16 a[120:123], a[240:243], v[228:231], a[120:123]
    s_waitcnt lgkmcnt(0)
    v_accvgpr_read_b32 v211, a99
    v_add_f32 v212, v204, v208
    v_mfma_f32_16x16x32_bf16 a[120:123], a[252:255], v[232:235], a[120:123]
    v_add_f32 v213, v205, v209
    v_add_f32 v214, v206, v210
    v_mfma_f32_16x16x32_bf16 a[124:127], v[240:243], v[232:235], a[124:127]
    buffer_load_dwordx4 a[220:223], v254, s[8:11], s42 offen offset:1024 sc1
    v_mfma_f32_16x16x32_bf16 a[124:127], a[244:247], v[228:231], a[124:127]
    v_add_f32 v215, v207, v211
    v_sub_f32 v204, v204, v208
    v_mfma_f32_16x16x32_bf16 a[124:127], a[232:235], v[236:239], a[124:127]
    v_sub_f32 v205, v205, v209
    v_sub_f32 v206, v206, v210
    v_mfma_f32_16x16x32_bf16 a[128:131], a[236:239], v[236:239], a[128:131]
    ds_read_b128 v[236:239], v253 offset:12224
    v_sub_f32 v207, v207, v211
    v_mfma_f32_16x16x32_bf16 a[128:131], a[248:251], v[228:231], a[128:131]
    buffer_load_dwordx4 a[224:227], v254, s[8:11], s42 offen offset:2048 sc1
    v_mfma_f32_16x16x32_bf16 a[128:131], v[244:247], v[232:235], a[128:131]
    v_accvgpr_write_b32 a0, v212
    v_accvgpr_write_b32 a1, v213
    v_mfma_f32_16x16x32_bf16 a[132:135], a[228:231], v[228:231], a[132:135]
    v_and_b32 v193, 0x1f0, v254
    v_mul_u32_u24 v193, 96, v193
    v_mfma_f32_16x16x32_bf16 a[132:135], a[240:243], v[232:235], a[132:135]
    s_waitcnt lgkmcnt(0)
    v_accvgpr_write_b32 a2, v214
    v_accvgpr_write_b32 a3, v215
    v_mfma_f32_16x16x32_bf16 a[132:135], a[252:255], v[236:239], a[132:135]
    buffer_load_dword v193, v193, s[4:7], s100 offen offset:768
    v_mfma_f32_16x16x32_bf16 a[136:139], v[240:243], v[236:239], a[136:139]
    v_accvgpr_write_b32 a96, v204
    v_accvgpr_write_b32 a97, v205
    v_mfma_f32_16x16x32_bf16 a[136:139], a[244:247], v[232:235], a[136:139]
    v_accvgpr_write_b32 a98, v206
    v_accvgpr_write_b32 a99, v207
    v_mfma_f32_16x16x32_bf16 a[136:139], a[232:235], v[228:231], a[136:139]
    v_accvgpr_read_b32 v204, a4
    v_accvgpr_read_b32 v205, a5
    v_mfma_f32_16x16x32_bf16 a[140:143], a[236:239], v[228:231], a[140:143]
    ds_read_b128 v[228:231], v253 offset:11968
    v_accvgpr_read_b32 v206, a6
    v_mfma_f32_16x16x32_bf16 a[140:143], a[248:251], v[232:235], a[140:143]
    v_accvgpr_read_b32 v207, a7
    v_accvgpr_read_b32 v208, a100
    v_mfma_f32_16x16x32_bf16 a[140:143], v[244:247], v[236:239], a[140:143]
    v_accvgpr_read_b32 v209, a101
    v_accvgpr_read_b32 v210, a102
    v_mfma_f32_16x16x32_bf16 a[144:147], a[228:231], v[232:235], a[144:147]
    v_accvgpr_read_b32 v211, a103
    v_add_f32 v212, v204, v208
    v_mfma_f32_16x16x32_bf16 a[144:147], a[240:243], v[236:239], a[144:147]
    s_waitcnt lgkmcnt(0)
    v_add_f32 v213, v205, v209
    v_add_f32 v214, v206, v210
    v_mfma_f32_16x16x32_bf16 a[144:147], a[252:255], v[228:231], a[144:147]
    v_add_f32 v215, v207, v211
    v_sub_f32 v204, v204, v208
    v_mfma_f32_16x16x32_bf16 a[148:151], v[240:243], v[228:231], a[148:151]
    v_sub_f32 v205, v205, v209
    v_sub_f32 v206, v206, v210
    v_mfma_f32_16x16x32_bf16 a[148:151], a[244:247], v[236:239], a[148:151]
    v_sub_f32 v207, v207, v211
    v_accvgpr_write_b32 a4, v212
    v_mfma_f32_16x16x32_bf16 a[148:151], a[232:235], v[232:235], a[148:151]
    v_accvgpr_write_b32 a5, v213
    v_accvgpr_write_b32 a6, v214
    v_mfma_f32_16x16x32_bf16 a[152:155], a[236:239], v[232:235], a[152:155]
    ds_read_b128 v[232:235], v253 offset:11712
    v_accvgpr_write_b32 a7, v215
    v_mfma_f32_16x16x32_bf16 a[152:155], a[248:251], v[236:239], a[152:155]
    v_accvgpr_write_b32 a100, v204
    v_accvgpr_write_b32 a101, v205
    v_mfma_f32_16x16x32_bf16 a[152:155], v[244:247], v[228:231], a[152:155]
    v_accvgpr_write_b32 a102, v206
    v_accvgpr_write_b32 a103, v207
    v_mfma_f32_16x16x32_bf16 a[156:159], a[228:231], v[236:239], a[156:159]
    v_accvgpr_read_b32 v204, a8
    v_accvgpr_read_b32 v205, a9
    v_mfma_f32_16x16x32_bf16 a[156:159], a[240:243], v[228:231], a[156:159]
    s_waitcnt lgkmcnt(0)
    v_accvgpr_read_b32 v206, a10
    v_accvgpr_read_b32 v207, a11
    v_mfma_f32_16x16x32_bf16 a[156:159], a[252:255], v[232:235], a[156:159]
    v_accvgpr_read_b32 v208, a104
    v_accvgpr_read_b32 v209, a105
    v_mfma_f32_16x16x32_bf16 a[160:163], v[240:243], v[232:235], a[160:163]
    v_accvgpr_read_b32 v210, a106
    v_accvgpr_read_b32 v211, a107
    v_mfma_f32_16x16x32_bf16 a[160:163], a[244:247], v[228:231], a[160:163]
    v_add_f32 v212, v204, v208
    v_add_f32 v213, v205, v209
    v_mfma_f32_16x16x32_bf16 a[160:163], a[232:235], v[236:239], a[160:163]
    v_add_f32 v214, v206, v210
    v_add_f32 v215, v207, v211
    v_mfma_f32_16x16x32_bf16 a[164:167], a[236:239], v[236:239], a[164:167]
    ds_read_b128 v[236:239], v253 offset:11456
    v_sub_f32 v204, v204, v208
    v_mfma_f32_16x16x32_bf16 a[164:167], a[248:251], v[228:231], a[164:167]
    v_sub_f32 v205, v205, v209
    v_sub_f32 v206, v206, v210
    v_mfma_f32_16x16x32_bf16 a[164:167], v[244:247], v[232:235], a[164:167]
    v_sub_f32 v207, v207, v211
    v_accvgpr_write_b32 a8, v212
    v_mfma_f32_16x16x32_bf16 a[168:171], a[228:231], v[228:231], a[168:171]
    v_accvgpr_write_b32 a9, v213
    v_accvgpr_write_b32 a10, v214
    v_mfma_f32_16x16x32_bf16 a[168:171], a[240:243], v[232:235], a[168:171]
    s_waitcnt lgkmcnt(0)
    v_accvgpr_write_b32 a11, v215
    v_accvgpr_write_b32 a104, v204
    v_mfma_f32_16x16x32_bf16 a[168:171], a[252:255], v[236:239], a[168:171]
    v_accvgpr_write_b32 a105, v205
    v_accvgpr_write_b32 a106, v206
    v_mfma_f32_16x16x32_bf16 a[172:175], v[240:243], v[236:239], a[172:175]
    v_accvgpr_write_b32 a107, v207
    v_accvgpr_read_b32 v204, a12
    v_mfma_f32_16x16x32_bf16 a[172:175], a[244:247], v[232:235], a[172:175]
    v_accvgpr_read_b32 v205, a13
    v_accvgpr_read_b32 v206, a14
    v_mfma_f32_16x16x32_bf16 a[172:175], a[232:235], v[228:231], a[172:175]
    v_accvgpr_read_b32 v207, a15
    v_accvgpr_read_b32 v208, a108
    v_mfma_f32_16x16x32_bf16 a[176:179], a[236:239], v[228:231], a[176:179]
    ds_read_b128 v[228:231], v253 offset:11184
    v_accvgpr_read_b32 v209, a109
    v_mfma_f32_16x16x32_bf16 a[176:179], a[248:251], v[232:235], a[176:179]
    v_accvgpr_read_b32 v210, a110
    v_accvgpr_read_b32 v211, a111
    v_mfma_f32_16x16x32_bf16 a[176:179], v[244:247], v[236:239], a[176:179]
    s_mov_b32 s42, 847872
    v_add_f32 v212, v204, v208
    v_add_f32 v213, v205, v209
    v_mfma_f32_16x16x32_bf16 a[180:183], a[228:231], v[232:235], a[180:183]
    v_add_f32 v214, v206, v210
    v_add_f32 v215, v207, v211
    v_mfma_f32_16x16x32_bf16 a[184:187], a[232:235], v[232:235], a[184:187]
    v_sub_f32 v204, v204, v208
    v_sub_f32 v205, v205, v209
    v_mfma_f32_16x16x32_bf16 a[188:191], a[236:239], v[232:235], a[188:191]
    ds_read_b128 v[232:235], v253 offset:13520
    v_sub_f32 v206, v206, v210
    v_mfma_f32_16x16x32_bf16 a[188:191], a[248:251], v[236:239], a[188:191]
    buffer_load_dwordx4 a[228:231], v254, s[8:11], s42 offen offset:0 sc1
    v_mfma_f32_16x16x32_bf16 a[184:187], a[244:247], v[236:239], a[184:187]
    s_waitcnt lgkmcnt(1)
    v_sub_f32 v207, v207, v211
    v_accvgpr_write_b32 a12, v212
    v_mfma_f32_16x16x32_bf16 a[180:183], a[240:243], v[236:239], a[180:183]
    ds_read_b128 v[236:239], v253 offset:13248
    v_accvgpr_write_b32 a13, v213
    v_mfma_f32_16x16x32_bf16 a[180:183], a[252:255], v[228:231], a[180:183]
    buffer_load_dwordx4 a[232:235], v254, s[8:11], s42 offen offset:1024 sc1
    v_mfma_f32_16x16x32_bf16 a[184:187], v[240:243], v[228:231], a[184:187]
    s_waitcnt vmcnt(9) lgkmcnt(1)
    v_accvgpr_write_b32 a14, v214
    v_accvgpr_write_b32 a15, v215
    v_mfma_f32_16x16x32_bf16 a[188:191], v[244:247], v[228:231], a[188:191]
    ds_read_b128 v[228:231], v253 offset:12992
    v_accvgpr_write_b32 a108, v204
sub22:
    v_mfma_f32_16x16x32_bf16 v[0:3], a[192:195], v[232:235], v[0:3]
    buffer_load_dwordx4 a[236:239], v254, s[8:11], s42 offen offset:2048 sc1
    v_mfma_f32_16x16x32_bf16 v[4:7], a[196:199], v[232:235], v[4:7]
    s_mov_b32 s42, 850944
    v_accvgpr_write_b32 a109, v205
    v_accvgpr_write_b32 a110, v206
    v_mfma_f32_16x16x32_bf16 v[8:11], a[200:203], v[232:235], v[8:11]
    ds_read_b128 v[232:235], v253 offset:12736
    s_waitcnt vmcnt(7)
    s_waitcnt lgkmcnt(2)
    v_mfma_f32_16x16x32_bf16 v[8:11], a[212:215], v[236:239], v[8:11]
    v_accvgpr_write_b32 a111, v207
    v_accvgpr_read_b32 v204, a16
    v_mfma_f32_16x16x32_bf16 v[4:7], a[208:211], v[236:239], v[4:7]
    buffer_load_dwordx4 a[240:243], v254, s[8:11], s42 offen offset:0 sc1
    v_mfma_f32_16x16x32_bf16 v[0:3], a[204:207], v[236:239], v[0:3]
    s_waitcnt vmcnt(5) lgkmcnt(1)
    v_accvgpr_read_b32 v205, a17
    v_accvgpr_read_b32 v206, a18
    v_mfma_f32_16x16x32_bf16 v[0:3], a[216:219], v[228:231], v[0:3]
    v_accvgpr_read_b32 v207, a19
    v_accvgpr_read_b32 v208, a112
    v_mfma_f32_16x16x32_bf16 v[4:7], a[220:223], v[228:231], v[4:7]
    v_accvgpr_read_b32 v209, a113
    v_accvgpr_read_b32 v210, a114
    v_mfma_f32_16x16x32_bf16 v[8:11], a[224:227], v[228:231], v[8:11]
    buffer_load_dwordx4 a[244:247], v254, s[8:11], s42 offen offset:1024 sc1
    v_mfma_f32_16x16x32_bf16 v[12:15], a[192:195], v[236:239], v[12:15]
    v_accvgpr_read_b32 v211, a115
    v_add_f32 v212, v204, v208
    v_mfma_f32_16x16x32_bf16 v[12:15], a[204:207], v[228:231], v[12:15]
    s_waitcnt lgkmcnt(0)
    v_add_f32 v213, v205, v209
    v_add_f32 v214, v206, v210
    v_mfma_f32_16x16x32_bf16 v[12:15], a[216:219], v[232:235], v[12:15]
    v_add_f32 v215, v207, v211
    v_sub_f32 v204, v204, v208
    v_mfma_f32_16x16x32_bf16 v[16:19], a[220:223], v[232:235], v[16:19]
    buffer_load_dwordx4 a[248:251], v254, s[8:11], s42 offen offset:2048 sc1
    v_mfma_f32_16x16x32_bf16 v[16:19], a[208:211], v[228:231], v[16:19]
    s_mov_b32 s42, 854016
    v_sub_f32 v205, v205, v209
    v_sub_f32 v206, v206, v210
    v_mfma_f32_16x16x32_bf16 v[16:19], a[196:199], v[236:239], v[16:19]
    v_sub_f32 v207, v207, v211
    v_accvgpr_write_b32 a16, v212
    v_mfma_f32_16x16x32_bf16 v[20:23], a[200:203], v[236:239], v[20:23]
    ds_read_b128 v[236:239], v253 offset:12480
    v_accvgpr_write_b32 a17, v213
    v_mfma_f32_16x16x32_bf16 v[20:23], a[212:215], v[228:231], v[20:23]
    buffer_load_dwordx4 a[252:255], v254, s[8:11], s42 offen offset:0 sc1
    v_mfma_f32_16x16x32_bf16 v[20:23], a[224:227], v[232:235], v[20:23]
    v_accvgpr_write_b32 a18, v214
    v_accvgpr_write_b32 a19, v215
    v_mfma_f32_16x16x32_bf16 v[24:27], a[192:195], v[228:231], v[24:27]
    v_accvgpr_write_b32 a112, v204
    v_accvgpr_write_b32 a113, v205
    v_mfma_f32_16x16x32_bf16 v[24:27], a[204:207], v[232:235], v[24:27]
    s_waitcnt lgkmcnt(0)
    v_accvgpr_write_b32 a114, v206
    v_accvgpr_write_b32 a115, v207
    v_mfma_f32_16x16x32_bf16 v[24:27], a[216:219], v[236:239], v[24:27]
    v_accvgpr_read_b32 v204, a20
    v_accvgpr_read_b32 v205, a21
    v_mfma_f32_16x16x32_bf16 v[28:31], a[220:223], v[236:239], v[28:31]
    buffer_load_dwordx4 v[240:243], v254, s[8:11], s42 offen offset:1024 sc1
    v_mfma_f32_16x16x32_bf16 v[28:31], a[208:211], v[232:235], v[28:31]
    v_accvgpr_read_b32 v206, a22
    v_accvgpr_read_b32 v207, a23
    v_mfma_f32_16x16x32_bf16 v[28:31], a[196:199], v[228:231], v[28:31]
    v_accvgpr_read_b32 v208, a116
    v_accvgpr_read_b32 v209, a117
    v_mfma_f32_16x16x32_bf16 v[32:35], a[200:203], v[228:231], v[32:35]
    ds_read_b128 v[228:231], v253 offset:14304
    v_accvgpr_read_b32 v210, a118
    v_mfma_f32_16x16x32_bf16 v[32:35], a[212:215], v[232:235], v[32:35]
    buffer_load_dwordx4 v[244:247], v254, s[8:11], s42 offen offset:2048 sc1
    v_mfma_f32_16x16x32_bf16 v[32:35], a[224:227], v[236:239], v[32:35]
    v_accvgpr_read_b32 v211, a119
    v_add_f32 v212, v204, v208
    v_mfma_f32_16x16x32_bf16 v[36:39], a[192:195], v[232:235], v[36:39]
    v_add_f32 v213, v205, v209
    v_add_f32 v214, v206, v210
    v_mfma_f32_16x16x32_bf16 v[36:39], a[204:207], v[236:239], v[36:39]
    s_waitcnt lgkmcnt(0)
    v_add_f32 v215, v207, v211
    v_sub_f32 v204, v204, v208
    v_mfma_f32_16x16x32_bf16 v[36:39], a[216:219], v[228:231], v[36:39]
    v_sub_f32 v205, v205, v209
    v_sub_f32 v206, v206, v210
    v_mfma_f32_16x16x32_bf16 v[40:43], a[220:223], v[228:231], v[40:43]
    v_sub_f32 v207, v207, v211
    v_accvgpr_write_b32 a20, v212
    v_mfma_f32_16x16x32_bf16 v[40:43], a[208:211], v[236:239], v[40:43]
    v_accvgpr_write_b32 a21, v213
    v_accvgpr_write_b32 a22, v214
    v_mfma_f32_16x16x32_bf16 v[40:43], a[196:199], v[232:235], v[40:43]
    v_accvgpr_write_b32 a23, v215
    v_accvgpr_write_b32 a116, v204
    v_mfma_f32_16x16x32_bf16 v[44:47], a[200:203], v[232:235], v[44:47]
    ds_read_b128 v[232:235], v253 offset:14048
    v_accvgpr_write_b32 a117, v205
    v_mfma_f32_16x16x32_bf16 v[44:47], a[212:215], v[236:239], v[44:47]
    v_accvgpr_write_b32 a118, v206
    v_accvgpr_write_b32 a119, v207
    v_mfma_f32_16x16x32_bf16 v[44:47], a[224:227], v[228:231], v[44:47]
    v_accvgpr_read_b32 v204, a24
    v_accvgpr_read_b32 v205, a25
    v_mfma_f32_16x16x32_bf16 v[48:51], a[192:195], v[236:239], v[48:51]
    v_accvgpr_read_b32 v206, a26
    v_accvgpr_read_b32 v207, a27
    v_mfma_f32_16x16x32_bf16 v[48:51], a[204:207], v[228:231], v[48:51]
    s_waitcnt lgkmcnt(0)
    v_accvgpr_read_b32 v208, a120
    v_accvgpr_read_b32 v209, a121
    v_mfma_f32_16x16x32_bf16 v[48:51], a[216:219], v[232:235], v[48:51]
    v_accvgpr_read_b32 v210, a122
    v_accvgpr_read_b32 v211, a123
    v_mfma_f32_16x16x32_bf16 v[52:55], a[220:223], v[232:235], v[52:55]
    v_add_f32 v212, v204, v208
    v_add_f32 v213, v205, v209
    v_mfma_f32_16x16x32_bf16 v[52:55], a[208:211], v[228:231], v[52:55]
    v_add_f32 v214, v206, v210
    v_add_f32 v215, v207, v211
    v_mfma_f32_16x16x32_bf16 v[52:55], a[196:199], v[236:239], v[52:55]
    v_sub_f32 v204, v204, v208
    v_sub_f32 v205, v205, v209
    v_mfma_f32_16x16x32_bf16 v[56:59], a[200:203], v[236:239], v[56:59]
    ds_read_b128 v[236:239], v253 offset:13792
    v_sub_f32 v206, v206, v210
    v_mfma_f32_16x16x32_bf16 v[56:59], a[212:215], v[228:231], v[56:59]
    v_sub_f32 v207, v207, v211
    v_accvgpr_write_b32 a24, v212
    v_mfma_f32_16x16x32_bf16 v[56:59], a[224:227], v[232:235], v[56:59]
    v_accvgpr_write_b32 a25, v213
    v_accvgpr_write_b32 a26, v214
    v_mfma_f32_16x16x32_bf16 v[60:63], a[192:195], v[228:231], v[60:63]
    v_accvgpr_write_b32 a27, v215
    v_accvgpr_write_b32 a120, v204
    v_mfma_f32_16x16x32_bf16 v[60:63], a[204:207], v[232:235], v[60:63]
    s_waitcnt lgkmcnt(0)
    v_accvgpr_write_b32 a121, v205
    v_accvgpr_write_b32 a122, v206
    v_mfma_f32_16x16x32_bf16 v[60:63], a[216:219], v[236:239], v[60:63]
    v_accvgpr_write_b32 a123, v207
    v_accvgpr_read_b32 v204, a84
    v_mfma_f32_16x16x32_bf16 v[64:67], a[220:223], v[236:239], v[64:67]
    v_accvgpr_read_b32 v205, a85
    v_accvgpr_read_b32 v206, a86
    v_mfma_f32_16x16x32_bf16 v[64:67], a[208:211], v[232:235], v[64:67]
    v_accvgpr_read_b32 v207, a87
    v_accvgpr_read_b32 v208, a180
    v_mfma_f32_16x16x32_bf16 v[64:67], a[196:199], v[228:231], v[64:67]
    v_accvgpr_read_b32 v209, a181
    v_accvgpr_read_b32 v210, a182
    v_mfma_f32_16x16x32_bf16 v[68:71], a[200:203], v[228:231], v[68:71]
    ds_read_b128 v[228:231], v253 offset:13536
    v_accvgpr_read_b32 v211, a183
    v_mfma_f32_16x16x32_bf16 v[68:71], a[212:215], v[232:235], v[68:71]
    v_add_f32 v212, v204, v208
    v_add_f32 v213, v205, v209
    v_mfma_f32_16x16x32_bf16 v[68:71], a[224:227], v[236:239], v[68:71]
    v_add_f32 v214, v206, v210
    v_add_f32 v215, v207, v211
    v_mfma_f32_16x16x32_bf16 v[72:75], a[192:195], v[232:235], v[72:75]
    v_sub_f32 v204, v204, v208
    v_sub_f32 v205, v205, v209
    v_mfma_f32_16x16x32_bf16 v[72:75], a[204:207], v[236:239], v[72:75]
    s_waitcnt lgkmcnt(0)
    v_sub_f32 v206, v206, v210
    v_sub_f32 v207, v207, v211
    v_mfma_f32_16x16x32_bf16 v[72:75], a[216:219], v[228:231], v[72:75]
    v_accvgpr_write_b32 a84, v212
    v_accvgpr_write_b32 a85, v213
    v_mfma_f32_16x16x32_bf16 v[76:79], a[220:223], v[228:231], v[76:79]
    v_accvgpr_write_b32 a86, v214
    v_accvgpr_write_b32 a87, v215
    v_mfma_f32_16x16x32_bf16 v[76:79], a[208:211], v[236:239], v[76:79]
    v_accvgpr_write_b32 a180, v204
    v_accvgpr_write_b32 a181, v205
    v_mfma_f32_16x16x32_bf16 v[76:79], a[196:199], v[232:235], v[76:79]
    v_accvgpr_write_b32 a182, v206
    v_accvgpr_write_b32 a183, v207
    v_mfma_f32_16x16x32_bf16 v[80:83], a[200:203], v[232:235], v[80:83]
    ds_read_b128 v[232:235], v253 offset:13264
    v_accvgpr_read_b32 v204, a88
    v_mfma_f32_16x16x32_bf16 v[80:83], a[212:215], v[236:239], v[80:83]
    v_accvgpr_read_b32 v205, a89
    v_accvgpr_read_b32 v206, a90
    v_mfma_f32_16x16x32_bf16 v[80:83], a[224:227], v[228:231], v[80:83]
    s_mov_b32 s42, 921600
    v_accvgpr_read_b32 v207, a91
    v_accvgpr_read_b32 v208, a184
    v_mfma_f32_16x16x32_bf16 v[84:87], a[192:195], v[236:239], v[84:87]
    v_accvgpr_read_b32 v209, a185
    v_accvgpr_read_b32 v210, a186
    v_mfma_f32_16x16x32_bf16 v[88:91], a[196:199], v[236:239], v[88:91]
    v_accvgpr_read_b32 v211, a187
    v_add_f32 v212, v204, v208
    v_mfma_f32_16x16x32_bf16 v[92:95], a[200:203], v[236:239], v[92:95]
    ds_read_b128 v[236:239], v253 offset:1040
    v_add_f32 v213, v205, v209
    v_mfma_f32_16x16x32_bf16 v[92:95], a[212:215], v[228:231], v[92:95]
    buffer_load_dwordx4 a[192:195], v254, s[8:11], s42 offen offset:0 sc1
    v_mfma_f32_16x16x32_bf16 v[88:91], a[208:211], v[228:231], v[88:91]
    s_waitcnt lgkmcnt(1)
    v_add_f32 v214, v206, v210
    v_add_f32 v215, v207, v211
    v_mfma_f32_16x16x32_bf16 v[84:87], a[204:207], v[228:231], v[84:87]
    ds_read_b128 v[228:231], v253 offset:768
    v_sub_f32 v204, v204, v208
    v_mfma_f32_16x16x32_bf16 v[84:87], a[216:219], v[232:235], v[84:87]
    buffer_load_dwordx4 a[196:199], v254, s[8:11], s42 offen offset:1024 sc1
    v_mfma_f32_16x16x32_bf16 v[88:91], a[220:223], v[232:235], v[88:91]
    s_waitcnt vmcnt(8) lgkmcnt(1)
    v_sub_f32 v205, v205, v209
    v_sub_f32 v206, v206, v210
    v_mfma_f32_16x16x32_bf16 v[92:95], a[224:227], v[232:235], v[92:95]
    ds_read_b128 v[232:235], v253 offset:512
    v_sub_f32 v207, v207, v211
sub23:
    v_mfma_f32_16x16x32_bf16 v[96:99], a[228:231], v[236:239], v[96:99]
    buffer_load_dwordx4 a[200:203], v254, s[8:11], s42 offen offset:2048 sc1
    v_mfma_f32_16x16x32_bf16 v[100:103], a[232:235], v[236:239], v[100:103]
    s_mov_b32 s42, 924672
    v_accvgpr_write_b32 a88, v212
    v_accvgpr_write_b32 a89, v213
    v_mfma_f32_16x16x32_bf16 v[104:107], a[236:239], v[236:239], v[104:107]
    ds_read_b128 v[236:239], v253 offset:256
    s_waitcnt vmcnt(6)
    s_waitcnt lgkmcnt(2)
    v_mfma_f32_16x16x32_bf16 v[104:107], a[248:251], v[228:231], v[104:107]
    v_accvgpr_write_b32 a90, v214
    v_accvgpr_write_b32 a91, v215
    v_mfma_f32_16x16x32_bf16 v[100:103], a[244:247], v[228:231], v[100:103]
    buffer_load_dwordx4 a[204:207], v254, s[8:11], s42 offen offset:0 sc1
    v_mfma_f32_16x16x32_bf16 v[96:99], a[240:243], v[228:231], v[96:99]
    s_waitcnt vmcnt(4) lgkmcnt(1)
    v_accvgpr_write_b32 a184, v204
    v_accvgpr_write_b32 a185, v205
    v_mfma_f32_16x16x32_bf16 v[96:99], a[252:255], v[232:235], v[96:99]
    v_accvgpr_write_b32 a186, v206
    v_accvgpr_write_b32 a187, v207
    v_mfma_f32_16x16x32_bf16 v[100:103], v[240:243], v[232:235], v[100:103]
    v_accvgpr_read_b32 v204, a92
    v_accvgpr_read_b32 v205, a93
    v_mfma_f32_16x16x32_bf16 v[104:107], v[244:247], v[232:235], v[104:107]
    buffer_load_dwordx4 a[208:211], v254, s[8:11], s42 offen offset:1024 sc1
    v_mfma_f32_16x16x32_bf16 v[108:111], a[228:231], v[228:231], v[108:111]
    v_accvgpr_read_b32 v206, a94
    v_accvgpr_read_b32 v207, a95
    v_mfma_f32_16x16x32_bf16 v[108:111], a[240:243], v[232:235], v[108:111]
    s_waitcnt lgkmcnt(0)
    v_accvgpr_read_b32 v208, a188
    v_accvgpr_read_b32 v209, a189
    v_mfma_f32_16x16x32_bf16 v[108:111], a[252:255], v[236:239], v[108:111]
    v_accvgpr_read_b32 v210, a190
    v_accvgpr_read_b32 v211, a191
    v_mfma_f32_16x16x32_bf16 v[112:115], v[240:243], v[236:239], v[112:115]
    buffer_load_dwordx4 a[212:215], v254, s[8:11], s42 offen offset:2048 sc1
    v_mfma_f32_16x16x32_bf16 v[112:115], a[244:247], v[232:235], v[112:115]
    s_mov_b32 s42, 927744
    v_add_f32 v212, v204, v208
    v_add_f32 v213, v205, v209
    v_mfma_f32_16x16x32_bf16 v[112:115], a[232:235], v[228:231], v[112:115]
    v_add_f32 v214, v206, v210
    v_add_f32 v215, v207, v211
    v_mfma_f32_16x16x32_bf16 v[116:119], a[236:239], v[228:231], v[116:119]
    ds_read_b128 v[228:231], v253 offset:0
    v_sub_f32 v204, v204, v208
    v_mfma_f32_16x16x32_bf16 v[116:119], a[248:251], v[232:235], v[116:119]
    buffer_load_dwordx4 a[216:219], v254, s[8:11], s42 offen offset:0 sc1
    v_mfma_f32_16x16x32_bf16 v[116:119], v[244:247], v[236:239], v[116:119]
pad8:
    s_cbranch_vccnz pad12
    v_sub_f32 v205, v205, v209
    v_sub_f32 v206, v206, v210
    v_mfma_f32_16x16x32_bf16 v[120:123], a[228:231], v[232:235], v[120:123]
    v_sub_f32 v207, v207, v211
    v_accvgpr_write_b32 a92, v212
    v_mfma_f32_16x16x32_bf16 v[120:123], a[240:243], v[236:239], v[120:123]
    s_waitcnt lgkmcnt(0)
    v_accvgpr_write_b32 a93, v213
    v_accvgpr_write_b32 a94, v214
    v_mfma_f32_16x16x32_bf16 v[120:123], a[252:255], v[228:231], v[120:123]
    v_accvgpr_write_b32 a95, v215
    v_accvgpr_write_b32 a188, v204
    v_mfma_f32_16x16x32_bf16 v[124:127], v[240:243], v[228:231], v[124:127]
    buffer_load_dwordx4 a[220:223], v254, s[8:11], s42 offen offset:1024 sc1
    v_mfma_f32_16x16x32_bf16 v[124:127], a[244:247], v[236:239], v[124:127]
    v_accvgpr_write_b32 a189, v205
    v_accvgpr_write_b32 a190, v206
    v_mfma_f32_16x16x32_bf16 v[124:127], a[232:235], v[232:235], v[124:127]
    v_accvgpr_write_b32 a191, v207
    v_accvgpr_read_b32 v204, a0
    v_mfma_f32_16x16x32_bf16 v[128:131], a[236:239], v[232:235], v[128:131]
    ds_read_b128 v[232:235], v253 offset:1824
    v_accvgpr_read_b32 v205, a1
    v_mfma_f32_16x16x32_bf16 v[128:131], a[248:251], v[236:239], v[128:131]
    buffer_load_dwordx4 a[224:227], v254, s[8:11], s42 offen offset:2048 sc1
    v_mfma_f32_16x16x32_bf16 v[128:131], v[244:247], v[228:231], v[128:131]
    v_accvgpr_read_b32 v206, a2
    v_accvgpr_read_b32 v207, a3
    v_mfma_f32_16x16x32_bf16 v[132:135], a[228:231], v[236:239], v[132:135]
    v_and_b32 v252, 0x1f0, v254
    v_mul_u32_u24 v252, 96, v252
    v_mfma_f32_16x16x32_bf16 v[132:135], a[240:243], v[228:231], v[132:135]
    s_waitcnt lgkmcnt(0)
    v_add_f32 v208, v0, v96
    v_add_f32 v209, v1, v97
    v_mfma_f32_16x16x32_bf16 v[132:135], a[252:255], v[232:235], v[132:135]
    buffer_load_dword v252, v252, s[4:7], s100 offen offset:1152
    v_mfma_f32_16x16x32_bf16 v[136:139], v[240:243], v[232:235], v[136:139]
    v_add_f32 v210, v2, v98
    v_add_f32 v211, v3, v99
    v_mfma_f32_16x16x32_bf16 v[136:139], a[244:247], v[228:231], v[136:139]
    v_sub_f32 v96, v0, v96
    v_sub_f32 v97, v1, v97
    v_mfma_f32_16x16x32_bf16 v[136:139], a[232:235], v[236:239], v[136:139]
    v_sub_f32 v98, v2, v98
    v_sub_f32 v99, v3, v99
    v_mfma_f32_16x16x32_bf16 v[140:143], a[236:239], v[236:239], v[140:143]
    ds_read_b128 v[236:239], v253 offset:1568
    v_fma_f32 v0, v208, s31, v204
    v_mfma_f32_16x16x32_bf16 v[140:143], a[248:251], v[228:231], v[140:143]
    v_fma_f32 v1, v209, s31, v205
    v_fma_f32 v2, v210, s31, v206
    v_mfma_f32_16x16x32_bf16 v[140:143], v[244:247], v[232:235], v[140:143]
    v_fma_f32 v3, v211, s31, v207
    v_fmac_f32 v208, s30, v204
    v_mfma_f32_16x16x32_bf16 v[144:147], a[228:231], v[228:231], v[144:147]
    v_fmac_f32 v209, s30, v205
    v_fmac_f32 v210, s30, v206
    v_mfma_f32_16x16x32_bf16 v[144:147], a[240:243], v[232:235], v[144:147]
    s_waitcnt lgkmcnt(0)
    v_fmac_f32 v211, s30, v207
    v_cvt_pk_bf16_f32 v194, v208, v209
    v_mfma_f32_16x16x32_bf16 v[144:147], a[252:255], v[236:239], v[144:147]
    v_cvt_pk_bf16_f32 v195, v210, v211
    v_accvgpr_read_b32 v204, a4
    v_mfma_f32_16x16x32_bf16 v[148:151], v[240:243], v[236:239], v[148:151]
    v_accvgpr_read_b32 v205, a5
    v_accvgpr_read_b32 v206, a6
    v_mfma_f32_16x16x32_bf16 v[148:151], a[244:247], v[232:235], v[148:151]
    v_accvgpr_read_b32 v207, a7
    v_add_f32 v208, v4, v100
    v_mfma_f32_16x16x32_bf16 v[148:151], a[232:235], v[228:231], v[148:151]
    v_add_f32 v209, v5, v101
    v_add_f32 v210, v6, v102
    v_mfma_f32_16x16x32_bf16 v[152:155], a[236:239], v[228:231], v[152:155]
    ds_read_b128 v[228:231], v253 offset:1312
    v_add_f32 v211, v7, v103
    v_mfma_f32_16x16x32_bf16 v[152:155], a[248:251], v[232:235], v[152:155]
    v_sub_f32 v100, v4, v100
    v_sub_f32 v101, v5, v101
    v_mfma_f32_16x16x32_bf16 v[152:155], v[244:247], v[236:239], v[152:155]
    v_sub_f32 v102, v6, v102
    v_sub_f32 v103, v7, v103
    v_mfma_f32_16x16x32_bf16 v[156:159], a[228:231], v[232:235], v[156:159]
    v_fma_f32 v4, v208, s31, v204
    v_fma_f32 v5, v209, s31, v205
    v_mfma_f32_16x16x32_bf16 v[156:159], a[240:243], v[236:239], v[156:159]
    s_waitcnt lgkmcnt(0)
    v_fma_f32 v6, v210, s31, v206
    v_fma_f32 v7, v211, s31, v207
    v_mfma_f32_16x16x32_bf16 v[156:159], a[252:255], v[228:231], v[156:159]
    v_fmac_f32 v208, s30, v204
    v_fmac_f32 v209, s30, v205
    v_mfma_f32_16x16x32_bf16 v[160:163], v[240:243], v[228:231], v[160:163]
    v_fmac_f32 v210, s30, v206
    v_fmac_f32 v211, s30, v207
    v_mfma_f32_16x16x32_bf16 v[160:163], a[244:247], v[236:239], v[160:163]
    v_cvt_pk_bf16_f32 v196, v208, v209
    v_cvt_pk_bf16_f32 v197, v210, v211
    v_mfma_f32_16x16x32_bf16 v[160:163], a[232:235], v[232:235], v[160:163]
    v_accvgpr_read_b32 v204, a8
    v_accvgpr_read_b32 v205, a9
    v_mfma_f32_16x16x32_bf16 v[164:167], a[236:239], v[232:235], v[164:167]
    ds_read_b128 v[232:235], v253 offset:1056
    v_accvgpr_read_b32 v206, a10
    v_mfma_f32_16x16x32_bf16 v[164:167], a[248:251], v[236:239], v[164:167]
    v_accvgpr_read_b32 v207, a11
    v_add_f32 v208, v8, v104
    v_mfma_f32_16x16x32_bf16 v[164:167], v[244:247], v[228:231], v[164:167]
    v_add_f32 v209, v9, v105
    v_add_f32 v210, v10, v106
    v_mfma_f32_16x16x32_bf16 v[168:171], a[228:231], v[236:239], v[168:171]
    v_add_f32 v211, v11, v107
    v_sub_f32 v104, v8, v104
    v_mfma_f32_16x16x32_bf16 v[168:171], a[240:243], v[228:231], v[168:171]
    s_waitcnt lgkmcnt(0)
    v_sub_f32 v105, v9, v105
    v_sub_f32 v106, v10, v106
    v_mfma_f32_16x16x32_bf16 v[168:171], a[252:255], v[232:235], v[168:171]
    v_sub_f32 v107, v11, v107
    v_fma_f32 v8, v208, s31, v204
    v_mfma_f32_16x16x32_bf16 v[172:175], v[240:243], v[232:235], v[172:175]
    v_fma_f32 v9, v209, s31, v205
    v_fma_f32 v10, v210, s31, v206
    v_mfma_f32_16x16x32_bf16 v[172:175], a[244:247], v[228:231], v[172:175]
    v_fma_f32 v11, v211, s31, v207
    v_fmac_f32 v208, s30, v204
    v_mfma_f32_16x16x32_bf16 v[172:175], a[232:235], v[236:239], v[172:175]
    v_fmac_f32 v209, s30, v205
    v_fmac_f32 v210, s30, v206
    v_mfma_f32_16x16x32_bf16 v[176:179], a[236:239], v[236:239], v[176:179]
    ds_read_b128 v[236:239], v253 offset:784
    v_fmac_f32 v211, s30, v207
    v_mfma_f32_16x16x32_bf16 v[176:179], a[248:251], v[228:231], v[176:179]
    v_cvt_pk_bf16_f32 v198, v208, v209
    v_cvt_pk_bf16_f32 v199, v210, v211
    v_mfma_f32_16x16x32_bf16 v[176:179], v[244:247], v[232:235], v[176:179]
    s_mov_b32 s42, 958464
    v_mfma_f32_16x16x32_bf16 v[180:183], a[228:231], v[228:231], v[180:183]
    s_waitcnt lgkmcnt(0)
    v_mfma_f32_16x16x32_bf16 v[184:187], a[232:235], v[228:231], v[184:187]
    s_barrier
    v_mfma_f32_16x16x32_bf16 v[188:191], a[236:239], v[228:231], v[188:191]
    ds_read_b128 v[228:231], v253 offset:15600
    v_mfma_f32_16x16x32_bf16 v[188:191], a[248:251], v[232:235], v[188:191]
    buffer_load_dwordx4 a[228:231], v254, s[8:11], s42 offen offset:0 sc1
    v_mfma_f32_16x16x32_bf16 v[184:187], a[244:247], v[232:235], v[184:187]
    v_mfma_f32_16x16x32_bf16 v[180:183], a[240:243], v[232:235], v[180:183]
    ds_read_b128 v[232:235], v253 offset:15328
    v_mfma_f32_16x16x32_bf16 v[180:183], a[252:255], v[236:239], v[180:183]
    buffer_load_dwordx4 a[232:235], v254, s[8:11], s42 offen offset:1024 sc1
    v_mfma_f32_16x16x32_bf16 v[184:187], v[240:243], v[236:239], v[184:187]
    s_waitcnt vmcnt(9) lgkmcnt(1)
    v_mfma_f32_16x16x32_bf16 v[188:191], v[244:247], v[236:239], v[188:191]
    ds_read_b128 v[236:239], v253 offset:15072
    s_nop 0
    ds_write_b128 v248, v[194:197] offset:0
    v_accvgpr_read_b32 v204, a12
    v_accvgpr_read_b32 v205, a13
    v_accvgpr_read_b32 v206, a14
    v_accvgpr_read_b32 v207, a15
    v_pk_add_f32 v[208:209], v[12:13], v[108:109]
    v_pk_add_f32 v[210:211], v[14:15], v[110:111]
    v_pk_add_f32 v[108:109], v[12:13], v[108:109] neg_lo:[0,1] neg_hi:[0,1]
    v_pk_add_f32 v[110:111], v[14:15], v[110:111] neg_lo:[0,1] neg_hi:[0,1]
    v_pk_fma_f32 v[12:13], v[208:209], s[30:31], v[204:205] op_sel:[0,1,0]
    v_pk_fma_f32 v[14:15], v[210:211], s[30:31], v[206:207] op_sel:[0,1,0]
    v_pk_fma_f32 v[204:205], v[204:205], s[30:31], v[208:209] op_sel_hi:[1,0,1]
    v_pk_fma_f32 v[206:207], v[206:207], s[30:31], v[210:211] op_sel_hi:[1,0,1]
    v_cvt_pk_bf16_f32 v220, v204, v205
    v_cvt_pk_bf16_f32 v221, v206, v207
    ds_write_b64 v249, v[198:199] offset:64
    v_accvgpr_read_b32 v212, a16
    v_accvgpr_read_b32 v213, a17
    v_accvgpr_read_b32 v214, a18
    v_accvgpr_read_b32 v215, a19
    v_pk_add_f32 v[216:217], v[16:17], v[112:113]
    v_pk_add_f32 v[218:219], v[18:19], v[114:115]
    v_pk_add_f32 v[112:113], v[16:17], v[112:113] neg_lo:[0,1] neg_hi:[0,1]
    v_pk_add_f32 v[114:115], v[18:19], v[114:115] neg_lo:[0,1] neg_hi:[0,1]
    v_pk_fma_f32 v[16:17], v[216:217], s[30:31], v[212:213] op_sel:[0,1,0]
    v_pk_fma_f32 v[18:19], v[218:219], s[30:31], v[214:215] op_sel:[0,1,0]
    v_pk_fma_f32 v[212:213], v[212:213], s[30:31], v[216:217] op_sel_hi:[1,0,1]
    v_pk_fma_f32 v[214:215], v[214:215], s[30:31], v[218:219] op_sel_hi:[1,0,1]
    v_cvt_pk_bf16_f32 v222, v212, v213
    v_cvt_pk_bf16_f32 v223, v214, v215
    ds_write_b128 v248, v[220:223] offset:384
    v_accvgpr_read_b32 v204, a20
    v_accvgpr_read_b32 v205, a21
    v_accvgpr_read_b32 v206, a22
    v_accvgpr_read_b32 v207, a23
    v_pk_add_f32 v[208:209], v[20:21], v[116:117]
    v_pk_add_f32 v[210:211], v[22:23], v[118:119]
    v_pk_add_f32 v[116:117], v[20:21], v[116:117] neg_lo:[0,1] neg_hi:[0,1]
    v_pk_add_f32 v[118:119], v[22:23], v[118:119] neg_lo:[0,1] neg_hi:[0,1]
    v_pk_fma_f32 v[20:21], v[208:209], s[30:31], v[204:205] op_sel:[0,1,0]
    v_pk_fma_f32 v[22:23], v[210:211], s[30:31], v[206:207] op_sel:[0,1,0]
    v_pk_fma_f32 v[204:205], v[204:205], s[30:31], v[208:209] op_sel_hi:[1,0,1]
    v_pk_fma_f32 v[206:207], v[206:207], s[30:31], v[210:211] op_sel_hi:[1,0,1]
    v_cvt_pk_bf16_f32 v224, v204, v205
    v_cvt_pk_bf16_f32 v225, v206, v207
    v_accvgpr_read_b32 v204, a24
    v_accvgpr_read_b32 v205, a25
    v_accvgpr_read_b32 v206, a26
    v_accvgpr_read_b32 v207, a27
    v_pk_add_f32 v[208:209], v[24:25], v[120:121]
    v_pk_add_f32 v[210:211], v[26:27], v[122:123]
    v_pk_add_f32 v[120:121], v[24:25], v[120:121] neg_lo:[0,1] neg_hi:[0,1]
    v_pk_add_f32 v[122:123], v[26:27], v[122:123] neg_lo:[0,1] neg_hi:[0,1]
    v_pk_fma_f32 v[24:25], v[208:209], s[30:31], v[204:205] op_sel:[0,1,0]
    v_pk_fma_f32 v[26:27], v[210:211], s[30:31], v[206:207] op_sel:[0,1,0]
    v_pk_fma_f32 v[204:205], v[204:205], s[30:31], v[208:209] op_sel_hi:[1,0,1]
    v_pk_fma_f32 v[206:207], v[206:207], s[30:31], v[210:211] op_sel_hi:[1,0,1]
    v_cvt_pk_bf16_f32 v194, v204, v205
    v_cvt_pk_bf16_f32 v195, v206, v207
    ds_write_b64 v249, v[224:225] offset:448
    v_accvgpr_read_b32 v212, a28
    v_accvgpr_read_b32 v213, a29
    v_accvgpr_read_b32 v214, a30
    v_accvgpr_read_b32 v215, a31
    v_accvgpr_read_b32 v216, a124
    v_accvgpr_read_b32 v217, a125
    v_accvgpr_read_b32 v218, a126
    v_accvgpr_read_b32 v219, a127
    v_pk_add_f32 v[212:213], v[212:213], v[216:217]
    v_pk_add_f32 v[214:215], v[214:215], v[218:219]
    v_pk_add_f32 v[216:217], v[28:29], v[124:125]
    v_pk_add_f32 v[218:219], v[30:31], v[126:127]
    v_pk_add_f32 v[124:125], v[28:29], v[124:125] neg_lo:[0,1] neg_hi:[0,1]
    v_pk_add_f32 v[126:127], v[30:31], v[126:127] neg_lo:[0,1] neg_hi:[0,1]
    v_pk_fma_f32 v[28:29], v[216:217], s[30:31], v[212:213] op_sel:[0,1,0]
    v_pk_fma_f32 v[30:31], v[218:219], s[30:31], v[214:215] op_sel:[0,1,0]
    v_pk_fma_f32 v[212:213], v[212:213], s[30:31], v[216:217] op_sel_hi:[1,0,1]
    v_pk_fma_f32 v[214:215], v[214:215], s[30:31], v[218:219] op_sel_hi:[1,0,1]
    v_cvt_pk_bf16_f32 v196, v212, v213
    v_cvt_pk_bf16_f32 v197, v214, v215
    ds_write_b128 v248, v[194:197] offset:768
    v_accvgpr_read_b32 v204, a32
    v_accvgpr_read_b32 v205, a33
    v_accvgpr_read_b32 v206, a34
    v_accvgpr_read_b32 v207, a35
    v_accvgpr_read_b32 v208, a128
    v_accvgpr_read_b32 v209, a129
    v_accvgpr_read_b32 v210, a130
    v_accvgpr_read_b32 v211, a131
    v_pk_add_f32 v[204:205], v[204:205], v[208:209]
    v_pk_add_f32 v[206:207], v[206:207], v[210:211]
    v_pk_add_f32 v[208:209], v[32:33], v[128:129]
    v_pk_add_f32 v[210:211], v[34:35], v[130:131]
    v_pk_add_f32 v[128:129], v[32:33], v[128:129] neg_lo:[0,1] neg_hi:[0,1]
    v_pk_add_f32 v[130:131], v[34:35], v[130:131] neg_lo:[0,1] neg_hi:[0,1]
    v_pk_fma_f32 v[32:33], v[208:209], s[30:31], v[204:205] op_sel:[0,1,0]
    v_pk_fma_f32 v[34:35], v[210:211], s[30:31], v[206:207] op_sel:[0,1,0]
    v_pk_fma_f32 v[204:205], v[204:205], s[30:31], v[208:209] op_sel_hi:[1,0,1]
    v_pk_fma_f32 v[206:207], v[206:207], s[30:31], v[210:211] op_sel_hi:[1,0,1]
    v_cvt_pk_bf16_f32 v198, v204, v205
    v_cvt_pk_bf16_f32 v199, v206, v207
    v_accvgpr_read_b32 v204, a36
    v_accvgpr_read_b32 v205, a37
    v_accvgpr_read_b32 v206, a38
    v_accvgpr_read_b32 v207, a39
    v_accvgpr_read_b32 v208, a132
    v_accvgpr_read_b32 v209, a133
    v_accvgpr_read_b32 v210, a134
    v_accvgpr_read_b32 v211, a135
    v_pk_add_f32 v[204:205], v[204:205], v[208:209]
    v_pk_add_f32 v[206:207], v[206:207], v[210:211]
    v_pk_add_f32 v[208:209], v[36:37], v[132:133]
    v_pk_add_f32 v[210:211], v[38:39], v[134:135]
    v_pk_add_f32 v[132:133], v[36:37], v[132:133] neg_lo:[0,1] neg_hi:[0,1]
    v_pk_add_f32 v[134:135], v[38:39], v[134:135] neg_lo:[0,1] neg_hi:[0,1]
    v_pk_fma_f32 v[36:37], v[208:209], s[30:31], v[204:205] op_sel:[0,1,0]
    v_pk_fma_f32 v[38:39], v[210:211], s[30:31], v[206:207] op_sel:[0,1,0]
    v_pk_fma_f32 v[204:205], v[204:205], s[30:31], v[208:209] op_sel_hi:[1,0,1]
    v_pk_fma_f32 v[206:207], v[206:207], s[30:31], v[210:211] op_sel_hi:[1,0,1]
    v_cvt_pk_bf16_f32 v220, v204, v205
    v_cvt_pk_bf16_f32 v221, v206, v207
    ds_write_b64 v249, v[198:199] offset:832
    v_accvgpr_read_b32 v212, a40
    v_accvgpr_read_b32 v213, a41
    v_accvgpr_read_b32 v214, a42
    v_accvgpr_read_b32 v215, a43
    v_accvgpr_read_b32 v216, a136
    v_accvgpr_read_b32 v217, a137
    v_accvgpr_read_b32 v218, a138
    v_accvgpr_read_b32 v219, a139
    v_pk_add_f32 v[212:213], v[212:213], v[216:217]
    v_pk_add_f32 v[214:215], v[214:215], v[218:219]
    v_pk_add_f32 v[216:217], v[40:41], v[136:137]
    v_pk_add_f32 v[218:219], v[42:43], v[138:139]
    v_pk_add_f32 v[136:137], v[40:41], v[136:137] neg_lo:[0,1] neg_hi:[0,1]
    v_pk_add_f32 v[138:139], v[42:43], v[138:139] neg_lo:[0,1] neg_hi:[0,1]
    v_pk_fma_f32 v[40:41], v[216:217], s[30:31], v[212:213] op_sel:[0,1,0]
    v_pk_fma_f32 v[42:43], v[218:219], s[30:31], v[214:215] op_sel:[0,1,0]
    v_pk_fma_f32 v[212:213], v[212:213], s[30:31], v[216:217] op_sel_hi:[1,0,1]
    v_pk_fma_f32 v[214:215], v[214:215], s[30:31], v[218:219] op_sel_hi:[1,0,1]
    v_cvt_pk_bf16_f32 v222, v212, v213
    v_cvt_pk_bf16_f32 v223, v214, v215
    ds_write_b128 v248, v[220:223] offset:1152
    v_accvgpr_read_b32 v204, a44
    v_accvgpr_read_b32 v205, a45
    v_accvgpr_read_b32 v206, a46
    v_accvgpr_read_b32 v207, a47
    v_accvgpr_read_b32 v208, a140
    v_accvgpr_read_b32 v209, a141
    v_accvgpr_read_b32 v210, a142
    v_accvgpr_read_b32 v211, a143
    v_pk_add_f32 v[204:205], v[204:205], v[208:209]
    v_pk_add_f32 v[206:207], v[206:207], v[210:211]
    v_pk_add_f32 v[208:209], v[44:45], v[140:141]
    v_pk_add_f32 v[210:211], v[46:47], v[142:143]
    v_pk_add_f32 v[140:141], v[44:45], v[140:141] neg_lo:[0,1] neg_hi:[0,1]
    v_pk_add_f32 v[142:143], v[46:47], v[142:143] neg_lo:[0,1] neg_hi:[0,1]
    v_pk_fma_f32 v[44:45], v[208:209], s[30:31], v[204:205] op_sel:[0,1,0]
    v_pk_fma_f32 v[46:47], v[210:211], s[30:31], v[206:207] op_sel:[0,1,0]
    v_pk_fma_f32 v[204:205], v[204:205], s[30:31], v[208:209] op_sel_hi:[1,0,1]
    v_pk_fma_f32 v[206:207], v[206:207], s[30:31], v[210:211] op_sel_hi:[1,0,1]
    v_cvt_pk_bf16_f32 v224, v204, v205
    v_cvt_pk_bf16_f32 v225, v206, v207
    v_accvgpr_read_b32 v204, a48
    v_accvgpr_read_b32 v205, a49
    v_accvgpr_read_b32 v206, a50
    v_accvgpr_read_b32 v207, a51
    v_accvgpr_read_b32 v208, a144
    v_accvgpr_read_b32 v209, a145
    v_accvgpr_read_b32 v210, a146
    v_accvgpr_read_b32 v211, a147
    v_pk_add_f32 v[204:205], v[204:205], v[208:209]
    v_pk_add_f32 v[206:207], v[206:207], v[210:211]
    v_pk_add_f32 v[208:209], v[48:49], v[144:145]
    v_pk_add_f32 v[210:211], v[50:51], v[146:147]
    v_pk_add_f32 v[144:145], v[48:49], v[144:145] neg_lo:[0,1] neg_hi:[0,1]
    v_pk_add_f32 v[146:147], v[50:51], v[146:147] neg_lo:[0,1] neg_hi:[0,1]
    v_pk_fma_f32 v[48:49], v[208:209], s[30:31], v[204:205] op_sel:[0,1,0]
    v_pk_fma_f32 v[50:51], v[210:211], s[30:31], v[206:207] op_sel:[0,1,0]
    v_pk_fma_f32 v[204:205], v[204:205], s[30:31], v[208:209] op_sel_hi:[1,0,1]
    v_pk_fma_f32 v[206:207], v[206:207], s[30:31], v[210:211] op_sel_hi:[1,0,1]
    v_cvt_pk_bf16_f32 v194, v204, v205
    v_cvt_pk_bf16_f32 v195, v206, v207
    ds_write_b64 v249, v[224:225] offset:1216
    v_accvgpr_read_b32 v212, a52
    v_accvgpr_read_b32 v213, a53
    v_accvgpr_read_b32 v214, a54
    v_accvgpr_read_b32 v215, a55
    v_accvgpr_read_b32 v216, a148
    v_accvgpr_read_b32 v217, a149
    v_accvgpr_read_b32 v218, a150
    v_accvgpr_read_b32 v219, a151
    v_pk_add_f32 v[212:213], v[212:213], v[216:217]
    v_pk_add_f32 v[214:215], v[214:215], v[218:219]
    v_pk_add_f32 v[216:217], v[52:53], v[148:149]
    v_pk_add_f32 v[218:219], v[54:55], v[150:151]
    v_pk_add_f32 v[148:149], v[52:53], v[148:149] neg_lo:[0,1] neg_hi:[0,1]
    v_pk_add_f32 v[150:151], v[54:55], v[150:151] neg_lo:[0,1] neg_hi:[0,1]
    v_pk_fma_f32 v[52:53], v[216:217], s[30:31], v[212:213] op_sel:[0,1,0]
    v_pk_fma_f32 v[54:55], v[218:219], s[30:31], v[214:215] op_sel:[0,1,0]
    v_pk_fma_f32 v[212:213], v[212:213], s[30:31], v[216:217] op_sel_hi:[1,0,1]
    v_pk_fma_f32 v[214:215], v[214:215], s[30:31], v[218:219] op_sel_hi:[1,0,1]
    v_cvt_pk_bf16_f32 v196, v212, v213
    v_cvt_pk_bf16_f32 v197, v214, v215
    ds_write_b128 v248, v[194:197] offset:1536
    v_accvgpr_read_b32 v204, a56
    v_accvgpr_read_b32 v205, a57
    v_accvgpr_read_b32 v206, a58
    v_accvgpr_read_b32 v207, a59
    v_accvgpr_read_b32 v208, a152
    v_accvgpr_read_b32 v209, a153
    v_accvgpr_read_b32 v210, a154
    v_accvgpr_read_b32 v211, a155
    v_pk_add_f32 v[204:205], v[204:205], v[208:209]
    v_pk_add_f32 v[206:207], v[206:207], v[210:211]
    v_pk_add_f32 v[208:209], v[56:57], v[152:153]
    v_pk_add_f32 v[210:211], v[58:59], v[154:155]
    v_pk_add_f32 v[152:153], v[56:57], v[152:153] neg_lo:[0,1] neg_hi:[0,1]
    v_pk_add_f32 v[154:155], v[58:59], v[154:155] neg_lo:[0,1] neg_hi:[0,1]
    v_pk_fma_f32 v[56:57], v[208:209], s[30:31], v[204:205] op_sel:[0,1,0]
    v_pk_fma_f32 v[58:59], v[210:211], s[30:31], v[206:207] op_sel:[0,1,0]
    v_pk_fma_f32 v[204:205], v[204:205], s[30:31], v[208:209] op_sel_hi:[1,0,1]
    v_pk_fma_f32 v[206:207], v[206:207], s[30:31], v[210:211] op_sel_hi:[1,0,1]
    v_cvt_pk_bf16_f32 v198, v204, v205
    v_cvt_pk_bf16_f32 v199, v206, v207
    v_accvgpr_read_b32 v204, a60
    v_accvgpr_read_b32 v205, a61
    v_accvgpr_read_b32 v206, a62
    v_accvgpr_read_b32 v207, a63
    v_accvgpr_read_b32 v208, a156
    v_accvgpr_read_b32 v209, a157
    v_accvgpr_read_b32 v210, a158
    v_accvgpr_read_b32 v211, a159
    v_pk_add_f32 v[204:205], v[204:205], v[208:209]
    v_pk_add_f32 v[206:207], v[206:207], v[210:211]
    v_pk_add_f32 v[208:209], v[60:61], v[156:157]
    v_pk_add_f32 v[210:211], v[62:63], v[158:159]
    v_pk_add_f32 v[156:157], v[60:61], v[156:157] neg_lo:[0,1] neg_hi:[0,1]
    v_pk_add_f32 v[158:159], v[62:63], v[158:159] neg_lo:[0,1] neg_hi:[0,1]
    v_pk_fma_f32 v[60:61], v[208:209], s[30:31], v[204:205] op_sel:[0,1,0]
    v_pk_fma_f32 v[62:63], v[210:211], s[30:31], v[206:207] op_sel:[0,1,0]
    v_pk_fma_f32 v[204:205], v[204:205], s[30:31], v[208:209] op_sel_hi:[1,0,1]
    v_pk_fma_f32 v[206:207], v[206:207], s[30:31], v[210:211] op_sel_hi:[1,0,1]
    v_cvt_pk_bf16_f32 v220, v204, v205
    v_cvt_pk_bf16_f32 v221, v206, v207
    ds_write_b64 v249, v[198:199] offset:1600
    v_accvgpr_read_b32 v212, a64
    v_accvgpr_read_b32 v213, a65
    v_accvgpr_read_b32 v214, a66
    v_accvgpr_read_b32 v215, a67
    v_accvgpr_read_b32 v216, a160
    v_accvgpr_read_b32 v217, a161
    v_accvgpr_read_b32 v218, a162
    v_accvgpr_read_b32 v219, a163
    v_pk_add_f32 v[212:213], v[212:213], v[216:217]
    v_pk_add_f32 v[214:215], v[214:215], v[218:219]
    v_pk_add_f32 v[216:217], v[64:65], v[160:161]
    v_pk_add_f32 v[218:219], v[66:67], v[162:163]
    v_pk_add_f32 v[160:161], v[64:65], v[160:161] neg_lo:[0,1] neg_hi:[0,1]
    v_pk_add_f32 v[162:163], v[66:67], v[162:163] neg_lo:[0,1] neg_hi:[0,1]
    v_pk_fma_f32 v[64:65], v[216:217], s[30:31], v[212:213] op_sel:[0,1,0]
    v_pk_fma_f32 v[66:67], v[218:219], s[30:31], v[214:215] op_sel:[0,1,0]
    v_pk_fma_f32 v[212:213], v[212:213], s[30:31], v[216:217] op_sel_hi:[1,0,1]
    v_pk_fma_f32 v[214:215], v[214:215], s[30:31], v[218:219] op_sel_hi:[1,0,1]
    v_cvt_pk_bf16_f32 v222, v212, v213
    v_cvt_pk_bf16_f32 v223, v214, v215
    ds_write_b128 v248, v[220:223] offset:1920
    v_accvgpr_read_b32 v204, a68
    v_accvgpr_read_b32 v205, a69
    v_accvgpr_read_b32 v206, a70
    v_accvgpr_read_b32 v207, a71
    v_accvgpr_read_b32 v208, a164
    v_accvgpr_read_b32 v209, a165
    v_accvgpr_read_b32 v210, a166
    v_accvgpr_read_b32 v211, a167
    v_pk_add_f32 v[204:205], v[204:205], v[208:209]
    v_pk_add_f32 v[206:207], v[206:207], v[210:211]
    v_pk_add_f32 v[208:209], v[68:69], v[164:165]
    v_pk_add_f32 v[210:211], v[70:71], v[166:167]
    v_pk_add_f32 v[164:165], v[68:69], v[164:165] neg_lo:[0,1] neg_hi:[0,1]
    v_pk_add_f32 v[166:167], v[70:71], v[166:167] neg_lo:[0,1] neg_hi:[0,1]
    v_pk_fma_f32 v[68:69], v[208:209], s[30:31], v[204:205] op_sel:[0,1,0]
    v_pk_fma_f32 v[70:71], v[210:211], s[30:31], v[206:207] op_sel:[0,1,0]
    v_pk_fma_f32 v[204:205], v[204:205], s[30:31], v[208:209] op_sel_hi:[1,0,1]
    v_pk_fma_f32 v[206:207], v[206:207], s[30:31], v[210:211] op_sel_hi:[1,0,1]
    v_cvt_pk_bf16_f32 v224, v204, v205
    v_cvt_pk_bf16_f32 v225, v206, v207
    v_accvgpr_read_b32 v204, a72
    v_accvgpr_read_b32 v205, a73
    v_accvgpr_read_b32 v206, a74
    v_accvgpr_read_b32 v207, a75
    v_accvgpr_read_b32 v208, a168
    v_accvgpr_read_b32 v209, a169
    v_accvgpr_read_b32 v210, a170
    v_accvgpr_read_b32 v211, a171
    v_pk_add_f32 v[204:205], v[204:205], v[208:209]
    v_pk_add_f32 v[206:207], v[206:207], v[210:211]
    v_pk_add_f32 v[208:209], v[72:73], v[168:169]
    v_pk_add_f32 v[210:211], v[74:75], v[170:171]
    v_pk_add_f32 v[168:169], v[72:73], v[168:169] neg_lo:[0,1] neg_hi:[0,1]
    v_pk_add_f32 v[170:171], v[74:75], v[170:171] neg_lo:[0,1] neg_hi:[0,1]
    v_pk_fma_f32 v[72:73], v[208:209], s[30:31], v[204:205] op_sel:[0,1,0]
    v_pk_fma_f32 v[74:75], v[210:211], s[30:31], v[206:207] op_sel:[0,1,0]
    v_pk_fma_f32 v[204:205], v[204:205], s[30:31], v[208:209] op_sel_hi:[1,0,1]
    v_pk_fma_f32 v[206:207], v[206:207], s[30:31], v[210:211] op_sel_hi:[1,0,1]
    v_cvt_pk_bf16_f32 v194, v204, v205
    v_cvt_pk_bf16_f32 v195, v206, v207
    ds_write_b64 v249, v[224:225] offset:1984
    v_accvgpr_read_b32 v212, a76
    v_accvgpr_read_b32 v213, a77
    v_accvgpr_read_b32 v214, a78
    v_accvgpr_read_b32 v215, a79
    v_accvgpr_read_b32 v216, a172
    v_accvgpr_read_b32 v217, a173
    v_accvgpr_read_b32 v218, a174
    v_accvgpr_read_b32 v219, a175
    v_pk_add_f32 v[212:213], v[212:213], v[216:217]
    v_pk_add_f32 v[214:215], v[214:215], v[218:219]
    v_pk_add_f32 v[216:217], v[76:77], v[172:173]
    v_pk_add_f32 v[218:219], v[78:79], v[174:175]
    v_pk_add_f32 v[172:173], v[76:77], v[172:173] neg_lo:[0,1] neg_hi:[0,1]
    v_pk_add_f32 v[174:175], v[78:79], v[174:175] neg_lo:[0,1] neg_hi:[0,1]
    v_pk_fma_f32 v[76:77], v[216:217], s[30:31], v[212:213] op_sel:[0,1,0]
    v_pk_fma_f32 v[78:79], v[218:219], s[30:31], v[214:215] op_sel:[0,1,0]
    v_pk_fma_f32 v[212:213], v[212:213], s[30:31], v[216:217] op_sel_hi:[1,0,1]
    v_pk_fma_f32 v[214:215], v[214:215], s[30:31], v[218:219] op_sel_hi:[1,0,1]
    v_cvt_pk_bf16_f32 v196, v212, v213
    v_cvt_pk_bf16_f32 v197, v214, v215
    ds_write_b128 v248, v[194:197] offset:2304
    v_accvgpr_read_b32 v204, a80
    v_accvgpr_read_b32 v205, a81
    v_accvgpr_read_b32 v206, a82
    v_accvgpr_read_b32 v207, a83
    v_accvgpr_read_b32 v208, a176
    v_accvgpr_read_b32 v209, a177
    v_accvgpr_read_b32 v210, a178
    v_accvgpr_read_b32 v211, a179
    v_pk_add_f32 v[204:205], v[204:205], v[208:209]
    v_pk_add_f32 v[206:207], v[206:207], v[210:211]
    v_pk_add_f32 v[208:209], v[80:81], v[176:177]
    v_pk_add_f32 v[210:211], v[82:83], v[178:179]
    v_pk_add_f32 v[176:177], v[80:81], v[176:177] neg_lo:[0,1] neg_hi:[0,1]
    v_pk_add_f32 v[178:179], v[82:83], v[178:179] neg_lo:[0,1] neg_hi:[0,1]
    v_pk_fma_f32 v[80:81], v[208:209], s[30:31], v[204:205] op_sel:[0,1,0]
    v_pk_fma_f32 v[82:83], v[210:211], s[30:31], v[206:207] op_sel:[0,1,0]
    v_pk_fma_f32 v[204:205], v[204:205], s[30:31], v[208:209] op_sel_hi:[1,0,1]
    v_pk_fma_f32 v[206:207], v[206:207], s[30:31], v[210:211] op_sel_hi:[1,0,1]
    v_cvt_pk_bf16_f32 v198, v204, v205
    v_cvt_pk_bf16_f32 v199, v206, v207
    ds_write_b64 v249, v[198:199] offset:2368
    s_waitcnt lgkmcnt(0)
    s_barrier
sub24:
    v_mfma_f32_16x16x32_bf16 v[0:3], a[192:195], v[228:231], v[0:3]
    buffer_load_dwordx4 a[236:239], v254, s[8:11], s42 offen offset:2048 sc1
    v_mfma_f32_16x16x32_bf16 v[4:7], a[196:199], v[228:231], v[4:7]
    s_mov_b32 s42, 961536
    v_accvgpr_read_b32 v204, a84
    v_accvgpr_read_b32 v205, a85
    v_mfma_f32_16x16x32_bf16 v[8:11], a[200:203], v[228:231], v[8:11]
    ds_read_b128 v[228:231], v253 offset:14816
    s_waitcnt vmcnt(7)
    v_mfma_f32_16x16x32_bf16 v[8:11], a[212:215], v[232:235], v[8:11]
    ds_read_b128 v[212:215], v250 offset:0
    v_accvgpr_read_b32 v206, a86
    v_mfma_f32_16x16x32_bf16 v[4:7], a[208:211], v[232:235], v[4:7]
    buffer_load_dwordx4 a[240:243], v254, s[8:11], s42 offen offset:0 sc1
    v_mfma_f32_16x16x32_bf16 v[0:3], a[204:207], v[232:235], v[0:3]
    s_waitcnt vmcnt(5)
    v_accvgpr_read_b32 v207, a87
    v_add_f32 v208, v84, v180
    v_mfma_f32_16x16x32_bf16 v[0:3], a[216:219], v[236:239], v[0:3]
    ds_read_b128 v[216:219], v250 offset:3104
    v_add_f32 v209, v85, v181
    v_mfma_f32_16x16x32_bf16 v[4:7], a[220:223], v[236:239], v[4:7]
    ds_read_b128 v[220:223], v250 offset:6208
    s_add_u32 s44, s40, 393216
    v_mfma_f32_16x16x32_bf16 v[8:11], a[224:227], v[236:239], v[8:11]
    buffer_load_dwordx4 a[244:247], v254, s[8:11], s42 offen offset:1024 sc1
    v_mfma_f32_16x16x32_bf16 v[12:15], a[192:195], v[232:235], v[12:15]
    ds_read_b128 v[224:227], v250 offset:9312
    v_add_f32 v210, v86, v182
    v_mfma_f32_16x16x32_bf16 v[12:15], a[204:207], v[236:239], v[12:15]
    s_waitcnt lgkmcnt(4)
    v_add_f32 v211, v87, v183
    v_sub_f32 v180, v84, v180
    v_mfma_f32_16x16x32_bf16 v[12:15], a[216:219], v[228:231], v[12:15]
pad9:
    s_cbranch_vccnz pad13
    s_waitcnt lgkmcnt(3)
    v_sub_f32 v181, v85, v181
    v_sub_f32 v182, v86, v182
    v_mfma_f32_16x16x32_bf16 v[16:19], a[220:223], v[228:231], v[16:19]
    buffer_load_dwordx4 a[248:251], v254, s[8:11], s42 offen offset:2048 sc1
    v_mfma_f32_16x16x32_bf16 v[16:19], a[208:211], v[236:239], v[16:19]
    s_mov_b32 s42, 964608
    v_sub_f32 v183, v87, v183
    v_fma_f32 v84, v208, s31, v204
    v_mfma_f32_16x16x32_bf16 v[16:19], a[196:199], v[232:235], v[16:19]
    v_fma_f32 v85, v209, s31, v205
    v_fma_f32 v86, v210, s31, v206
    v_mfma_f32_16x16x32_bf16 v[20:23], a[200:203], v[232:235], v[20:23]
    ds_read_b128 v[232:235], v253 offset:14560
    v_fma_f32 v87, v211, s31, v207
    v_mfma_f32_16x16x32_bf16 v[20:23], a[212:215], v[236:239], v[20:23]
    buffer_load_dwordx4 a[252:255], v254, s[8:11], s42 offen offset:0 sc1
    v_mfma_f32_16x16x32_bf16 v[20:23], a[224:227], v[228:231], v[20:23]
    v_fmac_f32 v208, s30, v204
    v_fmac_f32 v209, s30, v205
    v_mfma_f32_16x16x32_bf16 v[24:27], a[192:195], v[236:239], v[24:27]
    v_fmac_f32 v210, s30, v206
    v_fmac_f32 v211, s30, v207
    v_mfma_f32_16x16x32_bf16 v[24:27], a[204:207], v[228:231], v[24:27]
    s_waitcnt lgkmcnt(0)
    v_cvt_pk_bf16_f32 v192, v208, v209
    v_cvt_pk_bf16_f32 v193, v210, v211
    v_mfma_f32_16x16x32_bf16 v[24:27], a[216:219], v[232:235], v[24:27]
    v_accvgpr_read_b32 v204, a88
    v_accvgpr_read_b32 v205, a89
    v_mfma_f32_16x16x32_bf16 v[28:31], a[220:223], v[232:235], v[28:31]
    buffer_load_dwordx4 v[240:243], v254, s[8:11], s42 offen offset:1024 sc1
    v_mfma_f32_16x16x32_bf16 v[28:31], a[208:211], v[228:231], v[28:31]
    v_accvgpr_read_b32 v206, a90
    v_accvgpr_read_b32 v207, a91
    v_mfma_f32_16x16x32_bf16 v[28:31], a[196:199], v[236:239], v[28:31]
    v_add_f32 v208, v88, v184
    v_add_f32 v209, v89, v185
    v_mfma_f32_16x16x32_bf16 v[32:35], a[200:203], v[236:239], v[32:35]
    ds_read_b128 v[236:239], v253 offset:16384
    v_add_f32 v210, v90, v186
    v_mfma_f32_16x16x32_bf16 v[32:35], a[212:215], v[228:231], v[32:35]
    buffer_load_dwordx4 v[244:247], v254, s[8:11], s42 offen offset:2048 sc1
    v_mfma_f32_16x16x32_bf16 v[32:35], a[224:227], v[232:235], v[32:35]
    v_add_f32 v211, v91, v187
    v_sub_f32 v184, v88, v184
    v_mfma_f32_16x16x32_bf16 v[36:39], a[192:195], v[228:231], v[36:39]
    v_sub_f32 v185, v89, v185
    v_sub_f32 v186, v90, v186
    v_mfma_f32_16x16x32_bf16 v[36:39], a[204:207], v[232:235], v[36:39]
    s_waitcnt lgkmcnt(0)
    v_sub_f32 v187, v91, v187
    v_fma_f32 v88, v208, s31, v204
    v_mfma_f32_16x16x32_bf16 v[36:39], a[216:219], v[236:239], v[36:39]
    buffer_store_dwordx4 v[212:215], v254, s[12:15], s44 offen nt
    s_add_u32 s44, s40, 396288
    v_mfma_f32_16x16x32_bf16 v[40:43], a[220:223], v[236:239], v[40:43]
    v_fma_f32 v89, v209, s31, v205
    v_fma_f32 v90, v210, s31, v206
    v_mfma_f32_16x16x32_bf16 v[40:43], a[208:211], v[232:235], v[40:43]
    v_fma_f32 v91, v211, s31, v207
    v_fmac_f32 v208, s30, v204
    v_mfma_f32_16x16x32_bf16 v[40:43], a[196:199], v[228:231], v[40:43]
    buffer_store_dwordx4 v[216:219], v254, s[12:15], s44 offen nt
    v_fmac_f32 v209, s30, v205
    v_fmac_f32 v210, s30, v206
    v_mfma_f32_16x16x32_bf16 v[44:47], a[200:203], v[228:231], v[44:47]
    ds_read_b128 v[228:231], v253 offset:16128
    v_fmac_f32 v211, s30, v207
    v_mfma_f32_16x16x32_bf16 v[44:47], a[212:215], v[232:235], v[44:47]
    ds_read_b128 v[212:215], v250 offset:1024
    v_cvt_pk_bf16_f32 v194, v208, v209
    v_mfma_f32_16x16x32_bf16 v[44:47], a[224:227], v[236:239], v[44:47]
    s_add_u32 s44, s40, 399360
    v_cvt_pk_bf16_f32 v195, v210, v211
    v_accvgpr_read_b32 v204, a92
    v_mfma_f32_16x16x32_bf16 v[48:51], a[192:195], v[232:235], v[48:51]
    ds_read_b128 v[216:219], v250 offset:4128
    v_accvgpr_read_b32 v205, a93
    v_mfma_f32_16x16x32_bf16 v[48:51], a[204:207], v[236:239], v[48:51]
    s_waitcnt lgkmcnt(2)
    v_accvgpr_read_b32 v206, a94
    v_accvgpr_read_b32 v207, a95
    v_mfma_f32_16x16x32_bf16 v[48:51], a[216:219], v[228:231], v[48:51]
    v_add_f32 v208, v92, v188
    v_add_f32 v209, v93, v189
    v_mfma_f32_16x16x32_bf16 v[52:55], a[220:223], v[228:231], v[52:55]
    v_add_f32 v210, v94, v190
    v_add_f32 v211, v95, v191
    v_mfma_f32_16x16x32_bf16 v[52:55], a[208:211], v[236:239], v[52:55]
    v_sub_f32 v188, v92, v188
    v_sub_f32 v189, v93, v189
    v_mfma_f32_16x16x32_bf16 v[52:55], a[196:199], v[232:235], v[52:55]
    v_sub_f32 v190, v94, v190
    v_sub_f32 v191, v95, v191
    v_mfma_f32_16x16x32_bf16 v[56:59], a[200:203], v[232:235], v[56:59]
    ds_read_b128 v[232:235], v253 offset:15872
    v_fma_f32 v92, v208, s31, v204
    v_mfma_f32_16x16x32_bf16 v[56:59], a[212:215], v[236:239], v[56:59]
    v_fma_f32 v93, v209, s31, v205
    v_fma_f32 v94, v210, s31, v206
    v_mfma_f32_16x16x32_bf16 v[56:59], a[224:227], v[228:231], v[56:59]
    buffer_store_dwordx4 v[220:223], v254, s[12:15], s44 offen nt
    v_fma_f32 v95, v211, s31, v207
    v_fmac_f32 v208, s30, v204
    v_mfma_f32_16x16x32_bf16 v[60:63], a[192:195], v[236:239], v[60:63]
    v_fmac_f32 v209, s30, v205
    v_fmac_f32 v210, s30, v206
    v_mfma_f32_16x16x32_bf16 v[60:63], a[204:207], v[228:231], v[60:63]
    s_waitcnt lgkmcnt(0)
    v_fmac_f32 v211, s30, v207
    v_cvt_pk_bf16_f32 v196, v208, v209
    v_mfma_f32_16x16x32_bf16 v[60:63], a[216:219], v[232:235], v[60:63]
    v_cvt_pk_bf16_f32 v197, v210, v211
    v_accvgpr_read_b32 v204, a96
    v_mfma_f32_16x16x32_bf16 v[64:67], a[220:223], v[232:235], v[64:67]
    ds_write_b64 v249, v[196:197] offset:2752
    v_mfma_f32_16x16x32_bf16 v[64:67], a[208:211], v[228:231], v[64:67]
    s_add_u32 s44, s40, 402432
    v_accvgpr_read_b32 v205, a97
    v_accvgpr_read_b32 v206, a98
    v_mfma_f32_16x16x32_bf16 v[64:67], a[196:199], v[236:239], v[64:67]
    ds_write_b128 v248, v[192:195] offset:2688
    v_mfma_f32_16x16x32_bf16 v[68:71], a[200:203], v[236:239], v[68:71]
    ds_read_b128 v[236:239], v253 offset:15616
    v_accvgpr_read_b32 v207, a99
    v_fma_f32 v208, v204, s34, v96 div:2
    v_mfma_f32_16x16x32_bf16 v[68:71], a[212:215], v[228:231], v[68:71]
    v_fma_f32 v209, v205, s34, v97 div:2
    v_fma_f32 v210, v206, s34, v98 div:2
    v_mfma_f32_16x16x32_bf16 v[68:71], a[224:227], v[232:235], v[68:71]
    v_fma_f32 v211, v207, s34, v99 div:2
    v_fma_f32 v96, v204, s35, v96 mul:2
    v_mfma_f32_16x16x32_bf16 v[72:75], a[192:195], v[228:231], v[72:75]
    v_fma_f32 v97, v205, s35, v97 mul:2
    v_fma_f32 v98, v206, s35, v98 mul:2
    v_mfma_f32_16x16x32_bf16 v[72:75], a[204:207], v[232:235], v[72:75]
    s_waitcnt lgkmcnt(0)
    v_fma_f32 v99, v207, s35, v99 mul:2
    v_cvt_pk_bf16_f32 v198, v208, v209
    v_mfma_f32_16x16x32_bf16 v[72:75], a[216:219], v[236:239], v[72:75]
    v_cvt_pk_bf16_f32 v199, v210, v211
    v_accvgpr_write_b32 a0, v198
    v_mfma_f32_16x16x32_bf16 v[76:79], a[220:223], v[236:239], v[76:79]
    v_accvgpr_write_b32 a1, v199
    v_accvgpr_read_b32 v204, a100
    v_mfma_f32_16x16x32_bf16 v[76:79], a[208:211], v[232:235], v[76:79]
    buffer_store_dwordx4 v[224:227], v254, s[12:15], s44 offen nt
    v_accvgpr_read_b32 v205, a101
    v_accvgpr_read_b32 v206, a102
    v_mfma_f32_16x16x32_bf16 v[76:79], a[196:199], v[228:231], v[76:79]
    v_accvgpr_read_b32 v207, a103
    v_fma_f32 v208, v204, s34, v100 div:2
    v_mfma_f32_16x16x32_bf16 v[80:83], a[200:203], v[228:231], v[80:83]
    ds_read_b128 v[228:231], v253 offset:15344
    v_fma_f32 v209, v205, s34, v101 div:2
    v_mfma_f32_16x16x32_bf16 v[80:83], a[212:215], v[232:235], v[80:83]
    v_fma_f32 v210, v206, s34, v102 div:2
    v_fma_f32 v211, v207, s34, v103 div:2
    v_fma_f32 v100, v204, s35, v100 mul:2
    v_mfma_f32_16x16x32_bf16 v[80:83], a[224:227], v[236:239], v[80:83]
    s_mov_b32 s42, 995328
    v_fma_f32 v101, v205, s35, v101 mul:2
    v_fma_f32 v102, v206, s35, v102 mul:2
    v_mfma_f32_16x16x32_bf16 v[84:87], a[192:195], v[232:235], v[84:87]
    s_waitcnt lgkmcnt(0)
    v_fma_f32 v103, v207, s35, v103 mul:2
    v_cvt_pk_bf16_f32 v200, v208, v209
    v_mfma_f32_16x16x32_bf16 v[88:91], a[196:199], v[232:235], v[88:91]
    s_barrier
    v_mfma_f32_16x16x32_bf16 v[92:95], a[200:203], v[232:235], v[92:95]
    ds_read_b128 v[232:235], v253 offset:17680
    v_cvt_pk_bf16_f32 v201, v210, v211
    v_mfma_f32_16x16x32_bf16 v[92:95], a[212:215], v[236:239], v[92:95]
    buffer_load_dwordx4 a[192:195], v254, s[8:11], s42 offen offset:0 sc1
    v_mfma_f32_16x16x32_bf16 v[88:91], a[208:211], v[236:239], v[88:91]
    v_accvgpr_write_b32 a2, v200
    v_accvgpr_write_b32 a3, v201
    v_mfma_f32_16x16x32_bf16 v[84:87], a[204:207], v[236:239], v[84:87]
    ds_read_b128 v[236:239], v253 offset:17408
    v_accvgpr_read_b32 v204, a104
    v_mfma_f32_16x16x32_bf16 v[84:87], a[216:219], v[228:231], v[84:87]
    buffer_load_dwordx4 a[196:199], v254, s[8:11], s42 offen offset:1024 sc1
    v_mfma_f32_16x16x32_bf16 v[88:91], a[220:223], v[228:231], v[88:91]
    s_waitcnt vmcnt(12) lgkmcnt(1)
    v_accvgpr_read_b32 v205, a105
    v_accvgpr_read_b32 v206, a106
    v_mfma_f32_16x16x32_bf16 v[92:95], a[224:227], v[228:231], v[92:95]
    ds_read_b128 v[228:231], v253 offset:17152
    v_accvgpr_read_b32 v207, a107
    v_fma_f32 v208, v204, s34, v104 div:2
sub25:
    v_mfma_f32_16x16x32_bf16 v[0:3], a[228:231], v[232:235], v[0:3]
    buffer_load_dwordx4 a[200:203], v254, s[8:11], s42 offen offset:2048 sc1
    v_mfma_f32_16x16x32_bf16 v[4:7], a[232:235], v[232:235], v[4:7]
    s_mov_b32 s42, 998400
    v_fma_f32 v209, v205, s34, v105 div:2
    v_fma_f32 v210, v206, s34, v106 div:2
    v_mfma_f32_16x16x32_bf16 v[8:11], a[236:239], v[232:235], v[8:11]
    ds_read_b128 v[232:235], v253 offset:16896
    s_waitcnt vmcnt(10)
    s_waitcnt lgkmcnt(2)
    v_mfma_f32_16x16x32_bf16 v[8:11], a[248:251], v[236:239], v[8:11]
    v_fma_f32 v211, v207, s34, v107 div:2
    v_fma_f32 v104, v204, s35, v104 mul:2
    v_mfma_f32_16x16x32_bf16 v[4:7], a[244:247], v[236:239], v[4:7]
    buffer_load_dwordx4 a[204:207], v254, s[8:11], s42 offen offset:0 sc1
    v_mfma_f32_16x16x32_bf16 v[0:3], a[240:243], v[236:239], v[0:3]
    s_waitcnt vmcnt(8) lgkmcnt(1)
    v_fma_f32 v105, v205, s35, v105 mul:2
    v_fma_f32 v106, v206, s35, v106 mul:2
    v_mfma_f32_16x16x32_bf16 v[0:3], a[252:255], v[228:231], v[0:3]
    s_add_u32 s44, s40, 394240
    v_fma_f32 v107, v207, s35, v107 mul:2
    v_cvt_pk_bf16_f32 v202, v208, v209
    v_mfma_f32_16x16x32_bf16 v[4:7], v[240:243], v[228:231], v[4:7]
    v_cvt_pk_bf16_f32 v203, v210, v211
    v_accvgpr_write_b32 a4, v202
    v_mfma_f32_16x16x32_bf16 v[8:11], v[244:247], v[228:231], v[8:11]
    buffer_load_dwordx4 a[208:211], v254, s[8:11], s42 offen offset:1024 sc1
    v_mfma_f32_16x16x32_bf16 v[12:15], a[228:231], v[236:239], v[12:15]
    v_accvgpr_write_b32 a5, v203
    v_accvgpr_read_b32 v204, a108
    v_accvgpr_read_b32 v205, a109
    v_mfma_f32_16x16x32_bf16 v[12:15], a[240:243], v[228:231], v[12:15]
    s_waitcnt lgkmcnt(0)
    v_accvgpr_read_b32 v206, a110
    v_accvgpr_read_b32 v207, a111
    v_mfma_f32_16x16x32_bf16 v[12:15], a[252:255], v[232:235], v[12:15]
    v_fma_f32 v208, v204, s34, v108 div:2
    v_fma_f32 v209, v205, s34, v109 div:2
    v_mfma_f32_16x16x32_bf16 v[16:19], v[240:243], v[232:235], v[16:19]
    buffer_load_dwordx4 a[212:215], v254, s[8:11], s42 offen offset:2048 sc1
    v_mfma_f32_16x16x32_bf16 v[16:19], a[244:247], v[228:231], v[16:19]
    s_mov_b32 s42, 1001472
    v_fma_f32 v210, v206, s34, v110 div:2
    v_fma_f32 v211, v207, s34, v111 div:2
    v_mfma_f32_16x16x32_bf16 v[16:19], a[232:235], v[236:239], v[16:19]
    v_fma_f32 v108, v204, s35, v108 mul:2
    v_fma_f32 v109, v205, s35, v109 mul:2
    v_mfma_f32_16x16x32_bf16 v[20:23], a[236:239], v[236:239], v[20:23]
    ds_read_b128 v[236:239], v253 offset:16640
    v_fma_f32 v110, v206, s35, v110 mul:2
    v_mfma_f32_16x16x32_bf16 v[20:23], a[248:251], v[228:231], v[20:23]
    buffer_load_dwordx4 a[216:219], v254, s[8:11], s42 offen offset:0 sc1
    v_mfma_f32_16x16x32_bf16 v[20:23], v[244:247], v[232:235], v[20:23]
    v_fma_f32 v111, v207, s35, v111 mul:2
    v_cvt_pk_bf16_f32 v192, v208, v209
    v_mfma_f32_16x16x32_bf16 v[24:27], a[228:231], v[228:231], v[24:27]
    v_cvt_pk_bf16_f32 v193, v210, v211
    v_accvgpr_write_b32 a12, v192
    v_mfma_f32_16x16x32_bf16 v[24:27], a[240:243], v[232:235], v[24:27]
    s_waitcnt lgkmcnt(0)
    v_accvgpr_write_b32 a13, v193
    v_accvgpr_read_b32 v204, a112
    v_accvgpr_read_b32 v205, a113
    v_mfma_f32_16x16x32_bf16 v[24:27], a[252:255], v[236:239], v[24:27]
    ds_read_b128 a[84:87], v250 offset:7232
    v_accvgpr_read_b32 v206, a114
    v_mfma_f32_16x16x32_bf16 v[28:31], v[240:243], v[236:239], v[28:31]
    buffer_load_dwordx4 a[220:223], v254, s[8:11], s42 offen offset:1024 sc1
    v_mfma_f32_16x16x32_bf16 v[28:31], a[244:247], v[232:235], v[28:31]
    v_accvgpr_read_b32 v207, a115
    v_fma_f32 v208, v204, s34, v112 div:2
    v_mfma_f32_16x16x32_bf16 v[28:31], a[232:235], v[228:231], v[28:31]
    v_fma_f32 v209, v205, s34, v113 div:2
    v_fma_f32 v210, v206, s34, v114 div:2
    v_mfma_f32_16x16x32_bf16 v[32:35], a[236:239], v[228:231], v[32:35]
    ds_read_b128 v[228:231], v253 offset:18464
    v_fma_f32 v211, v207, s34, v115 div:2
    v_mfma_f32_16x16x32_bf16 v[32:35], a[248:251], v[232:235], v[32:35]
    buffer_load_dwordx4 a[224:227], v254, s[8:11], s42 offen offset:2048 sc1
    v_mfma_f32_16x16x32_bf16 v[32:35], v[244:247], v[236:239], v[32:35]
    ds_read_b128 a[88:91], v250 offset:10336
    v_fma_f32 v112, v204, s35, v112 mul:2
    v_mfma_f32_16x16x32_bf16 v[36:39], a[228:231], v[232:235], v[36:39]
    v_fma_f32 v113, v205, s35, v113 mul:2
    v_fma_f32 v114, v206, s35, v114 mul:2
    v_mfma_f32_16x16x32_bf16 v[36:39], a[240:243], v[236:239], v[36:39]
    s_waitcnt lgkmcnt(1)
    v_fma_f32 v115, v207, s35, v115 mul:2
    v_cvt_pk_bf16_f32 v194, v208, v209
    v_mfma_f32_16x16x32_bf16 v[36:39], a[252:255], v[228:231], v[36:39]
    buffer_store_dwordx4 v[212:215], v254, s[12:15], s44 offen nt
    s_add_u32 s44, s40, 397312
    v_cvt_pk_bf16_f32 v195, v210, v211
    v_mfma_f32_16x16x32_bf16 v[40:43], v[240:243], v[228:231], v[40:43]
    v_accvgpr_write_b32 a14, v194
    v_accvgpr_write_b32 a15, v195
    v_mfma_f32_16x16x32_bf16 v[40:43], a[244:247], v[236:239], v[40:43]
    v_accvgpr_read_b32 v204, a116
    v_accvgpr_read_b32 v205, a117
    v_mfma_f32_16x16x32_bf16 v[40:43], a[232:235], v[232:235], v[40:43]
    buffer_store_dwordx4 v[216:219], v254, s[12:15], s44 offen nt
    v_accvgpr_read_b32 v206, a118
    v_accvgpr_read_b32 v207, a119
    v_mfma_f32_16x16x32_bf16 v[44:47], a[236:239], v[232:235], v[44:47]
    ds_read_b128 v[232:235], v253 offset:18208
    v_fma_f32 v208, v204, s34, v116 div:2
    v_mfma_f32_16x16x32_bf16 v[44:47], a[248:251], v[236:239], v[44:47]
    ds_read_b128 a[92:95], v250 offset:2048
    v_fma_f32 v209, v205, s34, v117 div:2
    v_mfma_f32_16x16x32_bf16 v[44:47], v[244:247], v[228:231], v[44:47]
    v_fma_f32 v210, v206, s34, v118 div:2
    v_fma_f32 v211, v207, s34, v119 div:2
    v_mfma_f32_16x16x32_bf16 v[48:51], a[228:231], v[236:239], v[48:51]
    v_fma_f32 v116, v204, s35, v116 mul:2
    v_fma_f32 v117, v205, s35, v117 mul:2
    v_mfma_f32_16x16x32_bf16 v[48:51], a[240:243], v[228:231], v[48:51]
    s_waitcnt lgkmcnt(1)
    s_add_u32 s44, s40, 400384
    v_fma_f32 v118, v206, s35, v118 mul:2
    v_mfma_f32_16x16x32_bf16 v[48:51], a[252:255], v[232:235], v[48:51]
    v_fma_f32 v119, v207, s35, v119 mul:2
    v_cvt_pk_bf16_f32 v196, v208, v209
    v_mfma_f32_16x16x32_bf16 v[52:55], v[240:243], v[232:235], v[52:55]
    ds_read_b128 a[96:99], v250 offset:5152
    v_cvt_pk_bf16_f32 v197, v210, v211
    v_accvgpr_write_b32 a16, v196
    v_mfma_f32_16x16x32_bf16 v[52:55], a[244:247], v[228:231], v[52:55]
    v_accvgpr_write_b32 a17, v197
    v_accvgpr_read_b32 v204, a120
    v_mfma_f32_16x16x32_bf16 v[52:55], a[232:235], v[236:239], v[52:55]
    v_accvgpr_read_b32 v205, a121
    v_accvgpr_read_b32 v206, a122
    v_mfma_f32_16x16x32_bf16 v[56:59], a[236:239], v[236:239], v[56:59]
    ds_read_b128 v[236:239], v253 offset:17952
    v_mfma_f32_16x16x32_bf16 v[56:59], a[248:251], v[228:231], v[56:59]
    v_accvgpr_read_b32 v207, a123
    v_fma_f32 v208, v204, s34, v120 div:2
    v_mfma_f32_16x16x32_bf16 v[56:59], v[244:247], v[232:235], v[56:59]
    v_fma_f32 v209, v205, s34, v121 div:2
    v_fma_f32 v210, v206, s34, v122 div:2
    v_mfma_f32_16x16x32_bf16 v[60:63], a[228:231], v[228:231], v[60:63]
    v_fma_f32 v211, v207, s34, v123 div:2
    v_fma_f32 v120, v204, s35, v120 mul:2
    v_mfma_f32_16x16x32_bf16 v[60:63], a[240:243], v[232:235], v[60:63]
    s_waitcnt lgkmcnt(0)
    v_fma_f32 v121, v205, s35, v121 mul:2
    v_fma_f32 v122, v206, s35, v122 mul:2
    v_mfma_f32_16x16x32_bf16 v[60:63], a[252:255], v[236:239], v[60:63]
    ds_read_b128 a[100:103], v250 offset:8256
    v_fma_f32 v123, v207, s35, v123 mul:2
    v_mfma_f32_16x16x32_bf16 v[64:67], v[240:243], v[236:239], v[64:67]
    buffer_store_dwordx4 a[84:87], v254, s[12:15], s44 offen nt
    v_cvt_pk_bf16_f32 v198, v208, v209
    v_cvt_pk_bf16_f32 v199, v210, v211
    v_mfma_f32_16x16x32_bf16 v[64:67], a[244:247], v[232:235], v[64:67]
    v_accvgpr_read_b32 v204, a28
    v_accvgpr_read_b32 v205, a29
    v_accvgpr_read_b32 v206, a30
    v_mfma_f32_16x16x32_bf16 v[64:67], a[232:235], v[228:231], v[64:67]
    v_accvgpr_read_b32 v207, a31
    v_accvgpr_read_b32 v208, a124
    v_mfma_f32_16x16x32_bf16 v[68:71], a[236:239], v[228:231], v[68:71]
    ds_read_b128 v[228:231], v253 offset:17696
    v_accvgpr_read_b32 v209, a125
    v_mfma_f32_16x16x32_bf16 v[68:71], a[248:251], v[232:235], v[68:71]
    ds_read_b128 a[104:107], v250 offset:11360
    s_add_u32 s44, s40, 403456
    v_mfma_f32_16x16x32_bf16 v[68:71], v[244:247], v[236:239], v[68:71]
    v_accvgpr_read_b32 v210, a126
    v_accvgpr_read_b32 v211, a127
    v_mfma_f32_16x16x32_bf16 v[72:75], a[228:231], v[232:235], v[72:75]
    v_sub_f32 v204, v204, v208
    v_sub_f32 v205, v205, v209
    v_mfma_f32_16x16x32_bf16 v[72:75], a[240:243], v[236:239], v[72:75]
    s_waitcnt lgkmcnt(1)
    v_sub_f32 v206, v206, v210
    v_sub_f32 v207, v207, v211
    v_mfma_f32_16x16x32_bf16 v[72:75], a[252:255], v[228:231], v[72:75]
    v_fma_f32 v208, v204, s34, v124 div:2
    v_fma_f32 v209, v205, s34, v125 div:2
    v_mfma_f32_16x16x32_bf16 v[76:79], v[240:243], v[228:231], v[76:79]
    v_fma_f32 v210, v206, s34, v126 div:2
    v_fma_f32 v211, v207, s34, v127 div:2
    v_mfma_f32_16x16x32_bf16 v[76:79], a[244:247], v[236:239], v[76:79]
    v_fma_f32 v124, v204, s35, v124 mul:2
    v_fma_f32 v125, v205, s35, v125 mul:2
    v_mfma_f32_16x16x32_bf16 v[76:79], a[232:235], v[232:235], v[76:79]
    v_fma_f32 v126, v206, s35, v126 mul:2
    v_fma_f32 v127, v207, s35, v127 mul:2
    v_cvt_pk_bf16_f32 v200, v208, v209
    v_mfma_f32_16x16x32_bf16 v[80:83], a[236:239], v[232:235], v[80:83]
    ds_read_b128 v[232:235], v253 offset:17424
    v_cvt_pk_bf16_f32 v201, v210, v211
    v_mfma_f32_16x16x32_bf16 v[80:83], a[248:251], v[236:239], v[80:83]
    v_accvgpr_read_b32 v204, a32
    v_accvgpr_read_b32 v205, a33
    v_mfma_f32_16x16x32_bf16 v[80:83], v[244:247], v[228:231], v[80:83]
    s_mov_b32 s42, 1032192
    v_accvgpr_read_b32 v206, a34
    v_accvgpr_read_b32 v207, a35
    v_mfma_f32_16x16x32_bf16 v[84:87], a[228:231], v[236:239], v[84:87]
    s_waitcnt lgkmcnt(0)
    v_accvgpr_read_b32 v208, a128
    v_accvgpr_read_b32 v209, a129
    v_mfma_f32_16x16x32_bf16 v[88:91], a[232:235], v[236:239], v[88:91]
    s_barrier
    v_mfma_f32_16x16x32_bf16 v[92:95], a[236:239], v[236:239], v[92:95]
    ds_read_b128 v[236:239], v253 offset:19760
    v_accvgpr_read_b32 v210, a130
    v_mfma_f32_16x16x32_bf16 v[92:95], a[248:251], v[228:231], v[92:95]
    buffer_load_dwordx4 a[228:231], v254, s[8:11], s42 offen offset:0 sc1
    v_mfma_f32_16x16x32_bf16 v[88:91], a[244:247], v[228:231], v[88:91]
    v_accvgpr_read_b32 v211, a131
    v_sub_f32 v204, v204, v208
    v_mfma_f32_16x16x32_bf16 v[84:87], a[240:243], v[228:231], v[84:87]
    ds_read_b128 v[228:231], v253 offset:19488
    v_sub_f32 v205, v205, v209
    v_mfma_f32_16x16x32_bf16 v[84:87], a[252:255], v[232:235], v[84:87]
    buffer_load_dwordx4 a[232:235], v254, s[8:11], s42 offen offset:1024 sc1
    v_sub_f32 v206, v206, v210
    v_mfma_f32_16x16x32_bf16 v[88:91], v[240:243], v[232:235], v[88:91]
    s_waitcnt vmcnt(11) lgkmcnt(1)
    v_sub_f32 v207, v207, v211
    v_fma_f32 v208, v204, s34, v128 div:2
    v_mfma_f32_16x16x32_bf16 v[92:95], v[244:247], v[232:235], v[92:95]
    ds_read_b128 v[232:235], v253 offset:19232
    v_fma_f32 v209, v205, s34, v129 div:2
sub26:
    v_mfma_f32_16x16x32_bf16 v[0:3], a[192:195], v[236:239], v[0:3]
    buffer_load_dwordx4 a[236:239], v254, s[8:11], s42 offen offset:2048 sc1
    v_mfma_f32_16x16x32_bf16 v[4:7], a[196:199], v[236:239], v[4:7]
    s_mov_b32 s42, 1035264
    v_fma_f32 v210, v206, s34, v130 div:2
    v_fma_f32 v211, v207, s34, v131 div:2
    v_mfma_f32_16x16x32_bf16 v[8:11], a[200:203], v[236:239], v[8:11]
    ds_read_b128 v[236:239], v253 offset:18976
    s_waitcnt vmcnt(9)
    s_waitcnt lgkmcnt(2)
    v_mfma_f32_16x16x32_bf16 v[8:11], a[212:215], v[228:231], v[8:11]
    ds_write_b128 v248, a[0:3] offset:0
    v_mfma_f32_16x16x32_bf16 v[4:7], a[208:211], v[228:231], v[4:7]
    buffer_load_dwordx4 a[240:243], v254, s[8:11], s42 offen offset:0 sc1
    v_mfma_f32_16x16x32_bf16 v[0:3], a[204:207], v[228:231], v[0:3]
    s_waitcnt vmcnt(7) lgkmcnt(2)
    v_fma_f32 v128, v204, s35, v128 mul:2
    v_fma_f32 v129, v205, s35, v129 mul:2
    v_mfma_f32_16x16x32_bf16 v[0:3], a[216:219], v[232:235], v[0:3]
    v_fma_f32 v130, v206, s35, v130 mul:2
    v_fma_f32 v131, v207, s35, v131 mul:2
    v_mfma_f32_16x16x32_bf16 v[4:7], a[220:223], v[232:235], v[4:7]
    ds_write_b64 v249, a[4:5] offset:64
    v_cvt_pk_bf16_f32 v202, v208, v209
    v_mfma_f32_16x16x32_bf16 v[8:11], a[224:227], v[232:235], v[8:11]
    buffer_load_dwordx4 a[244:247], v254, s[8:11], s42 offen offset:1024 sc1
    v_mfma_f32_16x16x32_bf16 v[12:15], a[192:195], v[228:231], v[12:15]
    ds_write_b128 v248, v[198:201] offset:768
    v_mfma_f32_16x16x32_bf16 v[12:15], a[204:207], v[232:235], v[12:15]
    s_waitcnt lgkmcnt(3)
    v_cvt_pk_bf16_f32 v203, v210, v211
    v_accvgpr_read_b32 v204, a36
    v_mfma_f32_16x16x32_bf16 v[12:15], a[216:219], v[236:239], v[12:15]
    v_accvgpr_read_b32 v205, a37
    v_accvgpr_read_b32 v206, a38
    v_mfma_f32_16x16x32_bf16 v[16:19], a[220:223], v[236:239], v[16:19]
    buffer_load_dwordx4 a[248:251], v254, s[8:11], s42 offen offset:2048 sc1
    v_mfma_f32_16x16x32_bf16 v[16:19], a[208:211], v[232:235], v[16:19]
    s_mov_b32 s42, 1038336
    v_accvgpr_read_b32 v207, a39
    v_accvgpr_read_b32 v208, a132
    v_mfma_f32_16x16x32_bf16 v[16:19], a[196:199], v[228:231], v[16:19]
    ds_write_b128 v248, a[12:15] offset:384
    v_mfma_f32_16x16x32_bf16 v[20:23], a[200:203], v[228:231], v[20:23]
    ds_read_b128 v[228:231], v253 offset:18720
    v_accvgpr_read_b32 v209, a133
    v_mfma_f32_16x16x32_bf16 v[20:23], a[212:215], v[232:235], v[20:23]
    buffer_load_dwordx4 a[252:255], v254, s[8:11], s42 offen offset:0 sc1
    v_mfma_f32_16x16x32_bf16 v[20:23], a[224:227], v[236:239], v[20:23]
    v_accvgpr_read_b32 v210, a134
    v_accvgpr_read_b32 v211, a135
    v_sub_f32 v204, v204, v208
    v_mfma_f32_16x16x32_bf16 v[24:27], a[192:195], v[232:235], v[24:27]
    ds_write_b64 v249, v[202:203] offset:832
    v_mfma_f32_16x16x32_bf16 v[24:27], a[204:207], v[236:239], v[24:27]
    s_waitcnt lgkmcnt(1)
    v_sub_f32 v205, v205, v209
    v_sub_f32 v206, v206, v210
    v_mfma_f32_16x16x32_bf16 v[24:27], a[216:219], v[228:231], v[24:27]
    v_sub_f32 v207, v207, v211
    v_fma_f32 v208, v204, s34, v132 div:2
    v_mfma_f32_16x16x32_bf16 v[28:31], a[220:223], v[228:231], v[28:31]
    buffer_load_dwordx4 v[240:243], v254, s[8:11], s42 offen offset:1024 sc1
    v_mfma_f32_16x16x32_bf16 v[28:31], a[208:211], v[236:239], v[28:31]
    ds_write_b64 v249, a[16:17] offset:448
    v_mfma_f32_16x16x32_bf16 v[28:31], a[196:199], v[232:235], v[28:31]
    v_fma_f32 v209, v205, s34, v133 div:2
    v_fma_f32 v210, v206, s34, v134 div:2
    v_mfma_f32_16x16x32_bf16 v[32:35], a[200:203], v[232:235], v[32:35]
    ds_read_b128 v[232:235], v253 offset:20544
    v_fma_f32 v211, v207, s34, v135 div:2
    v_mfma_f32_16x16x32_bf16 v[32:35], a[212:215], v[236:239], v[32:35]
    buffer_load_dwordx4 v[244:247], v254, s[8:11], s42 offen offset:2048 sc1
    v_mfma_f32_16x16x32_bf16 v[32:35], a[224:227], v[228:231], v[32:35]
    v_fma_f32 v132, v204, s35, v132 mul:2
    v_fma_f32 v133, v205, s35, v133 mul:2
    v_mfma_f32_16x16x32_bf16 v[36:39], a[192:195], v[236:239], v[36:39]
    v_fma_f32 v134, v206, s35, v134 mul:2
    v_fma_f32 v135, v207, s35, v135 mul:2
    v_cvt_pk_bf16_f32 v192, v208, v209
    v_mfma_f32_16x16x32_bf16 v[36:39], a[204:207], v[228:231], v[36:39]
    s_waitcnt lgkmcnt(0)
    v_cvt_pk_bf16_f32 v193, v210, v211
    v_accvgpr_read_b32 v204, a40
    v_mfma_f32_16x16x32_bf16 v[36:39], a[216:219], v[232:235], v[36:39]
    buffer_store_dwordx4 a[88:91], v254, s[12:15], s44 offen nt
    s_add_u32 s44, s40, 395264
    v_mfma_f32_16x16x32_bf16 v[40:43], a[220:223], v[232:235], v[40:43]
    v_accvgpr_read_b32 v205, a41
    v_accvgpr_read_b32 v206, a42
    v_mfma_f32_16x16x32_bf16 v[40:43], a[208:211], v[228:231], v[40:43]
    v_accvgpr_read_b32 v207, a43
    v_accvgpr_read_b32 v208, a136
    v_mfma_f32_16x16x32_bf16 v[40:43], a[196:199], v[236:239], v[40:43]
    buffer_store_dwordx4 a[92:95], v254, s[12:15], s44 offen nt
    s_add_u32 s44, s40, 398336
    v_mfma_f32_16x16x32_bf16 v[44:47], a[200:203], v[236:239], v[44:47]
    ds_read_b128 v[236:239], v253 offset:20288
    v_accvgpr_read_b32 v209, a137
    v_mfma_f32_16x16x32_bf16 v[44:47], a[212:215], v[228:231], v[44:47]
    v_accvgpr_read_b32 v210, a138
    v_accvgpr_read_b32 v211, a139
    v_mfma_f32_16x16x32_bf16 v[44:47], a[224:227], v[232:235], v[44:47]
    buffer_store_dwordx4 a[96:99], v254, s[12:15], s44 offen nt
    s_add_u32 s44, s40, 401408
    v_mfma_f32_16x16x32_bf16 v[48:51], a[192:195], v[228:231], v[48:51]
    v_sub_f32 v204, v204, v208
    v_sub_f32 v205, v205, v209
    v_mfma_f32_16x16x32_bf16 v[48:51], a[204:207], v[232:235], v[48:51]
    s_waitcnt lgkmcnt(0)
    v_sub_f32 v206, v206, v210
    v_sub_f32 v207, v207, v211
    v_fma_f32 v208, v204, s34, v136 div:2
    v_mfma_f32_16x16x32_bf16 v[48:51], a[216:219], v[236:239], v[48:51]
    buffer_store_dwordx4 a[100:103], v254, s[12:15], s44 offen nt
    v_fma_f32 v209, v205, s34, v137 div:2
    v_fma_f32 v210, v206, s34, v138 div:2
    v_mfma_f32_16x16x32_bf16 v[52:55], a[220:223], v[236:239], v[52:55]
    v_fma_f32 v211, v207, s34, v139 div:2
    v_fma_f32 v136, v204, s35, v136 mul:2
    v_mfma_f32_16x16x32_bf16 v[52:55], a[208:211], v[232:235], v[52:55]
    v_fma_f32 v137, v205, s35, v137 mul:2
    v_fma_f32 v138, v206, s35, v138 mul:2
    v_mfma_f32_16x16x32_bf16 v[52:55], a[196:199], v[228:231], v[52:55]
    v_fma_f32 v139, v207, s35, v139 mul:2
    v_cvt_pk_bf16_f32 v194, v208, v209
    v_mfma_f32_16x16x32_bf16 v[56:59], a[200:203], v[228:231], v[56:59]
    ds_read_b128 v[228:231], v253 offset:20032
    s_add_u32 s44, s40, 404480
    v_mfma_f32_16x16x32_bf16 v[56:59], a[212:215], v[232:235], v[56:59]
pad10:
    s_cbranch_vccnz warm_ret
    v_cvt_pk_bf16_f32 v195, v210, v211
    v_accvgpr_read_b32 v204, a44
    v_mfma_f32_16x16x32_bf16 v[56:59], a[224:227], v[236:239], v[56:59]
    ds_write_b128 v248, v[192:195] offset:1152
    v_mfma_f32_16x16x32_bf16 v[60:63], a[192:195], v[232:235], v[60:63]
    v_accvgpr_read_b32 v205, a45
    v_accvgpr_read_b32 v206, a46
    v_mfma_f32_16x16x32_bf16 v[60:63], a[204:207], v[236:239], v[60:63]
    s_waitcnt lgkmcnt(1)
    v_accvgpr_read_b32 v207, a47
    v_accvgpr_read_b32 v208, a140
    v_mfma_f32_16x16x32_bf16 v[60:63], a[216:219], v[228:231], v[60:63]
    v_accvgpr_read_b32 v209, a141
    v_accvgpr_read_b32 v210, a142
    v_accvgpr_read_b32 v211, a143
    v_mfma_f32_16x16x32_bf16 v[64:67], a[220:223], v[228:231], v[64:67]
    v_sub_f32 v204, v204, v208
    v_sub_f32 v205, v205, v209
    v_mfma_f32_16x16x32_bf16 v[64:67], a[208:211], v[236:239], v[64:67]
    v_sub_f32 v206, v206, v210
    v_sub_f32 v207, v207, v211
    v_mfma_f32_16x16x32_bf16 v[64:67], a[196:199], v[232:235], v[64:67]
    v_fma_f32 v208, v204, s34, v140 div:2
    v_fma_f32 v209, v205, s34, v141 div:2
    v_mfma_f32_16x16x32_bf16 v[68:71], a[200:203], v[232:235], v[68:71]
    ds_read_b128 v[232:235], v253 offset:19776
    v_fma_f32 v210, v206, s34, v142 div:2
    v_mfma_f32_16x16x32_bf16 v[68:71], a[212:215], v[236:239], v[68:71]
    v_fma_f32 v211, v207, s34, v143 div:2
    v_fma_f32 v140, v204, s35, v140 mul:2
    v_mfma_f32_16x16x32_bf16 v[68:71], a[224:227], v[228:231], v[68:71]
    buffer_store_dwordx4 a[104:107], v254, s[12:15], s44 offen nt
    v_fma_f32 v141, v205, s35, v141 mul:2
    v_fma_f32 v142, v206, s35, v142 mul:2
    v_mfma_f32_16x16x32_bf16 v[72:75], a[192:195], v[236:239], v[72:75]
    v_fma_f32 v143, v207, s35, v143 mul:2
    v_cvt_pk_bf16_f32 v196, v208, v209
    v_mfma_f32_16x16x32_bf16 v[72:75], a[204:207], v[228:231], v[72:75]
    s_waitcnt lgkmcnt(0)
    v_cvt_pk_bf16_f32 v197, v210, v211
    v_accvgpr_read_b32 v204, a48
    v_mfma_f32_16x16x32_bf16 v[72:75], a[216:219], v[232:235], v[72:75]
    ds_write_b64 v249, v[196:197] offset:1216
    v_mfma_f32_16x16x32_bf16 v[76:79], a[220:223], v[232:235], v[76:79]
    v_accvgpr_read_b32 v205, a49
    v_accvgpr_read_b32 v206, a50
    v_accvgpr_read_b32 v207, a51
    v_mfma_f32_16x16x32_bf16 v[76:79], a[208:211], v[228:231], v[76:79]
    v_accvgpr_read_b32 v208, a144
    v_accvgpr_read_b32 v209, a145
    v_mfma_f32_16x16x32_bf16 v[76:79], a[196:199], v[236:239], v[76:79]
    v_accvgpr_read_b32 v210, a146
    v_accvgpr_read_b32 v211, a147
    v_mfma_f32_16x16x32_bf16 v[80:83], a[200:203], v[236:239], v[80:83]
    ds_read_b128 v[236:239], v253 offset:19504
    v_sub_f32 v204, v204, v208
    v_mfma_f32_16x16x32_bf16 v[80:83], a[212:215], v[228:231], v[80:83]
    v_sub_f32 v205, v205, v209
    v_sub_f32 v206, v206, v210
    v_mfma_f32_16x16x32_bf16 v[80:83], a[224:227], v[232:235], v[80:83]
    s_mov_b32 s42, 1069056
    v_sub_f32 v207, v207, v211
    v_fma_f32 v208, v204, s34, v144 div:2
    v_mfma_f32_16x16x32_bf16 v[84:87], a[192:195], v[228:231], v[84:87]
    s_waitcnt lgkmcnt(0)
    v_fma_f32 v209, v205, s34, v145 div:2
    v_fma_f32 v210, v206, s34, v146 div:2
    v_mfma_f32_16x16x32_bf16 v[88:91], a[196:199], v[228:231], v[88:91]
    s_barrier
    v_mfma_f32_16x16x32_bf16 v[92:95], a[200:203], v[228:231], v[92:95]
    ds_read_b128 v[228:231], v253 offset:21840
    v_fma_f32 v211, v207, s34, v147 div:2
    v_mfma_f32_16x16x32_bf16 v[92:95], a[212:215], v[232:235], v[92:95]
    buffer_load_dwordx4 a[192:195], v254, s[8:11], s42 offen offset:0 sc1
    v_mfma_f32_16x16x32_bf16 v[88:91], a[208:211], v[232:235], v[88:91]
    v_fma_f32 v144, v204, s35, v144 mul:2
    v_fma_f32 v145, v205, s35, v145 mul:2
    v_fma_f32 v146, v206, s35, v146 mul:2
    v_mfma_f32_16x16x32_bf16 v[84:87], a[204:207], v[232:235], v[84:87]
    ds_read_b128 v[232:235], v253 offset:21568
    v_fma_f32 v147, v207, s35, v147 mul:2
    v_mfma_f32_16x16x32_bf16 v[84:87], a[216:219], v[236:239], v[84:87]
    buffer_load_dwordx4 a[196:199], v254, s[8:11], s42 offen offset:1024 sc1
    v_mfma_f32_16x16x32_bf16 v[88:91], a[220:223], v[236:239], v[88:91]
    s_waitcnt vmcnt(13) lgkmcnt(1)
    v_cvt_pk_bf16_f32 v198, v208, v209
    v_cvt_pk_bf16_f32 v199, v210, v211
    v_mfma_f32_16x16x32_bf16 v[92:95], a[224:227], v[236:239], v[92:95]
    ds_read_b128 v[236:239], v253 offset:21312
    v_accvgpr_read_b32 v204, a52
sub27:
    v_mfma_f32_16x16x32_bf16 v[0:3], a[228:231], v[228:231], v[0:3]
    buffer_load_dwordx4 a[200:203], v254, s[8:11], s42 offen offset:2048 sc1
    v_mfma_f32_16x16x32_bf16 v[4:7], a[232:235], v[228:231], v[4:7]
    s_mov_b32 s42, 1072128
    s_add_u32 s44, s40, 196608
    v_accvgpr_read_b32 v205, a53
    v_mfma_f32_16x16x32_bf16 v[8:11], a[236:239], v[228:231], v[8:11]
    ds_read_b128 v[228:231], v253 offset:21056
    s_waitcnt vmcnt(11)
    s_waitcnt lgkmcnt(2)
    v_mfma_f32_16x16x32_bf16 v[8:11], a[248:251], v[232:235], v[8:11]
    ds_read_b128 a[108:111], v250 offset:0
    v_accvgpr_read_b32 v206, a54
    v_mfma_f32_16x16x32_bf16 v[4:7], a[244:247], v[232:235], v[4:7]
    buffer_load_dwordx4 a[204:207], v254, s[8:11], s42 offen offset:0 sc1
    v_mfma_f32_16x16x32_bf16 v[0:3], a[240:243], v[232:235], v[0:3]
    s_waitcnt vmcnt(9) lgkmcnt(2)
    v_accvgpr_read_b32 v207, a55
    v_accvgpr_read_b32 v208, a148
    v_accvgpr_read_b32 v209, a149
    v_mfma_f32_16x16x32_bf16 v[0:3], a[252:255], v[236:239], v[0:3]
    ds_read_b128 a[112:115], v250 offset:3104
    v_accvgpr_read_b32 v210, a150
    v_mfma_f32_16x16x32_bf16 v[4:7], v[240:243], v[236:239], v[4:7]
    v_accvgpr_read_b32 v211, a151
    v_sub_f32 v204, v204, v208
    v_mfma_f32_16x16x32_bf16 v[8:11], v[244:247], v[236:239], v[8:11]
    buffer_load_dwordx4 a[208:211], v254, s[8:11], s42 offen offset:1024 sc1
    v_mfma_f32_16x16x32_bf16 v[12:15], a[228:231], v[232:235], v[12:15]
    s_waitcnt lgkmcnt(1)
    v_sub_f32 v205, v205, v209
    v_sub_f32 v206, v206, v210
    v_mfma_f32_16x16x32_bf16 v[12:15], a[240:243], v[236:239], v[12:15]
    v_sub_f32 v207, v207, v211
    v_fma_f32 v208, v204, s34, v148 div:2
    v_mfma_f32_16x16x32_bf16 v[12:15], a[252:255], v[228:231], v[12:15]
    v_fma_f32 v209, v205, s34, v149 div:2
    v_fma_f32 v210, v206, s34, v150 div:2
    v_mfma_f32_16x16x32_bf16 v[16:19], v[240:243], v[228:231], v[16:19]
    buffer_load_dwordx4 a[212:215], v254, s[8:11], s42 offen offset:2048 sc1
    v_mfma_f32_16x16x32_bf16 v[16:19], a[244:247], v[236:239], v[16:19]
    s_mov_b32 s42, 1075200
    v_fma_f32 v211, v207, s34, v151 div:2
    v_fma_f32 v148, v204, s35, v148 mul:2
    v_mfma_f32_16x16x32_bf16 v[16:19], a[232:235], v[232:235], v[16:19]
    ds_read_b128 a[116:119], v250 offset:6208
    v_fma_f32 v149, v205, s35, v149 mul:2
    v_mfma_f32_16x16x32_bf16 v[20:23], a[236:239], v[232:235], v[20:23]
    ds_read_b128 v[232:235], v253 offset:20800
    v_fma_f32 v150, v206, s35, v150 mul:2
    v_fma_f32 v151, v207, s35, v151 mul:2
    v_mfma_f32_16x16x32_bf16 v[20:23], a[248:251], v[236:239], v[20:23]
    buffer_load_dwordx4 a[216:219], v254, s[8:11], s42 offen offset:0 sc1
    v_mfma_f32_16x16x32_bf16 v[20:23], v[244:247], v[228:231], v[20:23]
    v_cvt_pk_bf16_f32 v200, v208, v209
    v_cvt_pk_bf16_f32 v201, v210, v211
    v_mfma_f32_16x16x32_bf16 v[24:27], a[228:231], v[236:239], v[24:27]
    ds_write_b128 v248, v[198:201] offset:1536
    v_mfma_f32_16x16x32_bf16 v[24:27], a[240:243], v[228:231], v[24:27]
    s_waitcnt lgkmcnt(1)
    v_accvgpr_read_b32 v204, a56
    v_accvgpr_read_b32 v205, a57
    v_mfma_f32_16x16x32_bf16 v[24:27], a[252:255], v[232:235], v[24:27]
    v_accvgpr_read_b32 v206, a58
    v_accvgpr_read_b32 v207, a59
    v_mfma_f32_16x16x32_bf16 v[28:31], v[240:243], v[232:235], v[28:31]
    buffer_load_dwordx4 a[220:223], v254, s[8:11], s42 offen offset:1024 sc1
    v_mfma_f32_16x16x32_bf16 v[28:31], a[244:247], v[228:231], v[28:31]
    ds_read_b128 a[120:123], v250 offset:9312
    v_accvgpr_read_b32 v208, a152
    v_mfma_f32_16x16x32_bf16 v[28:31], a[232:235], v[236:239], v[28:31]
    v_accvgpr_read_b32 v209, a153
    v_accvgpr_read_b32 v210, a154
    v_mfma_f32_16x16x32_bf16 v[32:35], a[236:239], v[236:239], v[32:35]
    ds_read_b128 v[236:239], v253 offset:22624
    v_accvgpr_read_b32 v211, a155
    v_mfma_f32_16x16x32_bf16 v[32:35], a[248:251], v[228:231], v[32:35]
    buffer_load_dwordx4 a[224:227], v254, s[8:11], s42 offen offset:2048 sc1
    v_sub_f32 v204, v204, v208
    v_mfma_f32_16x16x32_bf16 v[32:35], v[244:247], v[232:235], v[32:35]
    v_sub_f32 v205, v205, v209
    v_sub_f32 v206, v206, v210
    v_mfma_f32_16x16x32_bf16 v[36:39], a[228:231], v[228:231], v[36:39]
    v_sub_f32 v207, v207, v211
    v_fma_f32 v208, v204, s34, v152 div:2
    v_mfma_f32_16x16x32_bf16 v[36:39], a[240:243], v[232:235], v[36:39]
    s_waitcnt lgkmcnt(0)
    v_fma_f32 v209, v205, s34, v153 div:2
    v_fma_f32 v210, v206, s34, v154 div:2
    v_mfma_f32_16x16x32_bf16 v[36:39], a[252:255], v[236:239], v[36:39]
    buffer_store_dwordx4 a[108:111], v254, s[12:15], s44 offen nt
    s_add_u32 s44, s40, 199680
    v_fma_f32 v211, v207, s34, v155 div:2
    v_mfma_f32_16x16x32_bf16 v[40:43], v[240:243], v[236:239], v[40:43]
    v_fma_f32 v152, v204, s35, v152 mul:2
    v_fma_f32 v153, v205, s35, v153 mul:2
    v_mfma_f32_16x16x32_bf16 v[40:43], a[244:247], v[232:235], v[40:43]
    v_fma_f32 v154, v206, s35, v154 mul:2
    v_fma_f32 v155, v207, s35, v155 mul:2
    v_mfma_f32_16x16x32_bf16 v[40:43], a[232:235], v[228:231], v[40:43]
    v_cvt_pk_bf16_f32 v202, v208, v209
    v_cvt_pk_bf16_f32 v203, v210, v211
    v_mfma_f32_16x16x32_bf16 v[44:47], a[236:239], v[228:231], v[44:47]
    ds_read_b128 v[228:231], v253 offset:22368
    v_mfma_f32_16x16x32_bf16 v[44:47], a[248:251], v[232:235], v[44:47]
    ds_write_b64 v249, v[202:203] offset:1600
    v_mfma_f32_16x16x32_bf16 v[44:47], v[244:247], v[236:239], v[44:47]
    v_accvgpr_read_b32 v204, a60
    v_accvgpr_read_b32 v205, a61
    v_accvgpr_read_b32 v206, a62
    v_mfma_f32_16x16x32_bf16 v[48:51], a[228:231], v[232:235], v[48:51]
    v_accvgpr_read_b32 v207, a63
    v_accvgpr_read_b32 v208, a156
    v_mfma_f32_16x16x32_bf16 v[48:51], a[240:243], v[236:239], v[48:51]
    s_waitcnt lgkmcnt(1)
    v_accvgpr_read_b32 v209, a157
    v_accvgpr_read_b32 v210, a158
    v_mfma_f32_16x16x32_bf16 v[48:51], a[252:255], v[228:231], v[48:51]
    v_accvgpr_read_b32 v211, a159
    v_sub_f32 v204, v204, v208
    v_mfma_f32_16x16x32_bf16 v[52:55], v[240:243], v[228:231], v[52:55]
    v_sub_f32 v205, v205, v209
    v_sub_f32 v206, v206, v210
    v_mfma_f32_16x16x32_bf16 v[52:55], a[244:247], v[236:239], v[52:55]
    v_sub_f32 v207, v207, v211
    v_fma_f32 v208, v204, s34, v156 div:2
    v_mfma_f32_16x16x32_bf16 v[52:55], a[232:235], v[232:235], v[52:55]
    buffer_store_dwordx4 a[112:115], v254, s[12:15], s44 offen nt
    v_fma_f32 v209, v205, s34, v157 div:2
    v_fma_f32 v210, v206, s34, v158 div:2
    v_mfma_f32_16x16x32_bf16 v[56:59], a[236:239], v[232:235], v[56:59]
    ds_read_b128 v[232:235], v253 offset:22112
    v_fma_f32 v211, v207, s34, v159 div:2
    v_mfma_f32_16x16x32_bf16 v[56:59], a[248:251], v[236:239], v[56:59]
    v_fma_f32 v156, v204, s35, v156 mul:2
    v_fma_f32 v157, v205, s35, v157 mul:2
    v_mfma_f32_16x16x32_bf16 v[56:59], v[244:247], v[228:231], v[56:59]
    v_fma_f32 v158, v206, s35, v158 mul:2
    v_fma_f32 v159, v207, s35, v159 mul:2
    v_mfma_f32_16x16x32_bf16 v[60:63], a[228:231], v[236:239], v[60:63]
    v_cvt_pk_bf16_f32 v192, v208, v209
    v_cvt_pk_bf16_f32 v193, v210, v211
    v_accvgpr_read_b32 v204, a64
    v_mfma_f32_16x16x32_bf16 v[60:63], a[240:243], v[228:231], v[60:63]
    s_waitcnt lgkmcnt(0)
    v_accvgpr_read_b32 v205, a65
    v_accvgpr_read_b32 v206, a66
    v_mfma_f32_16x16x32_bf16 v[60:63], a[252:255], v[232:235], v[60:63]
    v_accvgpr_read_b32 v207, a67
    v_accvgpr_read_b32 v208, a160
    v_mfma_f32_16x16x32_bf16 v[64:67], v[240:243], v[232:235], v[64:67]
    v_accvgpr_read_b32 v209, a161
    v_accvgpr_read_b32 v210, a162
    v_mfma_f32_16x16x32_bf16 v[64:67], a[244:247], v[228:231], v[64:67]
    v_accvgpr_read_b32 v211, a163
    v_sub_f32 v204, v204, v208
    v_mfma_f32_16x16x32_bf16 v[64:67], a[232:235], v[236:239], v[64:67]
    s_add_u32 s44, s40, 202752
    v_sub_f32 v205, v205, v209
    v_sub_f32 v206, v206, v210
    v_mfma_f32_16x16x32_bf16 v[68:71], a[236:239], v[236:239], v[68:71]
    ds_read_b128 v[236:239], v253 offset:21856
    v_sub_f32 v207, v207, v211
    v_mfma_f32_16x16x32_bf16 v[68:71], a[248:251], v[228:231], v[68:71]
    v_fma_f32 v208, v204, s34, v160 div:2
    v_fma_f32 v209, v205, s34, v161 div:2
    v_mfma_f32_16x16x32_bf16 v[68:71], v[244:247], v[232:235], v[68:71]
    v_fma_f32 v210, v206, s34, v162 div:2
    v_fma_f32 v211, v207, s34, v163 div:2
    v_mfma_f32_16x16x32_bf16 v[72:75], a[228:231], v[228:231], v[72:75]
    v_fma_f32 v160, v204, s35, v160 mul:2
    v_fma_f32 v161, v205, s35, v161 mul:2
    v_mfma_f32_16x16x32_bf16 v[72:75], a[240:243], v[232:235], v[72:75]
    s_waitcnt lgkmcnt(0)
    v_fma_f32 v162, v206, s35, v162 mul:2
    v_fma_f32 v163, v207, s35, v163 mul:2
    v_cvt_pk_bf16_f32 v194, v208, v209
    v_mfma_f32_16x16x32_bf16 v[72:75], a[252:255], v[236:239], v[72:75]
    v_cvt_pk_bf16_f32 v195, v210, v211
    v_accvgpr_read_b32 v204, a68
    v_mfma_f32_16x16x32_bf16 v[76:79], v[240:243], v[236:239], v[76:79]
    ds_write_b128 v248, v[192:195] offset:1920
    v_mfma_f32_16x16x32_bf16 v[76:79], a[244:247], v[232:235], v[76:79]
    v_accvgpr_read_b32 v205, a69
    v_accvgpr_read_b32 v206, a70
    v_mfma_f32_16x16x32_bf16 v[76:79], a[232:235], v[228:231], v[76:79]
    v_accvgpr_read_b32 v207, a71
    v_accvgpr_read_b32 v208, a164
    v_mfma_f32_16x16x32_bf16 v[80:83], a[236:239], v[228:231], v[80:83]
    ds_read_b128 v[228:231], v253 offset:21584
    v_accvgpr_read_b32 v209, a165
    v_mfma_f32_16x16x32_bf16 v[80:83], a[248:251], v[232:235], v[80:83]
    v_accvgpr_read_b32 v210, a166
    v_accvgpr_read_b32 v211, a167
    v_mfma_f32_16x16x32_bf16 v[80:83], v[244:247], v[236:239], v[80:83]
    s_mov_b32 s42, 884736
    v_sub_f32 v204, v204, v208
    v_sub_f32 v205, v205, v209
    v_mfma_f32_16x16x32_bf16 v[84:87], a[228:231], v[232:235], v[84:87]
    v_sub_f32 v206, v206, v210
    v_sub_f32 v207, v207, v211
    v_mfma_f32_16x16x32_bf16 v[88:91], a[232:235], v[232:235], v[88:91]
    v_fma_f32 v208, v204, s34, v164 div:2
    v_fma_f32 v209, v205, s34, v165 div:2
    v_mfma_f32_16x16x32_bf16 v[92:95], a[236:239], v[232:235], v[92:95]
    ds_read_b128 v[232:235], v253 offset:23920
    v_fma_f32 v210, v206, s34, v166 div:2
    v_fma_f32 v211, v207, s34, v167 div:2
    v_mfma_f32_16x16x32_bf16 v[92:95], a[248:251], v[236:239], v[92:95]
    buffer_load_dwordx4 a[228:231], v254, s[8:11], s42 offen offset:0 sc1
    v_mfma_f32_16x16x32_bf16 v[88:91], a[244:247], v[236:239], v[88:91]
    s_waitcnt lgkmcnt(1)
    v_fma_f32 v164, v204, s35, v164 mul:2
    v_fma_f32 v165, v205, s35, v165 mul:2
    v_mfma_f32_16x16x32_bf16 v[84:87], a[240:243], v[236:239], v[84:87]
    ds_read_b128 v[236:239], v253 offset:23648
    v_fma_f32 v166, v206, s35, v166 mul:2
    v_mfma_f32_16x16x32_bf16 v[84:87], a[252:255], v[228:231], v[84:87]
    buffer_load_dwordx4 a[232:235], v254, s[8:11], s42 offen offset:1024 sc1
    v_mfma_f32_16x16x32_bf16 v[88:91], v[240:243], v[228:231], v[88:91]
    s_waitcnt vmcnt(10) lgkmcnt(1)
    v_fma_f32 v167, v207, s35, v167 mul:2
    v_cvt_pk_bf16_f32 v196, v208, v209
    v_mfma_f32_16x16x32_bf16 v[92:95], v[244:247], v[228:231], v[92:95]
    ds_read_b128 v[228:231], v253 offset:23392
    v_cvt_pk_bf16_f32 v197, v210, v211
sub28:
    v_mfma_f32_16x16x32_bf16 v[0:3], a[192:195], v[232:235], v[0:3]
    buffer_load_dwordx4 a[236:239], v254, s[8:11], s42 offen offset:2048 sc1
    v_mfma_f32_16x16x32_bf16 v[4:7], a[196:199], v[232:235], v[4:7]
    s_mov_b32 s42, 887808
    v_accvgpr_read_b32 v204, a72
    v_accvgpr_read_b32 v205, a73
    v_mfma_f32_16x16x32_bf16 v[8:11], a[200:203], v[232:235], v[8:11]
    ds_read_b128 v[232:235], v253 offset:23136
    s_waitcnt vmcnt(8)
    s_waitcnt lgkmcnt(2)
    v_mfma_f32_16x16x32_bf16 v[8:11], a[212:215], v[236:239], v[8:11]
    ds_write_b64 v249, v[196:197] offset:1984
    v_accvgpr_read_b32 v206, a74
    v_mfma_f32_16x16x32_bf16 v[4:7], a[208:211], v[236:239], v[4:7]
    buffer_load_dwordx4 a[240:243], v254, s[8:11], s42 offen offset:0 sc1
    v_mfma_f32_16x16x32_bf16 v[0:3], a[204:207], v[236:239], v[0:3]
    s_waitcnt vmcnt(6) lgkmcnt(2)
    v_accvgpr_read_b32 v207, a75
    v_accvgpr_read_b32 v208, a168
    v_mfma_f32_16x16x32_bf16 v[0:3], a[216:219], v[228:231], v[0:3]
    v_accvgpr_read_b32 v209, a169
    v_accvgpr_read_b32 v210, a170
    v_mfma_f32_16x16x32_bf16 v[4:7], a[220:223], v[228:231], v[4:7]
    v_accvgpr_read_b32 v211, a171
    v_sub_f32 v204, v204, v208
    v_mfma_f32_16x16x32_bf16 v[8:11], a[224:227], v[228:231], v[8:11]
    buffer_load_dwordx4 a[244:247], v254, s[8:11], s42 offen offset:1024 sc1
    v_mfma_f32_16x16x32_bf16 v[12:15], a[192:195], v[236:239], v[12:15]
    v_sub_f32 v205, v205, v209
    v_sub_f32 v206, v206, v210
    v_mfma_f32_16x16x32_bf16 v[12:15], a[204:207], v[228:231], v[12:15]
    s_waitcnt lgkmcnt(1)
    v_sub_f32 v207, v207, v211
    v_fma_f32 v208, v204, s34, v168 div:2
    v_mfma_f32_16x16x32_bf16 v[12:15], a[216:219], v[232:235], v[12:15]
    v_fma_f32 v209, v205, s34, v169 div:2
    v_fma_f32 v210, v206, s34, v170 div:2
    v_mfma_f32_16x16x32_bf16 v[16:19], a[220:223], v[232:235], v[16:19]
    buffer_load_dwordx4 a[248:251], v254, s[8:11], s42 offen offset:2048 sc1
    v_mfma_f32_16x16x32_bf16 v[16:19], a[208:211], v[228:231], v[16:19]
    s_mov_b32 s42, 890880
    v_fma_f32 v211, v207, s34, v171 div:2
    v_fma_f32 v168, v204, s35, v168 mul:2
    v_fma_f32 v169, v205, s35, v169 mul:2
    v_mfma_f32_16x16x32_bf16 v[16:19], a[196:199], v[236:239], v[16:19]
    v_fma_f32 v170, v206, s35, v170 mul:2
    v_fma_f32 v171, v207, s35, v171 mul:2
    v_mfma_f32_16x16x32_bf16 v[20:23], a[200:203], v[236:239], v[20:23]
    ds_read_b128 v[236:239], v253 offset:22880
    v_cvt_pk_bf16_f32 v198, v208, v209
    v_mfma_f32_16x16x32_bf16 v[20:23], a[212:215], v[228:231], v[20:23]
    buffer_load_dwordx4 a[252:255], v254, s[8:11], s42 offen offset:0 sc1
    v_mfma_f32_16x16x32_bf16 v[20:23], a[224:227], v[232:235], v[20:23]
    v_cvt_pk_bf16_f32 v199, v210, v211
    v_accvgpr_read_b32 v204, a76
    v_mfma_f32_16x16x32_bf16 v[24:27], a[192:195], v[228:231], v[24:27]
    v_accvgpr_read_b32 v205, a77
    v_accvgpr_read_b32 v206, a78
    v_mfma_f32_16x16x32_bf16 v[24:27], a[204:207], v[232:235], v[24:27]
    s_waitcnt lgkmcnt(0)
    v_accvgpr_read_b32 v207, a79
    v_accvgpr_read_b32 v208, a172
    v_mfma_f32_16x16x32_bf16 v[24:27], a[216:219], v[236:239], v[24:27]
    v_accvgpr_read_b32 v209, a173
    v_accvgpr_read_b32 v210, a174
    v_mfma_f32_16x16x32_bf16 v[28:31], a[220:223], v[236:239], v[28:31]
    buffer_load_dwordx4 v[240:243], v254, s[8:11], s42 offen offset:1024 sc1
    v_mfma_f32_16x16x32_bf16 v[28:31], a[208:211], v[232:235], v[28:31]
    v_accvgpr_read_b32 v211, a175
    v_sub_f32 v204, v204, v208
    v_mfma_f32_16x16x32_bf16 v[28:31], a[196:199], v[228:231], v[28:31]
    v_sub_f32 v205, v205, v209
    v_sub_f32 v206, v206, v210
    v_sub_f32 v207, v207, v211
    v_mfma_f32_16x16x32_bf16 v[32:35], a[200:203], v[228:231], v[32:35]
    ds_read_b128 v[228:231], v253 offset:24704
    v_fma_f32 v208, v204, s34, v172 div:2
    v_mfma_f32_16x16x32_bf16 v[32:35], a[212:215], v[232:235], v[32:35]
    buffer_load_dwordx4 v[244:247], v254, s[8:11], s42 offen offset:2048 sc1
    v_mfma_f32_16x16x32_bf16 v[32:35], a[224:227], v[236:239], v[32:35]
    v_fma_f32 v209, v205, s34, v173 div:2
    v_fma_f32 v210, v206, s34, v174 div:2
    v_mfma_f32_16x16x32_bf16 v[36:39], a[192:195], v[232:235], v[36:39]
    v_fma_f32 v211, v207, s34, v175 div:2
    v_fma_f32 v172, v204, s35, v172 mul:2
    v_mfma_f32_16x16x32_bf16 v[36:39], a[204:207], v[236:239], v[36:39]
    s_waitcnt lgkmcnt(0)
    v_fma_f32 v173, v205, s35, v173 mul:2
    v_fma_f32 v174, v206, s35, v174 mul:2
    v_mfma_f32_16x16x32_bf16 v[36:39], a[216:219], v[228:231], v[36:39]
    buffer_store_dwordx4 a[116:119], v254, s[12:15], s44 offen nt
    s_add_u32 s44, s40, 205824
    v_mfma_f32_16x16x32_bf16 v[40:43], a[220:223], v[228:231], v[40:43]
    v_fma_f32 v175, v207, s35, v175 mul:2
    v_cvt_pk_bf16_f32 v200, v208, v209
    v_mfma_f32_16x16x32_bf16 v[40:43], a[208:211], v[236:239], v[40:43]
    v_cvt_pk_bf16_f32 v201, v210, v211
    v_accvgpr_read_b32 v204, a80
    v_mfma_f32_16x16x32_bf16 v[40:43], a[196:199], v[232:235], v[40:43]
    buffer_store_dwordx4 a[120:123], v254, s[12:15], s44 offen nt
    s_add_u32 s44, s40, 197632
    v_accvgpr_read_b32 v205, a81
    v_mfma_f32_16x16x32_bf16 v[44:47], a[200:203], v[232:235], v[44:47]
    ds_read_b128 v[232:235], v253 offset:24448
    v_accvgpr_read_b32 v206, a82
    v_accvgpr_read_b32 v207, a83
    v_mfma_f32_16x16x32_bf16 v[44:47], a[212:215], v[236:239], v[44:47]
    ds_write_b128 v248, v[198:201] offset:2304
    v_mfma_f32_16x16x32_bf16 v[44:47], a[224:227], v[228:231], v[44:47]
    v_accvgpr_read_b32 v208, a176
    v_accvgpr_read_b32 v209, a177
    v_mfma_f32_16x16x32_bf16 v[48:51], a[192:195], v[236:239], v[48:51]
    v_accvgpr_read_b32 v210, a178
    v_accvgpr_read_b32 v211, a179
    v_mfma_f32_16x16x32_bf16 v[48:51], a[204:207], v[228:231], v[48:51]
    s_waitcnt lgkmcnt(1)
    v_sub_f32 v204, v204, v208
    v_sub_f32 v205, v205, v209
    v_mfma_f32_16x16x32_bf16 v[48:51], a[216:219], v[232:235], v[48:51]
    v_sub_f32 v206, v206, v210
    v_sub_f32 v207, v207, v211
    v_mfma_f32_16x16x32_bf16 v[52:55], a[220:223], v[232:235], v[52:55]
    v_fma_f32 v208, v204, s34, v176 div:2
    v_fma_f32 v209, v205, s34, v177 div:2
    v_mfma_f32_16x16x32_bf16 v[52:55], a[208:211], v[228:231], v[52:55]
    v_fma_f32 v210, v206, s34, v178 div:2
    v_fma_f32 v211, v207, s34, v179 div:2
    v_mfma_f32_16x16x32_bf16 v[52:55], a[196:199], v[236:239], v[52:55]
    v_fma_f32 v176, v204, s35, v176 mul:2
    v_fma_f32 v177, v205, s35, v177 mul:2
    v_mfma_f32_16x16x32_bf16 v[56:59], a[200:203], v[236:239], v[56:59]
    ds_read_b128 v[236:239], v253 offset:24192
    v_fma_f32 v178, v206, s35, v178 mul:2
    v_mfma_f32_16x16x32_bf16 v[56:59], a[212:215], v[228:231], v[56:59]
    v_fma_f32 v179, v207, s35, v179 mul:2
    v_cvt_pk_bf16_f32 v202, v208, v209
    v_cvt_pk_bf16_f32 v203, v210, v211
    v_mfma_f32_16x16x32_bf16 v[56:59], a[224:227], v[232:235], v[56:59]
    ds_write_b64 v249, v[202:203] offset:2368
    v_mfma_f32_16x16x32_bf16 v[60:63], a[192:195], v[228:231], v[60:63]
    v_accvgpr_read_b32 v204, a180
    v_accvgpr_read_b32 v205, a181
    v_mfma_f32_16x16x32_bf16 v[60:63], a[204:207], v[232:235], v[60:63]
    s_waitcnt lgkmcnt(1)
    v_accvgpr_read_b32 v206, a182
    v_accvgpr_read_b32 v207, a183
    v_mfma_f32_16x16x32_bf16 v[60:63], a[216:219], v[236:239], v[60:63]
    v_fma_f32 v208, v204, s34, v180 div:2
    v_fma_f32 v209, v205, s34, v181 div:2
    v_mfma_f32_16x16x32_bf16 v[64:67], a[220:223], v[236:239], v[64:67]
    v_fma_f32 v210, v206, s34, v182 div:2
    v_fma_f32 v211, v207, s34, v183 div:2
    v_mfma_f32_16x16x32_bf16 v[64:67], a[208:211], v[232:235], v[64:67]
    v_fma_f32 v180, v204, s35, v180 mul:2
    v_fma_f32 v181, v205, s35, v181 mul:2
    v_mfma_f32_16x16x32_bf16 v[64:67], a[196:199], v[228:231], v[64:67]
    v_fma_f32 v182, v206, s35, v182 mul:2
    v_fma_f32 v183, v207, s35, v183 mul:2
    v_mfma_f32_16x16x32_bf16 v[68:71], a[200:203], v[228:231], v[68:71]
    ds_read_b128 v[228:231], v253 offset:23936
    v_cvt_pk_bf16_f32 v192, v208, v209
    v_mfma_f32_16x16x32_bf16 v[68:71], a[212:215], v[232:235], v[68:71]
    v_cvt_pk_bf16_f32 v193, v210, v211
    v_accvgpr_read_b32 v204, a184
    v_mfma_f32_16x16x32_bf16 v[68:71], a[224:227], v[236:239], v[68:71]
    v_accvgpr_read_b32 v205, a185
    v_accvgpr_read_b32 v206, a186
    v_accvgpr_read_b32 v207, a187
    v_mfma_f32_16x16x32_bf16 v[72:75], a[192:195], v[232:235], v[72:75]
    v_fma_f32 v208, v204, s34, v184 div:2
    v_fma_f32 v209, v205, s34, v185 div:2
    v_mfma_f32_16x16x32_bf16 v[72:75], a[204:207], v[236:239], v[72:75]
    s_waitcnt lgkmcnt(0)
    v_fma_f32 v210, v206, s34, v186 div:2
    v_fma_f32 v211, v207, s34, v187 div:2
    v_mfma_f32_16x16x32_bf16 v[72:75], a[216:219], v[228:231], v[72:75]
    v_fma_f32 v184, v204, s35, v184 mul:2
    v_fma_f32 v185, v205, s35, v185 mul:2
    v_mfma_f32_16x16x32_bf16 v[76:79], a[220:223], v[228:231], v[76:79]
    v_fma_f32 v186, v206, s35, v186 mul:2
    v_fma_f32 v187, v207, s35, v187 mul:2
    v_mfma_f32_16x16x32_bf16 v[76:79], a[208:211], v[236:239], v[76:79]
    v_cvt_pk_bf16_f32 v194, v208, v209
    v_cvt_pk_bf16_f32 v195, v210, v211
    v_mfma_f32_16x16x32_bf16 v[76:79], a[196:199], v[232:235], v[76:79]
    ds_write_b128 v248, v[192:195] offset:2688
    v_mfma_f32_16x16x32_bf16 v[80:83], a[200:203], v[232:235], v[80:83]
    ds_read_b128 v[232:235], v253 offset:23664
    v_accvgpr_read_b32 v204, a188
    v_mfma_f32_16x16x32_bf16 v[80:83], a[212:215], v[236:239], v[80:83]
    v_accvgpr_read_b32 v205, a189
    v_accvgpr_read_b32 v206, a190
    v_mfma_f32_16x16x32_bf16 v[80:83], a[224:227], v[228:231], v[80:83]
    s_mov_b32 s42, 1105920
    v_accvgpr_read_b32 v207, a191
    v_fma_f32 v208, v204, s34, v188 div:2
    v_mfma_f32_16x16x32_bf16 v[84:87], a[192:195], v[236:239], v[84:87]
    s_waitcnt lgkmcnt(0)
    v_fma_f32 v209, v205, s34, v189 div:2
    v_fma_f32 v210, v206, s34, v190 div:2
    v_fma_f32 v211, v207, s34, v191 div:2
    v_mfma_f32_16x16x32_bf16 v[88:91], a[196:199], v[236:239], v[88:91]
    s_barrier
    v_mfma_f32_16x16x32_bf16 v[92:95], a[200:203], v[236:239], v[92:95]
    ds_read_b128 v[236:239], v253 offset:34320
    v_fma_f32 v188, v204, s35, v188 mul:2
    v_mfma_f32_16x16x32_bf16 v[92:95], a[212:215], v[228:231], v[92:95]
    buffer_load_dwordx4 a[192:195], v254, s[8:11], s42 offen offset:0 sc1
    v_mfma_f32_16x16x32_bf16 v[88:91], a[208:211], v[228:231], v[88:91]
    v_fma_f32 v189, v205, s35, v189 mul:2
    v_fma_f32 v190, v206, s35, v190 mul:2
    v_mfma_f32_16x16x32_bf16 v[84:87], a[204:207], v[228:231], v[84:87]
    ds_read_b128 v[228:231], v253 offset:34048
    v_fma_f32 v191, v207, s35, v191 mul:2
    v_mfma_f32_16x16x32_bf16 v[84:87], a[216:219], v[232:235], v[84:87]
    buffer_load_dwordx4 a[196:199], v254, s[8:11], s42 offen offset:1024 sc1
    v_mfma_f32_16x16x32_bf16 v[88:91], a[220:223], v[232:235], v[88:91]
    s_waitcnt vmcnt(10) lgkmcnt(1)
    v_cvt_pk_bf16_f32 v196, v208, v209
    v_cvt_pk_bf16_f32 v197, v210, v211
    v_mfma_f32_16x16x32_bf16 v[92:95], a[224:227], v[232:235], v[92:95]
    ds_read_b128 v[232:235], v253 offset:33792
sub29:
    v_mfma_f32_16x16x32_bf16 v[0:3], a[228:231], v[236:239], v[0:3]
    buffer_load_dwordx4 a[200:203], v254, s[8:11], s42 offen offset:2048 sc1
    v_mfma_f32_16x16x32_bf16 v[4:7], a[232:235], v[236:239], v[4:7]
    s_mov_b32 s42, 1108992
    v_mfma_f32_16x16x32_bf16 v[8:11], a[236:239], v[236:239], v[8:11]
    ds_read_b128 v[236:239], v253 offset:33536
    s_waitcnt vmcnt(8)
    s_waitcnt lgkmcnt(2)
    v_mfma_f32_16x16x32_bf16 v[8:11], a[248:251], v[228:231], v[8:11]
pad11:
    s_cbranch_vccnz warm_ret
    ds_read_b128 a[124:127], v250 offset:1024
    v_mfma_f32_16x16x32_bf16 v[4:7], a[244:247], v[228:231], v[4:7]
    buffer_load_dwordx4 a[204:207], v254, s[8:11], s42 offen offset:0 sc1
    v_mfma_f32_16x16x32_bf16 v[0:3], a[240:243], v[228:231], v[0:3]
    s_waitcnt vmcnt(6) lgkmcnt(2)
    v_mfma_f32_16x16x32_bf16 v[0:3], a[252:255], v[232:235], v[0:3]
    ds_write_b64 v249, v[196:197] offset:2752
    v_mfma_f32_16x16x32_bf16 v[4:7], v[240:243], v[232:235], v[4:7]
    ds_read_b128 a[128:131], v250 offset:4128
    v_mfma_f32_16x16x32_bf16 v[8:11], v[244:247], v[232:235], v[8:11]
    buffer_load_dwordx4 a[208:211], v254, s[8:11], s42 offen offset:1024 sc1
    v_mfma_f32_16x16x32_bf16 v[12:15], a[228:231], v[228:231], v[12:15]
    ds_read_b128 a[132:135], v250 offset:7232
    s_waitcnt lgkmcnt(3)
    v_mfma_f32_16x16x32_bf16 v[12:15], a[240:243], v[232:235], v[12:15]
    v_mfma_f32_16x16x32_bf16 v[12:15], a[252:255], v[236:239], v[12:15]
    v_mfma_f32_16x16x32_bf16 v[16:19], v[240:243], v[236:239], v[16:19]
    buffer_load_dwordx4 a[212:215], v254, s[8:11], s42 offen offset:2048 sc1
    v_mfma_f32_16x16x32_bf16 v[16:19], a[244:247], v[232:235], v[16:19]
    s_mov_b32 s42, 1112064
    v_mfma_f32_16x16x32_bf16 v[16:19], a[232:235], v[228:231], v[16:19]
    buffer_store_dwordx4 a[124:127], v254, s[12:15], s44 offen nt
    s_add_u32 s44, s40, 200704
    s_waitcnt lgkmcnt(1)
    v_mfma_f32_16x16x32_bf16 v[20:23], a[236:239], v[228:231], v[20:23]
    ds_read_b128 v[228:231], v253 offset:33280
    v_mfma_f32_16x16x32_bf16 v[20:23], a[248:251], v[232:235], v[20:23]
    buffer_load_dwordx4 a[216:219], v254, s[8:11], s42 offen offset:0 sc1
    v_mfma_f32_16x16x32_bf16 v[20:23], v[244:247], v[236:239], v[20:23]
    ds_read_b128 a[136:139], v250 offset:10336
    v_mfma_f32_16x16x32_bf16 v[24:27], a[228:231], v[232:235], v[24:27]
    buffer_store_dwordx4 a[128:131], v254, s[12:15], s44 offen nt
    s_add_u32 s44, s40, 203776
    s_waitcnt lgkmcnt(2)
    v_mfma_f32_16x16x32_bf16 v[24:27], a[240:243], v[236:239], v[24:27]
    s_waitcnt lgkmcnt(1)
    v_mfma_f32_16x16x32_bf16 v[24:27], a[252:255], v[228:231], v[24:27]
    v_cvt_pk_bf16_f32 v8, v8, v9
    v_cvt_pk_bf16_f32 v9, v10, v11
    v_mfma_f32_16x16x32_bf16 v[28:31], v[240:243], v[228:231], v[28:31]
    buffer_load_dwordx4 a[220:223], v254, s[8:11], s42 offen offset:1024 sc1
    v_mfma_f32_16x16x32_bf16 v[28:31], a[244:247], v[236:239], v[28:31]
    ds_write_b64 v249, v[8:9] offset:12544
    v_mfma_f32_16x16x32_bf16 v[28:31], a[232:235], v[232:235], v[28:31]
    v_cvt_pk_bf16_f32 v0, v0, v1
    v_cvt_pk_bf16_f32 v1, v2, v3
    v_mfma_f32_16x16x32_bf16 v[32:35], a[236:239], v[232:235], v[32:35]
    ds_read_b128 v[232:235], v253 offset:35104
    v_cvt_pk_bf16_f32 v2, v4, v5
    v_mfma_f32_16x16x32_bf16 v[32:35], a[248:251], v[236:239], v[32:35]
    buffer_load_dwordx4 a[224:227], v254, s[8:11], s42 offen offset:2048 sc1
    v_mfma_f32_16x16x32_bf16 v[32:35], v[244:247], v[228:231], v[32:35]
    v_cvt_pk_bf16_f32 v3, v6, v7
    v_mov_b32 v4, v248
    v_mfma_f32_16x16x32_bf16 v[36:39], a[228:231], v[236:239], v[36:39]
    buffer_store_dwordx4 a[132:135], v254, s[12:15], s44 offen nt
    v_and_b32 v227, 0x7fff, v255
    v_mov_b32 v5, v249
    v_mfma_f32_16x16x32_bf16 v[36:39], a[240:243], v[228:231], v[36:39]
    s_waitcnt lgkmcnt(0)
    s_add_u32 s44, s40, 206848
    v_mov_b32 v6, v250
    v_mfma_f32_16x16x32_bf16 v[36:39], a[252:255], v[232:235], v[36:39]
    buffer_load_dwordx2 v[216:217], v227, s[4:7], s16 offen offset:0
    v_mfma_f32_16x16x32_bf16 v[40:43], v[240:243], v[232:235], v[40:43]
    ds_write_b128 v248, v[0:3] offset:12480
    v_mfma_f32_16x16x32_bf16 v[40:43], a[244:247], v[228:231], v[40:43]
    v_cvt_pk_bf16_f32 v20, v20, v21
    v_cvt_pk_bf16_f32 v21, v22, v23
    v_mfma_f32_16x16x32_bf16 v[40:43], a[232:235], v[236:239], v[40:43]
    v_cvt_pk_bf16_f32 v12, v12, v13
    v_cvt_pk_bf16_f32 v13, v14, v15
    v_mfma_f32_16x16x32_bf16 v[44:47], a[236:239], v[236:239], v[44:47]
    ds_read_b128 v[236:239], v253 offset:34848
    v_cvt_pk_bf16_f32 v14, v16, v17
    v_mfma_f32_16x16x32_bf16 v[44:47], a[248:251], v[228:231], v[44:47]
    buffer_load_dwordx2 v[218:219], v227, s[4:7], s17 offen offset:0
    v_mfma_f32_16x16x32_bf16 v[44:47], v[244:247], v[232:235], v[44:47]
    ds_write_b64 v5, v[20:21] offset:12928
    v_mfma_f32_16x16x32_bf16 v[48:51], a[228:231], v[228:231], v[48:51]
    v_cvt_pk_bf16_f32 v15, v18, v19
    v_cvt_pk_bf16_f32 v32, v32, v33
    v_mfma_f32_16x16x32_bf16 v[48:51], a[240:243], v[232:235], v[48:51]
    s_waitcnt lgkmcnt(1)
    v_cvt_pk_bf16_f32 v33, v34, v35
    v_cvt_pk_bf16_f32 v24, v24, v25
    v_mfma_f32_16x16x32_bf16 v[48:51], a[252:255], v[236:239], v[48:51]
    buffer_load_dwordx2 v[220:221], v227, s[4:7], s18 offen offset:0
    v_mfma_f32_16x16x32_bf16 v[52:55], v[240:243], v[236:239], v[52:55]
    ds_write_b128 v4, v[12:15] offset:12864
    v_mfma_f32_16x16x32_bf16 v[52:55], a[244:247], v[232:235], v[52:55]
    v_cvt_pk_bf16_f32 v25, v26, v27
    v_cvt_pk_bf16_f32 v26, v28, v29
    v_mfma_f32_16x16x32_bf16 v[52:55], a[232:235], v[228:231], v[52:55]
    v_cvt_pk_bf16_f32 v27, v30, v31
    v_cvt_pk_bf16_f32 v44, v44, v45
    v_mfma_f32_16x16x32_bf16 v[56:59], a[236:239], v[228:231], v[56:59]
    ds_read_b128 v[228:231], v253 offset:34592
    v_cvt_pk_bf16_f32 v45, v46, v47
    v_mfma_f32_16x16x32_bf16 v[56:59], a[248:251], v[232:235], v[56:59]
    buffer_load_dwordx2 v[222:223], v227, s[4:7], s19 offen offset:0
    v_mfma_f32_16x16x32_bf16 v[56:59], v[244:247], v[236:239], v[56:59]
    ds_write_b64 v5, v[32:33] offset:13312
    v_mfma_f32_16x16x32_bf16 v[60:63], a[228:231], v[232:235], v[60:63]
    v_cvt_pk_bf16_f32 v36, v36, v37
    v_cvt_pk_bf16_f32 v37, v38, v39
    v_mfma_f32_16x16x32_bf16 v[60:63], a[240:243], v[236:239], v[60:63]
    s_waitcnt lgkmcnt(1)
    v_cvt_pk_bf16_f32 v38, v40, v41
    v_cvt_pk_bf16_f32 v39, v42, v43
    v_mfma_f32_16x16x32_bf16 v[60:63], a[252:255], v[228:231], v[60:63]
    buffer_load_dwordx2 v[224:225], v227, s[4:7], s20 offen offset:0
    v_mfma_f32_16x16x32_bf16 v[64:67], v[240:243], v[228:231], v[64:67]
    ds_write_b128 v4, v[24:27] offset:13248
    v_mfma_f32_16x16x32_bf16 v[64:67], a[244:247], v[236:239], v[64:67]
    v_mfma_f32_16x16x32_bf16 v[64:67], a[232:235], v[232:235], v[64:67]
    v_cvt_pk_bf16_f32 v56, v56, v57
    v_cvt_pk_bf16_f32 v57, v58, v59
    v_mfma_f32_16x16x32_bf16 v[68:71], a[236:239], v[232:235], v[68:71]
    ds_read_b128 v[232:235], v253 offset:34336
    v_cvt_pk_bf16_f32 v48, v48, v49
    v_mfma_f32_16x16x32_bf16 v[68:71], a[248:251], v[236:239], v[68:71]
    buffer_load_dwordx2 v[226:227], v227, s[4:7], s21 offen offset:0
    v_mfma_f32_16x16x32_bf16 v[68:71], v[244:247], v[228:231], v[68:71]
    ds_write_b64 v5, v[44:45] offset:13696
    v_mfma_f32_16x16x32_bf16 v[72:75], a[228:231], v[236:239], v[72:75]
    buffer_store_dwordx4 a[136:139], v254, s[12:15], s44 offen nt
    s_add_u32 s44, s40, 198656
    v_cvt_pk_bf16_f32 v49, v50, v51
    v_mfma_f32_16x16x32_bf16 v[72:75], a[240:243], v[228:231], v[72:75]
    s_waitcnt lgkmcnt(1)
    v_cvt_pk_bf16_f32 v50, v52, v53
    v_cvt_pk_bf16_f32 v51, v54, v55
    v_mfma_f32_16x16x32_bf16 v[72:75], a[252:255], v[232:235], v[72:75]
    ds_write_b128 v4, v[36:39] offset:13632
    v_mfma_f32_16x16x32_bf16 v[76:79], v[240:243], v[232:235], v[76:79]
    v_mfma_f32_16x16x32_bf16 v[76:79], a[244:247], v[228:231], v[76:79]
    v_mfma_f32_16x16x32_bf16 v[76:79], a[232:235], v[236:239], v[76:79]
    v_cvt_pk_bf16_f32 v68, v68, v69
    v_cvt_pk_bf16_f32 v69, v70, v71
    v_mfma_f32_16x16x32_bf16 v[80:83], a[236:239], v[236:239], v[80:83]
    ds_read_b128 v[236:239], v253 offset:34064
    v_cvt_pk_bf16_f32 v60, v60, v61
    v_mfma_f32_16x16x32_bf16 v[80:83], a[248:251], v[228:231], v[80:83]
    v_cvt_pk_bf16_f32 v61, v62, v63
    v_cvt_pk_bf16_f32 v62, v64, v65
    v_mfma_f32_16x16x32_bf16 v[80:83], v[244:247], v[232:235], v[80:83]
    s_mov_b32 s42, 1142784
    v_cvt_pk_bf16_f32 v63, v66, v67
    v_mfma_f32_16x16x32_bf16 v[84:87], a[228:231], v[228:231], v[84:87]
    s_waitcnt lgkmcnt(0)
    v_mfma_f32_16x16x32_bf16 v[88:91], a[232:235], v[228:231], v[88:91]
    s_barrier
    v_mfma_f32_16x16x32_bf16 v[92:95], a[236:239], v[228:231], v[92:95]
    ds_read_b128 v[228:231], v253 offset:36400
    v_mfma_f32_16x16x32_bf16 v[92:95], a[248:251], v[232:235], v[92:95]
    buffer_load_dwordx4 a[228:231], v254, s[8:11], s42 offen offset:0 sc1
    v_mfma_f32_16x16x32_bf16 v[88:91], a[244:247], v[232:235], v[88:91]
    v_mfma_f32_16x16x32_bf16 v[84:87], a[240:243], v[232:235], v[84:87]
    ds_read_b128 v[232:235], v253 offset:36128
    v_cvt_pk_bf16_f32 v80, v80, v81
    v_mfma_f32_16x16x32_bf16 v[84:87], a[252:255], v[236:239], v[84:87]
    buffer_load_dwordx4 a[232:235], v254, s[8:11], s42 offen offset:1024 sc1
    v_mfma_f32_16x16x32_bf16 v[88:91], v[240:243], v[236:239], v[88:91]
    s_waitcnt vmcnt(18) lgkmcnt(1)
    v_cvt_pk_bf16_f32 v81, v82, v83
    v_cvt_pk_bf16_f32 v72, v72, v73
    v_mfma_f32_16x16x32_bf16 v[92:95], v[244:247], v[236:239], v[92:95]
    ds_read_b128 v[236:239], v253 offset:35872
    v_cvt_pk_bf16_f32 v73, v74, v75
sub30:
    v_mfma_f32_16x16x32_bf16 v[96:99], a[192:195], v[228:231], v[96:99]
    buffer_load_dwordx4 a[236:239], v254, s[8:11], s42 offen offset:2048 sc1
    v_mfma_f32_16x16x32_bf16 v[100:103], a[196:199], v[228:231], v[100:103]
    s_mov_b32 s42, 1145856
    v_cvt_pk_bf16_f32 v74, v76, v77
    v_cvt_pk_bf16_f32 v75, v78, v79
    v_mfma_f32_16x16x32_bf16 v[104:107], a[200:203], v[228:231], v[104:107]
    ds_read_b128 v[228:231], v253 offset:35616
    s_waitcnt vmcnt(16)
    s_waitcnt lgkmcnt(2)
    v_mfma_f32_16x16x32_bf16 v[104:107], a[212:215], v[232:235], v[104:107]
    ds_read_b128 a[140:143], v6 offset:2048
    v_mfma_f32_16x16x32_bf16 v[100:103], a[208:211], v[232:235], v[100:103]
    buffer_load_dwordx4 a[240:243], v254, s[8:11], s42 offen offset:0 sc1
    v_mfma_f32_16x16x32_bf16 v[96:99], a[204:207], v[232:235], v[96:99]
    s_waitcnt vmcnt(12) lgkmcnt(2)
    v_cvt_pk_bf16_f32 v92, v92, v93
    v_cvt_pk_bf16_f32 v93, v94, v95
    v_mfma_f32_16x16x32_bf16 v[96:99], a[216:219], v[236:239], v[96:99]
    v_cvt_pk_bf16_f32 v84, v84, v85
    v_cvt_pk_bf16_f32 v85, v86, v87
    v_mfma_f32_16x16x32_bf16 v[100:103], a[220:223], v[236:239], v[100:103]
    ds_read_b128 a[144:147], v6 offset:5152
    v_cvt_pk_bf16_f32 v86, v88, v89
    v_mfma_f32_16x16x32_bf16 v[104:107], a[224:227], v[236:239], v[104:107]
    buffer_load_dwordx4 a[244:247], v254, s[8:11], s42 offen offset:1024 sc1
    v_mfma_f32_16x16x32_bf16 v[108:111], a[192:195], v[232:235], v[108:111]
    s_waitcnt lgkmcnt(1)
    v_cvt_pk_bf16_f32 v87, v90, v91
    v_mfma_f32_16x16x32_bf16 v[108:111], a[204:207], v[236:239], v[108:111]
    v_mfma_f32_16x16x32_bf16 v[108:111], a[216:219], v[228:231], v[108:111]
    ds_write_b64 v5, v[56:57] offset:14080
    v_mfma_f32_16x16x32_bf16 v[112:115], a[220:223], v[228:231], v[112:115]
    buffer_load_dwordx4 a[248:251], v254, s[8:11], s42 offen offset:2048 sc1
    v_mfma_f32_16x16x32_bf16 v[112:115], a[208:211], v[236:239], v[112:115]
    s_mov_b32 s42, 1148928
    v_mfma_f32_16x16x32_bf16 v[112:115], a[196:199], v[232:235], v[112:115]
    buffer_store_dwordx4 a[140:143], v254, s[12:15], s44 offen nt
    s_add_u32 s44, s40, 201728
    s_waitcnt lgkmcnt(1)
    v_mfma_f32_16x16x32_bf16 v[116:119], a[200:203], v[232:235], v[116:119]
    ds_read_b128 v[232:235], v253 offset:35360
    v_mfma_f32_16x16x32_bf16 v[116:119], a[212:215], v[236:239], v[116:119]
    buffer_load_dwordx4 a[252:255], v254, s[8:11], s42 offen offset:0 sc1
    v_mfma_f32_16x16x32_bf16 v[116:119], a[224:227], v[228:231], v[116:119]
    ds_read_b128 a[148:151], v6 offset:8256
    v_mfma_f32_16x16x32_bf16 v[120:123], a[192:195], v[236:239], v[120:123]
    v_mfma_f32_16x16x32_bf16 v[120:123], a[204:207], v[228:231], v[120:123]
    s_waitcnt lgkmcnt(1)
    v_mfma_f32_16x16x32_bf16 v[120:123], a[216:219], v[232:235], v[120:123]
    ds_write_b128 v4, v[48:51] offset:14016
    v_mfma_f32_16x16x32_bf16 v[124:127], a[220:223], v[232:235], v[124:127]
    buffer_load_dwordx4 v[240:243], v254, s[8:11], s42 offen offset:1024 sc1
    v_mfma_f32_16x16x32_bf16 v[124:127], a[208:211], v[228:231], v[124:127]
    ds_read_b128 a[152:155], v6 offset:11360
    v_mfma_f32_16x16x32_bf16 v[124:127], a[196:199], v[236:239], v[124:127]
    v_mfma_f32_16x16x32_bf16 v[128:131], a[200:203], v[236:239], v[128:131]
    ds_read_b128 v[236:239], v253 offset:37184
    v_mfma_f32_16x16x32_bf16 v[128:131], a[212:215], v[228:231], v[128:131]
    buffer_load_dwordx4 v[244:247], v254, s[8:11], s42 offen offset:2048 sc1
    v_mfma_f32_16x16x32_bf16 v[128:131], a[224:227], v[232:235], v[128:131]
    ds_write_b64 v5, v[68:69] offset:14464
    v_mfma_f32_16x16x32_bf16 v[132:135], a[192:195], v[228:231], v[132:135]
    buffer_store_dwordx4 a[144:147], v254, s[12:15], s44 offen nt
    v_and_b32 v203, 0x7fff, v255
    s_waitcnt vmcnt(12)
    v_mfma_f32_16x16x32_bf16 v[132:135], a[204:207], v[232:235], v[132:135]
    s_waitcnt lgkmcnt(1)
    v_lshlrev_b32 v248, 16, v218
    v_lshlrev_b32 v249, 16, v220
    v_mfma_f32_16x16x32_bf16 v[132:135], a[216:219], v[236:239], v[132:135]
    buffer_load_dwordx2 v[192:193], v203, s[4:7], s16 offen offset:384
    v_mfma_f32_16x16x32_bf16 v[136:139], a[220:223], v[236:239], v[136:139]
    s_add_u32 s44, s40, 204800
    v_lshlrev_b32 v250, 16, v222
    v_lshlrev_b32 v251, 16, v224
    v_mfma_f32_16x16x32_bf16 v[136:139], a[208:211], v[232:235], v[136:139]
    ds_write_b128 v4, v[60:63] offset:14400
    v_mfma_f32_16x16x32_bf16 v[136:139], a[196:199], v[228:231], v[136:139]
    v_and_b32 v218, s22, v218
    v_and_b32 v220, s22, v220
    v_mfma_f32_16x16x32_bf16 v[140:143], a[200:203], v[228:231], v[140:143]
    ds_read_b128 v[228:231], v253 offset:36928
    v_and_b32 v222, s22, v222
    v_mfma_f32_16x16x32_bf16 v[140:143], a[212:215], v[232:235], v[140:143]
    buffer_load_dwordx2 v[194:195], v203, s[4:7], s17 offen offset:384
    v_mfma_f32_16x16x32_bf16 v[140:143], a[224:227], v[236:239], v[140:143]
    ds_write_b64 v5, v[80:81] offset:14848
    v_mfma_f32_16x16x32_bf16 v[144:147], a[192:195], v[232:235], v[144:147]
    v_and_b32 v224, s22, v224
    v_lshlrev_b32 v252, 16, v216
    v_mfma_f32_16x16x32_bf16 v[144:147], a[204:207], v[236:239], v[144:147]
    s_waitcnt lgkmcnt(1)
    v_and_b32 v216, s22, v216
    v_fmac_f32 v252, s25, v251
    v_mfma_f32_16x16x32_bf16 v[144:147], a[216:219], v[228:231], v[144:147]
    buffer_load_dwordx2 v[196:197], v203, s[4:7], s18 offen offset:384
    v_mfma_f32_16x16x32_bf16 v[148:151], a[220:223], v[228:231], v[148:151]
    v_fmac_f32 v216, s25, v224
    v_fmac_f32 v252, s28, v249
    v_mfma_f32_16x16x32_bf16 v[148:151], a[208:211], v[236:239], v[148:151]
    ds_write_b128 v4, v[72:75] offset:14784
    v_mfma_f32_16x16x32_bf16 v[148:151], a[196:199], v[232:235], v[148:151]
    v_fmac_f32 v216, s28, v220
    v_cvt_pk_bf16_f32 v216, v252, v216
    v_mfma_f32_16x16x32_bf16 v[152:155], a[200:203], v[232:235], v[152:155]
    ds_read_b128 v[232:235], v253 offset:36672
    v_lshlrev_b32 v252, 16, v226
    v_mfma_f32_16x16x32_bf16 v[152:155], a[212:215], v[236:239], v[152:155]
    buffer_load_dwordx2 v[198:199], v203, s[4:7], s19 offen offset:384
    v_mfma_f32_16x16x32_bf16 v[152:155], a[224:227], v[228:231], v[152:155]
    ds_write_b64 v5, v[92:93] offset:15232
    v_mfma_f32_16x16x32_bf16 v[156:159], a[192:195], v[236:239], v[156:159]
    v_and_b32 v226, s22, v226
    v_fmac_f32 v252, s29, v248
    v_mfma_f32_16x16x32_bf16 v[156:159], a[204:207], v[228:231], v[156:159]
    s_waitcnt lgkmcnt(1)
    v_fmac_f32 v226, s29, v218
    v_fmac_f32 v252, s23, v250
    v_mfma_f32_16x16x32_bf16 v[156:159], a[216:219], v[232:235], v[156:159]
    buffer_load_dwordx2 v[200:201], v203, s[4:7], s20 offen offset:384
    v_mfma_f32_16x16x32_bf16 v[160:163], a[220:223], v[232:235], v[160:163]
    ds_write_b128 v4, v[84:87] offset:15168
    v_mfma_f32_16x16x32_bf16 v[160:163], a[208:211], v[228:231], v[160:163]
    v_fmac_f32 v226, s23, v222
    v_cvt_pk_bf16_f32 v226, v252, v226
    v_mfma_f32_16x16x32_bf16 v[160:163], a[196:199], v[236:239], v[160:163]
    v_fma_f32 v252, v249, s24, v251
    v_fmac_f32 v251, -4.0, v249
    v_mfma_f32_16x16x32_bf16 v[164:167], a[200:203], v[236:239], v[164:167]
    ds_read_b128 v[236:239], v253 offset:36416
    v_fma_f32 v249, v248, s24, v250
    v_mfma_f32_16x16x32_bf16 v[164:167], a[212:215], v[228:231], v[164:167]
    buffer_load_dwordx2 v[202:203], v203, s[4:7], s21 offen offset:384
    v_mfma_f32_16x16x32_bf16 v[164:167], a[224:227], v[232:235], v[164:167]
    v_fmac_f32 v250, -4.0, v248
    v_fma_f32 v248, v250, s26, v251
    v_mfma_f32_16x16x32_bf16 v[168:171], a[192:195], v[228:231], v[168:171]
    buffer_store_dwordx4 a[148:151], v254, s[12:15], s44 offen nt
    s_add_u32 s44, s40, 207872
    v_fmac_f32 v251, s27, v250
    v_mfma_f32_16x16x32_bf16 v[168:171], a[204:207], v[232:235], v[168:171]
    s_waitcnt lgkmcnt(0)
    v_fma_f32 v250, v249, 2.0, v252
    v_fmac_f32 v252, -2.0, v249
    v_mfma_f32_16x16x32_bf16 v[168:171], a[216:219], v[236:239], v[168:171]
    v_fma_f32 v249, v220, s24, v224
    v_fmac_f32 v224, -4.0, v220
    v_mfma_f32_16x16x32_bf16 v[172:175], a[220:223], v[236:239], v[172:175]
    v_fma_f32 v220, v218, s24, v222
    v_fmac_f32 v222, -4.0, v218
    v_mfma_f32_16x16x32_bf16 v[172:175], a[208:211], v[232:235], v[172:175]
    v_fma_f32 v218, v222, s26, v224
    v_fmac_f32 v224, s27, v222
    v_mfma_f32_16x16x32_bf16 v[172:175], a[196:199], v[228:231], v[172:175]
    v_fma_f32 v222, v220, 2.0, v249
    v_fmac_f32 v249, -2.0, v220
    v_mfma_f32_16x16x32_bf16 v[176:179], a[200:203], v[228:231], v[176:179]
    ds_read_b128 v[228:231], v253 offset:36144
    v_cvt_pk_bf16_f32 v218, v248, v218
    v_mfma_f32_16x16x32_bf16 v[176:179], a[212:215], v[232:235], v[176:179]
    v_cvt_pk_bf16_f32 v224, v251, v224
    v_cvt_pk_bf16_f32 v222, v250, v222
    v_mfma_f32_16x16x32_bf16 v[176:179], a[224:227], v[236:239], v[176:179]
    s_mov_b32 s42, 1179648
    v_cvt_pk_bf16_f32 v220, v252, v249
    v_mfma_f32_16x16x32_bf16 v[180:183], a[192:195], v[232:235], v[180:183]
    s_waitcnt lgkmcnt(0)
    v_lshlrev_b32 v248, 16, v219
    v_lshlrev_b32 v249, 16, v221
    v_mfma_f32_16x16x32_bf16 v[184:187], a[196:199], v[232:235], v[184:187]
    s_barrier
    v_mfma_f32_16x16x32_bf16 v[188:191], a[200:203], v[232:235], v[188:191]
    ds_read_b128 v[232:235], v253 offset:38480
    v_lshlrev_b32 v250, 16, v223
    v_mfma_f32_16x16x32_bf16 v[188:191], a[212:215], v[236:239], v[188:191]
    buffer_load_dwordx4 a[192:195], v254, s[8:11], s42 offen offset:0 sc1
    v_mfma_f32_16x16x32_bf16 v[184:187], a[208:211], v[236:239], v[184:187]
    v_lshlrev_b32 v251, 16, v225
    v_and_b32 v219, s22, v219
    v_mfma_f32_16x16x32_bf16 v[180:183], a[204:207], v[236:239], v[180:183]
    ds_read_b128 v[236:239], v253 offset:38208
    v_and_b32 v221, s22, v221
    v_mfma_f32_16x16x32_bf16 v[180:183], a[216:219], v[228:231], v[180:183]
    buffer_load_dwordx4 a[196:199], v254, s[8:11], s42 offen offset:1024 sc1
    v_mfma_f32_16x16x32_bf16 v[184:187], a[220:223], v[228:231], v[184:187]
    s_waitcnt vmcnt(17) lgkmcnt(1)
    v_and_b32 v223, s22, v223
    v_and_b32 v225, s22, v225
    v_mfma_f32_16x16x32_bf16 v[188:191], a[224:227], v[228:231], v[188:191]
    ds_read_b128 v[228:231], v253 offset:37952
    v_lshlrev_b32 v252, 16, v217
sub31:
    v_mfma_f32_16x16x32_bf16 v[96:99], a[228:231], v[232:235], v[96:99]
    buffer_load_dwordx4 a[200:203], v254, s[8:11], s42 offen offset:2048 sc1
    v_mfma_f32_16x16x32_bf16 v[100:103], a[232:235], v[232:235], v[100:103]
    s_mov_b32 s42, 1182720
    v_and_b32 v217, s22, v217
    v_fmac_f32 v252, s25, v251
    v_mfma_f32_16x16x32_bf16 v[104:107], a[236:239], v[232:235], v[104:107]
    ds_read_b128 v[232:235], v253 offset:37696
    s_waitcnt vmcnt(15)
    s_waitcnt lgkmcnt(2)
    v_mfma_f32_16x16x32_bf16 v[104:107], a[248:251], v[236:239], v[104:107]
    ds_read_b128 a[0:3], v6 offset:12480
    v_fmac_f32 v217, s25, v225
    v_mfma_f32_16x16x32_bf16 v[100:103], a[244:247], v[236:239], v[100:103]
    buffer_load_dwordx4 a[204:207], v254, s[8:11], s42 offen offset:0 sc1
    v_mfma_f32_16x16x32_bf16 v[96:99], a[240:243], v[236:239], v[96:99]
    s_waitcnt vmcnt(12) lgkmcnt(2)
    v_fmac_f32 v252, s28, v249
    v_fmac_f32 v217, s28, v221
    v_mfma_f32_16x16x32_bf16 v[96:99], a[252:255], v[228:231], v[96:99]
    buffer_store_dwordx4 a[152:155], v254, s[12:15], s44 offen nt
    v_cvt_pk_bf16_f32 v217, v252, v217
    v_lshlrev_b32 v252, 16, v227
    v_mfma_f32_16x16x32_bf16 v[100:103], v[240:243], v[228:231], v[100:103]
    v_and_b32 v227, s22, v227
    v_fmac_f32 v252, s29, v248
    v_mfma_f32_16x16x32_bf16 v[104:107], v[244:247], v[228:231], v[104:107]
    buffer_load_dwordx4 a[208:211], v254, s[8:11], s42 offen offset:1024 sc1
    v_mfma_f32_16x16x32_bf16 v[108:111], a[228:231], v[236:239], v[108:111]
    ds_read_b128 a[4:7], v6 offset:13504
    s_add_u32 s44, s40, 0
    v_mfma_f32_16x16x32_bf16 v[108:111], a[240:243], v[228:231], v[108:111]
    s_waitcnt lgkmcnt(2)
    v_fmac_f32 v227, s29, v219
    v_fmac_f32 v252, s23, v250
    v_mfma_f32_16x16x32_bf16 v[108:111], a[252:255], v[232:235], v[108:111]
    v_fmac_f32 v227, s23, v223
    v_cvt_pk_bf16_f32 v227, v252, v227
    v_mfma_f32_16x16x32_bf16 v[112:115], v[240:243], v[232:235], v[112:115]
    buffer_load_dwordx4 a[212:215], v254, s[8:11], s42 offen offset:2048 sc1
    v_mfma_f32_16x16x32_bf16 v[112:115], a[244:247], v[228:231], v[112:115]
    s_mov_b32 s42, 1185792
    v_fma_f32 v252, v249, s24, v251
    v_fmac_f32 v251, -4.0, v249
    v_mfma_f32_16x16x32_bf16 v[112:115], a[232:235], v[236:239], v[112:115]
    s_waitcnt lgkmcnt(1)
    v_fma_f32 v249, v248, s24, v250
    v_mfma_f32_16x16x32_bf16 v[116:119], a[236:239], v[236:239], v[116:119]
    ds_read_b128 v[236:239], v253 offset:37440
    v_fmac_f32 v250, -4.0, v248
    v_mfma_f32_16x16x32_bf16 v[116:119], a[248:251], v[228:231], v[116:119]
    buffer_load_dwordx4 a[216:219], v254, s[8:11], s42 offen offset:0 sc1
    v_mfma_f32_16x16x32_bf16 v[116:119], v[244:247], v[232:235], v[116:119]
    v_fma_f32 v248, v250, s26, v251
    v_fmac_f32 v251, s27, v250
    v_mfma_f32_16x16x32_bf16 v[120:123], a[228:231], v[228:231], v[120:123]
    v_fma_f32 v250, v249, 2.0, v252
    v_fmac_f32 v252, -2.0, v249
    v_mfma_f32_16x16x32_bf16 v[120:123], a[240:243], v[232:235], v[120:123]
    s_waitcnt lgkmcnt(0)
    v_fma_f32 v249, v221, s24, v225
    v_fmac_f32 v225, -4.0, v221
    v_mfma_f32_16x16x32_bf16 v[120:123], a[252:255], v[236:239], v[120:123]
    v_fma_f32 v221, v219, s24, v223
    v_fmac_f32 v223, -4.0, v219
    v_mfma_f32_16x16x32_bf16 v[124:127], v[240:243], v[236:239], v[124:127]
    buffer_load_dwordx4 a[220:223], v254, s[8:11], s42 offen offset:1024 sc1
    v_mfma_f32_16x16x32_bf16 v[124:127], a[244:247], v[232:235], v[124:127]
    ds_read_b128 a[8:11], v6 offset:14528
    v_fma_f32 v219, v223, s26, v225
    v_mfma_f32_16x16x32_bf16 v[124:127], a[232:235], v[228:231], v[124:127]
    v_fmac_f32 v225, s27, v223
    v_fma_f32 v223, v221, 2.0, v249
    v_mfma_f32_16x16x32_bf16 v[128:131], a[236:239], v[228:231], v[128:131]
    ds_read_b128 v[228:231], v253 offset:39264
    v_fmac_f32 v249, -2.0, v221
    v_mfma_f32_16x16x32_bf16 v[128:131], a[248:251], v[232:235], v[128:131]
    buffer_load_dwordx4 a[224:227], v254, s[8:11], s42 offen offset:2048 sc1
    v_mfma_f32_16x16x32_bf16 v[128:131], v[244:247], v[236:239], v[128:131]
    v_cvt_pk_bf16_f32 v219, v248, v219
    v_cvt_pk_bf16_f32 v225, v251, v225
    v_mfma_f32_16x16x32_bf16 v[132:135], a[228:231], v[232:235], v[132:135]
    buffer_store_dwordx4 a[0:3], v254, s[12:15], s44 offen nt
    v_and_b32 v215, 0x7fff, v255
    v_cvt_pk_bf16_f32 v223, v250, v223
    v_mfma_f32_16x16x32_bf16 v[132:135], a[240:243], v[236:239], v[132:135]
    s_waitcnt lgkmcnt(0)
    s_add_u32 s44, s40, 1024
    v_cvt_pk_bf16_f32 v221, v252, v249
    v_mfma_f32_16x16x32_bf16 v[132:135], a[252:255], v[228:231], v[132:135]
    buffer_load_dwordx2 v[204:205], v215, s[4:7], s16 offen offset:768
    v_mfma_f32_16x16x32_bf16 v[136:139], v[240:243], v[228:231], v[136:139]
    v_lshrrev_b32 v252, 15, v255
    v_mfma_f32_16x16x32_bf16 v[136:139], a[244:247], v[236:239], v[136:139]
    ds_write_b64 v252, v[218:219] offset:768
    v_mfma_f32_16x16x32_bf16 v[136:139], a[232:235], v[232:235], v[136:139]
    s_waitcnt vmcnt(13)
    v_lshrrev_b32 v218, 15, v255
    v_lshlrev_b32 v248, 16, v194
    v_mfma_f32_16x16x32_bf16 v[140:143], a[236:239], v[232:235], v[140:143]
    ds_read_b128 v[232:235], v253 offset:39008
    v_lshlrev_b32 v249, 16, v196
    v_mfma_f32_16x16x32_bf16 v[140:143], a[248:251], v[236:239], v[140:143]
    buffer_load_dwordx2 v[206:207], v215, s[4:7], s17 offen offset:768
    v_mfma_f32_16x16x32_bf16 v[140:143], v[244:247], v[228:231], v[140:143]
    v_lshlrev_b32 v250, 16, v198
    v_lshlrev_b32 v251, 16, v200
    v_mfma_f32_16x16x32_bf16 v[144:147], a[228:231], v[236:239], v[144:147]
    ds_read_b128 a[12:15], v6 offset:15584
    v_and_b32 v194, s22, v194
    v_mfma_f32_16x16x32_bf16 v[144:147], a[240:243], v[228:231], v[144:147]
    s_waitcnt lgkmcnt(1)
    v_and_b32 v196, s22, v196
    v_and_b32 v198, s22, v198
    v_mfma_f32_16x16x32_bf16 v[144:147], a[252:255], v[232:235], v[144:147]
    buffer_load_dwordx2 v[208:209], v215, s[4:7], s18 offen offset:768
    v_mfma_f32_16x16x32_bf16 v[148:151], v[240:243], v[232:235], v[148:151]
    ds_write_b64 v218, v[224:225] offset:2848
    v_mfma_f32_16x16x32_bf16 v[148:151], a[244:247], v[228:231], v[148:151]
    v_and_b32 v200, s22, v200
    v_lshlrev_b32 v252, 16, v192
    v_mfma_f32_16x16x32_bf16 v[148:151], a[232:235], v[236:239], v[148:151]
    ds_write_b64 v218, v[222:223] offset:4928
    v_mfma_f32_16x16x32_bf16 v[152:155], a[236:239], v[236:239], v[152:155]
    ds_read_b128 v[236:239], v253 offset:38752
    v_and_b32 v192, s22, v192
    v_mfma_f32_16x16x32_bf16 v[152:155], a[248:251], v[228:231], v[152:155]
    buffer_load_dwordx2 v[210:211], v215, s[4:7], s19 offen offset:768
    v_mfma_f32_16x16x32_bf16 v[152:155], v[244:247], v[232:235], v[152:155]
    ds_write_b64 v218, v[216:217] offset:34048
    v_mfma_f32_16x16x32_bf16 v[156:159], a[228:231], v[228:231], v[156:159]
    v_fmac_f32 v252, s25, v251
    v_fmac_f32 v192, s25, v200
    v_mfma_f32_16x16x32_bf16 v[156:159], a[240:243], v[232:235], v[156:159]
    s_waitcnt lgkmcnt(1)
    v_fmac_f32 v252, s28, v249
    v_fmac_f32 v192, s28, v196
    v_mfma_f32_16x16x32_bf16 v[156:159], a[252:255], v[236:239], v[156:159]
    buffer_load_dwordx2 v[212:213], v215, s[4:7], s20 offen offset:768
    v_mfma_f32_16x16x32_bf16 v[160:163], v[240:243], v[236:239], v[160:163]
    ds_write_b64 v218, v[226:227] offset:36128
    v_mfma_f32_16x16x32_bf16 v[160:163], a[244:247], v[232:235], v[160:163]
    v_cvt_pk_bf16_f32 v192, v252, v192
    v_lshlrev_b32 v252, 16, v202
    v_mfma_f32_16x16x32_bf16 v[160:163], a[232:235], v[228:231], v[160:163]
    ds_read_b128 a[16:19], v6 offset:16608
    v_and_b32 v202, s22, v202
    v_mfma_f32_16x16x32_bf16 v[164:167], a[236:239], v[228:231], v[164:167]
    ds_read_b128 v[228:231], v253 offset:38496
    v_fmac_f32 v252, s29, v248
    v_mfma_f32_16x16x32_bf16 v[164:167], a[248:251], v[232:235], v[164:167]
    buffer_load_dwordx2 v[214:215], v215, s[4:7], s21 offen offset:768
    v_mfma_f32_16x16x32_bf16 v[164:167], v[244:247], v[236:239], v[164:167]
    ds_write_b64 v218, v[220:221] offset:7008
    v_mfma_f32_16x16x32_bf16 v[168:171], a[228:231], v[232:235], v[168:171]
    buffer_store_dwordx4 a[4:7], v254, s[12:15], s44 offen nt
    s_add_u32 s44, s40, 2048
    v_fmac_f32 v202, s29, v194
    v_mfma_f32_16x16x32_bf16 v[168:171], a[240:243], v[236:239], v[168:171]
    s_waitcnt lgkmcnt(1)
    v_fmac_f32 v252, s23, v250
    v_fmac_f32 v202, s23, v198
    v_mfma_f32_16x16x32_bf16 v[168:171], a[252:255], v[228:231], v[168:171]
    v_cvt_pk_bf16_f32 v202, v252, v202
    v_fma_f32 v252, v249, s24, v251
    v_mfma_f32_16x16x32_bf16 v[172:175], v[240:243], v[228:231], v[172:175]
    v_fmac_f32 v251, -4.0, v249
    v_fma_f32 v249, v248, s24, v250
    v_mfma_f32_16x16x32_bf16 v[172:175], a[244:247], v[236:239], v[172:175]
    v_fmac_f32 v250, -4.0, v248
    v_fma_f32 v248, v250, s26, v251
    v_mfma_f32_16x16x32_bf16 v[172:175], a[232:235], v[232:235], v[172:175]
    v_fmac_f32 v251, s27, v250
    v_fma_f32 v250, v249, 2.0, v252
    v_mfma_f32_16x16x32_bf16 v[176:179], a[236:239], v[232:235], v[176:179]
    ds_read_b128 v[232:235], v253 offset:38224
    v_fmac_f32 v252, -2.0, v249
    v_mfma_f32_16x16x32_bf16 v[176:179], a[248:251], v[236:239], v[176:179]
    v_fma_f32 v249, v196, s24, v200
    v_fmac_f32 v200, -4.0, v196
    v_mfma_f32_16x16x32_bf16 v[176:179], v[244:247], v[228:231], v[176:179]
    s_mov_b32 s42, 1216512
    v_fma_f32 v196, v194, s24, v198
    v_fmac_f32 v198, -4.0, v194
    v_mfma_f32_16x16x32_bf16 v[180:183], a[228:231], v[236:239], v[180:183]
    v_fma_f32 v194, v198, s26, v200
    v_fmac_f32 v200, s27, v198
    v_mfma_f32_16x16x32_bf16 v[184:187], a[232:235], v[236:239], v[184:187]
    ds_read_b128 a[20:23], v6 offset:17632
    v_fma_f32 v198, v196, 2.0, v249
    v_mfma_f32_16x16x32_bf16 v[188:191], a[236:239], v[236:239], v[188:191]
    ds_read_b128 v[236:239], v253 offset:26000
    v_fmac_f32 v249, -2.0, v196
    v_mfma_f32_16x16x32_bf16 v[188:191], a[248:251], v[228:231], v[188:191]
    buffer_load_dwordx4 a[228:231], v254, s[8:11], s42 offen offset:0 sc1
    v_mfma_f32_16x16x32_bf16 v[184:187], a[244:247], v[228:231], v[184:187]
    s_waitcnt lgkmcnt(2)
    v_cvt_pk_bf16_f32 v194, v248, v194
    v_cvt_pk_bf16_f32 v200, v251, v200
    v_mfma_f32_16x16x32_bf16 v[180:183], a[240:243], v[228:231], v[180:183]
    ds_read_b128 v[228:231], v253 offset:25728
    v_cvt_pk_bf16_f32 v198, v250, v198
    v_mfma_f32_16x16x32_bf16 v[180:183], a[252:255], v[232:235], v[180:183]
    buffer_load_dwordx4 a[232:235], v254, s[8:11], s42 offen offset:1024 sc1
    v_mfma_f32_16x16x32_bf16 v[184:187], v[240:243], v[232:235], v[184:187]
    s_waitcnt vmcnt(17) lgkmcnt(1)
    v_cvt_pk_bf16_f32 v196, v252, v249
    v_lshlrev_b32 v248, 16, v195
    v_mfma_f32_16x16x32_bf16 v[188:191], v[244:247], v[232:235], v[188:191]
    ds_read_b128 v[232:235], v253 offset:25472
    v_lshlrev_b32 v249, 16, v197
sub32:
    v_mfma_f32_16x16x32_bf16 v[96:99], a[192:195], v[236:239], v[96:99]
    buffer_load_dwordx4 a[236:239], v254, s[8:11], s42 offen offset:2048 sc1
    v_mfma_f32_16x16x32_bf16 v[100:103], a[196:199], v[236:239], v[100:103]
pad12:
    s_cbranch_vccnz warm_ret
    s_mov_b32 s42, 1219584
    v_lshlrev_b32 v250, 16, v199
    v_lshlrev_b32 v251, 16, v201
    v_mfma_f32_16x16x32_bf16 v[104:107], a[200:203], v[236:239], v[104:107]
    ds_read_b128 v[236:239], v253 offset:25216
    s_waitcnt vmcnt(14)
    s_waitcnt lgkmcnt(2)
    v_mfma_f32_16x16x32_bf16 v[104:107], a[212:215], v[228:231], v[104:107]
    v_and_b32 v195, s22, v195
    v_and_b32 v197, s22, v197
    v_mfma_f32_16x16x32_bf16 v[100:103], a[208:211], v[228:231], v[100:103]
    buffer_load_dwordx4 a[240:243], v254, s[8:11], s42 offen offset:0 sc1
    v_mfma_f32_16x16x32_bf16 v[96:99], a[204:207], v[228:231], v[96:99]
    s_waitcnt vmcnt(12) lgkmcnt(1)
    v_and_b32 v199, s22, v199
    v_and_b32 v201, s22, v201
    v_mfma_f32_16x16x32_bf16 v[96:99], a[216:219], v[232:235], v[96:99]
    buffer_store_dwordx4 a[8:11], v254, s[12:15], s44 offen nt
    s_add_u32 s44, s40, 3072
    v_mfma_f32_16x16x32_bf16 v[100:103], a[220:223], v[232:235], v[100:103]
    ds_read_b128 a[24:27], v6 offset:18688
    v_lshlrev_b32 v252, 16, v193
    v_mfma_f32_16x16x32_bf16 v[104:107], a[224:227], v[232:235], v[104:107]
    buffer_load_dwordx4 a[244:247], v254, s[8:11], s42 offen offset:1024 sc1
    v_mfma_f32_16x16x32_bf16 v[108:111], a[192:195], v[228:231], v[108:111]
    v_and_b32 v193, s22, v193
    v_fmac_f32 v252, s25, v251
    v_mfma_f32_16x16x32_bf16 v[108:111], a[204:207], v[232:235], v[108:111]
    s_waitcnt lgkmcnt(1)
    v_fmac_f32 v193, s25, v201
    v_fmac_f32 v252, s28, v249
    v_mfma_f32_16x16x32_bf16 v[108:111], a[216:219], v[236:239], v[108:111]
    v_fmac_f32 v193, s28, v197
    v_cvt_pk_bf16_f32 v193, v252, v193
    v_mfma_f32_16x16x32_bf16 v[112:115], a[220:223], v[236:239], v[112:115]
    buffer_load_dwordx4 a[248:251], v254, s[8:11], s42 offen offset:2048 sc1
    v_mfma_f32_16x16x32_bf16 v[112:115], a[208:211], v[232:235], v[112:115]
    s_mov_b32 s42, 1222656
    v_lshlrev_b32 v252, 16, v203
    v_and_b32 v203, s22, v203
    v_mfma_f32_16x16x32_bf16 v[112:115], a[196:199], v[228:231], v[112:115]
    buffer_store_dwordx4 a[12:15], v254, s[12:15], s44 offen nt
    v_fmac_f32 v252, s29, v248
    v_fmac_f32 v203, s29, v195
    v_mfma_f32_16x16x32_bf16 v[116:119], a[200:203], v[228:231], v[116:119]
    ds_read_b128 v[228:231], v253 offset:24960
    v_fmac_f32 v252, s23, v250
    v_mfma_f32_16x16x32_bf16 v[116:119], a[212:215], v[232:235], v[116:119]
    buffer_load_dwordx4 a[252:255], v254, s[8:11], s42 offen offset:0 sc1
    v_mfma_f32_16x16x32_bf16 v[116:119], a[224:227], v[236:239], v[116:119]
    v_fmac_f32 v203, s23, v199
    v_cvt_pk_bf16_f32 v203, v252, v203
    v_mfma_f32_16x16x32_bf16 v[120:123], a[192:195], v[232:235], v[120:123]
    v_fma_f32 v252, v249, s24, v251
    v_fmac_f32 v251, -4.0, v249
    v_mfma_f32_16x16x32_bf16 v[120:123], a[204:207], v[236:239], v[120:123]
    s_waitcnt lgkmcnt(0)
    s_add_u32 s44, s40, 4096
    v_fma_f32 v249, v248, s24, v250
    v_mfma_f32_16x16x32_bf16 v[120:123], a[216:219], v[228:231], v[120:123]
    ds_read_b128 a[28:31], v6 offset:19712
    v_fmac_f32 v250, -4.0, v248
    v_mfma_f32_16x16x32_bf16 v[124:127], a[220:223], v[228:231], v[124:127]
    buffer_load_dwordx4 v[240:243], v254, s[8:11], s42 offen offset:1024 sc1
    v_mfma_f32_16x16x32_bf16 v[124:127], a[208:211], v[236:239], v[124:127]
    v_fma_f32 v248, v250, s26, v251
    v_fmac_f32 v251, s27, v250
    v_mfma_f32_16x16x32_bf16 v[124:127], a[196:199], v[232:235], v[124:127]
    v_fma_f32 v250, v249, 2.0, v252
    v_fmac_f32 v252, -2.0, v249
    v_mfma_f32_16x16x32_bf16 v[128:131], a[200:203], v[232:235], v[128:131]
    ds_read_b128 v[232:235], v253 offset:26784
    v_fma_f32 v249, v197, s24, v201
    v_mfma_f32_16x16x32_bf16 v[128:131], a[212:215], v[236:239], v[128:131]
    buffer_load_dwordx4 v[244:247], v254, s[8:11], s42 offen offset:2048 sc1
    v_mfma_f32_16x16x32_bf16 v[128:131], a[224:227], v[228:231], v[128:131]
    v_fmac_f32 v201, -4.0, v197
    v_fma_f32 v197, v195, s24, v199
    v_mfma_f32_16x16x32_bf16 v[132:135], a[192:195], v[236:239], v[132:135]
    v_and_b32 v227, 0x7fff, v255
    v_fmac_f32 v199, -4.0, v195
    v_mfma_f32_16x16x32_bf16 v[132:135], a[204:207], v[228:231], v[132:135]
    s_waitcnt lgkmcnt(0)
    v_fma_f32 v195, v199, s26, v201
    v_fmac_f32 v201, s27, v199
    v_mfma_f32_16x16x32_bf16 v[132:135], a[216:219], v[232:235], v[132:135]
    buffer_load_dwordx2 v[216:217], v227, s[4:7], s16 offen offset:1152
    v_mfma_f32_16x16x32_bf16 v[136:139], a[220:223], v[232:235], v[136:139]
    v_fma_f32 v199, v197, 2.0, v249
    v_fmac_f32 v249, -2.0, v197
    v_mfma_f32_16x16x32_bf16 v[136:139], a[208:211], v[228:231], v[136:139]
    v_cvt_pk_bf16_f32 v195, v248, v195
    v_cvt_pk_bf16_f32 v201, v251, v201
    v_mfma_f32_16x16x32_bf16 v[136:139], a[196:199], v[236:239], v[136:139]
    v_cvt_pk_bf16_f32 v199, v250, v199
    v_cvt_pk_bf16_f32 v197, v252, v249
    v_mfma_f32_16x16x32_bf16 v[140:143], a[200:203], v[236:239], v[140:143]
    ds_read_b128 v[236:239], v253 offset:26528
    v_lshrrev_b32 v252, 15, v255
    v_mfma_f32_16x16x32_bf16 v[140:143], a[212:215], v[228:231], v[140:143]
    buffer_load_dwordx2 v[218:219], v227, s[4:7], s17 offen offset:1152
    v_mfma_f32_16x16x32_bf16 v[140:143], a[224:227], v[232:235], v[140:143]
    ds_read_b128 a[32:35], v6 offset:20736
    v_mfma_f32_16x16x32_bf16 v[144:147], a[192:195], v[228:231], v[144:147]
    ds_write_b64 v252, v[194:195] offset:512
    v_mfma_f32_16x16x32_bf16 v[144:147], a[204:207], v[232:235], v[144:147]
    s_waitcnt lgkmcnt(2)
    v_lshrrev_b32 v194, 15, v255
    s_waitcnt vmcnt(14)
    v_mfma_f32_16x16x32_bf16 v[144:147], a[216:219], v[236:239], v[144:147]
    buffer_load_dwordx2 v[220:221], v227, s[4:7], s18 offen offset:1152
    v_mfma_f32_16x16x32_bf16 v[148:151], a[220:223], v[236:239], v[148:151]
    ds_write_b64 v194, v[200:201] offset:2592
    v_mfma_f32_16x16x32_bf16 v[148:151], a[208:211], v[232:235], v[148:151]
    v_lshlrev_b32 v248, 16, v206
    v_lshlrev_b32 v249, 16, v208
    v_mfma_f32_16x16x32_bf16 v[148:151], a[196:199], v[228:231], v[148:151]
    ds_write_b64 v194, v[198:199] offset:4672
    v_mfma_f32_16x16x32_bf16 v[152:155], a[200:203], v[228:231], v[152:155]
    ds_read_b128 v[228:231], v253 offset:26272
    v_lshlrev_b32 v250, 16, v210
    v_mfma_f32_16x16x32_bf16 v[152:155], a[212:215], v[232:235], v[152:155]
    buffer_load_dwordx2 v[222:223], v227, s[4:7], s19 offen offset:1152
    v_mfma_f32_16x16x32_bf16 v[152:155], a[224:227], v[236:239], v[152:155]
    ds_write_b64 v194, v[192:193] offset:33792
    v_mfma_f32_16x16x32_bf16 v[156:159], a[192:195], v[232:235], v[156:159]
    v_lshlrev_b32 v251, 16, v212
    v_and_b32 v206, s22, v206
    v_mfma_f32_16x16x32_bf16 v[156:159], a[204:207], v[236:239], v[156:159]
    s_waitcnt lgkmcnt(1)
    v_and_b32 v208, s22, v208
    v_and_b32 v210, s22, v210
    v_mfma_f32_16x16x32_bf16 v[156:159], a[216:219], v[228:231], v[156:159]
    buffer_load_dwordx2 v[224:225], v227, s[4:7], s20 offen offset:1152
    v_mfma_f32_16x16x32_bf16 v[160:163], a[220:223], v[228:231], v[160:163]
    ds_read_b128 a[36:39], v6 offset:21792
    v_and_b32 v212, s22, v212
    v_mfma_f32_16x16x32_bf16 v[160:163], a[208:211], v[236:239], v[160:163]
    ds_write_b64 v194, v[202:203] offset:35872
    v_mfma_f32_16x16x32_bf16 v[160:163], a[196:199], v[232:235], v[160:163]
    v_lshlrev_b32 v252, 16, v204
    v_and_b32 v204, s22, v204
    v_mfma_f32_16x16x32_bf16 v[164:167], a[200:203], v[232:235], v[164:167]
    ds_read_b128 v[232:235], v253 offset:26016
    v_fmac_f32 v252, s25, v251
    v_mfma_f32_16x16x32_bf16 v[164:167], a[212:215], v[236:239], v[164:167]
    buffer_load_dwordx2 v[226:227], v227, s[4:7], s21 offen offset:1152
    v_mfma_f32_16x16x32_bf16 v[164:167], a[224:227], v[228:231], v[164:167]
    ds_write_b64 v194, v[196:197] offset:6752
    v_mfma_f32_16x16x32_bf16 v[168:171], a[192:195], v[236:239], v[168:171]
    buffer_store_dwordx4 a[16:19], v254, s[12:15], s44 offen nt
    s_add_u32 s44, s40, 5120
    v_mfma_f32_16x16x32_bf16 v[168:171], a[204:207], v[228:231], v[168:171]
    s_waitcnt lgkmcnt(1)
    v_fmac_f32 v204, s25, v212
    v_fmac_f32 v252, s28, v249
    v_mfma_f32_16x16x32_bf16 v[168:171], a[216:219], v[232:235], v[168:171]
    ds_read_b128 v[192:195], v253 offset:39520
    s_mov_b32 s45, 573637648
    v_mfma_f32_16x16x32_bf16 v[172:175], a[220:223], v[232:235], v[172:175]
    buffer_store_dwordx4 a[20:23], v254, s[12:15], s44 offen nt
    v_bfe_u32 v196, v254, 5, 3
    v_mul_u32_u24 v197, 5, v196
    v_mfma_f32_16x16x32_bf16 v[172:175], a[208:211], v[228:231], v[172:175]
    v_bfe_u32 v197, s45, v197, 5
    v_mul_u32_u24 v197, 65, v197
    v_mfma_f32_16x16x32_bf16 v[172:175], a[196:199], v[236:239], v[172:175]
    v_sub_u32 v197, v197, v196
    v_lshl_add_u32 v196, v197, 5, v253
    v_mfma_f32_16x16x32_bf16 v[176:179], a[200:203], v[236:239], v[176:179]
    ds_read_b128 v[236:239], v253 offset:25744
    s_waitcnt lgkmcnt(1)
    v_mfma_f32_16x16x32_bf16 v[176:179], a[212:215], v[228:231], v[176:179]
    s_add_u32 s44, s40, 6144
    v_fmac_f32 v204, s28, v208
    v_mfma_f32_16x16x32_bf16 v[176:179], a[224:227], v[232:235], v[176:179]
    s_mov_b32 s42, 1253376
    v_cvt_pk_bf16_f32 v204, v252, v204
    v_lshlrev_b32 v252, 16, v214
    v_mfma_f32_16x16x32_bf16 v[180:183], a[192:195], v[228:231], v[180:183]
    ds_read_b128 a[40:43], v6 offset:22816
    v_and_b32 v214, s22, v214
    v_mfma_f32_16x16x32_bf16 v[184:187], a[196:199], v[228:231], v[184:187]
    s_mov_b64 exec, s[46:47]
    ds_write_b128 v196, v[192:195] offset:1024
    s_mov_b64 exec, -1
    v_mfma_f32_16x16x32_bf16 v[188:191], a[200:203], v[228:231], v[188:191]
    ds_read_b128 v[228:231], v253 offset:28080
    v_fmac_f32 v252, s29, v248
    v_mfma_f32_16x16x32_bf16 v[188:191], a[212:215], v[232:235], v[188:191]
    buffer_load_dwordx4 a[96:99], v254, s[8:11], s42 offen offset:0 sc1
    v_mfma_f32_16x16x32_bf16 v[184:187], a[208:211], v[232:235], v[184:187]
    s_waitcnt lgkmcnt(3)
    v_fmac_f32 v214, s29, v206
    v_fmac_f32 v252, s23, v250
    v_mfma_f32_16x16x32_bf16 v[180:183], a[204:207], v[232:235], v[180:183]
    ds_read_b128 v[232:235], v253 offset:27808
    v_mfma_f32_16x16x32_bf16 v[180:183], a[216:219], v[236:239], v[180:183]
    buffer_load_dwordx4 a[100:103], v254, s[8:11], s42 offen offset:1024 sc1
    v_mfma_f32_16x16x32_bf16 v[184:187], a[220:223], v[236:239], v[184:187]
    s_waitcnt vmcnt(18) lgkmcnt(1)
    v_fmac_f32 v214, s23, v210
    v_cvt_pk_bf16_f32 v214, v252, v214
    v_mfma_f32_16x16x32_bf16 v[188:191], a[224:227], v[236:239], v[188:191]
    ds_read_b128 v[236:239], v253 offset:27552
    v_fma_f32 v252, v249, s24, v251
sub33:
    v_mfma_f32_16x16x32_bf16 v[96:99], a[228:231], v[228:231], v[96:99]
    buffer_load_dwordx4 a[104:107], v254, s[8:11], s42 offen offset:2048 sc1
    v_mfma_f32_16x16x32_bf16 v[100:103], a[232:235], v[228:231], v[100:103]
    s_mov_b32 s42, 1256448
    v_fmac_f32 v251, -4.0, v249
    v_fma_f32 v249, v248, s24, v250
    v_mfma_f32_16x16x32_bf16 v[104:107], a[236:239], v[228:231], v[104:107]
    ds_read_b128 v[228:231], v253 offset:27296
    s_waitcnt vmcnt(15)
    s_waitcnt lgkmcnt(2)
    v_mfma_f32_16x16x32_bf16 v[104:107], a[248:251], v[232:235], v[104:107]
    v_fmac_f32 v250, -4.0, v248
    v_fma_f32 v248, v250, s26, v251
    v_mfma_f32_16x16x32_bf16 v[100:103], a[244:247], v[232:235], v[100:103]
    buffer_load_dwordx4 a[108:111], v254, s[8:11], s42 offen offset:0 sc1
    v_mfma_f32_16x16x32_bf16 v[96:99], a[240:243], v[232:235], v[96:99]
    s_waitcnt vmcnt(12) lgkmcnt(1)
    v_fmac_f32 v251, s27, v250
    v_fma_f32 v250, v249, 2.0, v252
    v_mfma_f32_16x16x32_bf16 v[96:99], a[252:255], v[236:239], v[96:99]
    buffer_store_dwordx4 a[24:27], v254, s[12:15], s44 offen nt
    v_fmac_f32 v252, -2.0, v249
    v_fma_f32 v249, v208, s24, v212
    v_mfma_f32_16x16x32_bf16 v[100:103], v[240:243], v[236:239], v[100:103]
    ds_read_b128 a[44:47], v6 offset:23840
    v_fmac_f32 v212, -4.0, v208
    v_mfma_f32_16x16x32_bf16 v[104:107], v[244:247], v[236:239], v[104:107]
    buffer_load_dwordx4 a[112:115], v254, s[8:11], s42 offen offset:1024 sc1
    v_mfma_f32_16x16x32_bf16 v[108:111], a[228:231], v[232:235], v[108:111]
    s_add_u32 s44, s40, 7168
    v_fma_f32 v208, v206, s24, v210
    v_fmac_f32 v210, -4.0, v206
    v_mfma_f32_16x16x32_bf16 v[108:111], a[240:243], v[236:239], v[108:111]
    s_waitcnt lgkmcnt(1)
    v_fma_f32 v206, v210, s26, v212
    v_fmac_f32 v212, s27, v210
    v_mfma_f32_16x16x32_bf16 v[108:111], a[252:255], v[228:231], v[108:111]
    v_fma_f32 v210, v208, 2.0, v249
    v_fmac_f32 v249, -2.0, v208
    v_mfma_f32_16x16x32_bf16 v[112:115], v[240:243], v[228:231], v[112:115]
    buffer_load_dwordx4 a[116:119], v254, s[8:11], s42 offen offset:2048 sc1
    v_mfma_f32_16x16x32_bf16 v[112:115], a[244:247], v[236:239], v[112:115]
    s_mov_b32 s42, 1259520
    v_cvt_pk_bf16_f32 v206, v248, v206
    v_cvt_pk_bf16_f32 v212, v251, v212
    v_mfma_f32_16x16x32_bf16 v[112:115], a[232:235], v[232:235], v[112:115]
    v_cvt_pk_bf16_f32 v210, v250, v210
    v_cvt_pk_bf16_f32 v208, v252, v249
    v_mfma_f32_16x16x32_bf16 v[116:119], a[236:239], v[232:235], v[116:119]
    ds_read_b128 v[232:235], v253 offset:27040
    v_lshlrev_b32 v248, 16, v207
    v_mfma_f32_16x16x32_bf16 v[116:119], a[248:251], v[236:239], v[116:119]
    buffer_load_dwordx4 a[120:123], v254, s[8:11], s42 offen offset:0 sc1
    v_mfma_f32_16x16x32_bf16 v[116:119], v[244:247], v[228:231], v[116:119]
    v_lshlrev_b32 v249, 16, v209
    v_lshlrev_b32 v250, 16, v211
    v_mfma_f32_16x16x32_bf16 v[120:123], a[228:231], v[236:239], v[120:123]
    v_lshlrev_b32 v251, 16, v213
    v_and_b32 v207, s22, v207
    v_mfma_f32_16x16x32_bf16 v[120:123], a[240:243], v[228:231], v[120:123]
    s_waitcnt lgkmcnt(0)
    v_and_b32 v209, s22, v209
    v_and_b32 v211, s22, v211
    v_mfma_f32_16x16x32_bf16 v[120:123], a[252:255], v[232:235], v[120:123]
    v_and_b32 v213, s22, v213
    v_lshlrev_b32 v252, 16, v205
    v_mfma_f32_16x16x32_bf16 v[124:127], v[240:243], v[232:235], v[124:127]
    buffer_load_dwordx4 a[124:127], v254, s[8:11], s42 offen offset:1024 sc1
    v_mfma_f32_16x16x32_bf16 v[124:127], a[244:247], v[228:231], v[124:127]
    v_and_b32 v205, s22, v205
    v_fmac_f32 v252, s25, v251
    v_mfma_f32_16x16x32_bf16 v[124:127], a[232:235], v[236:239], v[124:127]
    v_fmac_f32 v205, s25, v213
    v_fmac_f32 v252, s28, v249
    v_mfma_f32_16x16x32_bf16 v[128:131], a[236:239], v[236:239], v[128:131]
    ds_read_b128 v[236:239], v253 offset:28864
    v_fmac_f32 v205, s28, v209
    v_mfma_f32_16x16x32_bf16 v[128:131], a[248:251], v[228:231], v[128:131]
    buffer_load_dwordx4 a[128:131], v254, s[8:11], s42 offen offset:2048 sc1
    v_mfma_f32_16x16x32_bf16 v[128:131], v[244:247], v[232:235], v[128:131]
    s_mov_b32 s42, 1290240
    v_cvt_pk_bf16_f32 v205, v252, v205
    v_lshlrev_b32 v252, 16, v215
    v_mfma_f32_16x16x32_bf16 v[132:135], a[228:231], v[228:231], v[132:135]
    ds_read_b128 a[48:51], v253 offset:30160
    v_and_b32 v215, s22, v215
    v_mfma_f32_16x16x32_bf16 v[132:135], a[240:243], v[232:235], v[132:135]
    s_waitcnt lgkmcnt(1)
    v_fmac_f32 v252, s29, v248
    v_fmac_f32 v215, s29, v207
    v_mfma_f32_16x16x32_bf16 v[132:135], a[252:255], v[236:239], v[132:135]
    buffer_load_dwordx4 a[132:135], v254, s[8:11], s42 offen offset:0 sc1
    v_mfma_f32_16x16x32_bf16 v[136:139], v[240:243], v[236:239], v[136:139]
    v_fmac_f32 v252, s23, v250
    v_fmac_f32 v215, s23, v211
    v_mfma_f32_16x16x32_bf16 v[136:139], a[244:247], v[232:235], v[136:139]
    ds_read_b128 a[64:67], v253 offset:32240
    v_cvt_pk_bf16_f32 v215, v252, v215
    v_mfma_f32_16x16x32_bf16 v[136:139], a[232:235], v[228:231], v[136:139]
    buffer_load_dwordx4 a[136:139], v254, s[8:11], s42 offen offset:1024 sc1
    v_mfma_f32_16x16x32_bf16 v[140:143], a[236:239], v[228:231], v[140:143]
    ds_read_b128 v[228:231], v253 offset:28608
    v_fma_f32 v252, v249, s24, v251
    v_mfma_f32_16x16x32_bf16 v[140:143], a[248:251], v[232:235], v[140:143]
    v_fmac_f32 v251, -4.0, v249
    v_fma_f32 v249, v248, s24, v250
    v_mfma_f32_16x16x32_bf16 v[140:143], v[244:247], v[236:239], v[140:143]
    ds_read_b128 a[52:55], v253 offset:29888
    v_fmac_f32 v250, -4.0, v248
    v_mfma_f32_16x16x32_bf16 v[144:147], a[228:231], v[232:235], v[144:147]
    buffer_load_dwordx4 a[140:143], v254, s[8:11], s42 offen offset:2048 sc1
    v_mfma_f32_16x16x32_bf16 v[144:147], a[240:243], v[236:239], v[144:147]
    s_mov_b32 s42, 1293312
    s_waitcnt lgkmcnt(1)
    v_fma_f32 v248, v250, s26, v251
    v_mfma_f32_16x16x32_bf16 v[144:147], a[252:255], v[228:231], v[144:147]
    v_fmac_f32 v251, s27, v250
    v_fma_f32 v250, v249, 2.0, v252
    v_mfma_f32_16x16x32_bf16 v[148:151], v[240:243], v[228:231], v[148:151]
    ds_read_b128 a[68:71], v253 offset:31968
    v_fmac_f32 v252, -2.0, v249
    v_mfma_f32_16x16x32_bf16 v[148:151], a[244:247], v[236:239], v[148:151]
    buffer_load_dwordx4 a[144:147], v254, s[8:11], s42 offen offset:0 sc1
    v_mfma_f32_16x16x32_bf16 v[148:151], a[232:235], v[232:235], v[148:151]
    v_fma_f32 v249, v209, s24, v213
    v_fmac_f32 v213, -4.0, v209
    v_mfma_f32_16x16x32_bf16 v[152:155], a[236:239], v[232:235], v[152:155]
    ds_read_b128 v[232:235], v253 offset:28352
    v_fma_f32 v209, v207, s24, v211
    v_mfma_f32_16x16x32_bf16 v[152:155], a[248:251], v[236:239], v[152:155]
    ds_read_b128 a[56:59], v253 offset:29632
    v_fmac_f32 v211, -4.0, v207
    v_mfma_f32_16x16x32_bf16 v[152:155], v[244:247], v[228:231], v[152:155]
    buffer_load_dwordx4 a[148:151], v254, s[8:11], s42 offen offset:1024 sc1
    v_mfma_f32_16x16x32_bf16 v[156:159], a[228:231], v[236:239], v[156:159]
    v_fma_f32 v207, v211, s26, v213
    v_fmac_f32 v213, s27, v211
    v_mfma_f32_16x16x32_bf16 v[156:159], a[240:243], v[228:231], v[156:159]
    s_waitcnt lgkmcnt(1)
    v_fma_f32 v211, v209, 2.0, v249
    v_fmac_f32 v249, -2.0, v209
    v_mfma_f32_16x16x32_bf16 v[156:159], a[252:255], v[232:235], v[156:159]
    ds_read_b128 a[72:75], v253 offset:31712
    v_cvt_pk_bf16_f32 v207, v248, v207
    v_mfma_f32_16x16x32_bf16 v[160:163], v[240:243], v[232:235], v[160:163]
    buffer_load_dwordx4 a[152:155], v254, s[8:11], s42 offen offset:2048 sc1
    v_mfma_f32_16x16x32_bf16 v[160:163], a[244:247], v[228:231], v[160:163]
    s_mov_b32 s42, 1296384
    v_cvt_pk_bf16_f32 v213, v251, v213
    v_cvt_pk_bf16_f32 v211, v250, v211
    v_mfma_f32_16x16x32_bf16 v[160:163], a[232:235], v[236:239], v[160:163]
    v_cvt_pk_bf16_f32 v209, v252, v249
    v_lshrrev_b32 v252, 15, v255
    v_mfma_f32_16x16x32_bf16 v[164:167], a[236:239], v[236:239], v[164:167]
    ds_read_b128 v[236:239], v253 offset:28096
    v_mfma_f32_16x16x32_bf16 v[164:167], a[248:251], v[228:231], v[164:167]
    buffer_load_dwordx4 a[156:159], v254, s[8:11], s42 offen offset:0 sc1
    v_mfma_f32_16x16x32_bf16 v[164:167], v[244:247], v[232:235], v[164:167]
    ds_read_b128 a[60:63], v253 offset:29376
    v_mfma_f32_16x16x32_bf16 v[168:171], a[228:231], v[228:231], v[168:171]
    buffer_store_dwordx4 a[28:31], v254, s[12:15], s44 offen nt
    s_add_u32 s44, s40, 8192
    v_mfma_f32_16x16x32_bf16 v[168:171], a[240:243], v[232:235], v[168:171]
    buffer_load_dwordx4 a[160:163], v254, s[8:11], s42 offen offset:1024 sc1
    s_waitcnt lgkmcnt(1)
    v_mfma_f32_16x16x32_bf16 v[168:171], a[252:255], v[236:239], v[168:171]
    ds_write_b64 v252, v[206:207] offset:256
    v_mfma_f32_16x16x32_bf16 v[172:175], v[240:243], v[236:239], v[172:175]
    ds_read_b128 a[76:79], v253 offset:31456
    v_lshrrev_b32 v206, 15, v255
    v_mfma_f32_16x16x32_bf16 v[172:175], a[244:247], v[232:235], v[172:175]
    ds_write_b64 v206, v[212:213] offset:2336
    s_waitcnt vmcnt(21)
    v_mfma_f32_16x16x32_bf16 v[172:175], a[232:235], v[228:231], v[172:175]
    buffer_load_dwordx4 a[164:167], v254, s[8:11], s42 offen offset:2048 sc1
    v_mfma_f32_16x16x32_bf16 v[176:179], a[236:239], v[228:231], v[176:179]
    ds_read_b128 v[228:231], v253 offset:27824
    v_lshlrev_b32 v248, 16, v218
    v_mfma_f32_16x16x32_bf16 v[176:179], a[248:251], v[232:235], v[176:179]
    buffer_store_dwordx4 a[32:35], v254, s[12:15], s44 offen nt
    s_add_u32 s44, s40, 9216
    v_mfma_f32_16x16x32_bf16 v[176:179], v[244:247], v[236:239], v[176:179]
    s_add_u32 s42, s36, 0
    v_lshlrev_b32 v249, 16, v220
    v_lshlrev_b32 v250, 16, v222
    v_mfma_f32_16x16x32_bf16 v[180:183], a[228:231], v[232:235], v[180:183]
    s_waitcnt lgkmcnt(0)
    v_lshlrev_b32 v251, 16, v224
    v_and_b32 v218, s22, v218
    v_and_b32 v220, s22, v220
    v_mfma_f32_16x16x32_bf16 v[184:187], a[232:235], v[232:235], v[184:187]
    s_barrier
    v_mfma_f32_16x16x32_bf16 v[188:191], a[236:239], v[232:235], v[188:191]
    ds_write_b64 v206, v[210:211] offset:4416
    v_mfma_f32_16x16x32_bf16 v[188:191], a[248:251], v[236:239], v[188:191]
    buffer_load_dwordx4 a[192:195], v254, s[8:11], s42 offen offset:0 sc1
    v_mfma_f32_16x16x32_bf16 v[184:187], a[244:247], v[236:239], v[184:187]
    ds_write_b64 v206, v[204:205] offset:33536
    v_mfma_f32_16x16x32_bf16 v[180:183], a[240:243], v[236:239], v[180:183]
    v_and_b32 v222, s22, v222
    v_and_b32 v224, s22, v224
    v_lshlrev_b32 v252, 16, v216
    v_mfma_f32_16x16x32_bf16 v[180:183], a[252:255], v[228:231], v[180:183]
    buffer_load_dwordx4 a[196:199], v254, s[8:11], s42 offen offset:1024 sc1
    v_mfma_f32_16x16x32_bf16 v[184:187], v[240:243], v[228:231], v[184:187]
    ds_write_b64 v206, v[214:215] offset:35616
    v_mfma_f32_16x16x32_bf16 v[188:191], v[244:247], v[228:231], v[188:191]
    s_waitcnt vmcnt(13)
    v_and_b32 v216, s22, v216
    v_fmac_f32 v252, s25, v251
sub34:
    v_mfma_f32_16x16x32_bf16 v[96:99], a[96:99], a[48:51], v[96:99]
    buffer_load_dwordx4 a[200:203], v254, s[8:11], s42 offen offset:2048 sc1
    v_mfma_f32_16x16x32_bf16 v[96:99], a[108:111], a[52:55], v[96:99]
    s_add_u32 s42, s36, 3072
    v_fmac_f32 v216, s25, v224
    v_fmac_f32 v252, s28, v249
    v_fmac_f32 v216, s28, v220
    v_mfma_f32_16x16x32_bf16 v[96:99], a[120:123], a[56:59], v[96:99]
    ds_write_b64 v206, v[208:209] offset:6496
    v_mfma_f32_16x16x32_bf16 v[100:103], a[124:127], a[56:59], v[100:103]
    v_cvt_pk_bf16_f32 v216, v252, v216
    v_lshlrev_b32 v252, 16, v226
    v_mfma_f32_16x16x32_bf16 v[100:103], a[112:115], a[52:55], v[100:103]
    buffer_load_dwordx4 a[204:207], v254, s[8:11], s42 offen offset:0 sc1
    v_mfma_f32_16x16x32_bf16 v[100:103], a[100:103], a[48:51], v[100:103]
    v_and_b32 v226, s22, v226
    v_fmac_f32 v252, s29, v248
    v_mfma_f32_16x16x32_bf16 v[104:107], a[104:107], a[48:51], v[104:107]
    ds_read_b128 a[48:51], v253 offset:29120
    v_fmac_f32 v226, s29, v218
    v_fmac_f32 v252, s23, v250
    v_mfma_f32_16x16x32_bf16 v[104:107], a[116:119], a[52:55], v[104:107]
    v_fmac_f32 v226, s23, v222
    v_cvt_pk_bf16_f32 v226, v252, v226
    v_mfma_f32_16x16x32_bf16 v[104:107], a[128:131], a[56:59], v[104:107]
    buffer_load_dwordx4 a[208:211], v254, s[8:11], s42 offen offset:1024 sc1
    v_mfma_f32_16x16x32_bf16 v[108:111], a[96:99], a[52:55], v[108:111]
    v_fma_f32 v252, v249, s24, v251
    v_fmac_f32 v251, -4.0, v249
    v_mfma_f32_16x16x32_bf16 v[108:111], a[108:111], a[56:59], v[108:111]
    v_fma_f32 v249, v248, s24, v250
    v_fmac_f32 v250, -4.0, v248
    v_mfma_f32_16x16x32_bf16 v[108:111], a[120:123], a[60:63], v[108:111]
    v_fma_f32 v248, v250, s26, v251
    v_fmac_f32 v251, s27, v250
    v_fma_f32 v250, v249, 2.0, v252
    v_mfma_f32_16x16x32_bf16 v[112:115], a[124:127], a[60:63], v[112:115]
    buffer_load_dwordx4 a[212:215], v254, s[8:11], s42 offen offset:2048 sc1
    v_mfma_f32_16x16x32_bf16 v[112:115], a[112:115], a[56:59], v[112:115]
    s_add_u32 s42, s36, 6144
    v_fmac_f32 v252, -2.0, v249
    v_fma_f32 v249, v220, s24, v224
    v_mfma_f32_16x16x32_bf16 v[112:115], a[100:103], a[52:55], v[112:115]
    buffer_store_dwordx4 a[36:39], v254, s[12:15], s44 offen nt
    s_add_u32 s44, s40, 10240
    v_mfma_f32_16x16x32_bf16 v[116:119], a[104:107], a[52:55], v[116:119]
    ds_read_b128 a[52:55], v253 offset:30944
    v_fmac_f32 v224, -4.0, v220
    v_mfma_f32_16x16x32_bf16 v[116:119], a[116:119], a[56:59], v[116:119]
    buffer_load_dwordx4 a[216:219], v254, s[8:11], s42 offen offset:0 sc1
    v_fma_f32 v220, v218, s24, v222
    v_mfma_f32_16x16x32_bf16 v[116:119], a[128:131], a[60:63], v[116:119]
    s_waitcnt vmcnt(16)
    v_fmac_f32 v222, -4.0, v218
    v_fma_f32 v218, v222, s26, v224
    v_mfma_f32_16x16x32_bf16 v[96:99], a[132:135], a[64:67], v[96:99]
    s_waitcnt vmcnt(13)
    v_fmac_f32 v224, s27, v222
    v_fma_f32 v222, v220, 2.0, v249
    v_mfma_f32_16x16x32_bf16 v[96:99], a[144:147], a[68:71], v[96:99]
    s_waitcnt vmcnt(9)
    v_fmac_f32 v249, -2.0, v220
    v_cvt_pk_bf16_f32 v218, v248, v218
    v_mfma_f32_16x16x32_bf16 v[96:99], a[156:159], a[72:75], v[96:99]
    v_cvt_pk_bf16_f32 v224, v251, v224
    v_cvt_pk_bf16_f32 v222, v250, v222
    v_mfma_f32_16x16x32_bf16 v[100:103], a[160:163], a[72:75], v[100:103]
    buffer_load_dwordx4 a[220:223], v254, s[8:11], s42 offen offset:1024 sc1
    v_cvt_pk_bf16_f32 v220, v252, v249
    v_mfma_f32_16x16x32_bf16 v[100:103], a[148:151], a[68:71], v[100:103]
    v_lshlrev_b32 v248, 16, v219
    v_lshlrev_b32 v249, 16, v221
    v_mfma_f32_16x16x32_bf16 v[100:103], a[136:139], a[64:67], v[100:103]
    v_lshlrev_b32 v250, 16, v223
    v_lshlrev_b32 v251, 16, v225
    v_mfma_f32_16x16x32_bf16 v[104:107], a[140:143], a[64:67], v[104:107]
    ds_read_b128 a[64:67], v253 offset:31200
    v_and_b32 v219, s22, v219
    v_mfma_f32_16x16x32_bf16 v[104:107], a[152:155], a[68:71], v[104:107]
    buffer_load_dwordx4 a[224:227], v254, s[8:11], s42 offen offset:2048 sc1
    v_mfma_f32_16x16x32_bf16 v[104:107], a[164:167], a[72:75], v[104:107]
    v_and_b32 v221, s22, v221
    v_and_b32 v223, s22, v223
    v_and_b32 v225, s22, v225
    v_mfma_f32_16x16x32_bf16 v[108:111], a[132:135], a[68:71], v[108:111]
    buffer_store_dwordx4 a[40:43], v254, s[12:15], s44 offen nt
    v_and_b32 v203, 0x7fff, v255
    s_add_u32 s44, s40, 11264
    v_mfma_f32_16x16x32_bf16 v[108:111], a[144:147], a[72:75], v[108:111]
    v_lshlrev_b32 v252, 16, v217
    v_mfma_f32_16x16x32_bf16 v[108:111], a[156:159], a[76:79], v[108:111]
    buffer_load_dwordx2 v[192:193], v203, s[4:7], s16 offen offset:64
    v_mfma_f32_16x16x32_bf16 v[112:115], a[160:163], a[76:79], v[112:115]
    v_and_b32 v217, s22, v217
    v_fmac_f32 v252, s25, v251
    v_mfma_f32_16x16x32_bf16 v[112:115], a[148:151], a[72:75], v[112:115]
    v_cvt_pk_bf16_f32 v96, v96, v97
    v_cvt_pk_bf16_f32 v97, v98, v99
    v_fmac_f32 v217, s25, v225
    v_mfma_f32_16x16x32_bf16 v[112:115], a[136:139], a[68:71], v[112:115]
    v_cvt_pk_bf16_f32 v98, v100, v101
    v_cvt_pk_bf16_f32 v99, v102, v103
    v_mfma_f32_16x16x32_bf16 v[116:119], a[140:143], a[68:71], v[116:119]
    ds_read_b128 a[68:71], v253 offset:33024
    v_fmac_f32 v252, s28, v249
    v_mfma_f32_16x16x32_bf16 v[116:119], a[152:155], a[72:75], v[116:119]
    buffer_load_dwordx2 v[194:195], v203, s[4:7], s17 offen offset:64
    v_mfma_f32_16x16x32_bf16 v[116:119], a[164:167], a[76:79], v[116:119]
    ds_write_b128 v4, v[96:99] offset:16640
    v_mfma_f32_16x16x32_bf16 v[120:123], a[96:99], a[56:59], v[120:123]
    v_fmac_f32 v217, s28, v221
    v_cvt_pk_bf16_f32 v217, v252, v217
    v_lshlrev_b32 v252, 16, v227
    v_mfma_f32_16x16x32_bf16 v[120:123], a[108:111], a[60:63], v[120:123]
    s_waitcnt lgkmcnt(4)
    v_cvt_pk_bf16_f32 v104, v104, v105
    v_cvt_pk_bf16_f32 v105, v106, v107
    v_mfma_f32_16x16x32_bf16 v[120:123], a[120:123], a[48:51], v[120:123]
    buffer_load_dwordx2 v[196:197], v203, s[4:7], s18 offen offset:64
    v_mfma_f32_16x16x32_bf16 v[120:123], a[132:135], a[72:75], v[120:123]
    ds_write_b64 v5, v[104:105] offset:16704
    v_mfma_f32_16x16x32_bf16 v[120:123], a[144:147], a[76:79], v[120:123]
    s_waitcnt lgkmcnt(3)
    v_cvt_pk_bf16_f32 v108, v108, v109
    v_cvt_pk_bf16_f32 v109, v110, v111
    v_mfma_f32_16x16x32_bf16 v[120:123], a[156:159], a[64:67], v[120:123]
    v_cvt_pk_bf16_f32 v110, v112, v113
    v_cvt_pk_bf16_f32 v111, v114, v115
    v_and_b32 v227, s22, v227
    v_mfma_f32_16x16x32_bf16 v[124:127], a[160:163], a[64:67], v[124:127]
    buffer_load_dwordx2 v[198:199], v203, s[4:7], s19 offen offset:64
    v_mfma_f32_16x16x32_bf16 v[124:127], a[148:151], a[76:79], v[124:127]
    ds_write_b128 v4, v[108:111] offset:17024
    v_mfma_f32_16x16x32_bf16 v[124:127], a[136:139], a[72:75], v[124:127]
    v_fmac_f32 v252, s29, v248
    v_fmac_f32 v227, s29, v219
    v_mfma_f32_16x16x32_bf16 v[124:127], a[124:127], a[48:51], v[124:127]
    v_fmac_f32 v252, s23, v250
    v_fmac_f32 v227, s23, v223
    v_mfma_f32_16x16x32_bf16 v[124:127], a[112:115], a[60:63], v[124:127]
    buffer_load_dwordx2 v[200:201], v203, s[4:7], s20 offen offset:64
    v_cvt_pk_bf16_f32 v227, v252, v227
    v_mfma_f32_16x16x32_bf16 v[124:127], a[100:103], a[56:59], v[124:127]
    v_cvt_pk_bf16_f32 v116, v116, v117
    v_cvt_pk_bf16_f32 v117, v118, v119
    v_mfma_f32_16x16x32_bf16 v[128:131], a[104:107], a[56:59], v[128:131]
    ds_read_b128 a[56:59], v253 offset:30688
    v_fma_f32 v252, v249, s24, v251
    v_mfma_f32_16x16x32_bf16 v[128:131], a[116:119], a[60:63], v[128:131]
    ds_write_b64 v5, v[116:117] offset:17088
    v_mfma_f32_16x16x32_bf16 v[128:131], a[128:131], a[48:51], v[128:131]
    buffer_load_dwordx2 v[202:203], v203, s[4:7], s21 offen offset:64
    v_mfma_f32_16x16x32_bf16 v[128:131], a[140:143], a[72:75], v[128:131]
    ds_read_b128 a[72:75], v253 offset:32768
    v_fmac_f32 v251, -4.0, v249
    v_fma_f32 v249, v248, s24, v250
    v_mfma_f32_16x16x32_bf16 v[128:131], a[152:155], a[76:79], v[128:131]
    v_fmac_f32 v250, -4.0, v248
    v_fma_f32 v248, v250, s26, v251
    v_mfma_f32_16x16x32_bf16 v[128:131], a[164:167], a[64:67], v[128:131]
    v_fmac_f32 v251, s27, v250
    v_fma_f32 v250, v249, 2.0, v252
    v_mfma_f32_16x16x32_bf16 v[132:135], a[96:99], a[60:63], v[132:135]
    buffer_store_dwordx4 a[44:47], v254, s[12:15], s44 offen nt
    v_fmac_f32 v252, -2.0, v249
    v_fma_f32 v249, v221, s24, v225
    v_mfma_f32_16x16x32_bf16 v[132:135], a[108:111], a[48:51], v[132:135]
    v_cvt_pk_bf16_f32 v120, v120, v121
    v_cvt_pk_bf16_f32 v121, v122, v123
    v_mfma_f32_16x16x32_bf16 v[132:135], a[120:123], a[52:55], v[132:135]
    v_cvt_pk_bf16_f32 v122, v124, v125
    v_cvt_pk_bf16_f32 v123, v126, v127
    v_fmac_f32 v225, -4.0, v221
    v_mfma_f32_16x16x32_bf16 v[132:135], a[132:135], a[76:79], v[132:135]
    v_fma_f32 v221, v219, s24, v223
    v_fmac_f32 v223, -4.0, v219
    v_mfma_f32_16x16x32_bf16 v[132:135], a[144:147], a[64:67], v[132:135]
    s_waitcnt lgkmcnt(6)
    v_fma_f32 v219, v223, s26, v225
    v_fmac_f32 v225, s27, v223
    v_mfma_f32_16x16x32_bf16 v[132:135], a[156:159], a[68:71], v[132:135]
    ds_write_b128 v4, v[120:123] offset:17408
    v_mfma_f32_16x16x32_bf16 v[136:139], a[160:163], a[68:71], v[136:139]
pad13:
    s_cbranch_vccnz warm_ret
    v_fma_f32 v223, v221, 2.0, v249
    v_fmac_f32 v249, -2.0, v221
    v_mfma_f32_16x16x32_bf16 v[136:139], a[148:151], a[64:67], v[136:139]
    v_cvt_pk_bf16_f32 v128, v128, v129
    v_cvt_pk_bf16_f32 v129, v130, v131
    v_cvt_pk_bf16_f32 v219, v248, v219
    v_mfma_f32_16x16x32_bf16 v[136:139], a[136:139], a[76:79], v[136:139]
    s_add_u32 s42, s36, 36864
    v_cvt_pk_bf16_f32 v225, v251, v225
    v_cvt_pk_bf16_f32 v223, v250, v223
    v_mfma_f32_16x16x32_bf16 v[136:139], a[124:127], a[52:55], v[136:139]
    ds_write_b64 v5, v[128:129] offset:17472
    v_mfma_f32_16x16x32_bf16 v[136:139], a[112:115], a[48:51], v[136:139]
    v_cvt_pk_bf16_f32 v221, v252, v249
    v_lshrrev_b32 v252, 15, v255
    v_mfma_f32_16x16x32_bf16 v[136:139], a[100:103], a[60:63], v[136:139]
    ds_write_b64 v252, v[218:219] offset:0
    v_mfma_f32_16x16x32_bf16 v[140:143], a[104:107], a[60:63], v[140:143]
    buffer_load_dwordx4 a[228:231], v254, s[8:11], s42 offen offset:0 sc1
    v_mfma_f32_16x16x32_bf16 v[140:143], a[116:119], a[48:51], v[140:143]
    ds_read_b128 a[60:63], v253 offset:30432
    v_lshrrev_b32 v218, 15, v255
    v_mfma_f32_16x16x32_bf16 v[140:143], a[128:131], a[52:55], v[140:143]
    ds_write_b64 v218, v[224:225] offset:2080
    v_mfma_f32_16x16x32_bf16 v[140:143], a[140:143], a[76:79], v[140:143]
    buffer_load_dwordx4 a[232:235], v254, s[8:11], s42 offen offset:1024 sc1
    v_mfma_f32_16x16x32_bf16 v[140:143], a[152:155], a[64:67], v[140:143]
    ds_read_b128 a[76:79], v253 offset:32512
    v_mfma_f32_16x16x32_bf16 v[140:143], a[164:167], a[68:71], v[140:143]
    s_waitcnt lgkmcnt(6)
    s_add_u32 s44, s40, 589824
sub35:
    v_mfma_f32_16x16x32_bf16 v[144:147], a[96:99], a[48:51], v[144:147]
    buffer_load_dwordx4 a[236:239], v254, s[8:11], s42 offen offset:2048 sc1
    v_mfma_f32_16x16x32_bf16 v[144:147], a[108:111], a[52:55], v[144:147]
    s_add_u32 s42, s36, 39936
    v_mfma_f32_16x16x32_bf16 v[144:147], a[120:123], a[56:59], v[144:147]
    s_waitcnt lgkmcnt(0)
    v_mfma_f32_16x16x32_bf16 v[144:147], a[132:135], a[64:67], v[144:147]
    s_barrier
    v_mfma_f32_16x16x32_bf16 v[144:147], a[144:147], a[68:71], v[144:147]
    buffer_load_dwordx4 a[240:243], v254, s[8:11], s42 offen offset:0 sc1
    v_mfma_f32_16x16x32_bf16 v[144:147], a[156:159], a[72:75], v[144:147]
    v_cvt_pk_bf16_f32 v132, v132, v133
    v_cvt_pk_bf16_f32 v133, v134, v135
    v_mfma_f32_16x16x32_bf16 v[148:151], a[160:163], a[72:75], v[148:151]
    v_cvt_pk_bf16_f32 v134, v136, v137
    v_cvt_pk_bf16_f32 v135, v138, v139
    v_mfma_f32_16x16x32_bf16 v[148:151], a[148:151], a[68:71], v[148:151]
    ds_write_b128 v4, v[132:135] offset:17792
    v_mfma_f32_16x16x32_bf16 v[148:151], a[136:139], a[64:67], v[148:151]
    buffer_load_dwordx4 a[244:247], v254, s[8:11], s42 offen offset:1024 sc1
    v_mfma_f32_16x16x32_bf16 v[148:151], a[124:127], a[56:59], v[148:151]
    ds_read_b128 v[96:99], v6 offset:16640
    v_cvt_pk_bf16_f32 v140, v140, v141
    v_cvt_pk_bf16_f32 v141, v142, v143
    v_mfma_f32_16x16x32_bf16 v[148:151], a[112:115], a[52:55], v[148:151]
    ds_read_b128 v[100:103], v6 offset:19744
    v_mfma_f32_16x16x32_bf16 v[148:151], a[100:103], a[48:51], v[148:151]
    ds_write_b64 v5, v[140:141] offset:17856
    v_mfma_f32_16x16x32_bf16 v[152:155], a[104:107], a[48:51], v[152:155]
    buffer_load_dwordx4 a[248:251], v254, s[8:11], s42 offen offset:2048 sc1
    v_mfma_f32_16x16x32_bf16 v[152:155], a[116:119], a[52:55], v[152:155]
    s_add_u32 s42, s36, 43008
    v_mfma_f32_16x16x32_bf16 v[152:155], a[128:131], a[56:59], v[152:155]
    ds_read_b128 a[48:51], v253 offset:30176
    s_waitcnt lgkmcnt(3)
    v_mfma_f32_16x16x32_bf16 v[152:155], a[140:143], a[64:67], v[152:155]
    ds_read_b128 a[64:67], v253 offset:32256
    v_mfma_f32_16x16x32_bf16 v[152:155], a[152:155], a[68:71], v[152:155]
    buffer_load_dwordx4 a[252:255], v254, s[8:11], s42 offen offset:0 sc1
    v_mfma_f32_16x16x32_bf16 v[152:155], a[164:167], a[72:75], v[152:155]
    ds_read_b128 v[104:107], v6 offset:22848
    v_mfma_f32_16x16x32_bf16 v[156:159], a[96:99], a[52:55], v[156:159]
    buffer_store_dwordx4 v[96:99], v254, s[12:15], s44 offen nt
    s_add_u32 s44, s40, 592896
    s_waitcnt lgkmcnt(4)
    v_mfma_f32_16x16x32_bf16 v[156:159], a[108:111], a[56:59], v[156:159]
    v_cvt_pk_bf16_f32 v144, v144, v145
    v_cvt_pk_bf16_f32 v145, v146, v147
    v_mfma_f32_16x16x32_bf16 v[156:159], a[120:123], a[60:63], v[156:159]
    v_cvt_pk_bf16_f32 v146, v148, v149
    v_cvt_pk_bf16_f32 v147, v150, v151
    v_mfma_f32_16x16x32_bf16 v[156:159], a[132:135], a[68:71], v[156:159]
    buffer_load_dwordx4 v[240:243], v254, s[8:11], s42 offen offset:1024 sc1
    v_mfma_f32_16x16x32_bf16 v[156:159], a[144:147], a[72:75], v[156:159]
    v_mfma_f32_16x16x32_bf16 v[156:159], a[156:159], a[76:79], v[156:159]
    ds_write_b128 v4, v[144:147] offset:18176
    v_mfma_f32_16x16x32_bf16 v[160:163], a[160:163], a[76:79], v[160:163]
    ds_read_b128 v[108:111], v6 offset:25952
    v_mfma_f32_16x16x32_bf16 v[160:163], a[148:151], a[72:75], v[160:163]
    buffer_load_dwordx4 v[244:247], v254, s[8:11], s42 offen offset:2048 sc1
    v_mfma_f32_16x16x32_bf16 v[160:163], a[136:139], a[68:71], v[160:163]
    v_cvt_pk_bf16_f32 v152, v152, v153
    v_cvt_pk_bf16_f32 v153, v154, v155
    v_mfma_f32_16x16x32_bf16 v[160:163], a[124:127], a[60:63], v[160:163]
    buffer_store_dwordx4 v[100:103], v254, s[12:15], s44 offen nt
    v_and_b32 v215, 0x7fff, v255
    s_add_u32 s44, s40, 595968
    v_mfma_f32_16x16x32_bf16 v[160:163], a[112:115], a[56:59], v[160:163]
    buffer_load_dwordx2 v[204:205], v215, s[4:7], s16 offen offset:448
    v_mfma_f32_16x16x32_bf16 v[160:163], a[100:103], a[52:55], v[160:163]
    ds_write_b64 v5, v[152:153] offset:18240
    v_mfma_f32_16x16x32_bf16 v[164:167], a[104:107], a[52:55], v[164:167]
    ds_read_b128 a[52:55], v253 offset:29904
    s_waitcnt lgkmcnt(4)
    v_mfma_f32_16x16x32_bf16 v[164:167], a[116:119], a[56:59], v[164:167]
    ds_write_b64 v218, v[222:223] offset:4160
    v_mfma_f32_16x16x32_bf16 v[164:167], a[128:131], a[60:63], v[164:167]
    buffer_load_dwordx2 v[206:207], v215, s[4:7], s17 offen offset:448
    v_mfma_f32_16x16x32_bf16 v[164:167], a[140:143], a[68:71], v[164:167]
    ds_read_b128 a[68:71], v253 offset:31984
    v_mfma_f32_16x16x32_bf16 v[164:167], a[152:155], a[72:75], v[164:167]
    ds_write_b64 v218, v[216:217] offset:33280
    v_mfma_f32_16x16x32_bf16 v[164:167], a[164:167], a[76:79], v[164:167]
    v_mfma_f32_16x16x32_bf16 v[168:171], a[96:99], a[56:59], v[168:171]
    buffer_load_dwordx2 v[208:209], v215, s[4:7], s18 offen offset:448
    v_mfma_f32_16x16x32_bf16 v[168:171], a[108:111], a[60:63], v[168:171]
    v_cvt_pk_bf16_f32 v156, v156, v157
    v_cvt_pk_bf16_f32 v157, v158, v159
    v_mfma_f32_16x16x32_bf16 v[168:171], a[120:123], a[48:51], v[168:171]
    v_cvt_pk_bf16_f32 v158, v160, v161
    v_cvt_pk_bf16_f32 v159, v162, v163
    v_mfma_f32_16x16x32_bf16 v[168:171], a[132:135], a[72:75], v[168:171]
    ds_write_b128 v4, v[156:159] offset:18560
    v_mfma_f32_16x16x32_bf16 v[168:171], a[144:147], a[76:79], v[168:171]
    v_mfma_f32_16x16x32_bf16 v[168:171], a[156:159], a[64:67], v[168:171]
    buffer_load_dwordx2 v[210:211], v215, s[4:7], s19 offen offset:448
    v_mfma_f32_16x16x32_bf16 v[172:175], a[160:163], a[64:67], v[172:175]
    v_mfma_f32_16x16x32_bf16 v[172:175], a[148:151], a[76:79], v[172:175]
    v_cvt_pk_bf16_f32 v164, v164, v165
    v_cvt_pk_bf16_f32 v165, v166, v167
    v_mfma_f32_16x16x32_bf16 v[172:175], a[136:139], a[72:75], v[172:175]
    ds_write_b64 v5, v[164:165] offset:18624
    v_mfma_f32_16x16x32_bf16 v[172:175], a[124:127], a[48:51], v[172:175]
    buffer_load_dwordx2 v[212:213], v215, s[4:7], s20 offen offset:448
    v_mfma_f32_16x16x32_bf16 v[172:175], a[112:115], a[60:63], v[172:175]
    ds_write_b64 v218, v[226:227] offset:35360
    v_mfma_f32_16x16x32_bf16 v[172:175], a[100:103], a[56:59], v[172:175]
    v_mfma_f32_16x16x32_bf16 v[176:179], a[104:107], a[56:59], v[176:179]
    ds_write_b64 v218, v[220:221] offset:6240
    v_mfma_f32_16x16x32_bf16 v[176:179], a[116:119], a[60:63], v[176:179]
    buffer_load_dwordx2 v[214:215], v215, s[4:7], s21 offen offset:448
    v_mfma_f32_16x16x32_bf16 v[176:179], a[128:131], a[48:51], v[176:179]
    s_waitcnt lgkmcnt(0)
    v_mfma_f32_16x16x32_bf16 v[176:179], a[140:143], a[72:75], v[176:179]
    s_barrier
    v_mfma_f32_16x16x32_bf16 v[176:179], a[152:155], a[76:79], v[176:179]
    ds_read_b128 v[228:231], v253 offset:1040
    v_mfma_f32_16x16x32_bf16 v[176:179], a[164:167], a[64:67], v[176:179]
    ds_read_b128 v[232:235], v253 offset:768
    v_mfma_f32_16x16x32_bf16 v[180:183], a[96:99], a[60:63], v[180:183]
    ds_read_b128 v[236:239], v253 offset:512
    v_mfma_f32_16x16x32_bf16 v[180:183], a[108:111], a[48:51], v[180:183]
    v_cvt_pk_bf16_f32 v168, v168, v169
    v_cvt_pk_bf16_f32 v169, v170, v171
    v_mfma_f32_16x16x32_bf16 v[180:183], a[120:123], a[52:55], v[180:183]
    buffer_store_dwordx4 v[104:107], v254, s[12:15], s44 offen nt
    v_cvt_pk_bf16_f32 v170, v172, v173
    v_cvt_pk_bf16_f32 v171, v174, v175
    v_mfma_f32_16x16x32_bf16 v[180:183], a[132:135], a[76:79], v[180:183]
    ds_write_b128 v4, v[168:171] offset:18944
    v_mfma_f32_16x16x32_bf16 v[180:183], a[144:147], a[64:67], v[180:183]
    s_add_u32 s44, s40, 599040
    v_mfma_f32_16x16x32_bf16 v[180:183], a[156:159], a[68:71], v[180:183]
    ds_read_b128 v[112:115], v6 offset:17664
    v_mfma_f32_16x16x32_bf16 v[184:187], a[160:163], a[68:71], v[184:187]
    ds_read_b128 v[116:119], v6 offset:20768
    v_mfma_f32_16x16x32_bf16 v[184:187], a[148:151], a[64:67], v[184:187]
    buffer_store_dwordx4 v[108:111], v254, s[12:15], s44 offen nt
    v_cvt_pk_bf16_f32 v176, v176, v177
    v_cvt_pk_bf16_f32 v177, v178, v179
    v_mfma_f32_16x16x32_bf16 v[184:187], a[136:139], a[76:79], v[184:187]
    ds_write_b64 v5, v[176:177] offset:19008
    v_mfma_f32_16x16x32_bf16 v[184:187], a[124:127], a[52:55], v[184:187]
    ds_read_b128 v[120:123], v6 offset:23872
    s_add_u32 s44, s40, 590848
    v_mfma_f32_16x16x32_bf16 v[184:187], a[112:115], a[48:51], v[184:187]
    ds_read_b128 v[124:127], v6 offset:26976
    s_waitcnt lgkmcnt(4)
    v_mfma_f32_16x16x32_bf16 v[184:187], a[100:103], a[60:63], v[184:187]
    buffer_store_dwordx4 v[112:115], v254, s[12:15], s44 offen nt
    s_add_u32 s44, s40, 593920
    s_waitcnt lgkmcnt(3)
    v_mfma_f32_16x16x32_bf16 v[188:191], a[104:107], a[60:63], v[188:191]
    v_mfma_f32_16x16x32_bf16 v[188:191], a[116:119], a[48:51], v[188:191]
    v_mfma_f32_16x16x32_bf16 v[188:191], a[128:131], a[52:55], v[188:191]
    buffer_store_dwordx4 v[116:119], v254, s[12:15], s44 offen nt
    v_mfma_f32_16x16x32_bf16 v[188:191], a[140:143], a[76:79], v[188:191]
    v_mfma_f32_16x16x32_bf16 v[188:191], a[152:155], a[64:67], v[188:191]
    v_mfma_f32_16x16x32_bf16 v[188:191], a[164:167], a[68:71], v[188:191]
    s_waitcnt vmcnt(36)
    s_add_u32 s41, s40, 589824
    s_add_u32 s40, s40, 6291456
    s_add_u32 s39, s39, 1
    s_cmp_lt_u32 s39, 2
    s_cbranch_scc1 blk_loop
    s_add_u32 s44, s41, 7168
    s_waitcnt lgkmcnt(1)
    buffer_store_dwordx4 v[120:123], v254, s[12:15], s44 offen nt
    s_add_u32 s44, s41, 10240
    s_waitcnt lgkmcnt(0)
    buffer_store_dwordx4 v[124:127], v254, s[12:15], s44 offen nt
    v_cvt_pk_bf16_f32 v180, v180, v181
    v_cvt_pk_bf16_f32 v181, v182, v183
    v_cvt_pk_bf16_f32 v182, v184, v185
    v_cvt_pk_bf16_f32 v183, v186, v187
    ds_write_b128 v4, v[180:183] offset:19328
    v_cvt_pk_bf16_f32 v188, v188, v189
    v_cvt_pk_bf16_f32 v189, v190, v191
    ds_write_b64 v5, v[188:189] offset:19392
    s_waitcnt lgkmcnt(0)
    s_barrier
    ds_read_b128 v[32:35], v6 offset:18688
    ds_read_b128 v[36:39], v6 offset:21792
    ds_read_b128 v[40:43], v6 offset:24896
    ds_read_b128 v[44:47], v6 offset:28000
    s_add_u32 s44, s41, 2048
    s_waitcnt lgkmcnt(3)
    buffer_store_dwordx4 v[32:35], v254, s[12:15], s44 offen nt
    s_add_u32 s44, s41, 5120
    s_waitcnt lgkmcnt(2)
    buffer_store_dwordx4 v[36:39], v254, s[12:15], s44 offen nt
    s_add_u32 s44, s41, 8192
    s_waitcnt lgkmcnt(1)
    buffer_store_dwordx4 v[40:43], v254, s[12:15], s44 offen nt
    s_add_u32 s44, s41, 11264
    s_waitcnt lgkmcnt(0)
    buffer_store_dwordx4 v[44:47], v254, s[12:15], s44 offen nt
main_done:
    s_endpgm
code_end:
wt_loop:
    s_mul_i32 s73, s70, 43691
    s_lshr_b32 s73, s73, 17
    s_mul_i32 s74, s73, 3
    s_sub_u32 s74, s70, s74
    s_mul_i32 s75, s73, 43691
    s_lshr_b32 s75, s75, 17
    s_mul_i32 s76, s75, 3
    s_sub_u32 s76, s73, s76
    v_and_b32 v101, 15, v2
    v_lshrrev_b32 v102, 4, v2
    v_and_b32 v103, 12, v101
    s_lshl_b32 s78, s74, 2
    s_cmp_lt_u32 s74, 2
    s_cselect_b32 s77, 1, 0
    s_cselect_b32 s78, s78, 32
    v_mul_u32_u24 v103, s77, v103
    v_add_u32 v103, v103, v101
    v_add_u32 v103, s78, v103
    v_lshl_add_u32 v103, v103, 1, s52
    v_mul_u32_u24 v104, 3072, v102
    v_add_u32 v103, v103, v104
    s_mul_i32 s79, s76, 73728
    s_mul_i32 s80, s75, 12288
    s_add_u32 s79, s79, s80
    s_add_u32 s80, s79, 221184
    s_add_u32 s81, s79, 442368
    buffer_load_ushort v110, v103, s[60:63], s79 offen offset:0
    buffer_load_ushort v111, v103, s[60:63], s79 offen offset:384
    buffer_load_ushort v112, v103, s[60:63], s79 offen offset:768
    buffer_load_ushort v113, v103, s[60:63], s79 offen offset:1152
    buffer_load_ushort v114, v103, s[60:63], s79 offen offset:1536
    buffer_load_ushort v115, v103, s[60:63], s79 offen offset:1920
    buffer_load_ushort v116, v103, s[60:63], s79 offen offset:2304
    buffer_load_ushort v117, v103, s[60:63], s79 offen offset:2688
    buffer_load_ushort v118, v103, s[60:63], s80 offen offset:0
    buffer_load_ushort v119, v103, s[60:63], s80 offen offset:384
    buffer_load_ushort v120, v103, s[60:63], s80 offen offset:768
    buffer_load_ushort v121, v103, s[60:63], s80 offen offset:1152
    buffer_load_ushort v122, v103, s[60:63], s80 offen offset:1536
    buffer_load_ushort v123, v103, s[60:63], s80 offen offset:1920
    buffer_load_ushort v124, v103, s[60:63], s80 offen offset:2304
    buffer_load_ushort v125, v103, s[60:63], s80 offen offset:2688
    buffer_load_ushort v126, v103, s[60:63], s81 offen offset:0
    buffer_load_ushort v127, v103, s[60:63], s81 offen offset:384
    buffer_load_ushort v128, v103, s[60:63], s81 offen offset:768
    buffer_load_ushort v129, v103, s[60:63], s81 offen offset:1152
    buffer_load_ushort v130, v103, s[60:63], s81 offen offset:1536
    buffer_load_ushort v131, v103, s[60:63], s81 offen offset:1920
    buffer_load_ushort v132, v103, s[60:63], s81 offen offset:2304
    buffer_load_ushort v133, v103, s[60:63], s81 offen offset:2688
    s_mul_i32 s82, s76, 3072
    s_lshl_b32 s83, s74, 10
    s_add_u32 s82, s82, s83
    s_mul_i32 s83, s75, 36864
    s_lshl_b32 s84, s83, 2
    s_add_u32 s83, s83, s82
    s_add_u32 s84, s84, s82
    s_waitcnt vmcnt(0)
    v_lshlrev_b32 v110, 16, v110
    v_lshlrev_b32 v111, 16, v111
    v_lshlrev_b32 v112, 16, v112
    v_lshlrev_b32 v113, 16, v113
    v_lshlrev_b32 v114, 16, v114
    v_lshlrev_b32 v115, 16, v115
    v_lshlrev_b32 v116, 16, v116
    v_lshlrev_b32 v117, 16, v117
    v_lshlrev_b32 v118, 16, v118
    v_lshlrev_b32 v119, 16, v119
    v_lshlrev_b32 v120, 16, v120
    v_lshlrev_b32 v121, 16, v121
    v_lshlrev_b32 v122, 16, v122
    v_lshlrev_b32 v123, 16, v123
    v_lshlrev_b32 v124, 16, v124
    v_lshlrev_b32 v125, 16, v125
    v_lshlrev_b32 v126, 16, v126
    v_lshlrev_b32 v127, 16, v127
    v_lshlrev_b32 v128, 16, v128
    v_lshlrev_b32 v129, 16, v129
    v_lshlrev_b32 v130, 16, v130
    v_lshlrev_b32 v131, 16, v131
    v_lshlrev_b32 v132, 16, v132
    v_lshlrev_b32 v133, 16, v133
    v_mul_f32 v136, 0xbedba55c, v110
    v_fmac_f32 v136, 0xbe0afea5, v126
    v_fmamk_f32 v144, v118, 0xbe771a08, v136
    v_fmac_f32 v136, 0x3e771a08, v118
    v_mul_f32 v137, 0xbedba55c, v111
    v_fmac_f32 v137, 0xbe0afea5, v127
    v_fmamk_f32 v145, v119, 0xbe771a08, v137
    v_fmac_f32 v137, 0x3e771a08, v119
    v_mul_f32 v138, 0xbedba55c, v112
    v_fmac_f32 v138, 0xbe0afea5, v128
    v_fmamk_f32 v146, v120, 0xbe771a08, v138
    v_fmac_f32 v138, 0x3e771a08, v120
    v_mul_f32 v139, 0xbedba55c, v113
    v_fmac_f32 v139, 0xbe0afea5, v129
    v_fmamk_f32 v147, v121, 0xbe771a08, v139
    v_fmac_f32 v139, 0x3e771a08, v121
    v_mul_f32 v140, 0xbedba55c, v114
    v_fmac_f32 v140, 0xbe0afea5, v130
    v_fmamk_f32 v148, v122, 0xbe771a08, v140
    v_fmac_f32 v140, 0x3e771a08, v122
    v_mul_f32 v141, 0xbedba55c, v115
    v_fmac_f32 v141, 0xbe0afea5, v131
    v_fmamk_f32 v149, v123, 0xbe771a08, v141
    v_fmac_f32 v141, 0x3e771a08, v123
    v_mul_f32 v142, 0xbedba55c, v116
    v_fmac_f32 v142, 0xbe0afea5, v132
    v_fmamk_f32 v150, v124, 0xbe771a08, v142
    v_fmac_f32 v142, 0x3e771a08, v124
    v_mul_f32 v143, 0xbedba55c, v117
    v_fmac_f32 v143, 0xbe0afea5, v133
    v_fmamk_f32 v151, v125, 0xbe771a08, v143
    v_fmac_f32 v143, 0x3e771a08, v125
    v_cvt_pk_bf16_f32 v156, v144, v145
    v_cvt_pk_bf16_f32 v157, v146, v147
    v_cvt_pk_bf16_f32 v158, v148, v149
    v_cvt_pk_bf16_f32 v159, v150, v151
    s_add_u32 s85, s84, 0
    buffer_store_dwordx4 v[156:159], v254, s[8:11], s85 offen sc1
    v_cvt_pk_bf16_f32 v160, v136, v137
    v_cvt_pk_bf16_f32 v161, v138, v139
    v_cvt_pk_bf16_f32 v162, v140, v141
    v_cvt_pk_bf16_f32 v163, v142, v143
    s_add_u32 s85, s84, 36864
    buffer_store_dwordx4 v[160:163], v254, s[8:11], s85 offen sc1
    v_mul_f32 v136, 0x3e0afea5, v110
    v_fmac_f32 v136, 0x3f0afea5, v126
    v_fmamk_f32 v144, v118, 0x3e8afea5, v136
    v_fmac_f32 v136, 0xbe8afea5, v118
    v_mul_f32 v137, 0x3e0afea5, v111
    v_fmac_f32 v137, 0x3f0afea5, v127
    v_fmamk_f32 v145, v119, 0x3e8afea5, v137
    v_fmac_f32 v137, 0xbe8afea5, v119
    v_mul_f32 v138, 0x3e0afea5, v112
    v_fmac_f32 v138, 0x3f0afea5, v128
    v_fmamk_f32 v146, v120, 0x3e8afea5, v138
    v_fmac_f32 v138, 0xbe8afea5, v120
    v_mul_f32 v139, 0x3e0afea5, v113
    v_fmac_f32 v139, 0x3f0afea5, v129
    v_fmamk_f32 v147, v121, 0x3e8afea5, v139
    v_fmac_f32 v139, 0xbe8afea5, v121
    v_mul_f32 v140, 0x3e0afea5, v114
    v_fmac_f32 v140, 0x3f0afea5, v130
    v_fmamk_f32 v148, v122, 0x3e8afea5, v140
    v_fmac_f32 v140, 0xbe8afea5, v122
    v_mul_f32 v141, 0x3e0afea5, v115
    v_fmac_f32 v141, 0x3f0afea5, v131
    v_fmamk_f32 v149, v123, 0x3e8afea5, v141
    v_fmac_f32 v141, 0xbe8afea5, v123
    v_mul_f32 v142, 0x3e0afea5, v116
    v_fmac_f32 v142, 0x3f0afea5, v132
    v_fmamk_f32 v150, v124, 0x3e8afea5, v142
    v_fmac_f32 v142, 0xbe8afea5, v124
    v_mul_f32 v143, 0x3e0afea5, v117
    v_fmac_f32 v143, 0x3f0afea5, v133
    v_fmamk_f32 v151, v125, 0x3e8afea5, v143
    v_fmac_f32 v143, 0xbe8afea5, v125
    v_cvt_pk_bf16_f32 v164, v144, v145
    v_cvt_pk_bf16_f32 v165, v146, v147
    v_cvt_pk_bf16_f32 v166, v148, v149
    v_cvt_pk_bf16_f32 v167, v150, v151
    s_add_u32 s85, s84, 73728
    buffer_store_dwordx4 v[164:167], v254, s[8:11], s85 offen sc1
    v_cvt_pk_bf16_f32 v168, v136, v137
    v_cvt_pk_bf16_f32 v169, v138, v139
    v_cvt_pk_bf16_f32 v170, v140, v141
    v_cvt_pk_bf16_f32 v171, v142, v143
    s_add_u32 s85, s84, 110592
    buffer_store_dwordx4 v[168:171], v254, s[8:11], s85 offen sc1
    v_cvt_pk_bf16_f32 v152, v110, v111
    v_cvt_pk_bf16_f32 v153, v112, v113
    v_cvt_pk_bf16_f32 v154, v114, v115
    v_cvt_pk_bf16_f32 v155, v116, v117
    s_add_u32 s85, s83, 884736
    buffer_store_dwordx4 v[152:155], v254, s[8:11], s85 offen sc1
    v_cvt_pk_bf16_f32 v172, v126, v127
    v_cvt_pk_bf16_f32 v173, v128, v129
    v_cvt_pk_bf16_f32 v174, v130, v131
    v_cvt_pk_bf16_f32 v175, v132, v133
    s_add_u32 s85, s83, 1105920
    buffer_store_dwordx4 v[172:175], v254, s[8:11], s85 offen sc1
    s_add_u32 s70, s70, 1
    s_cmp_lt_u32 s70, 54
    s_cbranch_scc1 wt_loop
    s_waitcnt vmcnt(0)
    s_branch u_ready
.section .rodata,"a"
.p2align 6
.amdhsa_kernel standalone__winograd__vision_kernel
  .amdhsa_next_free_vgpr 512
  .amdhsa_next_free_sgpr 102
  .amdhsa_accum_offset 256
  .amdhsa_group_segment_fixed_size 0
  .amdhsa_kernarg_size 40
  .amdhsa_user_sgpr_count 2
  .amdhsa_user_sgpr_kernarg_segment_ptr 1
  .amdhsa_system_sgpr_workgroup_id_x 1
  .amdhsa_ieee_mode 0
.end_amdhsa_kernel
```

```asm
; @launch grid=(256,1,1) block=(256,1,1) lds=163840
.amdgcn_target "amdgcn-amd-amdhsa--gfx950"
.text
.globl standalone__winograd__vision_kernel
.p2align 8
.type standalone__winograd__vision_kernel,@function
standalone__winograd__vision_kernel:
    s_cmp_ge_u32 s2, 256
    s_cbranch_scc1 main_done
    s_load_dwordx4 s[4:7], s[0:1], 0
    s_load_dwordx4 s[12:15], s[0:1], 16
    s_load_dwordx2 s[8:9], s[0:1], 32
    s_getpc_b64 s[92:93]
pcref:
    v_and_b32 v70, 3, v0
    v_lshrrev_b32 v71, 6, v0
    v_lshl_add_u32 v70, v70, 7, v71
    s_lshr_b32 s94, s2, 3
    s_lshl_b32 s94, s94, 2
    v_add_lshl_u32 v70, v70, s94, 7
    v_min_u32 v70, code_end-pcref-4, v70
    v_add_co_u32 v72, vcc, s92, v70
    v_mov_b32 v73, s93
    s_nop 0
    v_addc_co_u32 v73, vcc, 0, v73, vcc
    global_load_dword v76, v[72:73], off
    v_lshrrev_b32 v1, 6, v0
    v_and_b32 v2, 63, v0
    v_readfirstlane_b32 s38, v1
    v_lshlrev_b32 v254, 4, v2
    v_mov_b32 v98, 0
    v_lshrrev_b32 v3, 3, v2
    v_and_b32 v4, 7, v2
    v_mul_u32_u24 v5, 3072, v3
    v_lshl_add_u32 v255, v4, 3, v5
    s_lshr_b32 s44, s2, 3
    s_and_b32 s48, s44, 3
    s_lshr_b32 s44, s44, 2
    s_and_b32 s49, s2, 7
    s_lshl_b32 s49, s49, 4
    s_add_u32 s49, s49, s44
    s_and_b32 s90, s38, 1
    s_lshr_b32 s91, s38, 1
    s_mul_i32 s50, s90, 24576
    s_mul_i32 s45, s91, 1536
    s_add_u32 s50, s50, s45
    s_mul_i32 s101, s38, 196608
    s_sub_u32 s101, s101, s50
    s_mul_i32 s53, s48, 49152
    s_add_u32 s53, s53, s50
    s_mul_i32 s43, s49, 786432
    s_add_u32 s43, s43, s53
    s_cmp_ge_u32 s49, 128
    s_cselect_b32 s43, 2130706432, s43
    s_sub_u32 s16, s43, 196608
    s_cmp_eq_u32 s49, 0
    s_cselect_b32 s16, 2130706432, s16
    s_mov_b32 s17, s43
    s_add_u32 s18, s43, 196608
    s_add_u32 s19, s43, 393216
    s_add_u32 s20, s43, 589824
    s_add_u32 s21, s43, 786432
    s_add_u32 s100, s43, s101
    s_mul_i32 s52, s38, 96
    s_mul_i32 s44, s38, 9216
    s_mov_b32 s70, s2
    v_mov_b32 v80, v255
    s_mul_i32 s73, s70, 43691
    s_lshr_b32 s73, s73, 17
    s_mul_i32 s74, s73, 3
    s_sub_u32 s74, s70, s74
    s_mul_i32 s75, s73, 43691
    s_lshr_b32 s75, s75, 17
    s_mul_i32 s76, s75, 3
    s_sub_u32 s76, s73, s76
    v_and_b32 v101, 15, v2
    v_lshrrev_b32 v102, 4, v2
    v_and_b32 v103, 12, v101
    s_lshl_b32 s78, s74, 2
    s_cmp_lt_u32 s74, 2
    s_cselect_b32 s77, 1, 0
    s_cselect_b32 s78, s78, 32
    v_mul_u32_u24 v103, s77, v103
    v_add_u32 v103, v103, v101
    v_add_u32 v103, s78, v103
    v_lshl_add_u32 v103, v103, 1, s52
    v_mul_u32_u24 v104, 3072, v102
    v_add_u32 v103, v103, v104
    s_mul_i32 s79, s76, 73728
    s_mul_i32 s80, s75, 12288
    s_add_u32 s79, s79, s80
    s_add_u32 s80, s79, 221184
    s_add_u32 s81, s79, 442368
    s_waitcnt lgkmcnt(0)
    s_mov_b32 s60, s6
    s_and_b32 s61, s7, 0xffff
    s_mov_b32 s62, 663552
    s_mov_b32 s63, 0x20000
    s_and_b32 s5, s5, 0xffff
    s_mov_b32 s6, 100663296
    s_mov_b32 s7, 0x20000
    s_add_u32 s8, s8, s44
    s_addc_u32 s9, s9, 0
    s_and_b32 s9, s9, 0xffff
    s_mov_b32 s10, 1299456
    s_mov_b32 s11, 0x20000
    s_mov_b32 s64, s14
    s_and_b32 s65, s15, 0xffff
    s_mov_b32 s66, 256
    s_mov_b32 s67, 0x20000
    s_mov_b64 s[68:69], s[14:15]
    s_cmp_lt_u32 s2, 54
    s_cbranch_scc1 wt_path
    buffer_load_dwordx2 v[8:9], v80, s[4:7], s16 offen offset:0
    buffer_load_dwordx2 v[10:11], v80, s[4:7], s17 offen offset:0
    buffer_load_dwordx2 v[12:13], v80, s[4:7], s18 offen offset:0
    buffer_load_dwordx2 v[14:15], v80, s[4:7], s19 offen offset:0
    buffer_load_dwordx2 v[16:17], v80, s[4:7], s20 offen offset:0
    buffer_load_dwordx2 v[18:19], v80, s[4:7], s21 offen offset:0
    buffer_load_dwordx2 v[20:21], v80, s[4:7], s16 offen offset:384
    buffer_load_dwordx2 v[22:23], v80, s[4:7], s17 offen offset:384
    buffer_load_dwordx2 v[24:25], v80, s[4:7], s18 offen offset:384
    buffer_load_dwordx2 v[26:27], v80, s[4:7], s19 offen offset:384
    buffer_load_dwordx2 v[28:29], v80, s[4:7], s20 offen offset:384
    buffer_load_dwordx2 v[30:31], v80, s[4:7], s21 offen offset:384
    s_branch wt_join
wt_path:
    buffer_load_ushort v110, v103, s[60:63], s79 offen offset:0
    buffer_load_ushort v111, v103, s[60:63], s79 offen offset:384
    buffer_load_ushort v112, v103, s[60:63], s79 offen offset:768
    buffer_load_ushort v113, v103, s[60:63], s79 offen offset:1152
    buffer_load_ushort v114, v103, s[60:63], s79 offen offset:1536
    buffer_load_ushort v115, v103, s[60:63], s79 offen offset:1920
    buffer_load_ushort v116, v103, s[60:63], s79 offen offset:2304
    buffer_load_ushort v117, v103, s[60:63], s79 offen offset:2688
    buffer_load_ushort v118, v103, s[60:63], s80 offen offset:0
    buffer_load_ushort v119, v103, s[60:63], s80 offen offset:384
    buffer_load_ushort v120, v103, s[60:63], s80 offen offset:768
    buffer_load_ushort v121, v103, s[60:63], s80 offen offset:1152
    buffer_load_ushort v122, v103, s[60:63], s80 offen offset:1536
    buffer_load_ushort v123, v103, s[60:63], s80 offen offset:1920
    buffer_load_ushort v124, v103, s[60:63], s80 offen offset:2304
    buffer_load_ushort v125, v103, s[60:63], s80 offen offset:2688
    buffer_load_ushort v126, v103, s[60:63], s81 offen offset:0
    buffer_load_ushort v127, v103, s[60:63], s81 offen offset:384
    buffer_load_ushort v128, v103, s[60:63], s81 offen offset:768
    buffer_load_ushort v129, v103, s[60:63], s81 offen offset:1152
    buffer_load_ushort v130, v103, s[60:63], s81 offen offset:1536
    buffer_load_ushort v131, v103, s[60:63], s81 offen offset:1920
    buffer_load_ushort v132, v103, s[60:63], s81 offen offset:2304
    buffer_load_ushort v133, v103, s[60:63], s81 offen offset:2688
    s_mul_i32 s82, s76, 3072
    s_lshl_b32 s83, s74, 10
    s_add_u32 s82, s82, s83
    s_mul_i32 s83, s75, 36864
    s_lshl_b32 s84, s83, 2
    s_add_u32 s83, s83, s82
    s_add_u32 s84, s84, s82
    s_waitcnt vmcnt(0)
    v_lshlrev_b32 v110, 16, v110
    v_lshlrev_b32 v111, 16, v111
    v_lshlrev_b32 v112, 16, v112
    v_lshlrev_b32 v113, 16, v113
    v_lshlrev_b32 v114, 16, v114
    v_lshlrev_b32 v115, 16, v115
    v_lshlrev_b32 v116, 16, v116
    v_lshlrev_b32 v117, 16, v117
    v_lshlrev_b32 v118, 16, v118
    v_lshlrev_b32 v119, 16, v119
    v_lshlrev_b32 v120, 16, v120
    v_lshlrev_b32 v121, 16, v121
    v_lshlrev_b32 v122, 16, v122
    v_lshlrev_b32 v123, 16, v123
    v_lshlrev_b32 v124, 16, v124
    v_lshlrev_b32 v125, 16, v125
    v_lshlrev_b32 v126, 16, v126
    v_lshlrev_b32 v127, 16, v127
    v_lshlrev_b32 v128, 16, v128
    v_lshlrev_b32 v129, 16, v129
    v_lshlrev_b32 v130, 16, v130
    v_lshlrev_b32 v131, 16, v131
    v_lshlrev_b32 v132, 16, v132
    v_lshlrev_b32 v133, 16, v133
    v_mul_f32 v136, 0xbedba55c, v110
    v_fmac_f32 v136, 0xbe0afea5, v126
    v_fmamk_f32 v144, v118, 0xbe771a08, v136
    v_fmac_f32 v136, 0x3e771a08, v118
    v_mul_f32 v137, 0xbedba55c, v111
    v_fmac_f32 v137, 0xbe0afea5, v127
    v_fmamk_f32 v145, v119, 0xbe771a08, v137
    v_fmac_f32 v137, 0x3e771a08, v119
    v_mul_f32 v138, 0xbedba55c, v112
    v_fmac_f32 v138, 0xbe0afea5, v128
    v_fmamk_f32 v146, v120, 0xbe771a08, v138
    v_fmac_f32 v138, 0x3e771a08, v120
    v_mul_f32 v139, 0xbedba55c, v113
    v_fmac_f32 v139, 0xbe0afea5, v129
    v_fmamk_f32 v147, v121, 0xbe771a08, v139
    v_fmac_f32 v139, 0x3e771a08, v121
    v_mul_f32 v140, 0xbedba55c, v114
    v_fmac_f32 v140, 0xbe0afea5, v130
    v_fmamk_f32 v148, v122, 0xbe771a08, v140
    v_fmac_f32 v140, 0x3e771a08, v122
    v_mul_f32 v141, 0xbedba55c, v115
    v_fmac_f32 v141, 0xbe0afea5, v131
    v_fmamk_f32 v149, v123, 0xbe771a08, v141
    v_fmac_f32 v141, 0x3e771a08, v123
    v_mul_f32 v142, 0xbedba55c, v116
    v_fmac_f32 v142, 0xbe0afea5, v132
    v_fmamk_f32 v150, v124, 0xbe771a08, v142
    v_fmac_f32 v142, 0x3e771a08, v124
    v_mul_f32 v143, 0xbedba55c, v117
    v_fmac_f32 v143, 0xbe0afea5, v133
    v_fmamk_f32 v151, v125, 0xbe771a08, v143
    v_fmac_f32 v143, 0x3e771a08, v125
    v_cvt_pk_bf16_f32 v156, v144, v145
    v_cvt_pk_bf16_f32 v157, v146, v147
    v_cvt_pk_bf16_f32 v158, v148, v149
    v_cvt_pk_bf16_f32 v159, v150, v151
    s_add_u32 s85, s84, 0
    buffer_store_dwordx4 v[156:159], v254, s[8:11], s85 offen sc1
    v_cvt_pk_bf16_f32 v160, v136, v137
    v_cvt_pk_bf16_f32 v161, v138, v139
    v_cvt_pk_bf16_f32 v162, v140, v141
    v_cvt_pk_bf16_f32 v163, v142, v143
    s_add_u32 s85, s84, 36864
    buffer_store_dwordx4 v[160:163], v254, s[8:11], s85 offen sc1
    v_mul_f32 v136, 0x3e0afea5, v110
    v_fmac_f32 v136, 0x3f0afea5, v126
    v_fmamk_f32 v144, v118, 0x3e8afea5, v136
    v_fmac_f32 v136, 0xbe8afea5, v118
    v_mul_f32 v137, 0x3e0afea5, v111
    v_fmac_f32 v137, 0x3f0afea5, v127
    v_fmamk_f32 v145, v119, 0x3e8afea5, v137
    v_fmac_f32 v137, 0xbe8afea5, v119
    v_mul_f32 v138, 0x3e0afea5, v112
    v_fmac_f32 v138, 0x3f0afea5, v128
    v_fmamk_f32 v146, v120, 0x3e8afea5, v138
    v_fmac_f32 v138, 0xbe8afea5, v120
    v_mul_f32 v139, 0x3e0afea5, v113
    v_fmac_f32 v139, 0x3f0afea5, v129
    v_fmamk_f32 v147, v121, 0x3e8afea5, v139
    v_fmac_f32 v139, 0xbe8afea5, v121
    v_mul_f32 v140, 0x3e0afea5, v114
    v_fmac_f32 v140, 0x3f0afea5, v130
    v_fmamk_f32 v148, v122, 0x3e8afea5, v140
    v_fmac_f32 v140, 0xbe8afea5, v122
    v_mul_f32 v141, 0x3e0afea5, v115
    v_fmac_f32 v141, 0x3f0afea5, v131
    v_fmamk_f32 v149, v123, 0x3e8afea5, v141
    v_fmac_f32 v141, 0xbe8afea5, v123
    v_mul_f32 v142, 0x3e0afea5, v116
    v_fmac_f32 v142, 0x3f0afea5, v132
    v_fmamk_f32 v150, v124, 0x3e8afea5, v142
    v_fmac_f32 v142, 0xbe8afea5, v124
    v_mul_f32 v143, 0x3e0afea5, v117
    v_fmac_f32 v143, 0x3f0afea5, v133
    v_fmamk_f32 v151, v125, 0x3e8afea5, v143
    v_fmac_f32 v143, 0xbe8afea5, v125
    v_cvt_pk_bf16_f32 v164, v144, v145
    v_cvt_pk_bf16_f32 v165, v146, v147
    v_cvt_pk_bf16_f32 v166, v148, v149
    v_cvt_pk_bf16_f32 v167, v150, v151
    s_add_u32 s85, s84, 73728
    buffer_store_dwordx4 v[164:167], v254, s[8:11], s85 offen sc1
    v_cvt_pk_bf16_f32 v168, v136, v137
    v_cvt_pk_bf16_f32 v169, v138, v139
    v_cvt_pk_bf16_f32 v170, v140, v141
    v_cvt_pk_bf16_f32 v171, v142, v143
    s_add_u32 s85, s84, 110592
    buffer_store_dwordx4 v[168:171], v254, s[8:11], s85 offen sc1
    v_cvt_pk_bf16_f32 v152, v110, v111
    v_cvt_pk_bf16_f32 v153, v112, v113
    v_cvt_pk_bf16_f32 v154, v114, v115
    v_cvt_pk_bf16_f32 v155, v116, v117
    s_add_u32 s85, s83, 884736
    buffer_store_dwordx4 v[152:155], v254, s[8:11], s85 offen sc1
    v_cvt_pk_bf16_f32 v172, v126, v127
    v_cvt_pk_bf16_f32 v173, v128, v129
    v_cvt_pk_bf16_f32 v174, v130, v131
    v_cvt_pk_bf16_f32 v175, v132, v133
    s_add_u32 s85, s83, 1105920
    buffer_store_dwordx4 v[172:175], v254, s[8:11], s85 offen sc1
    buffer_load_dwordx2 v[8:9], v80, s[4:7], s16 offen offset:0
    buffer_load_dwordx2 v[10:11], v80, s[4:7], s17 offen offset:0
    buffer_load_dwordx2 v[12:13], v80, s[4:7], s18 offen offset:0
    buffer_load_dwordx2 v[14:15], v80, s[4:7], s19 offen offset:0
    buffer_load_dwordx2 v[16:17], v80, s[4:7], s20 offen offset:0
    buffer_load_dwordx2 v[18:19], v80, s[4:7], s21 offen offset:0
wt_join:
    s_and_b32 s13, s13, 0xffff
    s_mov_b32 s14, 100663296
    s_mov_b32 s15, 0x20000
    v_lshrrev_b32 v5, 4, v2
    v_mul_u32_u24 v6, 40704, v5
    v_lshrrev_b32 v5, 1, v5
    v_lshl_add_u32 v6, v5, 6, v6
    v_and_b32 v5, 0xf0, v254
    v_add_u32 v253, v6, v5
    v_lshrrev_b32 v6, 1, v4
    v_mul_u32_u24 v7, 40704, v6
    v_lshrrev_b32 v6, 1, v6
    v_lshl_add_u32 v7, v6, 6, v7
    v_and_b32 v6, 1, v2
    v_lshl_add_u32 v7, v6, 3, v7
    v_lshl_add_u32 v7, v3, 4, v7
    s_lshl_b32 s44, s90, 7
    s_mul_i32 s45, s91, 1056
    s_add_u32 s44, s44, s45
    v_add_u32 v7, s44, v7
    v_lshl_or_b32 v255, v7, 15, v255
    s_mul_i32 s51, s38, 40704
    s_lshl_b32 s45, s91, 6
    s_add_u32 s51, s51, s45
    s_lshl_b32 s45, s90, 4
    s_add_u32 s51, s51, s45
    s_mul_i32 s40, s49, 786432
    s_mul_i32 s45, s48, 49152
    s_add_u32 s40, s40, s45
    s_mul_i32 s45, s38, 12288
    s_add_u32 s40, s40, s45
    s_mov_b32 s41, 2130706432
    s_mov_b32 s39, 0
    s_mov_b32 s36, 0
    s_lshl_b32 s45, s38, 4
    s_mov_b32 s46, 0xfff
    s_mov_b32 s47, 0
    s_lshl_b64 s[46:47], s[46:47], s45
    s_mov_b32 s58, 0x0fff0fff
    s_mov_b32 s59, 0
    s_mov_b32 s23, 0xc08a2000
    s_mov_b32 s24, 0xbea20000
    s_mov_b32 s25, 0x3f4a4588
    s_mov_b32 s26, 0x3f100000
    s_mov_b32 s27, 0xbf100000
    s_mov_b32 s28, 0xc05a4588
    s_mov_b32 s29, 0x3fa20000
    s_mov_b32 s30, 0x3ea20000
    s_mov_b32 s31, 0x3e800000
    s_mov_b32 s34, 0x3f900000
    s_mov_b32 s35, 0x3db64000
    s_mov_b32 s22, 0xffff0000
    s_and_b32 s45, s49, 7
    s_cmp_eq_u32 s45, 0
    s_cselect_b32 s33, 4294770688, 0x40000000
    s_cmp_eq_u32 s45, 7
    s_cselect_b32 s33, 786432, s33
    s_mul_i32 s45, s38, 196224
    s_sub_u32 s45, s101, s45
    s_add_u32 s33, s33, s45
    s_mov_b32 s37, 2130706432
    v_bfe_u32 v6, v254, 6, 2
    v_mul_u32_u24 v4, 40704, v6
    v_and_b32 v6, 0x80, v254
    v_lshrrev_b32 v6, 1, v6
    v_add_u32 v4, v4, v6
    v_and_b32 v6, 0x40, v254
    v_lshrrev_b32 v6, 2, v6
    v_add_u32 v4, v4, v6
    v_bfe_u32 v6, v254, 4, 2
    v_mul_u32_u24 v6, 3104, v6
    v_add_u32 v4, v4, v6
    v_add_u32 v4, s52, v4
    v_lshrrev_b32 v6, 8, v254
    v_lshl_add_u32 v5, v6, 3, v4
    v_lshl_add_u32 v4, v6, 4, v4
    v_add_u32 v6, s51, v254
    v_mov_b32 v192, 0
    v_mov_b32 v193, 0
    v_mov_b32 v203, 0
    v_mov_b32 v215, 0
    v_mov_b32 v224, 0
    v_mov_b32 v227, 0
    v_mov_b32 v252, 0
    s_mov_b32 s42, 0
    s_cmp_gt_u32 s48, 0
    s_cselect_b32 s45, 384, 0
    s_cselect_b32 s55, 0, 2130706432
    s_add_u32 s50, s50, s45
    s_add_u32 s54, s45, 49152
    s_cmp_eq_u32 s48, 3
    s_cselect_b32 s54, 2130706432, s54
    s_mov_b32 s56, 0xffff0000
    s_mov_b32 s57, 0
    s_cmp_ge_u32 s2, 54
    s_cbranch_scc1 pub_skip
    s_branch do_warm
wt_ret:
    s_mov_b32 s87, 1
    s_cmp_lg_u32 s38, 0
    s_waitcnt vmcnt(0)
    s_barrier
    s_cbranch_scc1 wt_pub
    s_atomic_add s87, s[68:69], 0 glc
    s_waitcnt lgkmcnt(0)
    s_cmp_lg_u32 s87, 53
    s_cbranch_scc1 wt_pub
    s_atomic_add s87, s[68:69], 128
wt_pub:
    buffer_load_dwordx2 v[20:21], v80, s[4:7], s16 offen offset:384
    buffer_load_dwordx2 v[22:23], v80, s[4:7], s17 offen offset:384
    buffer_load_dwordx2 v[24:25], v80, s[4:7], s18 offen offset:384
    buffer_load_dwordx2 v[26:27], v80, s[4:7], s19 offen offset:384
    buffer_load_dwordx2 v[28:29], v80, s[4:7], s20 offen offset:384
    buffer_load_dwordx2 v[30:31], v80, s[4:7], s21 offen offset:384
pub_skip:
    v_and_b32 v67, 0xf0, v254
    v_lshrrev_b32 v67, 1, v67
    v_add_u32 v67, s52, v67
    v_mov_b32 v66, s54
    v_mov_b32 v65, s55
    v_cndmask_b32 v66, v66, v65, s[56:57]
    v_add_u32 v67, v67, v66
    s_sub_u32 s45, s16, s50
    buffer_load_dwordx2 v[56:57], v67, s[4:7], s45 offen
    s_sub_u32 s45, s17, s50
    buffer_load_dwordx2 v[58:59], v67, s[4:7], s45 offen
    s_sub_u32 s45, s18, s50
    buffer_load_dwordx2 v[60:61], v67, s[4:7], s45 offen
    s_sub_u32 s45, s19, s50
    buffer_load_dwordx2 v[62:63], v67, s[4:7], s45 offen
    s_sub_u32 s45, s20, s50
    buffer_load_dwordx2 v[64:65], v67, s[4:7], s45 offen
    s_sub_u32 s45, s21, s50
    buffer_load_dwordx2 v[66:67], v67, s[4:7], s45 offen
    buffer_load_dwordx2 v[32:33], v80, s[4:7], s16 offen offset:768
    buffer_load_dwordx2 v[34:35], v80, s[4:7], s17 offen offset:768
    buffer_load_dwordx2 v[36:37], v80, s[4:7], s18 offen offset:768
    buffer_load_dwordx2 v[38:39], v80, s[4:7], s19 offen offset:768
    buffer_load_dwordx2 v[40:41], v80, s[4:7], s20 offen offset:768
    buffer_load_dwordx2 v[42:43], v80, s[4:7], s21 offen offset:768
    buffer_load_dwordx2 v[44:45], v80, s[4:7], s16 offen offset:1152
    buffer_load_dwordx2 v[46:47], v80, s[4:7], s17 offen offset:1152
    buffer_load_dwordx2 v[48:49], v80, s[4:7], s18 offen offset:1152
    buffer_load_dwordx2 v[50:51], v80, s[4:7], s19 offen offset:1152
    buffer_load_dwordx2 v[52:53], v80, s[4:7], s20 offen offset:1152
    buffer_load_dwordx2 v[54:55], v80, s[4:7], s21 offen offset:1152
    s_waitcnt vmcnt(24)
    v_lshlrev_b32 v176, 16, v8
    v_and_b32 v177, s22, v8
    v_lshlrev_b32 v178, 16, v10
    v_and_b32 v179, s22, v10
    v_lshlrev_b32 v180, 16, v12
    v_and_b32 v181, s22, v12
    v_lshlrev_b32 v182, 16, v14
    v_and_b32 v183, s22, v14
    v_lshlrev_b32 v184, 16, v16
    v_and_b32 v185, s22, v16
    v_lshlrev_b32 v186, 16, v18
    v_and_b32 v187, s22, v18
    v_pk_fma_f32 v[176:177], v[184:185], s[24:25], v[176:177] op_sel:[0,1,0]
    v_pk_fma_f32 v[186:187], v[178:179], s[28:29], v[186:187] op_sel:[0,1,0]
    v_pk_fma_f32 v[176:177], v[180:181], s[28:29], v[176:177] op_sel_hi:[1,0,1]
    v_pk_fma_f32 v[186:187], v[182:183], s[22:23], v[186:187] op_sel:[0,1,0]
    v_pk_fma_f32 v[188:189], v[180:181], s[24:25], v[184:185] op_sel_hi:[1,0,1]
    v_pk_fma_f32 v[184:185], v[180:181], -4.0, v[184:185] op_sel_hi:[1,0,1]
    v_pk_fma_f32 v[180:181], v[178:179], s[24:25], v[182:183] op_sel_hi:[1,0,1]
    v_pk_fma_f32 v[182:183], v[178:179], -4.0, v[182:183] op_sel_hi:[1,0,1]
    v_pk_fma_f32 v[178:179], v[182:183], s[26:27], v[184:185] op_sel_hi:[1,0,1]
    v_pk_fma_f32 v[184:185], v[182:183], s[26:27], v[184:185] op_sel:[0,1,0]
    v_pk_fma_f32 v[182:183], v[180:181], 2.0, v[188:189] op_sel_hi:[1,0,1]
    v_pk_fma_f32 v[180:181], v[180:181], -2.0, v[188:189] op_sel_hi:[1,0,1]
    v_cvt_pk_bf16_f32 v8, v176, v177
    v_cvt_pk_bf16_f32 v10, v178, v179
    v_cvt_pk_bf16_f32 v12, v180, v181
    v_cvt_pk_bf16_f32 v14, v182, v183
    v_cvt_pk_bf16_f32 v16, v184, v185
    v_cvt_pk_bf16_f32 v18, v186, v187
    v_lshlrev_b32 v176, 16, v9
    v_and_b32 v177, s22, v9
    v_lshlrev_b32 v178, 16, v11
    v_and_b32 v179, s22, v11
    v_lshlrev_b32 v180, 16, v13
    v_and_b32 v181, s22, v13
    v_lshlrev_b32 v182, 16, v15
    v_and_b32 v183, s22, v15
    v_lshlrev_b32 v184, 16, v17
    v_and_b32 v185, s22, v17
    v_lshlrev_b32 v186, 16, v19
    v_and_b32 v187, s22, v19
    v_pk_fma_f32 v[176:177], v[184:185], s[24:25], v[176:177] op_sel:[0,1,0]
    v_pk_fma_f32 v[186:187], v[178:179], s[28:29], v[186:187] op_sel:[0,1,0]
    v_pk_fma_f32 v[176:177], v[180:181], s[28:29], v[176:177] op_sel_hi:[1,0,1]
    v_pk_fma_f32 v[186:187], v[182:183], s[22:23], v[186:187] op_sel:[0,1,0]
    v_pk_fma_f32 v[188:189], v[180:181], s[24:25], v[184:185] op_sel_hi:[1,0,1]
    v_pk_fma_f32 v[184:185], v[180:181], -4.0, v[184:185] op_sel_hi:[1,0,1]
    v_pk_fma_f32 v[180:181], v[178:179], s[24:25], v[182:183] op_sel_hi:[1,0,1]
    v_pk_fma_f32 v[182:183], v[178:179], -4.0, v[182:183] op_sel_hi:[1,0,1]
    v_pk_fma_f32 v[178:179], v[182:183], s[26:27], v[184:185] op_sel_hi:[1,0,1]
    v_pk_fma_f32 v[184:185], v[182:183], s[26:27], v[184:185] op_sel:[0,1,0]
    v_pk_fma_f32 v[182:183], v[180:181], 2.0, v[188:189] op_sel_hi:[1,0,1]
    v_pk_fma_f32 v[180:181], v[180:181], -2.0, v[188:189] op_sel_hi:[1,0,1]
    v_cvt_pk_bf16_f32 v9, v176, v177
    v_cvt_pk_bf16_f32 v11, v178, v179
    v_cvt_pk_bf16_f32 v13, v180, v181
    v_cvt_pk_bf16_f32 v15, v182, v183
    v_cvt_pk_bf16_f32 v17, v184, v185
    v_cvt_pk_bf16_f32 v19, v186, v187
    v_lshrrev_b32 v252, 15, v255
    ds_write_b64 v252, v[8:9] offset:34048
    ds_write_b64 v252, v[10:11] offset:768
    ds_write_b64 v252, v[16:17] offset:2848
    ds_write_b64 v252, v[14:15] offset:4928
    ds_write_b64 v252, v[12:13] offset:7008
    ds_write_b64 v252, v[18:19] offset:36128
    s_waitcnt vmcnt(18)
    v_lshlrev_b32 v176, 16, v20
    v_and_b32 v177, s22, v20
    v_lshlrev_b32 v178, 16, v22
    v_and_b32 v179, s22, v22
    v_lshlrev_b32 v180, 16, v24
    v_and_b32 v181, s22, v24
    v_lshlrev_b32 v182, 16, v26
    v_and_b32 v183, s22, v26
    v_lshlrev_b32 v184, 16, v28
    v_and_b32 v185, s22, v28
    v_lshlrev_b32 v186, 16, v30
    v_and_b32 v187, s22, v30
    v_pk_fma_f32 v[176:177], v[184:185], s[24:25], v[176:177] op_sel:[0,1,0]
    v_pk_fma_f32 v[186:187], v[178:179], s[28:29], v[186:187] op_sel:[0,1,0]
    v_pk_fma_f32 v[176:177], v[180:181], s[28:29], v[176:177] op_sel_hi:[1,0,1]
    v_pk_fma_f32 v[186:187], v[182:183], s[22:23], v[186:187] op_sel:[0,1,0]
    v_pk_fma_f32 v[188:189], v[180:181], s[24:25], v[184:185] op_sel_hi:[1,0,1]
    v_pk_fma_f32 v[184:185], v[180:181], -4.0, v[184:185] op_sel_hi:[1,0,1]
    v_pk_fma_f32 v[180:181], v[178:179], s[24:25], v[182:183] op_sel_hi:[1,0,1]
    v_pk_fma_f32 v[182:183], v[178:179], -4.0, v[182:183] op_sel_hi:[1,0,1]
    v_pk_fma_f32 v[178:179], v[182:183], s[26:27], v[184:185] op_sel_hi:[1,0,1]
    v_pk_fma_f32 v[184:185], v[182:183], s[26:27], v[184:185] op_sel:[0,1,0]
    v_pk_fma_f32 v[182:183], v[180:181], 2.0, v[188:189] op_sel_hi:[1,0,1]
    v_pk_fma_f32 v[180:181], v[180:181], -2.0, v[188:189] op_sel_hi:[1,0,1]
    v_cvt_pk_bf16_f32 v20, v176, v177
    v_cvt_pk_bf16_f32 v22, v178, v179
    v_cvt_pk_bf16_f32 v24, v180, v181
    v_cvt_pk_bf16_f32 v26, v182, v183
    v_cvt_pk_bf16_f32 v28, v184, v185
    v_cvt_pk_bf16_f32 v30, v186, v187
    v_lshlrev_b32 v176, 16, v21
    v_and_b32 v177, s22, v21
    v_lshlrev_b32 v178, 16, v23
    v_and_b32 v179, s22, v23
    v_lshlrev_b32 v180, 16, v25
    v_and_b32 v181, s22, v25
    v_lshlrev_b32 v182, 16, v27
    v_and_b32 v183, s22, v27
    v_lshlrev_b32 v184, 16, v29
    v_and_b32 v185, s22, v29
    v_lshlrev_b32 v186, 16, v31
    v_and_b32 v187, s22, v31
    v_pk_fma_f32 v[176:177], v[184:185], s[24:25], v[176:177] op_sel:[0,1,0]
    v_pk_fma_f32 v[186:187], v[178:179], s[28:29], v[186:187] op_sel:[0,1,0]
    v_pk_fma_f32 v[176:177], v[180:181], s[28:29], v[176:177] op_sel_hi:[1,0,1]
    v_pk_fma_f32 v[186:187], v[182:183], s[22:23], v[186:187] op_sel:[0,1,0]
    v_pk_fma_f32 v[188:189], v[180:181], s[24:25], v[184:185] op_sel_hi:[1,0,1]
    v_pk_fma_f32 v[184:185], v[180:181], -4.0, v[184:185] op_sel_hi:[1,0,1]
    v_pk_fma_f32 v[180:181], v[178:179], s[24:25], v[182:183] op_sel_hi:[1,0,1]
    v_pk_fma_f32 v[182:183], v[178:179], -4.0, v[182:183] op_sel_hi:[1,0,1]
    v_pk_fma_f32 v[178:179], v[182:183], s[26:27], v[184:185] op_sel_hi:[1,0,1]
    v_pk_fma_f32 v[184:185], v[182:183], s[26:27], v[184:185] op_sel:[0,1,0]
    v_pk_fma_f32 v[182:183], v[180:181], 2.0, v[188:189] op_sel_hi:[1,0,1]
    v_pk_fma_f32 v[180:181], v[180:181], -2.0, v[188:189] op_sel_hi:[1,0,1]
    v_cvt_pk_bf16_f32 v21, v176, v177
    v_cvt_pk_bf16_f32 v23, v178, v179
    v_cvt_pk_bf16_f32 v25, v180, v181
    v_cvt_pk_bf16_f32 v27, v182, v183
    v_cvt_pk_bf16_f32 v29, v184, v185
    v_cvt_pk_bf16_f32 v31, v186, v187
    v_lshrrev_b32 v252, 15, v255
    ds_write_b64 v252, v[20:21] offset:33792
    ds_write_b64 v252, v[22:23] offset:512
    ds_write_b64 v252, v[28:29] offset:2592
    ds_write_b64 v252, v[26:27] offset:4672
    ds_write_b64 v252, v[24:25] offset:6752
    ds_write_b64 v252, v[30:31] offset:35872
    s_waitcnt vmcnt(12)
    v_lshlrev_b32 v176, 16, v56
    v_and_b32 v177, s22, v56
    v_lshlrev_b32 v178, 16, v58
    v_and_b32 v179, s22, v58
    v_lshlrev_b32 v180, 16, v60
    v_and_b32 v181, s22, v60
    v_lshlrev_b32 v182, 16, v62
    v_and_b32 v183, s22, v62
    v_lshlrev_b32 v184, 16, v64
    v_and_b32 v185, s22, v64
    v_lshlrev_b32 v186, 16, v66
    v_and_b32 v187, s22, v66
    v_pk_fma_f32 v[176:177], v[184:185], s[24:25], v[176:177] op_sel:[0,1,0]
    v_pk_fma_f32 v[186:187], v[178:179], s[28:29], v[186:187] op_sel:[0,1,0]
    v_pk_fma_f32 v[176:177], v[180:181], s[28:29], v[176:177] op_sel_hi:[1,0,1]
    v_pk_fma_f32 v[186:187], v[182:183], s[22:23], v[186:187] op_sel:[0,1,0]
    v_pk_fma_f32 v[188:189], v[180:181], s[24:25], v[184:185] op_sel_hi:[1,0,1]
    v_pk_fma_f32 v[184:185], v[180:181], -4.0, v[184:185] op_sel_hi:[1,0,1]
    v_pk_fma_f32 v[180:181], v[178:179], s[24:25], v[182:183] op_sel_hi:[1,0,1]
    v_pk_fma_f32 v[182:183], v[178:179], -4.0, v[182:183] op_sel_hi:[1,0,1]
    v_pk_fma_f32 v[178:179], v[182:183], s[26:27], v[184:185] op_sel_hi:[1,0,1]
    v_pk_fma_f32 v[184:185], v[182:183], s[26:27], v[184:185] op_sel:[0,1,0]
    v_pk_fma_f32 v[182:183], v[180:181], 2.0, v[188:189] op_sel_hi:[1,0,1]
    v_pk_fma_f32 v[180:181], v[180:181], -2.0, v[188:189] op_sel_hi:[1,0,1]
    v_cvt_pk_bf16_f32 v56, v176, v177
    v_cvt_pk_bf16_f32 v58, v178, v179
    v_cvt_pk_bf16_f32 v60, v180, v181
    v_cvt_pk_bf16_f32 v62, v182, v183
    v_cvt_pk_bf16_f32 v64, v184, v185
    v_cvt_pk_bf16_f32 v66, v186, v187
    v_lshlrev_b32 v176, 16, v57
    v_and_b32 v177, s22, v57
    v_lshlrev_b32 v178, 16, v59
    v_and_b32 v179, s22, v59
    v_lshlrev_b32 v180, 16, v61
    v_and_b32 v181, s22, v61
    v_lshlrev_b32 v182, 16, v63
    v_and_b32 v183, s22, v63
    v_lshlrev_b32 v184, 16, v65
    v_and_b32 v185, s22, v65
    v_lshlrev_b32 v186, 16, v67
    v_and_b32 v187, s22, v67
    v_pk_fma_f32 v[176:177], v[184:185], s[24:25], v[176:177] op_sel:[0,1,0]
    v_pk_fma_f32 v[186:187], v[178:179], s[28:29], v[186:187] op_sel:[0,1,0]
    v_pk_fma_f32 v[176:177], v[180:181], s[28:29], v[176:177] op_sel_hi:[1,0,1]
    v_pk_fma_f32 v[186:187], v[182:183], s[22:23], v[186:187] op_sel:[0,1,0]
    v_pk_fma_f32 v[188:189], v[180:181], s[24:25], v[184:185] op_sel_hi:[1,0,1]
    v_pk_fma_f32 v[184:185], v[180:181], -4.0, v[184:185] op_sel_hi:[1,0,1]
    v_pk_fma_f32 v[180:181], v[178:179], s[24:25], v[182:183] op_sel_hi:[1,0,1]
    v_pk_fma_f32 v[182:183], v[178:179], -4.0, v[182:183] op_sel_hi:[1,0,1]
    v_pk_fma_f32 v[178:179], v[182:183], s[26:27], v[184:185] op_sel_hi:[1,0,1]
    v_pk_fma_f32 v[184:185], v[182:183], s[26:27], v[184:185] op_sel:[0,1,0]
    v_pk_fma_f32 v[182:183], v[180:181], 2.0, v[188:189] op_sel_hi:[1,0,1]
    v_pk_fma_f32 v[180:181], v[180:181], -2.0, v[188:189] op_sel_hi:[1,0,1]
    v_cvt_pk_bf16_f32 v57, v176, v177
    v_cvt_pk_bf16_f32 v59, v178, v179
    v_cvt_pk_bf16_f32 v61, v180, v181
    v_cvt_pk_bf16_f32 v63, v182, v183
    v_cvt_pk_bf16_f32 v65, v184, v185
    v_cvt_pk_bf16_f32 v67, v186, v187
    v_and_b32 v248, 0xf0, v254
    v_lshrrev_b32 v248, 1, v248
    v_add_u32 v248, s52, v248
    v_and_b32 v252, 8, v248
    v_lshrrev_b32 v249, 6, v248
    v_mul_u32_u24 v249, 192, v249
    v_cmp_eq_u32 s[92:93], 0, v249
    v_add_u32 v252, v252, v249
    v_bfe_u32 v249, v248, 4, 2
    v_mul_u32_u24 v249, 40704, v249
    v_add_u32 v252, v252, v249
    v_and_b32 v249, 32, v248
    v_lshl_add_u32 v252, v249, 1, v252
    v_bfe_u32 v249, v254, 8, 1
    v_lshl_add_u32 v252, v249, 4, v252
    v_mov_b32 v249, 123328
    v_cndmask_b32 v252, v249, v252, s[58:59]
    ds_write_b64 v252, v[56:57] offset:39520
    ds_write_b64 v252, v[58:59] offset:39552
    ds_write_b64 v252, v[64:65] offset:39584
    ds_write_b64 v252, v[62:63] offset:39616
    ds_write_b64 v252, v[60:61] offset:39648
    ds_write_b64 v252, v[66:67] offset:39680
    s_and_b64 exec, s[92:93], s[58:59]
    ds_write_b64 v252, v[56:57] offset:34304
    ds_write_b64 v252, v[58:59] offset:1024
    ds_write_b64 v252, v[64:65] offset:3104
    ds_write_b64 v252, v[62:63] offset:5184
    ds_write_b64 v252, v[60:61] offset:7264
    ds_write_b64 v252, v[66:67] offset:36384
    s_mov_b64 exec, -1
    v_and_b32 v203, 0x7fff, v255
    buffer_load_dwordx2 v[192:193], v203, s[4:7], s16 offen offset:64
    buffer_load_dwordx2 v[194:195], v203, s[4:7], s17 offen offset:64
    buffer_load_dwordx2 v[196:197], v203, s[4:7], s18 offen offset:64
    buffer_load_dwordx2 v[198:199], v203, s[4:7], s19 offen offset:64
    buffer_load_dwordx2 v[200:201], v203, s[4:7], s20 offen offset:64
    buffer_load_dwordx2 v[202:203], v203, s[4:7], s21 offen offset:64
    v_and_b32 v215, 0x7fff, v255
    buffer_load_dwordx2 v[204:205], v215, s[4:7], s16 offen offset:448
    buffer_load_dwordx2 v[206:207], v215, s[4:7], s17 offen offset:448
    buffer_load_dwordx2 v[208:209], v215, s[4:7], s18 offen offset:448
    buffer_load_dwordx2 v[210:211], v215, s[4:7], s19 offen offset:448
    buffer_load_dwordx2 v[212:213], v215, s[4:7], s20 offen offset:448
    buffer_load_dwordx2 v[214:215], v215, s[4:7], s21 offen offset:448
    s_waitcnt vmcnt(18)
    v_lshlrev_b32 v176, 16, v32
    v_and_b32 v177, s22, v32
    v_lshlrev_b32 v178, 16, v34
    v_and_b32 v179, s22, v34
    v_lshlrev_b32 v180, 16, v36
    v_and_b32 v181, s22, v36
    v_lshlrev_b32 v182, 16, v38
    v_and_b32 v183, s22, v38
    v_lshlrev_b32 v184, 16, v40
    v_and_b32 v185, s22, v40
    v_lshlrev_b32 v186, 16, v42
    v_and_b32 v187, s22, v42
    v_pk_fma_f32 v[176:177], v[184:185], s[24:25], v[176:177] op_sel:[0,1,0]
    v_pk_fma_f32 v[186:187], v[178:179], s[28:29], v[186:187] op_sel:[0,1,0]
    v_pk_fma_f32 v[176:177], v[180:181], s[28:29], v[176:177] op_sel_hi:[1,0,1]
    v_pk_fma_f32 v[186:187], v[182:183], s[22:23], v[186:187] op_sel:[0,1,0]
    v_pk_fma_f32 v[188:189], v[180:181], s[24:25], v[184:185] op_sel_hi:[1,0,1]
    v_pk_fma_f32 v[184:185], v[180:181], -4.0, v[184:185] op_sel_hi:[1,0,1]
    v_pk_fma_f32 v[180:181], v[178:179], s[24:25], v[182:183] op_sel_hi:[1,0,1]
    v_pk_fma_f32 v[182:183], v[178:179], -4.0, v[182:183] op_sel_hi:[1,0,1]
    v_pk_fma_f32 v[178:179], v[182:183], s[26:27], v[184:185] op_sel_hi:[1,0,1]
    v_pk_fma_f32 v[184:185], v[182:183], s[26:27], v[184:185] op_sel:[0,1,0]
    v_pk_fma_f32 v[182:183], v[180:181], 2.0, v[188:189] op_sel_hi:[1,0,1]
    v_pk_fma_f32 v[180:181], v[180:181], -2.0, v[188:189] op_sel_hi:[1,0,1]
    v_cvt_pk_bf16_f32 v32, v176, v177
    v_cvt_pk_bf16_f32 v34, v178, v179
    v_cvt_pk_bf16_f32 v36, v180, v181
    v_cvt_pk_bf16_f32 v38, v182, v183
    v_cvt_pk_bf16_f32 v40, v184, v185
    v_cvt_pk_bf16_f32 v42, v186, v187
    v_lshlrev_b32 v176, 16, v33
    v_and_b32 v177, s22, v33
    v_lshlrev_b32 v178, 16, v35
    v_and_b32 v179, s22, v35
    v_lshlrev_b32 v180, 16, v37
    v_and_b32 v181, s22, v37
    v_lshlrev_b32 v182, 16, v39
    v_and_b32 v183, s22, v39
    v_lshlrev_b32 v184, 16, v41
    v_and_b32 v185, s22, v41
    v_lshlrev_b32 v186, 16, v43
    v_and_b32 v187, s22, v43
    v_pk_fma_f32 v[176:177], v[184:185], s[24:25], v[176:177] op_sel:[0,1,0]
    v_pk_fma_f32 v[186:187], v[178:179], s[28:29], v[186:187] op_sel:[0,1,0]
    v_pk_fma_f32 v[176:177], v[180:181], s[28:29], v[176:177] op_sel_hi:[1,0,1]
    v_pk_fma_f32 v[186:187], v[182:183], s[22:23], v[186:187] op_sel:[0,1,0]
    v_pk_fma_f32 v[188:189], v[180:181], s[24:25], v[184:185] op_sel_hi:[1,0,1]
    v_pk_fma_f32 v[184:185], v[180:181], -4.0, v[184:185] op_sel_hi:[1,0,1]
    v_pk_fma_f32 v[180:181], v[178:179], s[24:25], v[182:183] op_sel_hi:[1,0,1]
    v_pk_fma_f32 v[182:183], v[178:179], -4.0, v[182:183] op_sel_hi:[1,0,1]
    v_pk_fma_f32 v[178:179], v[182:183], s[26:27], v[184:185] op_sel_hi:[1,0,1]
    v_pk_fma_f32 v[184:185], v[182:183], s[26:27], v[184:185] op_sel:[0,1,0]
    v_pk_fma_f32 v[182:183], v[180:181], 2.0, v[188:189] op_sel_hi:[1,0,1]
    v_pk_fma_f32 v[180:181], v[180:181], -2.0, v[188:189] op_sel_hi:[1,0,1]
    v_cvt_pk_bf16_f32 v33, v176, v177
    v_cvt_pk_bf16_f32 v35, v178, v179
    v_cvt_pk_bf16_f32 v37, v180, v181
    v_cvt_pk_bf16_f32 v39, v182, v183
    v_cvt_pk_bf16_f32 v41, v184, v185
    v_cvt_pk_bf16_f32 v43, v186, v187
    v_lshrrev_b32 v252, 15, v255
    ds_write_b64 v252, v[32:33] offset:33536
    ds_write_b64 v252, v[34:35] offset:256
    ds_write_b64 v252, v[40:41] offset:2336
    ds_write_b64 v252, v[38:39] offset:4416
    ds_write_b64 v252, v[36:37] offset:6496
    ds_write_b64 v252, v[42:43] offset:35616
    s_waitcnt vmcnt(12)
    v_lshlrev_b32 v176, 16, v44
    v_and_b32 v177, s22, v44
    v_lshlrev_b32 v178, 16, v46
    v_and_b32 v179, s22, v46
    v_lshlrev_b32 v180, 16, v48
    v_and_b32 v181, s22, v48
    v_lshlrev_b32 v182, 16, v50
    v_and_b32 v183, s22, v50
    v_lshlrev_b32 v184, 16, v52
    v_and_b32 v185, s22, v52
    v_lshlrev_b32 v186, 16, v54
    v_and_b32 v187, s22, v54
    v_pk_fma_f32 v[176:177], v[184:185], s[24:25], v[176:177] op_sel:[0,1,0]
    v_pk_fma_f32 v[186:187], v[178:179], s[28:29], v[186:187] op_sel:[0,1,0]
    v_pk_fma_f32 v[176:177], v[180:181], s[28:29], v[176:177] op_sel_hi:[1,0,1]
    v_pk_fma_f32 v[186:187], v[182:183], s[22:23], v[186:187] op_sel:[0,1,0]
    v_pk_fma_f32 v[188:189], v[180:181], s[24:25], v[184:185] op_sel_hi:[1,0,1]
    v_pk_fma_f32 v[184:185], v[180:181], -4.0, v[184:185] op_sel_hi:[1,0,1]
    v_pk_fma_f32 v[180:181], v[178:179], s[24:25], v[182:183] op_sel_hi:[1,0,1]
    v_pk_fma_f32 v[182:183], v[178:179], -4.0, v[182:183] op_sel_hi:[1,0,1]
    v_pk_fma_f32 v[178:179], v[182:183], s[26:27], v[184:185] op_sel_hi:[1,0,1]
    v_pk_fma_f32 v[184:185], v[182:183], s[26:27], v[184:185] op_sel:[0,1,0]
    v_pk_fma_f32 v[182:183], v[180:181], 2.0, v[188:189] op_sel_hi:[1,0,1]
    v_pk_fma_f32 v[180:181], v[180:181], -2.0, v[188:189] op_sel_hi:[1,0,1]
    v_cvt_pk_bf16_f32 v44, v176, v177
    v_cvt_pk_bf16_f32 v46, v178, v179
    v_cvt_pk_bf16_f32 v48, v180, v181
    v_cvt_pk_bf16_f32 v50, v182, v183
    v_cvt_pk_bf16_f32 v52, v184, v185
    v_cvt_pk_bf16_f32 v54, v186, v187
    v_lshlrev_b32 v176, 16, v45
    v_and_b32 v177, s22, v45
    v_lshlrev_b32 v178, 16, v47
    v_and_b32 v179, s22, v47
    v_lshlrev_b32 v180, 16, v49
    v_and_b32 v181, s22, v49
    v_lshlrev_b32 v182, 16, v51
    v_and_b32 v183, s22, v51
    v_lshlrev_b32 v184, 16, v53
    v_and_b32 v185, s22, v53
    v_lshlrev_b32 v186, 16, v55
    v_and_b32 v187, s22, v55
    v_pk_fma_f32 v[176:177], v[184:185], s[24:25], v[176:177] op_sel:[0,1,0]
    v_pk_fma_f32 v[186:187], v[178:179], s[28:29], v[186:187] op_sel:[0,1,0]
    v_pk_fma_f32 v[176:177], v[180:181], s[28:29], v[176:177] op_sel_hi:[1,0,1]
    v_pk_fma_f32 v[186:187], v[182:183], s[22:23], v[186:187] op_sel:[0,1,0]
    v_pk_fma_f32 v[188:189], v[180:181], s[24:25], v[184:185] op_sel_hi:[1,0,1]
    v_pk_fma_f32 v[184:185], v[180:181], -4.0, v[184:185] op_sel_hi:[1,0,1]
    v_pk_fma_f32 v[180:181], v[178:179], s[24:25], v[182:183] op_sel_hi:[1,0,1]
    v_pk_fma_f32 v[182:183], v[178:179], -4.0, v[182:183] op_sel_hi:[1,0,1]
    v_pk_fma_f32 v[178:179], v[182:183], s[26:27], v[184:185] op_sel_hi:[1,0,1]
    v_pk_fma_f32 v[184:185], v[182:183], s[26:27], v[184:185] op_sel:[0,1,0]
    v_pk_fma_f32 v[182:183], v[180:181], 2.0, v[188:189] op_sel_hi:[1,0,1]
    v_pk_fma_f32 v[180:181], v[180:181], -2.0, v[188:189] op_sel_hi:[1,0,1]
    v_cvt_pk_bf16_f32 v45, v176, v177
    v_cvt_pk_bf16_f32 v47, v178, v179
    v_cvt_pk_bf16_f32 v49, v180, v181
    v_cvt_pk_bf16_f32 v51, v182, v183
    v_cvt_pk_bf16_f32 v53, v184, v185
    v_cvt_pk_bf16_f32 v55, v186, v187
    v_lshrrev_b32 v252, 15, v255
    ds_write_b64 v252, v[44:45] offset:33280
    ds_write_b64 v252, v[46:47] offset:0
    ds_write_b64 v252, v[52:53] offset:2080
    ds_write_b64 v252, v[50:51] offset:4160
    ds_write_b64 v252, v[48:49] offset:6240
    ds_write_b64 v252, v[54:55] offset:35360
    buffer_load_dword v97, v98, s[64:67], 0 offen offset:128 sc1
no_poll:
    s_cmp_lt_u32 s2, 54
    s_cbranch_scc1 warm_done
do_warm:
    s_mov_b64 vcc, -1
    s_cmp_eq_u32 s38, 0
    s_cbranch_scc1 pad0
    s_cmp_eq_u32 s38, 1
    s_cbranch_scc1 pad1
    s_cmp_eq_u32 s38, 2
    s_cbranch_scc1 pad2
    s_branch pad3
warm_ret:
    s_mov_b64 vcc, 0
    s_cmp_lt_u32 s2, 54
    s_cbranch_scc1 wt_ret
warm_done:
    s_mov_b32 s86, 0
    s_waitcnt vmcnt(0)
poll_loop:
    v_readfirstlane_b32 s87, v97
    s_add_u32 s86, s86, 1
    s_cmp_lg_u32 s87, 0
    s_cbranch_scc1 u_ready
    buffer_load_dword v97, v98, s[64:67], 0 offen offset:128 sc1
    s_cmp_lt_u32 s86, 512
    s_waitcnt vmcnt(0)
    s_cbranch_scc1 poll_loop
    s_mov_b32 s70, 0
    s_branch wt_loop
u_ready:
    s_mov_b32 s42, 0
    buffer_load_dwordx4 a[192:195], v254, s[8:11], s42 offen offset:0 sc1
    buffer_load_dwordx4 a[196:199], v254, s[8:11], s42 offen offset:1024 sc1
    buffer_load_dwordx4 a[200:203], v254, s[8:11], s42 offen offset:2048 sc1
    s_mov_b32 s42, 3072
    buffer_load_dwordx4 a[204:207], v254, s[8:11], s42 offen offset:0 sc1
    buffer_load_dwordx4 a[208:211], v254, s[8:11], s42 offen offset:1024 sc1
    buffer_load_dwordx4 a[212:215], v254, s[8:11], s42 offen offset:2048 sc1
    s_mov_b32 s42, 6144
    buffer_load_dwordx4 a[216:219], v254, s[8:11], s42 offen offset:0 sc1
    buffer_load_dwordx4 a[220:223], v254, s[8:11], s42 offen offset:1024 sc1
    buffer_load_dwordx4 a[224:227], v254, s[8:11], s42 offen offset:2048 sc1
    s_mov_b32 s42, 36864
    buffer_load_dwordx4 a[228:231], v254, s[8:11], s42 offen offset:0 sc1
    buffer_load_dwordx4 a[232:235], v254, s[8:11], s42 offen offset:1024 sc1
    buffer_load_dwordx4 a[236:239], v254, s[8:11], s42 offen offset:2048 sc1
    s_mov_b32 s42, 39936
    buffer_load_dwordx4 a[240:243], v254, s[8:11], s42 offen offset:0 sc1
    buffer_load_dwordx4 a[244:247], v254, s[8:11], s42 offen offset:1024 sc1
    buffer_load_dwordx4 a[248:251], v254, s[8:11], s42 offen offset:2048 sc1
    s_mov_b32 s42, 43008
    buffer_load_dwordx4 a[252:255], v254, s[8:11], s42 offen offset:0 sc1
    buffer_load_dwordx4 v[240:243], v254, s[8:11], s42 offen offset:1024 sc1
    buffer_load_dwordx4 v[244:247], v254, s[8:11], s42 offen offset:2048 sc1
u_done:
    s_waitcnt lgkmcnt(0)
    s_barrier
    ds_read_b128 v[228:231], v253 offset:1040
    ds_read_b128 v[232:235], v253 offset:768
    ds_read_b128 v[236:239], v253 offset:512
    s_waitcnt vmcnt(9) lgkmcnt(0)
    s_branch blk_loop
.p2align 12
blk_loop:
sub0:
    v_mfma_f32_16x16x32_bf16 a[0:3], a[192:195], v[228:231], 0
pad0:
    s_cbranch_vccnz pad4
    s_add_u32 s44, s41, 10240
    s_waitcnt vmcnt(23)
    v_lshlrev_b32 v248, 16, v194
    v_mfma_f32_16x16x32_bf16 a[4:7], a[196:199], v[228:231], 0
    v_cvt_pk_bf16_f32 v180, v180, v181
    v_cvt_pk_bf16_f32 v181, v182, v183
    v_mfma_f32_16x16x32_bf16 a[8:11], a[200:203], v[228:231], 0
    ds_read_b128 v[228:231], v253 offset:256
    v_cvt_pk_bf16_f32 v182, v184, v185
    v_mfma_f32_16x16x32_bf16 a[8:11], a[212:215], v[232:235], a[8:11]
    s_waitcnt lgkmcnt(1)
    buffer_store_dwordx4 v[124:127], v254, s[12:15], s44 offen nt
    v_cvt_pk_bf16_f32 v183, v186, v187
    v_lshlrev_b32 v249, 16, v196
    v_mfma_f32_16x16x32_bf16 a[4:7], a[208:211], v[232:235], a[4:7]
    ds_write_b128 v4, v[180:183] offset:19328
    v_mfma_f32_16x16x32_bf16 a[0:3], a[204:207], v[232:235], a[0:3]
    v_lshlrev_b32 v250, 16, v198
    v_lshlrev_b32 v251, 16, v200
    v_mfma_f32_16x16x32_bf16 a[0:3], a[216:219], v[236:239], a[0:3]
    v_and_b32 v194, s22, v194
    v_and_b32 v196, s22, v196
    v_and_b32 v198, s22, v198
    v_mfma_f32_16x16x32_bf16 a[4:7], a[220:223], v[236:239], a[4:7]
    v_cvt_pk_bf16_f32 v188, v188, v189
    v_cvt_pk_bf16_f32 v189, v190, v191
    v_mfma_f32_16x16x32_bf16 a[8:11], a[224:227], v[236:239], a[8:11]
    ds_write_b64 v5, v[188:189] offset:19392
    v_mfma_f32_16x16x32_bf16 a[12:15], a[192:195], v[232:235], 0
    v_and_b32 v200, s22, v200
    v_lshlrev_b32 v252, 16, v192
    v_mfma_f32_16x16x32_bf16 a[12:15], a[204:207], v[236:239], a[12:15]
    s_waitcnt lgkmcnt(2)
    v_and_b32 v192, s22, v192
    v_fmac_f32 v252, s25, v251
    v_mfma_f32_16x16x32_bf16 a[12:15], a[216:219], v[228:231], a[12:15]
    v_fmac_f32 v192, s25, v200
    v_fmac_f32 v252, s28, v249
    v_mfma_f32_16x16x32_bf16 a[16:19], a[220:223], v[228:231], 0
    v_fmac_f32 v192, s28, v196
    v_cvt_pk_bf16_f32 v192, v252, v192
    v_mfma_f32_16x16x32_bf16 a[16:19], a[208:211], v[236:239], a[16:19]
    v_lshlrev_b32 v252, 16, v202
    v_and_b32 v202, s22, v202
    v_fmac_f32 v252, s29, v248
    v_mfma_f32_16x16x32_bf16 a[16:19], a[196:199], v[232:235], a[16:19]
    v_fmac_f32 v202, s29, v194
    v_fmac_f32 v252, s23, v250
    v_mfma_f32_16x16x32_bf16 a[20:23], a[200:203], v[232:235], 0
    ds_read_b128 v[232:235], v253 offset:0
    v_fmac_f32 v202, s23, v198
    v_mfma_f32_16x16x32_bf16 a[20:23], a[212:215], v[236:239], a[20:23]
    s_waitcnt lgkmcnt(0)
    v_cvt_pk_bf16_f32 v202, v252, v202
    v_fma_f32 v252, v249, s24, v251
    v_mfma_f32_16x16x32_bf16 a[20:23], a[224:227], v[228:231], a[20:23]
    s_barrier
    v_mfma_f32_16x16x32_bf16 a[24:27], a[192:195], v[236:239], 0
    ds_read_b128 v[128:131], v6 offset:18688
    v_fmac_f32 v251, -4.0, v249
    v_mfma_f32_16x16x32_bf16 a[24:27], a[204:207], v[228:231], a[24:27]
    v_fma_f32 v249, v248, s24, v250
    v_fmac_f32 v250, -4.0, v248
    v_fma_f32 v248, v250, s26, v251
    v_mfma_f32_16x16x32_bf16 a[24:27], a[216:219], v[232:235], a[24:27]
    v_fmac_f32 v251, s27, v250
    v_fma_f32 v250, v249, 2.0, v252
    v_mfma_f32_16x16x32_bf16 a[28:31], a[220:223], v[232:235], 0
    v_fmac_f32 v252, -2.0, v249
    v_fma_f32 v249, v196, s24, v200
    v_mfma_f32_16x16x32_bf16 a[28:31], a[208:211], v[228:231], a[28:31]
    v_fmac_f32 v200, -4.0, v196
    v_fma_f32 v196, v194, s24, v198
    v_mfma_f32_16x16x32_bf16 a[28:31], a[196:199], v[236:239], a[28:31]
    s_add_u32 s44, s41, 2048
    v_fmac_f32 v198, -4.0, v194
    v_fma_f32 v194, v198, s26, v200
    v_mfma_f32_16x16x32_bf16 a[32:35], a[200:203], v[236:239], 0
    ds_read_b128 v[236:239], v253 offset:1824
    v_fmac_f32 v200, s27, v198
    v_mfma_f32_16x16x32_bf16 a[32:35], a[212:215], v[228:231], a[32:35]
    v_fma_f32 v198, v196, 2.0, v249
    v_fmac_f32 v249, -2.0, v196
    v_mfma_f32_16x16x32_bf16 a[32:35], a[224:227], v[232:235], a[32:35]
    v_cvt_pk_bf16_f32 v194, v248, v194
    v_cvt_pk_bf16_f32 v200, v251, v200
    v_cvt_pk_bf16_f32 v198, v250, v198
    v_mfma_f32_16x16x32_bf16 a[36:39], a[192:195], v[228:231], 0
    v_and_b32 v227, 0x7fff, v255
    v_cvt_pk_bf16_f32 v196, v252, v249
    v_mfma_f32_16x16x32_bf16 a[36:39], a[204:207], v[232:235], a[36:39]
    s_waitcnt lgkmcnt(0)
    v_lshlrev_b32 v248, 16, v195
    v_lshlrev_b32 v249, 16, v197
    v_mfma_f32_16x16x32_bf16 a[36:39], a[216:219], v[236:239], a[36:39]
    buffer_load_dwordx2 v[216:217], v227, s[4:7], s16 offen offset:832
    v_mfma_f32_16x16x32_bf16 a[40:43], a[220:223], v[236:239], 0
    ds_read_b128 v[132:135], v6 offset:21792
    v_mfma_f32_16x16x32_bf16 a[40:43], a[208:211], v[232:235], a[40:43]
    v_lshlrev_b32 v250, 16, v199
    v_lshlrev_b32 v251, 16, v201
    v_mfma_f32_16x16x32_bf16 a[40:43], a[196:199], v[228:231], a[40:43]
    v_and_b32 v195, s22, v195
    v_and_b32 v197, s22, v197
    v_mfma_f32_16x16x32_bf16 a[44:47], a[200:203], v[228:231], 0
    ds_read_b128 v[228:231], v253 offset:1568
    v_and_b32 v199, s22, v199
    v_and_b32 v201, s22, v201
    v_mfma_f32_16x16x32_bf16 a[44:47], a[212:215], v[232:235], a[44:47]
    buffer_load_dwordx2 v[218:219], v227, s[4:7], s17 offen offset:832
    v_mfma_f32_16x16x32_bf16 a[44:47], a[224:227], v[236:239], a[44:47]
    v_lshlrev_b32 v252, 16, v193
    v_and_b32 v193, s22, v193
    v_mfma_f32_16x16x32_bf16 a[48:51], a[192:195], v[232:235], 0
    v_fmac_f32 v252, s25, v251
    v_fmac_f32 v193, s25, v201
    v_mfma_f32_16x16x32_bf16 a[48:51], a[204:207], v[236:239], a[48:51]
    s_waitcnt lgkmcnt(0)
    v_fmac_f32 v252, s28, v249
    v_fmac_f32 v193, s28, v197
    v_mfma_f32_16x16x32_bf16 a[48:51], a[216:219], v[228:231], a[48:51]
    buffer_load_dwordx2 v[220:221], v227, s[4:7], s18 offen offset:832
    v_mfma_f32_16x16x32_bf16 a[52:55], a[220:223], v[228:231], 0
    ds_read_b128 v[136:139], v6 offset:24896
    v_cvt_pk_bf16_f32 v193, v252, v193
    v_lshlrev_b32 v252, 16, v203
    v_mfma_f32_16x16x32_bf16 a[52:55], a[208:211], v[236:239], a[52:55]
    v_and_b32 v203, s22, v203
    v_fmac_f32 v252, s29, v248
    v_mfma_f32_16x16x32_bf16 a[52:55], a[196:199], v[232:235], a[52:55]
    v_fmac_f32 v203, s29, v195
    v_fmac_f32 v252, s23, v250
    v_mfma_f32_16x16x32_bf16 a[56:59], a[200:203], v[232:235], 0
    ds_read_b128 v[232:235], v253 offset:1312
    v_fmac_f32 v203, s23, v199
    v_mfma_f32_16x16x32_bf16 a[56:59], a[212:215], v[236:239], a[56:59]
    buffer_load_dwordx2 v[222:223], v227, s[4:7], s19 offen offset:832
    v_mfma_f32_16x16x32_bf16 a[56:59], a[224:227], v[228:231], a[56:59]
    v_cvt_pk_bf16_f32 v203, v252, v203
    v_fma_f32 v252, v249, s24, v251
    v_mfma_f32_16x16x32_bf16 a[60:63], a[192:195], v[236:239], 0
    v_fmac_f32 v251, -4.0, v249
    v_fma_f32 v249, v248, s24, v250
    v_mfma_f32_16x16x32_bf16 a[60:63], a[204:207], v[228:231], a[60:63]
    s_waitcnt lgkmcnt(0)
    v_fmac_f32 v250, -4.0, v248
    v_fma_f32 v248, v250, s26, v251
    v_fmac_f32 v251, s27, v250
    v_mfma_f32_16x16x32_bf16 a[60:63], a[216:219], v[232:235], a[60:63]
    buffer_load_dwordx2 v[224:225], v227, s[4:7], s20 offen offset:832
    v_mfma_f32_16x16x32_bf16 a[64:67], a[220:223], v[232:235], 0
    v_fma_f32 v250, v249, 2.0, v252
    v_fmac_f32 v252, -2.0, v249
    v_mfma_f32_16x16x32_bf16 a[64:67], a[208:211], v[228:231], a[64:67]
    ds_read_b128 v[140:143], v6 offset:28000
    v_fma_f32 v249, v197, s24, v201
    v_mfma_f32_16x16x32_bf16 a[64:67], a[196:199], v[236:239], a[64:67]
    v_fmac_f32 v201, -4.0, v197
    v_fma_f32 v197, v195, s24, v199
    v_mfma_f32_16x16x32_bf16 a[68:71], a[200:203], v[236:239], 0
    ds_read_b128 v[236:239], v253 offset:1056
    v_fmac_f32 v199, -4.0, v195
    v_mfma_f32_16x16x32_bf16 a[68:71], a[212:215], v[228:231], a[68:71]
    buffer_load_dwordx2 v[226:227], v227, s[4:7], s21 offen offset:832
    v_mfma_f32_16x16x32_bf16 a[68:71], a[224:227], v[232:235], a[68:71]
    v_fma_f32 v195, v199, s26, v201
    v_fmac_f32 v201, s27, v199
    v_fma_f32 v199, v197, 2.0, v249
    v_mfma_f32_16x16x32_bf16 a[72:75], a[192:195], v[228:231], 0
    buffer_store_dwordx4 v[128:131], v254, s[12:15], s44 offen nt
    s_add_u32 s44, s41, 5120
    v_mfma_f32_16x16x32_bf16 a[72:75], a[204:207], v[232:235], a[72:75]
    s_waitcnt lgkmcnt(0)
    v_fmac_f32 v249, -2.0, v197
    v_cvt_pk_bf16_f32 v195, v248, v195
    v_mfma_f32_16x16x32_bf16 a[72:75], a[216:219], v[236:239], a[72:75]
    v_cvt_pk_bf16_f32 v201, v251, v201
    v_cvt_pk_bf16_f32 v199, v250, v199
    v_mfma_f32_16x16x32_bf16 a[76:79], a[220:223], v[236:239], 0
    buffer_store_dwordx4 v[132:135], v254, s[12:15], s44 offen nt
    v_cvt_pk_bf16_f32 v197, v252, v249
    v_lshrrev_b32 v252, 15, v255
    v_mfma_f32_16x16x32_bf16 a[76:79], a[208:211], v[232:235], a[76:79]
    ds_write_b64 v252, v[194:195] offset:9088
    v_mfma_f32_16x16x32_bf16 a[76:79], a[196:199], v[228:231], a[76:79]
    s_waitcnt vmcnt(14)
    v_lshrrev_b32 v194, 15, v255
    v_lshlrev_b32 v248, 16, v206
    v_lshlrev_b32 v249, 16, v208
    v_mfma_f32_16x16x32_bf16 a[80:83], a[200:203], v[228:231], 0
    ds_read_b128 v[228:231], v253 offset:784
    v_lshlrev_b32 v250, 16, v210
    v_mfma_f32_16x16x32_bf16 a[80:83], a[212:215], v[232:235], a[80:83]
    ds_write_b64 v194, v[200:201] offset:11168
    v_mfma_f32_16x16x32_bf16 a[80:83], a[224:227], v[236:239], a[80:83]
    s_mov_b32 s42, 73728
    s_add_u32 s44, s41, 8192
    v_lshlrev_b32 v251, 16, v212
    v_mfma_f32_16x16x32_bf16 a[84:87], a[192:195], v[232:235], 0
    ds_write_b64 v194, v[198:199] offset:13248
    v_mfma_f32_16x16x32_bf16 a[88:91], a[196:199], v[232:235], 0
    v_and_b32 v206, s22, v206
    v_and_b32 v208, s22, v208
    v_mfma_f32_16x16x32_bf16 a[92:95], a[200:203], v[232:235], 0
    ds_read_b128 v[232:235], v253 offset:3120
    v_and_b32 v210, s22, v210
    v_mfma_f32_16x16x32_bf16 a[92:95], a[212:215], v[236:239], a[92:95]
    buffer_load_dwordx4 a[192:195], v254, s[8:11], s42 offen offset:0 sc1
    v_and_b32 v212, s22, v212
    v_mfma_f32_16x16x32_bf16 a[88:91], a[208:211], v[236:239], a[88:91]
    s_waitcnt lgkmcnt(3)
    v_lshlrev_b32 v252, 16, v204
    v_and_b32 v204, s22, v204
    v_mfma_f32_16x16x32_bf16 a[84:87], a[204:207], v[236:239], a[84:87]
    ds_read_b128 v[236:239], v253 offset:2848
    v_mfma_f32_16x16x32_bf16 a[84:87], a[216:219], v[228:231], a[84:87]
    buffer_load_dwordx4 a[196:199], v254, s[8:11], s42 offen offset:1024 sc1
    v_mfma_f32_16x16x32_bf16 a[88:91], a[220:223], v[228:231], a[88:91]
    s_waitcnt vmcnt(11) lgkmcnt(1)
    v_fmac_f32 v252, s25, v251
    v_fmac_f32 v204, s25, v212
    v_mfma_f32_16x16x32_bf16 a[92:95], a[224:227], v[228:231], a[92:95]
    ds_read_b128 v[228:231], v253 offset:2592
    v_fmac_f32 v252, s28, v249
sub1:
    v_mfma_f32_16x16x32_bf16 a[96:99], a[228:231], v[232:235], 0
    buffer_load_dwordx4 a[200:203], v254, s[8:11], s42 offen offset:2048 sc1
    v_mfma_f32_16x16x32_bf16 a[100:103], a[232:235], v[232:235], 0
    s_mov_b32 s42, 76800
    v_fmac_f32 v204, s28, v208
    v_cvt_pk_bf16_f32 v204, v252, v204
    v_lshlrev_b32 v252, 16, v214
    v_mfma_f32_16x16x32_bf16 a[104:107], a[236:239], v[232:235], 0
    ds_read_b128 v[232:235], v253 offset:2336
    s_waitcnt vmcnt(12)
    s_waitcnt lgkmcnt(2)
    v_mfma_f32_16x16x32_bf16 a[104:107], a[248:251], v[236:239], a[104:107]
    ds_write_b64 v194, v[192:193] offset:15328
    v_mfma_f32_16x16x32_bf16 a[100:103], a[244:247], v[236:239], a[100:103]
    buffer_load_dwordx4 a[204:207], v254, s[8:11], s42 offen offset:0 sc1
    v_mfma_f32_16x16x32_bf16 a[96:99], a[240:243], v[236:239], a[96:99]
    s_waitcnt vmcnt(13) lgkmcnt(2)
    v_and_b32 v214, s22, v214
    v_fmac_f32 v252, s29, v248
    v_mfma_f32_16x16x32_bf16 a[96:99], a[252:255], v[228:231], a[96:99]
    buffer_store_dwordx4 v[136:139], v254, s[12:15], s44 offen nt
    v_fmac_f32 v214, s29, v206
    v_fmac_f32 v252, s23, v250
    v_mfma_f32_16x16x32_bf16 a[100:103], v[240:243], v[228:231], a[100:103]
    ds_write_b64 v194, v[202:203] offset:38208
    v_fmac_f32 v214, s23, v210
    v_mfma_f32_16x16x32_bf16 a[104:107], v[244:247], v[228:231], a[104:107]
    buffer_load_dwordx4 a[208:211], v254, s[8:11], s42 offen offset:1024 sc1
    v_mfma_f32_16x16x32_bf16 a[108:111], a[228:231], v[236:239], 0
    s_add_u32 s44, s41, 11264
    v_cvt_pk_bf16_f32 v214, v252, v214
    v_fma_f32 v252, v249, s24, v251
    v_mfma_f32_16x16x32_bf16 a[108:111], a[240:243], v[228:231], a[108:111]
    s_waitcnt lgkmcnt(2)
    v_fmac_f32 v251, -4.0, v249
    v_fma_f32 v249, v248, s24, v250
    v_mfma_f32_16x16x32_bf16 a[108:111], a[252:255], v[232:235], a[108:111]
    ds_write_b64 v194, v[196:197] offset:31968
    v_mfma_f32_16x16x32_bf16 a[112:115], v[240:243], v[232:235], 0
    buffer_load_dwordx4 a[212:215], v254, s[8:11], s42 offen offset:2048 sc1
    v_mfma_f32_16x16x32_bf16 a[112:115], a[244:247], v[228:231], a[112:115]
    s_mov_b32 s42, 79872
    v_fmac_f32 v250, -4.0, v248
    v_fma_f32 v248, v250, s26, v251
    v_mfma_f32_16x16x32_bf16 a[112:115], a[232:235], v[236:239], a[112:115]
    v_fmac_f32 v251, s27, v250
    v_fma_f32 v250, v249, 2.0, v252
    v_fmac_f32 v252, -2.0, v249
    v_mfma_f32_16x16x32_bf16 a[116:119], a[236:239], v[236:239], 0
    ds_read_b128 v[236:239], v253 offset:2080
    v_fma_f32 v249, v208, s24, v212
    v_mfma_f32_16x16x32_bf16 a[116:119], a[248:251], v[228:231], a[116:119]
    buffer_load_dwordx4 a[216:219], v254, s[8:11], s42 offen offset:0 sc1
    v_mfma_f32_16x16x32_bf16 a[116:119], v[244:247], v[232:235], a[116:119]
    v_fmac_f32 v212, -4.0, v208
    v_fma_f32 v208, v206, s24, v210
    v_mfma_f32_16x16x32_bf16 a[120:123], a[228:231], v[228:231], 0
    v_fmac_f32 v210, -4.0, v206
    v_fma_f32 v206, v210, s26, v212
    v_mfma_f32_16x16x32_bf16 a[120:123], a[240:243], v[232:235], a[120:123]
    s_waitcnt lgkmcnt(0)
    v_fmac_f32 v212, s27, v210
    v_fma_f32 v210, v208, 2.0, v249
    v_mfma_f32_16x16x32_bf16 a[120:123], a[252:255], v[236:239], a[120:123]
    v_fmac_f32 v249, -2.0, v208
    v_cvt_pk_bf16_f32 v206, v248, v206
    v_mfma_f32_16x16x32_bf16 a[124:127], v[240:243], v[236:239], 0
    buffer_load_dwordx4 a[220:223], v254, s[8:11], s42 offen offset:1024 sc1
    v_cvt_pk_bf16_f32 v212, v251, v212
    v_mfma_f32_16x16x32_bf16 a[124:127], a[244:247], v[232:235], a[124:127]
    v_cvt_pk_bf16_f32 v210, v250, v210
    v_cvt_pk_bf16_f32 v208, v252, v249
    v_mfma_f32_16x16x32_bf16 a[124:127], a[232:235], v[228:231], a[124:127]
    v_lshlrev_b32 v248, 16, v207
    v_lshlrev_b32 v249, 16, v209
    v_mfma_f32_16x16x32_bf16 a[128:131], a[236:239], v[228:231], 0
    ds_read_b128 v[228:231], v253 offset:3904
    v_lshlrev_b32 v250, 16, v211
    v_mfma_f32_16x16x32_bf16 a[128:131], a[248:251], v[232:235], a[128:131]
    buffer_load_dwordx4 a[224:227], v254, s[8:11], s42 offen offset:2048 sc1
    v_mfma_f32_16x16x32_bf16 a[128:131], v[244:247], v[236:239], a[128:131]
    v_lshlrev_b32 v251, 16, v213
    v_and_b32 v207, s22, v207
    v_mfma_f32_16x16x32_bf16 a[132:135], a[228:231], v[232:235], 0
    buffer_store_dwordx4 v[140:143], v254, s[12:15], s44 offen nt
    v_and_b32 v203, 0x7fff, v255
    v_and_b32 v209, s22, v209
    v_and_b32 v211, s22, v211
    v_mfma_f32_16x16x32_bf16 a[132:135], a[240:243], v[236:239], a[132:135]
    s_waitcnt lgkmcnt(0)
    v_and_b32 v213, s22, v213
    v_lshlrev_b32 v252, 16, v205
    v_mfma_f32_16x16x32_bf16 a[132:135], a[252:255], v[228:231], a[132:135]
    buffer_load_dwordx2 v[192:193], v203, s[4:7], s16 offen offset:1216
    v_mfma_f32_16x16x32_bf16 a[136:139], v[240:243], v[228:231], 0
    v_and_b32 v205, s22, v205
    v_fmac_f32 v252, s25, v251
    v_mfma_f32_16x16x32_bf16 a[136:139], a[244:247], v[236:239], a[136:139]
    v_fmac_f32 v205, s25, v213
    v_fmac_f32 v252, s28, v249
    v_mfma_f32_16x16x32_bf16 a[136:139], a[232:235], v[232:235], a[136:139]
    v_fmac_f32 v205, s28, v209
    v_cvt_pk_bf16_f32 v205, v252, v205
    v_mfma_f32_16x16x32_bf16 a[140:143], a[236:239], v[232:235], 0
    ds_read_b128 v[232:235], v253 offset:3648
    v_lshlrev_b32 v252, 16, v215
    v_mfma_f32_16x16x32_bf16 a[140:143], a[248:251], v[236:239], a[140:143]
    buffer_load_dwordx2 v[194:195], v203, s[4:7], s17 offen offset:1216
    v_and_b32 v215, s22, v215
    v_mfma_f32_16x16x32_bf16 a[140:143], v[244:247], v[228:231], a[140:143]
    v_fmac_f32 v252, s29, v248
    v_fmac_f32 v215, s29, v207
    v_mfma_f32_16x16x32_bf16 a[144:147], a[228:231], v[236:239], 0
    v_fmac_f32 v252, s23, v250
    v_fmac_f32 v215, s23, v211
    v_mfma_f32_16x16x32_bf16 a[144:147], a[240:243], v[228:231], a[144:147]
    s_waitcnt lgkmcnt(0)
    v_cvt_pk_bf16_f32 v215, v252, v215
    v_fma_f32 v252, v249, s24, v251
    v_mfma_f32_16x16x32_bf16 a[144:147], a[252:255], v[232:235], a[144:147]
    buffer_load_dwordx2 v[196:197], v203, s[4:7], s18 offen offset:1216
    v_mfma_f32_16x16x32_bf16 a[148:151], v[240:243], v[232:235], 0
    v_fmac_f32 v251, -4.0, v249
    v_fma_f32 v249, v248, s24, v250
    v_mfma_f32_16x16x32_bf16 a[148:151], a[244:247], v[228:231], a[148:151]
    v_fmac_f32 v250, -4.0, v248
    v_fma_f32 v248, v250, s26, v251
    v_mfma_f32_16x16x32_bf16 a[148:151], a[232:235], v[236:239], a[148:151]
    v_fmac_f32 v251, s27, v250
    v_fma_f32 v250, v249, 2.0, v252
    v_fmac_f32 v252, -2.0, v249
    v_mfma_f32_16x16x32_bf16 a[152:155], a[236:239], v[236:239], 0
    ds_read_b128 v[236:239], v253 offset:3392
    v_fma_f32 v249, v209, s24, v213
    v_mfma_f32_16x16x32_bf16 a[152:155], a[248:251], v[228:231], a[152:155]
    buffer_load_dwordx2 v[198:199], v203, s[4:7], s19 offen offset:1216
    v_mfma_f32_16x16x32_bf16 a[152:155], v[244:247], v[232:235], a[152:155]
    v_fmac_f32 v213, -4.0, v209
    v_fma_f32 v209, v207, s24, v211
    v_mfma_f32_16x16x32_bf16 a[156:159], a[228:231], v[228:231], 0
    v_fmac_f32 v211, -4.0, v207
    v_fma_f32 v207, v211, s26, v213
    v_mfma_f32_16x16x32_bf16 a[156:159], a[240:243], v[232:235], a[156:159]
    s_waitcnt lgkmcnt(0)
    v_fmac_f32 v213, s27, v211
    v_fma_f32 v211, v209, 2.0, v249
    v_mfma_f32_16x16x32_bf16 a[156:159], a[252:255], v[236:239], a[156:159]
    buffer_load_dwordx2 v[200:201], v203, s[4:7], s20 offen offset:1216
    v_fmac_f32 v249, -2.0, v209
    v_mfma_f32_16x16x32_bf16 a[160:163], v[240:243], v[236:239], 0
    v_cvt_pk_bf16_f32 v207, v248, v207
    v_cvt_pk_bf16_f32 v213, v251, v213
    v_mfma_f32_16x16x32_bf16 a[160:163], a[244:247], v[232:235], a[160:163]
    v_cvt_pk_bf16_f32 v211, v250, v211
    v_cvt_pk_bf16_f32 v209, v252, v249
    v_mfma_f32_16x16x32_bf16 a[160:163], a[232:235], v[228:231], a[160:163]
    v_lshrrev_b32 v252, 15, v255
    v_mfma_f32_16x16x32_bf16 a[164:167], a[236:239], v[228:231], 0
    ds_read_b128 v[228:231], v253 offset:3136
    v_mfma_f32_16x16x32_bf16 a[164:167], a[248:251], v[232:235], a[164:167]
    buffer_load_dwordx2 v[202:203], v203, s[4:7], s21 offen offset:1216
    v_mfma_f32_16x16x32_bf16 a[164:167], v[244:247], v[236:239], a[164:167]
    ds_write_b64 v252, v[206:207] offset:8832
    v_mfma_f32_16x16x32_bf16 a[168:171], a[228:231], v[232:235], 0
    s_waitcnt vmcnt(19)
    v_lshrrev_b32 v206, 15, v255
    v_lshlrev_b32 v248, 16, v218
    v_lshlrev_b32 v249, 16, v220
    v_mfma_f32_16x16x32_bf16 a[168:171], a[240:243], v[236:239], a[168:171]
    s_waitcnt lgkmcnt(1)
    v_lshlrev_b32 v250, 16, v222
    v_lshlrev_b32 v251, 16, v224
    v_mfma_f32_16x16x32_bf16 a[168:171], a[252:255], v[228:231], a[168:171]
    ds_write_b64 v206, v[212:213] offset:10912
    v_mfma_f32_16x16x32_bf16 a[172:175], v[240:243], v[228:231], 0
    v_and_b32 v218, s22, v218
    v_and_b32 v220, s22, v220
    v_mfma_f32_16x16x32_bf16 a[172:175], a[244:247], v[236:239], a[172:175]
    ds_write_b64 v206, v[210:211] offset:12992
    v_mfma_f32_16x16x32_bf16 a[172:175], a[232:235], v[232:235], a[172:175]
    v_and_b32 v222, s22, v222
    v_and_b32 v224, s22, v224
    v_mfma_f32_16x16x32_bf16 a[176:179], a[236:239], v[232:235], 0
    ds_read_b128 v[232:235], v253 offset:2864
    v_lshlrev_b32 v252, 16, v216
    v_mfma_f32_16x16x32_bf16 a[176:179], a[248:251], v[236:239], a[176:179]
    ds_write_b64 v206, v[204:205] offset:15072
    v_and_b32 v216, s22, v216
    v_mfma_f32_16x16x32_bf16 a[176:179], v[244:247], v[228:231], a[176:179]
    s_mov_b32 s42, 110592
    v_fmac_f32 v252, s25, v251
    v_fmac_f32 v216, s25, v224
    v_mfma_f32_16x16x32_bf16 a[180:183], a[228:231], v[236:239], 0
    ds_write_b64 v206, v[214:215] offset:37952
    v_mfma_f32_16x16x32_bf16 a[184:187], a[232:235], v[236:239], 0
    v_fmac_f32 v252, s28, v249
    v_fmac_f32 v216, s28, v220
    v_mfma_f32_16x16x32_bf16 a[188:191], a[236:239], v[236:239], 0
    ds_read_b128 v[236:239], v253 offset:5200
    v_cvt_pk_bf16_f32 v216, v252, v216
    v_mfma_f32_16x16x32_bf16 a[188:191], a[248:251], v[228:231], a[188:191]
    buffer_load_dwordx4 a[228:231], v254, s[8:11], s42 offen offset:0 sc1
    v_mfma_f32_16x16x32_bf16 a[184:187], a[244:247], v[228:231], a[184:187]
    s_waitcnt lgkmcnt(3)
    v_lshlrev_b32 v252, 16, v226
    v_and_b32 v226, s22, v226
    v_fmac_f32 v252, s29, v248
    v_mfma_f32_16x16x32_bf16 a[180:183], a[240:243], v[228:231], a[180:183]
    ds_read_b128 v[228:231], v253 offset:4928
    v_fmac_f32 v226, s29, v218
    v_mfma_f32_16x16x32_bf16 a[180:183], a[252:255], v[232:235], a[180:183]
    buffer_load_dwordx4 a[232:235], v254, s[8:11], s42 offen offset:1024 sc1
    v_mfma_f32_16x16x32_bf16 a[184:187], v[240:243], v[232:235], a[184:187]
    s_waitcnt vmcnt(16) lgkmcnt(1)
    v_fmac_f32 v252, s23, v250
    v_fmac_f32 v226, s23, v222
    v_mfma_f32_16x16x32_bf16 a[188:191], v[244:247], v[232:235], a[188:191]
    ds_read_b128 v[232:235], v253 offset:4672
    v_cvt_pk_bf16_f32 v226, v252, v226
sub2:
    v_mfma_f32_16x16x32_bf16 v[0:3], a[192:195], v[236:239], 0
    buffer_load_dwordx4 a[236:239], v254, s[8:11], s42 offen offset:2048 sc1
    v_mfma_f32_16x16x32_bf16 v[4:7], a[196:199], v[236:239], 0
    s_mov_b32 s42, 113664
    v_fma_f32 v252, v249, s24, v251
    v_fmac_f32 v251, -4.0, v249
    v_mfma_f32_16x16x32_bf16 v[8:11], a[200:203], v[236:239], 0
    ds_read_b128 v[236:239], v253 offset:4416
    s_waitcnt vmcnt(13)
    s_waitcnt lgkmcnt(2)
    v_mfma_f32_16x16x32_bf16 v[8:11], a[212:215], v[228:231], v[8:11]
    ds_write_b64 v206, v[208:209] offset:31712
    v_mfma_f32_16x16x32_bf16 v[4:7], a[208:211], v[228:231], v[4:7]
    buffer_load_dwordx4 a[240:243], v254, s[8:11], s42 offen offset:0 sc1
    v_mfma_f32_16x16x32_bf16 v[0:3], a[204:207], v[228:231], v[0:3]
    s_waitcnt vmcnt(11) lgkmcnt(2)
    v_fma_f32 v249, v248, s24, v250
    v_fmac_f32 v250, -4.0, v248
    v_mfma_f32_16x16x32_bf16 v[0:3], a[216:219], v[232:235], v[0:3]
    ds_read_b128 v[204:207], v253 offset:39712
    s_mov_b32 s45, 619910279
    v_mfma_f32_16x16x32_bf16 v[4:7], a[220:223], v[232:235], v[4:7]
    v_bfe_u32 v208, v254, 5, 3
    v_mul_u32_u24 v209, 5, v208
    v_mfma_f32_16x16x32_bf16 v[8:11], a[224:227], v[232:235], v[8:11]
    buffer_load_dwordx4 a[244:247], v254, s[8:11], s42 offen offset:1024 sc1
    v_mfma_f32_16x16x32_bf16 v[12:15], a[192:195], v[228:231], 0
    v_bfe_u32 v209, s45, v209, 5
    v_mul_u32_u24 v209, 65, v209
    v_fma_f32 v248, v250, s26, v251
    v_mfma_f32_16x16x32_bf16 v[12:15], a[204:207], v[232:235], v[12:15]
    s_waitcnt lgkmcnt(2)
    v_sub_u32 v209, v209, v208
    v_lshl_add_u32 v208, v209, 5, v253
    v_mfma_f32_16x16x32_bf16 v[12:15], a[216:219], v[236:239], v[12:15]
    s_waitcnt lgkmcnt(0)
    v_fmac_f32 v251, s27, v250
    v_fma_f32 v250, v249, 2.0, v252
    v_mfma_f32_16x16x32_bf16 v[16:19], a[220:223], v[236:239], 0
    buffer_load_dwordx4 a[248:251], v254, s[8:11], s42 offen offset:2048 sc1
    v_mfma_f32_16x16x32_bf16 v[16:19], a[208:211], v[232:235], v[16:19]
    s_mov_b32 s42, 116736
    v_fmac_f32 v252, -2.0, v249
    v_fma_f32 v249, v220, s24, v224
    v_mfma_f32_16x16x32_bf16 v[16:19], a[196:199], v[228:231], v[16:19]
    s_mov_b64 exec, s[46:47]
    ds_write_b128 v208, v[204:207] offset:1024
    s_mov_b64 exec, -1
    v_mfma_f32_16x16x32_bf16 v[20:23], a[200:203], v[228:231], 0
    ds_read_b128 v[228:231], v253 offset:4160
    v_fmac_f32 v224, -4.0, v220
    v_fma_f32 v220, v218, s24, v222
    v_mfma_f32_16x16x32_bf16 v[20:23], a[212:215], v[232:235], v[20:23]
    buffer_load_dwordx4 a[252:255], v254, s[8:11], s42 offen offset:0 sc1
    v_mfma_f32_16x16x32_bf16 v[20:23], a[224:227], v[236:239], v[20:23]
    v_fmac_f32 v222, -4.0, v218
    v_fma_f32 v218, v222, s26, v224
    v_mfma_f32_16x16x32_bf16 v[24:27], a[192:195], v[232:235], 0
    v_fmac_f32 v224, s27, v222
    v_fma_f32 v222, v220, 2.0, v249
    v_mfma_f32_16x16x32_bf16 v[24:27], a[204:207], v[236:239], v[24:27]
    s_waitcnt lgkmcnt(0)
    v_fmac_f32 v249, -2.0, v220
    v_cvt_pk_bf16_f32 v218, v248, v218
    v_mfma_f32_16x16x32_bf16 v[24:27], a[216:219], v[228:231], v[24:27]
    v_cvt_pk_bf16_f32 v224, v251, v224
    v_cvt_pk_bf16_f32 v222, v250, v222
    v_mfma_f32_16x16x32_bf16 v[28:31], a[220:223], v[228:231], 0
    buffer_load_dwordx4 v[240:243], v254, s[8:11], s42 offen offset:1024 sc1
    v_mfma_f32_16x16x32_bf16 v[28:31], a[208:211], v[236:239], v[28:31]
    v_cvt_pk_bf16_f32 v220, v252, v249
    v_lshlrev_b32 v248, 16, v219
    v_lshlrev_b32 v249, 16, v221
    v_mfma_f32_16x16x32_bf16 v[28:31], a[196:199], v[232:235], v[28:31]
    v_lshlrev_b32 v250, 16, v223
    v_lshlrev_b32 v251, 16, v225
    v_mfma_f32_16x16x32_bf16 v[32:35], a[200:203], v[232:235], 0
    ds_read_b128 v[232:235], v253 offset:5984
    v_and_b32 v219, s22, v219
    v_mfma_f32_16x16x32_bf16 v[32:35], a[212:215], v[236:239], v[32:35]
    buffer_load_dwordx4 v[244:247], v254, s[8:11], s42 offen offset:2048 sc1
    v_mfma_f32_16x16x32_bf16 v[32:35], a[224:227], v[228:231], v[32:35]
    v_and_b32 v221, s22, v221
    v_and_b32 v223, s22, v223
    v_mfma_f32_16x16x32_bf16 v[36:39], a[192:195], v[236:239], 0
    v_and_b32 v215, 0x7fff, v255
    v_and_b32 v225, s22, v225
    v_mfma_f32_16x16x32_bf16 v[36:39], a[204:207], v[228:231], v[36:39]
    s_waitcnt lgkmcnt(0)
    v_lshlrev_b32 v252, 16, v217
    v_and_b32 v217, s22, v217
    v_mfma_f32_16x16x32_bf16 v[36:39], a[216:219], v[232:235], v[36:39]
    buffer_load_dwordx2 v[204:205], v215, s[4:7], s16 offen offset:128
    v_fmac_f32 v252, s25, v251
    v_mfma_f32_16x16x32_bf16 v[40:43], a[220:223], v[232:235], 0
    v_fmac_f32 v217, s25, v225
    v_fmac_f32 v252, s28, v249
    v_mfma_f32_16x16x32_bf16 v[40:43], a[208:211], v[228:231], v[40:43]
    v_fmac_f32 v217, s28, v221
    v_cvt_pk_bf16_f32 v217, v252, v217
    v_mfma_f32_16x16x32_bf16 v[40:43], a[196:199], v[236:239], v[40:43]
    v_lshlrev_b32 v252, 16, v227
    v_and_b32 v227, s22, v227
    v_mfma_f32_16x16x32_bf16 v[44:47], a[200:203], v[236:239], 0
    ds_read_b128 v[236:239], v253 offset:5728
    v_fmac_f32 v252, s29, v248
    v_mfma_f32_16x16x32_bf16 v[44:47], a[212:215], v[228:231], v[44:47]
    buffer_load_dwordx2 v[206:207], v215, s[4:7], s17 offen offset:128
    v_mfma_f32_16x16x32_bf16 v[44:47], a[224:227], v[232:235], v[44:47]
    v_fmac_f32 v227, s29, v219
    v_fmac_f32 v252, s23, v250
    v_fmac_f32 v227, s23, v223
    v_mfma_f32_16x16x32_bf16 v[48:51], a[192:195], v[228:231], 0
    v_cvt_pk_bf16_f32 v227, v252, v227
    v_fma_f32 v252, v249, s24, v251
    v_mfma_f32_16x16x32_bf16 v[48:51], a[204:207], v[232:235], v[48:51]
    s_waitcnt lgkmcnt(0)
    v_fmac_f32 v251, -4.0, v249
    v_fma_f32 v249, v248, s24, v250
    v_mfma_f32_16x16x32_bf16 v[48:51], a[216:219], v[236:239], v[48:51]
    buffer_load_dwordx2 v[208:209], v215, s[4:7], s18 offen offset:128
    v_mfma_f32_16x16x32_bf16 v[52:55], a[220:223], v[236:239], 0
    v_fmac_f32 v250, -4.0, v248
    v_fma_f32 v248, v250, s26, v251
    v_mfma_f32_16x16x32_bf16 v[52:55], a[208:211], v[232:235], v[52:55]
    v_fmac_f32 v251, s27, v250
    v_fma_f32 v250, v249, 2.0, v252
    v_mfma_f32_16x16x32_bf16 v[52:55], a[196:199], v[228:231], v[52:55]
    v_fmac_f32 v252, -2.0, v249
    v_fma_f32 v249, v221, s24, v225
    v_mfma_f32_16x16x32_bf16 v[56:59], a[200:203], v[228:231], 0
    ds_read_b128 v[228:231], v253 offset:5472
    v_fmac_f32 v225, -4.0, v221
    v_fma_f32 v221, v219, s24, v223
    v_mfma_f32_16x16x32_bf16 v[56:59], a[212:215], v[232:235], v[56:59]
    buffer_load_dwordx2 v[210:211], v215, s[4:7], s19 offen offset:128
    v_mfma_f32_16x16x32_bf16 v[56:59], a[224:227], v[236:239], v[56:59]
    v_fmac_f32 v223, -4.0, v219
    v_fma_f32 v219, v223, s26, v225
    v_mfma_f32_16x16x32_bf16 v[60:63], a[192:195], v[232:235], 0
    v_fmac_f32 v225, s27, v223
    v_fma_f32 v223, v221, 2.0, v249
    v_mfma_f32_16x16x32_bf16 v[60:63], a[204:207], v[236:239], v[60:63]
    s_waitcnt lgkmcnt(0)
    v_fmac_f32 v249, -2.0, v221
    v_cvt_pk_bf16_f32 v219, v248, v219
    v_mfma_f32_16x16x32_bf16 v[60:63], a[216:219], v[228:231], v[60:63]
    buffer_load_dwordx2 v[212:213], v215, s[4:7], s20 offen offset:128
    v_mfma_f32_16x16x32_bf16 v[64:67], a[220:223], v[228:231], 0
    v_cvt_pk_bf16_f32 v225, v251, v225
    v_cvt_pk_bf16_f32 v223, v250, v223
    v_mfma_f32_16x16x32_bf16 v[64:67], a[208:211], v[236:239], v[64:67]
    v_cvt_pk_bf16_f32 v221, v252, v249
    v_lshrrev_b32 v252, 15, v255
    v_mfma_f32_16x16x32_bf16 v[64:67], a[196:199], v[232:235], v[64:67]
    ds_write_b64 v252, v[218:219] offset:8576
    v_mfma_f32_16x16x32_bf16 v[68:71], a[200:203], v[232:235], 0
    ds_read_b128 v[232:235], v253 offset:5216
    v_lshrrev_b32 v218, 15, v255
    v_mfma_f32_16x16x32_bf16 v[68:71], a[212:215], v[236:239], v[68:71]
    buffer_load_dwordx2 v[214:215], v215, s[4:7], s21 offen offset:128
    v_mfma_f32_16x16x32_bf16 v[68:71], a[224:227], v[228:231], v[68:71]
    ds_write_b64 v218, v[224:225] offset:10656
    v_mfma_f32_16x16x32_bf16 v[72:75], a[192:195], v[236:239], 0
    s_waitcnt vmcnt(15)
    v_lshlrev_b32 v248, 16, v194
    v_lshlrev_b32 v249, 16, v196
    v_mfma_f32_16x16x32_bf16 v[72:75], a[204:207], v[228:231], v[72:75]
    s_waitcnt lgkmcnt(1)
    v_lshlrev_b32 v250, 16, v198
    v_lshlrev_b32 v251, 16, v200
    v_and_b32 v194, s22, v194
    v_mfma_f32_16x16x32_bf16 v[72:75], a[216:219], v[232:235], v[72:75]
    ds_write_b64 v218, v[222:223] offset:12736
    v_mfma_f32_16x16x32_bf16 v[76:79], a[220:223], v[232:235], 0
    v_and_b32 v196, s22, v196
    v_and_b32 v198, s22, v198
    v_mfma_f32_16x16x32_bf16 v[76:79], a[208:211], v[228:231], v[76:79]
pad1:
    s_cbranch_vccnz pad5
    ds_write_b64 v218, v[216:217] offset:14816
    v_mfma_f32_16x16x32_bf16 v[76:79], a[196:199], v[236:239], v[76:79]
    v_and_b32 v200, s22, v200
    v_lshlrev_b32 v252, 16, v192
    v_mfma_f32_16x16x32_bf16 v[80:83], a[200:203], v[236:239], 0
    ds_read_b128 v[236:239], v253 offset:4944
    v_and_b32 v192, s22, v192
    v_mfma_f32_16x16x32_bf16 v[80:83], a[212:215], v[228:231], v[80:83]
    ds_write_b64 v218, v[226:227] offset:37696
    v_mfma_f32_16x16x32_bf16 v[80:83], a[224:227], v[232:235], v[80:83]
    s_mov_b32 s42, 147456
    v_fmac_f32 v252, s25, v251
    v_fmac_f32 v192, s25, v200
    v_fmac_f32 v252, s28, v249
    v_mfma_f32_16x16x32_bf16 v[84:87], a[192:195], v[228:231], 0
    ds_write_b64 v218, v[220:221] offset:31456
    v_mfma_f32_16x16x32_bf16 v[88:91], a[196:199], v[228:231], 0
    v_fmac_f32 v192, s28, v196
    v_cvt_pk_bf16_f32 v192, v252, v192
    v_mfma_f32_16x16x32_bf16 v[92:95], a[200:203], v[228:231], 0
    ds_read_b128 v[228:231], v253 offset:7280
    v_lshlrev_b32 v252, 16, v202
    v_mfma_f32_16x16x32_bf16 v[92:95], a[212:215], v[232:235], v[92:95]
    buffer_load_dwordx4 a[192:195], v254, s[8:11], s42 offen offset:0 sc1
    v_mfma_f32_16x16x32_bf16 v[88:91], a[208:211], v[232:235], v[88:91]
    s_waitcnt lgkmcnt(3)
    v_and_b32 v202, s22, v202
    v_fmac_f32 v252, s29, v248
    v_mfma_f32_16x16x32_bf16 v[84:87], a[204:207], v[232:235], v[84:87]
    ds_read_b128 v[232:235], v253 offset:7008
    v_fmac_f32 v202, s29, v194
    v_mfma_f32_16x16x32_bf16 v[84:87], a[216:219], v[236:239], v[84:87]
    buffer_load_dwordx4 a[196:199], v254, s[8:11], s42 offen offset:1024 sc1
    v_fmac_f32 v252, s23, v250
    v_mfma_f32_16x16x32_bf16 v[88:91], a[220:223], v[236:239], v[88:91]
    s_waitcnt vmcnt(14) lgkmcnt(1)
    v_fmac_f32 v202, s23, v198
    v_cvt_pk_bf16_f32 v202, v252, v202
    v_mfma_f32_16x16x32_bf16 v[92:95], a[224:227], v[236:239], v[92:95]
    ds_read_b128 v[236:239], v253 offset:6752
    v_fma_f32 v252, v249, s24, v251
sub3:
    v_mfma_f32_16x16x32_bf16 v[96:99], a[228:231], v[228:231], 0
    buffer_load_dwordx4 a[200:203], v254, s[8:11], s42 offen offset:2048 sc1
    v_mfma_f32_16x16x32_bf16 v[100:103], a[232:235], v[228:231], 0
    s_mov_b32 s42, 150528
    v_fmac_f32 v251, -4.0, v249
    v_fma_f32 v249, v248, s24, v250
    v_mfma_f32_16x16x32_bf16 v[104:107], a[236:239], v[228:231], 0
    ds_read_b128 v[228:231], v253 offset:6496
    s_waitcnt vmcnt(12)
    s_waitcnt lgkmcnt(2)
    v_mfma_f32_16x16x32_bf16 v[104:107], a[248:251], v[232:235], v[104:107]
    v_fmac_f32 v250, -4.0, v248
    v_fma_f32 v248, v250, s26, v251
    v_fmac_f32 v251, s27, v250
    v_mfma_f32_16x16x32_bf16 v[100:103], a[244:247], v[232:235], v[100:103]
    buffer_load_dwordx4 a[204:207], v254, s[8:11], s42 offen offset:0 sc1
    v_mfma_f32_16x16x32_bf16 v[96:99], a[240:243], v[232:235], v[96:99]
    s_waitcnt vmcnt(10) lgkmcnt(1)
    v_fma_f32 v250, v249, 2.0, v252
    v_fmac_f32 v252, -2.0, v249
    v_mfma_f32_16x16x32_bf16 v[96:99], a[252:255], v[236:239], v[96:99]
    v_fma_f32 v249, v196, s24, v200
    v_fmac_f32 v200, -4.0, v196
    v_mfma_f32_16x16x32_bf16 v[100:103], v[240:243], v[236:239], v[100:103]
    v_fma_f32 v196, v194, s24, v198
    v_fmac_f32 v198, -4.0, v194
    v_mfma_f32_16x16x32_bf16 v[104:107], v[244:247], v[236:239], v[104:107]
    buffer_load_dwordx4 a[208:211], v254, s[8:11], s42 offen offset:1024 sc1
    v_mfma_f32_16x16x32_bf16 v[108:111], a[228:231], v[232:235], 0
    v_fma_f32 v194, v198, s26, v200
    v_fmac_f32 v200, s27, v198
    v_mfma_f32_16x16x32_bf16 v[108:111], a[240:243], v[236:239], v[108:111]
    s_waitcnt lgkmcnt(0)
    v_fma_f32 v198, v196, 2.0, v249
    v_fmac_f32 v249, -2.0, v196
    v_cvt_pk_bf16_f32 v194, v248, v194
    v_mfma_f32_16x16x32_bf16 v[108:111], a[252:255], v[228:231], v[108:111]
    v_cvt_pk_bf16_f32 v200, v251, v200
    v_cvt_pk_bf16_f32 v198, v250, v198
    v_mfma_f32_16x16x32_bf16 v[112:115], v[240:243], v[228:231], 0
    buffer_load_dwordx4 a[212:215], v254, s[8:11], s42 offen offset:2048 sc1
    v_mfma_f32_16x16x32_bf16 v[112:115], a[244:247], v[236:239], v[112:115]
    s_mov_b32 s42, 153600
    v_cvt_pk_bf16_f32 v196, v252, v249
    v_lshlrev_b32 v248, 16, v195
    v_mfma_f32_16x16x32_bf16 v[112:115], a[232:235], v[232:235], v[112:115]
    v_lshlrev_b32 v249, 16, v197
    v_lshlrev_b32 v250, 16, v199
    v_mfma_f32_16x16x32_bf16 v[116:119], a[236:239], v[232:235], 0
    ds_read_b128 v[232:235], v253 offset:6240
    v_lshlrev_b32 v251, 16, v201
    v_mfma_f32_16x16x32_bf16 v[116:119], a[248:251], v[236:239], v[116:119]
    buffer_load_dwordx4 a[216:219], v254, s[8:11], s42 offen offset:0 sc1
    v_mfma_f32_16x16x32_bf16 v[116:119], v[244:247], v[228:231], v[116:119]
    v_and_b32 v195, s22, v195
    v_and_b32 v197, s22, v197
    v_and_b32 v199, s22, v199
    v_mfma_f32_16x16x32_bf16 v[120:123], a[228:231], v[236:239], 0
    v_and_b32 v201, s22, v201
    v_lshlrev_b32 v252, 16, v193
    v_mfma_f32_16x16x32_bf16 v[120:123], a[240:243], v[228:231], v[120:123]
    s_waitcnt lgkmcnt(0)
    v_and_b32 v193, s22, v193
    v_fmac_f32 v252, s25, v251
    v_mfma_f32_16x16x32_bf16 v[120:123], a[252:255], v[232:235], v[120:123]
    v_fmac_f32 v193, s25, v201
    v_fmac_f32 v252, s28, v249
    v_mfma_f32_16x16x32_bf16 v[124:127], v[240:243], v[232:235], 0
    buffer_load_dwordx4 a[220:223], v254, s[8:11], s42 offen offset:1024 sc1
    v_mfma_f32_16x16x32_bf16 v[124:127], a[244:247], v[228:231], v[124:127]
    v_fmac_f32 v193, s28, v197
    v_cvt_pk_bf16_f32 v193, v252, v193
    v_mfma_f32_16x16x32_bf16 v[124:127], a[232:235], v[236:239], v[124:127]
    v_lshlrev_b32 v252, 16, v203
    v_and_b32 v203, s22, v203
    v_fmac_f32 v252, s29, v248
    v_mfma_f32_16x16x32_bf16 v[128:131], a[236:239], v[236:239], 0
    ds_read_b128 v[236:239], v253 offset:8064
    v_fmac_f32 v203, s29, v195
    v_mfma_f32_16x16x32_bf16 v[128:131], a[248:251], v[228:231], v[128:131]
    buffer_load_dwordx4 a[224:227], v254, s[8:11], s42 offen offset:2048 sc1
    v_mfma_f32_16x16x32_bf16 v[128:131], v[244:247], v[232:235], v[128:131]
    v_fmac_f32 v252, s23, v250
    v_fmac_f32 v203, s23, v199
    v_mfma_f32_16x16x32_bf16 v[132:135], a[228:231], v[228:231], 0
    v_and_b32 v227, 0x7fff, v255
    v_cvt_pk_bf16_f32 v203, v252, v203
    v_mfma_f32_16x16x32_bf16 v[132:135], a[240:243], v[232:235], v[132:135]
    s_waitcnt lgkmcnt(0)
    v_fma_f32 v252, v249, s24, v251
    v_fmac_f32 v251, -4.0, v249
    v_mfma_f32_16x16x32_bf16 v[132:135], a[252:255], v[236:239], v[132:135]
    buffer_load_dwordx2 v[216:217], v227, s[4:7], s16 offen offset:512
    v_mfma_f32_16x16x32_bf16 v[136:139], v[240:243], v[236:239], 0
    v_fma_f32 v249, v248, s24, v250
    v_fmac_f32 v250, -4.0, v248
    v_fma_f32 v248, v250, s26, v251
    v_mfma_f32_16x16x32_bf16 v[136:139], a[244:247], v[232:235], v[136:139]
    v_fmac_f32 v251, s27, v250
    v_fma_f32 v250, v249, 2.0, v252
    v_mfma_f32_16x16x32_bf16 v[136:139], a[232:235], v[228:231], v[136:139]
    v_fmac_f32 v252, -2.0, v249
    v_fma_f32 v249, v197, s24, v201
    v_mfma_f32_16x16x32_bf16 v[140:143], a[236:239], v[228:231], 0
    ds_read_b128 v[228:231], v253 offset:7808
    v_fmac_f32 v201, -4.0, v197
    v_mfma_f32_16x16x32_bf16 v[140:143], a[248:251], v[232:235], v[140:143]
    buffer_load_dwordx2 v[218:219], v227, s[4:7], s17 offen offset:512
    v_mfma_f32_16x16x32_bf16 v[140:143], v[244:247], v[236:239], v[140:143]
    v_fma_f32 v197, v195, s24, v199
    v_fmac_f32 v199, -4.0, v195
    v_mfma_f32_16x16x32_bf16 v[144:147], a[228:231], v[232:235], 0
    v_fma_f32 v195, v199, s26, v201
    v_fmac_f32 v201, s27, v199
    v_mfma_f32_16x16x32_bf16 v[144:147], a[240:243], v[236:239], v[144:147]
    s_waitcnt lgkmcnt(0)
    v_fma_f32 v199, v197, 2.0, v249
    v_fmac_f32 v249, -2.0, v197
    v_cvt_pk_bf16_f32 v195, v248, v195
    v_mfma_f32_16x16x32_bf16 v[144:147], a[252:255], v[228:231], v[144:147]
    buffer_load_dwordx2 v[220:221], v227, s[4:7], s18 offen offset:512
    v_mfma_f32_16x16x32_bf16 v[148:151], v[240:243], v[228:231], 0
    v_cvt_pk_bf16_f32 v201, v251, v201
    v_cvt_pk_bf16_f32 v199, v250, v199
    v_mfma_f32_16x16x32_bf16 v[148:151], a[244:247], v[236:239], v[148:151]
    v_cvt_pk_bf16_f32 v197, v252, v249
    v_lshrrev_b32 v252, 15, v255
    v_mfma_f32_16x16x32_bf16 v[148:151], a[232:235], v[232:235], v[148:151]
    ds_write_b64 v252, v[194:195] offset:8320
    v_mfma_f32_16x16x32_bf16 v[152:155], a[236:239], v[232:235], 0
    ds_read_b128 v[232:235], v253 offset:7552
    v_lshrrev_b32 v194, 15, v255
    v_mfma_f32_16x16x32_bf16 v[152:155], a[248:251], v[236:239], v[152:155]
    buffer_load_dwordx2 v[222:223], v227, s[4:7], s19 offen offset:512
    v_mfma_f32_16x16x32_bf16 v[152:155], v[244:247], v[228:231], v[152:155]
    ds_write_b64 v194, v[200:201] offset:10400
    v_mfma_f32_16x16x32_bf16 v[156:159], a[228:231], v[236:239], 0
    v_mfma_f32_16x16x32_bf16 v[156:159], a[240:243], v[228:231], v[156:159]
    s_waitcnt lgkmcnt(1)
    s_waitcnt vmcnt(13)
    v_lshlrev_b32 v248, 16, v206
    v_mfma_f32_16x16x32_bf16 v[156:159], a[252:255], v[232:235], v[156:159]
    buffer_load_dwordx2 v[224:225], v227, s[4:7], s20 offen offset:512
    v_mfma_f32_16x16x32_bf16 v[160:163], v[240:243], v[232:235], 0
    ds_write_b64 v194, v[198:199] offset:12480
    v_mfma_f32_16x16x32_bf16 v[160:163], a[244:247], v[228:231], v[160:163]
    v_lshlrev_b32 v249, 16, v208
    v_lshlrev_b32 v250, 16, v210
    v_mfma_f32_16x16x32_bf16 v[160:163], a[232:235], v[236:239], v[160:163]
    ds_write_b64 v194, v[192:193] offset:14560
    v_mfma_f32_16x16x32_bf16 v[164:167], a[236:239], v[236:239], 0
    ds_read_b128 v[236:239], v253 offset:7296
    v_lshlrev_b32 v251, 16, v212
    v_mfma_f32_16x16x32_bf16 v[164:167], a[248:251], v[228:231], v[164:167]
    buffer_load_dwordx2 v[226:227], v227, s[4:7], s21 offen offset:512
    v_mfma_f32_16x16x32_bf16 v[164:167], v[244:247], v[232:235], v[164:167]
    ds_write_b64 v194, v[202:203] offset:37440
    v_mfma_f32_16x16x32_bf16 v[168:171], a[228:231], v[228:231], 0
    v_and_b32 v206, s22, v206
    v_and_b32 v208, s22, v208
    v_mfma_f32_16x16x32_bf16 v[168:171], a[240:243], v[232:235], v[168:171]
    s_waitcnt lgkmcnt(1)
    v_and_b32 v210, s22, v210
    v_and_b32 v212, s22, v212
    v_mfma_f32_16x16x32_bf16 v[168:171], a[252:255], v[236:239], v[168:171]
    ds_write_b64 v194, v[196:197] offset:31200
    v_mfma_f32_16x16x32_bf16 v[172:175], v[240:243], v[236:239], 0
    v_lshlrev_b32 v252, 16, v204
    v_and_b32 v204, s22, v204
    v_mfma_f32_16x16x32_bf16 v[172:175], a[244:247], v[232:235], v[172:175]
    v_fmac_f32 v252, s25, v251
    v_fmac_f32 v204, s25, v212
    v_mfma_f32_16x16x32_bf16 v[172:175], a[232:235], v[228:231], v[172:175]
    v_fmac_f32 v252, s28, v249
    v_fmac_f32 v204, s28, v208
    v_mfma_f32_16x16x32_bf16 v[176:179], a[236:239], v[228:231], 0
    ds_read_b128 v[228:231], v253 offset:7024
    v_cvt_pk_bf16_f32 v204, v252, v204
    v_mfma_f32_16x16x32_bf16 v[176:179], a[248:251], v[232:235], v[176:179]
    v_lshlrev_b32 v252, 16, v214
    v_and_b32 v214, s22, v214
    v_mfma_f32_16x16x32_bf16 v[176:179], v[244:247], v[236:239], v[176:179]
    s_mov_b32 s42, 184320
    v_fmac_f32 v252, s29, v248
    v_fmac_f32 v214, s29, v206
    v_mfma_f32_16x16x32_bf16 v[180:183], a[228:231], v[232:235], 0
    s_waitcnt lgkmcnt(0)
    v_fmac_f32 v252, s23, v250
    v_fmac_f32 v214, s23, v210
    v_cvt_pk_bf16_f32 v214, v252, v214
    v_mfma_f32_16x16x32_bf16 v[184:187], a[232:235], v[232:235], 0
    s_barrier
    v_mfma_f32_16x16x32_bf16 v[188:191], a[236:239], v[232:235], 0
    ds_read_b128 v[232:235], v253 offset:9360
    v_fma_f32 v252, v249, s24, v251
    v_mfma_f32_16x16x32_bf16 v[188:191], a[248:251], v[236:239], v[188:191]
    buffer_load_dwordx4 a[228:231], v254, s[8:11], s42 offen offset:0 sc1
    v_mfma_f32_16x16x32_bf16 v[184:187], a[244:247], v[236:239], v[184:187]
    v_fmac_f32 v251, -4.0, v249
    v_fma_f32 v249, v248, s24, v250
    v_mfma_f32_16x16x32_bf16 v[180:183], a[240:243], v[236:239], v[180:183]
    ds_read_b128 v[236:239], v253 offset:9088
    v_fmac_f32 v250, -4.0, v248
    v_mfma_f32_16x16x32_bf16 v[180:183], a[252:255], v[228:231], v[180:183]
    buffer_load_dwordx4 a[232:235], v254, s[8:11], s42 offen offset:1024 sc1
    v_mfma_f32_16x16x32_bf16 v[184:187], v[240:243], v[228:231], v[184:187]
    s_waitcnt vmcnt(14) lgkmcnt(1)
    v_fma_f32 v248, v250, s26, v251
    v_fmac_f32 v251, s27, v250
    v_mfma_f32_16x16x32_bf16 v[188:191], v[244:247], v[228:231], v[188:191]
    ds_read_b128 v[228:231], v253 offset:8832
    v_fma_f32 v250, v249, 2.0, v252
sub4:
    v_mfma_f32_16x16x32_bf16 a[0:3], a[192:195], v[232:235], a[0:3]
    buffer_load_dwordx4 a[236:239], v254, s[8:11], s42 offen offset:2048 sc1
    v_mfma_f32_16x16x32_bf16 a[4:7], a[196:199], v[232:235], a[4:7]
    s_mov_b32 s42, 187392
    v_fmac_f32 v252, -2.0, v249
    v_fma_f32 v249, v208, s24, v212
    v_mfma_f32_16x16x32_bf16 a[8:11], a[200:203], v[232:235], a[8:11]
    ds_read_b128 v[232:235], v253 offset:8576
    s_waitcnt vmcnt(12)
    s_waitcnt lgkmcnt(2)
    v_mfma_f32_16x16x32_bf16 a[8:11], a[212:215], v[236:239], a[8:11]
    v_fmac_f32 v212, -4.0, v208
    v_fma_f32 v208, v206, s24, v210
    v_mfma_f32_16x16x32_bf16 a[4:7], a[208:211], v[236:239], a[4:7]
    buffer_load_dwordx4 a[240:243], v254, s[8:11], s42 offen offset:0 sc1
    v_mfma_f32_16x16x32_bf16 a[0:3], a[204:207], v[236:239], a[0:3]
    s_waitcnt vmcnt(10) lgkmcnt(1)
    v_fmac_f32 v210, -4.0, v206
    v_fma_f32 v206, v210, s26, v212
    v_mfma_f32_16x16x32_bf16 a[0:3], a[216:219], v[228:231], a[0:3]
    v_fmac_f32 v212, s27, v210
    v_fma_f32 v210, v208, 2.0, v249
    v_mfma_f32_16x16x32_bf16 a[4:7], a[220:223], v[228:231], a[4:7]
    v_fmac_f32 v249, -2.0, v208
    v_cvt_pk_bf16_f32 v206, v248, v206
    v_mfma_f32_16x16x32_bf16 a[8:11], a[224:227], v[228:231], a[8:11]
    buffer_load_dwordx4 a[244:247], v254, s[8:11], s42 offen offset:1024 sc1
    v_mfma_f32_16x16x32_bf16 a[12:15], a[192:195], v[236:239], a[12:15]
    v_cvt_pk_bf16_f32 v212, v251, v212
    v_cvt_pk_bf16_f32 v210, v250, v210
    v_mfma_f32_16x16x32_bf16 a[12:15], a[204:207], v[228:231], a[12:15]
    s_waitcnt lgkmcnt(0)
    v_cvt_pk_bf16_f32 v208, v252, v249
    v_lshlrev_b32 v248, 16, v207
    v_mfma_f32_16x16x32_bf16 a[12:15], a[216:219], v[232:235], a[12:15]
    v_lshlrev_b32 v249, 16, v209
    v_lshlrev_b32 v250, 16, v211
    v_mfma_f32_16x16x32_bf16 a[16:19], a[220:223], v[232:235], a[16:19]
    buffer_load_dwordx4 a[248:251], v254, s[8:11], s42 offen offset:2048 sc1
    v_mfma_f32_16x16x32_bf16 a[16:19], a[208:211], v[228:231], a[16:19]
    s_mov_b32 s42, 190464
    v_lshlrev_b32 v251, 16, v213
    v_and_b32 v207, s22, v207
    v_mfma_f32_16x16x32_bf16 a[16:19], a[196:199], v[236:239], a[16:19]
    v_and_b32 v209, s22, v209
    v_and_b32 v211, s22, v211
    v_mfma_f32_16x16x32_bf16 a[20:23], a[200:203], v[236:239], a[20:23]
    ds_read_b128 v[236:239], v253 offset:8320
    v_and_b32 v213, s22, v213
    v_mfma_f32_16x16x32_bf16 a[20:23], a[212:215], v[228:231], a[20:23]
    buffer_load_dwordx4 a[252:255], v254, s[8:11], s42 offen offset:0 sc1
    v_mfma_f32_16x16x32_bf16 a[20:23], a[224:227], v[232:235], a[20:23]
    v_lshlrev_b32 v252, 16, v205
    v_and_b32 v205, s22, v205
    v_mfma_f32_16x16x32_bf16 a[24:27], a[192:195], v[228:231], a[24:27]
    v_fmac_f32 v252, s25, v251
    v_fmac_f32 v205, s25, v213
    v_mfma_f32_16x16x32_bf16 a[24:27], a[204:207], v[232:235], a[24:27]
    s_waitcnt lgkmcnt(0)
    v_fmac_f32 v252, s28, v249
    v_fmac_f32 v205, s28, v209
    v_mfma_f32_16x16x32_bf16 a[24:27], a[216:219], v[236:239], a[24:27]
    v_cvt_pk_bf16_f32 v205, v252, v205
    v_lshlrev_b32 v252, 16, v215
    v_mfma_f32_16x16x32_bf16 a[28:31], a[220:223], v[236:239], a[28:31]
    buffer_load_dwordx4 v[240:243], v254, s[8:11], s42 offen offset:1024 sc1
    v_mfma_f32_16x16x32_bf16 a[28:31], a[208:211], v[232:235], a[28:31]
    v_and_b32 v215, s22, v215
    v_fmac_f32 v252, s29, v248
    v_mfma_f32_16x16x32_bf16 a[28:31], a[196:199], v[228:231], a[28:31]
    v_fmac_f32 v215, s29, v207
    v_fmac_f32 v252, s23, v250
    v_mfma_f32_16x16x32_bf16 a[32:35], a[200:203], v[228:231], a[32:35]
    ds_read_b128 v[228:231], v253 offset:10144
    v_fmac_f32 v215, s23, v211
    v_mfma_f32_16x16x32_bf16 a[32:35], a[212:215], v[232:235], a[32:35]
    buffer_load_dwordx4 v[244:247], v254, s[8:11], s42 offen offset:2048 sc1
    v_mfma_f32_16x16x32_bf16 a[32:35], a[224:227], v[236:239], a[32:35]
    v_cvt_pk_bf16_f32 v215, v252, v215
    v_fma_f32 v252, v249, s24, v251
    v_mfma_f32_16x16x32_bf16 a[36:39], a[192:195], v[232:235], a[36:39]
    v_and_b32 v203, 0x7fff, v255
    v_fmac_f32 v251, -4.0, v249
    v_mfma_f32_16x16x32_bf16 a[36:39], a[204:207], v[236:239], a[36:39]
    s_waitcnt lgkmcnt(0)
    v_fma_f32 v249, v248, s24, v250
    v_fmac_f32 v250, -4.0, v248
    v_mfma_f32_16x16x32_bf16 a[36:39], a[216:219], v[228:231], a[36:39]
    buffer_load_dwordx2 v[192:193], v203, s[4:7], s16 offen offset:896
    v_mfma_f32_16x16x32_bf16 a[40:43], a[220:223], v[228:231], a[40:43]
    v_fma_f32 v248, v250, s26, v251
    v_fmac_f32 v251, s27, v250
    v_mfma_f32_16x16x32_bf16 a[40:43], a[208:211], v[236:239], a[40:43]
    v_fma_f32 v250, v249, 2.0, v252
    v_fmac_f32 v252, -2.0, v249
    v_fma_f32 v249, v209, s24, v213
    v_mfma_f32_16x16x32_bf16 a[40:43], a[196:199], v[232:235], a[40:43]
    v_fmac_f32 v213, -4.0, v209
    v_fma_f32 v209, v207, s24, v211
    v_mfma_f32_16x16x32_bf16 a[44:47], a[200:203], v[232:235], a[44:47]
    ds_read_b128 v[232:235], v253 offset:9888
    v_fmac_f32 v211, -4.0, v207
    v_mfma_f32_16x16x32_bf16 a[44:47], a[212:215], v[236:239], a[44:47]
    buffer_load_dwordx2 v[194:195], v203, s[4:7], s17 offen offset:896
    v_mfma_f32_16x16x32_bf16 a[44:47], a[224:227], v[228:231], a[44:47]
    v_fma_f32 v207, v211, s26, v213
    v_fmac_f32 v213, s27, v211
    v_mfma_f32_16x16x32_bf16 a[48:51], a[192:195], v[236:239], a[48:51]
    v_fma_f32 v211, v209, 2.0, v249
    v_fmac_f32 v249, -2.0, v209
    v_mfma_f32_16x16x32_bf16 a[48:51], a[204:207], v[228:231], a[48:51]
    s_waitcnt lgkmcnt(0)
    v_cvt_pk_bf16_f32 v207, v248, v207
    v_cvt_pk_bf16_f32 v213, v251, v213
    v_mfma_f32_16x16x32_bf16 a[48:51], a[216:219], v[232:235], a[48:51]
    buffer_load_dwordx2 v[196:197], v203, s[4:7], s18 offen offset:896
    v_mfma_f32_16x16x32_bf16 a[52:55], a[220:223], v[232:235], a[52:55]
    v_cvt_pk_bf16_f32 v211, v250, v211
    v_cvt_pk_bf16_f32 v209, v252, v249
    v_mfma_f32_16x16x32_bf16 a[52:55], a[208:211], v[228:231], a[52:55]
    v_lshrrev_b32 v252, 15, v255
    v_mfma_f32_16x16x32_bf16 a[52:55], a[196:199], v[236:239], a[52:55]
    ds_write_b64 v252, v[206:207] offset:768
    v_mfma_f32_16x16x32_bf16 a[56:59], a[200:203], v[236:239], a[56:59]
    ds_read_b128 v[236:239], v253 offset:9632
    v_lshrrev_b32 v206, 15, v255
    v_mfma_f32_16x16x32_bf16 a[56:59], a[212:215], v[228:231], a[56:59]
    buffer_load_dwordx2 v[198:199], v203, s[4:7], s19 offen offset:896
    v_mfma_f32_16x16x32_bf16 a[56:59], a[224:227], v[232:235], a[56:59]
    ds_write_b64 v206, v[212:213] offset:2848
    v_mfma_f32_16x16x32_bf16 a[60:63], a[192:195], v[228:231], a[60:63]
    v_mfma_f32_16x16x32_bf16 a[60:63], a[204:207], v[232:235], a[60:63]
    s_waitcnt lgkmcnt(1)
    s_waitcnt vmcnt(13)
    v_lshlrev_b32 v248, 16, v218
    v_mfma_f32_16x16x32_bf16 a[60:63], a[216:219], v[236:239], a[60:63]
    buffer_load_dwordx2 v[200:201], v203, s[4:7], s20 offen offset:896
    v_mfma_f32_16x16x32_bf16 a[64:67], a[220:223], v[236:239], a[64:67]
    ds_write_b64 v206, v[210:211] offset:4928
    v_mfma_f32_16x16x32_bf16 a[64:67], a[208:211], v[232:235], a[64:67]
    v_lshlrev_b32 v249, 16, v220
    v_lshlrev_b32 v250, 16, v222
    v_mfma_f32_16x16x32_bf16 a[64:67], a[196:199], v[228:231], a[64:67]
    ds_write_b64 v206, v[204:205] offset:17408
    v_mfma_f32_16x16x32_bf16 a[68:71], a[200:203], v[228:231], a[68:71]
    ds_read_b128 v[228:231], v253 offset:9376
    v_lshlrev_b32 v251, 16, v224
    v_mfma_f32_16x16x32_bf16 a[68:71], a[212:215], v[232:235], a[68:71]
    buffer_load_dwordx2 v[202:203], v203, s[4:7], s21 offen offset:896
    v_mfma_f32_16x16x32_bf16 a[68:71], a[224:227], v[236:239], a[68:71]
    ds_write_b64 v206, v[214:215] offset:25728
    v_mfma_f32_16x16x32_bf16 a[72:75], a[192:195], v[232:235], a[72:75]
    v_and_b32 v218, s22, v218
    v_and_b32 v220, s22, v220
    v_mfma_f32_16x16x32_bf16 a[72:75], a[204:207], v[236:239], a[72:75]
    s_waitcnt lgkmcnt(1)
    v_and_b32 v222, s22, v222
    v_and_b32 v224, s22, v224
    v_mfma_f32_16x16x32_bf16 a[72:75], a[216:219], v[228:231], a[72:75]
    ds_write_b64 v206, v[208:209] offset:7008
    v_mfma_f32_16x16x32_bf16 a[76:79], a[220:223], v[228:231], a[76:79]
    v_lshlrev_b32 v252, 16, v216
    v_and_b32 v216, s22, v216
    v_mfma_f32_16x16x32_bf16 a[76:79], a[208:211], v[236:239], a[76:79]
    v_fmac_f32 v252, s25, v251
    v_fmac_f32 v216, s25, v224
    v_mfma_f32_16x16x32_bf16 a[76:79], a[196:199], v[232:235], a[76:79]
    v_fmac_f32 v252, s28, v249
    v_fmac_f32 v216, s28, v220
    v_mfma_f32_16x16x32_bf16 a[80:83], a[200:203], v[232:235], a[80:83]
    ds_read_b128 v[232:235], v253 offset:9104
    v_cvt_pk_bf16_f32 v216, v252, v216
    v_mfma_f32_16x16x32_bf16 a[80:83], a[212:215], v[236:239], a[80:83]
    v_lshlrev_b32 v252, 16, v226
    v_and_b32 v226, s22, v226
    v_mfma_f32_16x16x32_bf16 a[80:83], a[224:227], v[228:231], a[80:83]
    s_mov_b32 s42, 221184
    v_fmac_f32 v252, s29, v248
    v_fmac_f32 v226, s29, v218
    v_mfma_f32_16x16x32_bf16 a[84:87], a[192:195], v[236:239], a[84:87]
    v_fmac_f32 v252, s23, v250
    v_fmac_f32 v226, s23, v222
    v_mfma_f32_16x16x32_bf16 a[88:91], a[196:199], v[236:239], a[88:91]
    v_cvt_pk_bf16_f32 v226, v252, v226
    v_fma_f32 v252, v249, s24, v251
    v_mfma_f32_16x16x32_bf16 a[92:95], a[200:203], v[236:239], a[92:95]
    ds_read_b128 v[236:239], v253 offset:11440
    v_fmac_f32 v251, -4.0, v249
    v_mfma_f32_16x16x32_bf16 a[92:95], a[212:215], v[228:231], a[92:95]
    buffer_load_dwordx4 a[192:195], v254, s[8:11], s42 offen offset:0 sc1
    v_mfma_f32_16x16x32_bf16 a[88:91], a[208:211], v[228:231], a[88:91]
    s_waitcnt lgkmcnt(1)
    v_fma_f32 v249, v248, s24, v250
    v_fmac_f32 v250, -4.0, v248
    v_mfma_f32_16x16x32_bf16 a[84:87], a[204:207], v[228:231], a[84:87]
    ds_read_b128 v[228:231], v253 offset:11168
    v_fma_f32 v248, v250, s26, v251
    v_mfma_f32_16x16x32_bf16 a[84:87], a[216:219], v[232:235], a[84:87]
    buffer_load_dwordx4 a[196:199], v254, s[8:11], s42 offen offset:1024 sc1
    v_mfma_f32_16x16x32_bf16 a[88:91], a[220:223], v[232:235], a[88:91]
    s_waitcnt vmcnt(14) lgkmcnt(1)
    v_fmac_f32 v251, s27, v250
    v_fma_f32 v250, v249, 2.0, v252
    v_mfma_f32_16x16x32_bf16 a[92:95], a[224:227], v[232:235], a[92:95]
    ds_read_b128 v[232:235], v253 offset:10912
    v_fmac_f32 v252, -2.0, v249
    v_fma_f32 v249, v220, s24, v224
sub5:
    v_mfma_f32_16x16x32_bf16 a[96:99], a[228:231], v[236:239], a[96:99]
    buffer_load_dwordx4 a[200:203], v254, s[8:11], s42 offen offset:2048 sc1
    v_mfma_f32_16x16x32_bf16 a[100:103], a[232:235], v[236:239], a[100:103]
    s_mov_b32 s42, 224256
    v_fmac_f32 v224, -4.0, v220
    v_fma_f32 v220, v218, s24, v222
    v_mfma_f32_16x16x32_bf16 a[104:107], a[236:239], v[236:239], a[104:107]
    ds_read_b128 v[236:239], v253 offset:10656
    s_waitcnt vmcnt(12)
    s_waitcnt lgkmcnt(2)
    v_mfma_f32_16x16x32_bf16 a[104:107], a[248:251], v[228:231], a[104:107]
    v_fmac_f32 v222, -4.0, v218
    v_fma_f32 v218, v222, s26, v224
    v_mfma_f32_16x16x32_bf16 a[100:103], a[244:247], v[228:231], a[100:103]
    buffer_load_dwordx4 a[204:207], v254, s[8:11], s42 offen offset:0 sc1
    v_mfma_f32_16x16x32_bf16 a[96:99], a[240:243], v[228:231], a[96:99]
    s_waitcnt vmcnt(10) lgkmcnt(1)
    v_fmac_f32 v224, s27, v222
    v_fma_f32 v222, v220, 2.0, v249
    v_mfma_f32_16x16x32_bf16 a[96:99], a[252:255], v[232:235], a[96:99]
    v_fmac_f32 v249, -2.0, v220
    v_cvt_pk_bf16_f32 v218, v248, v218
    v_mfma_f32_16x16x32_bf16 a[100:103], v[240:243], v[232:235], a[100:103]
    v_cvt_pk_bf16_f32 v224, v251, v224
    v_cvt_pk_bf16_f32 v222, v250, v222
    v_mfma_f32_16x16x32_bf16 a[104:107], v[244:247], v[232:235], a[104:107]
    buffer_load_dwordx4 a[208:211], v254, s[8:11], s42 offen offset:1024 sc1
    v_mfma_f32_16x16x32_bf16 a[108:111], a[228:231], v[228:231], a[108:111]
    v_cvt_pk_bf16_f32 v220, v252, v249
    v_lshlrev_b32 v248, 16, v219
    v_mfma_f32_16x16x32_bf16 a[108:111], a[240:243], v[232:235], a[108:111]
    s_waitcnt lgkmcnt(0)
    v_lshlrev_b32 v249, 16, v221
    v_lshlrev_b32 v250, 16, v223
    v_mfma_f32_16x16x32_bf16 a[108:111], a[252:255], v[236:239], a[108:111]
    v_lshlrev_b32 v251, 16, v225
    v_and_b32 v219, s22, v219
    v_mfma_f32_16x16x32_bf16 a[112:115], v[240:243], v[236:239], a[112:115]
    buffer_load_dwordx4 a[212:215], v254, s[8:11], s42 offen offset:2048 sc1
    v_mfma_f32_16x16x32_bf16 a[112:115], a[244:247], v[232:235], a[112:115]
    s_mov_b32 s42, 227328
    v_and_b32 v221, s22, v221
    v_and_b32 v223, s22, v223
    v_mfma_f32_16x16x32_bf16 a[112:115], a[232:235], v[228:231], a[112:115]
    v_and_b32 v225, s22, v225
    v_lshlrev_b32 v252, 16, v217
    v_mfma_f32_16x16x32_bf16 a[116:119], a[236:239], v[228:231], a[116:119]
    ds_read_b128 v[228:231], v253 offset:10400
    v_and_b32 v217, s22, v217
    v_mfma_f32_16x16x32_bf16 a[116:119], a[248:251], v[232:235], a[116:119]
    buffer_load_dwordx4 a[216:219], v254, s[8:11], s42 offen offset:0 sc1
    v_mfma_f32_16x16x32_bf16 a[116:119], v[244:247], v[236:239], a[116:119]
    v_fmac_f32 v252, s25, v251
    v_fmac_f32 v217, s25, v225
    v_mfma_f32_16x16x32_bf16 a[120:123], a[228:231], v[232:235], a[120:123]
    v_fmac_f32 v252, s28, v249
    v_fmac_f32 v217, s28, v221
    v_mfma_f32_16x16x32_bf16 a[120:123], a[240:243], v[236:239], a[120:123]
    s_waitcnt lgkmcnt(0)
    v_cvt_pk_bf16_f32 v217, v252, v217
    v_lshlrev_b32 v252, 16, v227
    v_mfma_f32_16x16x32_bf16 a[120:123], a[252:255], v[228:231], a[120:123]
    v_and_b32 v227, s22, v227
    v_fmac_f32 v252, s29, v248
    v_mfma_f32_16x16x32_bf16 a[124:127], v[240:243], v[228:231], a[124:127]
    buffer_load_dwordx4 a[220:223], v254, s[8:11], s42 offen offset:1024 sc1
    v_mfma_f32_16x16x32_bf16 a[124:127], a[244:247], v[236:239], a[124:127]
    v_fmac_f32 v227, s29, v219
    v_fmac_f32 v252, s23, v250
    v_mfma_f32_16x16x32_bf16 a[124:127], a[232:235], v[232:235], a[124:127]
    v_fmac_f32 v227, s23, v223
    v_cvt_pk_bf16_f32 v227, v252, v227
    v_mfma_f32_16x16x32_bf16 a[128:131], a[236:239], v[232:235], a[128:131]
    ds_read_b128 v[232:235], v253 offset:12224
    v_fma_f32 v252, v249, s24, v251
    v_mfma_f32_16x16x32_bf16 a[128:131], a[248:251], v[236:239], a[128:131]
    buffer_load_dwordx4 a[224:227], v254, s[8:11], s42 offen offset:2048 sc1
    v_mfma_f32_16x16x32_bf16 a[128:131], v[244:247], v[228:231], a[128:131]
    v_fmac_f32 v251, -4.0, v249
    v_fma_f32 v249, v248, s24, v250
    v_mfma_f32_16x16x32_bf16 a[132:135], a[228:231], v[236:239], a[132:135]
    v_and_b32 v215, 0x7fff, v255
    v_fmac_f32 v250, -4.0, v248
    v_mfma_f32_16x16x32_bf16 a[132:135], a[240:243], v[228:231], a[132:135]
    s_waitcnt lgkmcnt(0)
    v_fma_f32 v248, v250, s26, v251
    v_fmac_f32 v251, s27, v250
    v_mfma_f32_16x16x32_bf16 a[132:135], a[252:255], v[232:235], a[132:135]
    buffer_load_dwordx2 v[204:205], v215, s[4:7], s16 offen offset:1280
    v_mfma_f32_16x16x32_bf16 a[136:139], v[240:243], v[232:235], a[136:139]
    v_fma_f32 v250, v249, 2.0, v252
    v_fmac_f32 v252, -2.0, v249
    v_mfma_f32_16x16x32_bf16 a[136:139], a[244:247], v[228:231], a[136:139]
    v_fma_f32 v249, v221, s24, v225
    v_fmac_f32 v225, -4.0, v221
    v_mfma_f32_16x16x32_bf16 a[136:139], a[232:235], v[236:239], a[136:139]
    v_fma_f32 v221, v219, s24, v223
    v_fmac_f32 v223, -4.0, v219
    v_mfma_f32_16x16x32_bf16 a[140:143], a[236:239], v[236:239], a[140:143]
    ds_read_b128 v[236:239], v253 offset:11968
    v_fma_f32 v219, v223, s26, v225
    v_mfma_f32_16x16x32_bf16 a[140:143], a[248:251], v[228:231], a[140:143]
    buffer_load_dwordx2 v[206:207], v215, s[4:7], s17 offen offset:1280
    v_mfma_f32_16x16x32_bf16 a[140:143], v[244:247], v[232:235], a[140:143]
    v_fmac_f32 v225, s27, v223
    v_fma_f32 v223, v221, 2.0, v249
    v_mfma_f32_16x16x32_bf16 a[144:147], a[228:231], v[228:231], a[144:147]
    v_fmac_f32 v249, -2.0, v221
    v_cvt_pk_bf16_f32 v219, v248, v219
    v_mfma_f32_16x16x32_bf16 a[144:147], a[240:243], v[232:235], a[144:147]
    s_waitcnt lgkmcnt(0)
    v_cvt_pk_bf16_f32 v225, v251, v225
    v_cvt_pk_bf16_f32 v223, v250, v223
    v_mfma_f32_16x16x32_bf16 a[144:147], a[252:255], v[236:239], a[144:147]
    buffer_load_dwordx2 v[208:209], v215, s[4:7], s18 offen offset:1280
    v_mfma_f32_16x16x32_bf16 a[148:151], v[240:243], v[236:239], a[148:151]
    v_cvt_pk_bf16_f32 v221, v252, v249
    v_lshrrev_b32 v252, 15, v255
    v_mfma_f32_16x16x32_bf16 a[148:151], a[244:247], v[232:235], a[148:151]
    ds_write_b64 v252, v[218:219] offset:512
    v_mfma_f32_16x16x32_bf16 a[148:151], a[232:235], v[228:231], a[148:151]
    v_lshrrev_b32 v218, 15, v255
    v_mfma_f32_16x16x32_bf16 a[152:155], a[236:239], v[228:231], a[152:155]
    ds_read_b128 v[228:231], v253 offset:11712
    v_mfma_f32_16x16x32_bf16 a[152:155], a[248:251], v[232:235], a[152:155]
    buffer_load_dwordx2 v[210:211], v215, s[4:7], s19 offen offset:1280
    v_mfma_f32_16x16x32_bf16 a[152:155], v[244:247], v[236:239], a[152:155]
    ds_write_b64 v218, v[224:225] offset:2592
    v_mfma_f32_16x16x32_bf16 a[156:159], a[228:231], v[232:235], a[156:159]
    v_mfma_f32_16x16x32_bf16 a[156:159], a[240:243], v[236:239], a[156:159]
    s_waitcnt lgkmcnt(1)
    s_waitcnt vmcnt(13)
    v_lshlrev_b32 v248, 16, v194
    v_mfma_f32_16x16x32_bf16 a[156:159], a[252:255], v[228:231], a[156:159]
    buffer_load_dwordx2 v[212:213], v215, s[4:7], s20 offen offset:1280
    v_mfma_f32_16x16x32_bf16 a[160:163], v[240:243], v[228:231], a[160:163]
    ds_write_b64 v218, v[222:223] offset:4672
    v_mfma_f32_16x16x32_bf16 a[160:163], a[244:247], v[236:239], a[160:163]
    v_lshlrev_b32 v249, 16, v196
    v_lshlrev_b32 v250, 16, v198
    v_mfma_f32_16x16x32_bf16 a[160:163], a[232:235], v[232:235], a[160:163]
    ds_write_b64 v218, v[216:217] offset:17152
    v_mfma_f32_16x16x32_bf16 a[164:167], a[236:239], v[232:235], a[164:167]
    ds_read_b128 v[232:235], v253 offset:11456
    v_lshlrev_b32 v251, 16, v200
    v_mfma_f32_16x16x32_bf16 a[164:167], a[248:251], v[236:239], a[164:167]
    buffer_load_dwordx2 v[214:215], v215, s[4:7], s21 offen offset:1280
    v_mfma_f32_16x16x32_bf16 a[164:167], v[244:247], v[228:231], a[164:167]
    ds_write_b64 v218, v[226:227] offset:25472
    v_mfma_f32_16x16x32_bf16 a[168:171], a[228:231], v[236:239], a[168:171]
    v_and_b32 v194, s22, v194
    v_and_b32 v196, s22, v196
    v_mfma_f32_16x16x32_bf16 a[168:171], a[240:243], v[228:231], a[168:171]
    s_waitcnt lgkmcnt(1)
    v_and_b32 v198, s22, v198
    v_and_b32 v200, s22, v200
    v_mfma_f32_16x16x32_bf16 a[168:171], a[252:255], v[232:235], a[168:171]
pad2:
    s_cbranch_vccnz pad6
    ds_write_b64 v218, v[220:221] offset:6752
    v_mfma_f32_16x16x32_bf16 a[172:175], v[240:243], v[232:235], a[172:175]
    ds_read_b128 v[216:219], v253 offset:39904
    s_mov_b32 s45, 405865480
    v_mfma_f32_16x16x32_bf16 a[172:175], a[244:247], v[228:231], a[172:175]
    v_bfe_u32 v220, v254, 5, 3
    v_mul_u32_u24 v221, 5, v220
    v_mfma_f32_16x16x32_bf16 a[172:175], a[232:235], v[236:239], a[172:175]
    v_bfe_u32 v221, s45, v221, 5
    v_mul_u32_u24 v221, 65, v221
    v_mfma_f32_16x16x32_bf16 a[176:179], a[236:239], v[236:239], a[176:179]
    ds_read_b128 v[236:239], v253 offset:11184
    v_sub_u32 v221, v221, v220
    v_mfma_f32_16x16x32_bf16 a[176:179], a[248:251], v[228:231], a[176:179]
    v_lshl_add_u32 v220, v221, 5, v253
    s_waitcnt lgkmcnt(1)
    v_mfma_f32_16x16x32_bf16 a[176:179], v[244:247], v[232:235], a[176:179]
    s_mov_b32 s42, 258048
    v_lshlrev_b32 v252, 16, v192
    v_and_b32 v192, s22, v192
    v_mfma_f32_16x16x32_bf16 a[180:183], a[228:231], v[228:231], a[180:183]
    s_mov_b64 exec, s[46:47]
    ds_write_b128 v220, v[216:219] offset:1024
    s_mov_b64 exec, -1
    v_mfma_f32_16x16x32_bf16 a[184:187], a[232:235], v[228:231], a[184:187]
    v_fmac_f32 v252, s25, v251
    v_fmac_f32 v192, s25, v200
    v_mfma_f32_16x16x32_bf16 a[188:191], a[236:239], v[228:231], a[188:191]
    ds_read_b128 v[228:231], v253 offset:13520
    v_fmac_f32 v252, s28, v249
    v_mfma_f32_16x16x32_bf16 a[188:191], a[248:251], v[232:235], a[188:191]
    buffer_load_dwordx4 a[228:231], v254, s[8:11], s42 offen offset:0 sc1
    v_mfma_f32_16x16x32_bf16 a[184:187], a[244:247], v[232:235], a[184:187]
    s_waitcnt lgkmcnt(2)
    v_fmac_f32 v192, s28, v196
    v_cvt_pk_bf16_f32 v192, v252, v192
    v_mfma_f32_16x16x32_bf16 a[180:183], a[240:243], v[232:235], a[180:183]
    ds_read_b128 v[232:235], v253 offset:13248
    v_lshlrev_b32 v252, 16, v202
    v_mfma_f32_16x16x32_bf16 a[180:183], a[252:255], v[236:239], a[180:183]
    buffer_load_dwordx4 a[232:235], v254, s[8:11], s42 offen offset:1024 sc1
    v_mfma_f32_16x16x32_bf16 a[184:187], v[240:243], v[236:239], a[184:187]
    s_waitcnt vmcnt(14) lgkmcnt(1)
    v_and_b32 v202, s22, v202
    v_fmac_f32 v252, s29, v248
    v_mfma_f32_16x16x32_bf16 a[188:191], v[244:247], v[236:239], a[188:191]
    ds_read_b128 v[236:239], v253 offset:12992
    v_fmac_f32 v202, s29, v194
sub6:
    v_mfma_f32_16x16x32_bf16 v[0:3], a[192:195], v[228:231], v[0:3]
    buffer_load_dwordx4 a[236:239], v254, s[8:11], s42 offen offset:2048 sc1
    v_mfma_f32_16x16x32_bf16 v[4:7], a[196:199], v[228:231], v[4:7]
    s_mov_b32 s42, 261120
    v_fmac_f32 v252, s23, v250
    v_fmac_f32 v202, s23, v198
    v_mfma_f32_16x16x32_bf16 v[8:11], a[200:203], v[228:231], v[8:11]
    ds_read_b128 v[228:231], v253 offset:12736
    s_waitcnt vmcnt(12)
    s_waitcnt lgkmcnt(2)
    v_mfma_f32_16x16x32_bf16 v[8:11], a[212:215], v[232:235], v[8:11]
    v_cvt_pk_bf16_f32 v202, v252, v202
    v_fma_f32 v252, v249, s24, v251
    v_mfma_f32_16x16x32_bf16 v[4:7], a[208:211], v[232:235], v[4:7]
    buffer_load_dwordx4 a[240:243], v254, s[8:11], s42 offen offset:0 sc1
    v_mfma_f32_16x16x32_bf16 v[0:3], a[204:207], v[232:235], v[0:3]
    s_waitcnt vmcnt(10) lgkmcnt(1)
    v_fmac_f32 v251, -4.0, v249
    v_fma_f32 v249, v248, s24, v250
    v_mfma_f32_16x16x32_bf16 v[0:3], a[216:219], v[236:239], v[0:3]
    v_fmac_f32 v250, -4.0, v248
    v_fma_f32 v248, v250, s26, v251
    v_mfma_f32_16x16x32_bf16 v[4:7], a[220:223], v[236:239], v[4:7]
    v_fmac_f32 v251, s27, v250
    v_fma_f32 v250, v249, 2.0, v252
    v_fmac_f32 v252, -2.0, v249
    v_mfma_f32_16x16x32_bf16 v[8:11], a[224:227], v[236:239], v[8:11]
    buffer_load_dwordx4 a[244:247], v254, s[8:11], s42 offen offset:1024 sc1
    v_mfma_f32_16x16x32_bf16 v[12:15], a[192:195], v[232:235], v[12:15]
    v_fma_f32 v249, v196, s24, v200
    v_fmac_f32 v200, -4.0, v196
    v_mfma_f32_16x16x32_bf16 v[12:15], a[204:207], v[236:239], v[12:15]
    s_waitcnt lgkmcnt(0)
    v_fma_f32 v196, v194, s24, v198
    v_fmac_f32 v198, -4.0, v194
    v_mfma_f32_16x16x32_bf16 v[12:15], a[216:219], v[228:231], v[12:15]
    v_fma_f32 v194, v198, s26, v200
    v_fmac_f32 v200, s27, v198
    v_mfma_f32_16x16x32_bf16 v[16:19], a[220:223], v[228:231], v[16:19]
    buffer_load_dwordx4 a[248:251], v254, s[8:11], s42 offen offset:2048 sc1
    v_mfma_f32_16x16x32_bf16 v[16:19], a[208:211], v[236:239], v[16:19]
    s_mov_b32 s42, 264192
    v_fma_f32 v198, v196, 2.0, v249
    v_fmac_f32 v249, -2.0, v196
    v_mfma_f32_16x16x32_bf16 v[16:19], a[196:199], v[232:235], v[16:19]
    v_cvt_pk_bf16_f32 v194, v248, v194
    v_cvt_pk_bf16_f32 v200, v251, v200
    v_mfma_f32_16x16x32_bf16 v[20:23], a[200:203], v[232:235], v[20:23]
    ds_read_b128 v[232:235], v253 offset:12480
    v_cvt_pk_bf16_f32 v198, v250, v198
    v_mfma_f32_16x16x32_bf16 v[20:23], a[212:215], v[236:239], v[20:23]
    buffer_load_dwordx4 a[252:255], v254, s[8:11], s42 offen offset:0 sc1
    v_mfma_f32_16x16x32_bf16 v[20:23], a[224:227], v[228:231], v[20:23]
    v_cvt_pk_bf16_f32 v196, v252, v249
    v_lshlrev_b32 v248, 16, v195
    v_mfma_f32_16x16x32_bf16 v[24:27], a[192:195], v[236:239], v[24:27]
    v_lshlrev_b32 v249, 16, v197
    v_lshlrev_b32 v250, 16, v199
    v_mfma_f32_16x16x32_bf16 v[24:27], a[204:207], v[228:231], v[24:27]
    s_waitcnt lgkmcnt(0)
    v_lshlrev_b32 v251, 16, v201
    v_and_b32 v195, s22, v195
    v_mfma_f32_16x16x32_bf16 v[24:27], a[216:219], v[232:235], v[24:27]
    v_and_b32 v197, s22, v197
    v_and_b32 v199, s22, v199
    v_mfma_f32_16x16x32_bf16 v[28:31], a[220:223], v[232:235], v[28:31]
    buffer_load_dwordx4 v[240:243], v254, s[8:11], s42 offen offset:1024 sc1
    v_mfma_f32_16x16x32_bf16 v[28:31], a[208:211], v[228:231], v[28:31]
    v_and_b32 v201, s22, v201
    v_lshlrev_b32 v252, 16, v193
    v_mfma_f32_16x16x32_bf16 v[28:31], a[196:199], v[236:239], v[28:31]
    v_and_b32 v193, s22, v193
    v_fmac_f32 v252, s25, v251
    v_mfma_f32_16x16x32_bf16 v[32:35], a[200:203], v[236:239], v[32:35]
    ds_read_b128 v[236:239], v253 offset:14304
    v_fmac_f32 v193, s25, v201
    v_mfma_f32_16x16x32_bf16 v[32:35], a[212:215], v[228:231], v[32:35]
    buffer_load_dwordx4 v[244:247], v254, s[8:11], s42 offen offset:2048 sc1
    v_mfma_f32_16x16x32_bf16 v[32:35], a[224:227], v[232:235], v[32:35]
    v_fmac_f32 v252, s28, v249
    v_fmac_f32 v193, s28, v197
    v_mfma_f32_16x16x32_bf16 v[36:39], a[192:195], v[228:231], v[36:39]
    v_and_b32 v227, 0x7fff, v255
    v_cvt_pk_bf16_f32 v193, v252, v193
    v_mfma_f32_16x16x32_bf16 v[36:39], a[204:207], v[232:235], v[36:39]
    s_waitcnt lgkmcnt(0)
    v_lshlrev_b32 v252, 16, v203
    v_and_b32 v203, s22, v203
    v_mfma_f32_16x16x32_bf16 v[36:39], a[216:219], v[236:239], v[36:39]
    buffer_load_dwordx2 v[216:217], v227, s[4:7], s16 offen offset:192
    v_mfma_f32_16x16x32_bf16 v[40:43], a[220:223], v[236:239], v[40:43]
    v_fmac_f32 v252, s29, v248
    v_fmac_f32 v203, s29, v195
    v_mfma_f32_16x16x32_bf16 v[40:43], a[208:211], v[232:235], v[40:43]
    v_fmac_f32 v252, s23, v250
    v_fmac_f32 v203, s23, v199
    v_mfma_f32_16x16x32_bf16 v[40:43], a[196:199], v[228:231], v[40:43]
    v_cvt_pk_bf16_f32 v203, v252, v203
    v_fma_f32 v252, v249, s24, v251
    v_mfma_f32_16x16x32_bf16 v[44:47], a[200:203], v[228:231], v[44:47]
    ds_read_b128 v[228:231], v253 offset:14048
    v_fmac_f32 v251, -4.0, v249
    v_mfma_f32_16x16x32_bf16 v[44:47], a[212:215], v[232:235], v[44:47]
    buffer_load_dwordx2 v[218:219], v227, s[4:7], s17 offen offset:192
    v_mfma_f32_16x16x32_bf16 v[44:47], a[224:227], v[236:239], v[44:47]
    v_fma_f32 v249, v248, s24, v250
    v_fmac_f32 v250, -4.0, v248
    v_mfma_f32_16x16x32_bf16 v[48:51], a[192:195], v[232:235], v[48:51]
    v_fma_f32 v248, v250, s26, v251
    v_fmac_f32 v251, s27, v250
    v_mfma_f32_16x16x32_bf16 v[48:51], a[204:207], v[236:239], v[48:51]
    s_waitcnt lgkmcnt(0)
    v_fma_f32 v250, v249, 2.0, v252
    v_fmac_f32 v252, -2.0, v249
    v_mfma_f32_16x16x32_bf16 v[48:51], a[216:219], v[228:231], v[48:51]
    buffer_load_dwordx2 v[220:221], v227, s[4:7], s18 offen offset:192
    v_mfma_f32_16x16x32_bf16 v[52:55], a[220:223], v[228:231], v[52:55]
    v_fma_f32 v249, v197, s24, v201
    v_fmac_f32 v201, -4.0, v197
    v_mfma_f32_16x16x32_bf16 v[52:55], a[208:211], v[236:239], v[52:55]
    v_fma_f32 v197, v195, s24, v199
    v_fmac_f32 v199, -4.0, v195
    v_mfma_f32_16x16x32_bf16 v[52:55], a[196:199], v[232:235], v[52:55]
    v_fma_f32 v195, v199, s26, v201
    v_fmac_f32 v201, s27, v199
    v_mfma_f32_16x16x32_bf16 v[56:59], a[200:203], v[232:235], v[56:59]
    ds_read_b128 v[232:235], v253 offset:13792
    v_fma_f32 v199, v197, 2.0, v249
    v_mfma_f32_16x16x32_bf16 v[56:59], a[212:215], v[236:239], v[56:59]
    buffer_load_dwordx2 v[222:223], v227, s[4:7], s19 offen offset:192
    v_mfma_f32_16x16x32_bf16 v[56:59], a[224:227], v[228:231], v[56:59]
    v_fmac_f32 v249, -2.0, v197
    v_cvt_pk_bf16_f32 v195, v248, v195
    v_mfma_f32_16x16x32_bf16 v[60:63], a[192:195], v[236:239], v[60:63]
    v_cvt_pk_bf16_f32 v201, v251, v201
    v_cvt_pk_bf16_f32 v199, v250, v199
    v_mfma_f32_16x16x32_bf16 v[60:63], a[204:207], v[228:231], v[60:63]
    s_waitcnt lgkmcnt(0)
    v_cvt_pk_bf16_f32 v197, v252, v249
    v_lshrrev_b32 v252, 15, v255
    v_mfma_f32_16x16x32_bf16 v[60:63], a[216:219], v[232:235], v[60:63]
    buffer_load_dwordx2 v[224:225], v227, s[4:7], s20 offen offset:192
    v_mfma_f32_16x16x32_bf16 v[64:67], a[220:223], v[232:235], v[64:67]
    ds_write_b64 v252, v[194:195] offset:256
    v_mfma_f32_16x16x32_bf16 v[64:67], a[208:211], v[228:231], v[64:67]
    s_waitcnt vmcnt(14)
    v_lshrrev_b32 v194, 15, v255
    v_lshlrev_b32 v248, 16, v206
    v_mfma_f32_16x16x32_bf16 v[64:67], a[196:199], v[236:239], v[64:67]
    ds_write_b64 v194, v[200:201] offset:2336
    v_mfma_f32_16x16x32_bf16 v[68:71], a[200:203], v[236:239], v[68:71]
    ds_read_b128 v[236:239], v253 offset:13536
    v_lshlrev_b32 v249, 16, v208
    v_mfma_f32_16x16x32_bf16 v[68:71], a[212:215], v[228:231], v[68:71]
    buffer_load_dwordx2 v[226:227], v227, s[4:7], s21 offen offset:192
    v_mfma_f32_16x16x32_bf16 v[68:71], a[224:227], v[232:235], v[68:71]
    ds_write_b64 v194, v[198:199] offset:4416
    v_mfma_f32_16x16x32_bf16 v[72:75], a[192:195], v[228:231], v[72:75]
    v_lshlrev_b32 v250, 16, v210
    v_lshlrev_b32 v251, 16, v212
    v_mfma_f32_16x16x32_bf16 v[72:75], a[204:207], v[232:235], v[72:75]
    s_waitcnt lgkmcnt(1)
    v_and_b32 v206, s22, v206
    v_and_b32 v208, s22, v208
    v_mfma_f32_16x16x32_bf16 v[72:75], a[216:219], v[236:239], v[72:75]
    ds_write_b64 v194, v[192:193] offset:16896
    v_mfma_f32_16x16x32_bf16 v[76:79], a[220:223], v[236:239], v[76:79]
    v_and_b32 v210, s22, v210
    v_and_b32 v212, s22, v212
    v_mfma_f32_16x16x32_bf16 v[76:79], a[208:211], v[232:235], v[76:79]
    ds_write_b64 v194, v[202:203] offset:25216
    v_mfma_f32_16x16x32_bf16 v[76:79], a[196:199], v[228:231], v[76:79]
    v_lshlrev_b32 v252, 16, v204
    v_and_b32 v204, s22, v204
    v_mfma_f32_16x16x32_bf16 v[80:83], a[200:203], v[228:231], v[80:83]
    ds_read_b128 v[228:231], v253 offset:13264
    v_fmac_f32 v252, s25, v251
    v_mfma_f32_16x16x32_bf16 v[80:83], a[212:215], v[232:235], v[80:83]
    ds_write_b64 v194, v[196:197] offset:6496
    v_mfma_f32_16x16x32_bf16 v[80:83], a[224:227], v[236:239], v[80:83]
    s_mov_b32 s42, 294912
    v_fmac_f32 v204, s25, v212
    v_fmac_f32 v252, s28, v249
    v_mfma_f32_16x16x32_bf16 v[84:87], a[192:195], v[232:235], v[84:87]
    v_fmac_f32 v204, s28, v208
    v_cvt_pk_bf16_f32 v204, v252, v204
    v_mfma_f32_16x16x32_bf16 v[88:91], a[196:199], v[232:235], v[88:91]
    v_lshlrev_b32 v252, 16, v214
    v_and_b32 v214, s22, v214
    v_mfma_f32_16x16x32_bf16 v[92:95], a[200:203], v[232:235], v[92:95]
    ds_read_b128 v[232:235], v253 offset:32240
    v_fmac_f32 v252, s29, v248
    v_mfma_f32_16x16x32_bf16 v[92:95], a[212:215], v[236:239], v[92:95]
    buffer_load_dwordx4 a[192:195], v254, s[8:11], s42 offen offset:0 sc1
    v_mfma_f32_16x16x32_bf16 v[88:91], a[208:211], v[236:239], v[88:91]
    s_waitcnt lgkmcnt(2)
    v_fmac_f32 v214, s29, v206
    v_fmac_f32 v252, s23, v250
    v_mfma_f32_16x16x32_bf16 v[84:87], a[204:207], v[236:239], v[84:87]
    ds_read_b128 v[236:239], v253 offset:31968
    v_fmac_f32 v214, s23, v210
    v_mfma_f32_16x16x32_bf16 v[84:87], a[216:219], v[228:231], v[84:87]
    buffer_load_dwordx4 a[196:199], v254, s[8:11], s42 offen offset:1024 sc1
    v_mfma_f32_16x16x32_bf16 v[88:91], a[220:223], v[228:231], v[88:91]
    s_waitcnt vmcnt(14) lgkmcnt(1)
    v_cvt_pk_bf16_f32 v214, v252, v214
    v_fma_f32 v252, v249, s24, v251
    v_mfma_f32_16x16x32_bf16 v[92:95], a[224:227], v[228:231], v[92:95]
    ds_read_b128 v[228:231], v253 offset:31712
    v_fmac_f32 v251, -4.0, v249
sub7:
    v_mfma_f32_16x16x32_bf16 v[96:99], a[228:231], v[232:235], v[96:99]
    buffer_load_dwordx4 a[200:203], v254, s[8:11], s42 offen offset:2048 sc1
    v_mfma_f32_16x16x32_bf16 v[100:103], a[232:235], v[232:235], v[100:103]
    s_mov_b32 s42, 297984
    v_fma_f32 v249, v248, s24, v250
    v_fmac_f32 v250, -4.0, v248
    v_mfma_f32_16x16x32_bf16 v[104:107], a[236:239], v[232:235], v[104:107]
    ds_read_b128 v[232:235], v253 offset:31456
    s_waitcnt vmcnt(12)
    s_waitcnt lgkmcnt(2)
    v_mfma_f32_16x16x32_bf16 v[104:107], a[248:251], v[236:239], v[104:107]
    v_fma_f32 v248, v250, s26, v251
    v_fmac_f32 v251, s27, v250
    v_mfma_f32_16x16x32_bf16 v[100:103], a[244:247], v[236:239], v[100:103]
    buffer_load_dwordx4 a[204:207], v254, s[8:11], s42 offen offset:0 sc1
    v_mfma_f32_16x16x32_bf16 v[96:99], a[240:243], v[236:239], v[96:99]
    s_waitcnt vmcnt(10) lgkmcnt(1)
    v_fma_f32 v250, v249, 2.0, v252
    v_fmac_f32 v252, -2.0, v249
    v_mfma_f32_16x16x32_bf16 v[96:99], a[252:255], v[228:231], v[96:99]
    v_fma_f32 v249, v208, s24, v212
    v_fmac_f32 v212, -4.0, v208
    v_mfma_f32_16x16x32_bf16 v[100:103], v[240:243], v[228:231], v[100:103]
    v_fma_f32 v208, v206, s24, v210
    v_fmac_f32 v210, -4.0, v206
    v_mfma_f32_16x16x32_bf16 v[104:107], v[244:247], v[228:231], v[104:107]
    buffer_load_dwordx4 a[208:211], v254, s[8:11], s42 offen offset:1024 sc1
    v_mfma_f32_16x16x32_bf16 v[108:111], a[228:231], v[236:239], v[108:111]
    v_fma_f32 v206, v210, s26, v212
    v_fmac_f32 v212, s27, v210
    v_mfma_f32_16x16x32_bf16 v[108:111], a[240:243], v[228:231], v[108:111]
    s_waitcnt lgkmcnt(0)
    v_fma_f32 v210, v208, 2.0, v249
    v_fmac_f32 v249, -2.0, v208
    v_mfma_f32_16x16x32_bf16 v[108:111], a[252:255], v[232:235], v[108:111]
    v_cvt_pk_bf16_f32 v206, v248, v206
    v_cvt_pk_bf16_f32 v212, v251, v212
    v_mfma_f32_16x16x32_bf16 v[112:115], v[240:243], v[232:235], v[112:115]
    buffer_load_dwordx4 a[212:215], v254, s[8:11], s42 offen offset:2048 sc1
    v_mfma_f32_16x16x32_bf16 v[112:115], a[244:247], v[228:231], v[112:115]
    s_mov_b32 s42, 301056
    v_cvt_pk_bf16_f32 v210, v250, v210
    v_cvt_pk_bf16_f32 v208, v252, v249
    v_mfma_f32_16x16x32_bf16 v[112:115], a[232:235], v[236:239], v[112:115]
    v_lshlrev_b32 v248, 16, v207
    v_lshlrev_b32 v249, 16, v209
    v_mfma_f32_16x16x32_bf16 v[116:119], a[236:239], v[236:239], v[116:119]
    ds_read_b128 v[236:239], v253 offset:31200
    v_lshlrev_b32 v250, 16, v211
    v_lshlrev_b32 v251, 16, v213
    v_mfma_f32_16x16x32_bf16 v[116:119], a[248:251], v[228:231], v[116:119]
    buffer_load_dwordx4 a[216:219], v254, s[8:11], s42 offen offset:0 sc1
    v_mfma_f32_16x16x32_bf16 v[116:119], v[244:247], v[232:235], v[116:119]
    v_and_b32 v207, s22, v207
    v_and_b32 v209, s22, v209
    v_mfma_f32_16x16x32_bf16 v[120:123], a[228:231], v[228:231], v[120:123]
    v_and_b32 v211, s22, v211
    v_and_b32 v213, s22, v213
    v_mfma_f32_16x16x32_bf16 v[120:123], a[240:243], v[232:235], v[120:123]
    s_waitcnt lgkmcnt(0)
    v_lshlrev_b32 v252, 16, v205
    v_and_b32 v205, s22, v205
    v_mfma_f32_16x16x32_bf16 v[120:123], a[252:255], v[236:239], v[120:123]
    v_fmac_f32 v252, s25, v251
    v_fmac_f32 v205, s25, v213
    v_mfma_f32_16x16x32_bf16 v[124:127], v[240:243], v[236:239], v[124:127]
    buffer_load_dwordx4 a[220:223], v254, s[8:11], s42 offen offset:1024 sc1
    v_mfma_f32_16x16x32_bf16 v[124:127], a[244:247], v[232:235], v[124:127]
    v_fmac_f32 v252, s28, v249
    v_fmac_f32 v205, s28, v209
    v_mfma_f32_16x16x32_bf16 v[124:127], a[232:235], v[228:231], v[124:127]
    v_cvt_pk_bf16_f32 v205, v252, v205
    v_lshlrev_b32 v252, 16, v215
    v_mfma_f32_16x16x32_bf16 v[128:131], a[236:239], v[228:231], v[128:131]
    ds_read_b128 v[228:231], v253 offset:33024
    v_and_b32 v215, s22, v215
    v_mfma_f32_16x16x32_bf16 v[128:131], a[248:251], v[232:235], v[128:131]
    buffer_load_dwordx4 a[224:227], v254, s[8:11], s42 offen offset:2048 sc1
    v_mfma_f32_16x16x32_bf16 v[128:131], v[244:247], v[236:239], v[128:131]
    v_fmac_f32 v252, s29, v248
    v_fmac_f32 v215, s29, v207
    v_mfma_f32_16x16x32_bf16 v[132:135], a[228:231], v[232:235], v[132:135]
    v_and_b32 v203, 0x7fff, v255
    v_fmac_f32 v252, s23, v250
    v_mfma_f32_16x16x32_bf16 v[132:135], a[240:243], v[236:239], v[132:135]
    s_waitcnt lgkmcnt(0)
    v_fmac_f32 v215, s23, v211
    v_cvt_pk_bf16_f32 v215, v252, v215
    v_mfma_f32_16x16x32_bf16 v[132:135], a[252:255], v[228:231], v[132:135]
    buffer_load_dwordx2 v[192:193], v203, s[4:7], s16 offen offset:576
    v_mfma_f32_16x16x32_bf16 v[136:139], v[240:243], v[228:231], v[136:139]
    v_fma_f32 v252, v249, s24, v251
    v_fmac_f32 v251, -4.0, v249
    v_mfma_f32_16x16x32_bf16 v[136:139], a[244:247], v[236:239], v[136:139]
    v_fma_f32 v249, v248, s24, v250
    v_fmac_f32 v250, -4.0, v248
    v_mfma_f32_16x16x32_bf16 v[136:139], a[232:235], v[232:235], v[136:139]
    v_fma_f32 v248, v250, s26, v251
    v_fmac_f32 v251, s27, v250
    v_mfma_f32_16x16x32_bf16 v[140:143], a[236:239], v[232:235], v[140:143]
    ds_read_b128 v[232:235], v253 offset:32768
    v_fma_f32 v250, v249, 2.0, v252
    v_mfma_f32_16x16x32_bf16 v[140:143], a[248:251], v[236:239], v[140:143]
    buffer_load_dwordx2 v[194:195], v203, s[4:7], s17 offen offset:576
    v_mfma_f32_16x16x32_bf16 v[140:143], v[244:247], v[228:231], v[140:143]
    v_fmac_f32 v252, -2.0, v249
    v_fma_f32 v249, v209, s24, v213
    v_mfma_f32_16x16x32_bf16 v[144:147], a[228:231], v[236:239], v[144:147]
    v_fmac_f32 v213, -4.0, v209
    v_fma_f32 v209, v207, s24, v211
    v_mfma_f32_16x16x32_bf16 v[144:147], a[240:243], v[228:231], v[144:147]
    s_waitcnt lgkmcnt(0)
    v_fmac_f32 v211, -4.0, v207
    v_fma_f32 v207, v211, s26, v213
    v_mfma_f32_16x16x32_bf16 v[144:147], a[252:255], v[232:235], v[144:147]
    buffer_load_dwordx2 v[196:197], v203, s[4:7], s18 offen offset:576
    v_mfma_f32_16x16x32_bf16 v[148:151], v[240:243], v[232:235], v[148:151]
    v_fmac_f32 v213, s27, v211
    v_fma_f32 v211, v209, 2.0, v249
    v_mfma_f32_16x16x32_bf16 v[148:151], a[244:247], v[228:231], v[148:151]
    v_fmac_f32 v249, -2.0, v209
    v_cvt_pk_bf16_f32 v207, v248, v207
    v_mfma_f32_16x16x32_bf16 v[148:151], a[232:235], v[236:239], v[148:151]
    v_cvt_pk_bf16_f32 v213, v251, v213
    v_cvt_pk_bf16_f32 v211, v250, v211
    v_mfma_f32_16x16x32_bf16 v[152:155], a[236:239], v[236:239], v[152:155]
    ds_read_b128 v[236:239], v253 offset:32512
    v_cvt_pk_bf16_f32 v209, v252, v249
    v_mfma_f32_16x16x32_bf16 v[152:155], a[248:251], v[228:231], v[152:155]
    buffer_load_dwordx2 v[198:199], v203, s[4:7], s19 offen offset:576
    v_mfma_f32_16x16x32_bf16 v[152:155], v[244:247], v[232:235], v[152:155]
    v_lshrrev_b32 v252, 15, v255
    v_mfma_f32_16x16x32_bf16 v[156:159], a[228:231], v[228:231], v[156:159]
    ds_write_b64 v252, v[206:207] offset:0
    v_mfma_f32_16x16x32_bf16 v[156:159], a[240:243], v[232:235], v[156:159]
    s_waitcnt lgkmcnt(1)
    v_lshrrev_b32 v206, 15, v255
    s_waitcnt vmcnt(13)
    v_mfma_f32_16x16x32_bf16 v[156:159], a[252:255], v[236:239], v[156:159]
    buffer_load_dwordx2 v[200:201], v203, s[4:7], s20 offen offset:576
    v_mfma_f32_16x16x32_bf16 v[160:163], v[240:243], v[236:239], v[160:163]
    ds_write_b64 v206, v[212:213] offset:2080
    v_mfma_f32_16x16x32_bf16 v[160:163], a[244:247], v[232:235], v[160:163]
    v_lshlrev_b32 v248, 16, v218
    v_lshlrev_b32 v249, 16, v220
    v_mfma_f32_16x16x32_bf16 v[160:163], a[232:235], v[228:231], v[160:163]
    ds_write_b64 v206, v[210:211] offset:4160
    v_mfma_f32_16x16x32_bf16 v[164:167], a[236:239], v[228:231], v[164:167]
    ds_read_b128 v[228:231], v253 offset:32256
    v_lshlrev_b32 v250, 16, v222
    v_mfma_f32_16x16x32_bf16 v[164:167], a[248:251], v[232:235], v[164:167]
    buffer_load_dwordx2 v[202:203], v203, s[4:7], s21 offen offset:576
    v_mfma_f32_16x16x32_bf16 v[164:167], v[244:247], v[236:239], v[164:167]
    ds_write_b64 v206, v[204:205] offset:16640
    v_mfma_f32_16x16x32_bf16 v[168:171], a[228:231], v[232:235], v[168:171]
    v_lshlrev_b32 v251, 16, v224
    v_and_b32 v218, s22, v218
    v_mfma_f32_16x16x32_bf16 v[168:171], a[240:243], v[236:239], v[168:171]
    s_waitcnt lgkmcnt(1)
    v_and_b32 v220, s22, v220
    v_and_b32 v222, s22, v222
    v_and_b32 v224, s22, v224
    v_mfma_f32_16x16x32_bf16 v[168:171], a[252:255], v[228:231], v[168:171]
    ds_write_b64 v206, v[214:215] offset:24960
    v_mfma_f32_16x16x32_bf16 v[172:175], v[240:243], v[228:231], v[172:175]
    v_lshlrev_b32 v252, 16, v216
    v_and_b32 v216, s22, v216
    v_mfma_f32_16x16x32_bf16 v[172:175], a[244:247], v[236:239], v[172:175]
    ds_write_b64 v206, v[208:209] offset:6240
    v_mfma_f32_16x16x32_bf16 v[172:175], a[232:235], v[232:235], v[172:175]
    v_fmac_f32 v252, s25, v251
    v_fmac_f32 v216, s25, v224
    v_mfma_f32_16x16x32_bf16 v[176:179], a[236:239], v[232:235], v[176:179]
    ds_read_b128 v[232:235], v253 offset:31984
    v_fmac_f32 v252, s28, v249
    v_mfma_f32_16x16x32_bf16 v[176:179], a[248:251], v[236:239], v[176:179]
    v_fmac_f32 v216, s28, v220
    v_cvt_pk_bf16_f32 v216, v252, v216
    v_mfma_f32_16x16x32_bf16 v[176:179], v[244:247], v[228:231], v[176:179]
    s_mov_b32 s42, 331776
    v_lshlrev_b32 v252, 16, v226
    v_and_b32 v226, s22, v226
    v_mfma_f32_16x16x32_bf16 v[180:183], a[228:231], v[236:239], v[180:183]
    s_waitcnt lgkmcnt(0)
    v_fmac_f32 v252, s29, v248
    v_fmac_f32 v226, s29, v218
    v_mfma_f32_16x16x32_bf16 v[184:187], a[232:235], v[236:239], v[184:187]
    s_barrier
    v_mfma_f32_16x16x32_bf16 v[188:191], a[236:239], v[236:239], v[188:191]
    ds_read_b128 v[236:239], v253 offset:1040
    v_fmac_f32 v252, s23, v250
    v_mfma_f32_16x16x32_bf16 v[188:191], a[248:251], v[228:231], v[188:191]
    buffer_load_dwordx4 a[228:231], v254, s[8:11], s42 offen offset:0 sc1
    v_mfma_f32_16x16x32_bf16 v[184:187], a[244:247], v[228:231], v[184:187]
    v_fmac_f32 v226, s23, v222
    v_cvt_pk_bf16_f32 v226, v252, v226
    v_mfma_f32_16x16x32_bf16 v[180:183], a[240:243], v[228:231], v[180:183]
    ds_read_b128 v[228:231], v253 offset:768
    v_fma_f32 v252, v249, s24, v251
    v_mfma_f32_16x16x32_bf16 v[180:183], a[252:255], v[232:235], v[180:183]
    buffer_load_dwordx4 a[232:235], v254, s[8:11], s42 offen offset:1024 sc1
    v_mfma_f32_16x16x32_bf16 v[184:187], v[240:243], v[232:235], v[184:187]
    s_waitcnt vmcnt(14) lgkmcnt(1)
    v_fmac_f32 v251, -4.0, v249
    v_fma_f32 v249, v248, s24, v250
    v_mfma_f32_16x16x32_bf16 v[188:191], v[244:247], v[232:235], v[188:191]
    ds_read_b128 v[232:235], v253 offset:512
    v_fmac_f32 v250, -4.0, v248
sub8:
    v_mfma_f32_16x16x32_bf16 a[0:3], a[192:195], v[236:239], a[0:3]
    buffer_load_dwordx4 a[236:239], v254, s[8:11], s42 offen offset:2048 sc1
    v_mfma_f32_16x16x32_bf16 a[4:7], a[196:199], v[236:239], a[4:7]
    s_mov_b32 s42, 334848
    v_fma_f32 v248, v250, s26, v251
    v_fmac_f32 v251, s27, v250
    v_mfma_f32_16x16x32_bf16 a[8:11], a[200:203], v[236:239], a[8:11]
    ds_read_b128 v[236:239], v253 offset:256
    s_waitcnt vmcnt(12)
    s_waitcnt lgkmcnt(2)
    v_mfma_f32_16x16x32_bf16 a[8:11], a[212:215], v[228:231], a[8:11]
    v_fma_f32 v250, v249, 2.0, v252
    v_fmac_f32 v252, -2.0, v249
    v_mfma_f32_16x16x32_bf16 a[4:7], a[208:211], v[228:231], a[4:7]
    buffer_load_dwordx4 a[240:243], v254, s[8:11], s42 offen offset:0 sc1
    v_mfma_f32_16x16x32_bf16 a[0:3], a[204:207], v[228:231], a[0:3]
    s_waitcnt vmcnt(10) lgkmcnt(1)
    v_fma_f32 v249, v220, s24, v224
    v_fmac_f32 v224, -4.0, v220
    v_mfma_f32_16x16x32_bf16 a[0:3], a[216:219], v[232:235], a[0:3]
    v_fma_f32 v220, v218, s24, v222
    v_fmac_f32 v222, -4.0, v218
    v_mfma_f32_16x16x32_bf16 a[4:7], a[220:223], v[232:235], a[4:7]
    v_fma_f32 v218, v222, s26, v224
    v_fmac_f32 v224, s27, v222
    v_mfma_f32_16x16x32_bf16 a[8:11], a[224:227], v[232:235], a[8:11]
    buffer_load_dwordx4 a[244:247], v254, s[8:11], s42 offen offset:1024 sc1
    v_mfma_f32_16x16x32_bf16 a[12:15], a[192:195], v[228:231], a[12:15]
    v_fma_f32 v222, v220, 2.0, v249
    v_fmac_f32 v249, -2.0, v220
    v_mfma_f32_16x16x32_bf16 a[12:15], a[204:207], v[232:235], a[12:15]
    s_waitcnt lgkmcnt(0)
    v_cvt_pk_bf16_f32 v218, v248, v218
    v_cvt_pk_bf16_f32 v224, v251, v224
    v_mfma_f32_16x16x32_bf16 a[12:15], a[216:219], v[236:239], a[12:15]
    v_cvt_pk_bf16_f32 v222, v250, v222
    v_cvt_pk_bf16_f32 v220, v252, v249
    v_mfma_f32_16x16x32_bf16 a[16:19], a[220:223], v[236:239], a[16:19]
    buffer_load_dwordx4 a[248:251], v254, s[8:11], s42 offen offset:2048 sc1
    v_mfma_f32_16x16x32_bf16 a[16:19], a[208:211], v[232:235], a[16:19]
    s_mov_b32 s42, 337920
    v_lshlrev_b32 v248, 16, v219
    v_lshlrev_b32 v249, 16, v221
    v_mfma_f32_16x16x32_bf16 a[16:19], a[196:199], v[228:231], a[16:19]
    v_lshlrev_b32 v250, 16, v223
    v_lshlrev_b32 v251, 16, v225
    v_mfma_f32_16x16x32_bf16 a[20:23], a[200:203], v[228:231], a[20:23]
    ds_read_b128 v[228:231], v253 offset:0
    v_and_b32 v219, s22, v219
    v_mfma_f32_16x16x32_bf16 a[20:23], a[212:215], v[232:235], a[20:23]
    buffer_load_dwordx4 a[252:255], v254, s[8:11], s42 offen offset:0 sc1
    v_mfma_f32_16x16x32_bf16 a[20:23], a[224:227], v[236:239], a[20:23]
    v_and_b32 v221, s22, v221
    v_and_b32 v223, s22, v223
    v_mfma_f32_16x16x32_bf16 a[24:27], a[192:195], v[232:235], a[24:27]
    v_and_b32 v225, s22, v225
    v_lshlrev_b32 v252, 16, v217
    v_mfma_f32_16x16x32_bf16 a[24:27], a[204:207], v[236:239], a[24:27]
    s_waitcnt lgkmcnt(0)
    v_and_b32 v217, s22, v217
    v_fmac_f32 v252, s25, v251
    v_mfma_f32_16x16x32_bf16 a[24:27], a[216:219], v[228:231], a[24:27]
    v_fmac_f32 v217, s25, v225
    v_fmac_f32 v252, s28, v249
    v_mfma_f32_16x16x32_bf16 a[28:31], a[220:223], v[228:231], a[28:31]
    buffer_load_dwordx4 v[240:243], v254, s[8:11], s42 offen offset:1024 sc1
    v_mfma_f32_16x16x32_bf16 a[28:31], a[208:211], v[236:239], a[28:31]
    v_fmac_f32 v217, s28, v221
    v_cvt_pk_bf16_f32 v217, v252, v217
    v_mfma_f32_16x16x32_bf16 a[28:31], a[196:199], v[232:235], a[28:31]
    v_lshlrev_b32 v252, 16, v227
    v_and_b32 v227, s22, v227
    v_fmac_f32 v252, s29, v248
    v_mfma_f32_16x16x32_bf16 a[32:35], a[200:203], v[232:235], a[32:35]
    ds_read_b128 v[232:235], v253 offset:1824
    v_fmac_f32 v227, s29, v219
    v_mfma_f32_16x16x32_bf16 a[32:35], a[212:215], v[236:239], a[32:35]
    buffer_load_dwordx4 v[244:247], v254, s[8:11], s42 offen offset:2048 sc1
    v_mfma_f32_16x16x32_bf16 a[32:35], a[224:227], v[228:231], a[32:35]
    v_fmac_f32 v252, s23, v250
    v_fmac_f32 v227, s23, v223
    v_mfma_f32_16x16x32_bf16 a[36:39], a[192:195], v[236:239], a[36:39]
    v_and_b32 v215, 0x7fff, v255
    v_cvt_pk_bf16_f32 v227, v252, v227
    v_mfma_f32_16x16x32_bf16 a[36:39], a[204:207], v[228:231], a[36:39]
    s_waitcnt lgkmcnt(0)
    v_fma_f32 v252, v249, s24, v251
    v_fmac_f32 v251, -4.0, v249
    v_mfma_f32_16x16x32_bf16 a[36:39], a[216:219], v[232:235], a[36:39]
    buffer_load_dwordx2 v[204:205], v215, s[4:7], s16 offen offset:960
    v_mfma_f32_16x16x32_bf16 a[40:43], a[220:223], v[232:235], a[40:43]
    v_fma_f32 v249, v248, s24, v250
    v_fmac_f32 v250, -4.0, v248
    v_mfma_f32_16x16x32_bf16 a[40:43], a[208:211], v[228:231], a[40:43]
    v_fma_f32 v248, v250, s26, v251
    v_fmac_f32 v251, s27, v250
    v_mfma_f32_16x16x32_bf16 a[40:43], a[196:199], v[236:239], a[40:43]
    v_fma_f32 v250, v249, 2.0, v252
    v_fmac_f32 v252, -2.0, v249
    v_mfma_f32_16x16x32_bf16 a[44:47], a[200:203], v[236:239], a[44:47]
    ds_read_b128 v[236:239], v253 offset:1568
    v_fma_f32 v249, v221, s24, v225
    v_mfma_f32_16x16x32_bf16 a[44:47], a[212:215], v[228:231], a[44:47]
    buffer_load_dwordx2 v[206:207], v215, s[4:7], s17 offen offset:960
    v_mfma_f32_16x16x32_bf16 a[44:47], a[224:227], v[232:235], a[44:47]
    v_fmac_f32 v225, -4.0, v221
    v_fma_f32 v221, v219, s24, v223
    v_mfma_f32_16x16x32_bf16 a[48:51], a[192:195], v[228:231], a[48:51]
    v_fmac_f32 v223, -4.0, v219
    v_fma_f32 v219, v223, s26, v225
    v_mfma_f32_16x16x32_bf16 a[48:51], a[204:207], v[232:235], a[48:51]
    s_waitcnt lgkmcnt(0)
    v_fmac_f32 v225, s27, v223
    v_fma_f32 v223, v221, 2.0, v249
    v_mfma_f32_16x16x32_bf16 a[48:51], a[216:219], v[236:239], a[48:51]
    buffer_load_dwordx2 v[208:209], v215, s[4:7], s18 offen offset:960
    v_mfma_f32_16x16x32_bf16 a[52:55], a[220:223], v[236:239], a[52:55]
    v_fmac_f32 v249, -2.0, v221
    v_cvt_pk_bf16_f32 v219, v248, v219
    v_mfma_f32_16x16x32_bf16 a[52:55], a[208:211], v[232:235], a[52:55]
    v_cvt_pk_bf16_f32 v225, v251, v225
    v_cvt_pk_bf16_f32 v223, v250, v223
    v_mfma_f32_16x16x32_bf16 a[52:55], a[196:199], v[228:231], a[52:55]
    v_cvt_pk_bf16_f32 v221, v252, v249
    v_lshrrev_b32 v252, 15, v255
    v_mfma_f32_16x16x32_bf16 a[56:59], a[200:203], v[228:231], a[56:59]
    ds_read_b128 v[228:231], v253 offset:1312
    v_mfma_f32_16x16x32_bf16 a[56:59], a[212:215], v[232:235], a[56:59]
    buffer_load_dwordx2 v[210:211], v215, s[4:7], s19 offen offset:960
    v_mfma_f32_16x16x32_bf16 a[56:59], a[224:227], v[236:239], a[56:59]
    ds_write_b64 v252, v[218:219] offset:9088
    v_mfma_f32_16x16x32_bf16 a[60:63], a[192:195], v[232:235], a[60:63]
    v_lshrrev_b32 v218, 15, v255
    v_mfma_f32_16x16x32_bf16 a[60:63], a[204:207], v[236:239], a[60:63]
    s_waitcnt lgkmcnt(1)
    s_waitcnt vmcnt(13)
    v_lshlrev_b32 v248, 16, v194
    v_mfma_f32_16x16x32_bf16 a[60:63], a[216:219], v[228:231], a[60:63]
    buffer_load_dwordx2 v[212:213], v215, s[4:7], s20 offen offset:960
    v_mfma_f32_16x16x32_bf16 a[64:67], a[220:223], v[228:231], a[64:67]
    ds_write_b64 v218, v[224:225] offset:11168
    v_mfma_f32_16x16x32_bf16 a[64:67], a[208:211], v[236:239], a[64:67]
    v_lshlrev_b32 v249, 16, v196
    v_lshlrev_b32 v250, 16, v198
    v_mfma_f32_16x16x32_bf16 a[64:67], a[196:199], v[232:235], a[64:67]
    ds_write_b64 v218, v[222:223] offset:13248
    v_mfma_f32_16x16x32_bf16 a[68:71], a[200:203], v[232:235], a[68:71]
    ds_read_b128 v[232:235], v253 offset:1056
    v_lshlrev_b32 v251, 16, v200
    v_mfma_f32_16x16x32_bf16 a[68:71], a[212:215], v[236:239], a[68:71]
    buffer_load_dwordx2 v[214:215], v215, s[4:7], s21 offen offset:960
    v_mfma_f32_16x16x32_bf16 a[68:71], a[224:227], v[228:231], a[68:71]
pad3:
    s_cbranch_vccnz pad7
    ds_write_b64 v218, v[216:217] offset:19488
    v_mfma_f32_16x16x32_bf16 a[72:75], a[192:195], v[236:239], a[72:75]
    v_and_b32 v194, s22, v194
    v_and_b32 v196, s22, v196
    v_mfma_f32_16x16x32_bf16 a[72:75], a[204:207], v[228:231], a[72:75]
    s_waitcnt lgkmcnt(1)
    v_and_b32 v198, s22, v198
    v_and_b32 v200, s22, v200
    v_mfma_f32_16x16x32_bf16 a[72:75], a[216:219], v[232:235], a[72:75]
    ds_write_b64 v218, v[226:227] offset:27808
    v_mfma_f32_16x16x32_bf16 a[76:79], a[220:223], v[232:235], a[76:79]
    v_lshlrev_b32 v252, 16, v192
    v_and_b32 v192, s22, v192
    v_mfma_f32_16x16x32_bf16 a[76:79], a[208:211], v[228:231], a[76:79]
    ds_write_b64 v218, v[220:221] offset:31968
    v_mfma_f32_16x16x32_bf16 a[76:79], a[196:199], v[236:239], a[76:79]
    v_fmac_f32 v252, s25, v251
    v_fmac_f32 v192, s25, v200
    v_mfma_f32_16x16x32_bf16 a[80:83], a[200:203], v[236:239], a[80:83]
    ds_read_b128 v[236:239], v253 offset:784
    v_fmac_f32 v252, s28, v249
    v_mfma_f32_16x16x32_bf16 a[80:83], a[212:215], v[228:231], a[80:83]
    v_fmac_f32 v192, s28, v196
    v_cvt_pk_bf16_f32 v192, v252, v192
    v_mfma_f32_16x16x32_bf16 a[80:83], a[224:227], v[232:235], a[80:83]
    s_mov_b32 s42, 368640
    v_lshlrev_b32 v252, 16, v202
    v_and_b32 v202, s22, v202
    v_mfma_f32_16x16x32_bf16 a[84:87], a[192:195], v[228:231], a[84:87]
    v_fmac_f32 v252, s29, v248
    v_fmac_f32 v202, s29, v194
    v_fmac_f32 v252, s23, v250
    v_mfma_f32_16x16x32_bf16 a[88:91], a[196:199], v[228:231], a[88:91]
    v_fmac_f32 v202, s23, v198
    v_cvt_pk_bf16_f32 v202, v252, v202
    v_mfma_f32_16x16x32_bf16 a[92:95], a[200:203], v[228:231], a[92:95]
    ds_read_b128 v[228:231], v253 offset:3120
    v_fma_f32 v252, v249, s24, v251
    v_mfma_f32_16x16x32_bf16 a[92:95], a[212:215], v[232:235], a[92:95]
    buffer_load_dwordx4 a[192:195], v254, s[8:11], s42 offen offset:0 sc1
    v_mfma_f32_16x16x32_bf16 a[88:91], a[208:211], v[232:235], a[88:91]
    s_waitcnt lgkmcnt(1)
    v_fmac_f32 v251, -4.0, v249
    v_fma_f32 v249, v248, s24, v250
    v_mfma_f32_16x16x32_bf16 a[84:87], a[204:207], v[232:235], a[84:87]
    ds_read_b128 v[232:235], v253 offset:2848
    v_fmac_f32 v250, -4.0, v248
    v_mfma_f32_16x16x32_bf16 a[84:87], a[216:219], v[236:239], a[84:87]
    buffer_load_dwordx4 a[196:199], v254, s[8:11], s42 offen offset:1024 sc1
    v_mfma_f32_16x16x32_bf16 a[88:91], a[220:223], v[236:239], a[88:91]
    s_waitcnt vmcnt(14) lgkmcnt(1)
    v_fma_f32 v248, v250, s26, v251
    v_fmac_f32 v251, s27, v250
    v_mfma_f32_16x16x32_bf16 a[92:95], a[224:227], v[236:239], a[92:95]
    ds_read_b128 v[236:239], v253 offset:2592
    v_fma_f32 v250, v249, 2.0, v252
sub9:
    v_mfma_f32_16x16x32_bf16 a[96:99], a[228:231], v[228:231], a[96:99]
    buffer_load_dwordx4 a[200:203], v254, s[8:11], s42 offen offset:2048 sc1
    v_mfma_f32_16x16x32_bf16 a[100:103], a[232:235], v[228:231], a[100:103]
    s_mov_b32 s42, 371712
    v_fmac_f32 v252, -2.0, v249
    v_fma_f32 v249, v196, s24, v200
    v_mfma_f32_16x16x32_bf16 a[104:107], a[236:239], v[228:231], a[104:107]
    ds_read_b128 v[228:231], v253 offset:2336
    s_waitcnt vmcnt(12)
    s_waitcnt lgkmcnt(2)
    v_mfma_f32_16x16x32_bf16 a[104:107], a[248:251], v[232:235], a[104:107]
    v_fmac_f32 v200, -4.0, v196
    v_fma_f32 v196, v194, s24, v198
    v_mfma_f32_16x16x32_bf16 a[100:103], a[244:247], v[232:235], a[100:103]
    buffer_load_dwordx4 a[204:207], v254, s[8:11], s42 offen offset:0 sc1
    v_mfma_f32_16x16x32_bf16 a[96:99], a[240:243], v[232:235], a[96:99]
    s_waitcnt vmcnt(10) lgkmcnt(1)
    v_fmac_f32 v198, -4.0, v194
    v_fma_f32 v194, v198, s26, v200
    v_mfma_f32_16x16x32_bf16 a[96:99], a[252:255], v[236:239], a[96:99]
    v_fmac_f32 v200, s27, v198
    v_fma_f32 v198, v196, 2.0, v249
    v_mfma_f32_16x16x32_bf16 a[100:103], v[240:243], v[236:239], a[100:103]
    v_fmac_f32 v249, -2.0, v196
    v_cvt_pk_bf16_f32 v194, v248, v194
    v_mfma_f32_16x16x32_bf16 a[104:107], v[244:247], v[236:239], a[104:107]
    buffer_load_dwordx4 a[208:211], v254, s[8:11], s42 offen offset:1024 sc1
    v_mfma_f32_16x16x32_bf16 a[108:111], a[228:231], v[232:235], a[108:111]
    v_cvt_pk_bf16_f32 v200, v251, v200
    v_cvt_pk_bf16_f32 v198, v250, v198
    v_mfma_f32_16x16x32_bf16 a[108:111], a[240:243], v[236:239], a[108:111]
    s_waitcnt lgkmcnt(0)
    v_cvt_pk_bf16_f32 v196, v252, v249
    v_lshlrev_b32 v248, 16, v195
    v_mfma_f32_16x16x32_bf16 a[108:111], a[252:255], v[228:231], a[108:111]
    v_lshlrev_b32 v249, 16, v197
    v_lshlrev_b32 v250, 16, v199
    v_mfma_f32_16x16x32_bf16 a[112:115], v[240:243], v[228:231], a[112:115]
    buffer_load_dwordx4 a[212:215], v254, s[8:11], s42 offen offset:2048 sc1
    v_mfma_f32_16x16x32_bf16 a[112:115], a[244:247], v[236:239], a[112:115]
    s_mov_b32 s42, 374784
    v_lshlrev_b32 v251, 16, v201
    v_and_b32 v195, s22, v195
    v_mfma_f32_16x16x32_bf16 a[112:115], a[232:235], v[232:235], a[112:115]
    v_and_b32 v197, s22, v197
    v_and_b32 v199, s22, v199
    v_mfma_f32_16x16x32_bf16 a[116:119], a[236:239], v[232:235], a[116:119]
    ds_read_b128 v[232:235], v253 offset:2080
    v_and_b32 v201, s22, v201
    v_mfma_f32_16x16x32_bf16 a[116:119], a[248:251], v[236:239], a[116:119]
    buffer_load_dwordx4 a[216:219], v254, s[8:11], s42 offen offset:0 sc1
    v_mfma_f32_16x16x32_bf16 a[116:119], v[244:247], v[228:231], a[116:119]
    v_lshlrev_b32 v252, 16, v193
    v_and_b32 v193, s22, v193
    v_mfma_f32_16x16x32_bf16 a[120:123], a[228:231], v[236:239], a[120:123]
    v_fmac_f32 v252, s25, v251
    v_fmac_f32 v193, s25, v201
    v_mfma_f32_16x16x32_bf16 a[120:123], a[240:243], v[228:231], a[120:123]
    s_waitcnt lgkmcnt(0)
    v_fmac_f32 v252, s28, v249
    v_fmac_f32 v193, s28, v197
    v_mfma_f32_16x16x32_bf16 a[120:123], a[252:255], v[232:235], a[120:123]
    v_cvt_pk_bf16_f32 v193, v252, v193
    v_lshlrev_b32 v252, 16, v203
    v_mfma_f32_16x16x32_bf16 a[124:127], v[240:243], v[232:235], a[124:127]
    buffer_load_dwordx4 a[220:223], v254, s[8:11], s42 offen offset:1024 sc1
    v_mfma_f32_16x16x32_bf16 a[124:127], a[244:247], v[228:231], a[124:127]
    v_and_b32 v203, s22, v203
    v_fmac_f32 v252, s29, v248
    v_mfma_f32_16x16x32_bf16 a[124:127], a[232:235], v[236:239], a[124:127]
    v_fmac_f32 v203, s29, v195
    v_fmac_f32 v252, s23, v250
    v_mfma_f32_16x16x32_bf16 a[128:131], a[236:239], v[236:239], a[128:131]
    ds_read_b128 v[236:239], v253 offset:3904
    v_fmac_f32 v203, s23, v199
    v_mfma_f32_16x16x32_bf16 a[128:131], a[248:251], v[228:231], a[128:131]
    buffer_load_dwordx4 a[224:227], v254, s[8:11], s42 offen offset:2048 sc1
    v_mfma_f32_16x16x32_bf16 a[128:131], v[244:247], v[232:235], a[128:131]
    v_cvt_pk_bf16_f32 v203, v252, v203
    v_fma_f32 v252, v249, s24, v251
    v_mfma_f32_16x16x32_bf16 a[132:135], a[228:231], v[228:231], a[132:135]
    v_and_b32 v227, 0x7fff, v255
    v_fmac_f32 v251, -4.0, v249
    v_mfma_f32_16x16x32_bf16 a[132:135], a[240:243], v[232:235], a[132:135]
    s_waitcnt lgkmcnt(0)
    v_fma_f32 v249, v248, s24, v250
    v_fmac_f32 v250, -4.0, v248
    v_mfma_f32_16x16x32_bf16 a[132:135], a[252:255], v[236:239], a[132:135]
    buffer_load_dwordx2 v[216:217], v227, s[4:7], s16 offen offset:1344
    v_mfma_f32_16x16x32_bf16 a[136:139], v[240:243], v[236:239], a[136:139]
    v_fma_f32 v248, v250, s26, v251
    v_fmac_f32 v251, s27, v250
    v_mfma_f32_16x16x32_bf16 a[136:139], a[244:247], v[232:235], a[136:139]
    v_fma_f32 v250, v249, 2.0, v252
    v_fmac_f32 v252, -2.0, v249
    v_fma_f32 v249, v197, s24, v201
    v_mfma_f32_16x16x32_bf16 a[136:139], a[232:235], v[228:231], a[136:139]
    v_fmac_f32 v201, -4.0, v197
    v_fma_f32 v197, v195, s24, v199
    v_mfma_f32_16x16x32_bf16 a[140:143], a[236:239], v[228:231], a[140:143]
    ds_read_b128 v[228:231], v253 offset:3648
    v_fmac_f32 v199, -4.0, v195
    v_mfma_f32_16x16x32_bf16 a[140:143], a[248:251], v[232:235], a[140:143]
    buffer_load_dwordx2 v[218:219], v227, s[4:7], s17 offen offset:1344
    v_mfma_f32_16x16x32_bf16 a[140:143], v[244:247], v[236:239], a[140:143]
    v_fma_f32 v195, v199, s26, v201
    v_fmac_f32 v201, s27, v199
    v_mfma_f32_16x16x32_bf16 a[144:147], a[228:231], v[232:235], a[144:147]
    v_fma_f32 v199, v197, 2.0, v249
    v_fmac_f32 v249, -2.0, v197
    v_mfma_f32_16x16x32_bf16 a[144:147], a[240:243], v[236:239], a[144:147]
    s_waitcnt lgkmcnt(0)
    v_cvt_pk_bf16_f32 v195, v248, v195
    v_cvt_pk_bf16_f32 v201, v251, v201
    v_mfma_f32_16x16x32_bf16 a[144:147], a[252:255], v[228:231], a[144:147]
    buffer_load_dwordx2 v[220:221], v227, s[4:7], s18 offen offset:1344
    v_mfma_f32_16x16x32_bf16 a[148:151], v[240:243], v[228:231], a[148:151]
    v_cvt_pk_bf16_f32 v199, v250, v199
    v_cvt_pk_bf16_f32 v197, v252, v249
    v_mfma_f32_16x16x32_bf16 a[148:151], a[244:247], v[236:239], a[148:151]
    v_lshrrev_b32 v252, 15, v255
    v_mfma_f32_16x16x32_bf16 a[148:151], a[232:235], v[232:235], a[148:151]
    ds_write_b64 v252, v[194:195] offset:8832
    v_mfma_f32_16x16x32_bf16 a[152:155], a[236:239], v[232:235], a[152:155]
    ds_read_b128 v[232:235], v253 offset:3392
    v_lshrrev_b32 v194, 15, v255
    v_mfma_f32_16x16x32_bf16 a[152:155], a[248:251], v[236:239], a[152:155]
    buffer_load_dwordx2 v[222:223], v227, s[4:7], s19 offen offset:1344
    v_mfma_f32_16x16x32_bf16 a[152:155], v[244:247], v[228:231], a[152:155]
    ds_write_b64 v194, v[200:201] offset:10912
    v_mfma_f32_16x16x32_bf16 a[156:159], a[228:231], v[236:239], a[156:159]
    v_mfma_f32_16x16x32_bf16 a[156:159], a[240:243], v[228:231], a[156:159]
    s_waitcnt lgkmcnt(1)
    s_waitcnt vmcnt(13)
    v_lshlrev_b32 v248, 16, v206
    v_mfma_f32_16x16x32_bf16 a[156:159], a[252:255], v[232:235], a[156:159]
    buffer_load_dwordx2 v[224:225], v227, s[4:7], s20 offen offset:1344
    v_mfma_f32_16x16x32_bf16 a[160:163], v[240:243], v[232:235], a[160:163]
    ds_write_b64 v194, v[198:199] offset:12992
    v_mfma_f32_16x16x32_bf16 a[160:163], a[244:247], v[228:231], a[160:163]
    v_lshlrev_b32 v249, 16, v208
    v_lshlrev_b32 v250, 16, v210
    v_mfma_f32_16x16x32_bf16 a[160:163], a[232:235], v[236:239], a[160:163]
    ds_write_b64 v194, v[192:193] offset:19232
    v_mfma_f32_16x16x32_bf16 a[164:167], a[236:239], v[236:239], a[164:167]
    ds_read_b128 v[236:239], v253 offset:3136
    v_lshlrev_b32 v251, 16, v212
    v_mfma_f32_16x16x32_bf16 a[164:167], a[248:251], v[228:231], a[164:167]
    buffer_load_dwordx2 v[226:227], v227, s[4:7], s21 offen offset:1344
    v_mfma_f32_16x16x32_bf16 a[164:167], v[244:247], v[232:235], a[164:167]
    ds_write_b64 v194, v[202:203] offset:27552
    v_mfma_f32_16x16x32_bf16 a[168:171], a[228:231], v[228:231], a[168:171]
    v_and_b32 v206, s22, v206
    v_and_b32 v208, s22, v208
    v_mfma_f32_16x16x32_bf16 a[168:171], a[240:243], v[232:235], a[168:171]
    s_waitcnt lgkmcnt(1)
    v_and_b32 v210, s22, v210
    v_and_b32 v212, s22, v212
    v_mfma_f32_16x16x32_bf16 a[168:171], a[252:255], v[236:239], a[168:171]
    ds_write_b64 v194, v[196:197] offset:31712
    v_mfma_f32_16x16x32_bf16 a[172:175], v[240:243], v[236:239], a[172:175]
    ds_read_b128 v[192:195], v253 offset:40096
    s_mov_b32 s45, 452138121
    v_mfma_f32_16x16x32_bf16 a[172:175], a[244:247], v[232:235], a[172:175]
    v_bfe_u32 v196, v254, 5, 3
    v_mul_u32_u24 v197, 5, v196
    v_mfma_f32_16x16x32_bf16 a[172:175], a[232:235], v[228:231], a[172:175]
    v_bfe_u32 v197, s45, v197, 5
    v_mul_u32_u24 v197, 65, v197
    v_mfma_f32_16x16x32_bf16 a[176:179], a[236:239], v[228:231], a[176:179]
    ds_read_b128 v[228:231], v253 offset:2864
    v_sub_u32 v197, v197, v196
    v_mfma_f32_16x16x32_bf16 a[176:179], a[248:251], v[232:235], a[176:179]
    v_lshl_add_u32 v196, v197, 5, v253
    s_waitcnt lgkmcnt(1)
    v_mfma_f32_16x16x32_bf16 a[176:179], v[244:247], v[236:239], a[176:179]
    s_mov_b32 s42, 405504
    v_lshlrev_b32 v252, 16, v204
    v_and_b32 v204, s22, v204
    v_mfma_f32_16x16x32_bf16 a[180:183], a[228:231], v[232:235], a[180:183]
    s_mov_b64 exec, s[46:47]
    ds_write_b128 v196, v[192:195] offset:1024
    s_mov_b64 exec, -1
    v_mfma_f32_16x16x32_bf16 a[184:187], a[232:235], v[232:235], a[184:187]
    v_fmac_f32 v252, s25, v251
    v_fmac_f32 v204, s25, v212
    v_mfma_f32_16x16x32_bf16 a[188:191], a[236:239], v[232:235], a[188:191]
    ds_read_b128 v[232:235], v253 offset:5200
    v_fmac_f32 v252, s28, v249
    v_mfma_f32_16x16x32_bf16 a[188:191], a[248:251], v[236:239], a[188:191]
    buffer_load_dwordx4 a[228:231], v254, s[8:11], s42 offen offset:0 sc1
    v_mfma_f32_16x16x32_bf16 a[184:187], a[244:247], v[236:239], a[184:187]
    s_waitcnt lgkmcnt(2)
    v_fmac_f32 v204, s28, v208
    v_cvt_pk_bf16_f32 v204, v252, v204
    v_mfma_f32_16x16x32_bf16 a[180:183], a[240:243], v[236:239], a[180:183]
    ds_read_b128 v[236:239], v253 offset:4928
    v_lshlrev_b32 v252, 16, v214
    v_mfma_f32_16x16x32_bf16 a[180:183], a[252:255], v[228:231], a[180:183]
    buffer_load_dwordx4 a[232:235], v254, s[8:11], s42 offen offset:1024 sc1
    v_mfma_f32_16x16x32_bf16 a[184:187], v[240:243], v[228:231], a[184:187]
    s_waitcnt vmcnt(14) lgkmcnt(1)
    v_and_b32 v214, s22, v214
    v_fmac_f32 v252, s29, v248
    v_mfma_f32_16x16x32_bf16 a[188:191], v[244:247], v[228:231], a[188:191]
    ds_read_b128 v[228:231], v253 offset:4672
    v_fmac_f32 v214, s29, v206
    v_fmac_f32 v252, s23, v250
sub10:
    v_mfma_f32_16x16x32_bf16 v[0:3], a[192:195], v[232:235], v[0:3]
    buffer_load_dwordx4 a[236:239], v254, s[8:11], s42 offen offset:2048 sc1
    v_mfma_f32_16x16x32_bf16 v[4:7], a[196:199], v[232:235], v[4:7]
    s_mov_b32 s42, 408576
    v_fmac_f32 v214, s23, v210
    v_cvt_pk_bf16_f32 v214, v252, v214
    v_mfma_f32_16x16x32_bf16 v[8:11], a[200:203], v[232:235], v[8:11]
    ds_read_b128 v[232:235], v253 offset:4416
    s_waitcnt vmcnt(12)
    s_waitcnt lgkmcnt(2)
    v_mfma_f32_16x16x32_bf16 v[8:11], a[212:215], v[236:239], v[8:11]
    v_fma_f32 v252, v249, s24, v251
    v_fmac_f32 v251, -4.0, v249
    v_mfma_f32_16x16x32_bf16 v[4:7], a[208:211], v[236:239], v[4:7]
    buffer_load_dwordx4 a[240:243], v254, s[8:11], s42 offen offset:0 sc1
    v_mfma_f32_16x16x32_bf16 v[0:3], a[204:207], v[236:239], v[0:3]
    s_waitcnt vmcnt(10) lgkmcnt(1)
    v_fma_f32 v249, v248, s24, v250
    v_fmac_f32 v250, -4.0, v248
    v_mfma_f32_16x16x32_bf16 v[0:3], a[216:219], v[228:231], v[0:3]
    v_fma_f32 v248, v250, s26, v251
    v_fmac_f32 v251, s27, v250
    v_mfma_f32_16x16x32_bf16 v[4:7], a[220:223], v[228:231], v[4:7]
    v_fma_f32 v250, v249, 2.0, v252
    v_fmac_f32 v252, -2.0, v249
    v_mfma_f32_16x16x32_bf16 v[8:11], a[224:227], v[228:231], v[8:11]
    buffer_load_dwordx4 a[244:247], v254, s[8:11], s42 offen offset:1024 sc1
    v_mfma_f32_16x16x32_bf16 v[12:15], a[192:195], v[236:239], v[12:15]
    v_fma_f32 v249, v208, s24, v212
    v_fmac_f32 v212, -4.0, v208
    v_mfma_f32_16x16x32_bf16 v[12:15], a[204:207], v[228:231], v[12:15]
    s_waitcnt lgkmcnt(0)
    v_fma_f32 v208, v206, s24, v210
    v_fmac_f32 v210, -4.0, v206
    v_mfma_f32_16x16x32_bf16 v[12:15], a[216:219], v[232:235], v[12:15]
    v_fma_f32 v206, v210, s26, v212
    v_fmac_f32 v212, s27, v210
    v_mfma_f32_16x16x32_bf16 v[16:19], a[220:223], v[232:235], v[16:19]
    buffer_load_dwordx4 a[248:251], v254, s[8:11], s42 offen offset:2048 sc1
    v_mfma_f32_16x16x32_bf16 v[16:19], a[208:211], v[228:231], v[16:19]
    s_mov_b32 s42, 411648
    v_fma_f32 v210, v208, 2.0, v249
    v_fmac_f32 v249, -2.0, v208
    v_mfma_f32_16x16x32_bf16 v[16:19], a[196:199], v[236:239], v[16:19]
    v_cvt_pk_bf16_f32 v206, v248, v206
    v_cvt_pk_bf16_f32 v212, v251, v212
    v_mfma_f32_16x16x32_bf16 v[20:23], a[200:203], v[236:239], v[20:23]
    ds_read_b128 v[236:239], v253 offset:4160
    v_cvt_pk_bf16_f32 v210, v250, v210
    v_mfma_f32_16x16x32_bf16 v[20:23], a[212:215], v[228:231], v[20:23]
    buffer_load_dwordx4 a[252:255], v254, s[8:11], s42 offen offset:0 sc1
    v_mfma_f32_16x16x32_bf16 v[20:23], a[224:227], v[232:235], v[20:23]
    v_cvt_pk_bf16_f32 v208, v252, v249
    v_lshlrev_b32 v248, 16, v207
    v_mfma_f32_16x16x32_bf16 v[24:27], a[192:195], v[228:231], v[24:27]
    v_lshlrev_b32 v249, 16, v209
    v_lshlrev_b32 v250, 16, v211
    v_mfma_f32_16x16x32_bf16 v[24:27], a[204:207], v[232:235], v[24:27]
    s_waitcnt lgkmcnt(0)
    v_lshlrev_b32 v251, 16, v213
    v_and_b32 v207, s22, v207
    v_mfma_f32_16x16x32_bf16 v[24:27], a[216:219], v[236:239], v[24:27]
    v_and_b32 v209, s22, v209
    v_and_b32 v211, s22, v211
    v_mfma_f32_16x16x32_bf16 v[28:31], a[220:223], v[236:239], v[28:31]
    buffer_load_dwordx4 v[240:243], v254, s[8:11], s42 offen offset:1024 sc1
    v_mfma_f32_16x16x32_bf16 v[28:31], a[208:211], v[232:235], v[28:31]
    v_and_b32 v213, s22, v213
    v_lshlrev_b32 v252, 16, v205
    v_mfma_f32_16x16x32_bf16 v[28:31], a[196:199], v[228:231], v[28:31]
    v_and_b32 v205, s22, v205
    v_fmac_f32 v252, s25, v251
    v_mfma_f32_16x16x32_bf16 v[32:35], a[200:203], v[228:231], v[32:35]
    ds_read_b128 v[228:231], v253 offset:5984
    v_fmac_f32 v205, s25, v213
    v_mfma_f32_16x16x32_bf16 v[32:35], a[212:215], v[232:235], v[32:35]
    buffer_load_dwordx4 v[244:247], v254, s[8:11], s42 offen offset:2048 sc1
    v_mfma_f32_16x16x32_bf16 v[32:35], a[224:227], v[236:239], v[32:35]
    v_fmac_f32 v252, s28, v249
    v_fmac_f32 v205, s28, v209
    v_mfma_f32_16x16x32_bf16 v[36:39], a[192:195], v[232:235], v[36:39]
    v_and_b32 v203, 0x7fff, v255
    v_cvt_pk_bf16_f32 v205, v252, v205
    v_mfma_f32_16x16x32_bf16 v[36:39], a[204:207], v[236:239], v[36:39]
    s_waitcnt lgkmcnt(0)
    v_lshlrev_b32 v252, 16, v215
    v_and_b32 v215, s22, v215
    v_mfma_f32_16x16x32_bf16 v[36:39], a[216:219], v[228:231], v[36:39]
    buffer_load_dwordx2 v[192:193], v203, s[4:7], s16 offen offset:256
    v_mfma_f32_16x16x32_bf16 v[40:43], a[220:223], v[228:231], v[40:43]
    v_fmac_f32 v252, s29, v248
    v_fmac_f32 v215, s29, v207
    v_mfma_f32_16x16x32_bf16 v[40:43], a[208:211], v[236:239], v[40:43]
    v_fmac_f32 v252, s23, v250
    v_fmac_f32 v215, s23, v211
    v_mfma_f32_16x16x32_bf16 v[40:43], a[196:199], v[232:235], v[40:43]
    v_cvt_pk_bf16_f32 v215, v252, v215
    v_fma_f32 v252, v249, s24, v251
    v_mfma_f32_16x16x32_bf16 v[44:47], a[200:203], v[232:235], v[44:47]
    ds_read_b128 v[232:235], v253 offset:5728
    v_fmac_f32 v251, -4.0, v249
    v_mfma_f32_16x16x32_bf16 v[44:47], a[212:215], v[236:239], v[44:47]
    buffer_load_dwordx2 v[194:195], v203, s[4:7], s17 offen offset:256
    v_mfma_f32_16x16x32_bf16 v[44:47], a[224:227], v[228:231], v[44:47]
    v_fma_f32 v249, v248, s24, v250
    v_fmac_f32 v250, -4.0, v248
    v_mfma_f32_16x16x32_bf16 v[48:51], a[192:195], v[236:239], v[48:51]
    v_fma_f32 v248, v250, s26, v251
    v_fmac_f32 v251, s27, v250
    v_mfma_f32_16x16x32_bf16 v[48:51], a[204:207], v[228:231], v[48:51]
    s_waitcnt lgkmcnt(0)
    v_fma_f32 v250, v249, 2.0, v252
    v_fmac_f32 v252, -2.0, v249
    v_mfma_f32_16x16x32_bf16 v[48:51], a[216:219], v[232:235], v[48:51]
    buffer_load_dwordx2 v[196:197], v203, s[4:7], s18 offen offset:256
    v_mfma_f32_16x16x32_bf16 v[52:55], a[220:223], v[232:235], v[52:55]
    v_fma_f32 v249, v209, s24, v213
    v_fmac_f32 v213, -4.0, v209
    v_fma_f32 v209, v207, s24, v211
    v_mfma_f32_16x16x32_bf16 v[52:55], a[208:211], v[228:231], v[52:55]
    v_fmac_f32 v211, -4.0, v207
    v_fma_f32 v207, v211, s26, v213
    v_mfma_f32_16x16x32_bf16 v[52:55], a[196:199], v[236:239], v[52:55]
    v_fmac_f32 v213, s27, v211
    v_fma_f32 v211, v209, 2.0, v249
    v_mfma_f32_16x16x32_bf16 v[56:59], a[200:203], v[236:239], v[56:59]
    ds_read_b128 v[236:239], v253 offset:5472
    v_fmac_f32 v249, -2.0, v209
    v_mfma_f32_16x16x32_bf16 v[56:59], a[212:215], v[228:231], v[56:59]
    buffer_load_dwordx2 v[198:199], v203, s[4:7], s19 offen offset:256
    v_mfma_f32_16x16x32_bf16 v[56:59], a[224:227], v[232:235], v[56:59]
    v_cvt_pk_bf16_f32 v207, v248, v207
    v_cvt_pk_bf16_f32 v213, v251, v213
    v_mfma_f32_16x16x32_bf16 v[60:63], a[192:195], v[228:231], v[60:63]
    v_cvt_pk_bf16_f32 v211, v250, v211
    v_cvt_pk_bf16_f32 v209, v252, v249
    v_mfma_f32_16x16x32_bf16 v[60:63], a[204:207], v[232:235], v[60:63]
    s_waitcnt lgkmcnt(0)
    v_lshrrev_b32 v252, 15, v255
    v_mfma_f32_16x16x32_bf16 v[60:63], a[216:219], v[236:239], v[60:63]
    buffer_load_dwordx2 v[200:201], v203, s[4:7], s20 offen offset:256
    v_mfma_f32_16x16x32_bf16 v[64:67], a[220:223], v[236:239], v[64:67]
    ds_write_b64 v252, v[206:207] offset:8576
    v_mfma_f32_16x16x32_bf16 v[64:67], a[208:211], v[232:235], v[64:67]
    s_waitcnt vmcnt(14)
    v_lshrrev_b32 v206, 15, v255
    v_lshlrev_b32 v248, 16, v218
    v_mfma_f32_16x16x32_bf16 v[64:67], a[196:199], v[228:231], v[64:67]
    ds_write_b64 v206, v[212:213] offset:10656
    v_mfma_f32_16x16x32_bf16 v[68:71], a[200:203], v[228:231], v[68:71]
    ds_read_b128 v[228:231], v253 offset:5216
    v_lshlrev_b32 v249, 16, v220
    v_mfma_f32_16x16x32_bf16 v[68:71], a[212:215], v[232:235], v[68:71]
    buffer_load_dwordx2 v[202:203], v203, s[4:7], s21 offen offset:256
    v_mfma_f32_16x16x32_bf16 v[68:71], a[224:227], v[236:239], v[68:71]
    ds_write_b64 v206, v[210:211] offset:12736
    v_mfma_f32_16x16x32_bf16 v[72:75], a[192:195], v[232:235], v[72:75]
    v_lshlrev_b32 v250, 16, v222
    v_lshlrev_b32 v251, 16, v224
    v_mfma_f32_16x16x32_bf16 v[72:75], a[204:207], v[236:239], v[72:75]
    s_waitcnt lgkmcnt(1)
    v_and_b32 v218, s22, v218
    v_and_b32 v220, s22, v220
    v_mfma_f32_16x16x32_bf16 v[72:75], a[216:219], v[228:231], v[72:75]
    ds_write_b64 v206, v[204:205] offset:18976
    v_mfma_f32_16x16x32_bf16 v[76:79], a[220:223], v[228:231], v[76:79]
    v_and_b32 v222, s22, v222
    v_and_b32 v224, s22, v224
    v_mfma_f32_16x16x32_bf16 v[76:79], a[208:211], v[236:239], v[76:79]
    ds_write_b64 v206, v[214:215] offset:27296
    v_mfma_f32_16x16x32_bf16 v[76:79], a[196:199], v[232:235], v[76:79]
    v_lshlrev_b32 v252, 16, v216
    v_and_b32 v216, s22, v216
    v_mfma_f32_16x16x32_bf16 v[80:83], a[200:203], v[232:235], v[80:83]
    ds_read_b128 v[232:235], v253 offset:4944
    v_fmac_f32 v252, s25, v251
    v_mfma_f32_16x16x32_bf16 v[80:83], a[212:215], v[236:239], v[80:83]
    ds_write_b64 v206, v[208:209] offset:31456
    v_mfma_f32_16x16x32_bf16 v[80:83], a[224:227], v[228:231], v[80:83]
    s_mov_b32 s42, 442368
    v_fmac_f32 v216, s25, v224
    v_fmac_f32 v252, s28, v249
    v_mfma_f32_16x16x32_bf16 v[84:87], a[192:195], v[236:239], v[84:87]
    v_fmac_f32 v216, s28, v220
    v_cvt_pk_bf16_f32 v216, v252, v216
    v_mfma_f32_16x16x32_bf16 v[88:91], a[196:199], v[236:239], v[88:91]
    v_lshlrev_b32 v252, 16, v226
    v_and_b32 v226, s22, v226
    v_mfma_f32_16x16x32_bf16 v[92:95], a[200:203], v[236:239], v[92:95]
    ds_read_b128 v[236:239], v253 offset:7280
    v_fmac_f32 v252, s29, v248
    v_mfma_f32_16x16x32_bf16 v[92:95], a[212:215], v[228:231], v[92:95]
    buffer_load_dwordx4 a[192:195], v254, s[8:11], s42 offen offset:0 sc1
    v_mfma_f32_16x16x32_bf16 v[88:91], a[208:211], v[228:231], v[88:91]
    s_waitcnt lgkmcnt(2)
    v_fmac_f32 v226, s29, v218
    v_fmac_f32 v252, s23, v250
    v_mfma_f32_16x16x32_bf16 v[84:87], a[204:207], v[228:231], v[84:87]
    ds_read_b128 v[228:231], v253 offset:7008
    v_fmac_f32 v226, s23, v222
    v_mfma_f32_16x16x32_bf16 v[84:87], a[216:219], v[232:235], v[84:87]
    buffer_load_dwordx4 a[196:199], v254, s[8:11], s42 offen offset:1024 sc1
    v_mfma_f32_16x16x32_bf16 v[88:91], a[220:223], v[232:235], v[88:91]
    s_waitcnt vmcnt(14) lgkmcnt(1)
    v_cvt_pk_bf16_f32 v226, v252, v226
    v_fma_f32 v252, v249, s24, v251
    v_mfma_f32_16x16x32_bf16 v[92:95], a[224:227], v[232:235], v[92:95]
    ds_read_b128 v[232:235], v253 offset:6752
    v_fmac_f32 v251, -4.0, v249
sub11:
    v_mfma_f32_16x16x32_bf16 v[96:99], a[228:231], v[236:239], v[96:99]
    buffer_load_dwordx4 a[200:203], v254, s[8:11], s42 offen offset:2048 sc1
    v_mfma_f32_16x16x32_bf16 v[100:103], a[232:235], v[236:239], v[100:103]
    s_mov_b32 s42, 445440
    v_fma_f32 v249, v248, s24, v250
    v_fmac_f32 v250, -4.0, v248
    v_mfma_f32_16x16x32_bf16 v[104:107], a[236:239], v[236:239], v[104:107]
    ds_read_b128 v[236:239], v253 offset:6496
    s_waitcnt vmcnt(12)
    s_waitcnt lgkmcnt(2)
    v_mfma_f32_16x16x32_bf16 v[104:107], a[248:251], v[228:231], v[104:107]
    v_fma_f32 v248, v250, s26, v251
    v_fmac_f32 v251, s27, v250
    v_mfma_f32_16x16x32_bf16 v[100:103], a[244:247], v[228:231], v[100:103]
    buffer_load_dwordx4 a[204:207], v254, s[8:11], s42 offen offset:0 sc1
    v_mfma_f32_16x16x32_bf16 v[96:99], a[240:243], v[228:231], v[96:99]
    s_waitcnt vmcnt(10) lgkmcnt(1)
    v_fma_f32 v250, v249, 2.0, v252
    v_fmac_f32 v252, -2.0, v249
    v_mfma_f32_16x16x32_bf16 v[96:99], a[252:255], v[232:235], v[96:99]
    v_fma_f32 v249, v220, s24, v224
    v_fmac_f32 v224, -4.0, v220
    v_mfma_f32_16x16x32_bf16 v[100:103], v[240:243], v[232:235], v[100:103]
    v_fma_f32 v220, v218, s24, v222
    v_fmac_f32 v222, -4.0, v218
    v_fma_f32 v218, v222, s26, v224
    v_mfma_f32_16x16x32_bf16 v[104:107], v[244:247], v[232:235], v[104:107]
    buffer_load_dwordx4 a[208:211], v254, s[8:11], s42 offen offset:1024 sc1
    v_mfma_f32_16x16x32_bf16 v[108:111], a[228:231], v[228:231], v[108:111]
    v_fmac_f32 v224, s27, v222
    v_fma_f32 v222, v220, 2.0, v249
    v_mfma_f32_16x16x32_bf16 v[108:111], a[240:243], v[232:235], v[108:111]
    s_waitcnt lgkmcnt(0)
    v_fmac_f32 v249, -2.0, v220
    v_cvt_pk_bf16_f32 v218, v248, v218
    v_mfma_f32_16x16x32_bf16 v[108:111], a[252:255], v[236:239], v[108:111]
    v_cvt_pk_bf16_f32 v224, v251, v224
    v_cvt_pk_bf16_f32 v222, v250, v222
    v_mfma_f32_16x16x32_bf16 v[112:115], v[240:243], v[236:239], v[112:115]
    buffer_load_dwordx4 a[212:215], v254, s[8:11], s42 offen offset:2048 sc1
    v_mfma_f32_16x16x32_bf16 v[112:115], a[244:247], v[232:235], v[112:115]
    s_mov_b32 s42, 448512
    v_cvt_pk_bf16_f32 v220, v252, v249
    v_lshlrev_b32 v248, 16, v219
    v_mfma_f32_16x16x32_bf16 v[112:115], a[232:235], v[228:231], v[112:115]
    v_lshlrev_b32 v249, 16, v221
    v_lshlrev_b32 v250, 16, v223
    v_mfma_f32_16x16x32_bf16 v[116:119], a[236:239], v[228:231], v[116:119]
    ds_read_b128 v[228:231], v253 offset:6240
    v_lshlrev_b32 v251, 16, v225
    v_mfma_f32_16x16x32_bf16 v[116:119], a[248:251], v[232:235], v[116:119]
    buffer_load_dwordx4 a[216:219], v254, s[8:11], s42 offen offset:0 sc1
    v_mfma_f32_16x16x32_bf16 v[116:119], v[244:247], v[236:239], v[116:119]
    v_and_b32 v219, s22, v219
    v_and_b32 v221, s22, v221
    v_mfma_f32_16x16x32_bf16 v[120:123], a[228:231], v[232:235], v[120:123]
    v_and_b32 v223, s22, v223
    v_and_b32 v225, s22, v225
    v_mfma_f32_16x16x32_bf16 v[120:123], a[240:243], v[236:239], v[120:123]
    s_waitcnt lgkmcnt(0)
    v_lshlrev_b32 v252, 16, v217
    v_and_b32 v217, s22, v217
    v_mfma_f32_16x16x32_bf16 v[120:123], a[252:255], v[228:231], v[120:123]
    v_fmac_f32 v252, s25, v251
    v_fmac_f32 v217, s25, v225
    v_mfma_f32_16x16x32_bf16 v[124:127], v[240:243], v[228:231], v[124:127]
    buffer_load_dwordx4 a[220:223], v254, s[8:11], s42 offen offset:1024 sc1
    v_mfma_f32_16x16x32_bf16 v[124:127], a[244:247], v[236:239], v[124:127]
    v_fmac_f32 v252, s28, v249
    v_fmac_f32 v217, s28, v221
    v_mfma_f32_16x16x32_bf16 v[124:127], a[232:235], v[232:235], v[124:127]
    v_cvt_pk_bf16_f32 v217, v252, v217
    v_lshlrev_b32 v252, 16, v227
    v_mfma_f32_16x16x32_bf16 v[128:131], a[236:239], v[232:235], v[128:131]
    ds_read_b128 v[232:235], v253 offset:8064
    v_and_b32 v227, s22, v227
    v_mfma_f32_16x16x32_bf16 v[128:131], a[248:251], v[236:239], v[128:131]
    buffer_load_dwordx4 a[224:227], v254, s[8:11], s42 offen offset:2048 sc1
    v_mfma_f32_16x16x32_bf16 v[128:131], v[244:247], v[228:231], v[128:131]
    v_fmac_f32 v252, s29, v248
    v_fmac_f32 v227, s29, v219
    v_mfma_f32_16x16x32_bf16 v[132:135], a[228:231], v[236:239], v[132:135]
    v_and_b32 v215, 0x7fff, v255
    v_fmac_f32 v252, s23, v250
    v_mfma_f32_16x16x32_bf16 v[132:135], a[240:243], v[228:231], v[132:135]
    s_waitcnt lgkmcnt(0)
    v_fmac_f32 v227, s23, v223
    v_cvt_pk_bf16_f32 v227, v252, v227
    v_mfma_f32_16x16x32_bf16 v[132:135], a[252:255], v[232:235], v[132:135]
    buffer_load_dwordx2 v[204:205], v215, s[4:7], s16 offen offset:640
    v_mfma_f32_16x16x32_bf16 v[136:139], v[240:243], v[232:235], v[136:139]
    v_fma_f32 v252, v249, s24, v251
    v_fmac_f32 v251, -4.0, v249
    v_mfma_f32_16x16x32_bf16 v[136:139], a[244:247], v[228:231], v[136:139]
    v_fma_f32 v249, v248, s24, v250
    v_fmac_f32 v250, -4.0, v248
    v_mfma_f32_16x16x32_bf16 v[136:139], a[232:235], v[236:239], v[136:139]
    v_fma_f32 v248, v250, s26, v251
    v_fmac_f32 v251, s27, v250
    v_mfma_f32_16x16x32_bf16 v[140:143], a[236:239], v[236:239], v[140:143]
    ds_read_b128 v[236:239], v253 offset:7808
    v_fma_f32 v250, v249, 2.0, v252
    v_mfma_f32_16x16x32_bf16 v[140:143], a[248:251], v[228:231], v[140:143]
    buffer_load_dwordx2 v[206:207], v215, s[4:7], s17 offen offset:640
    v_mfma_f32_16x16x32_bf16 v[140:143], v[244:247], v[232:235], v[140:143]
    v_fmac_f32 v252, -2.0, v249
    v_fma_f32 v249, v221, s24, v225
    v_mfma_f32_16x16x32_bf16 v[144:147], a[228:231], v[228:231], v[144:147]
    v_fmac_f32 v225, -4.0, v221
    v_fma_f32 v221, v219, s24, v223
    v_mfma_f32_16x16x32_bf16 v[144:147], a[240:243], v[232:235], v[144:147]
    s_waitcnt lgkmcnt(0)
    v_fmac_f32 v223, -4.0, v219
    v_fma_f32 v219, v223, s26, v225
    v_mfma_f32_16x16x32_bf16 v[144:147], a[252:255], v[236:239], v[144:147]
    buffer_load_dwordx2 v[208:209], v215, s[4:7], s18 offen offset:640
    v_mfma_f32_16x16x32_bf16 v[148:151], v[240:243], v[236:239], v[148:151]
    v_fmac_f32 v225, s27, v223
    v_fma_f32 v223, v221, 2.0, v249
    v_mfma_f32_16x16x32_bf16 v[148:151], a[244:247], v[232:235], v[148:151]
    v_fmac_f32 v249, -2.0, v221
    v_cvt_pk_bf16_f32 v219, v248, v219
    v_mfma_f32_16x16x32_bf16 v[148:151], a[232:235], v[228:231], v[148:151]
    v_cvt_pk_bf16_f32 v225, v251, v225
    v_cvt_pk_bf16_f32 v223, v250, v223
    v_mfma_f32_16x16x32_bf16 v[152:155], a[236:239], v[228:231], v[152:155]
    ds_read_b128 v[228:231], v253 offset:7552
    v_cvt_pk_bf16_f32 v221, v252, v249
    v_mfma_f32_16x16x32_bf16 v[152:155], a[248:251], v[232:235], v[152:155]
    buffer_load_dwordx2 v[210:211], v215, s[4:7], s19 offen offset:640
    v_mfma_f32_16x16x32_bf16 v[152:155], v[244:247], v[236:239], v[152:155]
    v_lshrrev_b32 v252, 15, v255
    v_mfma_f32_16x16x32_bf16 v[156:159], a[228:231], v[232:235], v[156:159]
    ds_write_b64 v252, v[218:219] offset:8320
    v_mfma_f32_16x16x32_bf16 v[156:159], a[240:243], v[236:239], v[156:159]
    s_waitcnt lgkmcnt(1)
    v_lshrrev_b32 v218, 15, v255
    s_waitcnt vmcnt(13)
    v_mfma_f32_16x16x32_bf16 v[156:159], a[252:255], v[228:231], v[156:159]
    buffer_load_dwordx2 v[212:213], v215, s[4:7], s20 offen offset:640
    v_lshlrev_b32 v248, 16, v194
    v_mfma_f32_16x16x32_bf16 v[160:163], v[240:243], v[228:231], v[160:163]
    ds_write_b64 v218, v[224:225] offset:10400
    v_mfma_f32_16x16x32_bf16 v[160:163], a[244:247], v[236:239], v[160:163]
pad4:
    s_cbranch_vccnz pad8
    v_lshlrev_b32 v249, 16, v196
    v_lshlrev_b32 v250, 16, v198
    v_mfma_f32_16x16x32_bf16 v[160:163], a[232:235], v[232:235], v[160:163]
    ds_write_b64 v218, v[222:223] offset:12480
    v_mfma_f32_16x16x32_bf16 v[164:167], a[236:239], v[232:235], v[164:167]
    ds_read_b128 v[232:235], v253 offset:7296
    v_lshlrev_b32 v251, 16, v200
    v_mfma_f32_16x16x32_bf16 v[164:167], a[248:251], v[236:239], v[164:167]
    buffer_load_dwordx2 v[214:215], v215, s[4:7], s21 offen offset:640
    v_mfma_f32_16x16x32_bf16 v[164:167], v[244:247], v[228:231], v[164:167]
    ds_write_b64 v218, v[216:217] offset:18720
    v_mfma_f32_16x16x32_bf16 v[168:171], a[228:231], v[236:239], v[168:171]
    v_and_b32 v194, s22, v194
    v_and_b32 v196, s22, v196
    v_mfma_f32_16x16x32_bf16 v[168:171], a[240:243], v[228:231], v[168:171]
    s_waitcnt lgkmcnt(1)
    v_and_b32 v198, s22, v198
    v_and_b32 v200, s22, v200
    v_mfma_f32_16x16x32_bf16 v[168:171], a[252:255], v[232:235], v[168:171]
    ds_write_b64 v218, v[226:227] offset:27040
    v_mfma_f32_16x16x32_bf16 v[172:175], v[240:243], v[232:235], v[172:175]
    v_lshlrev_b32 v252, 16, v192
    v_and_b32 v192, s22, v192
    v_mfma_f32_16x16x32_bf16 v[172:175], a[244:247], v[228:231], v[172:175]
    ds_write_b64 v218, v[220:221] offset:31200
    v_mfma_f32_16x16x32_bf16 v[172:175], a[232:235], v[236:239], v[172:175]
    v_fmac_f32 v252, s25, v251
    v_fmac_f32 v192, s25, v200
    v_mfma_f32_16x16x32_bf16 v[176:179], a[236:239], v[236:239], v[176:179]
    ds_read_b128 v[236:239], v253 offset:7024
    v_fmac_f32 v252, s28, v249
    v_mfma_f32_16x16x32_bf16 v[176:179], a[248:251], v[228:231], v[176:179]
    v_fmac_f32 v192, s28, v196
    v_cvt_pk_bf16_f32 v192, v252, v192
    v_mfma_f32_16x16x32_bf16 v[176:179], v[244:247], v[232:235], v[176:179]
    s_mov_b32 s42, 479232
    v_lshlrev_b32 v252, 16, v202
    v_and_b32 v202, s22, v202
    v_mfma_f32_16x16x32_bf16 v[180:183], a[228:231], v[228:231], v[180:183]
    s_waitcnt lgkmcnt(0)
    v_fmac_f32 v252, s29, v248
    v_fmac_f32 v202, s29, v194
    v_mfma_f32_16x16x32_bf16 v[184:187], a[232:235], v[228:231], v[184:187]
    s_barrier
    v_mfma_f32_16x16x32_bf16 v[188:191], a[236:239], v[228:231], v[188:191]
    ds_read_b128 v[228:231], v253 offset:9360
    v_fmac_f32 v252, s23, v250
    v_mfma_f32_16x16x32_bf16 v[188:191], a[248:251], v[232:235], v[188:191]
    buffer_load_dwordx4 a[228:231], v254, s[8:11], s42 offen offset:0 sc1
    v_mfma_f32_16x16x32_bf16 v[184:187], a[244:247], v[232:235], v[184:187]
    v_fmac_f32 v202, s23, v198
    v_cvt_pk_bf16_f32 v202, v252, v202
    v_mfma_f32_16x16x32_bf16 v[180:183], a[240:243], v[232:235], v[180:183]
    ds_read_b128 v[232:235], v253 offset:9088
    v_fma_f32 v252, v249, s24, v251
    v_mfma_f32_16x16x32_bf16 v[180:183], a[252:255], v[236:239], v[180:183]
    buffer_load_dwordx4 a[232:235], v254, s[8:11], s42 offen offset:1024 sc1
    v_mfma_f32_16x16x32_bf16 v[184:187], v[240:243], v[236:239], v[184:187]
    s_waitcnt vmcnt(14) lgkmcnt(1)
    v_fmac_f32 v251, -4.0, v249
    v_fma_f32 v249, v248, s24, v250
    v_mfma_f32_16x16x32_bf16 v[188:191], v[244:247], v[236:239], v[188:191]
    ds_read_b128 v[236:239], v253 offset:8832
    v_fmac_f32 v250, -4.0, v248
sub12:
    v_mfma_f32_16x16x32_bf16 a[0:3], a[192:195], v[228:231], a[0:3]
    buffer_load_dwordx4 a[236:239], v254, s[8:11], s42 offen offset:2048 sc1
    v_mfma_f32_16x16x32_bf16 a[4:7], a[196:199], v[228:231], a[4:7]
    s_mov_b32 s42, 482304
    v_fma_f32 v248, v250, s26, v251
    v_fmac_f32 v251, s27, v250
    v_mfma_f32_16x16x32_bf16 a[8:11], a[200:203], v[228:231], a[8:11]
    ds_read_b128 v[228:231], v253 offset:8576
    s_waitcnt vmcnt(12)
    s_waitcnt lgkmcnt(2)
    v_mfma_f32_16x16x32_bf16 a[8:11], a[212:215], v[232:235], a[8:11]
    v_fma_f32 v250, v249, 2.0, v252
    v_fmac_f32 v252, -2.0, v249
    v_mfma_f32_16x16x32_bf16 a[4:7], a[208:211], v[232:235], a[4:7]
    buffer_load_dwordx4 a[240:243], v254, s[8:11], s42 offen offset:0 sc1
    v_mfma_f32_16x16x32_bf16 a[0:3], a[204:207], v[232:235], a[0:3]
    s_waitcnt vmcnt(10) lgkmcnt(1)
    v_fma_f32 v249, v196, s24, v200
    v_fmac_f32 v200, -4.0, v196
    v_mfma_f32_16x16x32_bf16 a[0:3], a[216:219], v[236:239], a[0:3]
    v_fma_f32 v196, v194, s24, v198
    v_fmac_f32 v198, -4.0, v194
    v_mfma_f32_16x16x32_bf16 a[4:7], a[220:223], v[236:239], a[4:7]
    v_fma_f32 v194, v198, s26, v200
    v_fmac_f32 v200, s27, v198
    v_mfma_f32_16x16x32_bf16 a[8:11], a[224:227], v[236:239], a[8:11]
    buffer_load_dwordx4 a[244:247], v254, s[8:11], s42 offen offset:1024 sc1
    v_mfma_f32_16x16x32_bf16 a[12:15], a[192:195], v[232:235], a[12:15]
    v_fma_f32 v198, v196, 2.0, v249
    v_fmac_f32 v249, -2.0, v196
    v_mfma_f32_16x16x32_bf16 a[12:15], a[204:207], v[236:239], a[12:15]
    s_waitcnt lgkmcnt(0)
    v_cvt_pk_bf16_f32 v194, v248, v194
    v_cvt_pk_bf16_f32 v200, v251, v200
    v_mfma_f32_16x16x32_bf16 a[12:15], a[216:219], v[228:231], a[12:15]
    v_cvt_pk_bf16_f32 v198, v250, v198
    v_cvt_pk_bf16_f32 v196, v252, v249
    v_mfma_f32_16x16x32_bf16 a[16:19], a[220:223], v[228:231], a[16:19]
    buffer_load_dwordx4 a[248:251], v254, s[8:11], s42 offen offset:2048 sc1
    v_mfma_f32_16x16x32_bf16 a[16:19], a[208:211], v[236:239], a[16:19]
    s_mov_b32 s42, 485376
    v_lshlrev_b32 v248, 16, v195
    v_lshlrev_b32 v249, 16, v197
    v_mfma_f32_16x16x32_bf16 a[16:19], a[196:199], v[232:235], a[16:19]
    v_lshlrev_b32 v250, 16, v199
    v_lshlrev_b32 v251, 16, v201
    v_mfma_f32_16x16x32_bf16 a[20:23], a[200:203], v[232:235], a[20:23]
    ds_read_b128 v[232:235], v253 offset:8320
    v_and_b32 v195, s22, v195
    v_and_b32 v197, s22, v197
    v_mfma_f32_16x16x32_bf16 a[20:23], a[212:215], v[236:239], a[20:23]
    buffer_load_dwordx4 a[252:255], v254, s[8:11], s42 offen offset:0 sc1
    v_mfma_f32_16x16x32_bf16 a[20:23], a[224:227], v[228:231], a[20:23]
    v_and_b32 v199, s22, v199
    v_and_b32 v201, s22, v201
    v_mfma_f32_16x16x32_bf16 a[24:27], a[192:195], v[236:239], a[24:27]
    v_lshlrev_b32 v252, 16, v193
    v_and_b32 v193, s22, v193
    v_mfma_f32_16x16x32_bf16 a[24:27], a[204:207], v[228:231], a[24:27]
    s_waitcnt lgkmcnt(0)
    v_fmac_f32 v252, s25, v251
    v_fmac_f32 v193, s25, v201
    v_mfma_f32_16x16x32_bf16 a[24:27], a[216:219], v[232:235], a[24:27]
    v_fmac_f32 v252, s28, v249
    v_fmac_f32 v193, s28, v197
    v_mfma_f32_16x16x32_bf16 a[28:31], a[220:223], v[232:235], a[28:31]
    buffer_load_dwordx4 v[240:243], v254, s[8:11], s42 offen offset:1024 sc1
    v_mfma_f32_16x16x32_bf16 a[28:31], a[208:211], v[228:231], a[28:31]
    v_cvt_pk_bf16_f32 v193, v252, v193
    v_lshlrev_b32 v252, 16, v203
    v_mfma_f32_16x16x32_bf16 a[28:31], a[196:199], v[236:239], a[28:31]
    v_and_b32 v203, s22, v203
    v_fmac_f32 v252, s29, v248
    v_mfma_f32_16x16x32_bf16 a[32:35], a[200:203], v[236:239], a[32:35]
    ds_read_b128 v[236:239], v253 offset:10144
    v_fmac_f32 v203, s29, v195
    v_mfma_f32_16x16x32_bf16 a[32:35], a[212:215], v[228:231], a[32:35]
    buffer_load_dwordx4 v[244:247], v254, s[8:11], s42 offen offset:2048 sc1
    v_mfma_f32_16x16x32_bf16 a[32:35], a[224:227], v[232:235], a[32:35]
    v_fmac_f32 v252, s23, v250
    v_fmac_f32 v203, s23, v199
    v_mfma_f32_16x16x32_bf16 a[36:39], a[192:195], v[228:231], a[36:39]
    v_and_b32 v227, 0x7fff, v255
    v_cvt_pk_bf16_f32 v203, v252, v203
    v_mfma_f32_16x16x32_bf16 a[36:39], a[204:207], v[232:235], a[36:39]
    s_waitcnt lgkmcnt(0)
    v_fma_f32 v252, v249, s24, v251
    v_fmac_f32 v251, -4.0, v249
    v_mfma_f32_16x16x32_bf16 a[36:39], a[216:219], v[236:239], a[36:39]
    buffer_load_dwordx2 v[216:217], v227, s[4:7], s16 offen offset:1024
    v_mfma_f32_16x16x32_bf16 a[40:43], a[220:223], v[236:239], a[40:43]
    v_fma_f32 v249, v248, s24, v250
    v_fmac_f32 v250, -4.0, v248
    v_mfma_f32_16x16x32_bf16 a[40:43], a[208:211], v[232:235], a[40:43]
    v_fma_f32 v248, v250, s26, v251
    v_fmac_f32 v251, s27, v250
    v_mfma_f32_16x16x32_bf16 a[40:43], a[196:199], v[228:231], a[40:43]
    v_fma_f32 v250, v249, 2.0, v252
    v_fmac_f32 v252, -2.0, v249
    v_mfma_f32_16x16x32_bf16 a[44:47], a[200:203], v[228:231], a[44:47]
    ds_read_b128 v[228:231], v253 offset:9888
    v_fma_f32 v249, v197, s24, v201
    v_mfma_f32_16x16x32_bf16 a[44:47], a[212:215], v[232:235], a[44:47]
    buffer_load_dwordx2 v[218:219], v227, s[4:7], s17 offen offset:1024
    v_mfma_f32_16x16x32_bf16 a[44:47], a[224:227], v[236:239], a[44:47]
    v_fmac_f32 v201, -4.0, v197
    v_fma_f32 v197, v195, s24, v199
    v_mfma_f32_16x16x32_bf16 a[48:51], a[192:195], v[232:235], a[48:51]
    v_fmac_f32 v199, -4.0, v195
    v_fma_f32 v195, v199, s26, v201
    v_mfma_f32_16x16x32_bf16 a[48:51], a[204:207], v[236:239], a[48:51]
    s_waitcnt lgkmcnt(0)
    v_fmac_f32 v201, s27, v199
    v_fma_f32 v199, v197, 2.0, v249
    v_mfma_f32_16x16x32_bf16 a[48:51], a[216:219], v[228:231], a[48:51]
    buffer_load_dwordx2 v[220:221], v227, s[4:7], s18 offen offset:1024
    v_mfma_f32_16x16x32_bf16 a[52:55], a[220:223], v[228:231], a[52:55]
    v_fmac_f32 v249, -2.0, v197
    v_cvt_pk_bf16_f32 v195, v248, v195
    v_mfma_f32_16x16x32_bf16 a[52:55], a[208:211], v[236:239], a[52:55]
    v_cvt_pk_bf16_f32 v201, v251, v201
    v_cvt_pk_bf16_f32 v199, v250, v199
    v_mfma_f32_16x16x32_bf16 a[52:55], a[196:199], v[232:235], a[52:55]
    v_cvt_pk_bf16_f32 v197, v252, v249
    v_lshrrev_b32 v252, 15, v255
    v_mfma_f32_16x16x32_bf16 a[56:59], a[200:203], v[232:235], a[56:59]
    ds_read_b128 v[232:235], v253 offset:9632
    v_mfma_f32_16x16x32_bf16 a[56:59], a[212:215], v[236:239], a[56:59]
    buffer_load_dwordx2 v[222:223], v227, s[4:7], s19 offen offset:1024
    v_mfma_f32_16x16x32_bf16 a[56:59], a[224:227], v[228:231], a[56:59]
    ds_write_b64 v252, v[194:195] offset:768
    v_mfma_f32_16x16x32_bf16 a[60:63], a[192:195], v[236:239], a[60:63]
    v_lshrrev_b32 v194, 15, v255
    v_mfma_f32_16x16x32_bf16 a[60:63], a[204:207], v[228:231], a[60:63]
    s_waitcnt lgkmcnt(1)
    s_waitcnt vmcnt(13)
    v_lshlrev_b32 v248, 16, v206
    v_mfma_f32_16x16x32_bf16 a[60:63], a[216:219], v[232:235], a[60:63]
    buffer_load_dwordx2 v[224:225], v227, s[4:7], s20 offen offset:1024
    v_mfma_f32_16x16x32_bf16 a[64:67], a[220:223], v[232:235], a[64:67]
    ds_write_b64 v194, v[200:201] offset:2848
    v_mfma_f32_16x16x32_bf16 a[64:67], a[208:211], v[228:231], a[64:67]
    v_lshlrev_b32 v249, 16, v208
    v_lshlrev_b32 v250, 16, v210
    v_mfma_f32_16x16x32_bf16 a[64:67], a[196:199], v[236:239], a[64:67]
    ds_write_b64 v194, v[198:199] offset:4928
    v_mfma_f32_16x16x32_bf16 a[68:71], a[200:203], v[236:239], a[68:71]
    ds_read_b128 v[236:239], v253 offset:9376
    v_lshlrev_b32 v251, 16, v212
    v_mfma_f32_16x16x32_bf16 a[68:71], a[212:215], v[228:231], a[68:71]
    buffer_load_dwordx2 v[226:227], v227, s[4:7], s21 offen offset:1024
    v_mfma_f32_16x16x32_bf16 a[68:71], a[224:227], v[232:235], a[68:71]
    ds_write_b64 v194, v[192:193] offset:21568
    v_mfma_f32_16x16x32_bf16 a[72:75], a[192:195], v[228:231], a[72:75]
    v_and_b32 v206, s22, v206
    v_and_b32 v208, s22, v208
    v_mfma_f32_16x16x32_bf16 a[72:75], a[204:207], v[232:235], a[72:75]
    s_waitcnt lgkmcnt(1)
    v_and_b32 v210, s22, v210
    v_and_b32 v212, s22, v212
    v_lshlrev_b32 v252, 16, v204
    v_mfma_f32_16x16x32_bf16 a[72:75], a[216:219], v[236:239], a[72:75]
    ds_write_b64 v194, v[202:203] offset:29888
    v_mfma_f32_16x16x32_bf16 a[76:79], a[220:223], v[236:239], a[76:79]
    v_and_b32 v204, s22, v204
    v_fmac_f32 v252, s25, v251
    v_mfma_f32_16x16x32_bf16 a[76:79], a[208:211], v[232:235], a[76:79]
    ds_write_b64 v194, v[196:197] offset:7008
    v_mfma_f32_16x16x32_bf16 a[76:79], a[196:199], v[228:231], a[76:79]
    v_fmac_f32 v204, s25, v212
    v_fmac_f32 v252, s28, v249
    v_mfma_f32_16x16x32_bf16 a[80:83], a[200:203], v[228:231], a[80:83]
    ds_read_b128 v[228:231], v253 offset:9104
    v_fmac_f32 v204, s28, v208
    v_mfma_f32_16x16x32_bf16 a[80:83], a[212:215], v[232:235], a[80:83]
    v_cvt_pk_bf16_f32 v204, v252, v204
    v_lshlrev_b32 v252, 16, v214
    v_mfma_f32_16x16x32_bf16 a[80:83], a[224:227], v[236:239], a[80:83]
    s_mov_b32 s42, 516096
    v_and_b32 v214, s22, v214
    v_fmac_f32 v252, s29, v248
    v_mfma_f32_16x16x32_bf16 a[84:87], a[192:195], v[232:235], a[84:87]
    v_fmac_f32 v214, s29, v206
    v_fmac_f32 v252, s23, v250
    v_mfma_f32_16x16x32_bf16 a[88:91], a[196:199], v[232:235], a[88:91]
    v_fmac_f32 v214, s23, v210
    v_cvt_pk_bf16_f32 v214, v252, v214
    v_mfma_f32_16x16x32_bf16 a[92:95], a[200:203], v[232:235], a[92:95]
    ds_read_b128 v[232:235], v253 offset:11440
    v_fma_f32 v252, v249, s24, v251
    v_mfma_f32_16x16x32_bf16 a[92:95], a[212:215], v[236:239], a[92:95]
    buffer_load_dwordx4 a[192:195], v254, s[8:11], s42 offen offset:0 sc1
    v_mfma_f32_16x16x32_bf16 a[88:91], a[208:211], v[236:239], a[88:91]
    s_waitcnt lgkmcnt(1)
    v_fmac_f32 v251, -4.0, v249
    v_fma_f32 v249, v248, s24, v250
    v_mfma_f32_16x16x32_bf16 a[84:87], a[204:207], v[236:239], a[84:87]
    ds_read_b128 v[236:239], v253 offset:11168
    v_fmac_f32 v250, -4.0, v248
    v_mfma_f32_16x16x32_bf16 a[84:87], a[216:219], v[228:231], a[84:87]
    buffer_load_dwordx4 a[196:199], v254, s[8:11], s42 offen offset:1024 sc1
    v_mfma_f32_16x16x32_bf16 a[88:91], a[220:223], v[228:231], a[88:91]
    s_waitcnt vmcnt(14) lgkmcnt(1)
    v_fma_f32 v248, v250, s26, v251
    v_fmac_f32 v251, s27, v250
    v_mfma_f32_16x16x32_bf16 a[92:95], a[224:227], v[228:231], a[92:95]
    ds_read_b128 v[228:231], v253 offset:10912
    v_fma_f32 v250, v249, 2.0, v252
sub13:
    v_mfma_f32_16x16x32_bf16 a[96:99], a[228:231], v[232:235], a[96:99]
    buffer_load_dwordx4 a[200:203], v254, s[8:11], s42 offen offset:2048 sc1
    v_mfma_f32_16x16x32_bf16 a[100:103], a[232:235], v[232:235], a[100:103]
    s_mov_b32 s42, 519168
    v_fmac_f32 v252, -2.0, v249
    v_fma_f32 v249, v208, s24, v212
    v_mfma_f32_16x16x32_bf16 a[104:107], a[236:239], v[232:235], a[104:107]
    ds_read_b128 v[232:235], v253 offset:10656
    s_waitcnt vmcnt(12)
    s_waitcnt lgkmcnt(2)
    v_mfma_f32_16x16x32_bf16 a[104:107], a[248:251], v[236:239], a[104:107]
    v_fmac_f32 v212, -4.0, v208
    v_fma_f32 v208, v206, s24, v210
    v_mfma_f32_16x16x32_bf16 a[100:103], a[244:247], v[236:239], a[100:103]
    buffer_load_dwordx4 a[204:207], v254, s[8:11], s42 offen offset:0 sc1
    v_mfma_f32_16x16x32_bf16 a[96:99], a[240:243], v[236:239], a[96:99]
    s_waitcnt vmcnt(10) lgkmcnt(1)
    v_fmac_f32 v210, -4.0, v206
    v_fma_f32 v206, v210, s26, v212
    v_mfma_f32_16x16x32_bf16 a[96:99], a[252:255], v[228:231], a[96:99]
    v_fmac_f32 v212, s27, v210
    v_fma_f32 v210, v208, 2.0, v249
    v_mfma_f32_16x16x32_bf16 a[100:103], v[240:243], v[228:231], a[100:103]
    v_fmac_f32 v249, -2.0, v208
    v_cvt_pk_bf16_f32 v206, v248, v206
    v_mfma_f32_16x16x32_bf16 a[104:107], v[244:247], v[228:231], a[104:107]
    buffer_load_dwordx4 a[208:211], v254, s[8:11], s42 offen offset:1024 sc1
    v_mfma_f32_16x16x32_bf16 a[108:111], a[228:231], v[236:239], a[108:111]
    v_cvt_pk_bf16_f32 v212, v251, v212
    v_cvt_pk_bf16_f32 v210, v250, v210
    v_mfma_f32_16x16x32_bf16 a[108:111], a[240:243], v[228:231], a[108:111]
    s_waitcnt lgkmcnt(0)
    v_cvt_pk_bf16_f32 v208, v252, v249
    v_lshlrev_b32 v248, 16, v207
    v_mfma_f32_16x16x32_bf16 a[108:111], a[252:255], v[232:235], a[108:111]
    v_lshlrev_b32 v249, 16, v209
    v_lshlrev_b32 v250, 16, v211
    v_mfma_f32_16x16x32_bf16 a[112:115], v[240:243], v[232:235], a[112:115]
    buffer_load_dwordx4 a[212:215], v254, s[8:11], s42 offen offset:2048 sc1
    v_mfma_f32_16x16x32_bf16 a[112:115], a[244:247], v[228:231], a[112:115]
    s_mov_b32 s42, 522240
    v_lshlrev_b32 v251, 16, v213
    v_and_b32 v207, s22, v207
    v_mfma_f32_16x16x32_bf16 a[112:115], a[232:235], v[236:239], a[112:115]
    v_and_b32 v209, s22, v209
    v_and_b32 v211, s22, v211
    v_mfma_f32_16x16x32_bf16 a[116:119], a[236:239], v[236:239], a[116:119]
    ds_read_b128 v[236:239], v253 offset:10400
    v_and_b32 v213, s22, v213
    v_mfma_f32_16x16x32_bf16 a[116:119], a[248:251], v[228:231], a[116:119]
    buffer_load_dwordx4 a[216:219], v254, s[8:11], s42 offen offset:0 sc1
    v_mfma_f32_16x16x32_bf16 a[116:119], v[244:247], v[232:235], a[116:119]
    v_lshlrev_b32 v252, 16, v205
    v_and_b32 v205, s22, v205
    v_mfma_f32_16x16x32_bf16 a[120:123], a[228:231], v[228:231], a[120:123]
    v_fmac_f32 v252, s25, v251
    v_fmac_f32 v205, s25, v213
    v_mfma_f32_16x16x32_bf16 a[120:123], a[240:243], v[232:235], a[120:123]
    s_waitcnt lgkmcnt(0)
    v_fmac_f32 v252, s28, v249
    v_fmac_f32 v205, s28, v209
    v_mfma_f32_16x16x32_bf16 a[120:123], a[252:255], v[236:239], a[120:123]
    v_cvt_pk_bf16_f32 v205, v252, v205
    v_lshlrev_b32 v252, 16, v215
    v_mfma_f32_16x16x32_bf16 a[124:127], v[240:243], v[236:239], a[124:127]
    buffer_load_dwordx4 a[220:223], v254, s[8:11], s42 offen offset:1024 sc1
    v_mfma_f32_16x16x32_bf16 a[124:127], a[244:247], v[232:235], a[124:127]
    v_and_b32 v215, s22, v215
    v_fmac_f32 v252, s29, v248
    v_mfma_f32_16x16x32_bf16 a[124:127], a[232:235], v[228:231], a[124:127]
    v_fmac_f32 v215, s29, v207
    v_fmac_f32 v252, s23, v250
    v_fmac_f32 v215, s23, v211
    v_mfma_f32_16x16x32_bf16 a[128:131], a[236:239], v[228:231], a[128:131]
    ds_read_b128 v[228:231], v253 offset:12224
    v_cvt_pk_bf16_f32 v215, v252, v215
    v_mfma_f32_16x16x32_bf16 a[128:131], a[248:251], v[232:235], a[128:131]
    buffer_load_dwordx4 a[224:227], v254, s[8:11], s42 offen offset:2048 sc1
    v_mfma_f32_16x16x32_bf16 a[128:131], v[244:247], v[236:239], a[128:131]
    v_fma_f32 v252, v249, s24, v251
    v_fmac_f32 v251, -4.0, v249
    v_mfma_f32_16x16x32_bf16 a[132:135], a[228:231], v[232:235], a[132:135]
    v_and_b32 v203, 0x7fff, v255
    v_fma_f32 v249, v248, s24, v250
    v_mfma_f32_16x16x32_bf16 a[132:135], a[240:243], v[236:239], a[132:135]
    s_waitcnt lgkmcnt(0)
    v_fmac_f32 v250, -4.0, v248
    v_fma_f32 v248, v250, s26, v251
    v_mfma_f32_16x16x32_bf16 a[132:135], a[252:255], v[228:231], a[132:135]
    buffer_load_dwordx2 v[192:193], v203, s[4:7], s16 offen offset:1408
    v_mfma_f32_16x16x32_bf16 a[136:139], v[240:243], v[228:231], a[136:139]
    v_fmac_f32 v251, s27, v250
    v_fma_f32 v250, v249, 2.0, v252
    v_mfma_f32_16x16x32_bf16 a[136:139], a[244:247], v[236:239], a[136:139]
    v_fmac_f32 v252, -2.0, v249
    v_fma_f32 v249, v209, s24, v213
    v_mfma_f32_16x16x32_bf16 a[136:139], a[232:235], v[232:235], a[136:139]
    v_fmac_f32 v213, -4.0, v209
    v_fma_f32 v209, v207, s24, v211
    v_mfma_f32_16x16x32_bf16 a[140:143], a[236:239], v[232:235], a[140:143]
    ds_read_b128 v[232:235], v253 offset:11968
    v_fmac_f32 v211, -4.0, v207
    v_mfma_f32_16x16x32_bf16 a[140:143], a[248:251], v[236:239], a[140:143]
    buffer_load_dwordx2 v[194:195], v203, s[4:7], s17 offen offset:1408
    v_mfma_f32_16x16x32_bf16 a[140:143], v[244:247], v[228:231], a[140:143]
    v_fma_f32 v207, v211, s26, v213
    v_fmac_f32 v213, s27, v211
    v_mfma_f32_16x16x32_bf16 a[144:147], a[228:231], v[236:239], a[144:147]
    v_fma_f32 v211, v209, 2.0, v249
    v_fmac_f32 v249, -2.0, v209
    v_mfma_f32_16x16x32_bf16 a[144:147], a[240:243], v[228:231], a[144:147]
    s_waitcnt lgkmcnt(0)
    v_cvt_pk_bf16_f32 v207, v248, v207
    v_cvt_pk_bf16_f32 v213, v251, v213
    v_mfma_f32_16x16x32_bf16 a[144:147], a[252:255], v[232:235], a[144:147]
    buffer_load_dwordx2 v[196:197], v203, s[4:7], s18 offen offset:1408
    v_mfma_f32_16x16x32_bf16 a[148:151], v[240:243], v[232:235], a[148:151]
    v_cvt_pk_bf16_f32 v211, v250, v211
    v_cvt_pk_bf16_f32 v209, v252, v249
    v_mfma_f32_16x16x32_bf16 a[148:151], a[244:247], v[228:231], a[148:151]
    v_lshrrev_b32 v252, 15, v255
    v_mfma_f32_16x16x32_bf16 a[148:151], a[232:235], v[236:239], a[148:151]
    ds_write_b64 v252, v[206:207] offset:512
    v_mfma_f32_16x16x32_bf16 a[152:155], a[236:239], v[236:239], a[152:155]
    ds_read_b128 v[236:239], v253 offset:11712
    v_lshrrev_b32 v206, 15, v255
    v_mfma_f32_16x16x32_bf16 a[152:155], a[248:251], v[228:231], a[152:155]
    buffer_load_dwordx2 v[198:199], v203, s[4:7], s19 offen offset:1408
    v_mfma_f32_16x16x32_bf16 a[152:155], v[244:247], v[232:235], a[152:155]
    ds_write_b64 v206, v[212:213] offset:2592
    v_mfma_f32_16x16x32_bf16 a[156:159], a[228:231], v[228:231], a[156:159]
    v_mfma_f32_16x16x32_bf16 a[156:159], a[240:243], v[232:235], a[156:159]
    s_waitcnt lgkmcnt(1)
    s_waitcnt vmcnt(13)
    v_lshlrev_b32 v248, 16, v218
    v_mfma_f32_16x16x32_bf16 a[156:159], a[252:255], v[236:239], a[156:159]
    buffer_load_dwordx2 v[200:201], v203, s[4:7], s20 offen offset:1408
    v_mfma_f32_16x16x32_bf16 a[160:163], v[240:243], v[236:239], a[160:163]
    ds_write_b64 v206, v[210:211] offset:4672
    v_mfma_f32_16x16x32_bf16 a[160:163], a[244:247], v[232:235], a[160:163]
    v_lshlrev_b32 v249, 16, v220
    v_lshlrev_b32 v250, 16, v222
    v_mfma_f32_16x16x32_bf16 a[160:163], a[232:235], v[228:231], a[160:163]
    ds_write_b64 v206, v[204:205] offset:21312
    v_mfma_f32_16x16x32_bf16 a[164:167], a[236:239], v[228:231], a[164:167]
    ds_read_b128 v[228:231], v253 offset:11456
    v_lshlrev_b32 v251, 16, v224
    v_mfma_f32_16x16x32_bf16 a[164:167], a[248:251], v[232:235], a[164:167]
    buffer_load_dwordx2 v[202:203], v203, s[4:7], s21 offen offset:1408
    v_mfma_f32_16x16x32_bf16 a[164:167], v[244:247], v[236:239], a[164:167]
    ds_write_b64 v206, v[214:215] offset:29632
    v_mfma_f32_16x16x32_bf16 a[168:171], a[228:231], v[232:235], a[168:171]
    v_and_b32 v218, s22, v218
    v_and_b32 v220, s22, v220
    v_mfma_f32_16x16x32_bf16 a[168:171], a[240:243], v[236:239], a[168:171]
    s_waitcnt lgkmcnt(1)
    v_and_b32 v222, s22, v222
    v_and_b32 v224, s22, v224
    v_mfma_f32_16x16x32_bf16 a[168:171], a[252:255], v[228:231], a[168:171]
    ds_write_b64 v206, v[208:209] offset:6752
    v_mfma_f32_16x16x32_bf16 a[172:175], v[240:243], v[228:231], a[172:175]
    ds_read_b128 v[204:207], v253 offset:40288
    s_mov_b32 s45, 472974346
    v_mfma_f32_16x16x32_bf16 a[172:175], a[244:247], v[236:239], a[172:175]
    v_bfe_u32 v208, v254, 5, 3
    v_mul_u32_u24 v209, 5, v208
    v_mfma_f32_16x16x32_bf16 a[172:175], a[232:235], v[232:235], a[172:175]
    v_bfe_u32 v209, s45, v209, 5
    v_mul_u32_u24 v209, 65, v209
    v_mfma_f32_16x16x32_bf16 a[176:179], a[236:239], v[232:235], a[176:179]
    ds_read_b128 v[232:235], v253 offset:11184
    v_sub_u32 v209, v209, v208
    v_mfma_f32_16x16x32_bf16 a[176:179], a[248:251], v[236:239], a[176:179]
    v_lshl_add_u32 v208, v209, 5, v253
    s_waitcnt lgkmcnt(1)
    v_mfma_f32_16x16x32_bf16 a[176:179], v[244:247], v[228:231], a[176:179]
    s_mov_b32 s42, 552960
    v_lshlrev_b32 v252, 16, v216
    v_and_b32 v216, s22, v216
    v_mfma_f32_16x16x32_bf16 a[180:183], a[228:231], v[236:239], a[180:183]
    s_mov_b64 exec, s[46:47]
    ds_write_b128 v208, v[204:207] offset:1024
    s_mov_b64 exec, -1
    v_fmac_f32 v252, s25, v251
    v_mfma_f32_16x16x32_bf16 a[184:187], a[232:235], v[236:239], a[184:187]
    v_fmac_f32 v216, s25, v224
    v_fmac_f32 v252, s28, v249
    v_mfma_f32_16x16x32_bf16 a[188:191], a[236:239], v[236:239], a[188:191]
    ds_read_b128 v[236:239], v253 offset:13520
    v_fmac_f32 v216, s28, v220
    v_mfma_f32_16x16x32_bf16 a[188:191], a[248:251], v[228:231], a[188:191]
    buffer_load_dwordx4 a[228:231], v254, s[8:11], s42 offen offset:0 sc1
    v_mfma_f32_16x16x32_bf16 a[184:187], a[244:247], v[228:231], a[184:187]
    s_waitcnt lgkmcnt(2)
    v_cvt_pk_bf16_f32 v216, v252, v216
    v_lshlrev_b32 v252, 16, v226
    v_mfma_f32_16x16x32_bf16 a[180:183], a[240:243], v[228:231], a[180:183]
    ds_read_b128 v[228:231], v253 offset:13248
    v_and_b32 v226, s22, v226
    v_mfma_f32_16x16x32_bf16 a[180:183], a[252:255], v[232:235], a[180:183]
    buffer_load_dwordx4 a[232:235], v254, s[8:11], s42 offen offset:1024 sc1
    v_mfma_f32_16x16x32_bf16 a[184:187], v[240:243], v[232:235], a[184:187]
    s_waitcnt vmcnt(14) lgkmcnt(1)
    v_fmac_f32 v252, s29, v248
    v_fmac_f32 v226, s29, v218
    v_mfma_f32_16x16x32_bf16 a[188:191], v[244:247], v[232:235], a[188:191]
    ds_read_b128 v[232:235], v253 offset:12992
    v_fmac_f32 v252, s23, v250
sub14:
    v_mfma_f32_16x16x32_bf16 v[0:3], a[192:195], v[236:239], v[0:3]
    buffer_load_dwordx4 a[236:239], v254, s[8:11], s42 offen offset:2048 sc1
    v_mfma_f32_16x16x32_bf16 v[4:7], a[196:199], v[236:239], v[4:7]
    s_mov_b32 s42, 556032
    v_fmac_f32 v226, s23, v222
    v_cvt_pk_bf16_f32 v226, v252, v226
    v_mfma_f32_16x16x32_bf16 v[8:11], a[200:203], v[236:239], v[8:11]
    ds_read_b128 v[236:239], v253 offset:12736
    s_waitcnt vmcnt(12)
    s_waitcnt lgkmcnt(2)
    v_mfma_f32_16x16x32_bf16 v[8:11], a[212:215], v[228:231], v[8:11]
    v_fma_f32 v252, v249, s24, v251
    v_fmac_f32 v251, -4.0, v249
    v_mfma_f32_16x16x32_bf16 v[4:7], a[208:211], v[228:231], v[4:7]
    buffer_load_dwordx4 a[240:243], v254, s[8:11], s42 offen offset:0 sc1
    v_mfma_f32_16x16x32_bf16 v[0:3], a[204:207], v[228:231], v[0:3]
    s_waitcnt vmcnt(10) lgkmcnt(1)
    v_fma_f32 v249, v248, s24, v250
    v_fmac_f32 v250, -4.0, v248
    v_mfma_f32_16x16x32_bf16 v[0:3], a[216:219], v[232:235], v[0:3]
    v_fma_f32 v248, v250, s26, v251
    v_fmac_f32 v251, s27, v250
    v_mfma_f32_16x16x32_bf16 v[4:7], a[220:223], v[232:235], v[4:7]
    v_fma_f32 v250, v249, 2.0, v252
    v_fmac_f32 v252, -2.0, v249
    v_mfma_f32_16x16x32_bf16 v[8:11], a[224:227], v[232:235], v[8:11]
    buffer_load_dwordx4 a[244:247], v254, s[8:11], s42 offen offset:1024 sc1
    v_mfma_f32_16x16x32_bf16 v[12:15], a[192:195], v[228:231], v[12:15]
    v_fma_f32 v249, v220, s24, v224
    v_fmac_f32 v224, -4.0, v220
    v_mfma_f32_16x16x32_bf16 v[12:15], a[204:207], v[232:235], v[12:15]
    s_waitcnt lgkmcnt(0)
    v_fma_f32 v220, v218, s24, v222
    v_fmac_f32 v222, -4.0, v218
    v_mfma_f32_16x16x32_bf16 v[12:15], a[216:219], v[236:239], v[12:15]
    v_fma_f32 v218, v222, s26, v224
    v_fmac_f32 v224, s27, v222
    v_mfma_f32_16x16x32_bf16 v[16:19], a[220:223], v[236:239], v[16:19]
    buffer_load_dwordx4 a[248:251], v254, s[8:11], s42 offen offset:2048 sc1
    v_mfma_f32_16x16x32_bf16 v[16:19], a[208:211], v[232:235], v[16:19]
    s_mov_b32 s42, 559104
    v_fma_f32 v222, v220, 2.0, v249
    v_fmac_f32 v249, -2.0, v220
    v_mfma_f32_16x16x32_bf16 v[16:19], a[196:199], v[228:231], v[16:19]
    v_cvt_pk_bf16_f32 v218, v248, v218
    v_cvt_pk_bf16_f32 v224, v251, v224
    v_mfma_f32_16x16x32_bf16 v[20:23], a[200:203], v[228:231], v[20:23]
    ds_read_b128 v[228:231], v253 offset:12480
    v_cvt_pk_bf16_f32 v222, v250, v222
    v_mfma_f32_16x16x32_bf16 v[20:23], a[212:215], v[232:235], v[20:23]
    buffer_load_dwordx4 a[252:255], v254, s[8:11], s42 offen offset:0 sc1
    v_mfma_f32_16x16x32_bf16 v[20:23], a[224:227], v[236:239], v[20:23]
    v_cvt_pk_bf16_f32 v220, v252, v249
    v_lshlrev_b32 v248, 16, v219
    v_mfma_f32_16x16x32_bf16 v[24:27], a[192:195], v[232:235], v[24:27]
    v_lshlrev_b32 v249, 16, v221
    v_lshlrev_b32 v250, 16, v223
    v_mfma_f32_16x16x32_bf16 v[24:27], a[204:207], v[236:239], v[24:27]
    s_waitcnt lgkmcnt(0)
    v_lshlrev_b32 v251, 16, v225
    v_and_b32 v219, s22, v219
    v_mfma_f32_16x16x32_bf16 v[24:27], a[216:219], v[228:231], v[24:27]
    v_and_b32 v221, s22, v221
    v_and_b32 v223, s22, v223
    v_mfma_f32_16x16x32_bf16 v[28:31], a[220:223], v[228:231], v[28:31]
    buffer_load_dwordx4 v[240:243], v254, s[8:11], s42 offen offset:1024 sc1
    v_mfma_f32_16x16x32_bf16 v[28:31], a[208:211], v[236:239], v[28:31]
    v_and_b32 v225, s22, v225
    v_lshlrev_b32 v252, 16, v217
    v_mfma_f32_16x16x32_bf16 v[28:31], a[196:199], v[232:235], v[28:31]
    v_and_b32 v217, s22, v217
    v_fmac_f32 v252, s25, v251
    v_mfma_f32_16x16x32_bf16 v[32:35], a[200:203], v[232:235], v[32:35]
    ds_read_b128 v[232:235], v253 offset:14304
    v_fmac_f32 v217, s25, v225
    v_mfma_f32_16x16x32_bf16 v[32:35], a[212:215], v[236:239], v[32:35]
    buffer_load_dwordx4 v[244:247], v254, s[8:11], s42 offen offset:2048 sc1
    v_mfma_f32_16x16x32_bf16 v[32:35], a[224:227], v[228:231], v[32:35]
    v_fmac_f32 v252, s28, v249
    v_fmac_f32 v217, s28, v221
    v_mfma_f32_16x16x32_bf16 v[36:39], a[192:195], v[236:239], v[36:39]
    v_and_b32 v215, 0x7fff, v255
    v_cvt_pk_bf16_f32 v217, v252, v217
    v_mfma_f32_16x16x32_bf16 v[36:39], a[204:207], v[228:231], v[36:39]
    s_waitcnt lgkmcnt(0)
    v_lshlrev_b32 v252, 16, v227
    v_and_b32 v227, s22, v227
    v_mfma_f32_16x16x32_bf16 v[36:39], a[216:219], v[232:235], v[36:39]
    buffer_load_dwordx2 v[204:205], v215, s[4:7], s16 offen offset:320
    v_mfma_f32_16x16x32_bf16 v[40:43], a[220:223], v[232:235], v[40:43]
    v_fmac_f32 v252, s29, v248
    v_fmac_f32 v227, s29, v219
    v_mfma_f32_16x16x32_bf16 v[40:43], a[208:211], v[228:231], v[40:43]
    v_fmac_f32 v252, s23, v250
    v_fmac_f32 v227, s23, v223
    v_cvt_pk_bf16_f32 v227, v252, v227
    v_mfma_f32_16x16x32_bf16 v[40:43], a[196:199], v[236:239], v[40:43]
    v_fma_f32 v252, v249, s24, v251
    v_fmac_f32 v251, -4.0, v249
    v_mfma_f32_16x16x32_bf16 v[44:47], a[200:203], v[236:239], v[44:47]
    ds_read_b128 v[236:239], v253 offset:14048
    v_fma_f32 v249, v248, s24, v250
    v_mfma_f32_16x16x32_bf16 v[44:47], a[212:215], v[228:231], v[44:47]
    buffer_load_dwordx2 v[206:207], v215, s[4:7], s17 offen offset:320
    v_mfma_f32_16x16x32_bf16 v[44:47], a[224:227], v[232:235], v[44:47]
    v_fmac_f32 v250, -4.0, v248
    v_fma_f32 v248, v250, s26, v251
    v_mfma_f32_16x16x32_bf16 v[48:51], a[192:195], v[228:231], v[48:51]
    v_fmac_f32 v251, s27, v250
    v_fma_f32 v250, v249, 2.0, v252
    v_mfma_f32_16x16x32_bf16 v[48:51], a[204:207], v[232:235], v[48:51]
    s_waitcnt lgkmcnt(0)
    v_fmac_f32 v252, -2.0, v249
    v_fma_f32 v249, v221, s24, v225
    v_mfma_f32_16x16x32_bf16 v[48:51], a[216:219], v[236:239], v[48:51]
    buffer_load_dwordx2 v[208:209], v215, s[4:7], s18 offen offset:320
    v_mfma_f32_16x16x32_bf16 v[52:55], a[220:223], v[236:239], v[52:55]
    v_fmac_f32 v225, -4.0, v221
    v_fma_f32 v221, v219, s24, v223
    v_mfma_f32_16x16x32_bf16 v[52:55], a[208:211], v[232:235], v[52:55]
    v_fmac_f32 v223, -4.0, v219
    v_fma_f32 v219, v223, s26, v225
    v_mfma_f32_16x16x32_bf16 v[52:55], a[196:199], v[228:231], v[52:55]
    v_fmac_f32 v225, s27, v223
    v_fma_f32 v223, v221, 2.0, v249
    v_mfma_f32_16x16x32_bf16 v[56:59], a[200:203], v[228:231], v[56:59]
    ds_read_b128 v[228:231], v253 offset:13792
    v_fmac_f32 v249, -2.0, v221
    v_mfma_f32_16x16x32_bf16 v[56:59], a[212:215], v[232:235], v[56:59]
    buffer_load_dwordx2 v[210:211], v215, s[4:7], s19 offen offset:320
    v_mfma_f32_16x16x32_bf16 v[56:59], a[224:227], v[236:239], v[56:59]
    v_cvt_pk_bf16_f32 v219, v248, v219
    v_cvt_pk_bf16_f32 v225, v251, v225
    v_mfma_f32_16x16x32_bf16 v[60:63], a[192:195], v[232:235], v[60:63]
    v_cvt_pk_bf16_f32 v223, v250, v223
    v_cvt_pk_bf16_f32 v221, v252, v249
    v_mfma_f32_16x16x32_bf16 v[60:63], a[204:207], v[236:239], v[60:63]
pad5:
    s_cbranch_vccnz pad9
    s_waitcnt lgkmcnt(0)
    v_lshrrev_b32 v252, 15, v255
    v_mfma_f32_16x16x32_bf16 v[60:63], a[216:219], v[228:231], v[60:63]
    buffer_load_dwordx2 v[212:213], v215, s[4:7], s20 offen offset:320
    v_mfma_f32_16x16x32_bf16 v[64:67], a[220:223], v[228:231], v[64:67]
    ds_write_b64 v252, v[218:219] offset:256
    v_mfma_f32_16x16x32_bf16 v[64:67], a[208:211], v[236:239], v[64:67]
    s_waitcnt vmcnt(14)
    v_lshrrev_b32 v218, 15, v255
    v_lshlrev_b32 v248, 16, v194
    v_mfma_f32_16x16x32_bf16 v[64:67], a[196:199], v[232:235], v[64:67]
    ds_write_b64 v218, v[224:225] offset:2336
    v_mfma_f32_16x16x32_bf16 v[68:71], a[200:203], v[232:235], v[68:71]
    ds_read_b128 v[232:235], v253 offset:13536
    v_lshlrev_b32 v249, 16, v196
    v_mfma_f32_16x16x32_bf16 v[68:71], a[212:215], v[236:239], v[68:71]
    buffer_load_dwordx2 v[214:215], v215, s[4:7], s21 offen offset:320
    v_mfma_f32_16x16x32_bf16 v[68:71], a[224:227], v[228:231], v[68:71]
    ds_write_b64 v218, v[222:223] offset:4416
    v_mfma_f32_16x16x32_bf16 v[72:75], a[192:195], v[236:239], v[72:75]
    v_lshlrev_b32 v250, 16, v198
    v_lshlrev_b32 v251, 16, v200
    v_mfma_f32_16x16x32_bf16 v[72:75], a[204:207], v[228:231], v[72:75]
    s_waitcnt lgkmcnt(1)
    v_and_b32 v194, s22, v194
    v_and_b32 v196, s22, v196
    v_mfma_f32_16x16x32_bf16 v[72:75], a[216:219], v[232:235], v[72:75]
    ds_write_b64 v218, v[216:217] offset:21056
    v_mfma_f32_16x16x32_bf16 v[76:79], a[220:223], v[232:235], v[76:79]
    v_and_b32 v198, s22, v198
    v_and_b32 v200, s22, v200
    v_mfma_f32_16x16x32_bf16 v[76:79], a[208:211], v[228:231], v[76:79]
    ds_write_b64 v218, v[226:227] offset:29376
    v_mfma_f32_16x16x32_bf16 v[76:79], a[196:199], v[236:239], v[76:79]
    v_lshlrev_b32 v252, 16, v192
    v_and_b32 v192, s22, v192
    v_mfma_f32_16x16x32_bf16 v[80:83], a[200:203], v[236:239], v[80:83]
    ds_read_b128 v[236:239], v253 offset:13264
    v_fmac_f32 v252, s25, v251
    v_mfma_f32_16x16x32_bf16 v[80:83], a[212:215], v[228:231], v[80:83]
    ds_write_b64 v218, v[220:221] offset:6496
    v_mfma_f32_16x16x32_bf16 v[80:83], a[224:227], v[232:235], v[80:83]
    s_mov_b32 s42, 589824
    v_fmac_f32 v192, s25, v200
    v_fmac_f32 v252, s28, v249
    v_mfma_f32_16x16x32_bf16 v[84:87], a[192:195], v[228:231], v[84:87]
    v_fmac_f32 v192, s28, v196
    v_cvt_pk_bf16_f32 v192, v252, v192
    v_mfma_f32_16x16x32_bf16 v[88:91], a[196:199], v[228:231], v[88:91]
    v_lshlrev_b32 v252, 16, v202
    v_and_b32 v202, s22, v202
    v_mfma_f32_16x16x32_bf16 v[92:95], a[200:203], v[228:231], v[92:95]
    ds_read_b128 v[228:231], v253 offset:32240
    v_fmac_f32 v252, s29, v248
    v_mfma_f32_16x16x32_bf16 v[92:95], a[212:215], v[232:235], v[92:95]
    buffer_load_dwordx4 a[192:195], v254, s[8:11], s42 offen offset:0 sc1
    v_mfma_f32_16x16x32_bf16 v[88:91], a[208:211], v[232:235], v[88:91]
    s_waitcnt lgkmcnt(2)
    v_fmac_f32 v202, s29, v194
    v_fmac_f32 v252, s23, v250
    v_mfma_f32_16x16x32_bf16 v[84:87], a[204:207], v[232:235], v[84:87]
    ds_read_b128 v[232:235], v253 offset:31968
    v_fmac_f32 v202, s23, v198
    v_mfma_f32_16x16x32_bf16 v[84:87], a[216:219], v[236:239], v[84:87]
    buffer_load_dwordx4 a[196:199], v254, s[8:11], s42 offen offset:1024 sc1
    v_mfma_f32_16x16x32_bf16 v[88:91], a[220:223], v[236:239], v[88:91]
    s_waitcnt vmcnt(14) lgkmcnt(1)
    v_cvt_pk_bf16_f32 v202, v252, v202
    v_fma_f32 v252, v249, s24, v251
    v_mfma_f32_16x16x32_bf16 v[92:95], a[224:227], v[236:239], v[92:95]
    ds_read_b128 v[236:239], v253 offset:31712
    v_fmac_f32 v251, -4.0, v249
    v_fma_f32 v249, v248, s24, v250
sub15:
    v_mfma_f32_16x16x32_bf16 v[96:99], a[228:231], v[228:231], v[96:99]
    buffer_load_dwordx4 a[200:203], v254, s[8:11], s42 offen offset:2048 sc1
    v_mfma_f32_16x16x32_bf16 v[100:103], a[232:235], v[228:231], v[100:103]
    s_mov_b32 s42, 592896
    v_fmac_f32 v250, -4.0, v248
    v_fma_f32 v248, v250, s26, v251
    v_mfma_f32_16x16x32_bf16 v[104:107], a[236:239], v[228:231], v[104:107]
    ds_read_b128 v[228:231], v253 offset:31456
    s_waitcnt vmcnt(12)
    s_waitcnt lgkmcnt(2)
    v_mfma_f32_16x16x32_bf16 v[104:107], a[248:251], v[232:235], v[104:107]
    v_fmac_f32 v251, s27, v250
    v_fma_f32 v250, v249, 2.0, v252
    v_mfma_f32_16x16x32_bf16 v[100:103], a[244:247], v[232:235], v[100:103]
    buffer_load_dwordx4 a[204:207], v254, s[8:11], s42 offen offset:0 sc1
    v_mfma_f32_16x16x32_bf16 v[96:99], a[240:243], v[232:235], v[96:99]
    s_waitcnt vmcnt(10) lgkmcnt(1)
    v_fmac_f32 v252, -2.0, v249
    v_fma_f32 v249, v196, s24, v200
    v_mfma_f32_16x16x32_bf16 v[96:99], a[252:255], v[236:239], v[96:99]
    v_fmac_f32 v200, -4.0, v196
    v_fma_f32 v196, v194, s24, v198
    v_mfma_f32_16x16x32_bf16 v[100:103], v[240:243], v[236:239], v[100:103]
    v_fmac_f32 v198, -4.0, v194
    v_fma_f32 v194, v198, s26, v200
    v_mfma_f32_16x16x32_bf16 v[104:107], v[244:247], v[236:239], v[104:107]
    buffer_load_dwordx4 a[208:211], v254, s[8:11], s42 offen offset:1024 sc1
    v_mfma_f32_16x16x32_bf16 v[108:111], a[228:231], v[232:235], v[108:111]
    v_fmac_f32 v200, s27, v198
    v_fma_f32 v198, v196, 2.0, v249
    v_mfma_f32_16x16x32_bf16 v[108:111], a[240:243], v[236:239], v[108:111]
    s_waitcnt lgkmcnt(0)
    v_fmac_f32 v249, -2.0, v196
    v_cvt_pk_bf16_f32 v194, v248, v194
    v_mfma_f32_16x16x32_bf16 v[108:111], a[252:255], v[228:231], v[108:111]
    v_cvt_pk_bf16_f32 v200, v251, v200
    v_cvt_pk_bf16_f32 v198, v250, v198
    v_mfma_f32_16x16x32_bf16 v[112:115], v[240:243], v[228:231], v[112:115]
    buffer_load_dwordx4 a[212:215], v254, s[8:11], s42 offen offset:2048 sc1
    v_mfma_f32_16x16x32_bf16 v[112:115], a[244:247], v[236:239], v[112:115]
    s_mov_b32 s42, 595968
    v_cvt_pk_bf16_f32 v196, v252, v249
    v_lshlrev_b32 v248, 16, v195
    v_mfma_f32_16x16x32_bf16 v[112:115], a[232:235], v[232:235], v[112:115]
    v_lshlrev_b32 v249, 16, v197
    v_lshlrev_b32 v250, 16, v199
    v_mfma_f32_16x16x32_bf16 v[116:119], a[236:239], v[232:235], v[116:119]
    ds_read_b128 v[232:235], v253 offset:31200
    v_lshlrev_b32 v251, 16, v201
    v_mfma_f32_16x16x32_bf16 v[116:119], a[248:251], v[236:239], v[116:119]
    buffer_load_dwordx4 a[216:219], v254, s[8:11], s42 offen offset:0 sc1
    v_mfma_f32_16x16x32_bf16 v[116:119], v[244:247], v[228:231], v[116:119]
    v_and_b32 v195, s22, v195
    v_and_b32 v197, s22, v197
    v_mfma_f32_16x16x32_bf16 v[120:123], a[228:231], v[236:239], v[120:123]
    v_and_b32 v199, s22, v199
    v_and_b32 v201, s22, v201
    v_mfma_f32_16x16x32_bf16 v[120:123], a[240:243], v[228:231], v[120:123]
    s_waitcnt lgkmcnt(0)
    v_lshlrev_b32 v252, 16, v193
    v_and_b32 v193, s22, v193
    v_mfma_f32_16x16x32_bf16 v[120:123], a[252:255], v[232:235], v[120:123]
    v_fmac_f32 v252, s25, v251
    v_fmac_f32 v193, s25, v201
    v_mfma_f32_16x16x32_bf16 v[124:127], v[240:243], v[232:235], v[124:127]
    buffer_load_dwordx4 a[220:223], v254, s[8:11], s42 offen offset:1024 sc1
    v_mfma_f32_16x16x32_bf16 v[124:127], a[244:247], v[228:231], v[124:127]
    v_fmac_f32 v252, s28, v249
    v_fmac_f32 v193, s28, v197
    v_mfma_f32_16x16x32_bf16 v[124:127], a[232:235], v[236:239], v[124:127]
    v_cvt_pk_bf16_f32 v193, v252, v193
    v_lshlrev_b32 v252, 16, v203
    v_mfma_f32_16x16x32_bf16 v[128:131], a[236:239], v[236:239], v[128:131]
    ds_read_b128 v[236:239], v253 offset:33024
    v_and_b32 v203, s22, v203
    v_mfma_f32_16x16x32_bf16 v[128:131], a[248:251], v[228:231], v[128:131]
    buffer_load_dwordx4 a[224:227], v254, s[8:11], s42 offen offset:2048 sc1
    v_mfma_f32_16x16x32_bf16 v[128:131], v[244:247], v[232:235], v[128:131]
    v_fmac_f32 v252, s29, v248
    v_fmac_f32 v203, s29, v195
    v_mfma_f32_16x16x32_bf16 v[132:135], a[228:231], v[228:231], v[132:135]
    v_and_b32 v227, 0x7fff, v255
    v_fmac_f32 v252, s23, v250
    v_mfma_f32_16x16x32_bf16 v[132:135], a[240:243], v[232:235], v[132:135]
    s_waitcnt lgkmcnt(0)
    v_fmac_f32 v203, s23, v199
    v_cvt_pk_bf16_f32 v203, v252, v203
    v_mfma_f32_16x16x32_bf16 v[132:135], a[252:255], v[236:239], v[132:135]
    buffer_load_dwordx2 v[216:217], v227, s[4:7], s16 offen offset:704
    v_mfma_f32_16x16x32_bf16 v[136:139], v[240:243], v[236:239], v[136:139]
    v_fma_f32 v252, v249, s24, v251
    v_fmac_f32 v251, -4.0, v249
    v_mfma_f32_16x16x32_bf16 v[136:139], a[244:247], v[232:235], v[136:139]
    v_fma_f32 v249, v248, s24, v250
    v_fmac_f32 v250, -4.0, v248
    v_mfma_f32_16x16x32_bf16 v[136:139], a[232:235], v[228:231], v[136:139]
    v_fma_f32 v248, v250, s26, v251
    v_fmac_f32 v251, s27, v250
    v_mfma_f32_16x16x32_bf16 v[140:143], a[236:239], v[228:231], v[140:143]
    ds_read_b128 v[228:231], v253 offset:32768
    v_fma_f32 v250, v249, 2.0, v252
    v_mfma_f32_16x16x32_bf16 v[140:143], a[248:251], v[232:235], v[140:143]
    buffer_load_dwordx2 v[218:219], v227, s[4:7], s17 offen offset:704
    v_mfma_f32_16x16x32_bf16 v[140:143], v[244:247], v[236:239], v[140:143]
    v_fmac_f32 v252, -2.0, v249
    v_fma_f32 v249, v197, s24, v201
    v_mfma_f32_16x16x32_bf16 v[144:147], a[228:231], v[232:235], v[144:147]
    v_fmac_f32 v201, -4.0, v197
    v_fma_f32 v197, v195, s24, v199
    v_mfma_f32_16x16x32_bf16 v[144:147], a[240:243], v[236:239], v[144:147]
    s_waitcnt lgkmcnt(0)
    v_fmac_f32 v199, -4.0, v195
    v_fma_f32 v195, v199, s26, v201
    v_mfma_f32_16x16x32_bf16 v[144:147], a[252:255], v[228:231], v[144:147]
    buffer_load_dwordx2 v[220:221], v227, s[4:7], s18 offen offset:704
    v_mfma_f32_16x16x32_bf16 v[148:151], v[240:243], v[228:231], v[148:151]
    v_fmac_f32 v201, s27, v199
    v_fma_f32 v199, v197, 2.0, v249
    v_fmac_f32 v249, -2.0, v197
    v_mfma_f32_16x16x32_bf16 v[148:151], a[244:247], v[236:239], v[148:151]
    v_cvt_pk_bf16_f32 v195, v248, v195
    v_cvt_pk_bf16_f32 v201, v251, v201
    v_mfma_f32_16x16x32_bf16 v[148:151], a[232:235], v[232:235], v[148:151]
    v_cvt_pk_bf16_f32 v199, v250, v199
    v_cvt_pk_bf16_f32 v197, v252, v249
    v_mfma_f32_16x16x32_bf16 v[152:155], a[236:239], v[232:235], v[152:155]
    ds_read_b128 v[232:235], v253 offset:32512
    v_lshrrev_b32 v252, 15, v255
    v_mfma_f32_16x16x32_bf16 v[152:155], a[248:251], v[236:239], v[152:155]
    buffer_load_dwordx2 v[222:223], v227, s[4:7], s19 offen offset:704
    v_mfma_f32_16x16x32_bf16 v[152:155], v[244:247], v[228:231], v[152:155]
    ds_write_b64 v252, v[194:195] offset:0
    v_mfma_f32_16x16x32_bf16 v[156:159], a[228:231], v[236:239], v[156:159]
    v_lshrrev_b32 v194, 15, v255
    v_mfma_f32_16x16x32_bf16 v[156:159], a[240:243], v[228:231], v[156:159]
    s_waitcnt lgkmcnt(1)
    s_waitcnt vmcnt(13)
    v_lshlrev_b32 v248, 16, v206
    v_mfma_f32_16x16x32_bf16 v[156:159], a[252:255], v[232:235], v[156:159]
    buffer_load_dwordx2 v[224:225], v227, s[4:7], s20 offen offset:704
    v_mfma_f32_16x16x32_bf16 v[160:163], v[240:243], v[232:235], v[160:163]
    ds_write_b64 v194, v[200:201] offset:2080
    v_mfma_f32_16x16x32_bf16 v[160:163], a[244:247], v[228:231], v[160:163]
    v_lshlrev_b32 v249, 16, v208
    v_lshlrev_b32 v250, 16, v210
    v_mfma_f32_16x16x32_bf16 v[160:163], a[232:235], v[236:239], v[160:163]
    ds_write_b64 v194, v[198:199] offset:4160
    v_mfma_f32_16x16x32_bf16 v[164:167], a[236:239], v[236:239], v[164:167]
    ds_read_b128 v[236:239], v253 offset:32256
    v_lshlrev_b32 v251, 16, v212
    v_mfma_f32_16x16x32_bf16 v[164:167], a[248:251], v[228:231], v[164:167]
    buffer_load_dwordx2 v[226:227], v227, s[4:7], s21 offen offset:704
    v_mfma_f32_16x16x32_bf16 v[164:167], v[244:247], v[232:235], v[164:167]
    ds_write_b64 v194, v[192:193] offset:20800
    v_mfma_f32_16x16x32_bf16 v[168:171], a[228:231], v[228:231], v[168:171]
    v_and_b32 v206, s22, v206
    v_and_b32 v208, s22, v208
    v_mfma_f32_16x16x32_bf16 v[168:171], a[240:243], v[232:235], v[168:171]
    s_waitcnt lgkmcnt(1)
    v_and_b32 v210, s22, v210
    v_and_b32 v212, s22, v212
    v_mfma_f32_16x16x32_bf16 v[168:171], a[252:255], v[236:239], v[168:171]
    ds_write_b64 v194, v[202:203] offset:29120
    v_mfma_f32_16x16x32_bf16 v[172:175], v[240:243], v[236:239], v[172:175]
    v_lshlrev_b32 v252, 16, v204
    v_and_b32 v204, s22, v204
    v_mfma_f32_16x16x32_bf16 v[172:175], a[244:247], v[232:235], v[172:175]
    ds_write_b64 v194, v[196:197] offset:6240
    v_mfma_f32_16x16x32_bf16 v[172:175], a[232:235], v[228:231], v[172:175]
    v_fmac_f32 v252, s25, v251
    v_fmac_f32 v204, s25, v212
    v_fmac_f32 v252, s28, v249
    v_mfma_f32_16x16x32_bf16 v[176:179], a[236:239], v[228:231], v[176:179]
    ds_read_b128 v[228:231], v253 offset:31984
    v_fmac_f32 v204, s28, v208
    v_mfma_f32_16x16x32_bf16 v[176:179], a[248:251], v[232:235], v[176:179]
    v_cvt_pk_bf16_f32 v204, v252, v204
    v_lshlrev_b32 v252, 16, v214
    v_mfma_f32_16x16x32_bf16 v[176:179], v[244:247], v[236:239], v[176:179]
    s_mov_b32 s42, 626688
    v_and_b32 v214, s22, v214
    v_fmac_f32 v252, s29, v248
    v_mfma_f32_16x16x32_bf16 v[180:183], a[228:231], v[232:235], v[180:183]
    s_waitcnt lgkmcnt(0)
    v_fmac_f32 v214, s29, v206
    v_fmac_f32 v252, s23, v250
    v_mfma_f32_16x16x32_bf16 v[184:187], a[232:235], v[232:235], v[184:187]
    s_barrier
    v_mfma_f32_16x16x32_bf16 v[188:191], a[236:239], v[232:235], v[188:191]
    ds_read_b128 v[232:235], v253 offset:1040
    v_fmac_f32 v214, s23, v210
    v_mfma_f32_16x16x32_bf16 v[188:191], a[248:251], v[236:239], v[188:191]
    buffer_load_dwordx4 a[228:231], v254, s[8:11], s42 offen offset:0 sc1
    v_mfma_f32_16x16x32_bf16 v[184:187], a[244:247], v[236:239], v[184:187]
    v_cvt_pk_bf16_f32 v214, v252, v214
    v_fma_f32 v252, v249, s24, v251
    v_mfma_f32_16x16x32_bf16 v[180:183], a[240:243], v[236:239], v[180:183]
    ds_read_b128 v[236:239], v253 offset:768
    v_fmac_f32 v251, -4.0, v249
    v_mfma_f32_16x16x32_bf16 v[180:183], a[252:255], v[228:231], v[180:183]
    buffer_load_dwordx4 a[232:235], v254, s[8:11], s42 offen offset:1024 sc1
    v_mfma_f32_16x16x32_bf16 v[184:187], v[240:243], v[228:231], v[184:187]
    s_waitcnt vmcnt(14) lgkmcnt(1)
    v_fma_f32 v249, v248, s24, v250
    v_fmac_f32 v250, -4.0, v248
    v_mfma_f32_16x16x32_bf16 v[188:191], v[244:247], v[228:231], v[188:191]
    ds_read_b128 v[228:231], v253 offset:512
    v_fma_f32 v248, v250, s26, v251
sub16:
    v_mfma_f32_16x16x32_bf16 a[0:3], a[192:195], v[232:235], a[0:3]
    buffer_load_dwordx4 a[236:239], v254, s[8:11], s42 offen offset:2048 sc1
    v_mfma_f32_16x16x32_bf16 a[4:7], a[196:199], v[232:235], a[4:7]
    s_mov_b32 s42, 629760
    v_fmac_f32 v251, s27, v250
    v_fma_f32 v250, v249, 2.0, v252
    v_mfma_f32_16x16x32_bf16 a[8:11], a[200:203], v[232:235], a[8:11]
    ds_read_b128 v[232:235], v253 offset:256
    s_waitcnt vmcnt(12)
    s_waitcnt lgkmcnt(2)
    v_mfma_f32_16x16x32_bf16 a[8:11], a[212:215], v[236:239], a[8:11]
    v_fmac_f32 v252, -2.0, v249
    v_fma_f32 v249, v208, s24, v212
    v_mfma_f32_16x16x32_bf16 a[4:7], a[208:211], v[236:239], a[4:7]
    buffer_load_dwordx4 a[240:243], v254, s[8:11], s42 offen offset:0 sc1
    v_mfma_f32_16x16x32_bf16 a[0:3], a[204:207], v[236:239], a[0:3]
    s_waitcnt vmcnt(10) lgkmcnt(1)
    v_fmac_f32 v212, -4.0, v208
    v_fma_f32 v208, v206, s24, v210
    v_mfma_f32_16x16x32_bf16 a[0:3], a[216:219], v[228:231], a[0:3]
    v_fmac_f32 v210, -4.0, v206
    v_fma_f32 v206, v210, s26, v212
    v_mfma_f32_16x16x32_bf16 a[4:7], a[220:223], v[228:231], a[4:7]
    v_fmac_f32 v212, s27, v210
    v_fma_f32 v210, v208, 2.0, v249
    v_fmac_f32 v249, -2.0, v208
    v_mfma_f32_16x16x32_bf16 a[8:11], a[224:227], v[228:231], a[8:11]
    buffer_load_dwordx4 a[244:247], v254, s[8:11], s42 offen offset:1024 sc1
    v_mfma_f32_16x16x32_bf16 a[12:15], a[192:195], v[236:239], a[12:15]
    v_cvt_pk_bf16_f32 v206, v248, v206
    v_cvt_pk_bf16_f32 v212, v251, v212
    v_mfma_f32_16x16x32_bf16 a[12:15], a[204:207], v[228:231], a[12:15]
    s_waitcnt lgkmcnt(0)
    v_cvt_pk_bf16_f32 v210, v250, v210
    v_cvt_pk_bf16_f32 v208, v252, v249
    v_mfma_f32_16x16x32_bf16 a[12:15], a[216:219], v[232:235], a[12:15]
    v_lshlrev_b32 v248, 16, v207
    v_lshlrev_b32 v249, 16, v209
    v_mfma_f32_16x16x32_bf16 a[16:19], a[220:223], v[232:235], a[16:19]
    buffer_load_dwordx4 a[248:251], v254, s[8:11], s42 offen offset:2048 sc1
    v_mfma_f32_16x16x32_bf16 a[16:19], a[208:211], v[228:231], a[16:19]
    s_mov_b32 s42, 632832
    v_lshlrev_b32 v250, 16, v211
    v_lshlrev_b32 v251, 16, v213
    v_mfma_f32_16x16x32_bf16 a[16:19], a[196:199], v[236:239], a[16:19]
    v_and_b32 v207, s22, v207
    v_and_b32 v209, s22, v209
    v_mfma_f32_16x16x32_bf16 a[20:23], a[200:203], v[236:239], a[20:23]
    ds_read_b128 v[236:239], v253 offset:0
    v_and_b32 v211, s22, v211
    v_mfma_f32_16x16x32_bf16 a[20:23], a[212:215], v[228:231], a[20:23]
    buffer_load_dwordx4 a[252:255], v254, s[8:11], s42 offen offset:0 sc1
    v_mfma_f32_16x16x32_bf16 a[20:23], a[224:227], v[232:235], a[20:23]
    v_and_b32 v213, s22, v213
    v_lshlrev_b32 v252, 16, v205
    v_mfma_f32_16x16x32_bf16 a[24:27], a[192:195], v[228:231], a[24:27]
    v_and_b32 v205, s22, v205
    v_fmac_f32 v252, s25, v251
    v_mfma_f32_16x16x32_bf16 a[24:27], a[204:207], v[232:235], a[24:27]
    s_waitcnt lgkmcnt(0)
    v_fmac_f32 v205, s25, v213
    v_fmac_f32 v252, s28, v249
    v_mfma_f32_16x16x32_bf16 a[24:27], a[216:219], v[236:239], a[24:27]
    v_fmac_f32 v205, s28, v209
    v_cvt_pk_bf16_f32 v205, v252, v205
    v_mfma_f32_16x16x32_bf16 a[28:31], a[220:223], v[236:239], a[28:31]
    buffer_load_dwordx4 v[240:243], v254, s[8:11], s42 offen offset:1024 sc1
    v_mfma_f32_16x16x32_bf16 a[28:31], a[208:211], v[232:235], a[28:31]
    v_lshlrev_b32 v252, 16, v215
    v_and_b32 v215, s22, v215
    v_mfma_f32_16x16x32_bf16 a[28:31], a[196:199], v[228:231], a[28:31]
    v_fmac_f32 v252, s29, v248
    v_fmac_f32 v215, s29, v207
    v_mfma_f32_16x16x32_bf16 a[32:35], a[200:203], v[228:231], a[32:35]
    ds_read_b128 v[228:231], v253 offset:1824
    v_fmac_f32 v252, s23, v250
    v_mfma_f32_16x16x32_bf16 a[32:35], a[212:215], v[232:235], a[32:35]
    buffer_load_dwordx4 v[244:247], v254, s[8:11], s42 offen offset:2048 sc1
    v_mfma_f32_16x16x32_bf16 a[32:35], a[224:227], v[236:239], a[32:35]
    v_fmac_f32 v215, s23, v211
    v_cvt_pk_bf16_f32 v215, v252, v215
    v_mfma_f32_16x16x32_bf16 a[36:39], a[192:195], v[232:235], a[36:39]
    v_and_b32 v203, 0x7fff, v255
    v_fma_f32 v252, v249, s24, v251
    v_fmac_f32 v251, -4.0, v249
    v_mfma_f32_16x16x32_bf16 a[36:39], a[204:207], v[236:239], a[36:39]
    s_waitcnt lgkmcnt(0)
    v_fma_f32 v249, v248, s24, v250
    v_fmac_f32 v250, -4.0, v248
    v_mfma_f32_16x16x32_bf16 a[36:39], a[216:219], v[228:231], a[36:39]
    buffer_load_dwordx2 v[192:193], v203, s[4:7], s16 offen offset:1088
    v_mfma_f32_16x16x32_bf16 a[40:43], a[220:223], v[228:231], a[40:43]
    v_fma_f32 v248, v250, s26, v251
    v_fmac_f32 v251, s27, v250
    v_mfma_f32_16x16x32_bf16 a[40:43], a[208:211], v[236:239], a[40:43]
    v_fma_f32 v250, v249, 2.0, v252
    v_fmac_f32 v252, -2.0, v249
    v_mfma_f32_16x16x32_bf16 a[40:43], a[196:199], v[232:235], a[40:43]
    v_fma_f32 v249, v209, s24, v213
    v_fmac_f32 v213, -4.0, v209
    v_mfma_f32_16x16x32_bf16 a[44:47], a[200:203], v[232:235], a[44:47]
    ds_read_b128 v[232:235], v253 offset:1568
    v_fma_f32 v209, v207, s24, v211
    v_mfma_f32_16x16x32_bf16 a[44:47], a[212:215], v[236:239], a[44:47]
    buffer_load_dwordx2 v[194:195], v203, s[4:7], s17 offen offset:1088
    v_mfma_f32_16x16x32_bf16 a[44:47], a[224:227], v[228:231], a[44:47]
    v_fmac_f32 v211, -4.0, v207
    v_fma_f32 v207, v211, s26, v213
    v_mfma_f32_16x16x32_bf16 a[48:51], a[192:195], v[236:239], a[48:51]
    v_fmac_f32 v213, s27, v211
    v_fma_f32 v211, v209, 2.0, v249
    v_mfma_f32_16x16x32_bf16 a[48:51], a[204:207], v[228:231], a[48:51]
    s_waitcnt lgkmcnt(0)
    v_fmac_f32 v249, -2.0, v209
    v_cvt_pk_bf16_f32 v207, v248, v207
    v_mfma_f32_16x16x32_bf16 a[48:51], a[216:219], v[232:235], a[48:51]
    buffer_load_dwordx2 v[196:197], v203, s[4:7], s18 offen offset:1088
    v_mfma_f32_16x16x32_bf16 a[52:55], a[220:223], v[232:235], a[52:55]
    v_cvt_pk_bf16_f32 v213, v251, v213
    v_cvt_pk_bf16_f32 v211, v250, v211
    v_mfma_f32_16x16x32_bf16 a[52:55], a[208:211], v[228:231], a[52:55]
    v_cvt_pk_bf16_f32 v209, v252, v249
    v_lshrrev_b32 v252, 15, v255
    v_mfma_f32_16x16x32_bf16 a[52:55], a[196:199], v[236:239], a[52:55]
    ds_write_b64 v252, v[206:207] offset:9088
    v_mfma_f32_16x16x32_bf16 a[56:59], a[200:203], v[236:239], a[56:59]
    ds_read_b128 v[236:239], v253 offset:1312
    v_lshrrev_b32 v206, 15, v255
    v_mfma_f32_16x16x32_bf16 a[56:59], a[212:215], v[228:231], a[56:59]
    buffer_load_dwordx2 v[198:199], v203, s[4:7], s19 offen offset:1088
    v_mfma_f32_16x16x32_bf16 a[56:59], a[224:227], v[232:235], a[56:59]
    ds_write_b64 v206, v[212:213] offset:11168
    v_mfma_f32_16x16x32_bf16 a[60:63], a[192:195], v[228:231], a[60:63]
    v_mfma_f32_16x16x32_bf16 a[60:63], a[204:207], v[232:235], a[60:63]
    s_waitcnt lgkmcnt(1)
    s_waitcnt vmcnt(13)
    v_lshlrev_b32 v248, 16, v218
    v_mfma_f32_16x16x32_bf16 a[60:63], a[216:219], v[236:239], a[60:63]
    buffer_load_dwordx2 v[200:201], v203, s[4:7], s20 offen offset:1088
    v_lshlrev_b32 v249, 16, v220
    v_mfma_f32_16x16x32_bf16 a[64:67], a[220:223], v[236:239], a[64:67]
    ds_write_b64 v206, v[210:211] offset:13248
    v_mfma_f32_16x16x32_bf16 a[64:67], a[208:211], v[232:235], a[64:67]
    v_lshlrev_b32 v250, 16, v222
    v_lshlrev_b32 v251, 16, v224
    v_mfma_f32_16x16x32_bf16 a[64:67], a[196:199], v[228:231], a[64:67]
    ds_write_b64 v206, v[204:205] offset:23648
    v_mfma_f32_16x16x32_bf16 a[68:71], a[200:203], v[228:231], a[68:71]
    ds_read_b128 v[228:231], v253 offset:1056
    v_and_b32 v218, s22, v218
    v_mfma_f32_16x16x32_bf16 a[68:71], a[212:215], v[232:235], a[68:71]
    buffer_load_dwordx2 v[202:203], v203, s[4:7], s21 offen offset:1088
    v_mfma_f32_16x16x32_bf16 a[68:71], a[224:227], v[236:239], a[68:71]
    ds_write_b64 v206, v[214:215] offset:31968
    v_mfma_f32_16x16x32_bf16 a[72:75], a[192:195], v[232:235], a[72:75]
    v_and_b32 v220, s22, v220
    v_and_b32 v222, s22, v222
    v_mfma_f32_16x16x32_bf16 a[72:75], a[204:207], v[236:239], a[72:75]
    s_waitcnt lgkmcnt(1)
    v_and_b32 v224, s22, v224
    v_lshlrev_b32 v252, 16, v216
    v_mfma_f32_16x16x32_bf16 a[72:75], a[216:219], v[228:231], a[72:75]
    v_and_b32 v216, s22, v216
    v_fmac_f32 v252, s25, v251
    v_mfma_f32_16x16x32_bf16 a[76:79], a[220:223], v[228:231], a[76:79]
    v_fmac_f32 v216, s25, v224
    v_fmac_f32 v252, s28, v249
    v_mfma_f32_16x16x32_bf16 a[76:79], a[208:211], v[236:239], a[76:79]
    v_fmac_f32 v216, s28, v220
    v_cvt_pk_bf16_f32 v216, v252, v216
    v_mfma_f32_16x16x32_bf16 a[76:79], a[196:199], v[232:235], a[76:79]
    v_lshlrev_b32 v252, 16, v226
    v_and_b32 v226, s22, v226
    v_mfma_f32_16x16x32_bf16 a[80:83], a[200:203], v[232:235], a[80:83]
    ds_read_b128 v[232:235], v253 offset:784
    v_fmac_f32 v252, s29, v248
    v_mfma_f32_16x16x32_bf16 a[80:83], a[212:215], v[236:239], a[80:83]
    v_fmac_f32 v226, s29, v218
    v_fmac_f32 v252, s23, v250
    v_mfma_f32_16x16x32_bf16 a[80:83], a[224:227], v[228:231], a[80:83]
    s_mov_b32 s42, 663552
    v_fmac_f32 v226, s23, v222
    v_cvt_pk_bf16_f32 v226, v252, v226
    v_mfma_f32_16x16x32_bf16 a[84:87], a[192:195], v[236:239], a[84:87]
    s_waitcnt lgkmcnt(0)
    v_fma_f32 v252, v249, s24, v251
    v_fmac_f32 v251, -4.0, v249
    v_mfma_f32_16x16x32_bf16 a[88:91], a[196:199], v[236:239], a[88:91]
    s_barrier
    v_mfma_f32_16x16x32_bf16 a[92:95], a[200:203], v[236:239], a[92:95]
    ds_read_b128 v[236:239], v253 offset:3120
    v_fma_f32 v249, v248, s24, v250
    v_mfma_f32_16x16x32_bf16 a[92:95], a[212:215], v[228:231], a[92:95]
    buffer_load_dwordx4 a[192:195], v254, s[8:11], s42 offen offset:0 sc1
    v_mfma_f32_16x16x32_bf16 a[88:91], a[208:211], v[228:231], a[88:91]
    v_fmac_f32 v250, -4.0, v248
    v_fma_f32 v248, v250, s26, v251
    v_fmac_f32 v251, s27, v250
    v_mfma_f32_16x16x32_bf16 a[84:87], a[204:207], v[228:231], a[84:87]
    ds_read_b128 v[228:231], v253 offset:2848
    v_fma_f32 v250, v249, 2.0, v252
    v_mfma_f32_16x16x32_bf16 a[84:87], a[216:219], v[232:235], a[84:87]
    buffer_load_dwordx4 a[196:199], v254, s[8:11], s42 offen offset:1024 sc1
    v_mfma_f32_16x16x32_bf16 a[88:91], a[220:223], v[232:235], a[88:91]
    s_waitcnt vmcnt(14) lgkmcnt(1)
    v_fmac_f32 v252, -2.0, v249
    v_fma_f32 v249, v220, s24, v224
    v_mfma_f32_16x16x32_bf16 a[92:95], a[224:227], v[232:235], a[92:95]
    ds_read_b128 v[232:235], v253 offset:2592
    v_fmac_f32 v224, -4.0, v220
sub17:
    v_mfma_f32_16x16x32_bf16 a[96:99], a[228:231], v[236:239], a[96:99]
    buffer_load_dwordx4 a[200:203], v254, s[8:11], s42 offen offset:2048 sc1
    v_mfma_f32_16x16x32_bf16 a[100:103], a[232:235], v[236:239], a[100:103]
    s_mov_b32 s42, 666624
    v_fma_f32 v220, v218, s24, v222
    v_fmac_f32 v222, -4.0, v218
    v_mfma_f32_16x16x32_bf16 a[104:107], a[236:239], v[236:239], a[104:107]
    ds_read_b128 v[236:239], v253 offset:2336
    s_waitcnt vmcnt(12)
    s_waitcnt lgkmcnt(2)
    v_mfma_f32_16x16x32_bf16 a[104:107], a[248:251], v[228:231], a[104:107]
    ds_write_b64 v206, v[208:209] offset:768
    v_mfma_f32_16x16x32_bf16 a[100:103], a[244:247], v[228:231], a[100:103]
    buffer_load_dwordx4 a[204:207], v254, s[8:11], s42 offen offset:0 sc1
    v_mfma_f32_16x16x32_bf16 a[96:99], a[240:243], v[228:231], a[96:99]
    s_waitcnt vmcnt(10) lgkmcnt(2)
    v_fma_f32 v218, v222, s26, v224
    v_fmac_f32 v224, s27, v222
    v_mfma_f32_16x16x32_bf16 a[96:99], a[252:255], v[232:235], a[96:99]
    v_fma_f32 v222, v220, 2.0, v249
    v_fmac_f32 v249, -2.0, v220
    v_mfma_f32_16x16x32_bf16 a[100:103], v[240:243], v[232:235], a[100:103]
    v_cvt_pk_bf16_f32 v218, v248, v218
    v_cvt_pk_bf16_f32 v224, v251, v224
    v_mfma_f32_16x16x32_bf16 a[104:107], v[244:247], v[232:235], a[104:107]
    buffer_load_dwordx4 a[208:211], v254, s[8:11], s42 offen offset:1024 sc1
    v_mfma_f32_16x16x32_bf16 a[108:111], a[228:231], v[228:231], a[108:111]
    v_cvt_pk_bf16_f32 v222, v250, v222
    v_cvt_pk_bf16_f32 v220, v252, v249
    v_mfma_f32_16x16x32_bf16 a[108:111], a[240:243], v[232:235], a[108:111]
    s_waitcnt lgkmcnt(1)
    v_lshlrev_b32 v248, 16, v219
    v_lshlrev_b32 v249, 16, v221
    v_mfma_f32_16x16x32_bf16 a[108:111], a[252:255], v[236:239], a[108:111]
    v_lshlrev_b32 v250, 16, v223
    v_lshlrev_b32 v251, 16, v225
    v_mfma_f32_16x16x32_bf16 a[112:115], v[240:243], v[236:239], a[112:115]
    buffer_load_dwordx4 a[212:215], v254, s[8:11], s42 offen offset:2048 sc1
    v_mfma_f32_16x16x32_bf16 a[112:115], a[244:247], v[232:235], a[112:115]
    s_mov_b32 s42, 669696
    v_and_b32 v219, s22, v219
    v_and_b32 v221, s22, v221
    v_mfma_f32_16x16x32_bf16 a[112:115], a[232:235], v[228:231], a[112:115]
    v_and_b32 v223, s22, v223
    v_and_b32 v225, s22, v225
    v_mfma_f32_16x16x32_bf16 a[116:119], a[236:239], v[228:231], a[116:119]
    ds_read_b128 v[228:231], v253 offset:2080
    v_lshlrev_b32 v252, 16, v217
    v_and_b32 v217, s22, v217
    v_mfma_f32_16x16x32_bf16 a[116:119], a[248:251], v[232:235], a[116:119]
    buffer_load_dwordx4 a[216:219], v254, s[8:11], s42 offen offset:0 sc1
    v_mfma_f32_16x16x32_bf16 a[116:119], v[244:247], v[236:239], a[116:119]
    v_fmac_f32 v252, s25, v251
    v_fmac_f32 v217, s25, v225
    v_mfma_f32_16x16x32_bf16 a[120:123], a[228:231], v[232:235], a[120:123]
    v_fmac_f32 v252, s28, v249
    v_fmac_f32 v217, s28, v221
    v_mfma_f32_16x16x32_bf16 a[120:123], a[240:243], v[236:239], a[120:123]
    s_waitcnt lgkmcnt(0)
    v_cvt_pk_bf16_f32 v217, v252, v217
    v_lshlrev_b32 v252, 16, v227
    v_mfma_f32_16x16x32_bf16 a[120:123], a[252:255], v[228:231], a[120:123]
    v_and_b32 v227, s22, v227
    v_fmac_f32 v252, s29, v248
    v_mfma_f32_16x16x32_bf16 a[124:127], v[240:243], v[228:231], a[124:127]
    buffer_load_dwordx4 a[220:223], v254, s[8:11], s42 offen offset:1024 sc1
    v_mfma_f32_16x16x32_bf16 a[124:127], a[244:247], v[236:239], a[124:127]
    v_fmac_f32 v227, s29, v219
    v_fmac_f32 v252, s23, v250
    v_mfma_f32_16x16x32_bf16 a[124:127], a[232:235], v[232:235], a[124:127]
    v_fmac_f32 v227, s23, v223
    v_cvt_pk_bf16_f32 v227, v252, v227
    v_mfma_f32_16x16x32_bf16 a[128:131], a[236:239], v[232:235], a[128:131]
    ds_read_b128 v[232:235], v253 offset:3904
    v_fma_f32 v252, v249, s24, v251
    v_mfma_f32_16x16x32_bf16 a[128:131], a[248:251], v[236:239], a[128:131]
    buffer_load_dwordx4 a[224:227], v254, s[8:11], s42 offen offset:2048 sc1
    v_mfma_f32_16x16x32_bf16 a[128:131], v[244:247], v[228:231], a[128:131]
    v_fmac_f32 v251, -4.0, v249
    v_fma_f32 v249, v248, s24, v250
    v_mfma_f32_16x16x32_bf16 a[132:135], a[228:231], v[236:239], a[132:135]
    v_and_b32 v215, 0x7fff, v255
    v_fmac_f32 v250, -4.0, v248
    v_mfma_f32_16x16x32_bf16 a[132:135], a[240:243], v[228:231], a[132:135]
    s_waitcnt lgkmcnt(0)
    v_fma_f32 v248, v250, s26, v251
    v_fmac_f32 v251, s27, v250
    v_mfma_f32_16x16x32_bf16 a[132:135], a[252:255], v[232:235], a[132:135]
    buffer_load_dwordx2 v[204:205], v215, s[4:7], s16 offen offset:1472
    v_mfma_f32_16x16x32_bf16 a[136:139], v[240:243], v[232:235], a[136:139]
    v_fma_f32 v250, v249, 2.0, v252
    v_fmac_f32 v252, -2.0, v249
    v_mfma_f32_16x16x32_bf16 a[136:139], a[244:247], v[228:231], a[136:139]
    v_fma_f32 v249, v221, s24, v225
    v_fmac_f32 v225, -4.0, v221
    v_mfma_f32_16x16x32_bf16 a[136:139], a[232:235], v[236:239], a[136:139]
    v_fma_f32 v221, v219, s24, v223
    v_fmac_f32 v223, -4.0, v219
    v_mfma_f32_16x16x32_bf16 a[140:143], a[236:239], v[236:239], a[140:143]
    ds_read_b128 v[236:239], v253 offset:3648
    v_fma_f32 v219, v223, s26, v225
    v_mfma_f32_16x16x32_bf16 a[140:143], a[248:251], v[228:231], a[140:143]
    buffer_load_dwordx2 v[206:207], v215, s[4:7], s17 offen offset:1472
    v_mfma_f32_16x16x32_bf16 a[140:143], v[244:247], v[232:235], a[140:143]
    v_fmac_f32 v225, s27, v223
    v_fma_f32 v223, v221, 2.0, v249
    v_fmac_f32 v249, -2.0, v221
    v_mfma_f32_16x16x32_bf16 a[144:147], a[228:231], v[228:231], a[144:147]
    v_cvt_pk_bf16_f32 v219, v248, v219
    v_cvt_pk_bf16_f32 v225, v251, v225
    v_mfma_f32_16x16x32_bf16 a[144:147], a[240:243], v[232:235], a[144:147]
    s_waitcnt lgkmcnt(0)
    v_cvt_pk_bf16_f32 v223, v250, v223
    v_cvt_pk_bf16_f32 v221, v252, v249
    v_mfma_f32_16x16x32_bf16 a[144:147], a[252:255], v[236:239], a[144:147]
    buffer_load_dwordx2 v[208:209], v215, s[4:7], s18 offen offset:1472
    v_mfma_f32_16x16x32_bf16 a[148:151], v[240:243], v[236:239], a[148:151]
    v_lshrrev_b32 v252, 15, v255
    v_mfma_f32_16x16x32_bf16 a[148:151], a[244:247], v[232:235], a[148:151]
    ds_write_b64 v252, v[218:219] offset:8832
    v_mfma_f32_16x16x32_bf16 a[148:151], a[232:235], v[228:231], a[148:151]
    v_lshrrev_b32 v218, 15, v255
    v_mfma_f32_16x16x32_bf16 a[152:155], a[236:239], v[228:231], a[152:155]
    ds_read_b128 v[228:231], v253 offset:3392
    v_mfma_f32_16x16x32_bf16 a[152:155], a[248:251], v[232:235], a[152:155]
    buffer_load_dwordx2 v[210:211], v215, s[4:7], s19 offen offset:1472
    v_mfma_f32_16x16x32_bf16 a[152:155], v[244:247], v[236:239], a[152:155]
pad6:
    s_cbranch_vccnz pad10
    ds_write_b64 v218, v[224:225] offset:10912
    v_mfma_f32_16x16x32_bf16 a[156:159], a[228:231], v[232:235], a[156:159]
    v_mfma_f32_16x16x32_bf16 a[156:159], a[240:243], v[236:239], a[156:159]
    s_waitcnt lgkmcnt(1)
    s_waitcnt vmcnt(13)
    v_lshlrev_b32 v248, 16, v194
    v_mfma_f32_16x16x32_bf16 a[156:159], a[252:255], v[228:231], a[156:159]
    buffer_load_dwordx2 v[212:213], v215, s[4:7], s20 offen offset:1472
    v_mfma_f32_16x16x32_bf16 a[160:163], v[240:243], v[228:231], a[160:163]
    ds_write_b64 v218, v[222:223] offset:12992
    v_mfma_f32_16x16x32_bf16 a[160:163], a[244:247], v[236:239], a[160:163]
    v_lshlrev_b32 v249, 16, v196
    v_lshlrev_b32 v250, 16, v198
    v_mfma_f32_16x16x32_bf16 a[160:163], a[232:235], v[232:235], a[160:163]
    ds_write_b64 v218, v[216:217] offset:23392
    v_mfma_f32_16x16x32_bf16 a[164:167], a[236:239], v[232:235], a[164:167]
    ds_read_b128 v[232:235], v253 offset:3136
    v_lshlrev_b32 v251, 16, v200
    v_mfma_f32_16x16x32_bf16 a[164:167], a[248:251], v[236:239], a[164:167]
    buffer_load_dwordx2 v[214:215], v215, s[4:7], s21 offen offset:1472
    v_mfma_f32_16x16x32_bf16 a[164:167], v[244:247], v[228:231], a[164:167]
    s_add_u32 s49, s49, 8
    v_and_b32 v194, s22, v194
    v_and_b32 v196, s22, v196
    v_mfma_f32_16x16x32_bf16 a[168:171], a[228:231], v[236:239], a[168:171]
    ds_write_b64 v218, v[226:227] offset:31712
    v_mfma_f32_16x16x32_bf16 a[168:171], a[240:243], v[228:231], a[168:171]
    s_waitcnt lgkmcnt(1)
    v_and_b32 v198, s22, v198
    v_and_b32 v200, s22, v200
    v_lshlrev_b32 v252, 16, v192
    v_mfma_f32_16x16x32_bf16 a[168:171], a[252:255], v[232:235], a[168:171]
    s_cmp_eq_u32 s39, 1
    s_cselect_b32 s49, 128, s49
    s_cselect_b32 s36, 2130706432, 0
    v_mfma_f32_16x16x32_bf16 a[172:175], v[240:243], v[232:235], a[172:175]
    ds_write_b64 v218, v[220:221] offset:512
    v_mfma_f32_16x16x32_bf16 a[172:175], a[244:247], v[228:231], a[172:175]
    ds_read_b128 v[216:219], v253 offset:40480
    s_mov_b32 s45, 503518347
    v_mfma_f32_16x16x32_bf16 a[172:175], a[232:235], v[236:239], a[172:175]
    s_mul_i32 s43, s49, 786432
    v_bfe_u32 v220, v254, 5, 3
    v_mul_u32_u24 v221, 5, v220
    v_mfma_f32_16x16x32_bf16 a[176:179], a[236:239], v[236:239], a[176:179]
    ds_read_b128 v[236:239], v253 offset:2864
    v_bfe_u32 v221, s45, v221, 5
    v_mfma_f32_16x16x32_bf16 a[176:179], a[248:251], v[228:231], a[176:179]
    v_mul_u32_u24 v221, 65, v221
    v_sub_u32 v221, v221, v220
    v_mfma_f32_16x16x32_bf16 a[176:179], v[244:247], v[232:235], a[176:179]
    s_mov_b32 s42, 700416
    s_add_u32 s43, s43, s53
    v_lshl_add_u32 v220, v221, 5, v253
    v_mfma_f32_16x16x32_bf16 a[180:183], a[228:231], v[228:231], a[180:183]
    s_waitcnt lgkmcnt(1)
    v_and_b32 v192, s22, v192
    v_fmac_f32 v252, s25, v251
    v_mfma_f32_16x16x32_bf16 a[184:187], a[232:235], v[228:231], a[184:187]
    s_mov_b64 exec, s[46:47]
    ds_write_b128 v220, v[216:219] offset:1024
    s_mov_b64 exec, -1
    v_mfma_f32_16x16x32_bf16 a[188:191], a[236:239], v[228:231], a[188:191]
    ds_read_b128 v[228:231], v253 offset:5200
    v_fmac_f32 v192, s25, v200
    v_mfma_f32_16x16x32_bf16 a[188:191], a[248:251], v[232:235], a[188:191]
    buffer_load_dwordx4 a[228:231], v254, s[8:11], s42 offen offset:0 sc1
    v_mfma_f32_16x16x32_bf16 a[184:187], a[244:247], v[232:235], a[184:187]
    s_waitcnt lgkmcnt(2)
    v_fmac_f32 v252, s28, v249
    v_fmac_f32 v192, s28, v196
    v_mfma_f32_16x16x32_bf16 a[180:183], a[240:243], v[232:235], a[180:183]
    ds_read_b128 v[232:235], v253 offset:4928
    v_cvt_pk_bf16_f32 v192, v252, v192
    v_mfma_f32_16x16x32_bf16 a[180:183], a[252:255], v[236:239], a[180:183]
    buffer_load_dwordx4 a[232:235], v254, s[8:11], s42 offen offset:1024 sc1
    v_mfma_f32_16x16x32_bf16 a[184:187], v[240:243], v[236:239], a[184:187]
    s_waitcnt vmcnt(14) lgkmcnt(1)
    v_lshlrev_b32 v252, 16, v202
    v_and_b32 v202, s22, v202
    v_mfma_f32_16x16x32_bf16 a[188:191], v[244:247], v[236:239], a[188:191]
    ds_read_b128 v[236:239], v253 offset:4672
    v_fmac_f32 v252, s29, v248
sub18:
    v_mfma_f32_16x16x32_bf16 v[0:3], a[192:195], v[228:231], v[0:3]
    buffer_load_dwordx4 a[236:239], v254, s[8:11], s42 offen offset:2048 sc1
    v_mfma_f32_16x16x32_bf16 v[4:7], a[196:199], v[228:231], v[4:7]
    s_mov_b32 s42, 703488
    v_fmac_f32 v202, s29, v194
    v_fmac_f32 v252, s23, v250
    v_mfma_f32_16x16x32_bf16 v[8:11], a[200:203], v[228:231], v[8:11]
    ds_read_b128 v[228:231], v253 offset:4416
    s_waitcnt vmcnt(12)
    s_waitcnt lgkmcnt(2)
    v_mfma_f32_16x16x32_bf16 v[8:11], a[212:215], v[232:235], v[8:11]
    s_cmp_ge_u32 s49, 128
    s_cselect_b32 s43, 2130706432, s43
    s_sub_u32 s16, s43, 196608
    v_fmac_f32 v202, s23, v198
    v_mfma_f32_16x16x32_bf16 v[4:7], a[208:211], v[232:235], v[4:7]
    buffer_load_dwordx4 a[240:243], v254, s[8:11], s42 offen offset:0 sc1
    v_mfma_f32_16x16x32_bf16 v[0:3], a[204:207], v[232:235], v[0:3]
    s_waitcnt vmcnt(10) lgkmcnt(1)
    v_cvt_pk_bf16_f32 v202, v252, v202
    v_fma_f32 v252, v249, s24, v251
    v_mfma_f32_16x16x32_bf16 v[0:3], a[216:219], v[236:239], v[0:3]
    s_cmp_eq_u32 s49, 0
    s_cselect_b32 s16, 2130706432, s16
    s_mov_b32 s17, s43
    v_mfma_f32_16x16x32_bf16 v[4:7], a[220:223], v[236:239], v[4:7]
    s_add_u32 s18, s43, 196608
    v_fmac_f32 v251, -4.0, v249
    v_fma_f32 v249, v248, s24, v250
    v_mfma_f32_16x16x32_bf16 v[8:11], a[224:227], v[236:239], v[8:11]
    buffer_load_dwordx4 a[244:247], v254, s[8:11], s42 offen offset:1024 sc1
    v_mfma_f32_16x16x32_bf16 v[12:15], a[192:195], v[232:235], v[12:15]
    s_add_u32 s19, s43, 393216
    v_fmac_f32 v250, -4.0, v248
    v_fma_f32 v248, v250, s26, v251
    v_mfma_f32_16x16x32_bf16 v[12:15], a[204:207], v[236:239], v[12:15]
    s_waitcnt lgkmcnt(0)
    v_fmac_f32 v251, s27, v250
    v_fma_f32 v250, v249, 2.0, v252
    v_mfma_f32_16x16x32_bf16 v[12:15], a[216:219], v[228:231], v[12:15]
    v_fmac_f32 v252, -2.0, v249
    v_fma_f32 v249, v196, s24, v200
    v_mfma_f32_16x16x32_bf16 v[16:19], a[220:223], v[228:231], v[16:19]
    buffer_load_dwordx4 a[248:251], v254, s[8:11], s42 offen offset:2048 sc1
    v_mfma_f32_16x16x32_bf16 v[16:19], a[208:211], v[236:239], v[16:19]
    s_mov_b32 s42, 706560
    s_add_u32 s20, s43, 589824
    v_fmac_f32 v200, -4.0, v196
    v_mfma_f32_16x16x32_bf16 v[16:19], a[196:199], v[232:235], v[16:19]
    v_fma_f32 v196, v194, s24, v198
    v_fmac_f32 v198, -4.0, v194
    v_mfma_f32_16x16x32_bf16 v[20:23], a[200:203], v[232:235], v[20:23]
    ds_read_b128 v[232:235], v253 offset:4160
    v_fma_f32 v194, v198, s26, v200
    v_mfma_f32_16x16x32_bf16 v[20:23], a[212:215], v[236:239], v[20:23]
    buffer_load_dwordx4 a[252:255], v254, s[8:11], s42 offen offset:0 sc1
    v_mfma_f32_16x16x32_bf16 v[20:23], a[224:227], v[228:231], v[20:23]
    s_add_u32 s21, s43, 786432
    v_fmac_f32 v200, s27, v198
    v_fma_f32 v198, v196, 2.0, v249
    v_mfma_f32_16x16x32_bf16 v[24:27], a[192:195], v[236:239], v[24:27]
    v_fmac_f32 v249, -2.0, v196
    v_cvt_pk_bf16_f32 v194, v248, v194
    v_mfma_f32_16x16x32_bf16 v[24:27], a[204:207], v[228:231], v[24:27]
    s_waitcnt lgkmcnt(0)
    s_add_u32 s100, s43, s101
    v_cvt_pk_bf16_f32 v200, v251, v200
    v_mfma_f32_16x16x32_bf16 v[24:27], a[216:219], v[232:235], v[24:27]
    v_cvt_pk_bf16_f32 v198, v250, v198
    v_cvt_pk_bf16_f32 v196, v252, v249
    v_mfma_f32_16x16x32_bf16 v[28:31], a[220:223], v[232:235], v[28:31]
    buffer_load_dwordx4 v[240:243], v254, s[8:11], s42 offen offset:1024 sc1
    v_mfma_f32_16x16x32_bf16 v[28:31], a[208:211], v[228:231], v[28:31]
    s_add_u32 s37, s43, s33
    v_lshlrev_b32 v248, 16, v195
    v_lshlrev_b32 v249, 16, v197
    v_mfma_f32_16x16x32_bf16 v[28:31], a[196:199], v[236:239], v[28:31]
    v_lshlrev_b32 v250, 16, v199
    v_lshlrev_b32 v251, 16, v201
    v_and_b32 v195, s22, v195
    v_mfma_f32_16x16x32_bf16 v[32:35], a[200:203], v[236:239], v[32:35]
    ds_read_b128 v[236:239], v253 offset:5984
    v_and_b32 v197, s22, v197
    v_mfma_f32_16x16x32_bf16 v[32:35], a[212:215], v[228:231], v[32:35]
    buffer_load_dwordx4 v[244:247], v254, s[8:11], s42 offen offset:2048 sc1
    v_mfma_f32_16x16x32_bf16 v[32:35], a[224:227], v[232:235], v[32:35]
    v_and_b32 v199, s22, v199
    v_and_b32 v201, s22, v201
    v_mfma_f32_16x16x32_bf16 v[36:39], a[192:195], v[228:231], v[36:39]
    v_and_b32 v224, 0x1f0, v254
    v_mul_u32_u24 v224, 96, v224
    v_mfma_f32_16x16x32_bf16 v[36:39], a[204:207], v[232:235], v[36:39]
    s_waitcnt lgkmcnt(0)
    v_lshlrev_b32 v252, 16, v193
    v_and_b32 v193, s22, v193
    v_mfma_f32_16x16x32_bf16 v[36:39], a[216:219], v[236:239], v[36:39]
    buffer_load_dword v224, v224, s[4:7], s100 offen offset:0
    v_mfma_f32_16x16x32_bf16 v[40:43], a[220:223], v[236:239], v[40:43]
    v_and_b32 v227, 0xf0, v254
    v_lshrrev_b32 v227, 1, v227
    v_mfma_f32_16x16x32_bf16 v[40:43], a[208:211], v[232:235], v[40:43]
    v_add_u32 v227, s52, v227
    v_mov_b32 v226, s54
    v_mfma_f32_16x16x32_bf16 v[40:43], a[196:199], v[228:231], v[40:43]
    v_mov_b32 v225, s55
    v_cndmask_b32 v226, v226, v225, s[56:57]
    v_mfma_f32_16x16x32_bf16 v[44:47], a[200:203], v[228:231], v[44:47]
    ds_read_b128 v[228:231], v253 offset:5728
    v_add_u32 v227, v227, v226
    v_mfma_f32_16x16x32_bf16 v[44:47], a[212:215], v[232:235], v[44:47]
    s_sub_u32 s45, s16, s50
    v_fmac_f32 v252, s25, v251
    v_fmac_f32 v193, s25, v201
    v_mfma_f32_16x16x32_bf16 v[44:47], a[224:227], v[236:239], v[44:47]
    buffer_load_dwordx2 v[216:217], v227, s[4:7], s45 offen
    v_mfma_f32_16x16x32_bf16 v[48:51], a[192:195], v[232:235], v[48:51]
    s_sub_u32 s45, s17, s50
    v_fmac_f32 v252, s28, v249
    v_fmac_f32 v193, s28, v197
    v_mfma_f32_16x16x32_bf16 v[48:51], a[204:207], v[236:239], v[48:51]
    s_waitcnt lgkmcnt(0)
    v_cvt_pk_bf16_f32 v193, v252, v193
    v_lshlrev_b32 v252, 16, v203
    v_mfma_f32_16x16x32_bf16 v[48:51], a[216:219], v[228:231], v[48:51]
    v_and_b32 v203, s22, v203
    v_fmac_f32 v252, s29, v248
    v_mfma_f32_16x16x32_bf16 v[52:55], a[220:223], v[228:231], v[52:55]
    buffer_load_dwordx2 v[218:219], v227, s[4:7], s45 offen
    v_mfma_f32_16x16x32_bf16 v[52:55], a[208:211], v[236:239], v[52:55]
    s_sub_u32 s45, s18, s50
    v_fmac_f32 v203, s29, v195
    v_fmac_f32 v252, s23, v250
    v_mfma_f32_16x16x32_bf16 v[52:55], a[196:199], v[232:235], v[52:55]
    v_fmac_f32 v203, s23, v199
    v_cvt_pk_bf16_f32 v203, v252, v203
    v_mfma_f32_16x16x32_bf16 v[56:59], a[200:203], v[232:235], v[56:59]
    ds_read_b128 v[232:235], v253 offset:5472
    v_fma_f32 v252, v249, s24, v251
    v_mfma_f32_16x16x32_bf16 v[56:59], a[212:215], v[236:239], v[56:59]
    buffer_load_dwordx2 v[220:221], v227, s[4:7], s45 offen
    v_fmac_f32 v251, -4.0, v249
    v_mfma_f32_16x16x32_bf16 v[56:59], a[224:227], v[228:231], v[56:59]
    s_sub_u32 s45, s19, s50
    v_fma_f32 v249, v248, s24, v250
    v_fmac_f32 v250, -4.0, v248
    v_mfma_f32_16x16x32_bf16 v[60:63], a[192:195], v[236:239], v[60:63]
    v_fma_f32 v248, v250, s26, v251
    v_fmac_f32 v251, s27, v250
    v_mfma_f32_16x16x32_bf16 v[60:63], a[204:207], v[228:231], v[60:63]
    s_waitcnt lgkmcnt(0)
    v_fma_f32 v250, v249, 2.0, v252
    v_fmac_f32 v252, -2.0, v249
    v_mfma_f32_16x16x32_bf16 v[60:63], a[216:219], v[232:235], v[60:63]
    buffer_load_dwordx2 v[222:223], v227, s[4:7], s45 offen
    v_mfma_f32_16x16x32_bf16 v[64:67], a[220:223], v[232:235], v[64:67]
    s_sub_u32 s45, s20, s50
    v_fma_f32 v249, v197, s24, v201
    v_fmac_f32 v201, -4.0, v197
    v_mfma_f32_16x16x32_bf16 v[64:67], a[208:211], v[228:231], v[64:67]
    v_fma_f32 v197, v195, s24, v199
    v_fmac_f32 v199, -4.0, v195
    v_mfma_f32_16x16x32_bf16 v[64:67], a[196:199], v[236:239], v[64:67]
    v_fma_f32 v195, v199, s26, v201
    v_fmac_f32 v201, s27, v199
    v_mfma_f32_16x16x32_bf16 v[68:71], a[200:203], v[236:239], v[68:71]
    ds_read_b128 v[236:239], v253 offset:5216
    v_fma_f32 v199, v197, 2.0, v249
    v_mfma_f32_16x16x32_bf16 v[68:71], a[212:215], v[228:231], v[68:71]
    buffer_load_dwordx2 v[224:225], v227, s[4:7], s45 offen
    v_mfma_f32_16x16x32_bf16 v[68:71], a[224:227], v[232:235], v[68:71]
    s_sub_u32 s45, s21, s50
    v_fmac_f32 v249, -2.0, v197
    v_cvt_pk_bf16_f32 v195, v248, v195
    v_mfma_f32_16x16x32_bf16 v[72:75], a[192:195], v[228:231], v[72:75]
    v_cvt_pk_bf16_f32 v201, v251, v201
    v_cvt_pk_bf16_f32 v199, v250, v199
    v_mfma_f32_16x16x32_bf16 v[72:75], a[204:207], v[232:235], v[72:75]
    s_waitcnt lgkmcnt(0)
    v_cvt_pk_bf16_f32 v197, v252, v249
    v_lshrrev_b32 v252, 15, v255
    v_mfma_f32_16x16x32_bf16 v[72:75], a[216:219], v[236:239], v[72:75]
    buffer_load_dwordx2 v[226:227], v227, s[4:7], s45 offen
    v_mfma_f32_16x16x32_bf16 v[76:79], a[220:223], v[236:239], v[76:79]
    ds_write_b64 v252, v[194:195] offset:8576
    v_mfma_f32_16x16x32_bf16 v[76:79], a[208:211], v[232:235], v[76:79]
    s_waitcnt vmcnt(16)
    v_lshrrev_b32 v194, 15, v255
    v_lshlrev_b32 v248, 16, v206
    v_mfma_f32_16x16x32_bf16 v[76:79], a[196:199], v[228:231], v[76:79]
    ds_write_b64 v194, v[200:201] offset:10656
    v_mfma_f32_16x16x32_bf16 v[80:83], a[200:203], v[228:231], v[80:83]
    ds_read_b128 v[228:231], v253 offset:4944
    v_lshlrev_b32 v249, 16, v208
    v_mfma_f32_16x16x32_bf16 v[80:83], a[212:215], v[232:235], v[80:83]
    ds_write_b64 v194, v[198:199] offset:12736
    v_mfma_f32_16x16x32_bf16 v[80:83], a[224:227], v[236:239], v[80:83]
    s_mov_b32 s42, 737280
    v_lshlrev_b32 v250, 16, v210
    v_lshlrev_b32 v251, 16, v212
    v_mfma_f32_16x16x32_bf16 v[84:87], a[192:195], v[232:235], v[84:87]
    ds_write_b64 v194, v[192:193] offset:23136
    v_and_b32 v206, s22, v206
    v_mfma_f32_16x16x32_bf16 v[88:91], a[196:199], v[232:235], v[88:91]
    v_and_b32 v208, s22, v208
    v_and_b32 v210, s22, v210
    v_mfma_f32_16x16x32_bf16 v[92:95], a[200:203], v[232:235], v[92:95]
    ds_read_b128 v[232:235], v253 offset:7280
    v_and_b32 v212, s22, v212
    v_mfma_f32_16x16x32_bf16 v[92:95], a[212:215], v[236:239], v[92:95]
    buffer_load_dwordx4 a[192:195], v254, s[8:11], s42 offen offset:0 sc1
    v_mfma_f32_16x16x32_bf16 v[88:91], a[208:211], v[236:239], v[88:91]
    s_waitcnt lgkmcnt(3)
    v_lshlrev_b32 v252, 16, v204
    v_and_b32 v204, s22, v204
    v_mfma_f32_16x16x32_bf16 v[84:87], a[204:207], v[236:239], v[84:87]
    ds_read_b128 v[236:239], v253 offset:7008
    v_fmac_f32 v252, s25, v251
    v_mfma_f32_16x16x32_bf16 v[84:87], a[216:219], v[228:231], v[84:87]
    buffer_load_dwordx4 a[196:199], v254, s[8:11], s42 offen offset:1024 sc1
    v_mfma_f32_16x16x32_bf16 v[88:91], a[220:223], v[228:231], v[88:91]
    s_waitcnt vmcnt(15) lgkmcnt(1)
    v_fmac_f32 v204, s25, v212
    v_fmac_f32 v252, s28, v249
    v_mfma_f32_16x16x32_bf16 v[92:95], a[224:227], v[228:231], v[92:95]
    ds_read_b128 v[228:231], v253 offset:6752
    v_fmac_f32 v204, s28, v208
sub19:
    v_mfma_f32_16x16x32_bf16 v[96:99], a[228:231], v[232:235], v[96:99]
    buffer_load_dwordx4 a[200:203], v254, s[8:11], s42 offen offset:2048 sc1
    v_mfma_f32_16x16x32_bf16 v[100:103], a[232:235], v[232:235], v[100:103]
    s_mov_b32 s42, 740352
    v_cvt_pk_bf16_f32 v204, v252, v204
    v_lshlrev_b32 v252, 16, v214
    v_mfma_f32_16x16x32_bf16 v[104:107], a[236:239], v[232:235], v[104:107]
    ds_read_b128 v[232:235], v253 offset:6496
    s_waitcnt vmcnt(13)
    s_waitcnt lgkmcnt(2)
    v_mfma_f32_16x16x32_bf16 v[104:107], a[248:251], v[236:239], v[104:107]
    ds_write_b64 v194, v[202:203] offset:31456
    v_mfma_f32_16x16x32_bf16 v[100:103], a[244:247], v[236:239], v[100:103]
    buffer_load_dwordx4 a[204:207], v254, s[8:11], s42 offen offset:0 sc1
    v_mfma_f32_16x16x32_bf16 v[96:99], a[240:243], v[236:239], v[96:99]
    s_waitcnt vmcnt(11) lgkmcnt(2)
    v_and_b32 v214, s22, v214
    v_fmac_f32 v252, s29, v248
    v_mfma_f32_16x16x32_bf16 v[96:99], a[252:255], v[228:231], v[96:99]
    ds_write_b64 v194, v[196:197] offset:256
    v_mfma_f32_16x16x32_bf16 v[100:103], v[240:243], v[228:231], v[100:103]
    v_fmac_f32 v214, s29, v206
    v_fmac_f32 v252, s23, v250
    v_mfma_f32_16x16x32_bf16 v[104:107], v[244:247], v[228:231], v[104:107]
    buffer_load_dwordx4 a[208:211], v254, s[8:11], s42 offen offset:1024 sc1
    v_mfma_f32_16x16x32_bf16 v[108:111], a[228:231], v[236:239], v[108:111]
    v_fmac_f32 v214, s23, v210
    v_cvt_pk_bf16_f32 v214, v252, v214
    v_mfma_f32_16x16x32_bf16 v[108:111], a[240:243], v[228:231], v[108:111]
    s_waitcnt lgkmcnt(2)
    v_fma_f32 v252, v249, s24, v251
    v_fmac_f32 v251, -4.0, v249
    v_mfma_f32_16x16x32_bf16 v[108:111], a[252:255], v[232:235], v[108:111]
    v_fma_f32 v249, v248, s24, v250
    v_fmac_f32 v250, -4.0, v248
    v_fma_f32 v248, v250, s26, v251
    v_mfma_f32_16x16x32_bf16 v[112:115], v[240:243], v[232:235], v[112:115]
    buffer_load_dwordx4 a[212:215], v254, s[8:11], s42 offen offset:2048 sc1
    v_mfma_f32_16x16x32_bf16 v[112:115], a[244:247], v[228:231], v[112:115]
    s_mov_b32 s42, 743424
    v_fmac_f32 v251, s27, v250
    v_fma_f32 v250, v249, 2.0, v252
    v_mfma_f32_16x16x32_bf16 v[112:115], a[232:235], v[236:239], v[112:115]
    v_fmac_f32 v252, -2.0, v249
    v_fma_f32 v249, v208, s24, v212
    v_mfma_f32_16x16x32_bf16 v[116:119], a[236:239], v[236:239], v[116:119]
    ds_read_b128 v[236:239], v253 offset:6240
    v_fmac_f32 v212, -4.0, v208
    v_mfma_f32_16x16x32_bf16 v[116:119], a[248:251], v[228:231], v[116:119]
    buffer_load_dwordx4 a[216:219], v254, s[8:11], s42 offen offset:0 sc1
    v_mfma_f32_16x16x32_bf16 v[116:119], v[244:247], v[232:235], v[116:119]
    v_fma_f32 v208, v206, s24, v210
    v_fmac_f32 v210, -4.0, v206
    v_mfma_f32_16x16x32_bf16 v[120:123], a[228:231], v[228:231], v[120:123]
    v_fma_f32 v206, v210, s26, v212
    v_fmac_f32 v212, s27, v210
    v_mfma_f32_16x16x32_bf16 v[120:123], a[240:243], v[232:235], v[120:123]
    s_waitcnt lgkmcnt(0)
    v_fma_f32 v210, v208, 2.0, v249
    v_fmac_f32 v249, -2.0, v208
    v_mfma_f32_16x16x32_bf16 v[120:123], a[252:255], v[236:239], v[120:123]
    v_cvt_pk_bf16_f32 v206, v248, v206
    v_cvt_pk_bf16_f32 v212, v251, v212
    v_mfma_f32_16x16x32_bf16 v[124:127], v[240:243], v[236:239], v[124:127]
    buffer_load_dwordx4 a[220:223], v254, s[8:11], s42 offen offset:1024 sc1
    v_mfma_f32_16x16x32_bf16 v[124:127], a[244:247], v[232:235], v[124:127]
    v_cvt_pk_bf16_f32 v210, v250, v210
    v_cvt_pk_bf16_f32 v208, v252, v249
    v_mfma_f32_16x16x32_bf16 v[124:127], a[232:235], v[228:231], v[124:127]
    v_lshlrev_b32 v248, 16, v207
    v_lshlrev_b32 v249, 16, v209
    v_mfma_f32_16x16x32_bf16 v[128:131], a[236:239], v[228:231], v[128:131]
    ds_read_b128 v[228:231], v253 offset:8064
    v_lshlrev_b32 v250, 16, v211
    v_mfma_f32_16x16x32_bf16 v[128:131], a[248:251], v[232:235], v[128:131]
    buffer_load_dwordx4 a[224:227], v254, s[8:11], s42 offen offset:2048 sc1
    v_mfma_f32_16x16x32_bf16 v[128:131], v[244:247], v[236:239], v[128:131]
    v_lshlrev_b32 v251, 16, v213
    v_and_b32 v207, s22, v207
    v_mfma_f32_16x16x32_bf16 v[132:135], a[228:231], v[232:235], v[132:135]
    v_and_b32 v209, s22, v209
    v_and_b32 v211, s22, v211
    v_mfma_f32_16x16x32_bf16 v[132:135], a[240:243], v[236:239], v[132:135]
    s_waitcnt lgkmcnt(0)
    v_and_b32 v213, s22, v213
    v_lshlrev_b32 v252, 16, v205
    v_mfma_f32_16x16x32_bf16 v[132:135], a[252:255], v[228:231], v[132:135]
    v_and_b32 v205, s22, v205
    v_fmac_f32 v252, s25, v251
    v_mfma_f32_16x16x32_bf16 v[136:139], v[240:243], v[228:231], v[136:139]
    v_fmac_f32 v205, s25, v213
    v_fmac_f32 v252, s28, v249
    v_mfma_f32_16x16x32_bf16 v[136:139], a[244:247], v[236:239], v[136:139]
    v_fmac_f32 v205, s28, v209
    v_cvt_pk_bf16_f32 v205, v252, v205
    v_lshlrev_b32 v252, 16, v215
    v_mfma_f32_16x16x32_bf16 v[136:139], a[232:235], v[232:235], v[136:139]
    v_and_b32 v215, s22, v215
    v_fmac_f32 v252, s29, v248
    v_mfma_f32_16x16x32_bf16 v[140:143], a[236:239], v[232:235], v[140:143]
    ds_read_b128 v[232:235], v253 offset:7808
    v_fmac_f32 v215, s29, v207
    v_mfma_f32_16x16x32_bf16 v[140:143], a[248:251], v[236:239], v[140:143]
    v_fmac_f32 v252, s23, v250
    v_fmac_f32 v215, s23, v211
    v_mfma_f32_16x16x32_bf16 v[140:143], v[244:247], v[228:231], v[140:143]
    v_cvt_pk_bf16_f32 v215, v252, v215
    v_fma_f32 v252, v249, s24, v251
    v_mfma_f32_16x16x32_bf16 v[144:147], a[228:231], v[236:239], v[144:147]
    v_fmac_f32 v251, -4.0, v249
    v_fma_f32 v249, v248, s24, v250
    v_mfma_f32_16x16x32_bf16 v[144:147], a[240:243], v[228:231], v[144:147]
    s_waitcnt lgkmcnt(0)
    v_fmac_f32 v250, -4.0, v248
    v_fma_f32 v248, v250, s26, v251
    v_mfma_f32_16x16x32_bf16 v[144:147], a[252:255], v[232:235], v[144:147]
    v_fmac_f32 v251, s27, v250
    v_fma_f32 v250, v249, 2.0, v252
    v_mfma_f32_16x16x32_bf16 v[148:151], v[240:243], v[232:235], v[148:151]
    v_fmac_f32 v252, -2.0, v249
    v_fma_f32 v249, v209, s24, v213
    v_mfma_f32_16x16x32_bf16 v[148:151], a[244:247], v[228:231], v[148:151]
    v_fmac_f32 v213, -4.0, v209
    v_fma_f32 v209, v207, s24, v211
    v_mfma_f32_16x16x32_bf16 v[148:151], a[232:235], v[236:239], v[148:151]
    v_fmac_f32 v211, -4.0, v207
    v_fma_f32 v207, v211, s26, v213
    v_mfma_f32_16x16x32_bf16 v[152:155], a[236:239], v[236:239], v[152:155]
    ds_read_b128 v[236:239], v253 offset:7552
    v_fmac_f32 v213, s27, v211
    v_mfma_f32_16x16x32_bf16 v[152:155], a[248:251], v[228:231], v[152:155]
    v_fma_f32 v211, v209, 2.0, v249
    v_fmac_f32 v249, -2.0, v209
    v_mfma_f32_16x16x32_bf16 v[152:155], v[244:247], v[232:235], v[152:155]
    v_cvt_pk_bf16_f32 v207, v248, v207
    v_cvt_pk_bf16_f32 v213, v251, v213
    v_mfma_f32_16x16x32_bf16 v[156:159], a[228:231], v[228:231], v[156:159]
    v_cvt_pk_bf16_f32 v211, v250, v211
    v_cvt_pk_bf16_f32 v209, v252, v249
    v_mfma_f32_16x16x32_bf16 v[156:159], a[240:243], v[232:235], v[156:159]
    s_waitcnt lgkmcnt(0)
    v_lshrrev_b32 v252, 15, v255
    v_mfma_f32_16x16x32_bf16 v[156:159], a[252:255], v[236:239], v[156:159]
    ds_write_b64 v252, v[206:207] offset:8320
    v_mfma_f32_16x16x32_bf16 v[160:163], v[240:243], v[236:239], v[160:163]
    v_lshrrev_b32 v206, 15, v255
    v_mfma_f32_16x16x32_bf16 v[160:163], a[244:247], v[232:235], v[160:163]
    ds_write_b64 v206, v[212:213] offset:10400
    v_mfma_f32_16x16x32_bf16 v[160:163], a[232:235], v[228:231], v[160:163]
    s_waitcnt vmcnt(9)
    v_lshlrev_b32 v248, 16, v218
    v_lshlrev_b32 v249, 16, v220
    v_mfma_f32_16x16x32_bf16 v[164:167], a[236:239], v[228:231], v[164:167]
    ds_read_b128 v[228:231], v253 offset:7296
    v_lshlrev_b32 v250, 16, v222
    v_mfma_f32_16x16x32_bf16 v[164:167], a[248:251], v[232:235], v[164:167]
    ds_write_b64 v206, v[210:211] offset:12480
    v_mfma_f32_16x16x32_bf16 v[164:167], v[244:247], v[236:239], v[164:167]
    v_lshlrev_b32 v251, 16, v224
    v_and_b32 v218, s22, v218
    v_mfma_f32_16x16x32_bf16 v[168:171], a[228:231], v[232:235], v[168:171]
    ds_write_b64 v206, v[204:205] offset:22880
    v_mfma_f32_16x16x32_bf16 v[168:171], a[240:243], v[236:239], v[168:171]
    s_waitcnt lgkmcnt(2)
    v_and_b32 v220, s22, v220
    v_and_b32 v222, s22, v222
    v_mfma_f32_16x16x32_bf16 v[168:171], a[252:255], v[228:231], v[168:171]
    ds_write_b64 v206, v[214:215] offset:31200
    v_mfma_f32_16x16x32_bf16 v[172:175], v[240:243], v[228:231], v[172:175]
    v_and_b32 v224, s22, v224
    v_lshlrev_b32 v252, 16, v216
    v_mfma_f32_16x16x32_bf16 v[172:175], a[244:247], v[236:239], v[172:175]
    ds_write_b64 v206, v[208:209] offset:0
    v_mfma_f32_16x16x32_bf16 v[172:175], a[232:235], v[232:235], v[172:175]
    v_and_b32 v216, s22, v216
    v_fmac_f32 v252, s25, v251
    v_mfma_f32_16x16x32_bf16 v[176:179], a[236:239], v[232:235], v[176:179]
    ds_read_b128 v[232:235], v253 offset:7024
    v_fmac_f32 v216, s25, v224
    v_mfma_f32_16x16x32_bf16 v[176:179], a[248:251], v[236:239], v[176:179]
    v_fmac_f32 v252, s28, v249
    v_fmac_f32 v216, s28, v220
    v_mfma_f32_16x16x32_bf16 v[176:179], v[244:247], v[228:231], v[176:179]
    s_mov_b32 s42, 774144
    v_cvt_pk_bf16_f32 v216, v252, v216
    v_lshlrev_b32 v252, 16, v226
    v_mfma_f32_16x16x32_bf16 v[180:183], a[228:231], v[236:239], v[180:183]
    s_waitcnt lgkmcnt(0)
    v_and_b32 v226, s22, v226
    v_fmac_f32 v252, s29, v248
    v_mfma_f32_16x16x32_bf16 v[184:187], a[232:235], v[236:239], v[184:187]
    s_barrier
    v_mfma_f32_16x16x32_bf16 v[188:191], a[236:239], v[236:239], v[188:191]
    ds_read_b128 v[236:239], v253 offset:9360
    v_fmac_f32 v226, s29, v218
    v_mfma_f32_16x16x32_bf16 v[188:191], a[248:251], v[228:231], v[188:191]
    buffer_load_dwordx4 a[228:231], v254, s[8:11], s42 offen offset:0 sc1
    v_mfma_f32_16x16x32_bf16 v[184:187], a[244:247], v[228:231], v[184:187]
    v_fmac_f32 v252, s23, v250
    v_fmac_f32 v226, s23, v222
    v_mfma_f32_16x16x32_bf16 v[180:183], a[240:243], v[228:231], v[180:183]
    ds_read_b128 v[228:231], v253 offset:9088
    v_cvt_pk_bf16_f32 v226, v252, v226
    v_mfma_f32_16x16x32_bf16 v[180:183], a[252:255], v[232:235], v[180:183]
    buffer_load_dwordx4 a[232:235], v254, s[8:11], s42 offen offset:1024 sc1
    v_mfma_f32_16x16x32_bf16 v[184:187], v[240:243], v[232:235], v[184:187]
    s_waitcnt vmcnt(8) lgkmcnt(1)
    v_fma_f32 v252, v249, s24, v251
    v_fmac_f32 v251, -4.0, v249
    v_mfma_f32_16x16x32_bf16 v[188:191], v[244:247], v[232:235], v[188:191]
    ds_read_b128 v[232:235], v253 offset:8832
    v_fma_f32 v249, v248, s24, v250
sub20:
    v_mfma_f32_16x16x32_bf16 a[0:3], a[192:195], v[236:239], a[0:3]
    buffer_load_dwordx4 a[236:239], v254, s[8:11], s42 offen offset:2048 sc1
    v_mfma_f32_16x16x32_bf16 a[4:7], a[196:199], v[236:239], a[4:7]
    s_mov_b32 s42, 777216
    v_fmac_f32 v250, -4.0, v248
    v_fma_f32 v248, v250, s26, v251
    v_mfma_f32_16x16x32_bf16 a[8:11], a[200:203], v[236:239], a[8:11]
    ds_read_b128 v[236:239], v253 offset:8576
    s_waitcnt vmcnt(6)
    s_waitcnt lgkmcnt(2)
    v_mfma_f32_16x16x32_bf16 a[8:11], a[212:215], v[228:231], a[8:11]
    v_fmac_f32 v251, s27, v250
    v_fma_f32 v250, v249, 2.0, v252
    v_mfma_f32_16x16x32_bf16 a[4:7], a[208:211], v[228:231], a[4:7]
    buffer_load_dwordx4 a[240:243], v254, s[8:11], s42 offen offset:0 sc1
    v_mfma_f32_16x16x32_bf16 a[0:3], a[204:207], v[228:231], a[0:3]
    s_waitcnt vmcnt(4) lgkmcnt(1)
    v_fmac_f32 v252, -2.0, v249
    v_fma_f32 v249, v220, s24, v224
    v_mfma_f32_16x16x32_bf16 a[0:3], a[216:219], v[232:235], a[0:3]
    v_fmac_f32 v224, -4.0, v220
    v_fma_f32 v220, v218, s24, v222
    v_mfma_f32_16x16x32_bf16 a[4:7], a[220:223], v[232:235], a[4:7]
    v_fmac_f32 v222, -4.0, v218
    v_fma_f32 v218, v222, s26, v224
    v_mfma_f32_16x16x32_bf16 a[8:11], a[224:227], v[232:235], a[8:11]
    buffer_load_dwordx4 a[244:247], v254, s[8:11], s42 offen offset:1024 sc1
    v_mfma_f32_16x16x32_bf16 a[12:15], a[192:195], v[228:231], a[12:15]
    v_fmac_f32 v224, s27, v222
    v_fma_f32 v222, v220, 2.0, v249
    v_mfma_f32_16x16x32_bf16 a[12:15], a[204:207], v[232:235], a[12:15]
    s_waitcnt lgkmcnt(0)
    v_fmac_f32 v249, -2.0, v220
    v_cvt_pk_bf16_f32 v218, v248, v218
    v_mfma_f32_16x16x32_bf16 a[12:15], a[216:219], v[236:239], a[12:15]
    v_cvt_pk_bf16_f32 v224, v251, v224
    v_cvt_pk_bf16_f32 v222, v250, v222
    v_mfma_f32_16x16x32_bf16 a[16:19], a[220:223], v[236:239], a[16:19]
    buffer_load_dwordx4 a[248:251], v254, s[8:11], s42 offen offset:2048 sc1
    v_mfma_f32_16x16x32_bf16 a[16:19], a[208:211], v[232:235], a[16:19]
    s_mov_b32 s42, 780288
    v_cvt_pk_bf16_f32 v220, v252, v249
    v_lshlrev_b32 v248, 16, v219
    v_mfma_f32_16x16x32_bf16 a[16:19], a[196:199], v[228:231], a[16:19]
    v_lshlrev_b32 v249, 16, v221
    v_lshlrev_b32 v250, 16, v223
    v_mfma_f32_16x16x32_bf16 a[20:23], a[200:203], v[228:231], a[20:23]
    ds_read_b128 v[228:231], v253 offset:8320
    v_lshlrev_b32 v251, 16, v225
    v_mfma_f32_16x16x32_bf16 a[20:23], a[212:215], v[232:235], a[20:23]
    buffer_load_dwordx4 a[252:255], v254, s[8:11], s42 offen offset:0 sc1
    v_mfma_f32_16x16x32_bf16 a[20:23], a[224:227], v[236:239], a[20:23]
    v_and_b32 v219, s22, v219
    v_and_b32 v221, s22, v221
    v_mfma_f32_16x16x32_bf16 a[24:27], a[192:195], v[232:235], a[24:27]
    v_and_b32 v223, s22, v223
    v_and_b32 v225, s22, v225
    v_mfma_f32_16x16x32_bf16 a[24:27], a[204:207], v[236:239], a[24:27]
    s_waitcnt lgkmcnt(0)
    v_lshlrev_b32 v252, 16, v217
    v_and_b32 v217, s22, v217
    v_mfma_f32_16x16x32_bf16 a[24:27], a[216:219], v[228:231], a[24:27]
    v_fmac_f32 v252, s25, v251
    v_fmac_f32 v217, s25, v225
    v_mfma_f32_16x16x32_bf16 a[28:31], a[220:223], v[228:231], a[28:31]
    buffer_load_dwordx4 v[240:243], v254, s[8:11], s42 offen offset:1024 sc1
    v_mfma_f32_16x16x32_bf16 a[28:31], a[208:211], v[236:239], a[28:31]
    v_fmac_f32 v252, s28, v249
    v_fmac_f32 v217, s28, v221
    v_mfma_f32_16x16x32_bf16 a[28:31], a[196:199], v[232:235], a[28:31]
    v_cvt_pk_bf16_f32 v217, v252, v217
    v_lshlrev_b32 v252, 16, v227
    v_mfma_f32_16x16x32_bf16 a[32:35], a[200:203], v[232:235], a[32:35]
    ds_read_b128 v[232:235], v253 offset:10144
    v_and_b32 v227, s22, v227
    v_mfma_f32_16x16x32_bf16 a[32:35], a[212:215], v[236:239], a[32:35]
    buffer_load_dwordx4 v[244:247], v254, s[8:11], s42 offen offset:2048 sc1
    v_mfma_f32_16x16x32_bf16 a[32:35], a[224:227], v[228:231], a[32:35]
    v_fmac_f32 v252, s29, v248
    v_fmac_f32 v227, s29, v219
    v_mfma_f32_16x16x32_bf16 a[36:39], a[192:195], v[236:239], a[36:39]
    v_and_b32 v192, 0x1f0, v254
    v_mul_u32_u24 v192, 96, v192
    v_mfma_f32_16x16x32_bf16 a[36:39], a[204:207], v[228:231], a[36:39]
    s_waitcnt lgkmcnt(0)
    v_fmac_f32 v252, s23, v250
    v_fmac_f32 v227, s23, v223
    v_mfma_f32_16x16x32_bf16 a[36:39], a[216:219], v[232:235], a[36:39]
    buffer_load_dword v192, v192, s[4:7], s100 offen offset:384
    v_mfma_f32_16x16x32_bf16 a[40:43], a[220:223], v[232:235], a[40:43]
    v_cvt_pk_bf16_f32 v227, v252, v227
    v_fma_f32 v252, v249, s24, v251
    v_mfma_f32_16x16x32_bf16 a[40:43], a[208:211], v[228:231], a[40:43]
    v_fmac_f32 v251, -4.0, v249
    v_fma_f32 v249, v248, s24, v250
    v_mfma_f32_16x16x32_bf16 a[40:43], a[196:199], v[236:239], a[40:43]
    v_fmac_f32 v250, -4.0, v248
    v_fma_f32 v248, v250, s26, v251
    v_mfma_f32_16x16x32_bf16 a[44:47], a[200:203], v[236:239], a[44:47]
    ds_read_b128 v[236:239], v253 offset:9888
    v_fmac_f32 v251, s27, v250
    v_mfma_f32_16x16x32_bf16 a[44:47], a[212:215], v[228:231], a[44:47]
    v_fma_f32 v250, v249, 2.0, v252
    v_fmac_f32 v252, -2.0, v249
    v_mfma_f32_16x16x32_bf16 a[44:47], a[224:227], v[232:235], a[44:47]
pad7:
    s_cbranch_vccnz pad11
    v_fma_f32 v249, v221, s24, v225
    v_fmac_f32 v225, -4.0, v221
    v_mfma_f32_16x16x32_bf16 a[48:51], a[192:195], v[228:231], a[48:51]
    v_fma_f32 v221, v219, s24, v223
    v_fmac_f32 v223, -4.0, v219
    v_mfma_f32_16x16x32_bf16 a[48:51], a[204:207], v[232:235], a[48:51]
    s_waitcnt lgkmcnt(0)
    v_fma_f32 v219, v223, s26, v225
    v_fmac_f32 v225, s27, v223
    v_mfma_f32_16x16x32_bf16 a[48:51], a[216:219], v[236:239], a[48:51]
    v_fma_f32 v223, v221, 2.0, v249
    v_fmac_f32 v249, -2.0, v221
    v_mfma_f32_16x16x32_bf16 a[52:55], a[220:223], v[236:239], a[52:55]
    v_cvt_pk_bf16_f32 v219, v248, v219
    v_cvt_pk_bf16_f32 v225, v251, v225
    v_mfma_f32_16x16x32_bf16 a[52:55], a[208:211], v[232:235], a[52:55]
    v_cvt_pk_bf16_f32 v223, v250, v223
    v_cvt_pk_bf16_f32 v221, v252, v249
    v_mfma_f32_16x16x32_bf16 a[52:55], a[196:199], v[228:231], a[52:55]
    v_and_b32 v248, 0xf0, v254
    v_lshrrev_b32 v248, 1, v248
    v_mfma_f32_16x16x32_bf16 a[56:59], a[200:203], v[228:231], a[56:59]
    ds_read_b128 v[228:231], v253 offset:9632
    v_add_u32 v248, s52, v248
    v_mfma_f32_16x16x32_bf16 a[56:59], a[212:215], v[232:235], a[56:59]
    v_and_b32 v252, 8, v248
    v_lshrrev_b32 v249, 6, v248
    v_mfma_f32_16x16x32_bf16 a[56:59], a[224:227], v[236:239], a[56:59]
    v_mul_u32_u24 v249, 192, v249
    v_add_u32 v252, v252, v249
    v_mfma_f32_16x16x32_bf16 a[60:63], a[192:195], v[232:235], a[60:63]
    v_bfe_u32 v249, v248, 4, 2
    v_mul_u32_u24 v249, 40704, v249
    v_mfma_f32_16x16x32_bf16 a[60:63], a[204:207], v[236:239], a[60:63]
    s_waitcnt lgkmcnt(0)
    v_add_u32 v252, v252, v249
    v_and_b32 v249, 32, v248
    v_mfma_f32_16x16x32_bf16 a[60:63], a[216:219], v[228:231], a[60:63]
    v_lshl_add_u32 v252, v249, 1, v252
    v_bfe_u32 v249, v254, 8, 1
    v_mfma_f32_16x16x32_bf16 a[64:67], a[220:223], v[228:231], a[64:67]
    v_lshl_add_u32 v252, v249, 4, v252
    v_mov_b32 v249, 123328
    v_mfma_f32_16x16x32_bf16 a[64:67], a[208:211], v[236:239], a[64:67]
    v_cndmask_b32 v252, v249, v252, s[58:59]
    v_mfma_f32_16x16x32_bf16 a[64:67], a[196:199], v[232:235], a[64:67]
    ds_write_b64 v252, v[216:217] offset:39520
    v_mfma_f32_16x16x32_bf16 a[68:71], a[200:203], v[232:235], a[68:71]
    ds_read_b128 v[232:235], v253 offset:9376
    v_mfma_f32_16x16x32_bf16 a[68:71], a[212:215], v[236:239], a[68:71]
    ds_write_b64 v252, v[218:219] offset:39552
    v_mfma_f32_16x16x32_bf16 a[68:71], a[224:227], v[228:231], a[68:71]
    v_mfma_f32_16x16x32_bf16 a[72:75], a[192:195], v[236:239], a[72:75]
    ds_write_b64 v252, v[224:225] offset:39584
    v_mfma_f32_16x16x32_bf16 a[72:75], a[204:207], v[228:231], a[72:75]
    s_waitcnt lgkmcnt(2)
    v_mfma_f32_16x16x32_bf16 a[72:75], a[216:219], v[232:235], a[72:75]
    ds_write_b64 v252, v[222:223] offset:39616
    v_mfma_f32_16x16x32_bf16 a[76:79], a[220:223], v[232:235], a[76:79]
    v_mfma_f32_16x16x32_bf16 a[76:79], a[208:211], v[228:231], a[76:79]
    ds_write_b64 v252, v[220:221] offset:39648
    v_mfma_f32_16x16x32_bf16 a[76:79], a[196:199], v[236:239], a[76:79]
    v_mfma_f32_16x16x32_bf16 a[80:83], a[200:203], v[236:239], a[80:83]
    ds_read_b128 v[236:239], v253 offset:9104
    v_mfma_f32_16x16x32_bf16 a[80:83], a[212:215], v[228:231], a[80:83]
    ds_write_b64 v252, v[226:227] offset:39680
    v_mfma_f32_16x16x32_bf16 a[80:83], a[224:227], v[232:235], a[80:83]
    s_mov_b32 s42, 811008
    v_mfma_f32_16x16x32_bf16 a[84:87], a[192:195], v[228:231], a[84:87]
    v_mfma_f32_16x16x32_bf16 a[88:91], a[196:199], v[228:231], a[88:91]
    v_mfma_f32_16x16x32_bf16 a[92:95], a[200:203], v[228:231], a[92:95]
    ds_read_b128 v[228:231], v253 offset:11440
    v_mfma_f32_16x16x32_bf16 a[92:95], a[212:215], v[232:235], a[92:95]
    buffer_load_dwordx4 a[192:195], v254, s[8:11], s42 offen offset:0 sc1
    v_mfma_f32_16x16x32_bf16 a[88:91], a[208:211], v[232:235], a[88:91]
    s_waitcnt lgkmcnt(2)
    v_mfma_f32_16x16x32_bf16 a[84:87], a[204:207], v[232:235], a[84:87]
    ds_read_b128 v[232:235], v253 offset:11168
    v_mfma_f32_16x16x32_bf16 a[84:87], a[216:219], v[236:239], a[84:87]
    buffer_load_dwordx4 a[196:199], v254, s[8:11], s42 offen offset:1024 sc1
    v_mfma_f32_16x16x32_bf16 a[88:91], a[220:223], v[236:239], a[88:91]
    s_waitcnt vmcnt(9) lgkmcnt(1)
    v_mfma_f32_16x16x32_bf16 a[92:95], a[224:227], v[236:239], a[92:95]
    ds_read_b128 v[236:239], v253 offset:10912
sub21:
    v_mfma_f32_16x16x32_bf16 a[96:99], a[228:231], v[228:231], a[96:99]
    buffer_load_dwordx4 a[200:203], v254, s[8:11], s42 offen offset:2048 sc1
    v_mfma_f32_16x16x32_bf16 a[100:103], a[232:235], v[228:231], a[100:103]
    s_mov_b32 s42, 814080
    v_mfma_f32_16x16x32_bf16 a[104:107], a[236:239], v[228:231], a[104:107]
    ds_read_b128 v[228:231], v253 offset:10656
    s_waitcnt vmcnt(7)
    s_waitcnt lgkmcnt(2)
    v_mfma_f32_16x16x32_bf16 a[104:107], a[248:251], v[232:235], a[104:107]
    v_bfe_u32 v251, v254, 6, 2
    v_mul_u32_u24 v248, 40704, v251
    v_mfma_f32_16x16x32_bf16 a[100:103], a[244:247], v[232:235], a[100:103]
    buffer_load_dwordx4 a[204:207], v254, s[8:11], s42 offen offset:0 sc1
    v_mfma_f32_16x16x32_bf16 a[96:99], a[240:243], v[232:235], a[96:99]
    s_waitcnt vmcnt(5) lgkmcnt(1)
    v_and_b32 v251, 0x80, v254
    v_lshrrev_b32 v251, 1, v251
    v_mfma_f32_16x16x32_bf16 a[96:99], a[252:255], v[236:239], a[96:99]
    v_add_u32 v248, v248, v251
    v_and_b32 v251, 0x40, v254
    v_mfma_f32_16x16x32_bf16 a[100:103], v[240:243], v[236:239], a[100:103]
    v_lshrrev_b32 v251, 2, v251
    v_add_u32 v248, v248, v251
    v_mfma_f32_16x16x32_bf16 a[104:107], v[244:247], v[236:239], a[104:107]
    buffer_load_dwordx4 a[208:211], v254, s[8:11], s42 offen offset:1024 sc1
    v_mfma_f32_16x16x32_bf16 a[108:111], a[228:231], v[232:235], a[108:111]
    v_bfe_u32 v251, v254, 4, 2
    v_mul_u32_u24 v251, 3104, v251
    v_mfma_f32_16x16x32_bf16 a[108:111], a[240:243], v[236:239], a[108:111]
    s_waitcnt lgkmcnt(0)
    v_add_u32 v248, v248, v251
    v_add_u32 v248, s52, v248
    v_mfma_f32_16x16x32_bf16 a[108:111], a[252:255], v[228:231], a[108:111]
    v_lshrrev_b32 v251, 8, v254
    v_lshl_add_u32 v249, v251, 3, v248
    v_mfma_f32_16x16x32_bf16 a[112:115], v[240:243], v[228:231], a[112:115]
    buffer_load_dwordx4 a[212:215], v254, s[8:11], s42 offen offset:2048 sc1
    v_mfma_f32_16x16x32_bf16 a[112:115], a[244:247], v[236:239], a[112:115]
    s_mov_b32 s42, 817152
    v_lshl_add_u32 v248, v251, 4, v248
    v_add_u32 v250, s51, v254
    v_mfma_f32_16x16x32_bf16 a[112:115], a[232:235], v[232:235], a[112:115]
    v_accvgpr_read_b32 v204, a0
    v_accvgpr_read_b32 v205, a1
    v_mfma_f32_16x16x32_bf16 a[116:119], a[236:239], v[232:235], a[116:119]
    ds_read_b128 v[232:235], v253 offset:10400
    v_accvgpr_read_b32 v206, a2
    v_mfma_f32_16x16x32_bf16 a[116:119], a[248:251], v[236:239], a[116:119]
    buffer_load_dwordx4 a[216:219], v254, s[8:11], s42 offen offset:0 sc1
    v_mfma_f32_16x16x32_bf16 a[116:119], v[244:247], v[228:231], a[116:119]
    v_accvgpr_read_b32 v207, a3
    v_accvgpr_read_b32 v208, a96
    v_mfma_f32_16x16x32_bf16 a[120:123], a[228:231], v[236:239], a[120:123]
    v_accvgpr_read_b32 v209, a97
    v_accvgpr_read_b32 v210, a98
    v_mfma_f32_16x16x32_bf16 a[120:123], a[240:243], v[228:231], a[120:123]
    s_waitcnt lgkmcnt(0)
    v_accvgpr_read_b32 v211, a99
    v_add_f32 v212, v204, v208
    v_mfma_f32_16x16x32_bf16 a[120:123], a[252:255], v[232:235], a[120:123]
    v_add_f32 v213, v205, v209
    v_add_f32 v214, v206, v210
    v_mfma_f32_16x16x32_bf16 a[124:127], v[240:243], v[232:235], a[124:127]
    buffer_load_dwordx4 a[220:223], v254, s[8:11], s42 offen offset:1024 sc1
    v_mfma_f32_16x16x32_bf16 a[124:127], a[244:247], v[228:231], a[124:127]
    v_add_f32 v215, v207, v211
    v_sub_f32 v204, v204, v208
    v_mfma_f32_16x16x32_bf16 a[124:127], a[232:235], v[236:239], a[124:127]
    v_sub_f32 v205, v205, v209
    v_sub_f32 v206, v206, v210
    v_mfma_f32_16x16x32_bf16 a[128:131], a[236:239], v[236:239], a[128:131]
    ds_read_b128 v[236:239], v253 offset:12224
    v_sub_f32 v207, v207, v211
    v_mfma_f32_16x16x32_bf16 a[128:131], a[248:251], v[228:231], a[128:131]
    buffer_load_dwordx4 a[224:227], v254, s[8:11], s42 offen offset:2048 sc1
    v_mfma_f32_16x16x32_bf16 a[128:131], v[244:247], v[232:235], a[128:131]
    v_accvgpr_write_b32 a0, v212
    v_accvgpr_write_b32 a1, v213
    v_mfma_f32_16x16x32_bf16 a[132:135], a[228:231], v[228:231], a[132:135]
    v_and_b32 v193, 0x1f0, v254
    v_mul_u32_u24 v193, 96, v193
    v_mfma_f32_16x16x32_bf16 a[132:135], a[240:243], v[232:235], a[132:135]
    s_waitcnt lgkmcnt(0)
    v_accvgpr_write_b32 a2, v214
    v_accvgpr_write_b32 a3, v215
    v_mfma_f32_16x16x32_bf16 a[132:135], a[252:255], v[236:239], a[132:135]
    buffer_load_dword v193, v193, s[4:7], s100 offen offset:768
    v_mfma_f32_16x16x32_bf16 a[136:139], v[240:243], v[236:239], a[136:139]
    v_accvgpr_write_b32 a96, v204
    v_accvgpr_write_b32 a97, v205
    v_mfma_f32_16x16x32_bf16 a[136:139], a[244:247], v[232:235], a[136:139]
    v_accvgpr_write_b32 a98, v206
    v_accvgpr_write_b32 a99, v207
    v_mfma_f32_16x16x32_bf16 a[136:139], a[232:235], v[228:231], a[136:139]
    v_accvgpr_read_b32 v204, a4
    v_accvgpr_read_b32 v205, a5
    v_mfma_f32_16x16x32_bf16 a[140:143], a[236:239], v[228:231], a[140:143]
    ds_read_b128 v[228:231], v253 offset:11968
    v_accvgpr_read_b32 v206, a6
    v_mfma_f32_16x16x32_bf16 a[140:143], a[248:251], v[232:235], a[140:143]
    v_accvgpr_read_b32 v207, a7
    v_accvgpr_read_b32 v208, a100
    v_mfma_f32_16x16x32_bf16 a[140:143], v[244:247], v[236:239], a[140:143]
    v_accvgpr_read_b32 v209, a101
    v_accvgpr_read_b32 v210, a102
    v_mfma_f32_16x16x32_bf16 a[144:147], a[228:231], v[232:235], a[144:147]
    v_accvgpr_read_b32 v211, a103
    v_add_f32 v212, v204, v208
    v_mfma_f32_16x16x32_bf16 a[144:147], a[240:243], v[236:239], a[144:147]
    s_waitcnt lgkmcnt(0)
    v_add_f32 v213, v205, v209
    v_add_f32 v214, v206, v210
    v_mfma_f32_16x16x32_bf16 a[144:147], a[252:255], v[228:231], a[144:147]
    v_add_f32 v215, v207, v211
    v_sub_f32 v204, v204, v208
    v_mfma_f32_16x16x32_bf16 a[148:151], v[240:243], v[228:231], a[148:151]
    v_sub_f32 v205, v205, v209
    v_sub_f32 v206, v206, v210
    v_mfma_f32_16x16x32_bf16 a[148:151], a[244:247], v[236:239], a[148:151]
    v_sub_f32 v207, v207, v211
    v_accvgpr_write_b32 a4, v212
    v_mfma_f32_16x16x32_bf16 a[148:151], a[232:235], v[232:235], a[148:151]
    v_accvgpr_write_b32 a5, v213
    v_accvgpr_write_b32 a6, v214
    v_mfma_f32_16x16x32_bf16 a[152:155], a[236:239], v[232:235], a[152:155]
    ds_read_b128 v[232:235], v253 offset:11712
    v_accvgpr_write_b32 a7, v215
    v_mfma_f32_16x16x32_bf16 a[152:155], a[248:251], v[236:239], a[152:155]
    v_accvgpr_write_b32 a100, v204
    v_accvgpr_write_b32 a101, v205
    v_mfma_f32_16x16x32_bf16 a[152:155], v[244:247], v[228:231], a[152:155]
    v_accvgpr_write_b32 a102, v206
    v_accvgpr_write_b32 a103, v207
    v_mfma_f32_16x16x32_bf16 a[156:159], a[228:231], v[236:239], a[156:159]
    v_accvgpr_read_b32 v204, a8
    v_accvgpr_read_b32 v205, a9
    v_mfma_f32_16x16x32_bf16 a[156:159], a[240:243], v[228:231], a[156:159]
    s_waitcnt lgkmcnt(0)
    v_accvgpr_read_b32 v206, a10
    v_accvgpr_read_b32 v207, a11
    v_mfma_f32_16x16x32_bf16 a[156:159], a[252:255], v[232:235], a[156:159]
    v_accvgpr_read_b32 v208, a104
    v_accvgpr_read_b32 v209, a105
    v_mfma_f32_16x16x32_bf16 a[160:163], v[240:243], v[232:235], a[160:163]
    v_accvgpr_read_b32 v210, a106
    v_accvgpr_read_b32 v211, a107
    v_mfma_f32_16x16x32_bf16 a[160:163], a[244:247], v[228:231], a[160:163]
    v_add_f32 v212, v204, v208
    v_add_f32 v213, v205, v209
    v_mfma_f32_16x16x32_bf16 a[160:163], a[232:235], v[236:239], a[160:163]
    v_add_f32 v214, v206, v210
    v_add_f32 v215, v207, v211
    v_mfma_f32_16x16x32_bf16 a[164:167], a[236:239], v[236:239], a[164:167]
    ds_read_b128 v[236:239], v253 offset:11456
    v_sub_f32 v204, v204, v208
    v_mfma_f32_16x16x32_bf16 a[164:167], a[248:251], v[228:231], a[164:167]
    v_sub_f32 v205, v205, v209
    v_sub_f32 v206, v206, v210
    v_mfma_f32_16x16x32_bf16 a[164:167], v[244:247], v[232:235], a[164:167]
    v_sub_f32 v207, v207, v211
    v_accvgpr_write_b32 a8, v212
    v_mfma_f32_16x16x32_bf16 a[168:171], a[228:231], v[228:231], a[168:171]
    v_accvgpr_write_b32 a9, v213
    v_accvgpr_write_b32 a10, v214
    v_mfma_f32_16x16x32_bf16 a[168:171], a[240:243], v[232:235], a[168:171]
    s_waitcnt lgkmcnt(0)
    v_accvgpr_write_b32 a11, v215
    v_accvgpr_write_b32 a104, v204
    v_mfma_f32_16x16x32_bf16 a[168:171], a[252:255], v[236:239], a[168:171]
    v_accvgpr_write_b32 a105, v205
    v_accvgpr_write_b32 a106, v206
    v_mfma_f32_16x16x32_bf16 a[172:175], v[240:243], v[236:239], a[172:175]
    v_accvgpr_write_b32 a107, v207
    v_accvgpr_read_b32 v204, a12
    v_mfma_f32_16x16x32_bf16 a[172:175], a[244:247], v[232:235], a[172:175]
    v_accvgpr_read_b32 v205, a13
    v_accvgpr_read_b32 v206, a14
    v_mfma_f32_16x16x32_bf16 a[172:175], a[232:235], v[228:231], a[172:175]
    v_accvgpr_read_b32 v207, a15
    v_accvgpr_read_b32 v208, a108
    v_mfma_f32_16x16x32_bf16 a[176:179], a[236:239], v[228:231], a[176:179]
    ds_read_b128 v[228:231], v253 offset:11184
    v_accvgpr_read_b32 v209, a109
    v_mfma_f32_16x16x32_bf16 a[176:179], a[248:251], v[232:235], a[176:179]
    v_accvgpr_read_b32 v210, a110
    v_accvgpr_read_b32 v211, a111
    v_mfma_f32_16x16x32_bf16 a[176:179], v[244:247], v[236:239], a[176:179]
    s_mov_b32 s42, 847872
    v_add_f32 v212, v204, v208
    v_add_f32 v213, v205, v209
    v_mfma_f32_16x16x32_bf16 a[180:183], a[228:231], v[232:235], a[180:183]
    v_add_f32 v214, v206, v210
    v_add_f32 v215, v207, v211
    v_mfma_f32_16x16x32_bf16 a[184:187], a[232:235], v[232:235], a[184:187]
    v_sub_f32 v204, v204, v208
    v_sub_f32 v205, v205, v209
    v_mfma_f32_16x16x32_bf16 a[188:191], a[236:239], v[232:235], a[188:191]
    ds_read_b128 v[232:235], v253 offset:13520
    v_sub_f32 v206, v206, v210
    v_mfma_f32_16x16x32_bf16 a[188:191], a[248:251], v[236:239], a[188:191]
    buffer_load_dwordx4 a[228:231], v254, s[8:11], s42 offen offset:0 sc1
    v_mfma_f32_16x16x32_bf16 a[184:187], a[244:247], v[236:239], a[184:187]
    s_waitcnt lgkmcnt(1)
    v_sub_f32 v207, v207, v211
    v_accvgpr_write_b32 a12, v212
    v_mfma_f32_16x16x32_bf16 a[180:183], a[240:243], v[236:239], a[180:183]
    ds_read_b128 v[236:239], v253 offset:13248
    v_accvgpr_write_b32 a13, v213
    v_mfma_f32_16x16x32_bf16 a[180:183], a[252:255], v[228:231], a[180:183]
    buffer_load_dwordx4 a[232:235], v254, s[8:11], s42 offen offset:1024 sc1
    v_mfma_f32_16x16x32_bf16 a[184:187], v[240:243], v[228:231], a[184:187]
    s_waitcnt vmcnt(9) lgkmcnt(1)
    v_accvgpr_write_b32 a14, v214
    v_accvgpr_write_b32 a15, v215
    v_mfma_f32_16x16x32_bf16 a[188:191], v[244:247], v[228:231], a[188:191]
    ds_read_b128 v[228:231], v253 offset:12992
    v_accvgpr_write_b32 a108, v204
sub22:
    v_mfma_f32_16x16x32_bf16 v[0:3], a[192:195], v[232:235], v[0:3]
    buffer_load_dwordx4 a[236:239], v254, s[8:11], s42 offen offset:2048 sc1
    v_mfma_f32_16x16x32_bf16 v[4:7], a[196:199], v[232:235], v[4:7]
    s_mov_b32 s42, 850944
    v_accvgpr_write_b32 a109, v205
    v_accvgpr_write_b32 a110, v206
    v_mfma_f32_16x16x32_bf16 v[8:11], a[200:203], v[232:235], v[8:11]
    ds_read_b128 v[232:235], v253 offset:12736
    s_waitcnt vmcnt(7)
    s_waitcnt lgkmcnt(2)
    v_mfma_f32_16x16x32_bf16 v[8:11], a[212:215], v[236:239], v[8:11]
    v_accvgpr_write_b32 a111, v207
    v_accvgpr_read_b32 v204, a16
    v_mfma_f32_16x16x32_bf16 v[4:7], a[208:211], v[236:239], v[4:7]
    buffer_load_dwordx4 a[240:243], v254, s[8:11], s42 offen offset:0 sc1
    v_mfma_f32_16x16x32_bf16 v[0:3], a[204:207], v[236:239], v[0:3]
    s_waitcnt vmcnt(5) lgkmcnt(1)
    v_accvgpr_read_b32 v205, a17
    v_accvgpr_read_b32 v206, a18
    v_mfma_f32_16x16x32_bf16 v[0:3], a[216:219], v[228:231], v[0:3]
    v_accvgpr_read_b32 v207, a19
    v_accvgpr_read_b32 v208, a112
    v_mfma_f32_16x16x32_bf16 v[4:7], a[220:223], v[228:231], v[4:7]
    v_accvgpr_read_b32 v209, a113
    v_accvgpr_read_b32 v210, a114
    v_mfma_f32_16x16x32_bf16 v[8:11], a[224:227], v[228:231], v[8:11]
    buffer_load_dwordx4 a[244:247], v254, s[8:11], s42 offen offset:1024 sc1
    v_mfma_f32_16x16x32_bf16 v[12:15], a[192:195], v[236:239], v[12:15]
    v_accvgpr_read_b32 v211, a115
    v_add_f32 v212, v204, v208
    v_mfma_f32_16x16x32_bf16 v[12:15], a[204:207], v[228:231], v[12:15]
    s_waitcnt lgkmcnt(0)
    v_add_f32 v213, v205, v209
    v_add_f32 v214, v206, v210
    v_mfma_f32_16x16x32_bf16 v[12:15], a[216:219], v[232:235], v[12:15]
    v_add_f32 v215, v207, v211
    v_sub_f32 v204, v204, v208
    v_mfma_f32_16x16x32_bf16 v[16:19], a[220:223], v[232:235], v[16:19]
    buffer_load_dwordx4 a[248:251], v254, s[8:11], s42 offen offset:2048 sc1
    v_mfma_f32_16x16x32_bf16 v[16:19], a[208:211], v[228:231], v[16:19]
    s_mov_b32 s42, 854016
    v_sub_f32 v205, v205, v209
    v_sub_f32 v206, v206, v210
    v_mfma_f32_16x16x32_bf16 v[16:19], a[196:199], v[236:239], v[16:19]
    v_sub_f32 v207, v207, v211
    v_accvgpr_write_b32 a16, v212
    v_mfma_f32_16x16x32_bf16 v[20:23], a[200:203], v[236:239], v[20:23]
    ds_read_b128 v[236:239], v253 offset:12480
    v_accvgpr_write_b32 a17, v213
    v_mfma_f32_16x16x32_bf16 v[20:23], a[212:215], v[228:231], v[20:23]
    buffer_load_dwordx4 a[252:255], v254, s[8:11], s42 offen offset:0 sc1
    v_mfma_f32_16x16x32_bf16 v[20:23], a[224:227], v[232:235], v[20:23]
    v_accvgpr_write_b32 a18, v214
    v_accvgpr_write_b32 a19, v215
    v_mfma_f32_16x16x32_bf16 v[24:27], a[192:195], v[228:231], v[24:27]
    v_accvgpr_write_b32 a112, v204
    v_accvgpr_write_b32 a113, v205
    v_mfma_f32_16x16x32_bf16 v[24:27], a[204:207], v[232:235], v[24:27]
    s_waitcnt lgkmcnt(0)
    v_accvgpr_write_b32 a114, v206
    v_accvgpr_write_b32 a115, v207
    v_mfma_f32_16x16x32_bf16 v[24:27], a[216:219], v[236:239], v[24:27]
    v_accvgpr_read_b32 v204, a20
    v_accvgpr_read_b32 v205, a21
    v_mfma_f32_16x16x32_bf16 v[28:31], a[220:223], v[236:239], v[28:31]
    buffer_load_dwordx4 v[240:243], v254, s[8:11], s42 offen offset:1024 sc1
    v_mfma_f32_16x16x32_bf16 v[28:31], a[208:211], v[232:235], v[28:31]
    v_accvgpr_read_b32 v206, a22
    v_accvgpr_read_b32 v207, a23
    v_mfma_f32_16x16x32_bf16 v[28:31], a[196:199], v[228:231], v[28:31]
    v_accvgpr_read_b32 v208, a116
    v_accvgpr_read_b32 v209, a117
    v_mfma_f32_16x16x32_bf16 v[32:35], a[200:203], v[228:231], v[32:35]
    ds_read_b128 v[228:231], v253 offset:14304
    v_accvgpr_read_b32 v210, a118
    v_mfma_f32_16x16x32_bf16 v[32:35], a[212:215], v[232:235], v[32:35]
    buffer_load_dwordx4 v[244:247], v254, s[8:11], s42 offen offset:2048 sc1
    v_mfma_f32_16x16x32_bf16 v[32:35], a[224:227], v[236:239], v[32:35]
    v_accvgpr_read_b32 v211, a119
    v_add_f32 v212, v204, v208
    v_mfma_f32_16x16x32_bf16 v[36:39], a[192:195], v[232:235], v[36:39]
    v_add_f32 v213, v205, v209
    v_add_f32 v214, v206, v210
    v_mfma_f32_16x16x32_bf16 v[36:39], a[204:207], v[236:239], v[36:39]
    s_waitcnt lgkmcnt(0)
    v_add_f32 v215, v207, v211
    v_sub_f32 v204, v204, v208
    v_mfma_f32_16x16x32_bf16 v[36:39], a[216:219], v[228:231], v[36:39]
    v_sub_f32 v205, v205, v209
    v_sub_f32 v206, v206, v210
    v_mfma_f32_16x16x32_bf16 v[40:43], a[220:223], v[228:231], v[40:43]
    v_sub_f32 v207, v207, v211
    v_accvgpr_write_b32 a20, v212
    v_mfma_f32_16x16x32_bf16 v[40:43], a[208:211], v[236:239], v[40:43]
    v_accvgpr_write_b32 a21, v213
    v_accvgpr_write_b32 a22, v214
    v_mfma_f32_16x16x32_bf16 v[40:43], a[196:199], v[232:235], v[40:43]
    v_accvgpr_write_b32 a23, v215
    v_accvgpr_write_b32 a116, v204
    v_mfma_f32_16x16x32_bf16 v[44:47], a[200:203], v[232:235], v[44:47]
    ds_read_b128 v[232:235], v253 offset:14048
    v_accvgpr_write_b32 a117, v205
    v_mfma_f32_16x16x32_bf16 v[44:47], a[212:215], v[236:239], v[44:47]
    v_accvgpr_write_b32 a118, v206
    v_accvgpr_write_b32 a119, v207
    v_mfma_f32_16x16x32_bf16 v[44:47], a[224:227], v[228:231], v[44:47]
    v_accvgpr_read_b32 v204, a24
    v_accvgpr_read_b32 v205, a25
    v_mfma_f32_16x16x32_bf16 v[48:51], a[192:195], v[236:239], v[48:51]
    v_accvgpr_read_b32 v206, a26
    v_accvgpr_read_b32 v207, a27
    v_mfma_f32_16x16x32_bf16 v[48:51], a[204:207], v[228:231], v[48:51]
    s_waitcnt lgkmcnt(0)
    v_accvgpr_read_b32 v208, a120
    v_accvgpr_read_b32 v209, a121
    v_mfma_f32_16x16x32_bf16 v[48:51], a[216:219], v[232:235], v[48:51]
    v_accvgpr_read_b32 v210, a122
    v_accvgpr_read_b32 v211, a123
    v_mfma_f32_16x16x32_bf16 v[52:55], a[220:223], v[232:235], v[52:55]
    v_add_f32 v212, v204, v208
    v_add_f32 v213, v205, v209
    v_mfma_f32_16x16x32_bf16 v[52:55], a[208:211], v[228:231], v[52:55]
    v_add_f32 v214, v206, v210
    v_add_f32 v215, v207, v211
    v_mfma_f32_16x16x32_bf16 v[52:55], a[196:199], v[236:239], v[52:55]
    v_sub_f32 v204, v204, v208
    v_sub_f32 v205, v205, v209
    v_mfma_f32_16x16x32_bf16 v[56:59], a[200:203], v[236:239], v[56:59]
    ds_read_b128 v[236:239], v253 offset:13792
    v_sub_f32 v206, v206, v210
    v_mfma_f32_16x16x32_bf16 v[56:59], a[212:215], v[228:231], v[56:59]
    v_sub_f32 v207, v207, v211
    v_accvgpr_write_b32 a24, v212
    v_mfma_f32_16x16x32_bf16 v[56:59], a[224:227], v[232:235], v[56:59]
    v_accvgpr_write_b32 a25, v213
    v_accvgpr_write_b32 a26, v214
    v_mfma_f32_16x16x32_bf16 v[60:63], a[192:195], v[228:231], v[60:63]
    v_accvgpr_write_b32 a27, v215
    v_accvgpr_write_b32 a120, v204
    v_mfma_f32_16x16x32_bf16 v[60:63], a[204:207], v[232:235], v[60:63]
    s_waitcnt lgkmcnt(0)
    v_accvgpr_write_b32 a121, v205
    v_accvgpr_write_b32 a122, v206
    v_mfma_f32_16x16x32_bf16 v[60:63], a[216:219], v[236:239], v[60:63]
    v_accvgpr_write_b32 a123, v207
    v_accvgpr_read_b32 v204, a84
    v_mfma_f32_16x16x32_bf16 v[64:67], a[220:223], v[236:239], v[64:67]
    v_accvgpr_read_b32 v205, a85
    v_accvgpr_read_b32 v206, a86
    v_mfma_f32_16x16x32_bf16 v[64:67], a[208:211], v[232:235], v[64:67]
    v_accvgpr_read_b32 v207, a87
    v_accvgpr_read_b32 v208, a180
    v_mfma_f32_16x16x32_bf16 v[64:67], a[196:199], v[228:231], v[64:67]
    v_accvgpr_read_b32 v209, a181
    v_accvgpr_read_b32 v210, a182
    v_mfma_f32_16x16x32_bf16 v[68:71], a[200:203], v[228:231], v[68:71]
    ds_read_b128 v[228:231], v253 offset:13536
    v_accvgpr_read_b32 v211, a183
    v_mfma_f32_16x16x32_bf16 v[68:71], a[212:215], v[232:235], v[68:71]
    v_add_f32 v212, v204, v208
    v_add_f32 v213, v205, v209
    v_mfma_f32_16x16x32_bf16 v[68:71], a[224:227], v[236:239], v[68:71]
    v_add_f32 v214, v206, v210
    v_add_f32 v215, v207, v211
    v_mfma_f32_16x16x32_bf16 v[72:75], a[192:195], v[232:235], v[72:75]
    v_sub_f32 v204, v204, v208
    v_sub_f32 v205, v205, v209
    v_mfma_f32_16x16x32_bf16 v[72:75], a[204:207], v[236:239], v[72:75]
    s_waitcnt lgkmcnt(0)
    v_sub_f32 v206, v206, v210
    v_sub_f32 v207, v207, v211
    v_mfma_f32_16x16x32_bf16 v[72:75], a[216:219], v[228:231], v[72:75]
    v_accvgpr_write_b32 a84, v212
    v_accvgpr_write_b32 a85, v213
    v_mfma_f32_16x16x32_bf16 v[76:79], a[220:223], v[228:231], v[76:79]
    v_accvgpr_write_b32 a86, v214
    v_accvgpr_write_b32 a87, v215
    v_mfma_f32_16x16x32_bf16 v[76:79], a[208:211], v[236:239], v[76:79]
    v_accvgpr_write_b32 a180, v204
    v_accvgpr_write_b32 a181, v205
    v_mfma_f32_16x16x32_bf16 v[76:79], a[196:199], v[232:235], v[76:79]
    v_accvgpr_write_b32 a182, v206
    v_accvgpr_write_b32 a183, v207
    v_mfma_f32_16x16x32_bf16 v[80:83], a[200:203], v[232:235], v[80:83]
    ds_read_b128 v[232:235], v253 offset:13264
    v_accvgpr_read_b32 v204, a88
    v_mfma_f32_16x16x32_bf16 v[80:83], a[212:215], v[236:239], v[80:83]
    v_accvgpr_read_b32 v205, a89
    v_accvgpr_read_b32 v206, a90
    v_mfma_f32_16x16x32_bf16 v[80:83], a[224:227], v[228:231], v[80:83]
    s_mov_b32 s42, 921600
    v_accvgpr_read_b32 v207, a91
    v_accvgpr_read_b32 v208, a184
    v_mfma_f32_16x16x32_bf16 v[84:87], a[192:195], v[236:239], v[84:87]
    v_accvgpr_read_b32 v209, a185
    v_accvgpr_read_b32 v210, a186
    v_mfma_f32_16x16x32_bf16 v[88:91], a[196:199], v[236:239], v[88:91]
    v_accvgpr_read_b32 v211, a187
    v_add_f32 v212, v204, v208
    v_mfma_f32_16x16x32_bf16 v[92:95], a[200:203], v[236:239], v[92:95]
    ds_read_b128 v[236:239], v253 offset:1040
    v_add_f32 v213, v205, v209
    v_mfma_f32_16x16x32_bf16 v[92:95], a[212:215], v[228:231], v[92:95]
    buffer_load_dwordx4 a[192:195], v254, s[8:11], s42 offen offset:0 sc1
    v_mfma_f32_16x16x32_bf16 v[88:91], a[208:211], v[228:231], v[88:91]
    s_waitcnt lgkmcnt(1)
    v_add_f32 v214, v206, v210
    v_add_f32 v215, v207, v211
    v_mfma_f32_16x16x32_bf16 v[84:87], a[204:207], v[228:231], v[84:87]
    ds_read_b128 v[228:231], v253 offset:768
    v_sub_f32 v204, v204, v208
    v_mfma_f32_16x16x32_bf16 v[84:87], a[216:219], v[232:235], v[84:87]
    buffer_load_dwordx4 a[196:199], v254, s[8:11], s42 offen offset:1024 sc1
    v_mfma_f32_16x16x32_bf16 v[88:91], a[220:223], v[232:235], v[88:91]
    s_waitcnt vmcnt(8) lgkmcnt(1)
    v_sub_f32 v205, v205, v209
    v_sub_f32 v206, v206, v210
    v_mfma_f32_16x16x32_bf16 v[92:95], a[224:227], v[232:235], v[92:95]
    ds_read_b128 v[232:235], v253 offset:512
    v_sub_f32 v207, v207, v211
sub23:
    v_mfma_f32_16x16x32_bf16 v[96:99], a[228:231], v[236:239], v[96:99]
    buffer_load_dwordx4 a[200:203], v254, s[8:11], s42 offen offset:2048 sc1
    v_mfma_f32_16x16x32_bf16 v[100:103], a[232:235], v[236:239], v[100:103]
    s_mov_b32 s42, 924672
    v_accvgpr_write_b32 a88, v212
    v_accvgpr_write_b32 a89, v213
    v_mfma_f32_16x16x32_bf16 v[104:107], a[236:239], v[236:239], v[104:107]
    ds_read_b128 v[236:239], v253 offset:256
    s_waitcnt vmcnt(6)
    s_waitcnt lgkmcnt(2)
    v_mfma_f32_16x16x32_bf16 v[104:107], a[248:251], v[228:231], v[104:107]
    v_accvgpr_write_b32 a90, v214
    v_accvgpr_write_b32 a91, v215
    v_mfma_f32_16x16x32_bf16 v[100:103], a[244:247], v[228:231], v[100:103]
    buffer_load_dwordx4 a[204:207], v254, s[8:11], s42 offen offset:0 sc1
    v_mfma_f32_16x16x32_bf16 v[96:99], a[240:243], v[228:231], v[96:99]
    s_waitcnt vmcnt(4) lgkmcnt(1)
    v_accvgpr_write_b32 a184, v204
    v_accvgpr_write_b32 a185, v205
    v_mfma_f32_16x16x32_bf16 v[96:99], a[252:255], v[232:235], v[96:99]
    v_accvgpr_write_b32 a186, v206
    v_accvgpr_write_b32 a187, v207
    v_mfma_f32_16x16x32_bf16 v[100:103], v[240:243], v[232:235], v[100:103]
    v_accvgpr_read_b32 v204, a92
    v_accvgpr_read_b32 v205, a93
    v_mfma_f32_16x16x32_bf16 v[104:107], v[244:247], v[232:235], v[104:107]
    buffer_load_dwordx4 a[208:211], v254, s[8:11], s42 offen offset:1024 sc1
    v_mfma_f32_16x16x32_bf16 v[108:111], a[228:231], v[228:231], v[108:111]
    v_accvgpr_read_b32 v206, a94
    v_accvgpr_read_b32 v207, a95
    v_mfma_f32_16x16x32_bf16 v[108:111], a[240:243], v[232:235], v[108:111]
    s_waitcnt lgkmcnt(0)
    v_accvgpr_read_b32 v208, a188
    v_accvgpr_read_b32 v209, a189
    v_mfma_f32_16x16x32_bf16 v[108:111], a[252:255], v[236:239], v[108:111]
    v_accvgpr_read_b32 v210, a190
    v_accvgpr_read_b32 v211, a191
    v_mfma_f32_16x16x32_bf16 v[112:115], v[240:243], v[236:239], v[112:115]
    buffer_load_dwordx4 a[212:215], v254, s[8:11], s42 offen offset:2048 sc1
    v_mfma_f32_16x16x32_bf16 v[112:115], a[244:247], v[232:235], v[112:115]
    s_mov_b32 s42, 927744
    v_add_f32 v212, v204, v208
    v_add_f32 v213, v205, v209
    v_mfma_f32_16x16x32_bf16 v[112:115], a[232:235], v[228:231], v[112:115]
    v_add_f32 v214, v206, v210
    v_add_f32 v215, v207, v211
    v_mfma_f32_16x16x32_bf16 v[116:119], a[236:239], v[228:231], v[116:119]
    ds_read_b128 v[228:231], v253 offset:0
    v_sub_f32 v204, v204, v208
    v_mfma_f32_16x16x32_bf16 v[116:119], a[248:251], v[232:235], v[116:119]
    buffer_load_dwordx4 a[216:219], v254, s[8:11], s42 offen offset:0 sc1
    v_mfma_f32_16x16x32_bf16 v[116:119], v[244:247], v[236:239], v[116:119]
    v_sub_f32 v205, v205, v209
    v_sub_f32 v206, v206, v210
    v_mfma_f32_16x16x32_bf16 v[120:123], a[228:231], v[232:235], v[120:123]
pad8:
    s_cbranch_vccnz pad12
    v_sub_f32 v207, v207, v211
    v_accvgpr_write_b32 a92, v212
    v_mfma_f32_16x16x32_bf16 v[120:123], a[240:243], v[236:239], v[120:123]
    s_waitcnt lgkmcnt(0)
    v_accvgpr_write_b32 a93, v213
    v_accvgpr_write_b32 a94, v214
    v_mfma_f32_16x16x32_bf16 v[120:123], a[252:255], v[228:231], v[120:123]
    v_accvgpr_write_b32 a95, v215
    v_accvgpr_write_b32 a188, v204
    v_mfma_f32_16x16x32_bf16 v[124:127], v[240:243], v[228:231], v[124:127]
    buffer_load_dwordx4 a[220:223], v254, s[8:11], s42 offen offset:1024 sc1
    v_mfma_f32_16x16x32_bf16 v[124:127], a[244:247], v[236:239], v[124:127]
    v_accvgpr_write_b32 a189, v205
    v_accvgpr_write_b32 a190, v206
    v_mfma_f32_16x16x32_bf16 v[124:127], a[232:235], v[232:235], v[124:127]
    v_accvgpr_write_b32 a191, v207
    v_accvgpr_read_b32 v204, a0
    v_mfma_f32_16x16x32_bf16 v[128:131], a[236:239], v[232:235], v[128:131]
    ds_read_b128 v[232:235], v253 offset:1824
    v_accvgpr_read_b32 v205, a1
    v_mfma_f32_16x16x32_bf16 v[128:131], a[248:251], v[236:239], v[128:131]
    buffer_load_dwordx4 a[224:227], v254, s[8:11], s42 offen offset:2048 sc1
    v_mfma_f32_16x16x32_bf16 v[128:131], v[244:247], v[228:231], v[128:131]
    v_accvgpr_read_b32 v206, a2
    v_accvgpr_read_b32 v207, a3
    v_mfma_f32_16x16x32_bf16 v[132:135], a[228:231], v[236:239], v[132:135]
    v_and_b32 v252, 0x1f0, v254
    v_mul_u32_u24 v252, 96, v252
    v_mfma_f32_16x16x32_bf16 v[132:135], a[240:243], v[228:231], v[132:135]
    s_waitcnt lgkmcnt(0)
    v_add_f32 v208, v0, v96
    v_add_f32 v209, v1, v97
    v_mfma_f32_16x16x32_bf16 v[132:135], a[252:255], v[232:235], v[132:135]
    buffer_load_dword v252, v252, s[4:7], s100 offen offset:1152
    v_mfma_f32_16x16x32_bf16 v[136:139], v[240:243], v[232:235], v[136:139]
    v_add_f32 v210, v2, v98
    v_add_f32 v211, v3, v99
    v_mfma_f32_16x16x32_bf16 v[136:139], a[244:247], v[228:231], v[136:139]
    v_sub_f32 v96, v0, v96
    v_sub_f32 v97, v1, v97
    v_mfma_f32_16x16x32_bf16 v[136:139], a[232:235], v[236:239], v[136:139]
    v_sub_f32 v98, v2, v98
    v_sub_f32 v99, v3, v99
    v_mfma_f32_16x16x32_bf16 v[140:143], a[236:239], v[236:239], v[140:143]
    ds_read_b128 v[236:239], v253 offset:1568
    v_fma_f32 v0, v208, s31, v204
    v_mfma_f32_16x16x32_bf16 v[140:143], a[248:251], v[228:231], v[140:143]
    v_fma_f32 v1, v209, s31, v205
    v_fma_f32 v2, v210, s31, v206
    v_mfma_f32_16x16x32_bf16 v[140:143], v[244:247], v[232:235], v[140:143]
    v_fma_f32 v3, v211, s31, v207
    v_fmac_f32 v208, s30, v204
    v_mfma_f32_16x16x32_bf16 v[144:147], a[228:231], v[228:231], v[144:147]
    v_fmac_f32 v209, s30, v205
    v_fmac_f32 v210, s30, v206
    v_mfma_f32_16x16x32_bf16 v[144:147], a[240:243], v[232:235], v[144:147]
    s_waitcnt lgkmcnt(0)
    v_fmac_f32 v211, s30, v207
    v_cvt_pk_bf16_f32 v194, v208, v209
    v_mfma_f32_16x16x32_bf16 v[144:147], a[252:255], v[236:239], v[144:147]
    v_cvt_pk_bf16_f32 v195, v210, v211
    v_accvgpr_read_b32 v204, a4
    v_mfma_f32_16x16x32_bf16 v[148:151], v[240:243], v[236:239], v[148:151]
    v_accvgpr_read_b32 v205, a5
    v_accvgpr_read_b32 v206, a6
    v_mfma_f32_16x16x32_bf16 v[148:151], a[244:247], v[232:235], v[148:151]
    v_accvgpr_read_b32 v207, a7
    v_add_f32 v208, v4, v100
    v_mfma_f32_16x16x32_bf16 v[148:151], a[232:235], v[228:231], v[148:151]
    v_add_f32 v209, v5, v101
    v_add_f32 v210, v6, v102
    v_mfma_f32_16x16x32_bf16 v[152:155], a[236:239], v[228:231], v[152:155]
    ds_read_b128 v[228:231], v253 offset:1312
    v_add_f32 v211, v7, v103
    v_mfma_f32_16x16x32_bf16 v[152:155], a[248:251], v[232:235], v[152:155]
    v_sub_f32 v100, v4, v100
    v_sub_f32 v101, v5, v101
    v_mfma_f32_16x16x32_bf16 v[152:155], v[244:247], v[236:239], v[152:155]
    v_sub_f32 v102, v6, v102
    v_sub_f32 v103, v7, v103
    v_mfma_f32_16x16x32_bf16 v[156:159], a[228:231], v[232:235], v[156:159]
    v_fma_f32 v4, v208, s31, v204
    v_fma_f32 v5, v209, s31, v205
    v_mfma_f32_16x16x32_bf16 v[156:159], a[240:243], v[236:239], v[156:159]
    s_waitcnt lgkmcnt(0)
    v_fma_f32 v6, v210, s31, v206
    v_fma_f32 v7, v211, s31, v207
    v_mfma_f32_16x16x32_bf16 v[156:159], a[252:255], v[228:231], v[156:159]
    v_fmac_f32 v208, s30, v204
    v_fmac_f32 v209, s30, v205
    v_mfma_f32_16x16x32_bf16 v[160:163], v[240:243], v[228:231], v[160:163]
    v_fmac_f32 v210, s30, v206
    v_fmac_f32 v211, s30, v207
    v_mfma_f32_16x16x32_bf16 v[160:163], a[244:247], v[236:239], v[160:163]
    v_cvt_pk_bf16_f32 v196, v208, v209
    v_cvt_pk_bf16_f32 v197, v210, v211
    v_mfma_f32_16x16x32_bf16 v[160:163], a[232:235], v[232:235], v[160:163]
    v_accvgpr_read_b32 v204, a8
    v_accvgpr_read_b32 v205, a9
    v_mfma_f32_16x16x32_bf16 v[164:167], a[236:239], v[232:235], v[164:167]
    ds_read_b128 v[232:235], v253 offset:1056
    v_accvgpr_read_b32 v206, a10
    v_mfma_f32_16x16x32_bf16 v[164:167], a[248:251], v[236:239], v[164:167]
    v_accvgpr_read_b32 v207, a11
    v_add_f32 v208, v8, v104
    v_mfma_f32_16x16x32_bf16 v[164:167], v[244:247], v[228:231], v[164:167]
    v_add_f32 v209, v9, v105
    v_add_f32 v210, v10, v106
    v_mfma_f32_16x16x32_bf16 v[168:171], a[228:231], v[236:239], v[168:171]
    v_add_f32 v211, v11, v107
    v_sub_f32 v104, v8, v104
    v_mfma_f32_16x16x32_bf16 v[168:171], a[240:243], v[228:231], v[168:171]
    s_waitcnt lgkmcnt(0)
    v_sub_f32 v105, v9, v105
    v_sub_f32 v106, v10, v106
    v_mfma_f32_16x16x32_bf16 v[168:171], a[252:255], v[232:235], v[168:171]
    v_sub_f32 v107, v11, v107
    v_fma_f32 v8, v208, s31, v204
    v_mfma_f32_16x16x32_bf16 v[172:175], v[240:243], v[232:235], v[172:175]
    v_fma_f32 v9, v209, s31, v205
    v_fma_f32 v10, v210, s31, v206
    v_mfma_f32_16x16x32_bf16 v[172:175], a[244:247], v[228:231], v[172:175]
    v_fma_f32 v11, v211, s31, v207
    v_fmac_f32 v208, s30, v204
    v_mfma_f32_16x16x32_bf16 v[172:175], a[232:235], v[236:239], v[172:175]
    v_fmac_f32 v209, s30, v205
    v_fmac_f32 v210, s30, v206
    v_mfma_f32_16x16x32_bf16 v[176:179], a[236:239], v[236:239], v[176:179]
    ds_read_b128 v[236:239], v253 offset:784
    v_fmac_f32 v211, s30, v207
    v_mfma_f32_16x16x32_bf16 v[176:179], a[248:251], v[228:231], v[176:179]
    v_cvt_pk_bf16_f32 v198, v208, v209
    v_cvt_pk_bf16_f32 v199, v210, v211
    v_mfma_f32_16x16x32_bf16 v[176:179], v[244:247], v[232:235], v[176:179]
    s_mov_b32 s42, 958464
    v_mfma_f32_16x16x32_bf16 v[180:183], a[228:231], v[228:231], v[180:183]
    s_waitcnt lgkmcnt(0)
    v_mfma_f32_16x16x32_bf16 v[184:187], a[232:235], v[228:231], v[184:187]
    s_barrier
    v_mfma_f32_16x16x32_bf16 v[188:191], a[236:239], v[228:231], v[188:191]
    ds_read_b128 v[228:231], v253 offset:15600
    v_mfma_f32_16x16x32_bf16 v[188:191], a[248:251], v[232:235], v[188:191]
    buffer_load_dwordx4 a[228:231], v254, s[8:11], s42 offen offset:0 sc1
    v_mfma_f32_16x16x32_bf16 v[184:187], a[244:247], v[232:235], v[184:187]
    v_mfma_f32_16x16x32_bf16 v[180:183], a[240:243], v[232:235], v[180:183]
    ds_read_b128 v[232:235], v253 offset:15328
    v_mfma_f32_16x16x32_bf16 v[180:183], a[252:255], v[236:239], v[180:183]
    buffer_load_dwordx4 a[232:235], v254, s[8:11], s42 offen offset:1024 sc1
    v_mfma_f32_16x16x32_bf16 v[184:187], v[240:243], v[236:239], v[184:187]
    s_waitcnt vmcnt(9) lgkmcnt(1)
    v_mfma_f32_16x16x32_bf16 v[188:191], v[244:247], v[236:239], v[188:191]
    ds_read_b128 v[236:239], v253 offset:15072
    s_nop 0
    ds_write_b128 v248, v[194:197] offset:0
    v_accvgpr_read_b32 v204, a12
    v_accvgpr_read_b32 v205, a13
    v_accvgpr_read_b32 v206, a14
    v_accvgpr_read_b32 v207, a15
    v_pk_add_f32 v[208:209], v[12:13], v[108:109]
    v_pk_add_f32 v[210:211], v[14:15], v[110:111]
    v_pk_add_f32 v[108:109], v[12:13], v[108:109] neg_lo:[0,1] neg_hi:[0,1]
    v_pk_add_f32 v[110:111], v[14:15], v[110:111] neg_lo:[0,1] neg_hi:[0,1]
    v_pk_fma_f32 v[12:13], v[208:209], s[30:31], v[204:205] op_sel:[0,1,0]
    v_pk_fma_f32 v[14:15], v[210:211], s[30:31], v[206:207] op_sel:[0,1,0]
    v_pk_fma_f32 v[204:205], v[204:205], s[30:31], v[208:209] op_sel_hi:[1,0,1]
    v_pk_fma_f32 v[206:207], v[206:207], s[30:31], v[210:211] op_sel_hi:[1,0,1]
    v_cvt_pk_bf16_f32 v220, v204, v205
    v_cvt_pk_bf16_f32 v221, v206, v207
    ds_write_b64 v249, v[198:199] offset:64
    v_accvgpr_read_b32 v212, a16
    v_accvgpr_read_b32 v213, a17
    v_accvgpr_read_b32 v214, a18
    v_accvgpr_read_b32 v215, a19
    v_pk_add_f32 v[216:217], v[16:17], v[112:113]
    v_pk_add_f32 v[218:219], v[18:19], v[114:115]
    v_pk_add_f32 v[112:113], v[16:17], v[112:113] neg_lo:[0,1] neg_hi:[0,1]
    v_pk_add_f32 v[114:115], v[18:19], v[114:115] neg_lo:[0,1] neg_hi:[0,1]
    v_pk_fma_f32 v[16:17], v[216:217], s[30:31], v[212:213] op_sel:[0,1,0]
    v_pk_fma_f32 v[18:19], v[218:219], s[30:31], v[214:215] op_sel:[0,1,0]
    v_pk_fma_f32 v[212:213], v[212:213], s[30:31], v[216:217] op_sel_hi:[1,0,1]
    v_pk_fma_f32 v[214:215], v[214:215], s[30:31], v[218:219] op_sel_hi:[1,0,1]
    v_cvt_pk_bf16_f32 v222, v212, v213
    v_cvt_pk_bf16_f32 v223, v214, v215
    ds_write_b128 v248, v[220:223] offset:384
    v_accvgpr_read_b32 v204, a20
    v_accvgpr_read_b32 v205, a21
    v_accvgpr_read_b32 v206, a22
    v_accvgpr_read_b32 v207, a23
    v_pk_add_f32 v[208:209], v[20:21], v[116:117]
    v_pk_add_f32 v[210:211], v[22:23], v[118:119]
    v_pk_add_f32 v[116:117], v[20:21], v[116:117] neg_lo:[0,1] neg_hi:[0,1]
    v_pk_add_f32 v[118:119], v[22:23], v[118:119] neg_lo:[0,1] neg_hi:[0,1]
    v_pk_fma_f32 v[20:21], v[208:209], s[30:31], v[204:205] op_sel:[0,1,0]
    v_pk_fma_f32 v[22:23], v[210:211], s[30:31], v[206:207] op_sel:[0,1,0]
    v_pk_fma_f32 v[204:205], v[204:205], s[30:31], v[208:209] op_sel_hi:[1,0,1]
    v_pk_fma_f32 v[206:207], v[206:207], s[30:31], v[210:211] op_sel_hi:[1,0,1]
    v_cvt_pk_bf16_f32 v224, v204, v205
    v_cvt_pk_bf16_f32 v225, v206, v207
    v_accvgpr_read_b32 v204, a24
    v_accvgpr_read_b32 v205, a25
    v_accvgpr_read_b32 v206, a26
    v_accvgpr_read_b32 v207, a27
    v_pk_add_f32 v[208:209], v[24:25], v[120:121]
    v_pk_add_f32 v[210:211], v[26:27], v[122:123]
    v_pk_add_f32 v[120:121], v[24:25], v[120:121] neg_lo:[0,1] neg_hi:[0,1]
    v_pk_add_f32 v[122:123], v[26:27], v[122:123] neg_lo:[0,1] neg_hi:[0,1]
    v_pk_fma_f32 v[24:25], v[208:209], s[30:31], v[204:205] op_sel:[0,1,0]
    v_pk_fma_f32 v[26:27], v[210:211], s[30:31], v[206:207] op_sel:[0,1,0]
    v_pk_fma_f32 v[204:205], v[204:205], s[30:31], v[208:209] op_sel_hi:[1,0,1]
    v_pk_fma_f32 v[206:207], v[206:207], s[30:31], v[210:211] op_sel_hi:[1,0,1]
    v_cvt_pk_bf16_f32 v194, v204, v205
    v_cvt_pk_bf16_f32 v195, v206, v207
    ds_write_b64 v249, v[224:225] offset:448
    v_accvgpr_read_b32 v212, a28
    v_accvgpr_read_b32 v213, a29
    v_accvgpr_read_b32 v214, a30
    v_accvgpr_read_b32 v215, a31
    v_accvgpr_read_b32 v216, a124
    v_accvgpr_read_b32 v217, a125
    v_accvgpr_read_b32 v218, a126
    v_accvgpr_read_b32 v219, a127
    v_pk_add_f32 v[212:213], v[212:213], v[216:217]
    v_pk_add_f32 v[214:215], v[214:215], v[218:219]
    v_pk_add_f32 v[216:217], v[28:29], v[124:125]
    v_pk_add_f32 v[218:219], v[30:31], v[126:127]
    v_pk_add_f32 v[124:125], v[28:29], v[124:125] neg_lo:[0,1] neg_hi:[0,1]
    v_pk_add_f32 v[126:127], v[30:31], v[126:127] neg_lo:[0,1] neg_hi:[0,1]
    v_pk_fma_f32 v[28:29], v[216:217], s[30:31], v[212:213] op_sel:[0,1,0]
    v_pk_fma_f32 v[30:31], v[218:219], s[30:31], v[214:215] op_sel:[0,1,0]
    v_pk_fma_f32 v[212:213], v[212:213], s[30:31], v[216:217] op_sel_hi:[1,0,1]
    v_pk_fma_f32 v[214:215], v[214:215], s[30:31], v[218:219] op_sel_hi:[1,0,1]
    v_cvt_pk_bf16_f32 v196, v212, v213
    v_cvt_pk_bf16_f32 v197, v214, v215
    ds_write_b128 v248, v[194:197] offset:768
    v_accvgpr_read_b32 v204, a32
    v_accvgpr_read_b32 v205, a33
    v_accvgpr_read_b32 v206, a34
    v_accvgpr_read_b32 v207, a35
    v_accvgpr_read_b32 v208, a128
    v_accvgpr_read_b32 v209, a129
    v_accvgpr_read_b32 v210, a130
    v_accvgpr_read_b32 v211, a131
    v_pk_add_f32 v[204:205], v[204:205], v[208:209]
    v_pk_add_f32 v[206:207], v[206:207], v[210:211]
    v_pk_add_f32 v[208:209], v[32:33], v[128:129]
    v_pk_add_f32 v[210:211], v[34:35], v[130:131]
    v_pk_add_f32 v[128:129], v[32:33], v[128:129] neg_lo:[0,1] neg_hi:[0,1]
    v_pk_add_f32 v[130:131], v[34:35], v[130:131] neg_lo:[0,1] neg_hi:[0,1]
    v_pk_fma_f32 v[32:33], v[208:209], s[30:31], v[204:205] op_sel:[0,1,0]
    v_pk_fma_f32 v[34:35], v[210:211], s[30:31], v[206:207] op_sel:[0,1,0]
    v_pk_fma_f32 v[204:205], v[204:205], s[30:31], v[208:209] op_sel_hi:[1,0,1]
    v_pk_fma_f32 v[206:207], v[206:207], s[30:31], v[210:211] op_sel_hi:[1,0,1]
    v_cvt_pk_bf16_f32 v198, v204, v205
    v_cvt_pk_bf16_f32 v199, v206, v207
    v_accvgpr_read_b32 v204, a36
    v_accvgpr_read_b32 v205, a37
    v_accvgpr_read_b32 v206, a38
    v_accvgpr_read_b32 v207, a39
    v_accvgpr_read_b32 v208, a132
    v_accvgpr_read_b32 v209, a133
    v_accvgpr_read_b32 v210, a134
    v_accvgpr_read_b32 v211, a135
    v_pk_add_f32 v[204:205], v[204:205], v[208:209]
    v_pk_add_f32 v[206:207], v[206:207], v[210:211]
    v_pk_add_f32 v[208:209], v[36:37], v[132:133]
    v_pk_add_f32 v[210:211], v[38:39], v[134:135]
    v_pk_add_f32 v[132:133], v[36:37], v[132:133] neg_lo:[0,1] neg_hi:[0,1]
    v_pk_add_f32 v[134:135], v[38:39], v[134:135] neg_lo:[0,1] neg_hi:[0,1]
    v_pk_fma_f32 v[36:37], v[208:209], s[30:31], v[204:205] op_sel:[0,1,0]
    v_pk_fma_f32 v[38:39], v[210:211], s[30:31], v[206:207] op_sel:[0,1,0]
    v_pk_fma_f32 v[204:205], v[204:205], s[30:31], v[208:209] op_sel_hi:[1,0,1]
    v_pk_fma_f32 v[206:207], v[206:207], s[30:31], v[210:211] op_sel_hi:[1,0,1]
    v_cvt_pk_bf16_f32 v220, v204, v205
    v_cvt_pk_bf16_f32 v221, v206, v207
    ds_write_b64 v249, v[198:199] offset:832
    v_accvgpr_read_b32 v212, a40
    v_accvgpr_read_b32 v213, a41
    v_accvgpr_read_b32 v214, a42
    v_accvgpr_read_b32 v215, a43
    v_accvgpr_read_b32 v216, a136
    v_accvgpr_read_b32 v217, a137
    v_accvgpr_read_b32 v218, a138
    v_accvgpr_read_b32 v219, a139
    v_pk_add_f32 v[212:213], v[212:213], v[216:217]
    v_pk_add_f32 v[214:215], v[214:215], v[218:219]
    v_pk_add_f32 v[216:217], v[40:41], v[136:137]
    v_pk_add_f32 v[218:219], v[42:43], v[138:139]
    v_pk_add_f32 v[136:137], v[40:41], v[136:137] neg_lo:[0,1] neg_hi:[0,1]
    v_pk_add_f32 v[138:139], v[42:43], v[138:139] neg_lo:[0,1] neg_hi:[0,1]
    v_pk_fma_f32 v[40:41], v[216:217], s[30:31], v[212:213] op_sel:[0,1,0]
    v_pk_fma_f32 v[42:43], v[218:219], s[30:31], v[214:215] op_sel:[0,1,0]
    v_pk_fma_f32 v[212:213], v[212:213], s[30:31], v[216:217] op_sel_hi:[1,0,1]
    v_pk_fma_f32 v[214:215], v[214:215], s[30:31], v[218:219] op_sel_hi:[1,0,1]
    v_cvt_pk_bf16_f32 v222, v212, v213
    v_cvt_pk_bf16_f32 v223, v214, v215
    ds_write_b128 v248, v[220:223] offset:1152
    v_accvgpr_read_b32 v204, a44
    v_accvgpr_read_b32 v205, a45
    v_accvgpr_read_b32 v206, a46
    v_accvgpr_read_b32 v207, a47
    v_accvgpr_read_b32 v208, a140
    v_accvgpr_read_b32 v209, a141
    v_accvgpr_read_b32 v210, a142
    v_accvgpr_read_b32 v211, a143
    v_pk_add_f32 v[204:205], v[204:205], v[208:209]
    v_pk_add_f32 v[206:207], v[206:207], v[210:211]
    v_pk_add_f32 v[208:209], v[44:45], v[140:141]
    v_pk_add_f32 v[210:211], v[46:47], v[142:143]
    v_pk_add_f32 v[140:141], v[44:45], v[140:141] neg_lo:[0,1] neg_hi:[0,1]
    v_pk_add_f32 v[142:143], v[46:47], v[142:143] neg_lo:[0,1] neg_hi:[0,1]
    v_pk_fma_f32 v[44:45], v[208:209], s[30:31], v[204:205] op_sel:[0,1,0]
    v_pk_fma_f32 v[46:47], v[210:211], s[30:31], v[206:207] op_sel:[0,1,0]
    v_pk_fma_f32 v[204:205], v[204:205], s[30:31], v[208:209] op_sel_hi:[1,0,1]
    v_pk_fma_f32 v[206:207], v[206:207], s[30:31], v[210:211] op_sel_hi:[1,0,1]
    v_cvt_pk_bf16_f32 v224, v204, v205
    v_cvt_pk_bf16_f32 v225, v206, v207
    v_accvgpr_read_b32 v204, a48
    v_accvgpr_read_b32 v205, a49
    v_accvgpr_read_b32 v206, a50
    v_accvgpr_read_b32 v207, a51
    v_accvgpr_read_b32 v208, a144
    v_accvgpr_read_b32 v209, a145
    v_accvgpr_read_b32 v210, a146
    v_accvgpr_read_b32 v211, a147
    v_pk_add_f32 v[204:205], v[204:205], v[208:209]
    v_pk_add_f32 v[206:207], v[206:207], v[210:211]
    v_pk_add_f32 v[208:209], v[48:49], v[144:145]
    v_pk_add_f32 v[210:211], v[50:51], v[146:147]
    v_pk_add_f32 v[144:145], v[48:49], v[144:145] neg_lo:[0,1] neg_hi:[0,1]
    v_pk_add_f32 v[146:147], v[50:51], v[146:147] neg_lo:[0,1] neg_hi:[0,1]
    v_pk_fma_f32 v[48:49], v[208:209], s[30:31], v[204:205] op_sel:[0,1,0]
    v_pk_fma_f32 v[50:51], v[210:211], s[30:31], v[206:207] op_sel:[0,1,0]
    v_pk_fma_f32 v[204:205], v[204:205], s[30:31], v[208:209] op_sel_hi:[1,0,1]
    v_pk_fma_f32 v[206:207], v[206:207], s[30:31], v[210:211] op_sel_hi:[1,0,1]
    v_cvt_pk_bf16_f32 v194, v204, v205
    v_cvt_pk_bf16_f32 v195, v206, v207
    ds_write_b64 v249, v[224:225] offset:1216
    v_accvgpr_read_b32 v212, a52
    v_accvgpr_read_b32 v213, a53
    v_accvgpr_read_b32 v214, a54
    v_accvgpr_read_b32 v215, a55
    v_accvgpr_read_b32 v216, a148
    v_accvgpr_read_b32 v217, a149
    v_accvgpr_read_b32 v218, a150
    v_accvgpr_read_b32 v219, a151
    v_pk_add_f32 v[212:213], v[212:213], v[216:217]
    v_pk_add_f32 v[214:215], v[214:215], v[218:219]
    v_pk_add_f32 v[216:217], v[52:53], v[148:149]
    v_pk_add_f32 v[218:219], v[54:55], v[150:151]
    v_pk_add_f32 v[148:149], v[52:53], v[148:149] neg_lo:[0,1] neg_hi:[0,1]
    v_pk_add_f32 v[150:151], v[54:55], v[150:151] neg_lo:[0,1] neg_hi:[0,1]
    v_pk_fma_f32 v[52:53], v[216:217], s[30:31], v[212:213] op_sel:[0,1,0]
    v_pk_fma_f32 v[54:55], v[218:219], s[30:31], v[214:215] op_sel:[0,1,0]
    v_pk_fma_f32 v[212:213], v[212:213], s[30:31], v[216:217] op_sel_hi:[1,0,1]
    v_pk_fma_f32 v[214:215], v[214:215], s[30:31], v[218:219] op_sel_hi:[1,0,1]
    v_cvt_pk_bf16_f32 v196, v212, v213
    v_cvt_pk_bf16_f32 v197, v214, v215
    ds_write_b128 v248, v[194:197] offset:1536
    v_accvgpr_read_b32 v204, a56
    v_accvgpr_read_b32 v205, a57
    v_accvgpr_read_b32 v206, a58
    v_accvgpr_read_b32 v207, a59
    v_accvgpr_read_b32 v208, a152
    v_accvgpr_read_b32 v209, a153
    v_accvgpr_read_b32 v210, a154
    v_accvgpr_read_b32 v211, a155
    v_pk_add_f32 v[204:205], v[204:205], v[208:209]
    v_pk_add_f32 v[206:207], v[206:207], v[210:211]
    v_pk_add_f32 v[208:209], v[56:57], v[152:153]
    v_pk_add_f32 v[210:211], v[58:59], v[154:155]
    v_pk_add_f32 v[152:153], v[56:57], v[152:153] neg_lo:[0,1] neg_hi:[0,1]
    v_pk_add_f32 v[154:155], v[58:59], v[154:155] neg_lo:[0,1] neg_hi:[0,1]
    v_pk_fma_f32 v[56:57], v[208:209], s[30:31], v[204:205] op_sel:[0,1,0]
    v_pk_fma_f32 v[58:59], v[210:211], s[30:31], v[206:207] op_sel:[0,1,0]
    v_pk_fma_f32 v[204:205], v[204:205], s[30:31], v[208:209] op_sel_hi:[1,0,1]
    v_pk_fma_f32 v[206:207], v[206:207], s[30:31], v[210:211] op_sel_hi:[1,0,1]
    v_cvt_pk_bf16_f32 v198, v204, v205
    v_cvt_pk_bf16_f32 v199, v206, v207
    v_accvgpr_read_b32 v204, a60
    v_accvgpr_read_b32 v205, a61
    v_accvgpr_read_b32 v206, a62
    v_accvgpr_read_b32 v207, a63
    v_accvgpr_read_b32 v208, a156
    v_accvgpr_read_b32 v209, a157
    v_accvgpr_read_b32 v210, a158
    v_accvgpr_read_b32 v211, a159
    v_pk_add_f32 v[204:205], v[204:205], v[208:209]
    v_pk_add_f32 v[206:207], v[206:207], v[210:211]
    v_pk_add_f32 v[208:209], v[60:61], v[156:157]
    v_pk_add_f32 v[210:211], v[62:63], v[158:159]
    v_pk_add_f32 v[156:157], v[60:61], v[156:157] neg_lo:[0,1] neg_hi:[0,1]
    v_pk_add_f32 v[158:159], v[62:63], v[158:159] neg_lo:[0,1] neg_hi:[0,1]
    v_pk_fma_f32 v[60:61], v[208:209], s[30:31], v[204:205] op_sel:[0,1,0]
    v_pk_fma_f32 v[62:63], v[210:211], s[30:31], v[206:207] op_sel:[0,1,0]
    v_pk_fma_f32 v[204:205], v[204:205], s[30:31], v[208:209] op_sel_hi:[1,0,1]
    v_pk_fma_f32 v[206:207], v[206:207], s[30:31], v[210:211] op_sel_hi:[1,0,1]
    v_cvt_pk_bf16_f32 v220, v204, v205
    v_cvt_pk_bf16_f32 v221, v206, v207
    ds_write_b64 v249, v[198:199] offset:1600
    v_accvgpr_read_b32 v212, a64
    v_accvgpr_read_b32 v213, a65
    v_accvgpr_read_b32 v214, a66
    v_accvgpr_read_b32 v215, a67
    v_accvgpr_read_b32 v216, a160
    v_accvgpr_read_b32 v217, a161
    v_accvgpr_read_b32 v218, a162
    v_accvgpr_read_b32 v219, a163
    v_pk_add_f32 v[212:213], v[212:213], v[216:217]
    v_pk_add_f32 v[214:215], v[214:215], v[218:219]
    v_pk_add_f32 v[216:217], v[64:65], v[160:161]
    v_pk_add_f32 v[218:219], v[66:67], v[162:163]
    v_pk_add_f32 v[160:161], v[64:65], v[160:161] neg_lo:[0,1] neg_hi:[0,1]
    v_pk_add_f32 v[162:163], v[66:67], v[162:163] neg_lo:[0,1] neg_hi:[0,1]
    v_pk_fma_f32 v[64:65], v[216:217], s[30:31], v[212:213] op_sel:[0,1,0]
    v_pk_fma_f32 v[66:67], v[218:219], s[30:31], v[214:215] op_sel:[0,1,0]
    v_pk_fma_f32 v[212:213], v[212:213], s[30:31], v[216:217] op_sel_hi:[1,0,1]
    v_pk_fma_f32 v[214:215], v[214:215], s[30:31], v[218:219] op_sel_hi:[1,0,1]
    v_cvt_pk_bf16_f32 v222, v212, v213
    v_cvt_pk_bf16_f32 v223, v214, v215
    ds_write_b128 v248, v[220:223] offset:1920
    v_accvgpr_read_b32 v204, a68
    v_accvgpr_read_b32 v205, a69
    v_accvgpr_read_b32 v206, a70
    v_accvgpr_read_b32 v207, a71
    v_accvgpr_read_b32 v208, a164
    v_accvgpr_read_b32 v209, a165
    v_accvgpr_read_b32 v210, a166
    v_accvgpr_read_b32 v211, a167
    v_pk_add_f32 v[204:205], v[204:205], v[208:209]
    v_pk_add_f32 v[206:207], v[206:207], v[210:211]
    v_pk_add_f32 v[208:209], v[68:69], v[164:165]
    v_pk_add_f32 v[210:211], v[70:71], v[166:167]
    v_pk_add_f32 v[164:165], v[68:69], v[164:165] neg_lo:[0,1] neg_hi:[0,1]
    v_pk_add_f32 v[166:167], v[70:71], v[166:167] neg_lo:[0,1] neg_hi:[0,1]
    v_pk_fma_f32 v[68:69], v[208:209], s[30:31], v[204:205] op_sel:[0,1,0]
    v_pk_fma_f32 v[70:71], v[210:211], s[30:31], v[206:207] op_sel:[0,1,0]
    v_pk_fma_f32 v[204:205], v[204:205], s[30:31], v[208:209] op_sel_hi:[1,0,1]
    v_pk_fma_f32 v[206:207], v[206:207], s[30:31], v[210:211] op_sel_hi:[1,0,1]
    v_cvt_pk_bf16_f32 v224, v204, v205
    v_cvt_pk_bf16_f32 v225, v206, v207
    v_accvgpr_read_b32 v204, a72
    v_accvgpr_read_b32 v205, a73
    v_accvgpr_read_b32 v206, a74
    v_accvgpr_read_b32 v207, a75
    v_accvgpr_read_b32 v208, a168
    v_accvgpr_read_b32 v209, a169
    v_accvgpr_read_b32 v210, a170
    v_accvgpr_read_b32 v211, a171
    v_pk_add_f32 v[204:205], v[204:205], v[208:209]
    v_pk_add_f32 v[206:207], v[206:207], v[210:211]
    v_pk_add_f32 v[208:209], v[72:73], v[168:169]
    v_pk_add_f32 v[210:211], v[74:75], v[170:171]
    v_pk_add_f32 v[168:169], v[72:73], v[168:169] neg_lo:[0,1] neg_hi:[0,1]
    v_pk_add_f32 v[170:171], v[74:75], v[170:171] neg_lo:[0,1] neg_hi:[0,1]
    v_pk_fma_f32 v[72:73], v[208:209], s[30:31], v[204:205] op_sel:[0,1,0]
    v_pk_fma_f32 v[74:75], v[210:211], s[30:31], v[206:207] op_sel:[0,1,0]
    v_pk_fma_f32 v[204:205], v[204:205], s[30:31], v[208:209] op_sel_hi:[1,0,1]
    v_pk_fma_f32 v[206:207], v[206:207], s[30:31], v[210:211] op_sel_hi:[1,0,1]
    v_cvt_pk_bf16_f32 v194, v204, v205
    v_cvt_pk_bf16_f32 v195, v206, v207
    ds_write_b64 v249, v[224:225] offset:1984
    v_accvgpr_read_b32 v212, a76
    v_accvgpr_read_b32 v213, a77
    v_accvgpr_read_b32 v214, a78
    v_accvgpr_read_b32 v215, a79
    v_accvgpr_read_b32 v216, a172
    v_accvgpr_read_b32 v217, a173
    v_accvgpr_read_b32 v218, a174
    v_accvgpr_read_b32 v219, a175
    v_pk_add_f32 v[212:213], v[212:213], v[216:217]
    v_pk_add_f32 v[214:215], v[214:215], v[218:219]
    v_pk_add_f32 v[216:217], v[76:77], v[172:173]
    v_pk_add_f32 v[218:219], v[78:79], v[174:175]
    v_pk_add_f32 v[172:173], v[76:77], v[172:173] neg_lo:[0,1] neg_hi:[0,1]
    v_pk_add_f32 v[174:175], v[78:79], v[174:175] neg_lo:[0,1] neg_hi:[0,1]
    v_pk_fma_f32 v[76:77], v[216:217], s[30:31], v[212:213] op_sel:[0,1,0]
    v_pk_fma_f32 v[78:79], v[218:219], s[30:31], v[214:215] op_sel:[0,1,0]
    v_pk_fma_f32 v[212:213], v[212:213], s[30:31], v[216:217] op_sel_hi:[1,0,1]
    v_pk_fma_f32 v[214:215], v[214:215], s[30:31], v[218:219] op_sel_hi:[1,0,1]
    v_cvt_pk_bf16_f32 v196, v212, v213
    v_cvt_pk_bf16_f32 v197, v214, v215
    ds_write_b128 v248, v[194:197] offset:2304
    v_accvgpr_read_b32 v204, a80
    v_accvgpr_read_b32 v205, a81
    v_accvgpr_read_b32 v206, a82
    v_accvgpr_read_b32 v207, a83
    v_accvgpr_read_b32 v208, a176
    v_accvgpr_read_b32 v209, a177
    v_accvgpr_read_b32 v210, a178
    v_accvgpr_read_b32 v211, a179
    v_pk_add_f32 v[204:205], v[204:205], v[208:209]
    v_pk_add_f32 v[206:207], v[206:207], v[210:211]
    v_pk_add_f32 v[208:209], v[80:81], v[176:177]
    v_pk_add_f32 v[210:211], v[82:83], v[178:179]
    v_pk_add_f32 v[176:177], v[80:81], v[176:177] neg_lo:[0,1] neg_hi:[0,1]
    v_pk_add_f32 v[178:179], v[82:83], v[178:179] neg_lo:[0,1] neg_hi:[0,1]
    v_pk_fma_f32 v[80:81], v[208:209], s[30:31], v[204:205] op_sel:[0,1,0]
    v_pk_fma_f32 v[82:83], v[210:211], s[30:31], v[206:207] op_sel:[0,1,0]
    v_pk_fma_f32 v[204:205], v[204:205], s[30:31], v[208:209] op_sel_hi:[1,0,1]
    v_pk_fma_f32 v[206:207], v[206:207], s[30:31], v[210:211] op_sel_hi:[1,0,1]
    v_cvt_pk_bf16_f32 v198, v204, v205
    v_cvt_pk_bf16_f32 v199, v206, v207
    ds_write_b64 v249, v[198:199] offset:2368
    s_waitcnt lgkmcnt(0)
    s_barrier
sub24:
    v_mfma_f32_16x16x32_bf16 v[0:3], a[192:195], v[228:231], v[0:3]
    buffer_load_dwordx4 a[236:239], v254, s[8:11], s42 offen offset:2048 sc1
    v_mfma_f32_16x16x32_bf16 v[4:7], a[196:199], v[228:231], v[4:7]
    s_mov_b32 s42, 961536
    v_accvgpr_read_b32 v204, a84
    v_accvgpr_read_b32 v205, a85
    v_mfma_f32_16x16x32_bf16 v[8:11], a[200:203], v[228:231], v[8:11]
    ds_read_b128 v[228:231], v253 offset:14816
    s_waitcnt vmcnt(7)
    v_mfma_f32_16x16x32_bf16 v[8:11], a[212:215], v[232:235], v[8:11]
    ds_read_b128 v[212:215], v250 offset:0
    v_accvgpr_read_b32 v206, a86
    v_mfma_f32_16x16x32_bf16 v[4:7], a[208:211], v[232:235], v[4:7]
    buffer_load_dwordx4 a[240:243], v254, s[8:11], s42 offen offset:0 sc1
    v_mfma_f32_16x16x32_bf16 v[0:3], a[204:207], v[232:235], v[0:3]
    s_waitcnt vmcnt(5)
    v_accvgpr_read_b32 v207, a87
    v_add_f32 v208, v84, v180
    v_mfma_f32_16x16x32_bf16 v[0:3], a[216:219], v[236:239], v[0:3]
    ds_read_b128 v[216:219], v250 offset:3104
    v_add_f32 v209, v85, v181
    v_mfma_f32_16x16x32_bf16 v[4:7], a[220:223], v[236:239], v[4:7]
    ds_read_b128 v[220:223], v250 offset:6208
    s_add_u32 s44, s40, 393216
    v_mfma_f32_16x16x32_bf16 v[8:11], a[224:227], v[236:239], v[8:11]
    buffer_load_dwordx4 a[244:247], v254, s[8:11], s42 offen offset:1024 sc1
    v_mfma_f32_16x16x32_bf16 v[12:15], a[192:195], v[232:235], v[12:15]
    ds_read_b128 v[224:227], v250 offset:9312
    v_add_f32 v210, v86, v182
    v_mfma_f32_16x16x32_bf16 v[12:15], a[204:207], v[236:239], v[12:15]
    s_waitcnt lgkmcnt(4)
    v_add_f32 v211, v87, v183
    v_sub_f32 v180, v84, v180
    v_mfma_f32_16x16x32_bf16 v[12:15], a[216:219], v[228:231], v[12:15]
pad9:
    s_cbranch_vccnz pad13
    s_waitcnt lgkmcnt(3)
    v_sub_f32 v181, v85, v181
    v_sub_f32 v182, v86, v182
    v_mfma_f32_16x16x32_bf16 v[16:19], a[220:223], v[228:231], v[16:19]
    buffer_load_dwordx4 a[248:251], v254, s[8:11], s42 offen offset:2048 sc1
    v_mfma_f32_16x16x32_bf16 v[16:19], a[208:211], v[236:239], v[16:19]
    s_mov_b32 s42, 964608
    v_sub_f32 v183, v87, v183
    v_fma_f32 v84, v208, s31, v204
    v_mfma_f32_16x16x32_bf16 v[16:19], a[196:199], v[232:235], v[16:19]
    v_fma_f32 v85, v209, s31, v205
    v_fma_f32 v86, v210, s31, v206
    v_mfma_f32_16x16x32_bf16 v[20:23], a[200:203], v[232:235], v[20:23]
    ds_read_b128 v[232:235], v253 offset:14560
    v_fma_f32 v87, v211, s31, v207
    v_mfma_f32_16x16x32_bf16 v[20:23], a[212:215], v[236:239], v[20:23]
    buffer_load_dwordx4 a[252:255], v254, s[8:11], s42 offen offset:0 sc1
    v_mfma_f32_16x16x32_bf16 v[20:23], a[224:227], v[228:231], v[20:23]
    v_fmac_f32 v208, s30, v204
    v_fmac_f32 v209, s30, v205
    v_mfma_f32_16x16x32_bf16 v[24:27], a[192:195], v[236:239], v[24:27]
    v_fmac_f32 v210, s30, v206
    v_fmac_f32 v211, s30, v207
    v_mfma_f32_16x16x32_bf16 v[24:27], a[204:207], v[228:231], v[24:27]
    s_waitcnt lgkmcnt(0)
    v_cvt_pk_bf16_f32 v192, v208, v209
    v_cvt_pk_bf16_f32 v193, v210, v211
    v_mfma_f32_16x16x32_bf16 v[24:27], a[216:219], v[232:235], v[24:27]
    v_accvgpr_read_b32 v204, a88
    v_accvgpr_read_b32 v205, a89
    v_mfma_f32_16x16x32_bf16 v[28:31], a[220:223], v[232:235], v[28:31]
    buffer_load_dwordx4 v[240:243], v254, s[8:11], s42 offen offset:1024 sc1
    v_mfma_f32_16x16x32_bf16 v[28:31], a[208:211], v[228:231], v[28:31]
    v_accvgpr_read_b32 v206, a90
    v_accvgpr_read_b32 v207, a91
    v_mfma_f32_16x16x32_bf16 v[28:31], a[196:199], v[236:239], v[28:31]
    v_add_f32 v208, v88, v184
    v_add_f32 v209, v89, v185
    v_mfma_f32_16x16x32_bf16 v[32:35], a[200:203], v[236:239], v[32:35]
    ds_read_b128 v[236:239], v253 offset:16384
    v_add_f32 v210, v90, v186
    v_mfma_f32_16x16x32_bf16 v[32:35], a[212:215], v[228:231], v[32:35]
    buffer_load_dwordx4 v[244:247], v254, s[8:11], s42 offen offset:2048 sc1
    v_mfma_f32_16x16x32_bf16 v[32:35], a[224:227], v[232:235], v[32:35]
    v_add_f32 v211, v91, v187
    v_sub_f32 v184, v88, v184
    v_mfma_f32_16x16x32_bf16 v[36:39], a[192:195], v[228:231], v[36:39]
    v_sub_f32 v185, v89, v185
    v_sub_f32 v186, v90, v186
    v_mfma_f32_16x16x32_bf16 v[36:39], a[204:207], v[232:235], v[36:39]
    s_waitcnt lgkmcnt(0)
    v_sub_f32 v187, v91, v187
    v_fma_f32 v88, v208, s31, v204
    v_mfma_f32_16x16x32_bf16 v[36:39], a[216:219], v[236:239], v[36:39]
    buffer_store_dwordx4 v[212:215], v254, s[12:15], s44 offen nt
    s_add_u32 s44, s40, 396288
    v_mfma_f32_16x16x32_bf16 v[40:43], a[220:223], v[236:239], v[40:43]
    v_fma_f32 v89, v209, s31, v205
    v_fma_f32 v90, v210, s31, v206
    v_mfma_f32_16x16x32_bf16 v[40:43], a[208:211], v[232:235], v[40:43]
    v_fma_f32 v91, v211, s31, v207
    v_fmac_f32 v208, s30, v204
    v_mfma_f32_16x16x32_bf16 v[40:43], a[196:199], v[228:231], v[40:43]
    buffer_store_dwordx4 v[216:219], v254, s[12:15], s44 offen nt
    v_fmac_f32 v209, s30, v205
    v_fmac_f32 v210, s30, v206
    v_mfma_f32_16x16x32_bf16 v[44:47], a[200:203], v[228:231], v[44:47]
    ds_read_b128 v[228:231], v253 offset:16128
    v_fmac_f32 v211, s30, v207
    v_mfma_f32_16x16x32_bf16 v[44:47], a[212:215], v[232:235], v[44:47]
    ds_read_b128 v[212:215], v250 offset:1024
    v_cvt_pk_bf16_f32 v194, v208, v209
    v_mfma_f32_16x16x32_bf16 v[44:47], a[224:227], v[236:239], v[44:47]
    s_add_u32 s44, s40, 399360
    v_cvt_pk_bf16_f32 v195, v210, v211
    v_accvgpr_read_b32 v204, a92
    v_mfma_f32_16x16x32_bf16 v[48:51], a[192:195], v[232:235], v[48:51]
    ds_read_b128 v[216:219], v250 offset:4128
    v_accvgpr_read_b32 v205, a93
    v_mfma_f32_16x16x32_bf16 v[48:51], a[204:207], v[236:239], v[48:51]
    s_waitcnt lgkmcnt(2)
    v_accvgpr_read_b32 v206, a94
    v_accvgpr_read_b32 v207, a95
    v_mfma_f32_16x16x32_bf16 v[48:51], a[216:219], v[228:231], v[48:51]
    v_add_f32 v208, v92, v188
    v_add_f32 v209, v93, v189
    v_mfma_f32_16x16x32_bf16 v[52:55], a[220:223], v[228:231], v[52:55]
    v_add_f32 v210, v94, v190
    v_add_f32 v211, v95, v191
    v_mfma_f32_16x16x32_bf16 v[52:55], a[208:211], v[236:239], v[52:55]
    v_sub_f32 v188, v92, v188
    v_sub_f32 v189, v93, v189
    v_mfma_f32_16x16x32_bf16 v[52:55], a[196:199], v[232:235], v[52:55]
    v_sub_f32 v190, v94, v190
    v_sub_f32 v191, v95, v191
    v_mfma_f32_16x16x32_bf16 v[56:59], a[200:203], v[232:235], v[56:59]
    ds_read_b128 v[232:235], v253 offset:15872
    v_fma_f32 v92, v208, s31, v204
    v_mfma_f32_16x16x32_bf16 v[56:59], a[212:215], v[236:239], v[56:59]
    v_fma_f32 v93, v209, s31, v205
    v_fma_f32 v94, v210, s31, v206
    v_mfma_f32_16x16x32_bf16 v[56:59], a[224:227], v[228:231], v[56:59]
    buffer_store_dwordx4 v[220:223], v254, s[12:15], s44 offen nt
    v_fma_f32 v95, v211, s31, v207
    v_fmac_f32 v208, s30, v204
    v_mfma_f32_16x16x32_bf16 v[60:63], a[192:195], v[236:239], v[60:63]
    v_fmac_f32 v209, s30, v205
    v_fmac_f32 v210, s30, v206
    v_mfma_f32_16x16x32_bf16 v[60:63], a[204:207], v[228:231], v[60:63]
    s_waitcnt lgkmcnt(0)
    v_fmac_f32 v211, s30, v207
    v_cvt_pk_bf16_f32 v196, v208, v209
    v_mfma_f32_16x16x32_bf16 v[60:63], a[216:219], v[232:235], v[60:63]
    v_cvt_pk_bf16_f32 v197, v210, v211
    v_accvgpr_read_b32 v204, a96
    v_mfma_f32_16x16x32_bf16 v[64:67], a[220:223], v[232:235], v[64:67]
    ds_write_b64 v249, v[196:197] offset:2752
    v_mfma_f32_16x16x32_bf16 v[64:67], a[208:211], v[228:231], v[64:67]
    s_add_u32 s44, s40, 402432
    v_accvgpr_read_b32 v205, a97
    v_accvgpr_read_b32 v206, a98
    v_mfma_f32_16x16x32_bf16 v[64:67], a[196:199], v[236:239], v[64:67]
    ds_write_b128 v248, v[192:195] offset:2688
    v_mfma_f32_16x16x32_bf16 v[68:71], a[200:203], v[236:239], v[68:71]
    ds_read_b128 v[236:239], v253 offset:15616
    v_accvgpr_read_b32 v207, a99
    v_fma_f32 v208, v204, s34, v96 div:2
    v_mfma_f32_16x16x32_bf16 v[68:71], a[212:215], v[228:231], v[68:71]
    v_fma_f32 v209, v205, s34, v97 div:2
    v_fma_f32 v210, v206, s34, v98 div:2
    v_mfma_f32_16x16x32_bf16 v[68:71], a[224:227], v[232:235], v[68:71]
    v_fma_f32 v211, v207, s34, v99 div:2
    v_fma_f32 v96, v204, s35, v96 mul:2
    v_mfma_f32_16x16x32_bf16 v[72:75], a[192:195], v[228:231], v[72:75]
    v_fma_f32 v97, v205, s35, v97 mul:2
    v_fma_f32 v98, v206, s35, v98 mul:2
    v_mfma_f32_16x16x32_bf16 v[72:75], a[204:207], v[232:235], v[72:75]
    s_waitcnt lgkmcnt(0)
    v_fma_f32 v99, v207, s35, v99 mul:2
    v_cvt_pk_bf16_f32 v198, v208, v209
    v_mfma_f32_16x16x32_bf16 v[72:75], a[216:219], v[236:239], v[72:75]
    v_cvt_pk_bf16_f32 v199, v210, v211
    v_accvgpr_write_b32 a0, v198
    v_mfma_f32_16x16x32_bf16 v[76:79], a[220:223], v[236:239], v[76:79]
    v_accvgpr_write_b32 a1, v199
    v_accvgpr_read_b32 v204, a100
    v_mfma_f32_16x16x32_bf16 v[76:79], a[208:211], v[232:235], v[76:79]
    buffer_store_dwordx4 v[224:227], v254, s[12:15], s44 offen nt
    v_accvgpr_read_b32 v205, a101
    v_accvgpr_read_b32 v206, a102
    v_mfma_f32_16x16x32_bf16 v[76:79], a[196:199], v[228:231], v[76:79]
    v_accvgpr_read_b32 v207, a103
    v_fma_f32 v208, v204, s34, v100 div:2
    v_mfma_f32_16x16x32_bf16 v[80:83], a[200:203], v[228:231], v[80:83]
    ds_read_b128 v[228:231], v253 offset:15344
    v_fma_f32 v209, v205, s34, v101 div:2
    v_mfma_f32_16x16x32_bf16 v[80:83], a[212:215], v[232:235], v[80:83]
    v_fma_f32 v210, v206, s34, v102 div:2
    v_fma_f32 v211, v207, s34, v103 div:2
    v_fma_f32 v100, v204, s35, v100 mul:2
    v_mfma_f32_16x16x32_bf16 v[80:83], a[224:227], v[236:239], v[80:83]
    s_mov_b32 s42, 995328
    v_fma_f32 v101, v205, s35, v101 mul:2
    v_fma_f32 v102, v206, s35, v102 mul:2
    v_mfma_f32_16x16x32_bf16 v[84:87], a[192:195], v[232:235], v[84:87]
    s_waitcnt lgkmcnt(0)
    v_fma_f32 v103, v207, s35, v103 mul:2
    v_cvt_pk_bf16_f32 v200, v208, v209
    v_mfma_f32_16x16x32_bf16 v[88:91], a[196:199], v[232:235], v[88:91]
    s_barrier
    v_mfma_f32_16x16x32_bf16 v[92:95], a[200:203], v[232:235], v[92:95]
    ds_read_b128 v[232:235], v253 offset:17680
    v_cvt_pk_bf16_f32 v201, v210, v211
    v_mfma_f32_16x16x32_bf16 v[92:95], a[212:215], v[236:239], v[92:95]
    buffer_load_dwordx4 a[192:195], v254, s[8:11], s42 offen offset:0 sc1
    v_mfma_f32_16x16x32_bf16 v[88:91], a[208:211], v[236:239], v[88:91]
    v_accvgpr_write_b32 a2, v200
    v_accvgpr_write_b32 a3, v201
    v_mfma_f32_16x16x32_bf16 v[84:87], a[204:207], v[236:239], v[84:87]
    ds_read_b128 v[236:239], v253 offset:17408
    v_accvgpr_read_b32 v204, a104
    v_mfma_f32_16x16x32_bf16 v[84:87], a[216:219], v[228:231], v[84:87]
    buffer_load_dwordx4 a[196:199], v254, s[8:11], s42 offen offset:1024 sc1
    v_mfma_f32_16x16x32_bf16 v[88:91], a[220:223], v[228:231], v[88:91]
    s_waitcnt vmcnt(12) lgkmcnt(1)
    v_accvgpr_read_b32 v205, a105
    v_accvgpr_read_b32 v206, a106
    v_mfma_f32_16x16x32_bf16 v[92:95], a[224:227], v[228:231], v[92:95]
    ds_read_b128 v[228:231], v253 offset:17152
    v_accvgpr_read_b32 v207, a107
    v_fma_f32 v208, v204, s34, v104 div:2
sub25:
    v_mfma_f32_16x16x32_bf16 v[0:3], a[228:231], v[232:235], v[0:3]
    buffer_load_dwordx4 a[200:203], v254, s[8:11], s42 offen offset:2048 sc1
    v_mfma_f32_16x16x32_bf16 v[4:7], a[232:235], v[232:235], v[4:7]
    s_mov_b32 s42, 998400
    v_fma_f32 v209, v205, s34, v105 div:2
    v_fma_f32 v210, v206, s34, v106 div:2
    v_mfma_f32_16x16x32_bf16 v[8:11], a[236:239], v[232:235], v[8:11]
    ds_read_b128 v[232:235], v253 offset:16896
    s_waitcnt vmcnt(10)
    s_waitcnt lgkmcnt(2)
    v_mfma_f32_16x16x32_bf16 v[8:11], a[248:251], v[236:239], v[8:11]
    v_fma_f32 v211, v207, s34, v107 div:2
    v_fma_f32 v104, v204, s35, v104 mul:2
    v_mfma_f32_16x16x32_bf16 v[4:7], a[244:247], v[236:239], v[4:7]
    buffer_load_dwordx4 a[204:207], v254, s[8:11], s42 offen offset:0 sc1
    v_mfma_f32_16x16x32_bf16 v[0:3], a[240:243], v[236:239], v[0:3]
    s_waitcnt vmcnt(8) lgkmcnt(1)
    v_fma_f32 v105, v205, s35, v105 mul:2
    v_fma_f32 v106, v206, s35, v106 mul:2
    v_mfma_f32_16x16x32_bf16 v[0:3], a[252:255], v[228:231], v[0:3]
    s_add_u32 s44, s40, 394240
    v_fma_f32 v107, v207, s35, v107 mul:2
    v_cvt_pk_bf16_f32 v202, v208, v209
    v_mfma_f32_16x16x32_bf16 v[4:7], v[240:243], v[228:231], v[4:7]
    v_cvt_pk_bf16_f32 v203, v210, v211
    v_accvgpr_write_b32 a4, v202
    v_mfma_f32_16x16x32_bf16 v[8:11], v[244:247], v[228:231], v[8:11]
    buffer_load_dwordx4 a[208:211], v254, s[8:11], s42 offen offset:1024 sc1
    v_mfma_f32_16x16x32_bf16 v[12:15], a[228:231], v[236:239], v[12:15]
    v_accvgpr_write_b32 a5, v203
    v_accvgpr_read_b32 v204, a108
    v_accvgpr_read_b32 v205, a109
    v_mfma_f32_16x16x32_bf16 v[12:15], a[240:243], v[228:231], v[12:15]
    s_waitcnt lgkmcnt(0)
    v_accvgpr_read_b32 v206, a110
    v_accvgpr_read_b32 v207, a111
    v_mfma_f32_16x16x32_bf16 v[12:15], a[252:255], v[232:235], v[12:15]
    v_fma_f32 v208, v204, s34, v108 div:2
    v_fma_f32 v209, v205, s34, v109 div:2
    v_mfma_f32_16x16x32_bf16 v[16:19], v[240:243], v[232:235], v[16:19]
    buffer_load_dwordx4 a[212:215], v254, s[8:11], s42 offen offset:2048 sc1
    v_mfma_f32_16x16x32_bf16 v[16:19], a[244:247], v[228:231], v[16:19]
    s_mov_b32 s42, 1001472
    v_fma_f32 v210, v206, s34, v110 div:2
    v_fma_f32 v211, v207, s34, v111 div:2
    v_mfma_f32_16x16x32_bf16 v[16:19], a[232:235], v[236:239], v[16:19]
    v_fma_f32 v108, v204, s35, v108 mul:2
    v_fma_f32 v109, v205, s35, v109 mul:2
    v_mfma_f32_16x16x32_bf16 v[20:23], a[236:239], v[236:239], v[20:23]
    ds_read_b128 v[236:239], v253 offset:16640
    v_fma_f32 v110, v206, s35, v110 mul:2
    v_mfma_f32_16x16x32_bf16 v[20:23], a[248:251], v[228:231], v[20:23]
    buffer_load_dwordx4 a[216:219], v254, s[8:11], s42 offen offset:0 sc1
    v_mfma_f32_16x16x32_bf16 v[20:23], v[244:247], v[232:235], v[20:23]
    v_fma_f32 v111, v207, s35, v111 mul:2
    v_cvt_pk_bf16_f32 v192, v208, v209
    v_mfma_f32_16x16x32_bf16 v[24:27], a[228:231], v[228:231], v[24:27]
    v_cvt_pk_bf16_f32 v193, v210, v211
    v_accvgpr_write_b32 a12, v192
    v_mfma_f32_16x16x32_bf16 v[24:27], a[240:243], v[232:235], v[24:27]
    s_waitcnt lgkmcnt(0)
    v_accvgpr_write_b32 a13, v193
    v_accvgpr_read_b32 v204, a112
    v_accvgpr_read_b32 v205, a113
    v_mfma_f32_16x16x32_bf16 v[24:27], a[252:255], v[236:239], v[24:27]
    ds_read_b128 a[84:87], v250 offset:7232
    v_accvgpr_read_b32 v206, a114
    v_mfma_f32_16x16x32_bf16 v[28:31], v[240:243], v[236:239], v[28:31]
    buffer_load_dwordx4 a[220:223], v254, s[8:11], s42 offen offset:1024 sc1
    v_mfma_f32_16x16x32_bf16 v[28:31], a[244:247], v[232:235], v[28:31]
    v_accvgpr_read_b32 v207, a115
    v_fma_f32 v208, v204, s34, v112 div:2
    v_mfma_f32_16x16x32_bf16 v[28:31], a[232:235], v[228:231], v[28:31]
    v_fma_f32 v209, v205, s34, v113 div:2
    v_fma_f32 v210, v206, s34, v114 div:2
    v_mfma_f32_16x16x32_bf16 v[32:35], a[236:239], v[228:231], v[32:35]
    ds_read_b128 v[228:231], v253 offset:18464
    v_fma_f32 v211, v207, s34, v115 div:2
    v_mfma_f32_16x16x32_bf16 v[32:35], a[248:251], v[232:235], v[32:35]
    buffer_load_dwordx4 a[224:227], v254, s[8:11], s42 offen offset:2048 sc1
    v_mfma_f32_16x16x32_bf16 v[32:35], v[244:247], v[236:239], v[32:35]
    ds_read_b128 a[88:91], v250 offset:10336
    v_fma_f32 v112, v204, s35, v112 mul:2
    v_mfma_f32_16x16x32_bf16 v[36:39], a[228:231], v[232:235], v[36:39]
    v_fma_f32 v113, v205, s35, v113 mul:2
    v_fma_f32 v114, v206, s35, v114 mul:2
    v_mfma_f32_16x16x32_bf16 v[36:39], a[240:243], v[236:239], v[36:39]
    s_waitcnt lgkmcnt(1)
    v_fma_f32 v115, v207, s35, v115 mul:2
    v_cvt_pk_bf16_f32 v194, v208, v209
    v_mfma_f32_16x16x32_bf16 v[36:39], a[252:255], v[228:231], v[36:39]
    buffer_store_dwordx4 v[212:215], v254, s[12:15], s44 offen nt
    s_add_u32 s44, s40, 397312
    v_cvt_pk_bf16_f32 v195, v210, v211
    v_mfma_f32_16x16x32_bf16 v[40:43], v[240:243], v[228:231], v[40:43]
    v_accvgpr_write_b32 a14, v194
    v_accvgpr_write_b32 a15, v195
    v_mfma_f32_16x16x32_bf16 v[40:43], a[244:247], v[236:239], v[40:43]
    v_accvgpr_read_b32 v204, a116
    v_accvgpr_read_b32 v205, a117
    v_mfma_f32_16x16x32_bf16 v[40:43], a[232:235], v[232:235], v[40:43]
    buffer_store_dwordx4 v[216:219], v254, s[12:15], s44 offen nt
    v_accvgpr_read_b32 v206, a118
    v_accvgpr_read_b32 v207, a119
    v_mfma_f32_16x16x32_bf16 v[44:47], a[236:239], v[232:235], v[44:47]
    ds_read_b128 v[232:235], v253 offset:18208
    v_fma_f32 v208, v204, s34, v116 div:2
    v_mfma_f32_16x16x32_bf16 v[44:47], a[248:251], v[236:239], v[44:47]
    ds_read_b128 a[92:95], v250 offset:2048
    v_fma_f32 v209, v205, s34, v117 div:2
    v_mfma_f32_16x16x32_bf16 v[44:47], v[244:247], v[228:231], v[44:47]
    v_fma_f32 v210, v206, s34, v118 div:2
    v_fma_f32 v211, v207, s34, v119 div:2
    v_mfma_f32_16x16x32_bf16 v[48:51], a[228:231], v[236:239], v[48:51]
    v_fma_f32 v116, v204, s35, v116 mul:2
    v_fma_f32 v117, v205, s35, v117 mul:2
    v_mfma_f32_16x16x32_bf16 v[48:51], a[240:243], v[228:231], v[48:51]
    s_waitcnt lgkmcnt(1)
    s_add_u32 s44, s40, 400384
    v_fma_f32 v118, v206, s35, v118 mul:2
    v_mfma_f32_16x16x32_bf16 v[48:51], a[252:255], v[232:235], v[48:51]
    v_fma_f32 v119, v207, s35, v119 mul:2
    v_cvt_pk_bf16_f32 v196, v208, v209
    v_mfma_f32_16x16x32_bf16 v[52:55], v[240:243], v[232:235], v[52:55]
    ds_read_b128 a[96:99], v250 offset:5152
    v_cvt_pk_bf16_f32 v197, v210, v211
    v_accvgpr_write_b32 a16, v196
    v_mfma_f32_16x16x32_bf16 v[52:55], a[244:247], v[228:231], v[52:55]
    v_accvgpr_write_b32 a17, v197
    v_accvgpr_read_b32 v204, a120
    v_mfma_f32_16x16x32_bf16 v[52:55], a[232:235], v[236:239], v[52:55]
    v_accvgpr_read_b32 v205, a121
    v_accvgpr_read_b32 v206, a122
    v_mfma_f32_16x16x32_bf16 v[56:59], a[236:239], v[236:239], v[56:59]
    ds_read_b128 v[236:239], v253 offset:17952
    v_mfma_f32_16x16x32_bf16 v[56:59], a[248:251], v[228:231], v[56:59]
    v_accvgpr_read_b32 v207, a123
    v_fma_f32 v208, v204, s34, v120 div:2
    v_mfma_f32_16x16x32_bf16 v[56:59], v[244:247], v[232:235], v[56:59]
    v_fma_f32 v209, v205, s34, v121 div:2
    v_fma_f32 v210, v206, s34, v122 div:2
    v_mfma_f32_16x16x32_bf16 v[60:63], a[228:231], v[228:231], v[60:63]
    v_fma_f32 v211, v207, s34, v123 div:2
    v_fma_f32 v120, v204, s35, v120 mul:2
    v_mfma_f32_16x16x32_bf16 v[60:63], a[240:243], v[232:235], v[60:63]
    s_waitcnt lgkmcnt(0)
    v_fma_f32 v121, v205, s35, v121 mul:2
    v_fma_f32 v122, v206, s35, v122 mul:2
    v_mfma_f32_16x16x32_bf16 v[60:63], a[252:255], v[236:239], v[60:63]
    ds_read_b128 a[100:103], v250 offset:8256
    v_fma_f32 v123, v207, s35, v123 mul:2
    v_mfma_f32_16x16x32_bf16 v[64:67], v[240:243], v[236:239], v[64:67]
    buffer_store_dwordx4 a[84:87], v254, s[12:15], s44 offen nt
    v_cvt_pk_bf16_f32 v198, v208, v209
    v_cvt_pk_bf16_f32 v199, v210, v211
    v_mfma_f32_16x16x32_bf16 v[64:67], a[244:247], v[232:235], v[64:67]
    v_accvgpr_read_b32 v204, a28
    v_accvgpr_read_b32 v205, a29
    v_accvgpr_read_b32 v206, a30
    v_mfma_f32_16x16x32_bf16 v[64:67], a[232:235], v[228:231], v[64:67]
    v_accvgpr_read_b32 v207, a31
    v_accvgpr_read_b32 v208, a124
    v_mfma_f32_16x16x32_bf16 v[68:71], a[236:239], v[228:231], v[68:71]
    ds_read_b128 v[228:231], v253 offset:17696
    v_accvgpr_read_b32 v209, a125
    v_mfma_f32_16x16x32_bf16 v[68:71], a[248:251], v[232:235], v[68:71]
    ds_read_b128 a[104:107], v250 offset:11360
    s_add_u32 s44, s40, 403456
    v_mfma_f32_16x16x32_bf16 v[68:71], v[244:247], v[236:239], v[68:71]
    v_accvgpr_read_b32 v210, a126
    v_accvgpr_read_b32 v211, a127
    v_mfma_f32_16x16x32_bf16 v[72:75], a[228:231], v[232:235], v[72:75]
    v_sub_f32 v204, v204, v208
    v_sub_f32 v205, v205, v209
    v_mfma_f32_16x16x32_bf16 v[72:75], a[240:243], v[236:239], v[72:75]
    s_waitcnt lgkmcnt(1)
    v_sub_f32 v206, v206, v210
    v_sub_f32 v207, v207, v211
    v_mfma_f32_16x16x32_bf16 v[72:75], a[252:255], v[228:231], v[72:75]
    v_fma_f32 v208, v204, s34, v124 div:2
    v_fma_f32 v209, v205, s34, v125 div:2
    v_mfma_f32_16x16x32_bf16 v[76:79], v[240:243], v[228:231], v[76:79]
    v_fma_f32 v210, v206, s34, v126 div:2
    v_fma_f32 v211, v207, s34, v127 div:2
    v_mfma_f32_16x16x32_bf16 v[76:79], a[244:247], v[236:239], v[76:79]
    v_fma_f32 v124, v204, s35, v124 mul:2
    v_fma_f32 v125, v205, s35, v125 mul:2
    v_mfma_f32_16x16x32_bf16 v[76:79], a[232:235], v[232:235], v[76:79]
    v_fma_f32 v126, v206, s35, v126 mul:2
    v_fma_f32 v127, v207, s35, v127 mul:2
    v_cvt_pk_bf16_f32 v200, v208, v209
    v_mfma_f32_16x16x32_bf16 v[80:83], a[236:239], v[232:235], v[80:83]
    ds_read_b128 v[232:235], v253 offset:17424
    v_cvt_pk_bf16_f32 v201, v210, v211
    v_mfma_f32_16x16x32_bf16 v[80:83], a[248:251], v[236:239], v[80:83]
    v_accvgpr_read_b32 v204, a32
    v_accvgpr_read_b32 v205, a33
    v_mfma_f32_16x16x32_bf16 v[80:83], v[244:247], v[228:231], v[80:83]
    s_mov_b32 s42, 1032192
    v_accvgpr_read_b32 v206, a34
    v_accvgpr_read_b32 v207, a35
    v_mfma_f32_16x16x32_bf16 v[84:87], a[228:231], v[236:239], v[84:87]
    s_waitcnt lgkmcnt(0)
    v_accvgpr_read_b32 v208, a128
    v_accvgpr_read_b32 v209, a129
    v_mfma_f32_16x16x32_bf16 v[88:91], a[232:235], v[236:239], v[88:91]
    s_barrier
    v_mfma_f32_16x16x32_bf16 v[92:95], a[236:239], v[236:239], v[92:95]
    ds_read_b128 v[236:239], v253 offset:19760
    v_accvgpr_read_b32 v210, a130
    v_mfma_f32_16x16x32_bf16 v[92:95], a[248:251], v[228:231], v[92:95]
    buffer_load_dwordx4 a[228:231], v254, s[8:11], s42 offen offset:0 sc1
    v_mfma_f32_16x16x32_bf16 v[88:91], a[244:247], v[228:231], v[88:91]
    v_accvgpr_read_b32 v211, a131
    v_sub_f32 v204, v204, v208
    v_mfma_f32_16x16x32_bf16 v[84:87], a[240:243], v[228:231], v[84:87]
    ds_read_b128 v[228:231], v253 offset:19488
    v_sub_f32 v205, v205, v209
    v_mfma_f32_16x16x32_bf16 v[84:87], a[252:255], v[232:235], v[84:87]
    buffer_load_dwordx4 a[232:235], v254, s[8:11], s42 offen offset:1024 sc1
    v_sub_f32 v206, v206, v210
    v_mfma_f32_16x16x32_bf16 v[88:91], v[240:243], v[232:235], v[88:91]
    s_waitcnt vmcnt(11) lgkmcnt(1)
    v_sub_f32 v207, v207, v211
    v_fma_f32 v208, v204, s34, v128 div:2
    v_mfma_f32_16x16x32_bf16 v[92:95], v[244:247], v[232:235], v[92:95]
    ds_read_b128 v[232:235], v253 offset:19232
    v_fma_f32 v209, v205, s34, v129 div:2
sub26:
    v_mfma_f32_16x16x32_bf16 v[0:3], a[192:195], v[236:239], v[0:3]
    buffer_load_dwordx4 a[236:239], v254, s[8:11], s42 offen offset:2048 sc1
    v_mfma_f32_16x16x32_bf16 v[4:7], a[196:199], v[236:239], v[4:7]
    s_mov_b32 s42, 1035264
    v_fma_f32 v210, v206, s34, v130 div:2
    v_fma_f32 v211, v207, s34, v131 div:2
    v_mfma_f32_16x16x32_bf16 v[8:11], a[200:203], v[236:239], v[8:11]
    ds_read_b128 v[236:239], v253 offset:18976
    s_waitcnt vmcnt(9)
    s_waitcnt lgkmcnt(2)
    v_mfma_f32_16x16x32_bf16 v[8:11], a[212:215], v[228:231], v[8:11]
    ds_write_b128 v248, a[0:3] offset:0
    v_mfma_f32_16x16x32_bf16 v[4:7], a[208:211], v[228:231], v[4:7]
    buffer_load_dwordx4 a[240:243], v254, s[8:11], s42 offen offset:0 sc1
    v_mfma_f32_16x16x32_bf16 v[0:3], a[204:207], v[228:231], v[0:3]
    s_waitcnt vmcnt(7) lgkmcnt(2)
    v_fma_f32 v128, v204, s35, v128 mul:2
    v_fma_f32 v129, v205, s35, v129 mul:2
    v_mfma_f32_16x16x32_bf16 v[0:3], a[216:219], v[232:235], v[0:3]
    v_fma_f32 v130, v206, s35, v130 mul:2
    v_fma_f32 v131, v207, s35, v131 mul:2
    v_mfma_f32_16x16x32_bf16 v[4:7], a[220:223], v[232:235], v[4:7]
    ds_write_b64 v249, a[4:5] offset:64
    v_cvt_pk_bf16_f32 v202, v208, v209
    v_mfma_f32_16x16x32_bf16 v[8:11], a[224:227], v[232:235], v[8:11]
    buffer_load_dwordx4 a[244:247], v254, s[8:11], s42 offen offset:1024 sc1
    v_mfma_f32_16x16x32_bf16 v[12:15], a[192:195], v[228:231], v[12:15]
    ds_write_b128 v248, v[198:201] offset:768
    v_mfma_f32_16x16x32_bf16 v[12:15], a[204:207], v[232:235], v[12:15]
    s_waitcnt lgkmcnt(3)
    v_cvt_pk_bf16_f32 v203, v210, v211
    v_accvgpr_read_b32 v204, a36
    v_mfma_f32_16x16x32_bf16 v[12:15], a[216:219], v[236:239], v[12:15]
    v_accvgpr_read_b32 v205, a37
    v_accvgpr_read_b32 v206, a38
    v_mfma_f32_16x16x32_bf16 v[16:19], a[220:223], v[236:239], v[16:19]
    buffer_load_dwordx4 a[248:251], v254, s[8:11], s42 offen offset:2048 sc1
    v_mfma_f32_16x16x32_bf16 v[16:19], a[208:211], v[232:235], v[16:19]
    s_mov_b32 s42, 1038336
    v_accvgpr_read_b32 v207, a39
    v_accvgpr_read_b32 v208, a132
    v_mfma_f32_16x16x32_bf16 v[16:19], a[196:199], v[228:231], v[16:19]
    ds_write_b128 v248, a[12:15] offset:384
    v_mfma_f32_16x16x32_bf16 v[20:23], a[200:203], v[228:231], v[20:23]
    ds_read_b128 v[228:231], v253 offset:18720
    v_accvgpr_read_b32 v209, a133
    v_mfma_f32_16x16x32_bf16 v[20:23], a[212:215], v[232:235], v[20:23]
    buffer_load_dwordx4 a[252:255], v254, s[8:11], s42 offen offset:0 sc1
    v_mfma_f32_16x16x32_bf16 v[20:23], a[224:227], v[236:239], v[20:23]
    v_accvgpr_read_b32 v210, a134
    v_accvgpr_read_b32 v211, a135
    v_sub_f32 v204, v204, v208
    v_mfma_f32_16x16x32_bf16 v[24:27], a[192:195], v[232:235], v[24:27]
    ds_write_b64 v249, v[202:203] offset:832
    v_mfma_f32_16x16x32_bf16 v[24:27], a[204:207], v[236:239], v[24:27]
    s_waitcnt lgkmcnt(1)
    v_sub_f32 v205, v205, v209
    v_sub_f32 v206, v206, v210
    v_mfma_f32_16x16x32_bf16 v[24:27], a[216:219], v[228:231], v[24:27]
    v_sub_f32 v207, v207, v211
    v_fma_f32 v208, v204, s34, v132 div:2
    v_mfma_f32_16x16x32_bf16 v[28:31], a[220:223], v[228:231], v[28:31]
    buffer_load_dwordx4 v[240:243], v254, s[8:11], s42 offen offset:1024 sc1
    v_mfma_f32_16x16x32_bf16 v[28:31], a[208:211], v[236:239], v[28:31]
    ds_write_b64 v249, a[16:17] offset:448
    v_mfma_f32_16x16x32_bf16 v[28:31], a[196:199], v[232:235], v[28:31]
    v_fma_f32 v209, v205, s34, v133 div:2
    v_fma_f32 v210, v206, s34, v134 div:2
    v_mfma_f32_16x16x32_bf16 v[32:35], a[200:203], v[232:235], v[32:35]
    ds_read_b128 v[232:235], v253 offset:20544
    v_fma_f32 v211, v207, s34, v135 div:2
    v_mfma_f32_16x16x32_bf16 v[32:35], a[212:215], v[236:239], v[32:35]
    buffer_load_dwordx4 v[244:247], v254, s[8:11], s42 offen offset:2048 sc1
    v_mfma_f32_16x16x32_bf16 v[32:35], a[224:227], v[228:231], v[32:35]
    v_fma_f32 v132, v204, s35, v132 mul:2
    v_fma_f32 v133, v205, s35, v133 mul:2
    v_mfma_f32_16x16x32_bf16 v[36:39], a[192:195], v[236:239], v[36:39]
    v_fma_f32 v134, v206, s35, v134 mul:2
    v_fma_f32 v135, v207, s35, v135 mul:2
    v_cvt_pk_bf16_f32 v192, v208, v209
    v_mfma_f32_16x16x32_bf16 v[36:39], a[204:207], v[228:231], v[36:39]
    s_waitcnt lgkmcnt(0)
    v_cvt_pk_bf16_f32 v193, v210, v211
    v_accvgpr_read_b32 v204, a40
    v_mfma_f32_16x16x32_bf16 v[36:39], a[216:219], v[232:235], v[36:39]
    buffer_store_dwordx4 a[88:91], v254, s[12:15], s44 offen nt
    s_add_u32 s44, s40, 395264
    v_mfma_f32_16x16x32_bf16 v[40:43], a[220:223], v[232:235], v[40:43]
    v_accvgpr_read_b32 v205, a41
    v_accvgpr_read_b32 v206, a42
    v_mfma_f32_16x16x32_bf16 v[40:43], a[208:211], v[228:231], v[40:43]
    v_accvgpr_read_b32 v207, a43
    v_accvgpr_read_b32 v208, a136
    v_mfma_f32_16x16x32_bf16 v[40:43], a[196:199], v[236:239], v[40:43]
    buffer_store_dwordx4 a[92:95], v254, s[12:15], s44 offen nt
    s_add_u32 s44, s40, 398336
    v_mfma_f32_16x16x32_bf16 v[44:47], a[200:203], v[236:239], v[44:47]
    ds_read_b128 v[236:239], v253 offset:20288
    v_accvgpr_read_b32 v209, a137
    v_mfma_f32_16x16x32_bf16 v[44:47], a[212:215], v[228:231], v[44:47]
    v_accvgpr_read_b32 v210, a138
    v_accvgpr_read_b32 v211, a139
    v_mfma_f32_16x16x32_bf16 v[44:47], a[224:227], v[232:235], v[44:47]
    buffer_store_dwordx4 a[96:99], v254, s[12:15], s44 offen nt
    s_add_u32 s44, s40, 401408
    v_mfma_f32_16x16x32_bf16 v[48:51], a[192:195], v[228:231], v[48:51]
    v_sub_f32 v204, v204, v208
    v_sub_f32 v205, v205, v209
    v_mfma_f32_16x16x32_bf16 v[48:51], a[204:207], v[232:235], v[48:51]
    s_waitcnt lgkmcnt(0)
    v_sub_f32 v206, v206, v210
    v_sub_f32 v207, v207, v211
    v_fma_f32 v208, v204, s34, v136 div:2
    v_mfma_f32_16x16x32_bf16 v[48:51], a[216:219], v[236:239], v[48:51]
    buffer_store_dwordx4 a[100:103], v254, s[12:15], s44 offen nt
    v_fma_f32 v209, v205, s34, v137 div:2
    v_fma_f32 v210, v206, s34, v138 div:2
    v_mfma_f32_16x16x32_bf16 v[52:55], a[220:223], v[236:239], v[52:55]
    v_fma_f32 v211, v207, s34, v139 div:2
    v_fma_f32 v136, v204, s35, v136 mul:2
    v_mfma_f32_16x16x32_bf16 v[52:55], a[208:211], v[232:235], v[52:55]
    v_fma_f32 v137, v205, s35, v137 mul:2
    v_fma_f32 v138, v206, s35, v138 mul:2
    v_mfma_f32_16x16x32_bf16 v[52:55], a[196:199], v[228:231], v[52:55]
    v_fma_f32 v139, v207, s35, v139 mul:2
    v_cvt_pk_bf16_f32 v194, v208, v209
    v_mfma_f32_16x16x32_bf16 v[56:59], a[200:203], v[228:231], v[56:59]
    ds_read_b128 v[228:231], v253 offset:20032
    s_add_u32 s44, s40, 404480
    v_mfma_f32_16x16x32_bf16 v[56:59], a[212:215], v[232:235], v[56:59]
pad10:
    s_cbranch_vccnz warm_ret
    v_cvt_pk_bf16_f32 v195, v210, v211
    v_accvgpr_read_b32 v204, a44
    v_mfma_f32_16x16x32_bf16 v[56:59], a[224:227], v[236:239], v[56:59]
    ds_write_b128 v248, v[192:195] offset:1152
    v_mfma_f32_16x16x32_bf16 v[60:63], a[192:195], v[232:235], v[60:63]
    v_accvgpr_read_b32 v205, a45
    v_accvgpr_read_b32 v206, a46
    v_mfma_f32_16x16x32_bf16 v[60:63], a[204:207], v[236:239], v[60:63]
    s_waitcnt lgkmcnt(1)
    v_accvgpr_read_b32 v207, a47
    v_accvgpr_read_b32 v208, a140
    v_mfma_f32_16x16x32_bf16 v[60:63], a[216:219], v[228:231], v[60:63]
    v_accvgpr_read_b32 v209, a141
    v_accvgpr_read_b32 v210, a142
    v_accvgpr_read_b32 v211, a143
    v_mfma_f32_16x16x32_bf16 v[64:67], a[220:223], v[228:231], v[64:67]
    v_sub_f32 v204, v204, v208
    v_sub_f32 v205, v205, v209
    v_mfma_f32_16x16x32_bf16 v[64:67], a[208:211], v[236:239], v[64:67]
    v_sub_f32 v206, v206, v210
    v_sub_f32 v207, v207, v211
    v_mfma_f32_16x16x32_bf16 v[64:67], a[196:199], v[232:235], v[64:67]
    v_fma_f32 v208, v204, s34, v140 div:2
    v_fma_f32 v209, v205, s34, v141 div:2
    v_mfma_f32_16x16x32_bf16 v[68:71], a[200:203], v[232:235], v[68:71]
    ds_read_b128 v[232:235], v253 offset:19776
    v_fma_f32 v210, v206, s34, v142 div:2
    v_mfma_f32_16x16x32_bf16 v[68:71], a[212:215], v[236:239], v[68:71]
    v_fma_f32 v211, v207, s34, v143 div:2
    v_fma_f32 v140, v204, s35, v140 mul:2
    v_mfma_f32_16x16x32_bf16 v[68:71], a[224:227], v[228:231], v[68:71]
    buffer_store_dwordx4 a[104:107], v254, s[12:15], s44 offen nt
    v_fma_f32 v141, v205, s35, v141 mul:2
    v_fma_f32 v142, v206, s35, v142 mul:2
    v_mfma_f32_16x16x32_bf16 v[72:75], a[192:195], v[236:239], v[72:75]
    v_fma_f32 v143, v207, s35, v143 mul:2
    v_cvt_pk_bf16_f32 v196, v208, v209
    v_mfma_f32_16x16x32_bf16 v[72:75], a[204:207], v[228:231], v[72:75]
    s_waitcnt lgkmcnt(0)
    v_cvt_pk_bf16_f32 v197, v210, v211
    v_accvgpr_read_b32 v204, a48
    v_mfma_f32_16x16x32_bf16 v[72:75], a[216:219], v[232:235], v[72:75]
    ds_write_b64 v249, v[196:197] offset:1216
    v_mfma_f32_16x16x32_bf16 v[76:79], a[220:223], v[232:235], v[76:79]
    v_accvgpr_read_b32 v205, a49
    v_accvgpr_read_b32 v206, a50
    v_accvgpr_read_b32 v207, a51
    v_mfma_f32_16x16x32_bf16 v[76:79], a[208:211], v[228:231], v[76:79]
    v_accvgpr_read_b32 v208, a144
    v_accvgpr_read_b32 v209, a145
    v_mfma_f32_16x16x32_bf16 v[76:79], a[196:199], v[236:239], v[76:79]
    v_accvgpr_read_b32 v210, a146
    v_accvgpr_read_b32 v211, a147
    v_mfma_f32_16x16x32_bf16 v[80:83], a[200:203], v[236:239], v[80:83]
    ds_read_b128 v[236:239], v253 offset:19504
    v_sub_f32 v204, v204, v208
    v_mfma_f32_16x16x32_bf16 v[80:83], a[212:215], v[228:231], v[80:83]
    v_sub_f32 v205, v205, v209
    v_sub_f32 v206, v206, v210
    v_mfma_f32_16x16x32_bf16 v[80:83], a[224:227], v[232:235], v[80:83]
    s_mov_b32 s42, 1069056
    v_sub_f32 v207, v207, v211
    v_fma_f32 v208, v204, s34, v144 div:2
    v_mfma_f32_16x16x32_bf16 v[84:87], a[192:195], v[228:231], v[84:87]
    s_waitcnt lgkmcnt(0)
    v_fma_f32 v209, v205, s34, v145 div:2
    v_fma_f32 v210, v206, s34, v146 div:2
    v_mfma_f32_16x16x32_bf16 v[88:91], a[196:199], v[228:231], v[88:91]
    s_barrier
    v_mfma_f32_16x16x32_bf16 v[92:95], a[200:203], v[228:231], v[92:95]
    ds_read_b128 v[228:231], v253 offset:21840
    v_fma_f32 v211, v207, s34, v147 div:2
    v_mfma_f32_16x16x32_bf16 v[92:95], a[212:215], v[232:235], v[92:95]
    buffer_load_dwordx4 a[192:195], v254, s[8:11], s42 offen offset:0 sc1
    v_mfma_f32_16x16x32_bf16 v[88:91], a[208:211], v[232:235], v[88:91]
    v_fma_f32 v144, v204, s35, v144 mul:2
    v_fma_f32 v145, v205, s35, v145 mul:2
    v_fma_f32 v146, v206, s35, v146 mul:2
    v_mfma_f32_16x16x32_bf16 v[84:87], a[204:207], v[232:235], v[84:87]
    ds_read_b128 v[232:235], v253 offset:21568
    v_fma_f32 v147, v207, s35, v147 mul:2
    v_mfma_f32_16x16x32_bf16 v[84:87], a[216:219], v[236:239], v[84:87]
    buffer_load_dwordx4 a[196:199], v254, s[8:11], s42 offen offset:1024 sc1
    v_mfma_f32_16x16x32_bf16 v[88:91], a[220:223], v[236:239], v[88:91]
    s_waitcnt vmcnt(13) lgkmcnt(1)
    v_cvt_pk_bf16_f32 v198, v208, v209
    v_cvt_pk_bf16_f32 v199, v210, v211
    v_mfma_f32_16x16x32_bf16 v[92:95], a[224:227], v[236:239], v[92:95]
    ds_read_b128 v[236:239], v253 offset:21312
    v_accvgpr_read_b32 v204, a52
sub27:
    v_mfma_f32_16x16x32_bf16 v[0:3], a[228:231], v[228:231], v[0:3]
    buffer_load_dwordx4 a[200:203], v254, s[8:11], s42 offen offset:2048 sc1
    v_mfma_f32_16x16x32_bf16 v[4:7], a[232:235], v[228:231], v[4:7]
    s_mov_b32 s42, 1072128
    s_add_u32 s44, s40, 196608
    v_accvgpr_read_b32 v205, a53
    v_mfma_f32_16x16x32_bf16 v[8:11], a[236:239], v[228:231], v[8:11]
    ds_read_b128 v[228:231], v253 offset:21056
    s_waitcnt vmcnt(11)
    s_waitcnt lgkmcnt(2)
    v_mfma_f32_16x16x32_bf16 v[8:11], a[248:251], v[232:235], v[8:11]
    ds_read_b128 a[108:111], v250 offset:0
    v_accvgpr_read_b32 v206, a54
    v_mfma_f32_16x16x32_bf16 v[4:7], a[244:247], v[232:235], v[4:7]
    buffer_load_dwordx4 a[204:207], v254, s[8:11], s42 offen offset:0 sc1
    v_mfma_f32_16x16x32_bf16 v[0:3], a[240:243], v[232:235], v[0:3]
    s_waitcnt vmcnt(9) lgkmcnt(2)
    v_accvgpr_read_b32 v207, a55
    v_accvgpr_read_b32 v208, a148
    v_accvgpr_read_b32 v209, a149
    v_mfma_f32_16x16x32_bf16 v[0:3], a[252:255], v[236:239], v[0:3]
    ds_read_b128 a[112:115], v250 offset:3104
    v_accvgpr_read_b32 v210, a150
    v_mfma_f32_16x16x32_bf16 v[4:7], v[240:243], v[236:239], v[4:7]
    v_accvgpr_read_b32 v211, a151
    v_sub_f32 v204, v204, v208
    v_mfma_f32_16x16x32_bf16 v[8:11], v[244:247], v[236:239], v[8:11]
    buffer_load_dwordx4 a[208:211], v254, s[8:11], s42 offen offset:1024 sc1
    v_mfma_f32_16x16x32_bf16 v[12:15], a[228:231], v[232:235], v[12:15]
    s_waitcnt lgkmcnt(1)
    v_sub_f32 v205, v205, v209
    v_sub_f32 v206, v206, v210
    v_mfma_f32_16x16x32_bf16 v[12:15], a[240:243], v[236:239], v[12:15]
    v_sub_f32 v207, v207, v211
    v_fma_f32 v208, v204, s34, v148 div:2
    v_mfma_f32_16x16x32_bf16 v[12:15], a[252:255], v[228:231], v[12:15]
    v_fma_f32 v209, v205, s34, v149 div:2
    v_fma_f32 v210, v206, s34, v150 div:2
    v_mfma_f32_16x16x32_bf16 v[16:19], v[240:243], v[228:231], v[16:19]
    buffer_load_dwordx4 a[212:215], v254, s[8:11], s42 offen offset:2048 sc1
    v_mfma_f32_16x16x32_bf16 v[16:19], a[244:247], v[236:239], v[16:19]
    s_mov_b32 s42, 1075200
    v_fma_f32 v211, v207, s34, v151 div:2
    v_fma_f32 v148, v204, s35, v148 mul:2
    v_mfma_f32_16x16x32_bf16 v[16:19], a[232:235], v[232:235], v[16:19]
    ds_read_b128 a[116:119], v250 offset:6208
    v_fma_f32 v149, v205, s35, v149 mul:2
    v_mfma_f32_16x16x32_bf16 v[20:23], a[236:239], v[232:235], v[20:23]
    ds_read_b128 v[232:235], v253 offset:20800
    v_fma_f32 v150, v206, s35, v150 mul:2
    v_fma_f32 v151, v207, s35, v151 mul:2
    v_mfma_f32_16x16x32_bf16 v[20:23], a[248:251], v[236:239], v[20:23]
    buffer_load_dwordx4 a[216:219], v254, s[8:11], s42 offen offset:0 sc1
    v_mfma_f32_16x16x32_bf16 v[20:23], v[244:247], v[228:231], v[20:23]
    v_cvt_pk_bf16_f32 v200, v208, v209
    v_cvt_pk_bf16_f32 v201, v210, v211
    v_mfma_f32_16x16x32_bf16 v[24:27], a[228:231], v[236:239], v[24:27]
    ds_write_b128 v248, v[198:201] offset:1536
    v_mfma_f32_16x16x32_bf16 v[24:27], a[240:243], v[228:231], v[24:27]
    s_waitcnt lgkmcnt(1)
    v_accvgpr_read_b32 v204, a56
    v_accvgpr_read_b32 v205, a57
    v_mfma_f32_16x16x32_bf16 v[24:27], a[252:255], v[232:235], v[24:27]
    v_accvgpr_read_b32 v206, a58
    v_accvgpr_read_b32 v207, a59
    v_mfma_f32_16x16x32_bf16 v[28:31], v[240:243], v[232:235], v[28:31]
    buffer_load_dwordx4 a[220:223], v254, s[8:11], s42 offen offset:1024 sc1
    v_mfma_f32_16x16x32_bf16 v[28:31], a[244:247], v[228:231], v[28:31]
    ds_read_b128 a[120:123], v250 offset:9312
    v_accvgpr_read_b32 v208, a152
    v_mfma_f32_16x16x32_bf16 v[28:31], a[232:235], v[236:239], v[28:31]
    v_accvgpr_read_b32 v209, a153
    v_accvgpr_read_b32 v210, a154
    v_mfma_f32_16x16x32_bf16 v[32:35], a[236:239], v[236:239], v[32:35]
    ds_read_b128 v[236:239], v253 offset:22624
    v_accvgpr_read_b32 v211, a155
    v_mfma_f32_16x16x32_bf16 v[32:35], a[248:251], v[228:231], v[32:35]
    buffer_load_dwordx4 a[224:227], v254, s[8:11], s42 offen offset:2048 sc1
    v_sub_f32 v204, v204, v208
    v_mfma_f32_16x16x32_bf16 v[32:35], v[244:247], v[232:235], v[32:35]
    v_sub_f32 v205, v205, v209
    v_sub_f32 v206, v206, v210
    v_mfma_f32_16x16x32_bf16 v[36:39], a[228:231], v[228:231], v[36:39]
    v_sub_f32 v207, v207, v211
    v_fma_f32 v208, v204, s34, v152 div:2
    v_mfma_f32_16x16x32_bf16 v[36:39], a[240:243], v[232:235], v[36:39]
    s_waitcnt lgkmcnt(0)
    v_fma_f32 v209, v205, s34, v153 div:2
    v_fma_f32 v210, v206, s34, v154 div:2
    v_mfma_f32_16x16x32_bf16 v[36:39], a[252:255], v[236:239], v[36:39]
    buffer_store_dwordx4 a[108:111], v254, s[12:15], s44 offen nt
    s_add_u32 s44, s40, 199680
    v_fma_f32 v211, v207, s34, v155 div:2
    v_mfma_f32_16x16x32_bf16 v[40:43], v[240:243], v[236:239], v[40:43]
    v_fma_f32 v152, v204, s35, v152 mul:2
    v_fma_f32 v153, v205, s35, v153 mul:2
    v_mfma_f32_16x16x32_bf16 v[40:43], a[244:247], v[232:235], v[40:43]
    v_fma_f32 v154, v206, s35, v154 mul:2
    v_fma_f32 v155, v207, s35, v155 mul:2
    v_mfma_f32_16x16x32_bf16 v[40:43], a[232:235], v[228:231], v[40:43]
    v_cvt_pk_bf16_f32 v202, v208, v209
    v_cvt_pk_bf16_f32 v203, v210, v211
    v_mfma_f32_16x16x32_bf16 v[44:47], a[236:239], v[228:231], v[44:47]
    ds_read_b128 v[228:231], v253 offset:22368
    v_mfma_f32_16x16x32_bf16 v[44:47], a[248:251], v[232:235], v[44:47]
    ds_write_b64 v249, v[202:203] offset:1600
    v_mfma_f32_16x16x32_bf16 v[44:47], v[244:247], v[236:239], v[44:47]
    v_accvgpr_read_b32 v204, a60
    v_accvgpr_read_b32 v205, a61
    v_accvgpr_read_b32 v206, a62
    v_mfma_f32_16x16x32_bf16 v[48:51], a[228:231], v[232:235], v[48:51]
    v_accvgpr_read_b32 v207, a63
    v_accvgpr_read_b32 v208, a156
    v_mfma_f32_16x16x32_bf16 v[48:51], a[240:243], v[236:239], v[48:51]
    s_waitcnt lgkmcnt(1)
    v_accvgpr_read_b32 v209, a157
    v_accvgpr_read_b32 v210, a158
    v_mfma_f32_16x16x32_bf16 v[48:51], a[252:255], v[228:231], v[48:51]
    v_accvgpr_read_b32 v211, a159
    v_sub_f32 v204, v204, v208
    v_mfma_f32_16x16x32_bf16 v[52:55], v[240:243], v[228:231], v[52:55]
    v_sub_f32 v205, v205, v209
    v_sub_f32 v206, v206, v210
    v_mfma_f32_16x16x32_bf16 v[52:55], a[244:247], v[236:239], v[52:55]
    v_sub_f32 v207, v207, v211
    v_fma_f32 v208, v204, s34, v156 div:2
    v_mfma_f32_16x16x32_bf16 v[52:55], a[232:235], v[232:235], v[52:55]
    buffer_store_dwordx4 a[112:115], v254, s[12:15], s44 offen nt
    v_fma_f32 v209, v205, s34, v157 div:2
    v_fma_f32 v210, v206, s34, v158 div:2
    v_mfma_f32_16x16x32_bf16 v[56:59], a[236:239], v[232:235], v[56:59]
    ds_read_b128 v[232:235], v253 offset:22112
    v_fma_f32 v211, v207, s34, v159 div:2
    v_mfma_f32_16x16x32_bf16 v[56:59], a[248:251], v[236:239], v[56:59]
    v_fma_f32 v156, v204, s35, v156 mul:2
    v_fma_f32 v157, v205, s35, v157 mul:2
    v_mfma_f32_16x16x32_bf16 v[56:59], v[244:247], v[228:231], v[56:59]
    v_fma_f32 v158, v206, s35, v158 mul:2
    v_fma_f32 v159, v207, s35, v159 mul:2
    v_mfma_f32_16x16x32_bf16 v[60:63], a[228:231], v[236:239], v[60:63]
    v_cvt_pk_bf16_f32 v192, v208, v209
    v_cvt_pk_bf16_f32 v193, v210, v211
    v_accvgpr_read_b32 v204, a64
    v_mfma_f32_16x16x32_bf16 v[60:63], a[240:243], v[228:231], v[60:63]
    s_waitcnt lgkmcnt(0)
    v_accvgpr_read_b32 v205, a65
    v_accvgpr_read_b32 v206, a66
    v_mfma_f32_16x16x32_bf16 v[60:63], a[252:255], v[232:235], v[60:63]
    v_accvgpr_read_b32 v207, a67
    v_accvgpr_read_b32 v208, a160
    v_mfma_f32_16x16x32_bf16 v[64:67], v[240:243], v[232:235], v[64:67]
    v_accvgpr_read_b32 v209, a161
    v_accvgpr_read_b32 v210, a162
    v_mfma_f32_16x16x32_bf16 v[64:67], a[244:247], v[228:231], v[64:67]
    v_accvgpr_read_b32 v211, a163
    v_sub_f32 v204, v204, v208
    v_mfma_f32_16x16x32_bf16 v[64:67], a[232:235], v[236:239], v[64:67]
    s_add_u32 s44, s40, 202752
    v_sub_f32 v205, v205, v209
    v_sub_f32 v206, v206, v210
    v_mfma_f32_16x16x32_bf16 v[68:71], a[236:239], v[236:239], v[68:71]
    ds_read_b128 v[236:239], v253 offset:21856
    v_sub_f32 v207, v207, v211
    v_mfma_f32_16x16x32_bf16 v[68:71], a[248:251], v[228:231], v[68:71]
    v_fma_f32 v208, v204, s34, v160 div:2
    v_fma_f32 v209, v205, s34, v161 div:2
    v_mfma_f32_16x16x32_bf16 v[68:71], v[244:247], v[232:235], v[68:71]
    v_fma_f32 v210, v206, s34, v162 div:2
    v_fma_f32 v211, v207, s34, v163 div:2
    v_mfma_f32_16x16x32_bf16 v[72:75], a[228:231], v[228:231], v[72:75]
    v_fma_f32 v160, v204, s35, v160 mul:2
    v_fma_f32 v161, v205, s35, v161 mul:2
    v_mfma_f32_16x16x32_bf16 v[72:75], a[240:243], v[232:235], v[72:75]
    s_waitcnt lgkmcnt(0)
    v_fma_f32 v162, v206, s35, v162 mul:2
    v_fma_f32 v163, v207, s35, v163 mul:2
    v_cvt_pk_bf16_f32 v194, v208, v209
    v_mfma_f32_16x16x32_bf16 v[72:75], a[252:255], v[236:239], v[72:75]
    v_cvt_pk_bf16_f32 v195, v210, v211
    v_accvgpr_read_b32 v204, a68
    v_mfma_f32_16x16x32_bf16 v[76:79], v[240:243], v[236:239], v[76:79]
    ds_write_b128 v248, v[192:195] offset:1920
    v_mfma_f32_16x16x32_bf16 v[76:79], a[244:247], v[232:235], v[76:79]
    v_accvgpr_read_b32 v205, a69
    v_accvgpr_read_b32 v206, a70
    v_mfma_f32_16x16x32_bf16 v[76:79], a[232:235], v[228:231], v[76:79]
    v_accvgpr_read_b32 v207, a71
    v_accvgpr_read_b32 v208, a164
    v_mfma_f32_16x16x32_bf16 v[80:83], a[236:239], v[228:231], v[80:83]
    ds_read_b128 v[228:231], v253 offset:21584
    v_accvgpr_read_b32 v209, a165
    v_mfma_f32_16x16x32_bf16 v[80:83], a[248:251], v[232:235], v[80:83]
    v_accvgpr_read_b32 v210, a166
    v_accvgpr_read_b32 v211, a167
    v_mfma_f32_16x16x32_bf16 v[80:83], v[244:247], v[236:239], v[80:83]
    s_mov_b32 s42, 884736
    v_sub_f32 v204, v204, v208
    v_sub_f32 v205, v205, v209
    v_mfma_f32_16x16x32_bf16 v[84:87], a[228:231], v[232:235], v[84:87]
    v_sub_f32 v206, v206, v210
    v_sub_f32 v207, v207, v211
    v_mfma_f32_16x16x32_bf16 v[88:91], a[232:235], v[232:235], v[88:91]
    v_fma_f32 v208, v204, s34, v164 div:2
    v_fma_f32 v209, v205, s34, v165 div:2
    v_mfma_f32_16x16x32_bf16 v[92:95], a[236:239], v[232:235], v[92:95]
    ds_read_b128 v[232:235], v253 offset:23920
    v_fma_f32 v210, v206, s34, v166 div:2
    v_fma_f32 v211, v207, s34, v167 div:2
    v_mfma_f32_16x16x32_bf16 v[92:95], a[248:251], v[236:239], v[92:95]
    buffer_load_dwordx4 a[228:231], v254, s[8:11], s42 offen offset:0 sc1
    v_mfma_f32_16x16x32_bf16 v[88:91], a[244:247], v[236:239], v[88:91]
    s_waitcnt lgkmcnt(1)
    v_fma_f32 v164, v204, s35, v164 mul:2
    v_fma_f32 v165, v205, s35, v165 mul:2
    v_mfma_f32_16x16x32_bf16 v[84:87], a[240:243], v[236:239], v[84:87]
    ds_read_b128 v[236:239], v253 offset:23648
    v_fma_f32 v166, v206, s35, v166 mul:2
    v_mfma_f32_16x16x32_bf16 v[84:87], a[252:255], v[228:231], v[84:87]
    buffer_load_dwordx4 a[232:235], v254, s[8:11], s42 offen offset:1024 sc1
    v_mfma_f32_16x16x32_bf16 v[88:91], v[240:243], v[228:231], v[88:91]
    s_waitcnt vmcnt(10) lgkmcnt(1)
    v_fma_f32 v167, v207, s35, v167 mul:2
    v_cvt_pk_bf16_f32 v196, v208, v209
    v_mfma_f32_16x16x32_bf16 v[92:95], v[244:247], v[228:231], v[92:95]
    ds_read_b128 v[228:231], v253 offset:23392
    v_cvt_pk_bf16_f32 v197, v210, v211
sub28:
    v_mfma_f32_16x16x32_bf16 v[0:3], a[192:195], v[232:235], v[0:3]
    buffer_load_dwordx4 a[236:239], v254, s[8:11], s42 offen offset:2048 sc1
    v_mfma_f32_16x16x32_bf16 v[4:7], a[196:199], v[232:235], v[4:7]
    s_mov_b32 s42, 887808
    v_accvgpr_read_b32 v204, a72
    v_accvgpr_read_b32 v205, a73
    v_mfma_f32_16x16x32_bf16 v[8:11], a[200:203], v[232:235], v[8:11]
    ds_read_b128 v[232:235], v253 offset:23136
    s_waitcnt vmcnt(8)
    s_waitcnt lgkmcnt(2)
    v_mfma_f32_16x16x32_bf16 v[8:11], a[212:215], v[236:239], v[8:11]
    ds_write_b64 v249, v[196:197] offset:1984
    v_accvgpr_read_b32 v206, a74
    v_mfma_f32_16x16x32_bf16 v[4:7], a[208:211], v[236:239], v[4:7]
    buffer_load_dwordx4 a[240:243], v254, s[8:11], s42 offen offset:0 sc1
    v_mfma_f32_16x16x32_bf16 v[0:3], a[204:207], v[236:239], v[0:3]
    s_waitcnt vmcnt(6) lgkmcnt(2)
    v_accvgpr_read_b32 v207, a75
    v_accvgpr_read_b32 v208, a168
    v_mfma_f32_16x16x32_bf16 v[0:3], a[216:219], v[228:231], v[0:3]
    v_accvgpr_read_b32 v209, a169
    v_accvgpr_read_b32 v210, a170
    v_mfma_f32_16x16x32_bf16 v[4:7], a[220:223], v[228:231], v[4:7]
    v_accvgpr_read_b32 v211, a171
    v_sub_f32 v204, v204, v208
    v_mfma_f32_16x16x32_bf16 v[8:11], a[224:227], v[228:231], v[8:11]
    buffer_load_dwordx4 a[244:247], v254, s[8:11], s42 offen offset:1024 sc1
    v_mfma_f32_16x16x32_bf16 v[12:15], a[192:195], v[236:239], v[12:15]
    v_sub_f32 v205, v205, v209
    v_sub_f32 v206, v206, v210
    v_mfma_f32_16x16x32_bf16 v[12:15], a[204:207], v[228:231], v[12:15]
    s_waitcnt lgkmcnt(1)
    v_sub_f32 v207, v207, v211
    v_fma_f32 v208, v204, s34, v168 div:2
    v_mfma_f32_16x16x32_bf16 v[12:15], a[216:219], v[232:235], v[12:15]
    v_fma_f32 v209, v205, s34, v169 div:2
    v_fma_f32 v210, v206, s34, v170 div:2
    v_mfma_f32_16x16x32_bf16 v[16:19], a[220:223], v[232:235], v[16:19]
    buffer_load_dwordx4 a[248:251], v254, s[8:11], s42 offen offset:2048 sc1
    v_mfma_f32_16x16x32_bf16 v[16:19], a[208:211], v[228:231], v[16:19]
    s_mov_b32 s42, 890880
    v_fma_f32 v211, v207, s34, v171 div:2
    v_fma_f32 v168, v204, s35, v168 mul:2
    v_fma_f32 v169, v205, s35, v169 mul:2
    v_mfma_f32_16x16x32_bf16 v[16:19], a[196:199], v[236:239], v[16:19]
    v_fma_f32 v170, v206, s35, v170 mul:2
    v_fma_f32 v171, v207, s35, v171 mul:2
    v_mfma_f32_16x16x32_bf16 v[20:23], a[200:203], v[236:239], v[20:23]
    ds_read_b128 v[236:239], v253 offset:22880
    v_cvt_pk_bf16_f32 v198, v208, v209
    v_mfma_f32_16x16x32_bf16 v[20:23], a[212:215], v[228:231], v[20:23]
    buffer_load_dwordx4 a[252:255], v254, s[8:11], s42 offen offset:0 sc1
    v_mfma_f32_16x16x32_bf16 v[20:23], a[224:227], v[232:235], v[20:23]
    v_cvt_pk_bf16_f32 v199, v210, v211
    v_accvgpr_read_b32 v204, a76
    v_mfma_f32_16x16x32_bf16 v[24:27], a[192:195], v[228:231], v[24:27]
    v_accvgpr_read_b32 v205, a77
    v_accvgpr_read_b32 v206, a78
    v_mfma_f32_16x16x32_bf16 v[24:27], a[204:207], v[232:235], v[24:27]
    s_waitcnt lgkmcnt(0)
    v_accvgpr_read_b32 v207, a79
    v_accvgpr_read_b32 v208, a172
    v_mfma_f32_16x16x32_bf16 v[24:27], a[216:219], v[236:239], v[24:27]
    v_accvgpr_read_b32 v209, a173
    v_accvgpr_read_b32 v210, a174
    v_mfma_f32_16x16x32_bf16 v[28:31], a[220:223], v[236:239], v[28:31]
    buffer_load_dwordx4 v[240:243], v254, s[8:11], s42 offen offset:1024 sc1
    v_mfma_f32_16x16x32_bf16 v[28:31], a[208:211], v[232:235], v[28:31]
    v_accvgpr_read_b32 v211, a175
    v_sub_f32 v204, v204, v208
    v_mfma_f32_16x16x32_bf16 v[28:31], a[196:199], v[228:231], v[28:31]
    v_sub_f32 v205, v205, v209
    v_sub_f32 v206, v206, v210
    v_sub_f32 v207, v207, v211
    v_mfma_f32_16x16x32_bf16 v[32:35], a[200:203], v[228:231], v[32:35]
    ds_read_b128 v[228:231], v253 offset:24704
    v_fma_f32 v208, v204, s34, v172 div:2
    v_mfma_f32_16x16x32_bf16 v[32:35], a[212:215], v[232:235], v[32:35]
    buffer_load_dwordx4 v[244:247], v254, s[8:11], s42 offen offset:2048 sc1
    v_mfma_f32_16x16x32_bf16 v[32:35], a[224:227], v[236:239], v[32:35]
    v_fma_f32 v209, v205, s34, v173 div:2
    v_fma_f32 v210, v206, s34, v174 div:2
    v_mfma_f32_16x16x32_bf16 v[36:39], a[192:195], v[232:235], v[36:39]
    v_fma_f32 v211, v207, s34, v175 div:2
    v_fma_f32 v172, v204, s35, v172 mul:2
    v_mfma_f32_16x16x32_bf16 v[36:39], a[204:207], v[236:239], v[36:39]
    s_waitcnt lgkmcnt(0)
    v_fma_f32 v173, v205, s35, v173 mul:2
    v_fma_f32 v174, v206, s35, v174 mul:2
    v_mfma_f32_16x16x32_bf16 v[36:39], a[216:219], v[228:231], v[36:39]
    buffer_store_dwordx4 a[116:119], v254, s[12:15], s44 offen nt
    s_add_u32 s44, s40, 205824
    v_mfma_f32_16x16x32_bf16 v[40:43], a[220:223], v[228:231], v[40:43]
    v_fma_f32 v175, v207, s35, v175 mul:2
    v_cvt_pk_bf16_f32 v200, v208, v209
    v_mfma_f32_16x16x32_bf16 v[40:43], a[208:211], v[236:239], v[40:43]
    v_cvt_pk_bf16_f32 v201, v210, v211
    v_accvgpr_read_b32 v204, a80
    v_mfma_f32_16x16x32_bf16 v[40:43], a[196:199], v[232:235], v[40:43]
    buffer_store_dwordx4 a[120:123], v254, s[12:15], s44 offen nt
    s_add_u32 s44, s40, 197632
    v_accvgpr_read_b32 v205, a81
    v_mfma_f32_16x16x32_bf16 v[44:47], a[200:203], v[232:235], v[44:47]
    ds_read_b128 v[232:235], v253 offset:24448
    v_accvgpr_read_b32 v206, a82
    v_accvgpr_read_b32 v207, a83
    v_mfma_f32_16x16x32_bf16 v[44:47], a[212:215], v[236:239], v[44:47]
    ds_write_b128 v248, v[198:201] offset:2304
    v_mfma_f32_16x16x32_bf16 v[44:47], a[224:227], v[228:231], v[44:47]
    v_accvgpr_read_b32 v208, a176
    v_accvgpr_read_b32 v209, a177
    v_mfma_f32_16x16x32_bf16 v[48:51], a[192:195], v[236:239], v[48:51]
    v_accvgpr_read_b32 v210, a178
    v_accvgpr_read_b32 v211, a179
    v_mfma_f32_16x16x32_bf16 v[48:51], a[204:207], v[228:231], v[48:51]
    s_waitcnt lgkmcnt(1)
    v_sub_f32 v204, v204, v208
    v_sub_f32 v205, v205, v209
    v_mfma_f32_16x16x32_bf16 v[48:51], a[216:219], v[232:235], v[48:51]
    v_sub_f32 v206, v206, v210
    v_sub_f32 v207, v207, v211
    v_mfma_f32_16x16x32_bf16 v[52:55], a[220:223], v[232:235], v[52:55]
    v_fma_f32 v208, v204, s34, v176 div:2
    v_fma_f32 v209, v205, s34, v177 div:2
    v_mfma_f32_16x16x32_bf16 v[52:55], a[208:211], v[228:231], v[52:55]
    v_fma_f32 v210, v206, s34, v178 div:2
    v_fma_f32 v211, v207, s34, v179 div:2
    v_mfma_f32_16x16x32_bf16 v[52:55], a[196:199], v[236:239], v[52:55]
    v_fma_f32 v176, v204, s35, v176 mul:2
    v_fma_f32 v177, v205, s35, v177 mul:2
    v_mfma_f32_16x16x32_bf16 v[56:59], a[200:203], v[236:239], v[56:59]
    ds_read_b128 v[236:239], v253 offset:24192
    v_fma_f32 v178, v206, s35, v178 mul:2
    v_mfma_f32_16x16x32_bf16 v[56:59], a[212:215], v[228:231], v[56:59]
    v_fma_f32 v179, v207, s35, v179 mul:2
    v_cvt_pk_bf16_f32 v202, v208, v209
    v_cvt_pk_bf16_f32 v203, v210, v211
    v_mfma_f32_16x16x32_bf16 v[56:59], a[224:227], v[232:235], v[56:59]
    ds_write_b64 v249, v[202:203] offset:2368
    v_mfma_f32_16x16x32_bf16 v[60:63], a[192:195], v[228:231], v[60:63]
    v_accvgpr_read_b32 v204, a180
    v_accvgpr_read_b32 v205, a181
    v_mfma_f32_16x16x32_bf16 v[60:63], a[204:207], v[232:235], v[60:63]
    s_waitcnt lgkmcnt(1)
    v_accvgpr_read_b32 v206, a182
    v_accvgpr_read_b32 v207, a183
    v_mfma_f32_16x16x32_bf16 v[60:63], a[216:219], v[236:239], v[60:63]
    v_fma_f32 v208, v204, s34, v180 div:2
    v_fma_f32 v209, v205, s34, v181 div:2
    v_mfma_f32_16x16x32_bf16 v[64:67], a[220:223], v[236:239], v[64:67]
    v_fma_f32 v210, v206, s34, v182 div:2
    v_fma_f32 v211, v207, s34, v183 div:2
    v_mfma_f32_16x16x32_bf16 v[64:67], a[208:211], v[232:235], v[64:67]
    v_fma_f32 v180, v204, s35, v180 mul:2
    v_fma_f32 v181, v205, s35, v181 mul:2
    v_mfma_f32_16x16x32_bf16 v[64:67], a[196:199], v[228:231], v[64:67]
    v_fma_f32 v182, v206, s35, v182 mul:2
    v_fma_f32 v183, v207, s35, v183 mul:2
    v_mfma_f32_16x16x32_bf16 v[68:71], a[200:203], v[228:231], v[68:71]
    ds_read_b128 v[228:231], v253 offset:23936
    v_cvt_pk_bf16_f32 v192, v208, v209
    v_mfma_f32_16x16x32_bf16 v[68:71], a[212:215], v[232:235], v[68:71]
    v_cvt_pk_bf16_f32 v193, v210, v211
    v_accvgpr_read_b32 v204, a184
    v_mfma_f32_16x16x32_bf16 v[68:71], a[224:227], v[236:239], v[68:71]
    v_accvgpr_read_b32 v205, a185
    v_accvgpr_read_b32 v206, a186
    v_accvgpr_read_b32 v207, a187
    v_mfma_f32_16x16x32_bf16 v[72:75], a[192:195], v[232:235], v[72:75]
    v_fma_f32 v208, v204, s34, v184 div:2
    v_fma_f32 v209, v205, s34, v185 div:2
    v_mfma_f32_16x16x32_bf16 v[72:75], a[204:207], v[236:239], v[72:75]
    s_waitcnt lgkmcnt(0)
    v_fma_f32 v210, v206, s34, v186 div:2
    v_fma_f32 v211, v207, s34, v187 div:2
    v_mfma_f32_16x16x32_bf16 v[72:75], a[216:219], v[228:231], v[72:75]
    v_fma_f32 v184, v204, s35, v184 mul:2
    v_fma_f32 v185, v205, s35, v185 mul:2
    v_mfma_f32_16x16x32_bf16 v[76:79], a[220:223], v[228:231], v[76:79]
    v_fma_f32 v186, v206, s35, v186 mul:2
    v_fma_f32 v187, v207, s35, v187 mul:2
    v_mfma_f32_16x16x32_bf16 v[76:79], a[208:211], v[236:239], v[76:79]
    v_cvt_pk_bf16_f32 v194, v208, v209
    v_cvt_pk_bf16_f32 v195, v210, v211
    v_mfma_f32_16x16x32_bf16 v[76:79], a[196:199], v[232:235], v[76:79]
    ds_write_b128 v248, v[192:195] offset:2688
    v_mfma_f32_16x16x32_bf16 v[80:83], a[200:203], v[232:235], v[80:83]
    ds_read_b128 v[232:235], v253 offset:23664
    v_accvgpr_read_b32 v204, a188
    v_mfma_f32_16x16x32_bf16 v[80:83], a[212:215], v[236:239], v[80:83]
    v_accvgpr_read_b32 v205, a189
    v_accvgpr_read_b32 v206, a190
    v_mfma_f32_16x16x32_bf16 v[80:83], a[224:227], v[228:231], v[80:83]
    s_mov_b32 s42, 1105920
    v_accvgpr_read_b32 v207, a191
    v_fma_f32 v208, v204, s34, v188 div:2
    v_mfma_f32_16x16x32_bf16 v[84:87], a[192:195], v[236:239], v[84:87]
    s_waitcnt lgkmcnt(0)
    v_fma_f32 v209, v205, s34, v189 div:2
    v_fma_f32 v210, v206, s34, v190 div:2
    v_fma_f32 v211, v207, s34, v191 div:2
    v_mfma_f32_16x16x32_bf16 v[88:91], a[196:199], v[236:239], v[88:91]
    s_barrier
    v_mfma_f32_16x16x32_bf16 v[92:95], a[200:203], v[236:239], v[92:95]
    ds_read_b128 v[236:239], v253 offset:34320
    v_fma_f32 v188, v204, s35, v188 mul:2
    v_mfma_f32_16x16x32_bf16 v[92:95], a[212:215], v[228:231], v[92:95]
    buffer_load_dwordx4 a[192:195], v254, s[8:11], s42 offen offset:0 sc1
    v_mfma_f32_16x16x32_bf16 v[88:91], a[208:211], v[228:231], v[88:91]
    v_fma_f32 v189, v205, s35, v189 mul:2
    v_fma_f32 v190, v206, s35, v190 mul:2
    v_mfma_f32_16x16x32_bf16 v[84:87], a[204:207], v[228:231], v[84:87]
    ds_read_b128 v[228:231], v253 offset:34048
    v_fma_f32 v191, v207, s35, v191 mul:2
    v_mfma_f32_16x16x32_bf16 v[84:87], a[216:219], v[232:235], v[84:87]
    buffer_load_dwordx4 a[196:199], v254, s[8:11], s42 offen offset:1024 sc1
    v_mfma_f32_16x16x32_bf16 v[88:91], a[220:223], v[232:235], v[88:91]
    s_waitcnt vmcnt(10) lgkmcnt(1)
    v_cvt_pk_bf16_f32 v196, v208, v209
    v_cvt_pk_bf16_f32 v197, v210, v211
    v_mfma_f32_16x16x32_bf16 v[92:95], a[224:227], v[232:235], v[92:95]
    ds_read_b128 v[232:235], v253 offset:33792
sub29:
    v_mfma_f32_16x16x32_bf16 v[0:3], a[228:231], v[236:239], v[0:3]
    buffer_load_dwordx4 a[200:203], v254, s[8:11], s42 offen offset:2048 sc1
    v_mfma_f32_16x16x32_bf16 v[4:7], a[232:235], v[236:239], v[4:7]
    s_mov_b32 s42, 1108992
    v_mfma_f32_16x16x32_bf16 v[8:11], a[236:239], v[236:239], v[8:11]
    ds_read_b128 v[236:239], v253 offset:33536
    s_waitcnt vmcnt(8)
    s_waitcnt lgkmcnt(2)
    v_mfma_f32_16x16x32_bf16 v[8:11], a[248:251], v[228:231], v[8:11]
pad11:
    s_cbranch_vccnz warm_ret
    ds_read_b128 a[124:127], v250 offset:1024
    v_mfma_f32_16x16x32_bf16 v[4:7], a[244:247], v[228:231], v[4:7]
    buffer_load_dwordx4 a[204:207], v254, s[8:11], s42 offen offset:0 sc1
    v_mfma_f32_16x16x32_bf16 v[0:3], a[240:243], v[228:231], v[0:3]
    s_waitcnt vmcnt(6) lgkmcnt(2)
    v_mfma_f32_16x16x32_bf16 v[0:3], a[252:255], v[232:235], v[0:3]
    ds_write_b64 v249, v[196:197] offset:2752
    v_mfma_f32_16x16x32_bf16 v[4:7], v[240:243], v[232:235], v[4:7]
    ds_read_b128 a[128:131], v250 offset:4128
    v_mfma_f32_16x16x32_bf16 v[8:11], v[244:247], v[232:235], v[8:11]
    buffer_load_dwordx4 a[208:211], v254, s[8:11], s42 offen offset:1024 sc1
    v_mfma_f32_16x16x32_bf16 v[12:15], a[228:231], v[228:231], v[12:15]
    ds_read_b128 a[132:135], v250 offset:7232
    s_waitcnt lgkmcnt(3)
    v_mfma_f32_16x16x32_bf16 v[12:15], a[240:243], v[232:235], v[12:15]
    v_mfma_f32_16x16x32_bf16 v[12:15], a[252:255], v[236:239], v[12:15]
    v_mfma_f32_16x16x32_bf16 v[16:19], v[240:243], v[236:239], v[16:19]
    buffer_load_dwordx4 a[212:215], v254, s[8:11], s42 offen offset:2048 sc1
    v_mfma_f32_16x16x32_bf16 v[16:19], a[244:247], v[232:235], v[16:19]
    s_mov_b32 s42, 1112064
    v_mfma_f32_16x16x32_bf16 v[16:19], a[232:235], v[228:231], v[16:19]
    buffer_store_dwordx4 a[124:127], v254, s[12:15], s44 offen nt
    s_add_u32 s44, s40, 200704
    s_waitcnt lgkmcnt(1)
    v_mfma_f32_16x16x32_bf16 v[20:23], a[236:239], v[228:231], v[20:23]
    ds_read_b128 v[228:231], v253 offset:33280
    v_mfma_f32_16x16x32_bf16 v[20:23], a[248:251], v[232:235], v[20:23]
    buffer_load_dwordx4 a[216:219], v254, s[8:11], s42 offen offset:0 sc1
    v_mfma_f32_16x16x32_bf16 v[20:23], v[244:247], v[236:239], v[20:23]
    ds_read_b128 a[136:139], v250 offset:10336
    v_mfma_f32_16x16x32_bf16 v[24:27], a[228:231], v[232:235], v[24:27]
    buffer_store_dwordx4 a[128:131], v254, s[12:15], s44 offen nt
    s_add_u32 s44, s40, 203776
    s_waitcnt lgkmcnt(2)
    v_mfma_f32_16x16x32_bf16 v[24:27], a[240:243], v[236:239], v[24:27]
    s_waitcnt lgkmcnt(1)
    v_mfma_f32_16x16x32_bf16 v[24:27], a[252:255], v[228:231], v[24:27]
    v_cvt_pk_bf16_f32 v8, v8, v9
    v_cvt_pk_bf16_f32 v9, v10, v11
    v_mfma_f32_16x16x32_bf16 v[28:31], v[240:243], v[228:231], v[28:31]
    buffer_load_dwordx4 a[220:223], v254, s[8:11], s42 offen offset:1024 sc1
    v_mfma_f32_16x16x32_bf16 v[28:31], a[244:247], v[236:239], v[28:31]
    ds_write_b64 v249, v[8:9] offset:12544
    v_mfma_f32_16x16x32_bf16 v[28:31], a[232:235], v[232:235], v[28:31]
    v_cvt_pk_bf16_f32 v0, v0, v1
    v_cvt_pk_bf16_f32 v1, v2, v3
    v_mfma_f32_16x16x32_bf16 v[32:35], a[236:239], v[232:235], v[32:35]
    ds_read_b128 v[232:235], v253 offset:35104
    v_cvt_pk_bf16_f32 v2, v4, v5
    v_mfma_f32_16x16x32_bf16 v[32:35], a[248:251], v[236:239], v[32:35]
    buffer_load_dwordx4 a[224:227], v254, s[8:11], s42 offen offset:2048 sc1
    v_mfma_f32_16x16x32_bf16 v[32:35], v[244:247], v[228:231], v[32:35]
    v_cvt_pk_bf16_f32 v3, v6, v7
    v_mov_b32 v4, v248
    v_mfma_f32_16x16x32_bf16 v[36:39], a[228:231], v[236:239], v[36:39]
    buffer_store_dwordx4 a[132:135], v254, s[12:15], s44 offen nt
    v_and_b32 v227, 0x7fff, v255
    v_mov_b32 v5, v249
    v_mfma_f32_16x16x32_bf16 v[36:39], a[240:243], v[228:231], v[36:39]
    s_waitcnt lgkmcnt(0)
    s_add_u32 s44, s40, 206848
    v_mov_b32 v6, v250
    v_mfma_f32_16x16x32_bf16 v[36:39], a[252:255], v[232:235], v[36:39]
    buffer_load_dwordx2 v[216:217], v227, s[4:7], s16 offen offset:0
    v_mfma_f32_16x16x32_bf16 v[40:43], v[240:243], v[232:235], v[40:43]
    ds_write_b128 v248, v[0:3] offset:12480
    v_mfma_f32_16x16x32_bf16 v[40:43], a[244:247], v[228:231], v[40:43]
    v_cvt_pk_bf16_f32 v20, v20, v21
    v_cvt_pk_bf16_f32 v21, v22, v23
    v_mfma_f32_16x16x32_bf16 v[40:43], a[232:235], v[236:239], v[40:43]
    v_cvt_pk_bf16_f32 v12, v12, v13
    v_cvt_pk_bf16_f32 v13, v14, v15
    v_mfma_f32_16x16x32_bf16 v[44:47], a[236:239], v[236:239], v[44:47]
    ds_read_b128 v[236:239], v253 offset:34848
    v_cvt_pk_bf16_f32 v14, v16, v17
    v_mfma_f32_16x16x32_bf16 v[44:47], a[248:251], v[228:231], v[44:47]
    buffer_load_dwordx2 v[218:219], v227, s[4:7], s17 offen offset:0
    v_mfma_f32_16x16x32_bf16 v[44:47], v[244:247], v[232:235], v[44:47]
    ds_write_b64 v5, v[20:21] offset:12928
    v_mfma_f32_16x16x32_bf16 v[48:51], a[228:231], v[228:231], v[48:51]
    v_cvt_pk_bf16_f32 v15, v18, v19
    v_cvt_pk_bf16_f32 v32, v32, v33
    v_mfma_f32_16x16x32_bf16 v[48:51], a[240:243], v[232:235], v[48:51]
    s_waitcnt lgkmcnt(1)
    v_cvt_pk_bf16_f32 v33, v34, v35
    v_cvt_pk_bf16_f32 v24, v24, v25
    v_mfma_f32_16x16x32_bf16 v[48:51], a[252:255], v[236:239], v[48:51]
    buffer_load_dwordx2 v[220:221], v227, s[4:7], s18 offen offset:0
    v_mfma_f32_16x16x32_bf16 v[52:55], v[240:243], v[236:239], v[52:55]
    ds_write_b128 v4, v[12:15] offset:12864
    v_mfma_f32_16x16x32_bf16 v[52:55], a[244:247], v[232:235], v[52:55]
    v_cvt_pk_bf16_f32 v25, v26, v27
    v_cvt_pk_bf16_f32 v26, v28, v29
    v_mfma_f32_16x16x32_bf16 v[52:55], a[232:235], v[228:231], v[52:55]
    v_cvt_pk_bf16_f32 v27, v30, v31
    v_cvt_pk_bf16_f32 v44, v44, v45
    v_mfma_f32_16x16x32_bf16 v[56:59], a[236:239], v[228:231], v[56:59]
    ds_read_b128 v[228:231], v253 offset:34592
    v_cvt_pk_bf16_f32 v45, v46, v47
    v_mfma_f32_16x16x32_bf16 v[56:59], a[248:251], v[232:235], v[56:59]
    buffer_load_dwordx2 v[222:223], v227, s[4:7], s19 offen offset:0
    v_mfma_f32_16x16x32_bf16 v[56:59], v[244:247], v[236:239], v[56:59]
    ds_write_b64 v5, v[32:33] offset:13312
    v_mfma_f32_16x16x32_bf16 v[60:63], a[228:231], v[232:235], v[60:63]
    v_cvt_pk_bf16_f32 v36, v36, v37
    v_cvt_pk_bf16_f32 v37, v38, v39
    v_mfma_f32_16x16x32_bf16 v[60:63], a[240:243], v[236:239], v[60:63]
    s_waitcnt lgkmcnt(1)
    v_cvt_pk_bf16_f32 v38, v40, v41
    v_cvt_pk_bf16_f32 v39, v42, v43
    v_mfma_f32_16x16x32_bf16 v[60:63], a[252:255], v[228:231], v[60:63]
    buffer_load_dwordx2 v[224:225], v227, s[4:7], s20 offen offset:0
    v_mfma_f32_16x16x32_bf16 v[64:67], v[240:243], v[228:231], v[64:67]
    ds_write_b128 v4, v[24:27] offset:13248
    v_mfma_f32_16x16x32_bf16 v[64:67], a[244:247], v[236:239], v[64:67]
    v_mfma_f32_16x16x32_bf16 v[64:67], a[232:235], v[232:235], v[64:67]
    v_cvt_pk_bf16_f32 v56, v56, v57
    v_cvt_pk_bf16_f32 v57, v58, v59
    v_mfma_f32_16x16x32_bf16 v[68:71], a[236:239], v[232:235], v[68:71]
    ds_read_b128 v[232:235], v253 offset:34336
    v_cvt_pk_bf16_f32 v48, v48, v49
    v_mfma_f32_16x16x32_bf16 v[68:71], a[248:251], v[236:239], v[68:71]
    buffer_load_dwordx2 v[226:227], v227, s[4:7], s21 offen offset:0
    v_mfma_f32_16x16x32_bf16 v[68:71], v[244:247], v[228:231], v[68:71]
    ds_write_b64 v5, v[44:45] offset:13696
    v_mfma_f32_16x16x32_bf16 v[72:75], a[228:231], v[236:239], v[72:75]
    buffer_store_dwordx4 a[136:139], v254, s[12:15], s44 offen nt
    s_add_u32 s44, s40, 198656
    v_cvt_pk_bf16_f32 v49, v50, v51
    v_mfma_f32_16x16x32_bf16 v[72:75], a[240:243], v[228:231], v[72:75]
    s_waitcnt lgkmcnt(1)
    v_cvt_pk_bf16_f32 v50, v52, v53
    v_cvt_pk_bf16_f32 v51, v54, v55
    v_mfma_f32_16x16x32_bf16 v[72:75], a[252:255], v[232:235], v[72:75]
    ds_write_b128 v4, v[36:39] offset:13632
    v_mfma_f32_16x16x32_bf16 v[76:79], v[240:243], v[232:235], v[76:79]
    v_mfma_f32_16x16x32_bf16 v[76:79], a[244:247], v[228:231], v[76:79]
    v_mfma_f32_16x16x32_bf16 v[76:79], a[232:235], v[236:239], v[76:79]
    v_cvt_pk_bf16_f32 v68, v68, v69
    v_cvt_pk_bf16_f32 v69, v70, v71
    v_mfma_f32_16x16x32_bf16 v[80:83], a[236:239], v[236:239], v[80:83]
    ds_read_b128 v[236:239], v253 offset:34064
    v_cvt_pk_bf16_f32 v60, v60, v61
    v_mfma_f32_16x16x32_bf16 v[80:83], a[248:251], v[228:231], v[80:83]
    v_cvt_pk_bf16_f32 v61, v62, v63
    v_cvt_pk_bf16_f32 v62, v64, v65
    v_mfma_f32_16x16x32_bf16 v[80:83], v[244:247], v[232:235], v[80:83]
    s_mov_b32 s42, 1142784
    v_cvt_pk_bf16_f32 v63, v66, v67
    v_mfma_f32_16x16x32_bf16 v[84:87], a[228:231], v[228:231], v[84:87]
    s_waitcnt lgkmcnt(0)
    v_mfma_f32_16x16x32_bf16 v[88:91], a[232:235], v[228:231], v[88:91]
    s_barrier
    v_mfma_f32_16x16x32_bf16 v[92:95], a[236:239], v[228:231], v[92:95]
    ds_read_b128 v[228:231], v253 offset:36400
    v_mfma_f32_16x16x32_bf16 v[92:95], a[248:251], v[232:235], v[92:95]
    buffer_load_dwordx4 a[228:231], v254, s[8:11], s42 offen offset:0 sc1
    v_mfma_f32_16x16x32_bf16 v[88:91], a[244:247], v[232:235], v[88:91]
    v_mfma_f32_16x16x32_bf16 v[84:87], a[240:243], v[232:235], v[84:87]
    ds_read_b128 v[232:235], v253 offset:36128
    v_cvt_pk_bf16_f32 v80, v80, v81
    v_mfma_f32_16x16x32_bf16 v[84:87], a[252:255], v[236:239], v[84:87]
    buffer_load_dwordx4 a[232:235], v254, s[8:11], s42 offen offset:1024 sc1
    v_mfma_f32_16x16x32_bf16 v[88:91], v[240:243], v[236:239], v[88:91]
    s_waitcnt vmcnt(18) lgkmcnt(1)
    v_cvt_pk_bf16_f32 v81, v82, v83
    v_cvt_pk_bf16_f32 v72, v72, v73
    v_mfma_f32_16x16x32_bf16 v[92:95], v[244:247], v[236:239], v[92:95]
    ds_read_b128 v[236:239], v253 offset:35872
    v_cvt_pk_bf16_f32 v73, v74, v75
sub30:
    v_mfma_f32_16x16x32_bf16 v[96:99], a[192:195], v[228:231], v[96:99]
    buffer_load_dwordx4 a[236:239], v254, s[8:11], s42 offen offset:2048 sc1
    v_mfma_f32_16x16x32_bf16 v[100:103], a[196:199], v[228:231], v[100:103]
    s_mov_b32 s42, 1145856
    v_cvt_pk_bf16_f32 v74, v76, v77
    v_cvt_pk_bf16_f32 v75, v78, v79
    v_mfma_f32_16x16x32_bf16 v[104:107], a[200:203], v[228:231], v[104:107]
    ds_read_b128 v[228:231], v253 offset:35616
    s_waitcnt vmcnt(16)
    s_waitcnt lgkmcnt(2)
    v_mfma_f32_16x16x32_bf16 v[104:107], a[212:215], v[232:235], v[104:107]
    ds_read_b128 a[140:143], v6 offset:2048
    v_mfma_f32_16x16x32_bf16 v[100:103], a[208:211], v[232:235], v[100:103]
    buffer_load_dwordx4 a[240:243], v254, s[8:11], s42 offen offset:0 sc1
    v_mfma_f32_16x16x32_bf16 v[96:99], a[204:207], v[232:235], v[96:99]
    s_waitcnt vmcnt(12) lgkmcnt(2)
    v_cvt_pk_bf16_f32 v92, v92, v93
    v_cvt_pk_bf16_f32 v93, v94, v95
    v_mfma_f32_16x16x32_bf16 v[96:99], a[216:219], v[236:239], v[96:99]
    v_cvt_pk_bf16_f32 v84, v84, v85
    v_cvt_pk_bf16_f32 v85, v86, v87
    v_mfma_f32_16x16x32_bf16 v[100:103], a[220:223], v[236:239], v[100:103]
    ds_read_b128 a[144:147], v6 offset:5152
    v_cvt_pk_bf16_f32 v86, v88, v89
    v_mfma_f32_16x16x32_bf16 v[104:107], a[224:227], v[236:239], v[104:107]
    buffer_load_dwordx4 a[244:247], v254, s[8:11], s42 offen offset:1024 sc1
    v_mfma_f32_16x16x32_bf16 v[108:111], a[192:195], v[232:235], v[108:111]
    s_waitcnt lgkmcnt(1)
    v_cvt_pk_bf16_f32 v87, v90, v91
    v_mfma_f32_16x16x32_bf16 v[108:111], a[204:207], v[236:239], v[108:111]
    v_mfma_f32_16x16x32_bf16 v[108:111], a[216:219], v[228:231], v[108:111]
    ds_write_b64 v5, v[56:57] offset:14080
    v_mfma_f32_16x16x32_bf16 v[112:115], a[220:223], v[228:231], v[112:115]
    buffer_load_dwordx4 a[248:251], v254, s[8:11], s42 offen offset:2048 sc1
    v_mfma_f32_16x16x32_bf16 v[112:115], a[208:211], v[236:239], v[112:115]
    s_mov_b32 s42, 1148928
    v_mfma_f32_16x16x32_bf16 v[112:115], a[196:199], v[232:235], v[112:115]
    buffer_store_dwordx4 a[140:143], v254, s[12:15], s44 offen nt
    s_add_u32 s44, s40, 201728
    s_waitcnt lgkmcnt(1)
    v_mfma_f32_16x16x32_bf16 v[116:119], a[200:203], v[232:235], v[116:119]
    ds_read_b128 v[232:235], v253 offset:35360
    v_mfma_f32_16x16x32_bf16 v[116:119], a[212:215], v[236:239], v[116:119]
    buffer_load_dwordx4 a[252:255], v254, s[8:11], s42 offen offset:0 sc1
    v_mfma_f32_16x16x32_bf16 v[116:119], a[224:227], v[228:231], v[116:119]
    ds_read_b128 a[148:151], v6 offset:8256
    v_mfma_f32_16x16x32_bf16 v[120:123], a[192:195], v[236:239], v[120:123]
    v_mfma_f32_16x16x32_bf16 v[120:123], a[204:207], v[228:231], v[120:123]
    s_waitcnt lgkmcnt(1)
    v_mfma_f32_16x16x32_bf16 v[120:123], a[216:219], v[232:235], v[120:123]
    ds_write_b128 v4, v[48:51] offset:14016
    v_mfma_f32_16x16x32_bf16 v[124:127], a[220:223], v[232:235], v[124:127]
    buffer_load_dwordx4 v[240:243], v254, s[8:11], s42 offen offset:1024 sc1
    v_mfma_f32_16x16x32_bf16 v[124:127], a[208:211], v[228:231], v[124:127]
    ds_read_b128 a[152:155], v6 offset:11360
    v_mfma_f32_16x16x32_bf16 v[124:127], a[196:199], v[236:239], v[124:127]
    v_mfma_f32_16x16x32_bf16 v[128:131], a[200:203], v[236:239], v[128:131]
    ds_read_b128 v[236:239], v253 offset:37184
    v_mfma_f32_16x16x32_bf16 v[128:131], a[212:215], v[228:231], v[128:131]
    buffer_load_dwordx4 v[244:247], v254, s[8:11], s42 offen offset:2048 sc1
    v_mfma_f32_16x16x32_bf16 v[128:131], a[224:227], v[232:235], v[128:131]
    ds_write_b64 v5, v[68:69] offset:14464
    v_mfma_f32_16x16x32_bf16 v[132:135], a[192:195], v[228:231], v[132:135]
    buffer_store_dwordx4 a[144:147], v254, s[12:15], s44 offen nt
    v_and_b32 v203, 0x7fff, v255
    s_waitcnt vmcnt(12)
    v_mfma_f32_16x16x32_bf16 v[132:135], a[204:207], v[232:235], v[132:135]
    s_waitcnt lgkmcnt(1)
    v_lshlrev_b32 v248, 16, v218
    v_lshlrev_b32 v249, 16, v220
    v_mfma_f32_16x16x32_bf16 v[132:135], a[216:219], v[236:239], v[132:135]
    buffer_load_dwordx2 v[192:193], v203, s[4:7], s16 offen offset:384
    v_mfma_f32_16x16x32_bf16 v[136:139], a[220:223], v[236:239], v[136:139]
    s_add_u32 s44, s40, 204800
    v_lshlrev_b32 v250, 16, v222
    v_lshlrev_b32 v251, 16, v224
    v_mfma_f32_16x16x32_bf16 v[136:139], a[208:211], v[232:235], v[136:139]
    ds_write_b128 v4, v[60:63] offset:14400
    v_mfma_f32_16x16x32_bf16 v[136:139], a[196:199], v[228:231], v[136:139]
    v_and_b32 v218, s22, v218
    v_and_b32 v220, s22, v220
    v_mfma_f32_16x16x32_bf16 v[140:143], a[200:203], v[228:231], v[140:143]
    ds_read_b128 v[228:231], v253 offset:36928
    v_and_b32 v222, s22, v222
    v_mfma_f32_16x16x32_bf16 v[140:143], a[212:215], v[232:235], v[140:143]
    buffer_load_dwordx2 v[194:195], v203, s[4:7], s17 offen offset:384
    v_mfma_f32_16x16x32_bf16 v[140:143], a[224:227], v[236:239], v[140:143]
    ds_write_b64 v5, v[80:81] offset:14848
    v_mfma_f32_16x16x32_bf16 v[144:147], a[192:195], v[232:235], v[144:147]
    v_and_b32 v224, s22, v224
    v_lshlrev_b32 v252, 16, v216
    v_mfma_f32_16x16x32_bf16 v[144:147], a[204:207], v[236:239], v[144:147]
    s_waitcnt lgkmcnt(1)
    v_and_b32 v216, s22, v216
    v_fmac_f32 v252, s25, v251
    v_mfma_f32_16x16x32_bf16 v[144:147], a[216:219], v[228:231], v[144:147]
    buffer_load_dwordx2 v[196:197], v203, s[4:7], s18 offen offset:384
    v_mfma_f32_16x16x32_bf16 v[148:151], a[220:223], v[228:231], v[148:151]
    v_fmac_f32 v216, s25, v224
    v_fmac_f32 v252, s28, v249
    v_mfma_f32_16x16x32_bf16 v[148:151], a[208:211], v[236:239], v[148:151]
    ds_write_b128 v4, v[72:75] offset:14784
    v_mfma_f32_16x16x32_bf16 v[148:151], a[196:199], v[232:235], v[148:151]
    v_fmac_f32 v216, s28, v220
    v_cvt_pk_bf16_f32 v216, v252, v216
    v_mfma_f32_16x16x32_bf16 v[152:155], a[200:203], v[232:235], v[152:155]
    ds_read_b128 v[232:235], v253 offset:36672
    v_lshlrev_b32 v252, 16, v226
    v_mfma_f32_16x16x32_bf16 v[152:155], a[212:215], v[236:239], v[152:155]
    buffer_load_dwordx2 v[198:199], v203, s[4:7], s19 offen offset:384
    v_mfma_f32_16x16x32_bf16 v[152:155], a[224:227], v[228:231], v[152:155]
    ds_write_b64 v5, v[92:93] offset:15232
    v_mfma_f32_16x16x32_bf16 v[156:159], a[192:195], v[236:239], v[156:159]
    v_and_b32 v226, s22, v226
    v_fmac_f32 v252, s29, v248
    v_mfma_f32_16x16x32_bf16 v[156:159], a[204:207], v[228:231], v[156:159]
    s_waitcnt lgkmcnt(1)
    v_fmac_f32 v226, s29, v218
    v_fmac_f32 v252, s23, v250
    v_mfma_f32_16x16x32_bf16 v[156:159], a[216:219], v[232:235], v[156:159]
    buffer_load_dwordx2 v[200:201], v203, s[4:7], s20 offen offset:384
    v_mfma_f32_16x16x32_bf16 v[160:163], a[220:223], v[232:235], v[160:163]
    ds_write_b128 v4, v[84:87] offset:15168
    v_mfma_f32_16x16x32_bf16 v[160:163], a[208:211], v[228:231], v[160:163]
    v_fmac_f32 v226, s23, v222
    v_cvt_pk_bf16_f32 v226, v252, v226
    v_mfma_f32_16x16x32_bf16 v[160:163], a[196:199], v[236:239], v[160:163]
    v_fma_f32 v252, v249, s24, v251
    v_fmac_f32 v251, -4.0, v249
    v_mfma_f32_16x16x32_bf16 v[164:167], a[200:203], v[236:239], v[164:167]
    ds_read_b128 v[236:239], v253 offset:36416
    v_fma_f32 v249, v248, s24, v250
    v_mfma_f32_16x16x32_bf16 v[164:167], a[212:215], v[228:231], v[164:167]
    buffer_load_dwordx2 v[202:203], v203, s[4:7], s21 offen offset:384
    v_mfma_f32_16x16x32_bf16 v[164:167], a[224:227], v[232:235], v[164:167]
    v_fmac_f32 v250, -4.0, v248
    v_fma_f32 v248, v250, s26, v251
    v_mfma_f32_16x16x32_bf16 v[168:171], a[192:195], v[228:231], v[168:171]
    buffer_store_dwordx4 a[148:151], v254, s[12:15], s44 offen nt
    s_add_u32 s44, s40, 207872
    v_fmac_f32 v251, s27, v250
    v_mfma_f32_16x16x32_bf16 v[168:171], a[204:207], v[232:235], v[168:171]
    s_waitcnt lgkmcnt(0)
    v_fma_f32 v250, v249, 2.0, v252
    v_fmac_f32 v252, -2.0, v249
    v_mfma_f32_16x16x32_bf16 v[168:171], a[216:219], v[236:239], v[168:171]
    v_fma_f32 v249, v220, s24, v224
    v_fmac_f32 v224, -4.0, v220
    v_mfma_f32_16x16x32_bf16 v[172:175], a[220:223], v[236:239], v[172:175]
    v_fma_f32 v220, v218, s24, v222
    v_fmac_f32 v222, -4.0, v218
    v_mfma_f32_16x16x32_bf16 v[172:175], a[208:211], v[232:235], v[172:175]
    v_fma_f32 v218, v222, s26, v224
    v_fmac_f32 v224, s27, v222
    v_mfma_f32_16x16x32_bf16 v[172:175], a[196:199], v[228:231], v[172:175]
    v_fma_f32 v222, v220, 2.0, v249
    v_fmac_f32 v249, -2.0, v220
    v_mfma_f32_16x16x32_bf16 v[176:179], a[200:203], v[228:231], v[176:179]
    ds_read_b128 v[228:231], v253 offset:36144
    v_cvt_pk_bf16_f32 v218, v248, v218
    v_mfma_f32_16x16x32_bf16 v[176:179], a[212:215], v[232:235], v[176:179]
    v_cvt_pk_bf16_f32 v224, v251, v224
    v_cvt_pk_bf16_f32 v222, v250, v222
    v_mfma_f32_16x16x32_bf16 v[176:179], a[224:227], v[236:239], v[176:179]
    s_mov_b32 s42, 1179648
    v_cvt_pk_bf16_f32 v220, v252, v249
    v_mfma_f32_16x16x32_bf16 v[180:183], a[192:195], v[232:235], v[180:183]
    s_waitcnt lgkmcnt(0)
    v_lshlrev_b32 v248, 16, v219
    v_lshlrev_b32 v249, 16, v221
    v_mfma_f32_16x16x32_bf16 v[184:187], a[196:199], v[232:235], v[184:187]
    s_barrier
    v_mfma_f32_16x16x32_bf16 v[188:191], a[200:203], v[232:235], v[188:191]
    ds_read_b128 v[232:235], v253 offset:38480
    v_lshlrev_b32 v250, 16, v223
    v_mfma_f32_16x16x32_bf16 v[188:191], a[212:215], v[236:239], v[188:191]
    buffer_load_dwordx4 a[192:195], v254, s[8:11], s42 offen offset:0 sc1
    v_mfma_f32_16x16x32_bf16 v[184:187], a[208:211], v[236:239], v[184:187]
    v_lshlrev_b32 v251, 16, v225
    v_and_b32 v219, s22, v219
    v_mfma_f32_16x16x32_bf16 v[180:183], a[204:207], v[236:239], v[180:183]
    ds_read_b128 v[236:239], v253 offset:38208
    v_and_b32 v221, s22, v221
    v_mfma_f32_16x16x32_bf16 v[180:183], a[216:219], v[228:231], v[180:183]
    buffer_load_dwordx4 a[196:199], v254, s[8:11], s42 offen offset:1024 sc1
    v_mfma_f32_16x16x32_bf16 v[184:187], a[220:223], v[228:231], v[184:187]
    s_waitcnt vmcnt(17) lgkmcnt(1)
    v_and_b32 v223, s22, v223
    v_and_b32 v225, s22, v225
    v_mfma_f32_16x16x32_bf16 v[188:191], a[224:227], v[228:231], v[188:191]
    ds_read_b128 v[228:231], v253 offset:37952
    v_lshlrev_b32 v252, 16, v217
sub31:
    v_mfma_f32_16x16x32_bf16 v[96:99], a[228:231], v[232:235], v[96:99]
    buffer_load_dwordx4 a[200:203], v254, s[8:11], s42 offen offset:2048 sc1
    v_mfma_f32_16x16x32_bf16 v[100:103], a[232:235], v[232:235], v[100:103]
    s_mov_b32 s42, 1182720
    v_and_b32 v217, s22, v217
    v_fmac_f32 v252, s25, v251
    v_mfma_f32_16x16x32_bf16 v[104:107], a[236:239], v[232:235], v[104:107]
    ds_read_b128 v[232:235], v253 offset:37696
    s_waitcnt vmcnt(15)
    s_waitcnt lgkmcnt(2)
    v_mfma_f32_16x16x32_bf16 v[104:107], a[248:251], v[236:239], v[104:107]
    ds_read_b128 a[0:3], v6 offset:12480
    v_fmac_f32 v217, s25, v225
    v_mfma_f32_16x16x32_bf16 v[100:103], a[244:247], v[236:239], v[100:103]
    buffer_load_dwordx4 a[204:207], v254, s[8:11], s42 offen offset:0 sc1
    v_mfma_f32_16x16x32_bf16 v[96:99], a[240:243], v[236:239], v[96:99]
    s_waitcnt vmcnt(12) lgkmcnt(2)
    v_fmac_f32 v252, s28, v249
    v_fmac_f32 v217, s28, v221
    v_mfma_f32_16x16x32_bf16 v[96:99], a[252:255], v[228:231], v[96:99]
    buffer_store_dwordx4 a[152:155], v254, s[12:15], s44 offen nt
    v_cvt_pk_bf16_f32 v217, v252, v217
    v_lshlrev_b32 v252, 16, v227
    v_mfma_f32_16x16x32_bf16 v[100:103], v[240:243], v[228:231], v[100:103]
    v_and_b32 v227, s22, v227
    v_fmac_f32 v252, s29, v248
    v_mfma_f32_16x16x32_bf16 v[104:107], v[244:247], v[228:231], v[104:107]
    buffer_load_dwordx4 a[208:211], v254, s[8:11], s42 offen offset:1024 sc1
    v_mfma_f32_16x16x32_bf16 v[108:111], a[228:231], v[236:239], v[108:111]
    ds_read_b128 a[4:7], v6 offset:13504
    s_add_u32 s44, s40, 0
    v_mfma_f32_16x16x32_bf16 v[108:111], a[240:243], v[228:231], v[108:111]
    s_waitcnt lgkmcnt(2)
    v_fmac_f32 v227, s29, v219
    v_fmac_f32 v252, s23, v250
    v_mfma_f32_16x16x32_bf16 v[108:111], a[252:255], v[232:235], v[108:111]
    v_fmac_f32 v227, s23, v223
    v_cvt_pk_bf16_f32 v227, v252, v227
    v_mfma_f32_16x16x32_bf16 v[112:115], v[240:243], v[232:235], v[112:115]
    buffer_load_dwordx4 a[212:215], v254, s[8:11], s42 offen offset:2048 sc1
    v_mfma_f32_16x16x32_bf16 v[112:115], a[244:247], v[228:231], v[112:115]
    s_mov_b32 s42, 1185792
    v_fma_f32 v252, v249, s24, v251
    v_fmac_f32 v251, -4.0, v249
    v_mfma_f32_16x16x32_bf16 v[112:115], a[232:235], v[236:239], v[112:115]
    s_waitcnt lgkmcnt(1)
    v_fma_f32 v249, v248, s24, v250
    v_mfma_f32_16x16x32_bf16 v[116:119], a[236:239], v[236:239], v[116:119]
    ds_read_b128 v[236:239], v253 offset:37440
    v_fmac_f32 v250, -4.0, v248
    v_mfma_f32_16x16x32_bf16 v[116:119], a[248:251], v[228:231], v[116:119]
    buffer_load_dwordx4 a[216:219], v254, s[8:11], s42 offen offset:0 sc1
    v_mfma_f32_16x16x32_bf16 v[116:119], v[244:247], v[232:235], v[116:119]
    v_fma_f32 v248, v250, s26, v251
    v_fmac_f32 v251, s27, v250
    v_mfma_f32_16x16x32_bf16 v[120:123], a[228:231], v[228:231], v[120:123]
    v_fma_f32 v250, v249, 2.0, v252
    v_fmac_f32 v252, -2.0, v249
    v_mfma_f32_16x16x32_bf16 v[120:123], a[240:243], v[232:235], v[120:123]
    s_waitcnt lgkmcnt(0)
    v_fma_f32 v249, v221, s24, v225
    v_fmac_f32 v225, -4.0, v221
    v_mfma_f32_16x16x32_bf16 v[120:123], a[252:255], v[236:239], v[120:123]
    v_fma_f32 v221, v219, s24, v223
    v_fmac_f32 v223, -4.0, v219
    v_mfma_f32_16x16x32_bf16 v[124:127], v[240:243], v[236:239], v[124:127]
    buffer_load_dwordx4 a[220:223], v254, s[8:11], s42 offen offset:1024 sc1
    v_mfma_f32_16x16x32_bf16 v[124:127], a[244:247], v[232:235], v[124:127]
    ds_read_b128 a[8:11], v6 offset:14528
    v_fma_f32 v219, v223, s26, v225
    v_mfma_f32_16x16x32_bf16 v[124:127], a[232:235], v[228:231], v[124:127]
    v_fmac_f32 v225, s27, v223
    v_fma_f32 v223, v221, 2.0, v249
    v_mfma_f32_16x16x32_bf16 v[128:131], a[236:239], v[228:231], v[128:131]
    ds_read_b128 v[228:231], v253 offset:39264
    v_fmac_f32 v249, -2.0, v221
    v_mfma_f32_16x16x32_bf16 v[128:131], a[248:251], v[232:235], v[128:131]
    buffer_load_dwordx4 a[224:227], v254, s[8:11], s42 offen offset:2048 sc1
    v_mfma_f32_16x16x32_bf16 v[128:131], v[244:247], v[236:239], v[128:131]
    v_cvt_pk_bf16_f32 v219, v248, v219
    v_cvt_pk_bf16_f32 v225, v251, v225
    v_mfma_f32_16x16x32_bf16 v[132:135], a[228:231], v[232:235], v[132:135]
    buffer_store_dwordx4 a[0:3], v254, s[12:15], s44 offen nt
    v_and_b32 v215, 0x7fff, v255
    v_cvt_pk_bf16_f32 v223, v250, v223
    v_mfma_f32_16x16x32_bf16 v[132:135], a[240:243], v[236:239], v[132:135]
    s_waitcnt lgkmcnt(0)
    s_add_u32 s44, s40, 1024
    v_cvt_pk_bf16_f32 v221, v252, v249
    v_mfma_f32_16x16x32_bf16 v[132:135], a[252:255], v[228:231], v[132:135]
    buffer_load_dwordx2 v[204:205], v215, s[4:7], s16 offen offset:768
    v_mfma_f32_16x16x32_bf16 v[136:139], v[240:243], v[228:231], v[136:139]
    v_lshrrev_b32 v252, 15, v255
    v_mfma_f32_16x16x32_bf16 v[136:139], a[244:247], v[236:239], v[136:139]
    ds_write_b64 v252, v[218:219] offset:768
    v_mfma_f32_16x16x32_bf16 v[136:139], a[232:235], v[232:235], v[136:139]
    s_waitcnt vmcnt(13)
    v_lshrrev_b32 v218, 15, v255
    v_lshlrev_b32 v248, 16, v194
    v_mfma_f32_16x16x32_bf16 v[140:143], a[236:239], v[232:235], v[140:143]
    ds_read_b128 v[232:235], v253 offset:39008
    v_lshlrev_b32 v249, 16, v196
    v_mfma_f32_16x16x32_bf16 v[140:143], a[248:251], v[236:239], v[140:143]
    buffer_load_dwordx2 v[206:207], v215, s[4:7], s17 offen offset:768
    v_mfma_f32_16x16x32_bf16 v[140:143], v[244:247], v[228:231], v[140:143]
    v_lshlrev_b32 v250, 16, v198
    v_lshlrev_b32 v251, 16, v200
    v_mfma_f32_16x16x32_bf16 v[144:147], a[228:231], v[236:239], v[144:147]
    ds_read_b128 a[12:15], v6 offset:15584
    v_and_b32 v194, s22, v194
    v_mfma_f32_16x16x32_bf16 v[144:147], a[240:243], v[228:231], v[144:147]
    s_waitcnt lgkmcnt(1)
    v_and_b32 v196, s22, v196
    v_and_b32 v198, s22, v198
    v_mfma_f32_16x16x32_bf16 v[144:147], a[252:255], v[232:235], v[144:147]
    buffer_load_dwordx2 v[208:209], v215, s[4:7], s18 offen offset:768
    v_mfma_f32_16x16x32_bf16 v[148:151], v[240:243], v[232:235], v[148:151]
    ds_write_b64 v218, v[224:225] offset:2848
    v_mfma_f32_16x16x32_bf16 v[148:151], a[244:247], v[228:231], v[148:151]
    v_and_b32 v200, s22, v200
    v_lshlrev_b32 v252, 16, v192
    v_mfma_f32_16x16x32_bf16 v[148:151], a[232:235], v[236:239], v[148:151]
    ds_write_b64 v218, v[222:223] offset:4928
    v_mfma_f32_16x16x32_bf16 v[152:155], a[236:239], v[236:239], v[152:155]
    ds_read_b128 v[236:239], v253 offset:38752
    v_and_b32 v192, s22, v192
    v_mfma_f32_16x16x32_bf16 v[152:155], a[248:251], v[228:231], v[152:155]
    buffer_load_dwordx2 v[210:211], v215, s[4:7], s19 offen offset:768
    v_mfma_f32_16x16x32_bf16 v[152:155], v[244:247], v[232:235], v[152:155]
    ds_write_b64 v218, v[216:217] offset:34048
    v_mfma_f32_16x16x32_bf16 v[156:159], a[228:231], v[228:231], v[156:159]
    v_fmac_f32 v252, s25, v251
    v_fmac_f32 v192, s25, v200
    v_mfma_f32_16x16x32_bf16 v[156:159], a[240:243], v[232:235], v[156:159]
    s_waitcnt lgkmcnt(1)
    v_fmac_f32 v252, s28, v249
    v_fmac_f32 v192, s28, v196
    v_mfma_f32_16x16x32_bf16 v[156:159], a[252:255], v[236:239], v[156:159]
    buffer_load_dwordx2 v[212:213], v215, s[4:7], s20 offen offset:768
    v_mfma_f32_16x16x32_bf16 v[160:163], v[240:243], v[236:239], v[160:163]
    ds_write_b64 v218, v[226:227] offset:36128
    v_mfma_f32_16x16x32_bf16 v[160:163], a[244:247], v[232:235], v[160:163]
    v_cvt_pk_bf16_f32 v192, v252, v192
    v_lshlrev_b32 v252, 16, v202
    v_mfma_f32_16x16x32_bf16 v[160:163], a[232:235], v[228:231], v[160:163]
    ds_read_b128 a[16:19], v6 offset:16608
    v_and_b32 v202, s22, v202
    v_mfma_f32_16x16x32_bf16 v[164:167], a[236:239], v[228:231], v[164:167]
    ds_read_b128 v[228:231], v253 offset:38496
    v_fmac_f32 v252, s29, v248
    v_mfma_f32_16x16x32_bf16 v[164:167], a[248:251], v[232:235], v[164:167]
    buffer_load_dwordx2 v[214:215], v215, s[4:7], s21 offen offset:768
    v_mfma_f32_16x16x32_bf16 v[164:167], v[244:247], v[236:239], v[164:167]
    ds_write_b64 v218, v[220:221] offset:7008
    v_mfma_f32_16x16x32_bf16 v[168:171], a[228:231], v[232:235], v[168:171]
    buffer_store_dwordx4 a[4:7], v254, s[12:15], s44 offen nt
    s_add_u32 s44, s40, 2048
    v_fmac_f32 v202, s29, v194
    v_mfma_f32_16x16x32_bf16 v[168:171], a[240:243], v[236:239], v[168:171]
    s_waitcnt lgkmcnt(1)
    v_fmac_f32 v252, s23, v250
    v_fmac_f32 v202, s23, v198
    v_mfma_f32_16x16x32_bf16 v[168:171], a[252:255], v[228:231], v[168:171]
    v_cvt_pk_bf16_f32 v202, v252, v202
    v_fma_f32 v252, v249, s24, v251
    v_mfma_f32_16x16x32_bf16 v[172:175], v[240:243], v[228:231], v[172:175]
    v_fmac_f32 v251, -4.0, v249
    v_fma_f32 v249, v248, s24, v250
    v_mfma_f32_16x16x32_bf16 v[172:175], a[244:247], v[236:239], v[172:175]
    v_fmac_f32 v250, -4.0, v248
    v_fma_f32 v248, v250, s26, v251
    v_mfma_f32_16x16x32_bf16 v[172:175], a[232:235], v[232:235], v[172:175]
    v_fmac_f32 v251, s27, v250
    v_fma_f32 v250, v249, 2.0, v252
    v_mfma_f32_16x16x32_bf16 v[176:179], a[236:239], v[232:235], v[176:179]
    ds_read_b128 v[232:235], v253 offset:38224
    v_fmac_f32 v252, -2.0, v249
    v_mfma_f32_16x16x32_bf16 v[176:179], a[248:251], v[236:239], v[176:179]
    v_fma_f32 v249, v196, s24, v200
    v_fmac_f32 v200, -4.0, v196
    v_mfma_f32_16x16x32_bf16 v[176:179], v[244:247], v[228:231], v[176:179]
    s_mov_b32 s42, 1216512
    v_fma_f32 v196, v194, s24, v198
    v_fmac_f32 v198, -4.0, v194
    v_mfma_f32_16x16x32_bf16 v[180:183], a[228:231], v[236:239], v[180:183]
    v_fma_f32 v194, v198, s26, v200
    v_fmac_f32 v200, s27, v198
    v_mfma_f32_16x16x32_bf16 v[184:187], a[232:235], v[236:239], v[184:187]
    ds_read_b128 a[20:23], v6 offset:17632
    v_fma_f32 v198, v196, 2.0, v249
    v_mfma_f32_16x16x32_bf16 v[188:191], a[236:239], v[236:239], v[188:191]
    ds_read_b128 v[236:239], v253 offset:26000
    v_fmac_f32 v249, -2.0, v196
    v_mfma_f32_16x16x32_bf16 v[188:191], a[248:251], v[228:231], v[188:191]
    buffer_load_dwordx4 a[228:231], v254, s[8:11], s42 offen offset:0 sc1
    v_mfma_f32_16x16x32_bf16 v[184:187], a[244:247], v[228:231], v[184:187]
    s_waitcnt lgkmcnt(2)
    v_cvt_pk_bf16_f32 v194, v248, v194
    v_cvt_pk_bf16_f32 v200, v251, v200
    v_mfma_f32_16x16x32_bf16 v[180:183], a[240:243], v[228:231], v[180:183]
    ds_read_b128 v[228:231], v253 offset:25728
    v_cvt_pk_bf16_f32 v198, v250, v198
    v_mfma_f32_16x16x32_bf16 v[180:183], a[252:255], v[232:235], v[180:183]
    buffer_load_dwordx4 a[232:235], v254, s[8:11], s42 offen offset:1024 sc1
    v_mfma_f32_16x16x32_bf16 v[184:187], v[240:243], v[232:235], v[184:187]
    s_waitcnt vmcnt(17) lgkmcnt(1)
    v_cvt_pk_bf16_f32 v196, v252, v249
    v_lshlrev_b32 v248, 16, v195
    v_mfma_f32_16x16x32_bf16 v[188:191], v[244:247], v[232:235], v[188:191]
    ds_read_b128 v[232:235], v253 offset:25472
    v_lshlrev_b32 v249, 16, v197
sub32:
    v_mfma_f32_16x16x32_bf16 v[96:99], a[192:195], v[236:239], v[96:99]
    buffer_load_dwordx4 a[236:239], v254, s[8:11], s42 offen offset:2048 sc1
    v_mfma_f32_16x16x32_bf16 v[100:103], a[196:199], v[236:239], v[100:103]
    s_mov_b32 s42, 1219584
    v_lshlrev_b32 v250, 16, v199
    v_lshlrev_b32 v251, 16, v201
    v_mfma_f32_16x16x32_bf16 v[104:107], a[200:203], v[236:239], v[104:107]
pad12:
    s_cbranch_vccnz warm_ret
    ds_read_b128 v[236:239], v253 offset:25216
    s_waitcnt vmcnt(14)
    s_waitcnt lgkmcnt(2)
    v_mfma_f32_16x16x32_bf16 v[104:107], a[212:215], v[228:231], v[104:107]
    v_and_b32 v195, s22, v195
    v_and_b32 v197, s22, v197
    v_mfma_f32_16x16x32_bf16 v[100:103], a[208:211], v[228:231], v[100:103]
    buffer_load_dwordx4 a[240:243], v254, s[8:11], s42 offen offset:0 sc1
    v_mfma_f32_16x16x32_bf16 v[96:99], a[204:207], v[228:231], v[96:99]
    s_waitcnt vmcnt(12) lgkmcnt(1)
    v_and_b32 v199, s22, v199
    v_and_b32 v201, s22, v201
    v_mfma_f32_16x16x32_bf16 v[96:99], a[216:219], v[232:235], v[96:99]
    buffer_store_dwordx4 a[8:11], v254, s[12:15], s44 offen nt
    s_add_u32 s44, s40, 3072
    v_mfma_f32_16x16x32_bf16 v[100:103], a[220:223], v[232:235], v[100:103]
    ds_read_b128 a[24:27], v6 offset:18688
    v_lshlrev_b32 v252, 16, v193
    v_mfma_f32_16x16x32_bf16 v[104:107], a[224:227], v[232:235], v[104:107]
    buffer_load_dwordx4 a[244:247], v254, s[8:11], s42 offen offset:1024 sc1
    v_mfma_f32_16x16x32_bf16 v[108:111], a[192:195], v[228:231], v[108:111]
    v_and_b32 v193, s22, v193
    v_fmac_f32 v252, s25, v251
    v_mfma_f32_16x16x32_bf16 v[108:111], a[204:207], v[232:235], v[108:111]
    s_waitcnt lgkmcnt(1)
    v_fmac_f32 v193, s25, v201
    v_fmac_f32 v252, s28, v249
    v_mfma_f32_16x16x32_bf16 v[108:111], a[216:219], v[236:239], v[108:111]
    v_fmac_f32 v193, s28, v197
    v_cvt_pk_bf16_f32 v193, v252, v193
    v_mfma_f32_16x16x32_bf16 v[112:115], a[220:223], v[236:239], v[112:115]
    buffer_load_dwordx4 a[248:251], v254, s[8:11], s42 offen offset:2048 sc1
    v_mfma_f32_16x16x32_bf16 v[112:115], a[208:211], v[232:235], v[112:115]
    s_mov_b32 s42, 1222656
    v_lshlrev_b32 v252, 16, v203
    v_and_b32 v203, s22, v203
    v_mfma_f32_16x16x32_bf16 v[112:115], a[196:199], v[228:231], v[112:115]
    buffer_store_dwordx4 a[12:15], v254, s[12:15], s44 offen nt
    v_fmac_f32 v252, s29, v248
    v_fmac_f32 v203, s29, v195
    v_mfma_f32_16x16x32_bf16 v[116:119], a[200:203], v[228:231], v[116:119]
    ds_read_b128 v[228:231], v253 offset:24960
    v_fmac_f32 v252, s23, v250
    v_mfma_f32_16x16x32_bf16 v[116:119], a[212:215], v[232:235], v[116:119]
    buffer_load_dwordx4 a[252:255], v254, s[8:11], s42 offen offset:0 sc1
    v_mfma_f32_16x16x32_bf16 v[116:119], a[224:227], v[236:239], v[116:119]
    v_fmac_f32 v203, s23, v199
    v_cvt_pk_bf16_f32 v203, v252, v203
    v_mfma_f32_16x16x32_bf16 v[120:123], a[192:195], v[232:235], v[120:123]
    v_fma_f32 v252, v249, s24, v251
    v_fmac_f32 v251, -4.0, v249
    v_mfma_f32_16x16x32_bf16 v[120:123], a[204:207], v[236:239], v[120:123]
    s_waitcnt lgkmcnt(0)
    s_add_u32 s44, s40, 4096
    v_fma_f32 v249, v248, s24, v250
    v_mfma_f32_16x16x32_bf16 v[120:123], a[216:219], v[228:231], v[120:123]
    ds_read_b128 a[28:31], v6 offset:19712
    v_fmac_f32 v250, -4.0, v248
    v_mfma_f32_16x16x32_bf16 v[124:127], a[220:223], v[228:231], v[124:127]
    buffer_load_dwordx4 v[240:243], v254, s[8:11], s42 offen offset:1024 sc1
    v_mfma_f32_16x16x32_bf16 v[124:127], a[208:211], v[236:239], v[124:127]
    v_fma_f32 v248, v250, s26, v251
    v_fmac_f32 v251, s27, v250
    v_mfma_f32_16x16x32_bf16 v[124:127], a[196:199], v[232:235], v[124:127]
    v_fma_f32 v250, v249, 2.0, v252
    v_fmac_f32 v252, -2.0, v249
    v_mfma_f32_16x16x32_bf16 v[128:131], a[200:203], v[232:235], v[128:131]
    ds_read_b128 v[232:235], v253 offset:26784
    v_fma_f32 v249, v197, s24, v201
    v_mfma_f32_16x16x32_bf16 v[128:131], a[212:215], v[236:239], v[128:131]
    buffer_load_dwordx4 v[244:247], v254, s[8:11], s42 offen offset:2048 sc1
    v_mfma_f32_16x16x32_bf16 v[128:131], a[224:227], v[228:231], v[128:131]
    v_fmac_f32 v201, -4.0, v197
    v_fma_f32 v197, v195, s24, v199
    v_mfma_f32_16x16x32_bf16 v[132:135], a[192:195], v[236:239], v[132:135]
    v_and_b32 v227, 0x7fff, v255
    v_fmac_f32 v199, -4.0, v195
    v_mfma_f32_16x16x32_bf16 v[132:135], a[204:207], v[228:231], v[132:135]
    s_waitcnt lgkmcnt(0)
    v_fma_f32 v195, v199, s26, v201
    v_fmac_f32 v201, s27, v199
    v_mfma_f32_16x16x32_bf16 v[132:135], a[216:219], v[232:235], v[132:135]
    buffer_load_dwordx2 v[216:217], v227, s[4:7], s16 offen offset:1152
    v_mfma_f32_16x16x32_bf16 v[136:139], a[220:223], v[232:235], v[136:139]
    v_fma_f32 v199, v197, 2.0, v249
    v_fmac_f32 v249, -2.0, v197
    v_mfma_f32_16x16x32_bf16 v[136:139], a[208:211], v[228:231], v[136:139]
    v_cvt_pk_bf16_f32 v195, v248, v195
    v_cvt_pk_bf16_f32 v201, v251, v201
    v_mfma_f32_16x16x32_bf16 v[136:139], a[196:199], v[236:239], v[136:139]
    v_cvt_pk_bf16_f32 v199, v250, v199
    v_cvt_pk_bf16_f32 v197, v252, v249
    v_mfma_f32_16x16x32_bf16 v[140:143], a[200:203], v[236:239], v[140:143]
    ds_read_b128 v[236:239], v253 offset:26528
    v_lshrrev_b32 v252, 15, v255
    v_mfma_f32_16x16x32_bf16 v[140:143], a[212:215], v[228:231], v[140:143]
    buffer_load_dwordx2 v[218:219], v227, s[4:7], s17 offen offset:1152
    v_mfma_f32_16x16x32_bf16 v[140:143], a[224:227], v[232:235], v[140:143]
    ds_read_b128 a[32:35], v6 offset:20736
    v_mfma_f32_16x16x32_bf16 v[144:147], a[192:195], v[228:231], v[144:147]
    ds_write_b64 v252, v[194:195] offset:512
    v_mfma_f32_16x16x32_bf16 v[144:147], a[204:207], v[232:235], v[144:147]
    s_waitcnt lgkmcnt(2)
    v_lshrrev_b32 v194, 15, v255
    s_waitcnt vmcnt(14)
    v_mfma_f32_16x16x32_bf16 v[144:147], a[216:219], v[236:239], v[144:147]
    buffer_load_dwordx2 v[220:221], v227, s[4:7], s18 offen offset:1152
    v_mfma_f32_16x16x32_bf16 v[148:151], a[220:223], v[236:239], v[148:151]
    ds_write_b64 v194, v[200:201] offset:2592
    v_mfma_f32_16x16x32_bf16 v[148:151], a[208:211], v[232:235], v[148:151]
    v_lshlrev_b32 v248, 16, v206
    v_lshlrev_b32 v249, 16, v208
    v_mfma_f32_16x16x32_bf16 v[148:151], a[196:199], v[228:231], v[148:151]
    ds_write_b64 v194, v[198:199] offset:4672
    v_mfma_f32_16x16x32_bf16 v[152:155], a[200:203], v[228:231], v[152:155]
    ds_read_b128 v[228:231], v253 offset:26272
    v_lshlrev_b32 v250, 16, v210
    v_mfma_f32_16x16x32_bf16 v[152:155], a[212:215], v[232:235], v[152:155]
    buffer_load_dwordx2 v[222:223], v227, s[4:7], s19 offen offset:1152
    v_mfma_f32_16x16x32_bf16 v[152:155], a[224:227], v[236:239], v[152:155]
    ds_write_b64 v194, v[192:193] offset:33792
    v_mfma_f32_16x16x32_bf16 v[156:159], a[192:195], v[232:235], v[156:159]
    v_lshlrev_b32 v251, 16, v212
    v_and_b32 v206, s22, v206
    v_mfma_f32_16x16x32_bf16 v[156:159], a[204:207], v[236:239], v[156:159]
    s_waitcnt lgkmcnt(1)
    v_and_b32 v208, s22, v208
    v_and_b32 v210, s22, v210
    v_mfma_f32_16x16x32_bf16 v[156:159], a[216:219], v[228:231], v[156:159]
    buffer_load_dwordx2 v[224:225], v227, s[4:7], s20 offen offset:1152
    v_mfma_f32_16x16x32_bf16 v[160:163], a[220:223], v[228:231], v[160:163]
    ds_read_b128 a[36:39], v6 offset:21792
    v_and_b32 v212, s22, v212
    v_mfma_f32_16x16x32_bf16 v[160:163], a[208:211], v[236:239], v[160:163]
    ds_write_b64 v194, v[202:203] offset:35872
    v_mfma_f32_16x16x32_bf16 v[160:163], a[196:199], v[232:235], v[160:163]
    v_lshlrev_b32 v252, 16, v204
    v_and_b32 v204, s22, v204
    v_mfma_f32_16x16x32_bf16 v[164:167], a[200:203], v[232:235], v[164:167]
    ds_read_b128 v[232:235], v253 offset:26016
    v_fmac_f32 v252, s25, v251
    v_mfma_f32_16x16x32_bf16 v[164:167], a[212:215], v[236:239], v[164:167]
    buffer_load_dwordx2 v[226:227], v227, s[4:7], s21 offen offset:1152
    v_mfma_f32_16x16x32_bf16 v[164:167], a[224:227], v[228:231], v[164:167]
    ds_write_b64 v194, v[196:197] offset:6752
    v_mfma_f32_16x16x32_bf16 v[168:171], a[192:195], v[236:239], v[168:171]
    buffer_store_dwordx4 a[16:19], v254, s[12:15], s44 offen nt
    s_add_u32 s44, s40, 5120
    v_mfma_f32_16x16x32_bf16 v[168:171], a[204:207], v[228:231], v[168:171]
    s_waitcnt lgkmcnt(1)
    v_fmac_f32 v204, s25, v212
    v_fmac_f32 v252, s28, v249
    v_mfma_f32_16x16x32_bf16 v[168:171], a[216:219], v[232:235], v[168:171]
    ds_read_b128 v[192:195], v253 offset:39520
    s_mov_b32 s45, 573637648
    v_mfma_f32_16x16x32_bf16 v[172:175], a[220:223], v[232:235], v[172:175]
    buffer_store_dwordx4 a[20:23], v254, s[12:15], s44 offen nt
    v_bfe_u32 v196, v254, 5, 3
    v_mul_u32_u24 v197, 5, v196
    v_mfma_f32_16x16x32_bf16 v[172:175], a[208:211], v[228:231], v[172:175]
    v_bfe_u32 v197, s45, v197, 5
    v_mul_u32_u24 v197, 65, v197
    v_mfma_f32_16x16x32_bf16 v[172:175], a[196:199], v[236:239], v[172:175]
    v_sub_u32 v197, v197, v196
    v_lshl_add_u32 v196, v197, 5, v253
    v_mfma_f32_16x16x32_bf16 v[176:179], a[200:203], v[236:239], v[176:179]
    ds_read_b128 v[236:239], v253 offset:25744
    s_waitcnt lgkmcnt(1)
    v_mfma_f32_16x16x32_bf16 v[176:179], a[212:215], v[228:231], v[176:179]
    s_add_u32 s44, s40, 6144
    v_fmac_f32 v204, s28, v208
    v_mfma_f32_16x16x32_bf16 v[176:179], a[224:227], v[232:235], v[176:179]
    s_mov_b32 s42, 1253376
    v_cvt_pk_bf16_f32 v204, v252, v204
    v_lshlrev_b32 v252, 16, v214
    v_mfma_f32_16x16x32_bf16 v[180:183], a[192:195], v[228:231], v[180:183]
    ds_read_b128 a[40:43], v6 offset:22816
    v_and_b32 v214, s22, v214
    v_mfma_f32_16x16x32_bf16 v[184:187], a[196:199], v[228:231], v[184:187]
    s_mov_b64 exec, s[46:47]
    ds_write_b128 v196, v[192:195] offset:1024
    s_mov_b64 exec, -1
    v_mfma_f32_16x16x32_bf16 v[188:191], a[200:203], v[228:231], v[188:191]
    ds_read_b128 v[228:231], v253 offset:28080
    v_fmac_f32 v252, s29, v248
    v_mfma_f32_16x16x32_bf16 v[188:191], a[212:215], v[232:235], v[188:191]
    buffer_load_dwordx4 a[96:99], v254, s[8:11], s42 offen offset:0 sc1
    v_mfma_f32_16x16x32_bf16 v[184:187], a[208:211], v[232:235], v[184:187]
    s_waitcnt lgkmcnt(3)
    v_fmac_f32 v214, s29, v206
    v_fmac_f32 v252, s23, v250
    v_mfma_f32_16x16x32_bf16 v[180:183], a[204:207], v[232:235], v[180:183]
    ds_read_b128 v[232:235], v253 offset:27808
    v_mfma_f32_16x16x32_bf16 v[180:183], a[216:219], v[236:239], v[180:183]
    buffer_load_dwordx4 a[100:103], v254, s[8:11], s42 offen offset:1024 sc1
    v_mfma_f32_16x16x32_bf16 v[184:187], a[220:223], v[236:239], v[184:187]
    s_waitcnt vmcnt(18) lgkmcnt(1)
    v_fmac_f32 v214, s23, v210
    v_cvt_pk_bf16_f32 v214, v252, v214
    v_mfma_f32_16x16x32_bf16 v[188:191], a[224:227], v[236:239], v[188:191]
    ds_read_b128 v[236:239], v253 offset:27552
    v_fma_f32 v252, v249, s24, v251
sub33:
    v_mfma_f32_16x16x32_bf16 v[96:99], a[228:231], v[228:231], v[96:99]
    buffer_load_dwordx4 a[104:107], v254, s[8:11], s42 offen offset:2048 sc1
    v_mfma_f32_16x16x32_bf16 v[100:103], a[232:235], v[228:231], v[100:103]
    s_mov_b32 s42, 1256448
    v_fmac_f32 v251, -4.0, v249
    v_fma_f32 v249, v248, s24, v250
    v_mfma_f32_16x16x32_bf16 v[104:107], a[236:239], v[228:231], v[104:107]
    ds_read_b128 v[228:231], v253 offset:27296
    s_waitcnt vmcnt(15)
    s_waitcnt lgkmcnt(2)
    v_mfma_f32_16x16x32_bf16 v[104:107], a[248:251], v[232:235], v[104:107]
    v_fmac_f32 v250, -4.0, v248
    v_fma_f32 v248, v250, s26, v251
    v_mfma_f32_16x16x32_bf16 v[100:103], a[244:247], v[232:235], v[100:103]
    buffer_load_dwordx4 a[108:111], v254, s[8:11], s42 offen offset:0 sc1
    v_mfma_f32_16x16x32_bf16 v[96:99], a[240:243], v[232:235], v[96:99]
    s_waitcnt vmcnt(12) lgkmcnt(1)
    v_fmac_f32 v251, s27, v250
    v_fma_f32 v250, v249, 2.0, v252
    v_mfma_f32_16x16x32_bf16 v[96:99], a[252:255], v[236:239], v[96:99]
    buffer_store_dwordx4 a[24:27], v254, s[12:15], s44 offen nt
    v_fmac_f32 v252, -2.0, v249
    v_fma_f32 v249, v208, s24, v212
    v_mfma_f32_16x16x32_bf16 v[100:103], v[240:243], v[236:239], v[100:103]
    ds_read_b128 a[44:47], v6 offset:23840
    v_fmac_f32 v212, -4.0, v208
    v_mfma_f32_16x16x32_bf16 v[104:107], v[244:247], v[236:239], v[104:107]
    buffer_load_dwordx4 a[112:115], v254, s[8:11], s42 offen offset:1024 sc1
    v_mfma_f32_16x16x32_bf16 v[108:111], a[228:231], v[232:235], v[108:111]
    s_add_u32 s44, s40, 7168
    v_fma_f32 v208, v206, s24, v210
    v_fmac_f32 v210, -4.0, v206
    v_mfma_f32_16x16x32_bf16 v[108:111], a[240:243], v[236:239], v[108:111]
    s_waitcnt lgkmcnt(1)
    v_fma_f32 v206, v210, s26, v212
    v_fmac_f32 v212, s27, v210
    v_mfma_f32_16x16x32_bf16 v[108:111], a[252:255], v[228:231], v[108:111]
    v_fma_f32 v210, v208, 2.0, v249
    v_fmac_f32 v249, -2.0, v208
    v_mfma_f32_16x16x32_bf16 v[112:115], v[240:243], v[228:231], v[112:115]
    buffer_load_dwordx4 a[116:119], v254, s[8:11], s42 offen offset:2048 sc1
    v_mfma_f32_16x16x32_bf16 v[112:115], a[244:247], v[236:239], v[112:115]
    s_mov_b32 s42, 1259520
    v_cvt_pk_bf16_f32 v206, v248, v206
    v_cvt_pk_bf16_f32 v212, v251, v212
    v_mfma_f32_16x16x32_bf16 v[112:115], a[232:235], v[232:235], v[112:115]
    v_cvt_pk_bf16_f32 v210, v250, v210
    v_cvt_pk_bf16_f32 v208, v252, v249
    v_mfma_f32_16x16x32_bf16 v[116:119], a[236:239], v[232:235], v[116:119]
    ds_read_b128 v[232:235], v253 offset:27040
    v_lshlrev_b32 v248, 16, v207
    v_mfma_f32_16x16x32_bf16 v[116:119], a[248:251], v[236:239], v[116:119]
    buffer_load_dwordx4 a[120:123], v254, s[8:11], s42 offen offset:0 sc1
    v_mfma_f32_16x16x32_bf16 v[116:119], v[244:247], v[228:231], v[116:119]
    v_lshlrev_b32 v249, 16, v209
    v_lshlrev_b32 v250, 16, v211
    v_mfma_f32_16x16x32_bf16 v[120:123], a[228:231], v[236:239], v[120:123]
    v_lshlrev_b32 v251, 16, v213
    v_and_b32 v207, s22, v207
    v_mfma_f32_16x16x32_bf16 v[120:123], a[240:243], v[228:231], v[120:123]
    s_waitcnt lgkmcnt(0)
    v_and_b32 v209, s22, v209
    v_and_b32 v211, s22, v211
    v_mfma_f32_16x16x32_bf16 v[120:123], a[252:255], v[232:235], v[120:123]
    v_and_b32 v213, s22, v213
    v_lshlrev_b32 v252, 16, v205
    v_mfma_f32_16x16x32_bf16 v[124:127], v[240:243], v[232:235], v[124:127]
    buffer_load_dwordx4 a[124:127], v254, s[8:11], s42 offen offset:1024 sc1
    v_mfma_f32_16x16x32_bf16 v[124:127], a[244:247], v[228:231], v[124:127]
    v_and_b32 v205, s22, v205
    v_fmac_f32 v252, s25, v251
    v_mfma_f32_16x16x32_bf16 v[124:127], a[232:235], v[236:239], v[124:127]
    v_fmac_f32 v205, s25, v213
    v_fmac_f32 v252, s28, v249
    v_mfma_f32_16x16x32_bf16 v[128:131], a[236:239], v[236:239], v[128:131]
    ds_read_b128 v[236:239], v253 offset:28864
    v_fmac_f32 v205, s28, v209
    v_mfma_f32_16x16x32_bf16 v[128:131], a[248:251], v[228:231], v[128:131]
    buffer_load_dwordx4 a[128:131], v254, s[8:11], s42 offen offset:2048 sc1
    v_mfma_f32_16x16x32_bf16 v[128:131], v[244:247], v[232:235], v[128:131]
    s_mov_b32 s42, 1290240
    v_cvt_pk_bf16_f32 v205, v252, v205
    v_lshlrev_b32 v252, 16, v215
    v_mfma_f32_16x16x32_bf16 v[132:135], a[228:231], v[228:231], v[132:135]
    ds_read_b128 a[48:51], v253 offset:30160
    v_and_b32 v215, s22, v215
    v_mfma_f32_16x16x32_bf16 v[132:135], a[240:243], v[232:235], v[132:135]
    s_waitcnt lgkmcnt(1)
    v_fmac_f32 v252, s29, v248
    v_fmac_f32 v215, s29, v207
    v_mfma_f32_16x16x32_bf16 v[132:135], a[252:255], v[236:239], v[132:135]
    buffer_load_dwordx4 a[132:135], v254, s[8:11], s42 offen offset:0 sc1
    v_mfma_f32_16x16x32_bf16 v[136:139], v[240:243], v[236:239], v[136:139]
    v_fmac_f32 v252, s23, v250
    v_fmac_f32 v215, s23, v211
    v_mfma_f32_16x16x32_bf16 v[136:139], a[244:247], v[232:235], v[136:139]
    ds_read_b128 a[64:67], v253 offset:32240
    v_cvt_pk_bf16_f32 v215, v252, v215
    v_mfma_f32_16x16x32_bf16 v[136:139], a[232:235], v[228:231], v[136:139]
    buffer_load_dwordx4 a[136:139], v254, s[8:11], s42 offen offset:1024 sc1
    v_mfma_f32_16x16x32_bf16 v[140:143], a[236:239], v[228:231], v[140:143]
    ds_read_b128 v[228:231], v253 offset:28608
    v_fma_f32 v252, v249, s24, v251
    v_mfma_f32_16x16x32_bf16 v[140:143], a[248:251], v[232:235], v[140:143]
    v_fmac_f32 v251, -4.0, v249
    v_fma_f32 v249, v248, s24, v250
    v_mfma_f32_16x16x32_bf16 v[140:143], v[244:247], v[236:239], v[140:143]
    ds_read_b128 a[52:55], v253 offset:29888
    v_fmac_f32 v250, -4.0, v248
    v_mfma_f32_16x16x32_bf16 v[144:147], a[228:231], v[232:235], v[144:147]
    buffer_load_dwordx4 a[140:143], v254, s[8:11], s42 offen offset:2048 sc1
    v_mfma_f32_16x16x32_bf16 v[144:147], a[240:243], v[236:239], v[144:147]
    s_mov_b32 s42, 1293312
    s_waitcnt lgkmcnt(1)
    v_fma_f32 v248, v250, s26, v251
    v_mfma_f32_16x16x32_bf16 v[144:147], a[252:255], v[228:231], v[144:147]
    v_fmac_f32 v251, s27, v250
    v_fma_f32 v250, v249, 2.0, v252
    v_mfma_f32_16x16x32_bf16 v[148:151], v[240:243], v[228:231], v[148:151]
    ds_read_b128 a[68:71], v253 offset:31968
    v_fmac_f32 v252, -2.0, v249
    v_mfma_f32_16x16x32_bf16 v[148:151], a[244:247], v[236:239], v[148:151]
    buffer_load_dwordx4 a[144:147], v254, s[8:11], s42 offen offset:0 sc1
    v_mfma_f32_16x16x32_bf16 v[148:151], a[232:235], v[232:235], v[148:151]
    v_fma_f32 v249, v209, s24, v213
    v_fmac_f32 v213, -4.0, v209
    v_mfma_f32_16x16x32_bf16 v[152:155], a[236:239], v[232:235], v[152:155]
    ds_read_b128 v[232:235], v253 offset:28352
    v_fma_f32 v209, v207, s24, v211
    v_mfma_f32_16x16x32_bf16 v[152:155], a[248:251], v[236:239], v[152:155]
    ds_read_b128 a[56:59], v253 offset:29632
    v_fmac_f32 v211, -4.0, v207
    v_mfma_f32_16x16x32_bf16 v[152:155], v[244:247], v[228:231], v[152:155]
    buffer_load_dwordx4 a[148:151], v254, s[8:11], s42 offen offset:1024 sc1
    v_mfma_f32_16x16x32_bf16 v[156:159], a[228:231], v[236:239], v[156:159]
    v_fma_f32 v207, v211, s26, v213
    v_fmac_f32 v213, s27, v211
    v_mfma_f32_16x16x32_bf16 v[156:159], a[240:243], v[228:231], v[156:159]
    s_waitcnt lgkmcnt(1)
    v_fma_f32 v211, v209, 2.0, v249
    v_fmac_f32 v249, -2.0, v209
    v_mfma_f32_16x16x32_bf16 v[156:159], a[252:255], v[232:235], v[156:159]
    ds_read_b128 a[72:75], v253 offset:31712
    v_cvt_pk_bf16_f32 v207, v248, v207
    v_mfma_f32_16x16x32_bf16 v[160:163], v[240:243], v[232:235], v[160:163]
    buffer_load_dwordx4 a[152:155], v254, s[8:11], s42 offen offset:2048 sc1
    v_mfma_f32_16x16x32_bf16 v[160:163], a[244:247], v[228:231], v[160:163]
    s_mov_b32 s42, 1296384
    v_cvt_pk_bf16_f32 v213, v251, v213
    v_cvt_pk_bf16_f32 v211, v250, v211
    v_mfma_f32_16x16x32_bf16 v[160:163], a[232:235], v[236:239], v[160:163]
    v_cvt_pk_bf16_f32 v209, v252, v249
    v_lshrrev_b32 v252, 15, v255
    v_mfma_f32_16x16x32_bf16 v[164:167], a[236:239], v[236:239], v[164:167]
    ds_read_b128 v[236:239], v253 offset:28096
    v_mfma_f32_16x16x32_bf16 v[164:167], a[248:251], v[228:231], v[164:167]
    buffer_load_dwordx4 a[156:159], v254, s[8:11], s42 offen offset:0 sc1
    v_mfma_f32_16x16x32_bf16 v[164:167], v[244:247], v[232:235], v[164:167]
    ds_read_b128 a[60:63], v253 offset:29376
    v_mfma_f32_16x16x32_bf16 v[168:171], a[228:231], v[228:231], v[168:171]
    buffer_store_dwordx4 a[28:31], v254, s[12:15], s44 offen nt
    s_add_u32 s44, s40, 8192
    v_mfma_f32_16x16x32_bf16 v[168:171], a[240:243], v[232:235], v[168:171]
    buffer_load_dwordx4 a[160:163], v254, s[8:11], s42 offen offset:1024 sc1
    s_waitcnt lgkmcnt(1)
    v_mfma_f32_16x16x32_bf16 v[168:171], a[252:255], v[236:239], v[168:171]
    ds_write_b64 v252, v[206:207] offset:256
    v_mfma_f32_16x16x32_bf16 v[172:175], v[240:243], v[236:239], v[172:175]
    ds_read_b128 a[76:79], v253 offset:31456
    v_lshrrev_b32 v206, 15, v255
    v_mfma_f32_16x16x32_bf16 v[172:175], a[244:247], v[232:235], v[172:175]
    ds_write_b64 v206, v[212:213] offset:2336
    s_waitcnt vmcnt(21)
    v_mfma_f32_16x16x32_bf16 v[172:175], a[232:235], v[228:231], v[172:175]
    buffer_load_dwordx4 a[164:167], v254, s[8:11], s42 offen offset:2048 sc1
    v_mfma_f32_16x16x32_bf16 v[176:179], a[236:239], v[228:231], v[176:179]
    ds_read_b128 v[228:231], v253 offset:27824
    v_lshlrev_b32 v248, 16, v218
    v_mfma_f32_16x16x32_bf16 v[176:179], a[248:251], v[232:235], v[176:179]
    buffer_store_dwordx4 a[32:35], v254, s[12:15], s44 offen nt
    s_add_u32 s44, s40, 9216
    v_mfma_f32_16x16x32_bf16 v[176:179], v[244:247], v[236:239], v[176:179]
    s_add_u32 s42, s36, 0
    v_lshlrev_b32 v249, 16, v220
    v_lshlrev_b32 v250, 16, v222
    v_mfma_f32_16x16x32_bf16 v[180:183], a[228:231], v[232:235], v[180:183]
    s_waitcnt lgkmcnt(0)
    v_lshlrev_b32 v251, 16, v224
    v_and_b32 v218, s22, v218
    v_and_b32 v220, s22, v220
    v_mfma_f32_16x16x32_bf16 v[184:187], a[232:235], v[232:235], v[184:187]
    s_barrier
    v_mfma_f32_16x16x32_bf16 v[188:191], a[236:239], v[232:235], v[188:191]
    ds_write_b64 v206, v[210:211] offset:4416
    v_mfma_f32_16x16x32_bf16 v[188:191], a[248:251], v[236:239], v[188:191]
    buffer_load_dwordx4 a[192:195], v254, s[8:11], s42 offen offset:0 sc1
    v_mfma_f32_16x16x32_bf16 v[184:187], a[244:247], v[236:239], v[184:187]
    ds_write_b64 v206, v[204:205] offset:33536
    v_mfma_f32_16x16x32_bf16 v[180:183], a[240:243], v[236:239], v[180:183]
    v_and_b32 v222, s22, v222
    v_and_b32 v224, s22, v224
    v_lshlrev_b32 v252, 16, v216
    v_mfma_f32_16x16x32_bf16 v[180:183], a[252:255], v[228:231], v[180:183]
    buffer_load_dwordx4 a[196:199], v254, s[8:11], s42 offen offset:1024 sc1
    v_mfma_f32_16x16x32_bf16 v[184:187], v[240:243], v[228:231], v[184:187]
    ds_write_b64 v206, v[214:215] offset:35616
    v_mfma_f32_16x16x32_bf16 v[188:191], v[244:247], v[228:231], v[188:191]
    s_waitcnt vmcnt(13)
    v_and_b32 v216, s22, v216
    v_fmac_f32 v252, s25, v251
sub34:
    v_mfma_f32_16x16x32_bf16 v[96:99], a[96:99], a[48:51], v[96:99]
    buffer_load_dwordx4 a[200:203], v254, s[8:11], s42 offen offset:2048 sc1
    v_mfma_f32_16x16x32_bf16 v[96:99], a[108:111], a[52:55], v[96:99]
    s_add_u32 s42, s36, 3072
    v_fmac_f32 v216, s25, v224
    v_fmac_f32 v252, s28, v249
    v_fmac_f32 v216, s28, v220
    v_mfma_f32_16x16x32_bf16 v[96:99], a[120:123], a[56:59], v[96:99]
    ds_write_b64 v206, v[208:209] offset:6496
    v_mfma_f32_16x16x32_bf16 v[100:103], a[124:127], a[56:59], v[100:103]
    v_cvt_pk_bf16_f32 v216, v252, v216
    v_lshlrev_b32 v252, 16, v226
    v_mfma_f32_16x16x32_bf16 v[100:103], a[112:115], a[52:55], v[100:103]
    buffer_load_dwordx4 a[204:207], v254, s[8:11], s42 offen offset:0 sc1
    v_mfma_f32_16x16x32_bf16 v[100:103], a[100:103], a[48:51], v[100:103]
    v_and_b32 v226, s22, v226
    v_fmac_f32 v252, s29, v248
    v_mfma_f32_16x16x32_bf16 v[104:107], a[104:107], a[48:51], v[104:107]
    ds_read_b128 a[48:51], v253 offset:29120
    v_fmac_f32 v226, s29, v218
    v_fmac_f32 v252, s23, v250
    v_mfma_f32_16x16x32_bf16 v[104:107], a[116:119], a[52:55], v[104:107]
    v_fmac_f32 v226, s23, v222
    v_cvt_pk_bf16_f32 v226, v252, v226
    v_mfma_f32_16x16x32_bf16 v[104:107], a[128:131], a[56:59], v[104:107]
    buffer_load_dwordx4 a[208:211], v254, s[8:11], s42 offen offset:1024 sc1
    v_mfma_f32_16x16x32_bf16 v[108:111], a[96:99], a[52:55], v[108:111]
    v_fma_f32 v252, v249, s24, v251
    v_fmac_f32 v251, -4.0, v249
    v_mfma_f32_16x16x32_bf16 v[108:111], a[108:111], a[56:59], v[108:111]
    v_fma_f32 v249, v248, s24, v250
    v_fmac_f32 v250, -4.0, v248
    v_mfma_f32_16x16x32_bf16 v[108:111], a[120:123], a[60:63], v[108:111]
    v_fma_f32 v248, v250, s26, v251
    v_fmac_f32 v251, s27, v250
    v_fma_f32 v250, v249, 2.0, v252
    v_mfma_f32_16x16x32_bf16 v[112:115], a[124:127], a[60:63], v[112:115]
    buffer_load_dwordx4 a[212:215], v254, s[8:11], s42 offen offset:2048 sc1
    v_mfma_f32_16x16x32_bf16 v[112:115], a[112:115], a[56:59], v[112:115]
    s_add_u32 s42, s36, 6144
    v_fmac_f32 v252, -2.0, v249
    v_fma_f32 v249, v220, s24, v224
    v_mfma_f32_16x16x32_bf16 v[112:115], a[100:103], a[52:55], v[112:115]
    buffer_store_dwordx4 a[36:39], v254, s[12:15], s44 offen nt
    s_add_u32 s44, s40, 10240
    v_mfma_f32_16x16x32_bf16 v[116:119], a[104:107], a[52:55], v[116:119]
    ds_read_b128 a[52:55], v253 offset:30944
    v_fmac_f32 v224, -4.0, v220
    v_mfma_f32_16x16x32_bf16 v[116:119], a[116:119], a[56:59], v[116:119]
    buffer_load_dwordx4 a[216:219], v254, s[8:11], s42 offen offset:0 sc1
    v_fma_f32 v220, v218, s24, v222
    v_mfma_f32_16x16x32_bf16 v[116:119], a[128:131], a[60:63], v[116:119]
    s_waitcnt vmcnt(16)
    v_fmac_f32 v222, -4.0, v218
    v_fma_f32 v218, v222, s26, v224
    v_mfma_f32_16x16x32_bf16 v[96:99], a[132:135], a[64:67], v[96:99]
    s_waitcnt vmcnt(13)
    v_fmac_f32 v224, s27, v222
    v_fma_f32 v222, v220, 2.0, v249
    v_mfma_f32_16x16x32_bf16 v[96:99], a[144:147], a[68:71], v[96:99]
    s_waitcnt vmcnt(9)
    v_fmac_f32 v249, -2.0, v220
    v_cvt_pk_bf16_f32 v218, v248, v218
    v_mfma_f32_16x16x32_bf16 v[96:99], a[156:159], a[72:75], v[96:99]
    v_cvt_pk_bf16_f32 v224, v251, v224
    v_cvt_pk_bf16_f32 v222, v250, v222
    v_mfma_f32_16x16x32_bf16 v[100:103], a[160:163], a[72:75], v[100:103]
    buffer_load_dwordx4 a[220:223], v254, s[8:11], s42 offen offset:1024 sc1
    v_cvt_pk_bf16_f32 v220, v252, v249
    v_mfma_f32_16x16x32_bf16 v[100:103], a[148:151], a[68:71], v[100:103]
    v_lshlrev_b32 v248, 16, v219
    v_lshlrev_b32 v249, 16, v221
    v_mfma_f32_16x16x32_bf16 v[100:103], a[136:139], a[64:67], v[100:103]
    v_lshlrev_b32 v250, 16, v223
    v_lshlrev_b32 v251, 16, v225
    v_mfma_f32_16x16x32_bf16 v[104:107], a[140:143], a[64:67], v[104:107]
    ds_read_b128 a[64:67], v253 offset:31200
    v_and_b32 v219, s22, v219
    v_mfma_f32_16x16x32_bf16 v[104:107], a[152:155], a[68:71], v[104:107]
    buffer_load_dwordx4 a[224:227], v254, s[8:11], s42 offen offset:2048 sc1
    v_mfma_f32_16x16x32_bf16 v[104:107], a[164:167], a[72:75], v[104:107]
    v_and_b32 v221, s22, v221
    v_and_b32 v223, s22, v223
    v_and_b32 v225, s22, v225
    v_mfma_f32_16x16x32_bf16 v[108:111], a[132:135], a[68:71], v[108:111]
    buffer_store_dwordx4 a[40:43], v254, s[12:15], s44 offen nt
    v_and_b32 v203, 0x7fff, v255
    s_add_u32 s44, s40, 11264
    v_mfma_f32_16x16x32_bf16 v[108:111], a[144:147], a[72:75], v[108:111]
    v_lshlrev_b32 v252, 16, v217
    v_mfma_f32_16x16x32_bf16 v[108:111], a[156:159], a[76:79], v[108:111]
    buffer_load_dwordx2 v[192:193], v203, s[4:7], s16 offen offset:64
    v_mfma_f32_16x16x32_bf16 v[112:115], a[160:163], a[76:79], v[112:115]
    v_and_b32 v217, s22, v217
    v_fmac_f32 v252, s25, v251
    v_mfma_f32_16x16x32_bf16 v[112:115], a[148:151], a[72:75], v[112:115]
    v_cvt_pk_bf16_f32 v96, v96, v97
    v_cvt_pk_bf16_f32 v97, v98, v99
    v_fmac_f32 v217, s25, v225
    v_mfma_f32_16x16x32_bf16 v[112:115], a[136:139], a[68:71], v[112:115]
    v_cvt_pk_bf16_f32 v98, v100, v101
    v_cvt_pk_bf16_f32 v99, v102, v103
    v_mfma_f32_16x16x32_bf16 v[116:119], a[140:143], a[68:71], v[116:119]
    ds_read_b128 a[68:71], v253 offset:33024
    v_fmac_f32 v252, s28, v249
    v_mfma_f32_16x16x32_bf16 v[116:119], a[152:155], a[72:75], v[116:119]
    buffer_load_dwordx2 v[194:195], v203, s[4:7], s17 offen offset:64
    v_mfma_f32_16x16x32_bf16 v[116:119], a[164:167], a[76:79], v[116:119]
    ds_write_b128 v4, v[96:99] offset:16640
    v_mfma_f32_16x16x32_bf16 v[120:123], a[96:99], a[56:59], v[120:123]
    v_fmac_f32 v217, s28, v221
    v_cvt_pk_bf16_f32 v217, v252, v217
    v_lshlrev_b32 v252, 16, v227
    v_mfma_f32_16x16x32_bf16 v[120:123], a[108:111], a[60:63], v[120:123]
    s_waitcnt lgkmcnt(4)
    v_cvt_pk_bf16_f32 v104, v104, v105
    v_cvt_pk_bf16_f32 v105, v106, v107
    v_mfma_f32_16x16x32_bf16 v[120:123], a[120:123], a[48:51], v[120:123]
    buffer_load_dwordx2 v[196:197], v203, s[4:7], s18 offen offset:64
    v_mfma_f32_16x16x32_bf16 v[120:123], a[132:135], a[72:75], v[120:123]
    ds_write_b64 v5, v[104:105] offset:16704
    v_mfma_f32_16x16x32_bf16 v[120:123], a[144:147], a[76:79], v[120:123]
    s_waitcnt lgkmcnt(3)
    v_cvt_pk_bf16_f32 v108, v108, v109
    v_cvt_pk_bf16_f32 v109, v110, v111
    v_mfma_f32_16x16x32_bf16 v[120:123], a[156:159], a[64:67], v[120:123]
    v_cvt_pk_bf16_f32 v110, v112, v113
    v_cvt_pk_bf16_f32 v111, v114, v115
    v_and_b32 v227, s22, v227
    v_mfma_f32_16x16x32_bf16 v[124:127], a[160:163], a[64:67], v[124:127]
    buffer_load_dwordx2 v[198:199], v203, s[4:7], s19 offen offset:64
    v_mfma_f32_16x16x32_bf16 v[124:127], a[148:151], a[76:79], v[124:127]
    ds_write_b128 v4, v[108:111] offset:17024
    v_mfma_f32_16x16x32_bf16 v[124:127], a[136:139], a[72:75], v[124:127]
    v_fmac_f32 v252, s29, v248
    v_fmac_f32 v227, s29, v219
    v_mfma_f32_16x16x32_bf16 v[124:127], a[124:127], a[48:51], v[124:127]
    v_fmac_f32 v252, s23, v250
    v_fmac_f32 v227, s23, v223
    v_mfma_f32_16x16x32_bf16 v[124:127], a[112:115], a[60:63], v[124:127]
    buffer_load_dwordx2 v[200:201], v203, s[4:7], s20 offen offset:64
    v_cvt_pk_bf16_f32 v227, v252, v227
    v_mfma_f32_16x16x32_bf16 v[124:127], a[100:103], a[56:59], v[124:127]
    v_cvt_pk_bf16_f32 v116, v116, v117
    v_cvt_pk_bf16_f32 v117, v118, v119
    v_mfma_f32_16x16x32_bf16 v[128:131], a[104:107], a[56:59], v[128:131]
    ds_read_b128 a[56:59], v253 offset:30688
    v_fma_f32 v252, v249, s24, v251
    v_mfma_f32_16x16x32_bf16 v[128:131], a[116:119], a[60:63], v[128:131]
    ds_write_b64 v5, v[116:117] offset:17088
    v_mfma_f32_16x16x32_bf16 v[128:131], a[128:131], a[48:51], v[128:131]
    buffer_load_dwordx2 v[202:203], v203, s[4:7], s21 offen offset:64
    v_mfma_f32_16x16x32_bf16 v[128:131], a[140:143], a[72:75], v[128:131]
    ds_read_b128 a[72:75], v253 offset:32768
    v_fmac_f32 v251, -4.0, v249
    v_fma_f32 v249, v248, s24, v250
    v_mfma_f32_16x16x32_bf16 v[128:131], a[152:155], a[76:79], v[128:131]
    v_fmac_f32 v250, -4.0, v248
    v_fma_f32 v248, v250, s26, v251
    v_mfma_f32_16x16x32_bf16 v[128:131], a[164:167], a[64:67], v[128:131]
    v_fmac_f32 v251, s27, v250
    v_fma_f32 v250, v249, 2.0, v252
    v_mfma_f32_16x16x32_bf16 v[132:135], a[96:99], a[60:63], v[132:135]
    buffer_store_dwordx4 a[44:47], v254, s[12:15], s44 offen nt
    v_fmac_f32 v252, -2.0, v249
    v_fma_f32 v249, v221, s24, v225
    v_mfma_f32_16x16x32_bf16 v[132:135], a[108:111], a[48:51], v[132:135]
    v_cvt_pk_bf16_f32 v120, v120, v121
    v_cvt_pk_bf16_f32 v121, v122, v123
    v_mfma_f32_16x16x32_bf16 v[132:135], a[120:123], a[52:55], v[132:135]
    v_cvt_pk_bf16_f32 v122, v124, v125
    v_cvt_pk_bf16_f32 v123, v126, v127
    v_fmac_f32 v225, -4.0, v221
    v_mfma_f32_16x16x32_bf16 v[132:135], a[132:135], a[76:79], v[132:135]
    v_fma_f32 v221, v219, s24, v223
    v_fmac_f32 v223, -4.0, v219
    v_mfma_f32_16x16x32_bf16 v[132:135], a[144:147], a[64:67], v[132:135]
    s_waitcnt lgkmcnt(6)
    v_fma_f32 v219, v223, s26, v225
    v_fmac_f32 v225, s27, v223
    v_mfma_f32_16x16x32_bf16 v[132:135], a[156:159], a[68:71], v[132:135]
    ds_write_b128 v4, v[120:123] offset:17408
    v_mfma_f32_16x16x32_bf16 v[136:139], a[160:163], a[68:71], v[136:139]
    v_fma_f32 v223, v221, 2.0, v249
    v_fmac_f32 v249, -2.0, v221
    v_mfma_f32_16x16x32_bf16 v[136:139], a[148:151], a[64:67], v[136:139]
pad13:
    s_cbranch_vccnz warm_ret
    v_cvt_pk_bf16_f32 v128, v128, v129
    v_cvt_pk_bf16_f32 v129, v130, v131
    v_cvt_pk_bf16_f32 v219, v248, v219
    v_mfma_f32_16x16x32_bf16 v[136:139], a[136:139], a[76:79], v[136:139]
    s_add_u32 s42, s36, 36864
    v_cvt_pk_bf16_f32 v225, v251, v225
    v_cvt_pk_bf16_f32 v223, v250, v223
    v_mfma_f32_16x16x32_bf16 v[136:139], a[124:127], a[52:55], v[136:139]
    ds_write_b64 v5, v[128:129] offset:17472
    v_mfma_f32_16x16x32_bf16 v[136:139], a[112:115], a[48:51], v[136:139]
    v_cvt_pk_bf16_f32 v221, v252, v249
    v_lshrrev_b32 v252, 15, v255
    v_mfma_f32_16x16x32_bf16 v[136:139], a[100:103], a[60:63], v[136:139]
    ds_write_b64 v252, v[218:219] offset:0
    v_mfma_f32_16x16x32_bf16 v[140:143], a[104:107], a[60:63], v[140:143]
    buffer_load_dwordx4 a[228:231], v254, s[8:11], s42 offen offset:0 sc1
    v_mfma_f32_16x16x32_bf16 v[140:143], a[116:119], a[48:51], v[140:143]
    ds_read_b128 a[60:63], v253 offset:30432
    v_lshrrev_b32 v218, 15, v255
    v_mfma_f32_16x16x32_bf16 v[140:143], a[128:131], a[52:55], v[140:143]
    ds_write_b64 v218, v[224:225] offset:2080
    v_mfma_f32_16x16x32_bf16 v[140:143], a[140:143], a[76:79], v[140:143]
    buffer_load_dwordx4 a[232:235], v254, s[8:11], s42 offen offset:1024 sc1
    v_mfma_f32_16x16x32_bf16 v[140:143], a[152:155], a[64:67], v[140:143]
    ds_read_b128 a[76:79], v253 offset:32512
    v_mfma_f32_16x16x32_bf16 v[140:143], a[164:167], a[68:71], v[140:143]
    s_waitcnt lgkmcnt(6)
    s_add_u32 s44, s40, 589824
sub35:
    v_mfma_f32_16x16x32_bf16 v[144:147], a[96:99], a[48:51], v[144:147]
    buffer_load_dwordx4 a[236:239], v254, s[8:11], s42 offen offset:2048 sc1
    v_mfma_f32_16x16x32_bf16 v[144:147], a[108:111], a[52:55], v[144:147]
    s_add_u32 s42, s36, 39936
    v_mfma_f32_16x16x32_bf16 v[144:147], a[120:123], a[56:59], v[144:147]
    s_waitcnt lgkmcnt(0)
    v_mfma_f32_16x16x32_bf16 v[144:147], a[132:135], a[64:67], v[144:147]
    s_barrier
    v_mfma_f32_16x16x32_bf16 v[144:147], a[144:147], a[68:71], v[144:147]
    buffer_load_dwordx4 a[240:243], v254, s[8:11], s42 offen offset:0 sc1
    v_mfma_f32_16x16x32_bf16 v[144:147], a[156:159], a[72:75], v[144:147]
    v_cvt_pk_bf16_f32 v132, v132, v133
    v_cvt_pk_bf16_f32 v133, v134, v135
    v_mfma_f32_16x16x32_bf16 v[148:151], a[160:163], a[72:75], v[148:151]
    v_cvt_pk_bf16_f32 v134, v136, v137
    v_cvt_pk_bf16_f32 v135, v138, v139
    v_mfma_f32_16x16x32_bf16 v[148:151], a[148:151], a[68:71], v[148:151]
    ds_write_b128 v4, v[132:135] offset:17792
    v_mfma_f32_16x16x32_bf16 v[148:151], a[136:139], a[64:67], v[148:151]
    buffer_load_dwordx4 a[244:247], v254, s[8:11], s42 offen offset:1024 sc1
    v_mfma_f32_16x16x32_bf16 v[148:151], a[124:127], a[56:59], v[148:151]
    ds_read_b128 v[96:99], v6 offset:16640
    v_cvt_pk_bf16_f32 v140, v140, v141
    v_cvt_pk_bf16_f32 v141, v142, v143
    v_mfma_f32_16x16x32_bf16 v[148:151], a[112:115], a[52:55], v[148:151]
    ds_read_b128 v[100:103], v6 offset:19744
    v_mfma_f32_16x16x32_bf16 v[148:151], a[100:103], a[48:51], v[148:151]
    ds_write_b64 v5, v[140:141] offset:17856
    v_mfma_f32_16x16x32_bf16 v[152:155], a[104:107], a[48:51], v[152:155]
    buffer_load_dwordx4 a[248:251], v254, s[8:11], s42 offen offset:2048 sc1
    v_mfma_f32_16x16x32_bf16 v[152:155], a[116:119], a[52:55], v[152:155]
    s_add_u32 s42, s36, 43008
    v_mfma_f32_16x16x32_bf16 v[152:155], a[128:131], a[56:59], v[152:155]
    ds_read_b128 a[48:51], v253 offset:30176
    s_waitcnt lgkmcnt(3)
    v_mfma_f32_16x16x32_bf16 v[152:155], a[140:143], a[64:67], v[152:155]
    ds_read_b128 a[64:67], v253 offset:32256
    v_mfma_f32_16x16x32_bf16 v[152:155], a[152:155], a[68:71], v[152:155]
    buffer_load_dwordx4 a[252:255], v254, s[8:11], s42 offen offset:0 sc1
    v_mfma_f32_16x16x32_bf16 v[152:155], a[164:167], a[72:75], v[152:155]
    ds_read_b128 v[104:107], v6 offset:22848
    v_mfma_f32_16x16x32_bf16 v[156:159], a[96:99], a[52:55], v[156:159]
    buffer_store_dwordx4 v[96:99], v254, s[12:15], s44 offen nt
    s_add_u32 s44, s40, 592896
    s_waitcnt lgkmcnt(4)
    v_mfma_f32_16x16x32_bf16 v[156:159], a[108:111], a[56:59], v[156:159]
    v_cvt_pk_bf16_f32 v144, v144, v145
    v_cvt_pk_bf16_f32 v145, v146, v147
    v_mfma_f32_16x16x32_bf16 v[156:159], a[120:123], a[60:63], v[156:159]
    v_cvt_pk_bf16_f32 v146, v148, v149
    v_cvt_pk_bf16_f32 v147, v150, v151
    v_mfma_f32_16x16x32_bf16 v[156:159], a[132:135], a[68:71], v[156:159]
    buffer_load_dwordx4 v[240:243], v254, s[8:11], s42 offen offset:1024 sc1
    v_mfma_f32_16x16x32_bf16 v[156:159], a[144:147], a[72:75], v[156:159]
    v_mfma_f32_16x16x32_bf16 v[156:159], a[156:159], a[76:79], v[156:159]
    ds_write_b128 v4, v[144:147] offset:18176
    v_mfma_f32_16x16x32_bf16 v[160:163], a[160:163], a[76:79], v[160:163]
    ds_read_b128 v[108:111], v6 offset:25952
    v_mfma_f32_16x16x32_bf16 v[160:163], a[148:151], a[72:75], v[160:163]
    buffer_load_dwordx4 v[244:247], v254, s[8:11], s42 offen offset:2048 sc1
    v_mfma_f32_16x16x32_bf16 v[160:163], a[136:139], a[68:71], v[160:163]
    v_cvt_pk_bf16_f32 v152, v152, v153
    v_cvt_pk_bf16_f32 v153, v154, v155
    v_mfma_f32_16x16x32_bf16 v[160:163], a[124:127], a[60:63], v[160:163]
    buffer_store_dwordx4 v[100:103], v254, s[12:15], s44 offen nt
    v_and_b32 v215, 0x7fff, v255
    s_add_u32 s44, s40, 595968
    v_mfma_f32_16x16x32_bf16 v[160:163], a[112:115], a[56:59], v[160:163]
    buffer_load_dwordx2 v[204:205], v215, s[4:7], s16 offen offset:448
    v_mfma_f32_16x16x32_bf16 v[160:163], a[100:103], a[52:55], v[160:163]
    ds_write_b64 v5, v[152:153] offset:18240
    v_mfma_f32_16x16x32_bf16 v[164:167], a[104:107], a[52:55], v[164:167]
    ds_read_b128 a[52:55], v253 offset:29904
    s_waitcnt lgkmcnt(4)
    v_mfma_f32_16x16x32_bf16 v[164:167], a[116:119], a[56:59], v[164:167]
    ds_write_b64 v218, v[222:223] offset:4160
    v_mfma_f32_16x16x32_bf16 v[164:167], a[128:131], a[60:63], v[164:167]
    buffer_load_dwordx2 v[206:207], v215, s[4:7], s17 offen offset:448
    v_mfma_f32_16x16x32_bf16 v[164:167], a[140:143], a[68:71], v[164:167]
    ds_read_b128 a[68:71], v253 offset:31984
    v_mfma_f32_16x16x32_bf16 v[164:167], a[152:155], a[72:75], v[164:167]
    ds_write_b64 v218, v[216:217] offset:33280
    v_mfma_f32_16x16x32_bf16 v[164:167], a[164:167], a[76:79], v[164:167]
    v_mfma_f32_16x16x32_bf16 v[168:171], a[96:99], a[56:59], v[168:171]
    buffer_load_dwordx2 v[208:209], v215, s[4:7], s18 offen offset:448
    v_mfma_f32_16x16x32_bf16 v[168:171], a[108:111], a[60:63], v[168:171]
    v_cvt_pk_bf16_f32 v156, v156, v157
    v_cvt_pk_bf16_f32 v157, v158, v159
    v_mfma_f32_16x16x32_bf16 v[168:171], a[120:123], a[48:51], v[168:171]
    v_cvt_pk_bf16_f32 v158, v160, v161
    v_cvt_pk_bf16_f32 v159, v162, v163
    v_mfma_f32_16x16x32_bf16 v[168:171], a[132:135], a[72:75], v[168:171]
    ds_write_b128 v4, v[156:159] offset:18560
    v_mfma_f32_16x16x32_bf16 v[168:171], a[144:147], a[76:79], v[168:171]
    v_mfma_f32_16x16x32_bf16 v[168:171], a[156:159], a[64:67], v[168:171]
    buffer_load_dwordx2 v[210:211], v215, s[4:7], s19 offen offset:448
    v_mfma_f32_16x16x32_bf16 v[172:175], a[160:163], a[64:67], v[172:175]
    v_mfma_f32_16x16x32_bf16 v[172:175], a[148:151], a[76:79], v[172:175]
    v_cvt_pk_bf16_f32 v164, v164, v165
    v_cvt_pk_bf16_f32 v165, v166, v167
    v_mfma_f32_16x16x32_bf16 v[172:175], a[136:139], a[72:75], v[172:175]
    ds_write_b64 v5, v[164:165] offset:18624
    v_mfma_f32_16x16x32_bf16 v[172:175], a[124:127], a[48:51], v[172:175]
    buffer_load_dwordx2 v[212:213], v215, s[4:7], s20 offen offset:448
    v_mfma_f32_16x16x32_bf16 v[172:175], a[112:115], a[60:63], v[172:175]
    ds_write_b64 v218, v[226:227] offset:35360
    v_mfma_f32_16x16x32_bf16 v[172:175], a[100:103], a[56:59], v[172:175]
    v_mfma_f32_16x16x32_bf16 v[176:179], a[104:107], a[56:59], v[176:179]
    ds_write_b64 v218, v[220:221] offset:6240
    v_mfma_f32_16x16x32_bf16 v[176:179], a[116:119], a[60:63], v[176:179]
    buffer_load_dwordx2 v[214:215], v215, s[4:7], s21 offen offset:448
    v_mfma_f32_16x16x32_bf16 v[176:179], a[128:131], a[48:51], v[176:179]
    s_waitcnt lgkmcnt(0)
    v_mfma_f32_16x16x32_bf16 v[176:179], a[140:143], a[72:75], v[176:179]
    s_barrier
    v_mfma_f32_16x16x32_bf16 v[176:179], a[152:155], a[76:79], v[176:179]
    ds_read_b128 v[228:231], v253 offset:1040
    v_mfma_f32_16x16x32_bf16 v[176:179], a[164:167], a[64:67], v[176:179]
    ds_read_b128 v[232:235], v253 offset:768
    v_mfma_f32_16x16x32_bf16 v[180:183], a[96:99], a[60:63], v[180:183]
    ds_read_b128 v[236:239], v253 offset:512
    v_mfma_f32_16x16x32_bf16 v[180:183], a[108:111], a[48:51], v[180:183]
    v_cvt_pk_bf16_f32 v168, v168, v169
    v_cvt_pk_bf16_f32 v169, v170, v171
    v_mfma_f32_16x16x32_bf16 v[180:183], a[120:123], a[52:55], v[180:183]
    buffer_store_dwordx4 v[104:107], v254, s[12:15], s44 offen nt
    v_cvt_pk_bf16_f32 v170, v172, v173
    v_cvt_pk_bf16_f32 v171, v174, v175
    v_mfma_f32_16x16x32_bf16 v[180:183], a[132:135], a[76:79], v[180:183]
    ds_write_b128 v4, v[168:171] offset:18944
    v_mfma_f32_16x16x32_bf16 v[180:183], a[144:147], a[64:67], v[180:183]
    s_add_u32 s44, s40, 599040
    v_mfma_f32_16x16x32_bf16 v[180:183], a[156:159], a[68:71], v[180:183]
    ds_read_b128 v[112:115], v6 offset:17664
    v_mfma_f32_16x16x32_bf16 v[184:187], a[160:163], a[68:71], v[184:187]
    ds_read_b128 v[116:119], v6 offset:20768
    v_mfma_f32_16x16x32_bf16 v[184:187], a[148:151], a[64:67], v[184:187]
    buffer_store_dwordx4 v[108:111], v254, s[12:15], s44 offen nt
    v_cvt_pk_bf16_f32 v176, v176, v177
    v_cvt_pk_bf16_f32 v177, v178, v179
    v_mfma_f32_16x16x32_bf16 v[184:187], a[136:139], a[76:79], v[184:187]
    ds_write_b64 v5, v[176:177] offset:19008
    v_mfma_f32_16x16x32_bf16 v[184:187], a[124:127], a[52:55], v[184:187]
    ds_read_b128 v[120:123], v6 offset:23872
    s_add_u32 s44, s40, 590848
    v_mfma_f32_16x16x32_bf16 v[184:187], a[112:115], a[48:51], v[184:187]
    ds_read_b128 v[124:127], v6 offset:26976
    s_waitcnt lgkmcnt(4)
    v_mfma_f32_16x16x32_bf16 v[184:187], a[100:103], a[60:63], v[184:187]
    buffer_store_dwordx4 v[112:115], v254, s[12:15], s44 offen nt
    s_add_u32 s44, s40, 593920
    s_waitcnt lgkmcnt(3)
    v_mfma_f32_16x16x32_bf16 v[188:191], a[104:107], a[60:63], v[188:191]
    v_mfma_f32_16x16x32_bf16 v[188:191], a[116:119], a[48:51], v[188:191]
    buffer_store_dwordx4 v[116:119], v254, s[12:15], s44 offen nt
    s_add_u32 s44, s40, 596992
    v_mfma_f32_16x16x32_bf16 v[188:191], a[128:131], a[52:55], v[188:191]
    s_waitcnt lgkmcnt(1)
    v_mfma_f32_16x16x32_bf16 v[188:191], a[140:143], a[76:79], v[188:191]
    buffer_store_dwordx4 v[120:123], v254, s[12:15], s44 offen nt
    v_mfma_f32_16x16x32_bf16 v[188:191], a[152:155], a[64:67], v[188:191]
    v_mfma_f32_16x16x32_bf16 v[188:191], a[164:167], a[68:71], v[188:191]
    s_waitcnt vmcnt(37)
    s_add_u32 s41, s40, 589824
    s_add_u32 s40, s40, 6291456
    s_add_u32 s39, s39, 1
    s_cmp_lt_u32 s39, 2
    s_cbranch_scc1 blk_loop
    s_add_u32 s44, s41, 10240
    s_waitcnt lgkmcnt(0)
    buffer_store_dwordx4 v[124:127], v254, s[12:15], s44 offen nt
    v_cvt_pk_bf16_f32 v180, v180, v181
    v_cvt_pk_bf16_f32 v181, v182, v183
    v_cvt_pk_bf16_f32 v182, v184, v185
    v_cvt_pk_bf16_f32 v183, v186, v187
    ds_write_b128 v4, v[180:183] offset:19328
    v_cvt_pk_bf16_f32 v188, v188, v189
    v_cvt_pk_bf16_f32 v189, v190, v191
    ds_write_b64 v5, v[188:189] offset:19392
    s_waitcnt lgkmcnt(0)
    s_barrier
    ds_read_b128 v[32:35], v6 offset:18688
    ds_read_b128 v[36:39], v6 offset:21792
    ds_read_b128 v[40:43], v6 offset:24896
    ds_read_b128 v[44:47], v6 offset:28000
    s_add_u32 s44, s41, 2048
    s_waitcnt lgkmcnt(3)
    buffer_store_dwordx4 v[32:35], v254, s[12:15], s44 offen nt
    s_add_u32 s44, s41, 5120
    s_waitcnt lgkmcnt(2)
    buffer_store_dwordx4 v[36:39], v254, s[12:15], s44 offen nt
    s_add_u32 s44, s41, 8192
    s_waitcnt lgkmcnt(1)
    buffer_store_dwordx4 v[40:43], v254, s[12:15], s44 offen nt
    s_add_u32 s44, s41, 11264
    s_waitcnt lgkmcnt(0)
    buffer_store_dwordx4 v[44:47], v254, s[12:15], s44 offen nt
main_done:
    s_endpgm
code_end:
wt_loop:
    s_mul_i32 s73, s70, 43691
    s_lshr_b32 s73, s73, 17
    s_mul_i32 s74, s73, 3
    s_sub_u32 s74, s70, s74
    s_mul_i32 s75, s73, 43691
    s_lshr_b32 s75, s75, 17
    s_mul_i32 s76, s75, 3
    s_sub_u32 s76, s73, s76
    v_and_b32 v101, 15, v2
    v_lshrrev_b32 v102, 4, v2
    v_and_b32 v103, 12, v101
    s_lshl_b32 s78, s74, 2
    s_cmp_lt_u32 s74, 2
    s_cselect_b32 s77, 1, 0
    s_cselect_b32 s78, s78, 32
    v_mul_u32_u24 v103, s77, v103
    v_add_u32 v103, v103, v101
    v_add_u32 v103, s78, v103
    v_lshl_add_u32 v103, v103, 1, s52
    v_mul_u32_u24 v104, 3072, v102
    v_add_u32 v103, v103, v104
    s_mul_i32 s79, s76, 73728
    s_mul_i32 s80, s75, 12288
    s_add_u32 s79, s79, s80
    s_add_u32 s80, s79, 221184
    s_add_u32 s81, s79, 442368
    buffer_load_ushort v110, v103, s[60:63], s79 offen offset:0
    buffer_load_ushort v111, v103, s[60:63], s79 offen offset:384
    buffer_load_ushort v112, v103, s[60:63], s79 offen offset:768
    buffer_load_ushort v113, v103, s[60:63], s79 offen offset:1152
    buffer_load_ushort v114, v103, s[60:63], s79 offen offset:1536
    buffer_load_ushort v115, v103, s[60:63], s79 offen offset:1920
    buffer_load_ushort v116, v103, s[60:63], s79 offen offset:2304
    buffer_load_ushort v117, v103, s[60:63], s79 offen offset:2688
    buffer_load_ushort v118, v103, s[60:63], s80 offen offset:0
    buffer_load_ushort v119, v103, s[60:63], s80 offen offset:384
    buffer_load_ushort v120, v103, s[60:63], s80 offen offset:768
    buffer_load_ushort v121, v103, s[60:63], s80 offen offset:1152
    buffer_load_ushort v122, v103, s[60:63], s80 offen offset:1536
    buffer_load_ushort v123, v103, s[60:63], s80 offen offset:1920
    buffer_load_ushort v124, v103, s[60:63], s80 offen offset:2304
    buffer_load_ushort v125, v103, s[60:63], s80 offen offset:2688
    buffer_load_ushort v126, v103, s[60:63], s81 offen offset:0
    buffer_load_ushort v127, v103, s[60:63], s81 offen offset:384
    buffer_load_ushort v128, v103, s[60:63], s81 offen offset:768
    buffer_load_ushort v129, v103, s[60:63], s81 offen offset:1152
    buffer_load_ushort v130, v103, s[60:63], s81 offen offset:1536
    buffer_load_ushort v131, v103, s[60:63], s81 offen offset:1920
    buffer_load_ushort v132, v103, s[60:63], s81 offen offset:2304
    buffer_load_ushort v133, v103, s[60:63], s81 offen offset:2688
    s_mul_i32 s82, s76, 3072
    s_lshl_b32 s83, s74, 10
    s_add_u32 s82, s82, s83
    s_mul_i32 s83, s75, 36864
    s_lshl_b32 s84, s83, 2
    s_add_u32 s83, s83, s82
    s_add_u32 s84, s84, s82
    s_waitcnt vmcnt(0)
    v_lshlrev_b32 v110, 16, v110
    v_lshlrev_b32 v111, 16, v111
    v_lshlrev_b32 v112, 16, v112
    v_lshlrev_b32 v113, 16, v113
    v_lshlrev_b32 v114, 16, v114
    v_lshlrev_b32 v115, 16, v115
    v_lshlrev_b32 v116, 16, v116
    v_lshlrev_b32 v117, 16, v117
    v_lshlrev_b32 v118, 16, v118
    v_lshlrev_b32 v119, 16, v119
    v_lshlrev_b32 v120, 16, v120
    v_lshlrev_b32 v121, 16, v121
    v_lshlrev_b32 v122, 16, v122
    v_lshlrev_b32 v123, 16, v123
    v_lshlrev_b32 v124, 16, v124
    v_lshlrev_b32 v125, 16, v125
    v_lshlrev_b32 v126, 16, v126
    v_lshlrev_b32 v127, 16, v127
    v_lshlrev_b32 v128, 16, v128
    v_lshlrev_b32 v129, 16, v129
    v_lshlrev_b32 v130, 16, v130
    v_lshlrev_b32 v131, 16, v131
    v_lshlrev_b32 v132, 16, v132
    v_lshlrev_b32 v133, 16, v133
    v_mul_f32 v136, 0xbedba55c, v110
    v_fmac_f32 v136, 0xbe0afea5, v126
    v_fmamk_f32 v144, v118, 0xbe771a08, v136
    v_fmac_f32 v136, 0x3e771a08, v118
    v_mul_f32 v137, 0xbedba55c, v111
    v_fmac_f32 v137, 0xbe0afea5, v127
    v_fmamk_f32 v145, v119, 0xbe771a08, v137
    v_fmac_f32 v137, 0x3e771a08, v119
    v_mul_f32 v138, 0xbedba55c, v112
    v_fmac_f32 v138, 0xbe0afea5, v128
    v_fmamk_f32 v146, v120, 0xbe771a08, v138
    v_fmac_f32 v138, 0x3e771a08, v120
    v_mul_f32 v139, 0xbedba55c, v113
    v_fmac_f32 v139, 0xbe0afea5, v129
    v_fmamk_f32 v147, v121, 0xbe771a08, v139
    v_fmac_f32 v139, 0x3e771a08, v121
    v_mul_f32 v140, 0xbedba55c, v114
    v_fmac_f32 v140, 0xbe0afea5, v130
    v_fmamk_f32 v148, v122, 0xbe771a08, v140
    v_fmac_f32 v140, 0x3e771a08, v122
    v_mul_f32 v141, 0xbedba55c, v115
    v_fmac_f32 v141, 0xbe0afea5, v131
    v_fmamk_f32 v149, v123, 0xbe771a08, v141
    v_fmac_f32 v141, 0x3e771a08, v123
    v_mul_f32 v142, 0xbedba55c, v116
    v_fmac_f32 v142, 0xbe0afea5, v132
    v_fmamk_f32 v150, v124, 0xbe771a08, v142
    v_fmac_f32 v142, 0x3e771a08, v124
    v_mul_f32 v143, 0xbedba55c, v117
    v_fmac_f32 v143, 0xbe0afea5, v133
    v_fmamk_f32 v151, v125, 0xbe771a08, v143
    v_fmac_f32 v143, 0x3e771a08, v125
    v_cvt_pk_bf16_f32 v156, v144, v145
    v_cvt_pk_bf16_f32 v157, v146, v147
    v_cvt_pk_bf16_f32 v158, v148, v149
    v_cvt_pk_bf16_f32 v159, v150, v151
    s_add_u32 s85, s84, 0
    buffer_store_dwordx4 v[156:159], v254, s[8:11], s85 offen sc1
    v_cvt_pk_bf16_f32 v160, v136, v137
    v_cvt_pk_bf16_f32 v161, v138, v139
    v_cvt_pk_bf16_f32 v162, v140, v141
    v_cvt_pk_bf16_f32 v163, v142, v143
    s_add_u32 s85, s84, 36864
    buffer_store_dwordx4 v[160:163], v254, s[8:11], s85 offen sc1
    v_mul_f32 v136, 0x3e0afea5, v110
    v_fmac_f32 v136, 0x3f0afea5, v126
    v_fmamk_f32 v144, v118, 0x3e8afea5, v136
    v_fmac_f32 v136, 0xbe8afea5, v118
    v_mul_f32 v137, 0x3e0afea5, v111
    v_fmac_f32 v137, 0x3f0afea5, v127
    v_fmamk_f32 v145, v119, 0x3e8afea5, v137
    v_fmac_f32 v137, 0xbe8afea5, v119
    v_mul_f32 v138, 0x3e0afea5, v112
    v_fmac_f32 v138, 0x3f0afea5, v128
    v_fmamk_f32 v146, v120, 0x3e8afea5, v138
    v_fmac_f32 v138, 0xbe8afea5, v120
    v_mul_f32 v139, 0x3e0afea5, v113
    v_fmac_f32 v139, 0x3f0afea5, v129
    v_fmamk_f32 v147, v121, 0x3e8afea5, v139
    v_fmac_f32 v139, 0xbe8afea5, v121
    v_mul_f32 v140, 0x3e0afea5, v114
    v_fmac_f32 v140, 0x3f0afea5, v130
    v_fmamk_f32 v148, v122, 0x3e8afea5, v140
    v_fmac_f32 v140, 0xbe8afea5, v122
    v_mul_f32 v141, 0x3e0afea5, v115
    v_fmac_f32 v141, 0x3f0afea5, v131
    v_fmamk_f32 v149, v123, 0x3e8afea5, v141
    v_fmac_f32 v141, 0xbe8afea5, v123
    v_mul_f32 v142, 0x3e0afea5, v116
    v_fmac_f32 v142, 0x3f0afea5, v132
    v_fmamk_f32 v150, v124, 0x3e8afea5, v142
    v_fmac_f32 v142, 0xbe8afea5, v124
    v_mul_f32 v143, 0x3e0afea5, v117
    v_fmac_f32 v143, 0x3f0afea5, v133
    v_fmamk_f32 v151, v125, 0x3e8afea5, v143
    v_fmac_f32 v143, 0xbe8afea5, v125
    v_cvt_pk_bf16_f32 v164, v144, v145
    v_cvt_pk_bf16_f32 v165, v146, v147
    v_cvt_pk_bf16_f32 v166, v148, v149
    v_cvt_pk_bf16_f32 v167, v150, v151
    s_add_u32 s85, s84, 73728
    buffer_store_dwordx4 v[164:167], v254, s[8:11], s85 offen sc1
    v_cvt_pk_bf16_f32 v168, v136, v137
    v_cvt_pk_bf16_f32 v169, v138, v139
    v_cvt_pk_bf16_f32 v170, v140, v141
    v_cvt_pk_bf16_f32 v171, v142, v143
    s_add_u32 s85, s84, 110592
    buffer_store_dwordx4 v[168:171], v254, s[8:11], s85 offen sc1
    v_cvt_pk_bf16_f32 v152, v110, v111
    v_cvt_pk_bf16_f32 v153, v112, v113
    v_cvt_pk_bf16_f32 v154, v114, v115
    v_cvt_pk_bf16_f32 v155, v116, v117
    s_add_u32 s85, s83, 884736
    buffer_store_dwordx4 v[152:155], v254, s[8:11], s85 offen sc1
    v_cvt_pk_bf16_f32 v172, v126, v127
    v_cvt_pk_bf16_f32 v173, v128, v129
    v_cvt_pk_bf16_f32 v174, v130, v131
    v_cvt_pk_bf16_f32 v175, v132, v133
    s_add_u32 s85, s83, 1105920
    buffer_store_dwordx4 v[172:175], v254, s[8:11], s85 offen sc1
    s_add_u32 s70, s70, 1
    s_cmp_lt_u32 s70, 54
    s_cbranch_scc1 wt_loop
    s_waitcnt vmcnt(0)
    s_branch u_ready
.section .rodata,"a"
.p2align 6
.amdhsa_kernel standalone__winograd__vision_kernel
  .amdhsa_next_free_vgpr 512
  .amdhsa_next_free_sgpr 102
  .amdhsa_accum_offset 256
  .amdhsa_group_segment_fixed_size 0
  .amdhsa_kernarg_size 40
  .amdhsa_user_sgpr_count 2
  .amdhsa_user_sgpr_kernarg_segment_ptr 1
  .amdhsa_system_sgpr_workgroup_id_x 1
  .amdhsa_ieee_mode 0
.end_amdhsa_kernel
```

```asm
; @launch grid=(256,1,1) block=(256,1,1) lds=163840
.amdgcn_target "amdgcn-amd-amdhsa--gfx950"
.text
.globl standalone__winograd__vision_kernel
.p2align 8
.type standalone__winograd__vision_kernel,@function
standalone__winograd__vision_kernel:
    s_cmp_ge_u32 s2, 256
    s_cbranch_scc1 main_done
    s_load_dwordx2 s[60:61], s[0:1], 8
    s_load_dwordx2 s[4:5], s[0:1], 0
    s_load_dwordx4 s[12:15], s[0:1], 16
    s_load_dwordx2 s[8:9], s[0:1], 32
    s_getpc_b64 s[92:93]
pcref:
    v_and_b32 v70, 3, v0
    v_lshrrev_b32 v71, 6, v0
    v_lshl_add_u32 v70, v70, 7, v71
    s_lshr_b32 s94, s2, 3
    s_lshl_b32 s94, s94, 2
    v_add_lshl_u32 v70, v70, s94, 7
    v_min_u32 v70, code_end-pcref-4, v70
    v_add_co_u32 v72, vcc, s92, v70
    v_mov_b32 v73, s93
    s_nop 0
    v_addc_co_u32 v73, vcc, 0, v73, vcc
    global_load_dword v76, v[72:73], off
    v_lshrrev_b32 v1, 6, v0
    v_and_b32 v2, 63, v0
    v_readfirstlane_b32 s38, v1
    s_mov_b32 s62, 663552
    s_mov_b32 s63, 0x20000
    s_mov_b32 s70, s2
    s_mul_i32 s52, s38, 96
    s_cmp_ge_u32 s2, 54
    s_cbranch_scc1 wl_skip
    s_mul_i32 s73, s70, 43691
    s_lshr_b32 s73, s73, 17
    s_mul_i32 s74, s73, 3
    s_sub_u32 s74, s70, s74
    s_mul_i32 s75, s73, 43691
    s_lshr_b32 s75, s75, 17
    s_mul_i32 s76, s75, 3
    s_sub_u32 s76, s73, s76
    v_and_b32 v101, 14, v2
    v_lshrrev_b32 v102, 4, v2
    v_and_b32 v103, 12, v101
    v_and_b32 v105, 1, v2
    s_lshl_b32 s78, s74, 2
    s_cmp_lt_u32 s74, 2
    s_cselect_b32 s77, 1, 0
    s_cselect_b32 s78, s78, 32
    v_mul_u32_u24 v103, s77, v103
    v_add_u32 v103, v103, v101
    v_add_u32 v103, s78, v103
    v_lshl_add_u32 v103, v103, 1, s52
    v_lshl_add_u32 v102, v102, 1, v105
    v_mul_u32_u24 v104, 1536, v102
    v_add_u32 v103, v103, v104
    s_mul_i32 s79, s76, 73728
    s_mul_i32 s80, s75, 12288
    s_add_u32 s79, s79, s80
    s_add_u32 s80, s79, 221184
    s_add_u32 s81, s79, 442368
    s_waitcnt lgkmcnt(0)
    s_and_b32 s61, s61, 0xffff
    buffer_load_dword v136, v103, s[60:63], s79 offen offset:0
    buffer_load_dword v137, v103, s[60:63], s79 offen offset:384
    buffer_load_dword v138, v103, s[60:63], s79 offen offset:768
    buffer_load_dword v139, v103, s[60:63], s79 offen offset:1152
    buffer_load_dword v140, v103, s[60:63], s80 offen offset:0
    buffer_load_dword v141, v103, s[60:63], s80 offen offset:384
    buffer_load_dword v142, v103, s[60:63], s80 offen offset:768
    buffer_load_dword v143, v103, s[60:63], s80 offen offset:1152
    buffer_load_dword v144, v103, s[60:63], s81 offen offset:0
    buffer_load_dword v145, v103, s[60:63], s81 offen offset:384
    buffer_load_dword v146, v103, s[60:63], s81 offen offset:768
    buffer_load_dword v147, v103, s[60:63], s81 offen offset:1152
    v_mul_u32_u24 v106, 0x0202, v105
    v_sub_u32 v106, 0x0504, v106
    v_mul_u32_u24 v107, 0x0606, v105
    v_add_u32 v107, 0x0100, v107
    v_mov_b32 v108, 0x0c0c
    v_lshl_or_b32 v106, v106, 16, v108
    v_lshl_or_b32 v107, v107, 16, v108
    s_mul_i32 s82, s76, 3072
    s_lshl_b32 s83, s74, 10
    s_add_u32 s82, s82, s83
    s_mul_i32 s83, s75, 36864
    s_lshl_b32 s84, s83, 2
    s_add_u32 s83, s83, s82
    s_add_u32 s84, s84, s82
wl_skip:
    v_lshlrev_b32 v254, 4, v2
    v_mov_b32 v98, 0
    v_lshrrev_b32 v3, 3, v2
    v_and_b32 v4, 7, v2
    v_mul_u32_u24 v5, 3072, v3
    v_lshl_add_u32 v255, v4, 3, v5
    s_lshr_b32 s44, s2, 3
    s_and_b32 s48, s44, 3
    s_lshr_b32 s44, s44, 2
    s_and_b32 s49, s2, 7
    s_lshl_b32 s49, s49, 4
    s_add_u32 s49, s49, s44
    s_and_b32 s90, s38, 1
    s_lshr_b32 s91, s38, 1
    s_mul_i32 s50, s90, 24576
    s_mul_i32 s45, s91, 1536
    s_add_u32 s50, s50, s45
    s_mul_i32 s101, s38, 196608
    s_sub_u32 s101, s101, s50
    s_mul_i32 s53, s48, 49152
    s_add_u32 s53, s53, s50
    s_mul_i32 s43, s49, 786432
    s_add_u32 s43, s43, s53
    s_cmp_ge_u32 s49, 128
    s_cselect_b32 s43, 2130706432, s43
    s_sub_u32 s16, s43, 196608
    s_cmp_eq_u32 s49, 0
    s_cselect_b32 s16, 2130706432, s16
    s_mov_b32 s17, s43
    s_add_u32 s18, s43, 196608
    s_add_u32 s19, s43, 393216
    s_add_u32 s20, s43, 589824
    s_add_u32 s21, s43, 786432
    s_add_u32 s100, s43, s101
    v_mov_b32 v80, v255
    s_mov_b32 s6, 100663296
    s_mov_b32 s7, 0x20000
    s_waitcnt lgkmcnt(0)
    s_and_b32 s5, s5, 0xffff
    s_cmp_lt_u32 s2, 54
    s_cbranch_scc1 wt_path
    buffer_load_dwordx2 v[8:9], v80, s[4:7], s16 offen offset:0
    buffer_load_dwordx2 v[10:11], v80, s[4:7], s17 offen offset:0
    buffer_load_dwordx2 v[12:13], v80, s[4:7], s18 offen offset:0
    buffer_load_dwordx2 v[14:15], v80, s[4:7], s19 offen offset:0
    buffer_load_dwordx2 v[16:17], v80, s[4:7], s20 offen offset:0
    buffer_load_dwordx2 v[18:19], v80, s[4:7], s21 offen offset:0
    buffer_load_dwordx2 v[20:21], v80, s[4:7], s16 offen offset:384
    buffer_load_dwordx2 v[22:23], v80, s[4:7], s17 offen offset:384
    buffer_load_dwordx2 v[24:25], v80, s[4:7], s18 offen offset:384
    buffer_load_dwordx2 v[26:27], v80, s[4:7], s19 offen offset:384
    buffer_load_dwordx2 v[28:29], v80, s[4:7], s20 offen offset:384
    buffer_load_dwordx2 v[30:31], v80, s[4:7], s21 offen offset:384
    s_and_b32 s61, s61, 0xffff
    s_mul_i32 s44, s38, 9216
    s_add_u32 s8, s8, s44
    s_addc_u32 s9, s9, 0
    s_and_b32 s9, s9, 0xffff
    s_mov_b32 s10, 1299456
    s_mov_b32 s11, 0x20000
    s_mov_b32 s64, s14
    s_and_b32 s65, s15, 0xffff
    s_mov_b32 s66, 256
    s_mov_b32 s67, 0x20000
    s_mov_b64 s[68:69], s[14:15]
    s_branch wt_join
wt_path:
    s_and_b32 s61, s61, 0xffff
    s_mul_i32 s44, s38, 9216
    s_add_u32 s8, s8, s44
    s_addc_u32 s9, s9, 0
    s_and_b32 s9, s9, 0xffff
    s_mov_b32 s10, 1299456
    s_mov_b32 s11, 0x20000
    s_mov_b32 s64, s14
    s_and_b32 s65, s15, 0xffff
    s_mov_b32 s66, 256
    s_mov_b32 s67, 0x20000
    s_mov_b64 s[68:69], s[14:15]
    s_waitcnt vmcnt(0)
    v_mov_b32_dpp v152, v136 quad_perm:[1,0,3,2] row_mask:0xf bank_mask:0xf
    v_mov_b32_dpp v153, v137 quad_perm:[1,0,3,2] row_mask:0xf bank_mask:0xf
    v_mov_b32_dpp v154, v138 quad_perm:[1,0,3,2] row_mask:0xf bank_mask:0xf
    v_mov_b32_dpp v155, v139 quad_perm:[1,0,3,2] row_mask:0xf bank_mask:0xf
    v_mov_b32_dpp v156, v140 quad_perm:[1,0,3,2] row_mask:0xf bank_mask:0xf
    v_mov_b32_dpp v157, v141 quad_perm:[1,0,3,2] row_mask:0xf bank_mask:0xf
    v_mov_b32_dpp v158, v142 quad_perm:[1,0,3,2] row_mask:0xf bank_mask:0xf
    v_mov_b32_dpp v159, v143 quad_perm:[1,0,3,2] row_mask:0xf bank_mask:0xf
    v_mov_b32_dpp v160, v144 quad_perm:[1,0,3,2] row_mask:0xf bank_mask:0xf
    v_mov_b32_dpp v161, v145 quad_perm:[1,0,3,2] row_mask:0xf bank_mask:0xf
    v_mov_b32_dpp v162, v146 quad_perm:[1,0,3,2] row_mask:0xf bank_mask:0xf
    v_mov_b32_dpp v163, v147 quad_perm:[1,0,3,2] row_mask:0xf bank_mask:0xf
    v_perm_b32 v110, v136, v152, v106
    v_perm_b32 v114, v136, v152, v107
    v_perm_b32 v111, v137, v153, v106
    v_perm_b32 v115, v137, v153, v107
    v_perm_b32 v112, v138, v154, v106
    v_perm_b32 v116, v138, v154, v107
    v_perm_b32 v113, v139, v155, v106
    v_perm_b32 v117, v139, v155, v107
    v_perm_b32 v118, v140, v156, v106
    v_perm_b32 v122, v140, v156, v107
    v_perm_b32 v119, v141, v157, v106
    v_perm_b32 v123, v141, v157, v107
    v_perm_b32 v120, v142, v158, v106
    v_perm_b32 v124, v142, v158, v107
    v_perm_b32 v121, v143, v159, v106
    v_perm_b32 v125, v143, v159, v107
    v_perm_b32 v126, v144, v160, v106
    v_perm_b32 v130, v144, v160, v107
    v_perm_b32 v127, v145, v161, v106
    v_perm_b32 v131, v145, v161, v107
    v_perm_b32 v128, v146, v162, v106
    v_perm_b32 v132, v146, v162, v107
    v_perm_b32 v129, v147, v163, v106
    v_perm_b32 v133, v147, v163, v107
    v_mul_f32 v136, 0xbedba55c, v110
    v_fmac_f32 v136, 0xbe0afea5, v126
    v_fmamk_f32 v144, v118, 0xbe771a08, v136
    v_fmac_f32 v136, 0x3e771a08, v118
    v_mul_f32 v137, 0xbedba55c, v111
    v_fmac_f32 v137, 0xbe0afea5, v127
    v_fmamk_f32 v145, v119, 0xbe771a08, v137
    v_fmac_f32 v137, 0x3e771a08, v119
    v_mul_f32 v138, 0xbedba55c, v112
    v_fmac_f32 v138, 0xbe0afea5, v128
    v_fmamk_f32 v146, v120, 0xbe771a08, v138
    v_fmac_f32 v138, 0x3e771a08, v120
    v_mul_f32 v139, 0xbedba55c, v113
    v_fmac_f32 v139, 0xbe0afea5, v129
    v_fmamk_f32 v147, v121, 0xbe771a08, v139
    v_fmac_f32 v139, 0x3e771a08, v121
    v_mul_f32 v140, 0xbedba55c, v114
    v_fmac_f32 v140, 0xbe0afea5, v130
    v_fmamk_f32 v148, v122, 0xbe771a08, v140
    v_fmac_f32 v140, 0x3e771a08, v122
    v_mul_f32 v141, 0xbedba55c, v115
    v_fmac_f32 v141, 0xbe0afea5, v131
    v_fmamk_f32 v149, v123, 0xbe771a08, v141
    v_fmac_f32 v141, 0x3e771a08, v123
    v_mul_f32 v142, 0xbedba55c, v116
    v_fmac_f32 v142, 0xbe0afea5, v132
    v_fmamk_f32 v150, v124, 0xbe771a08, v142
    v_fmac_f32 v142, 0x3e771a08, v124
    v_mul_f32 v143, 0xbedba55c, v117
    v_fmac_f32 v143, 0xbe0afea5, v133
    v_fmamk_f32 v151, v125, 0xbe771a08, v143
    v_fmac_f32 v143, 0x3e771a08, v125
    v_cvt_pk_bf16_f32 v156, v144, v145
    v_cvt_pk_bf16_f32 v157, v146, v147
    v_cvt_pk_bf16_f32 v158, v148, v149
    v_cvt_pk_bf16_f32 v159, v150, v151
    s_add_u32 s85, s84, 0
    buffer_store_dwordx4 v[156:159], v254, s[8:11], s85 offen sc1
    v_cvt_pk_bf16_f32 v160, v136, v137
    v_cvt_pk_bf16_f32 v161, v138, v139
    v_cvt_pk_bf16_f32 v162, v140, v141
    v_cvt_pk_bf16_f32 v163, v142, v143
    s_add_u32 s85, s84, 36864
    buffer_store_dwordx4 v[160:163], v254, s[8:11], s85 offen sc1
    v_mul_f32 v136, 0x3e0afea5, v110
    v_fmac_f32 v136, 0x3f0afea5, v126
    v_fmamk_f32 v144, v118, 0x3e8afea5, v136
    v_fmac_f32 v136, 0xbe8afea5, v118
    v_mul_f32 v137, 0x3e0afea5, v111
    v_fmac_f32 v137, 0x3f0afea5, v127
    v_fmamk_f32 v145, v119, 0x3e8afea5, v137
    v_fmac_f32 v137, 0xbe8afea5, v119
    v_mul_f32 v138, 0x3e0afea5, v112
    v_fmac_f32 v138, 0x3f0afea5, v128
    v_fmamk_f32 v146, v120, 0x3e8afea5, v138
    v_fmac_f32 v138, 0xbe8afea5, v120
    v_mul_f32 v139, 0x3e0afea5, v113
    v_fmac_f32 v139, 0x3f0afea5, v129
    v_fmamk_f32 v147, v121, 0x3e8afea5, v139
    v_fmac_f32 v139, 0xbe8afea5, v121
    v_mul_f32 v140, 0x3e0afea5, v114
    v_fmac_f32 v140, 0x3f0afea5, v130
    v_fmamk_f32 v148, v122, 0x3e8afea5, v140
    v_fmac_f32 v140, 0xbe8afea5, v122
    v_mul_f32 v141, 0x3e0afea5, v115
    v_fmac_f32 v141, 0x3f0afea5, v131
    v_fmamk_f32 v149, v123, 0x3e8afea5, v141
    v_fmac_f32 v141, 0xbe8afea5, v123
    v_mul_f32 v142, 0x3e0afea5, v116
    v_fmac_f32 v142, 0x3f0afea5, v132
    v_fmamk_f32 v150, v124, 0x3e8afea5, v142
    v_fmac_f32 v142, 0xbe8afea5, v124
    v_mul_f32 v143, 0x3e0afea5, v117
    v_fmac_f32 v143, 0x3f0afea5, v133
    v_fmamk_f32 v151, v125, 0x3e8afea5, v143
    v_fmac_f32 v143, 0xbe8afea5, v125
    v_cvt_pk_bf16_f32 v164, v144, v145
    v_cvt_pk_bf16_f32 v165, v146, v147
    v_cvt_pk_bf16_f32 v166, v148, v149
    v_cvt_pk_bf16_f32 v167, v150, v151
    s_add_u32 s85, s84, 73728
    buffer_store_dwordx4 v[164:167], v254, s[8:11], s85 offen sc1
    v_cvt_pk_bf16_f32 v168, v136, v137
    v_cvt_pk_bf16_f32 v169, v138, v139
    v_cvt_pk_bf16_f32 v170, v140, v141
    v_cvt_pk_bf16_f32 v171, v142, v143
    s_add_u32 s85, s84, 110592
    buffer_store_dwordx4 v[168:171], v254, s[8:11], s85 offen sc1
    v_cvt_pk_bf16_f32 v152, v110, v111
    v_cvt_pk_bf16_f32 v153, v112, v113
    v_cvt_pk_bf16_f32 v154, v114, v115
    v_cvt_pk_bf16_f32 v155, v116, v117
    s_add_u32 s85, s83, 884736
    buffer_store_dwordx4 v[152:155], v254, s[8:11], s85 offen sc1
    v_cvt_pk_bf16_f32 v172, v126, v127
    v_cvt_pk_bf16_f32 v173, v128, v129
    v_cvt_pk_bf16_f32 v174, v130, v131
    v_cvt_pk_bf16_f32 v175, v132, v133
    s_add_u32 s85, s83, 1105920
    buffer_store_dwordx4 v[172:175], v254, s[8:11], s85 offen sc1
wt_join:
    s_and_b32 s13, s13, 0xffff
    s_mov_b32 s14, 100663296
    s_mov_b32 s15, 0x20000
    v_lshrrev_b32 v5, 4, v2
    v_mul_u32_u24 v6, 40704, v5
    v_lshrrev_b32 v5, 1, v5
    v_lshl_add_u32 v6, v5, 6, v6
    v_and_b32 v5, 0xf0, v254
    v_add_u32 v253, v6, v5
    v_lshrrev_b32 v6, 1, v4
    v_mul_u32_u24 v7, 40704, v6
    v_lshrrev_b32 v6, 1, v6
    v_lshl_add_u32 v7, v6, 6, v7
    v_and_b32 v6, 1, v2
    v_lshl_add_u32 v7, v6, 3, v7
    v_lshl_add_u32 v7, v3, 4, v7
    s_lshl_b32 s44, s90, 7
    s_mul_i32 s45, s91, 1056
    s_add_u32 s44, s44, s45
    v_add_u32 v7, s44, v7
    v_lshl_or_b32 v255, v7, 15, v255
    s_mul_i32 s51, s38, 40704
    s_lshl_b32 s45, s91, 6
    s_add_u32 s51, s51, s45
    s_lshl_b32 s45, s90, 4
    s_add_u32 s51, s51, s45
    s_mul_i32 s40, s49, 786432
    s_mul_i32 s45, s48, 49152
    s_add_u32 s40, s40, s45
    s_mul_i32 s45, s38, 12288
    s_add_u32 s40, s40, s45
    s_mov_b32 s41, 2130706432
    s_mov_b32 s39, 0
    s_mov_b32 s36, 0
    s_lshl_b32 s45, s38, 4
    s_mov_b32 s46, 0xfff
    s_mov_b32 s47, 0
    s_lshl_b64 s[46:47], s[46:47], s45
    s_mov_b32 s58, 0x0fff0fff
    s_mov_b32 s59, 0
    s_mov_b32 s23, 0xc08a2000
    s_mov_b32 s24, 0xbea20000
    s_mov_b32 s25, 0x3f4a4588
    s_mov_b32 s26, 0x3f100000
    s_mov_b32 s27, 0xbf100000
    s_mov_b32 s28, 0xc05a4588
    s_mov_b32 s29, 0x3fa20000
    s_mov_b32 s30, 0x3ea20000
    s_mov_b32 s31, 0x3e800000
    s_mov_b32 s34, 0x3f900000
    s_mov_b32 s35, 0x3db64000
    s_mov_b32 s22, 0xffff0000
    s_and_b32 s45, s49, 7
    s_cmp_eq_u32 s45, 0
    s_cselect_b32 s33, 4294770688, 0x40000000
    s_cmp_eq_u32 s45, 7
    s_cselect_b32 s33, 786432, s33
    s_mul_i32 s45, s38, 196224
    s_sub_u32 s45, s101, s45
    s_add_u32 s33, s33, s45
    s_mov_b32 s37, 2130706432
    v_bfe_u32 v6, v254, 6, 2
    v_mul_u32_u24 v4, 40704, v6
    v_and_b32 v6, 0x80, v254
    v_lshrrev_b32 v6, 1, v6
    v_add_u32 v4, v4, v6
    v_and_b32 v6, 0x40, v254
    v_lshrrev_b32 v6, 2, v6
    v_add_u32 v4, v4, v6
    v_bfe_u32 v6, v254, 4, 2
    v_mul_u32_u24 v6, 3104, v6
    v_add_u32 v4, v4, v6
    v_add_u32 v4, s52, v4
    v_lshrrev_b32 v6, 8, v254
    v_lshl_add_u32 v5, v6, 3, v4
    v_lshl_add_u32 v4, v6, 4, v4
    v_add_u32 v6, s51, v254
    v_mov_b32 v192, 0
    v_mov_b32 v193, 0
    v_mov_b32 v203, 0
    v_mov_b32 v215, 0
    v_mov_b32 v224, 0
    v_mov_b32 v227, 0
    v_mov_b32 v252, 0
    s_mov_b32 s42, 0
    s_cmp_gt_u32 s48, 0
    s_cselect_b32 s45, 384, 0
    s_cselect_b32 s55, 0, 2130706432
    s_add_u32 s50, s50, s45
    s_add_u32 s54, s45, 49152
    s_cmp_eq_u32 s48, 3
    s_cselect_b32 s54, 2130706432, s54
    s_mov_b32 s56, 0xffff0000
    s_mov_b32 s57, 0
    s_cmp_ge_u32 s2, 54
    s_cbranch_scc1 pub_skip
    s_branch do_warm
wt_ret:
    s_mov_b32 s87, 1
    s_cmp_lg_u32 s38, 0
    s_waitcnt vmcnt(0)
    s_barrier
    s_cbranch_scc1 wt_pub
    s_atomic_add s87, s[68:69], 0 glc
    s_waitcnt lgkmcnt(0)
    s_cmp_lg_u32 s87, 53
    s_cbranch_scc1 wt_pub
    s_atomic_add s87, s[68:69], 128
wt_pub:
    buffer_load_dwordx2 v[8:9], v80, s[4:7], s16 offen offset:0
    buffer_load_dwordx2 v[10:11], v80, s[4:7], s17 offen offset:0
    buffer_load_dwordx2 v[12:13], v80, s[4:7], s18 offen offset:0
    buffer_load_dwordx2 v[14:15], v80, s[4:7], s19 offen offset:0
    buffer_load_dwordx2 v[16:17], v80, s[4:7], s20 offen offset:0
    buffer_load_dwordx2 v[18:19], v80, s[4:7], s21 offen offset:0
    buffer_load_dwordx2 v[20:21], v80, s[4:7], s16 offen offset:384
    buffer_load_dwordx2 v[22:23], v80, s[4:7], s17 offen offset:384
    buffer_load_dwordx2 v[24:25], v80, s[4:7], s18 offen offset:384
    buffer_load_dwordx2 v[26:27], v80, s[4:7], s19 offen offset:384
    buffer_load_dwordx2 v[28:29], v80, s[4:7], s20 offen offset:384
    buffer_load_dwordx2 v[30:31], v80, s[4:7], s21 offen offset:384
pub_skip:
    v_and_b32 v67, 0xf0, v254
    v_lshrrev_b32 v67, 1, v67
    v_add_u32 v67, s52, v67
    v_mov_b32 v66, s54
    v_mov_b32 v65, s55
    v_cndmask_b32 v66, v66, v65, s[56:57]
    v_add_u32 v67, v67, v66
    s_sub_u32 s45, s16, s50
    buffer_load_dwordx2 v[56:57], v67, s[4:7], s45 offen
    s_sub_u32 s45, s17, s50
    buffer_load_dwordx2 v[58:59], v67, s[4:7], s45 offen
    s_sub_u32 s45, s18, s50
    buffer_load_dwordx2 v[60:61], v67, s[4:7], s45 offen
    s_sub_u32 s45, s19, s50
    buffer_load_dwordx2 v[62:63], v67, s[4:7], s45 offen
    s_sub_u32 s45, s20, s50
    buffer_load_dwordx2 v[64:65], v67, s[4:7], s45 offen
    s_sub_u32 s45, s21, s50
    buffer_load_dwordx2 v[66:67], v67, s[4:7], s45 offen
    buffer_load_dwordx2 v[32:33], v80, s[4:7], s16 offen offset:768
    buffer_load_dwordx2 v[34:35], v80, s[4:7], s17 offen offset:768
    buffer_load_dwordx2 v[36:37], v80, s[4:7], s18 offen offset:768
    buffer_load_dwordx2 v[38:39], v80, s[4:7], s19 offen offset:768
    buffer_load_dwordx2 v[40:41], v80, s[4:7], s20 offen offset:768
    buffer_load_dwordx2 v[42:43], v80, s[4:7], s21 offen offset:768
    buffer_load_dwordx2 v[44:45], v80, s[4:7], s16 offen offset:1152
    buffer_load_dwordx2 v[46:47], v80, s[4:7], s17 offen offset:1152
    buffer_load_dwordx2 v[48:49], v80, s[4:7], s18 offen offset:1152
    buffer_load_dwordx2 v[50:51], v80, s[4:7], s19 offen offset:1152
    buffer_load_dwordx2 v[52:53], v80, s[4:7], s20 offen offset:1152
    buffer_load_dwordx2 v[54:55], v80, s[4:7], s21 offen offset:1152
    s_waitcnt vmcnt(24)
    v_lshlrev_b32 v176, 16, v8
    v_and_b32 v177, s22, v8
    v_lshlrev_b32 v178, 16, v10
    v_and_b32 v179, s22, v10
    v_lshlrev_b32 v180, 16, v12
    v_and_b32 v181, s22, v12
    v_lshlrev_b32 v182, 16, v14
    v_and_b32 v183, s22, v14
    v_lshlrev_b32 v184, 16, v16
    v_and_b32 v185, s22, v16
    v_lshlrev_b32 v186, 16, v18
    v_and_b32 v187, s22, v18
    v_pk_fma_f32 v[176:177], v[184:185], s[24:25], v[176:177] op_sel:[0,1,0]
    v_pk_fma_f32 v[186:187], v[178:179], s[28:29], v[186:187] op_sel:[0,1,0]
    v_pk_fma_f32 v[176:177], v[180:181], s[28:29], v[176:177] op_sel_hi:[1,0,1]
    v_pk_fma_f32 v[186:187], v[182:183], s[22:23], v[186:187] op_sel:[0,1,0]
    v_pk_fma_f32 v[188:189], v[180:181], s[24:25], v[184:185] op_sel_hi:[1,0,1]
    v_pk_fma_f32 v[184:185], v[180:181], -4.0, v[184:185] op_sel_hi:[1,0,1]
    v_pk_fma_f32 v[180:181], v[178:179], s[24:25], v[182:183] op_sel_hi:[1,0,1]
    v_pk_fma_f32 v[182:183], v[178:179], -4.0, v[182:183] op_sel_hi:[1,0,1]
    v_pk_fma_f32 v[178:179], v[182:183], s[26:27], v[184:185] op_sel_hi:[1,0,1]
    v_pk_fma_f32 v[184:185], v[182:183], s[26:27], v[184:185] op_sel:[0,1,0]
    v_pk_fma_f32 v[182:183], v[180:181], 2.0, v[188:189] op_sel_hi:[1,0,1]
    v_pk_fma_f32 v[180:181], v[180:181], -2.0, v[188:189] op_sel_hi:[1,0,1]
    v_cvt_pk_bf16_f32 v8, v176, v177
    v_cvt_pk_bf16_f32 v10, v178, v179
    v_cvt_pk_bf16_f32 v12, v180, v181
    v_cvt_pk_bf16_f32 v14, v182, v183
    v_cvt_pk_bf16_f32 v16, v184, v185
    v_cvt_pk_bf16_f32 v18, v186, v187
    v_lshlrev_b32 v176, 16, v9
    v_and_b32 v177, s22, v9
    v_lshlrev_b32 v178, 16, v11
    v_and_b32 v179, s22, v11
    v_lshlrev_b32 v180, 16, v13
    v_and_b32 v181, s22, v13
    v_lshlrev_b32 v182, 16, v15
    v_and_b32 v183, s22, v15
    v_lshlrev_b32 v184, 16, v17
    v_and_b32 v185, s22, v17
    v_lshlrev_b32 v186, 16, v19
    v_and_b32 v187, s22, v19
    v_pk_fma_f32 v[176:177], v[184:185], s[24:25], v[176:177] op_sel:[0,1,0]
    v_pk_fma_f32 v[186:187], v[178:179], s[28:29], v[186:187] op_sel:[0,1,0]
    v_pk_fma_f32 v[176:177], v[180:181], s[28:29], v[176:177] op_sel_hi:[1,0,1]
    v_pk_fma_f32 v[186:187], v[182:183], s[22:23], v[186:187] op_sel:[0,1,0]
    v_pk_fma_f32 v[188:189], v[180:181], s[24:25], v[184:185] op_sel_hi:[1,0,1]
    v_pk_fma_f32 v[184:185], v[180:181], -4.0, v[184:185] op_sel_hi:[1,0,1]
    v_pk_fma_f32 v[180:181], v[178:179], s[24:25], v[182:183] op_sel_hi:[1,0,1]
    v_pk_fma_f32 v[182:183], v[178:179], -4.0, v[182:183] op_sel_hi:[1,0,1]
    v_pk_fma_f32 v[178:179], v[182:183], s[26:27], v[184:185] op_sel_hi:[1,0,1]
    v_pk_fma_f32 v[184:185], v[182:183], s[26:27], v[184:185] op_sel:[0,1,0]
    v_pk_fma_f32 v[182:183], v[180:181], 2.0, v[188:189] op_sel_hi:[1,0,1]
    v_pk_fma_f32 v[180:181], v[180:181], -2.0, v[188:189] op_sel_hi:[1,0,1]
    v_cvt_pk_bf16_f32 v9, v176, v177
    v_cvt_pk_bf16_f32 v11, v178, v179
    v_cvt_pk_bf16_f32 v13, v180, v181
    v_cvt_pk_bf16_f32 v15, v182, v183
    v_cvt_pk_bf16_f32 v17, v184, v185
    v_cvt_pk_bf16_f32 v19, v186, v187
    v_lshrrev_b32 v252, 15, v255
    ds_write_b64 v252, v[8:9] offset:34048
    ds_write_b64 v252, v[10:11] offset:768
    ds_write_b64 v252, v[16:17] offset:2848
    ds_write_b64 v252, v[14:15] offset:4928
    ds_write_b64 v252, v[12:13] offset:7008
    ds_write_b64 v252, v[18:19] offset:36128
    s_waitcnt vmcnt(18)
    v_lshlrev_b32 v176, 16, v20
    v_and_b32 v177, s22, v20
    v_lshlrev_b32 v178, 16, v22
    v_and_b32 v179, s22, v22
    v_lshlrev_b32 v180, 16, v24
    v_and_b32 v181, s22, v24
    v_lshlrev_b32 v182, 16, v26
    v_and_b32 v183, s22, v26
    v_lshlrev_b32 v184, 16, v28
    v_and_b32 v185, s22, v28
    v_lshlrev_b32 v186, 16, v30
    v_and_b32 v187, s22, v30
    v_pk_fma_f32 v[176:177], v[184:185], s[24:25], v[176:177] op_sel:[0,1,0]
    v_pk_fma_f32 v[186:187], v[178:179], s[28:29], v[186:187] op_sel:[0,1,0]
    v_pk_fma_f32 v[176:177], v[180:181], s[28:29], v[176:177] op_sel_hi:[1,0,1]
    v_pk_fma_f32 v[186:187], v[182:183], s[22:23], v[186:187] op_sel:[0,1,0]
    v_pk_fma_f32 v[188:189], v[180:181], s[24:25], v[184:185] op_sel_hi:[1,0,1]
    v_pk_fma_f32 v[184:185], v[180:181], -4.0, v[184:185] op_sel_hi:[1,0,1]
    v_pk_fma_f32 v[180:181], v[178:179], s[24:25], v[182:183] op_sel_hi:[1,0,1]
    v_pk_fma_f32 v[182:183], v[178:179], -4.0, v[182:183] op_sel_hi:[1,0,1]
    v_pk_fma_f32 v[178:179], v[182:183], s[26:27], v[184:185] op_sel_hi:[1,0,1]
    v_pk_fma_f32 v[184:185], v[182:183], s[26:27], v[184:185] op_sel:[0,1,0]
    v_pk_fma_f32 v[182:183], v[180:181], 2.0, v[188:189] op_sel_hi:[1,0,1]
    v_pk_fma_f32 v[180:181], v[180:181], -2.0, v[188:189] op_sel_hi:[1,0,1]
    v_cvt_pk_bf16_f32 v20, v176, v177
    v_cvt_pk_bf16_f32 v22, v178, v179
    v_cvt_pk_bf16_f32 v24, v180, v181
    v_cvt_pk_bf16_f32 v26, v182, v183
    v_cvt_pk_bf16_f32 v28, v184, v185
    v_cvt_pk_bf16_f32 v30, v186, v187
    v_lshlrev_b32 v176, 16, v21
    v_and_b32 v177, s22, v21
    v_lshlrev_b32 v178, 16, v23
    v_and_b32 v179, s22, v23
    v_lshlrev_b32 v180, 16, v25
    v_and_b32 v181, s22, v25
    v_lshlrev_b32 v182, 16, v27
    v_and_b32 v183, s22, v27
    v_lshlrev_b32 v184, 16, v29
    v_and_b32 v185, s22, v29
    v_lshlrev_b32 v186, 16, v31
    v_and_b32 v187, s22, v31
    v_pk_fma_f32 v[176:177], v[184:185], s[24:25], v[176:177] op_sel:[0,1,0]
    v_pk_fma_f32 v[186:187], v[178:179], s[28:29], v[186:187] op_sel:[0,1,0]
    v_pk_fma_f32 v[176:177], v[180:181], s[28:29], v[176:177] op_sel_hi:[1,0,1]
    v_pk_fma_f32 v[186:187], v[182:183], s[22:23], v[186:187] op_sel:[0,1,0]
    v_pk_fma_f32 v[188:189], v[180:181], s[24:25], v[184:185] op_sel_hi:[1,0,1]
    v_pk_fma_f32 v[184:185], v[180:181], -4.0, v[184:185] op_sel_hi:[1,0,1]
    v_pk_fma_f32 v[180:181], v[178:179], s[24:25], v[182:183] op_sel_hi:[1,0,1]
    v_pk_fma_f32 v[182:183], v[178:179], -4.0, v[182:183] op_sel_hi:[1,0,1]
    v_pk_fma_f32 v[178:179], v[182:183], s[26:27], v[184:185] op_sel_hi:[1,0,1]
    v_pk_fma_f32 v[184:185], v[182:183], s[26:27], v[184:185] op_sel:[0,1,0]
    v_pk_fma_f32 v[182:183], v[180:181], 2.0, v[188:189] op_sel_hi:[1,0,1]
    v_pk_fma_f32 v[180:181], v[180:181], -2.0, v[188:189] op_sel_hi:[1,0,1]
    v_cvt_pk_bf16_f32 v21, v176, v177
    v_cvt_pk_bf16_f32 v23, v178, v179
    v_cvt_pk_bf16_f32 v25, v180, v181
    v_cvt_pk_bf16_f32 v27, v182, v183
    v_cvt_pk_bf16_f32 v29, v184, v185
    v_cvt_pk_bf16_f32 v31, v186, v187
    v_lshrrev_b32 v252, 15, v255
    ds_write_b64 v252, v[20:21] offset:33792
    ds_write_b64 v252, v[22:23] offset:512
    ds_write_b64 v252, v[28:29] offset:2592
    ds_write_b64 v252, v[26:27] offset:4672
    ds_write_b64 v252, v[24:25] offset:6752
    ds_write_b64 v252, v[30:31] offset:35872
    s_waitcnt vmcnt(12)
    v_lshlrev_b32 v176, 16, v56
    v_and_b32 v177, s22, v56
    v_lshlrev_b32 v178, 16, v58
    v_and_b32 v179, s22, v58
    v_lshlrev_b32 v180, 16, v60
    v_and_b32 v181, s22, v60
    v_lshlrev_b32 v182, 16, v62
    v_and_b32 v183, s22, v62
    v_lshlrev_b32 v184, 16, v64
    v_and_b32 v185, s22, v64
    v_lshlrev_b32 v186, 16, v66
    v_and_b32 v187, s22, v66
    v_pk_fma_f32 v[176:177], v[184:185], s[24:25], v[176:177] op_sel:[0,1,0]
    v_pk_fma_f32 v[186:187], v[178:179], s[28:29], v[186:187] op_sel:[0,1,0]
    v_pk_fma_f32 v[176:177], v[180:181], s[28:29], v[176:177] op_sel_hi:[1,0,1]
    v_pk_fma_f32 v[186:187], v[182:183], s[22:23], v[186:187] op_sel:[0,1,0]
    v_pk_fma_f32 v[188:189], v[180:181], s[24:25], v[184:185] op_sel_hi:[1,0,1]
    v_pk_fma_f32 v[184:185], v[180:181], -4.0, v[184:185] op_sel_hi:[1,0,1]
    v_pk_fma_f32 v[180:181], v[178:179], s[24:25], v[182:183] op_sel_hi:[1,0,1]
    v_pk_fma_f32 v[182:183], v[178:179], -4.0, v[182:183] op_sel_hi:[1,0,1]
    v_pk_fma_f32 v[178:179], v[182:183], s[26:27], v[184:185] op_sel_hi:[1,0,1]
    v_pk_fma_f32 v[184:185], v[182:183], s[26:27], v[184:185] op_sel:[0,1,0]
    v_pk_fma_f32 v[182:183], v[180:181], 2.0, v[188:189] op_sel_hi:[1,0,1]
    v_pk_fma_f32 v[180:181], v[180:181], -2.0, v[188:189] op_sel_hi:[1,0,1]
    v_cvt_pk_bf16_f32 v56, v176, v177
    v_cvt_pk_bf16_f32 v58, v178, v179
    v_cvt_pk_bf16_f32 v60, v180, v181
    v_cvt_pk_bf16_f32 v62, v182, v183
    v_cvt_pk_bf16_f32 v64, v184, v185
    v_cvt_pk_bf16_f32 v66, v186, v187
    v_lshlrev_b32 v176, 16, v57
    v_and_b32 v177, s22, v57
    v_lshlrev_b32 v178, 16, v59
    v_and_b32 v179, s22, v59
    v_lshlrev_b32 v180, 16, v61
    v_and_b32 v181, s22, v61
    v_lshlrev_b32 v182, 16, v63
    v_and_b32 v183, s22, v63
    v_lshlrev_b32 v184, 16, v65
    v_and_b32 v185, s22, v65
    v_lshlrev_b32 v186, 16, v67
    v_and_b32 v187, s22, v67
    v_pk_fma_f32 v[176:177], v[184:185], s[24:25], v[176:177] op_sel:[0,1,0]
    v_pk_fma_f32 v[186:187], v[178:179], s[28:29], v[186:187] op_sel:[0,1,0]
    v_pk_fma_f32 v[176:177], v[180:181], s[28:29], v[176:177] op_sel_hi:[1,0,1]
    v_pk_fma_f32 v[186:187], v[182:183], s[22:23], v[186:187] op_sel:[0,1,0]
    v_pk_fma_f32 v[188:189], v[180:181], s[24:25], v[184:185] op_sel_hi:[1,0,1]
    v_pk_fma_f32 v[184:185], v[180:181], -4.0, v[184:185] op_sel_hi:[1,0,1]
    v_pk_fma_f32 v[180:181], v[178:179], s[24:25], v[182:183] op_sel_hi:[1,0,1]
    v_pk_fma_f32 v[182:183], v[178:179], -4.0, v[182:183] op_sel_hi:[1,0,1]
    v_pk_fma_f32 v[178:179], v[182:183], s[26:27], v[184:185] op_sel_hi:[1,0,1]
    v_pk_fma_f32 v[184:185], v[182:183], s[26:27], v[184:185] op_sel:[0,1,0]
    v_pk_fma_f32 v[182:183], v[180:181], 2.0, v[188:189] op_sel_hi:[1,0,1]
    v_pk_fma_f32 v[180:181], v[180:181], -2.0, v[188:189] op_sel_hi:[1,0,1]
    v_cvt_pk_bf16_f32 v57, v176, v177
    v_cvt_pk_bf16_f32 v59, v178, v179
    v_cvt_pk_bf16_f32 v61, v180, v181
    v_cvt_pk_bf16_f32 v63, v182, v183
    v_cvt_pk_bf16_f32 v65, v184, v185
    v_cvt_pk_bf16_f32 v67, v186, v187
    v_and_b32 v248, 0xf0, v254
    v_lshrrev_b32 v248, 1, v248
    v_add_u32 v248, s52, v248
    v_and_b32 v252, 8, v248
    v_lshrrev_b32 v249, 6, v248
    v_mul_u32_u24 v249, 192, v249
    v_cmp_eq_u32 s[92:93], 0, v249
    v_add_u32 v252, v252, v249
    v_bfe_u32 v249, v248, 4, 2
    v_mul_u32_u24 v249, 40704, v249
    v_add_u32 v252, v252, v249
    v_and_b32 v249, 32, v248
    v_lshl_add_u32 v252, v249, 1, v252
    v_bfe_u32 v249, v254, 8, 1
    v_lshl_add_u32 v252, v249, 4, v252
    v_mov_b32 v249, 123328
    v_cndmask_b32 v252, v249, v252, s[58:59]
    ds_write_b64 v252, v[56:57] offset:39520
    ds_write_b64 v252, v[58:59] offset:39552
    ds_write_b64 v252, v[64:65] offset:39584
    ds_write_b64 v252, v[62:63] offset:39616
    ds_write_b64 v252, v[60:61] offset:39648
    ds_write_b64 v252, v[66:67] offset:39680
    s_and_b64 exec, s[92:93], s[58:59]
    ds_write_b64 v252, v[56:57] offset:34304
    ds_write_b64 v252, v[58:59] offset:1024
    ds_write_b64 v252, v[64:65] offset:3104
    ds_write_b64 v252, v[62:63] offset:5184
    ds_write_b64 v252, v[60:61] offset:7264
    ds_write_b64 v252, v[66:67] offset:36384
    s_mov_b64 exec, -1
    v_and_b32 v203, 0x7fff, v255
    buffer_load_dwordx2 v[192:193], v203, s[4:7], s16 offen offset:64
    buffer_load_dwordx2 v[194:195], v203, s[4:7], s17 offen offset:64
    buffer_load_dwordx2 v[196:197], v203, s[4:7], s18 offen offset:64
    buffer_load_dwordx2 v[198:199], v203, s[4:7], s19 offen offset:64
    buffer_load_dwordx2 v[200:201], v203, s[4:7], s20 offen offset:64
    buffer_load_dwordx2 v[202:203], v203, s[4:7], s21 offen offset:64
    v_and_b32 v215, 0x7fff, v255
    buffer_load_dwordx2 v[204:205], v215, s[4:7], s16 offen offset:448
    buffer_load_dwordx2 v[206:207], v215, s[4:7], s17 offen offset:448
    buffer_load_dwordx2 v[208:209], v215, s[4:7], s18 offen offset:448
    buffer_load_dwordx2 v[210:211], v215, s[4:7], s19 offen offset:448
    buffer_load_dwordx2 v[212:213], v215, s[4:7], s20 offen offset:448
    buffer_load_dwordx2 v[214:215], v215, s[4:7], s21 offen offset:448
    s_waitcnt vmcnt(18)
    v_lshlrev_b32 v176, 16, v32
    v_and_b32 v177, s22, v32
    v_lshlrev_b32 v178, 16, v34
    v_and_b32 v179, s22, v34
    v_lshlrev_b32 v180, 16, v36
    v_and_b32 v181, s22, v36
    v_lshlrev_b32 v182, 16, v38
    v_and_b32 v183, s22, v38
    v_lshlrev_b32 v184, 16, v40
    v_and_b32 v185, s22, v40
    v_lshlrev_b32 v186, 16, v42
    v_and_b32 v187, s22, v42
    v_pk_fma_f32 v[176:177], v[184:185], s[24:25], v[176:177] op_sel:[0,1,0]
    v_pk_fma_f32 v[186:187], v[178:179], s[28:29], v[186:187] op_sel:[0,1,0]
    v_pk_fma_f32 v[176:177], v[180:181], s[28:29], v[176:177] op_sel_hi:[1,0,1]
    v_pk_fma_f32 v[186:187], v[182:183], s[22:23], v[186:187] op_sel:[0,1,0]
    v_pk_fma_f32 v[188:189], v[180:181], s[24:25], v[184:185] op_sel_hi:[1,0,1]
    v_pk_fma_f32 v[184:185], v[180:181], -4.0, v[184:185] op_sel_hi:[1,0,1]
    v_pk_fma_f32 v[180:181], v[178:179], s[24:25], v[182:183] op_sel_hi:[1,0,1]
    v_pk_fma_f32 v[182:183], v[178:179], -4.0, v[182:183] op_sel_hi:[1,0,1]
    v_pk_fma_f32 v[178:179], v[182:183], s[26:27], v[184:185] op_sel_hi:[1,0,1]
    v_pk_fma_f32 v[184:185], v[182:183], s[26:27], v[184:185] op_sel:[0,1,0]
    v_pk_fma_f32 v[182:183], v[180:181], 2.0, v[188:189] op_sel_hi:[1,0,1]
    v_pk_fma_f32 v[180:181], v[180:181], -2.0, v[188:189] op_sel_hi:[1,0,1]
    v_cvt_pk_bf16_f32 v32, v176, v177
    v_cvt_pk_bf16_f32 v34, v178, v179
    v_cvt_pk_bf16_f32 v36, v180, v181
    v_cvt_pk_bf16_f32 v38, v182, v183
    v_cvt_pk_bf16_f32 v40, v184, v185
    v_cvt_pk_bf16_f32 v42, v186, v187
    v_lshlrev_b32 v176, 16, v33
    v_and_b32 v177, s22, v33
    v_lshlrev_b32 v178, 16, v35
    v_and_b32 v179, s22, v35
    v_lshlrev_b32 v180, 16, v37
    v_and_b32 v181, s22, v37
    v_lshlrev_b32 v182, 16, v39
    v_and_b32 v183, s22, v39
    v_lshlrev_b32 v184, 16, v41
    v_and_b32 v185, s22, v41
    v_lshlrev_b32 v186, 16, v43
    v_and_b32 v187, s22, v43
    v_pk_fma_f32 v[176:177], v[184:185], s[24:25], v[176:177] op_sel:[0,1,0]
    v_pk_fma_f32 v[186:187], v[178:179], s[28:29], v[186:187] op_sel:[0,1,0]
    v_pk_fma_f32 v[176:177], v[180:181], s[28:29], v[176:177] op_sel_hi:[1,0,1]
    v_pk_fma_f32 v[186:187], v[182:183], s[22:23], v[186:187] op_sel:[0,1,0]
    v_pk_fma_f32 v[188:189], v[180:181], s[24:25], v[184:185] op_sel_hi:[1,0,1]
    v_pk_fma_f32 v[184:185], v[180:181], -4.0, v[184:185] op_sel_hi:[1,0,1]
    v_pk_fma_f32 v[180:181], v[178:179], s[24:25], v[182:183] op_sel_hi:[1,0,1]
    v_pk_fma_f32 v[182:183], v[178:179], -4.0, v[182:183] op_sel_hi:[1,0,1]
    v_pk_fma_f32 v[178:179], v[182:183], s[26:27], v[184:185] op_sel_hi:[1,0,1]
    v_pk_fma_f32 v[184:185], v[182:183], s[26:27], v[184:185] op_sel:[0,1,0]
    v_pk_fma_f32 v[182:183], v[180:181], 2.0, v[188:189] op_sel_hi:[1,0,1]
    v_pk_fma_f32 v[180:181], v[180:181], -2.0, v[188:189] op_sel_hi:[1,0,1]
    v_cvt_pk_bf16_f32 v33, v176, v177
    v_cvt_pk_bf16_f32 v35, v178, v179
    v_cvt_pk_bf16_f32 v37, v180, v181
    v_cvt_pk_bf16_f32 v39, v182, v183
    v_cvt_pk_bf16_f32 v41, v184, v185
    v_cvt_pk_bf16_f32 v43, v186, v187
    v_lshrrev_b32 v252, 15, v255
    ds_write_b64 v252, v[32:33] offset:33536
    ds_write_b64 v252, v[34:35] offset:256
    ds_write_b64 v252, v[40:41] offset:2336
    ds_write_b64 v252, v[38:39] offset:4416
    ds_write_b64 v252, v[36:37] offset:6496
    ds_write_b64 v252, v[42:43] offset:35616
    s_waitcnt vmcnt(12)
    v_lshlrev_b32 v176, 16, v44
    v_and_b32 v177, s22, v44
    v_lshlrev_b32 v178, 16, v46
    v_and_b32 v179, s22, v46
    v_lshlrev_b32 v180, 16, v48
    v_and_b32 v181, s22, v48
    v_lshlrev_b32 v182, 16, v50
    v_and_b32 v183, s22, v50
    v_lshlrev_b32 v184, 16, v52
    v_and_b32 v185, s22, v52
    v_lshlrev_b32 v186, 16, v54
    v_and_b32 v187, s22, v54
    v_pk_fma_f32 v[176:177], v[184:185], s[24:25], v[176:177] op_sel:[0,1,0]
    v_pk_fma_f32 v[186:187], v[178:179], s[28:29], v[186:187] op_sel:[0,1,0]
    v_pk_fma_f32 v[176:177], v[180:181], s[28:29], v[176:177] op_sel_hi:[1,0,1]
    v_pk_fma_f32 v[186:187], v[182:183], s[22:23], v[186:187] op_sel:[0,1,0]
    v_pk_fma_f32 v[188:189], v[180:181], s[24:25], v[184:185] op_sel_hi:[1,0,1]
    v_pk_fma_f32 v[184:185], v[180:181], -4.0, v[184:185] op_sel_hi:[1,0,1]
    v_pk_fma_f32 v[180:181], v[178:179], s[24:25], v[182:183] op_sel_hi:[1,0,1]
    v_pk_fma_f32 v[182:183], v[178:179], -4.0, v[182:183] op_sel_hi:[1,0,1]
    v_pk_fma_f32 v[178:179], v[182:183], s[26:27], v[184:185] op_sel_hi:[1,0,1]
    v_pk_fma_f32 v[184:185], v[182:183], s[26:27], v[184:185] op_sel:[0,1,0]
    v_pk_fma_f32 v[182:183], v[180:181], 2.0, v[188:189] op_sel_hi:[1,0,1]
    v_pk_fma_f32 v[180:181], v[180:181], -2.0, v[188:189] op_sel_hi:[1,0,1]
    v_cvt_pk_bf16_f32 v44, v176, v177
    v_cvt_pk_bf16_f32 v46, v178, v179
    v_cvt_pk_bf16_f32 v48, v180, v181
    v_cvt_pk_bf16_f32 v50, v182, v183
    v_cvt_pk_bf16_f32 v52, v184, v185
    v_cvt_pk_bf16_f32 v54, v186, v187
    v_lshlrev_b32 v176, 16, v45
    v_and_b32 v177, s22, v45
    v_lshlrev_b32 v178, 16, v47
    v_and_b32 v179, s22, v47
    v_lshlrev_b32 v180, 16, v49
    v_and_b32 v181, s22, v49
    v_lshlrev_b32 v182, 16, v51
    v_and_b32 v183, s22, v51
    v_lshlrev_b32 v184, 16, v53
    v_and_b32 v185, s22, v53
    v_lshlrev_b32 v186, 16, v55
    v_and_b32 v187, s22, v55
    v_pk_fma_f32 v[176:177], v[184:185], s[24:25], v[176:177] op_sel:[0,1,0]
    v_pk_fma_f32 v[186:187], v[178:179], s[28:29], v[186:187] op_sel:[0,1,0]
    v_pk_fma_f32 v[176:177], v[180:181], s[28:29], v[176:177] op_sel_hi:[1,0,1]
    v_pk_fma_f32 v[186:187], v[182:183], s[22:23], v[186:187] op_sel:[0,1,0]
    v_pk_fma_f32 v[188:189], v[180:181], s[24:25], v[184:185] op_sel_hi:[1,0,1]
    v_pk_fma_f32 v[184:185], v[180:181], -4.0, v[184:185] op_sel_hi:[1,0,1]
    v_pk_fma_f32 v[180:181], v[178:179], s[24:25], v[182:183] op_sel_hi:[1,0,1]
    v_pk_fma_f32 v[182:183], v[178:179], -4.0, v[182:183] op_sel_hi:[1,0,1]
    v_pk_fma_f32 v[178:179], v[182:183], s[26:27], v[184:185] op_sel_hi:[1,0,1]
    v_pk_fma_f32 v[184:185], v[182:183], s[26:27], v[184:185] op_sel:[0,1,0]
    v_pk_fma_f32 v[182:183], v[180:181], 2.0, v[188:189] op_sel_hi:[1,0,1]
    v_pk_fma_f32 v[180:181], v[180:181], -2.0, v[188:189] op_sel_hi:[1,0,1]
    v_cvt_pk_bf16_f32 v45, v176, v177
    v_cvt_pk_bf16_f32 v47, v178, v179
    v_cvt_pk_bf16_f32 v49, v180, v181
    v_cvt_pk_bf16_f32 v51, v182, v183
    v_cvt_pk_bf16_f32 v53, v184, v185
    v_cvt_pk_bf16_f32 v55, v186, v187
    v_lshrrev_b32 v252, 15, v255
    ds_write_b64 v252, v[44:45] offset:33280
    ds_write_b64 v252, v[46:47] offset:0
    ds_write_b64 v252, v[52:53] offset:2080
    ds_write_b64 v252, v[50:51] offset:4160
    ds_write_b64 v252, v[48:49] offset:6240
    ds_write_b64 v252, v[54:55] offset:35360
    buffer_load_dword v97, v98, s[64:67], 0 offen offset:128 sc1
    s_cmp_lt_u32 s2, 54
    s_cbranch_scc1 warm_done
do_warm:
    s_mov_b64 vcc, -1
    s_cmp_eq_u32 s38, 0
    s_cbranch_scc1 pad0
    s_cmp_eq_u32 s38, 1
    s_cbranch_scc1 pad1
    s_cmp_eq_u32 s38, 2
    s_cbranch_scc1 pad2
    s_branch pad3
warm_ret:
    s_mov_b64 vcc, 0
    s_cmp_lt_u32 s2, 54
    s_cbranch_scc1 wt_ret
warm_done:
    s_mov_b32 s86, 0
    s_waitcnt vmcnt(0)
poll_loop:
    v_readfirstlane_b32 s87, v97
    s_add_u32 s86, s86, 1
    s_cmp_lg_u32 s87, 0
    s_cbranch_scc1 u_ready
    buffer_load_dword v97, v98, s[64:67], 0 offen offset:128 sc1
    s_cmp_lt_u32 s86, 512
    s_waitcnt vmcnt(0)
    s_cbranch_scc1 poll_loop
    s_mov_b32 s70, 0
    s_branch wt_loop
u_ready:
    s_mov_b32 s42, 0
    buffer_load_dwordx4 a[192:195], v254, s[8:11], s42 offen offset:0 sc1
    buffer_load_dwordx4 a[196:199], v254, s[8:11], s42 offen offset:1024 sc1
    buffer_load_dwordx4 a[200:203], v254, s[8:11], s42 offen offset:2048 sc1
    s_mov_b32 s42, 3072
    buffer_load_dwordx4 a[204:207], v254, s[8:11], s42 offen offset:0 sc1
    buffer_load_dwordx4 a[208:211], v254, s[8:11], s42 offen offset:1024 sc1
    buffer_load_dwordx4 a[212:215], v254, s[8:11], s42 offen offset:2048 sc1
    s_mov_b32 s42, 6144
    buffer_load_dwordx4 a[216:219], v254, s[8:11], s42 offen offset:0 sc1
    buffer_load_dwordx4 a[220:223], v254, s[8:11], s42 offen offset:1024 sc1
    buffer_load_dwordx4 a[224:227], v254, s[8:11], s42 offen offset:2048 sc1
u_done:
    s_mov_b32 s42, 36864
    buffer_load_dwordx4 a[228:231], v254, s[8:11], s42 offen offset:0 sc1
    buffer_load_dwordx4 a[232:235], v254, s[8:11], s42 offen offset:1024 sc1
    buffer_load_dwordx4 a[236:239], v254, s[8:11], s42 offen offset:2048 sc1
    s_mov_b32 s42, 39936
    buffer_load_dwordx4 a[240:243], v254, s[8:11], s42 offen offset:0 sc1
    buffer_load_dwordx4 a[244:247], v254, s[8:11], s42 offen offset:1024 sc1
    buffer_load_dwordx4 a[248:251], v254, s[8:11], s42 offen offset:2048 sc1
    s_mov_b32 s42, 43008
    buffer_load_dwordx4 a[252:255], v254, s[8:11], s42 offen offset:0 sc1
    buffer_load_dwordx4 v[240:243], v254, s[8:11], s42 offen offset:1024 sc1
    buffer_load_dwordx4 v[244:247], v254, s[8:11], s42 offen offset:2048 sc1
    s_waitcnt lgkmcnt(0)
    s_barrier
    ds_read_b128 v[228:231], v253 offset:1040
    ds_read_b128 v[232:235], v253 offset:768
    ds_read_b128 v[236:239], v253 offset:512
    s_waitcnt vmcnt(9) lgkmcnt(0)
    s_branch blk_loop
.p2align 12
blk_loop:
sub0:
    v_mfma_f32_16x16x32_bf16 a[0:3], a[192:195], v[228:231], 0
pad0:
    s_cbranch_vccnz pad4
    s_add_u32 s44, s41, 10240
    s_waitcnt vmcnt(23)
    v_lshlrev_b32 v248, 16, v194
    v_mfma_f32_16x16x32_bf16 a[4:7], a[196:199], v[228:231], 0
    v_cvt_pk_bf16_f32 v180, v180, v181
    v_cvt_pk_bf16_f32 v181, v182, v183
    v_mfma_f32_16x16x32_bf16 a[8:11], a[200:203], v[228:231], 0
    ds_read_b128 v[228:231], v253 offset:256
    v_cvt_pk_bf16_f32 v182, v184, v185
    v_mfma_f32_16x16x32_bf16 a[8:11], a[212:215], v[232:235], a[8:11]
    s_waitcnt lgkmcnt(1)
    buffer_store_dwordx4 v[124:127], v254, s[12:15], s44 offen nt
    v_cvt_pk_bf16_f32 v183, v186, v187
    v_lshlrev_b32 v249, 16, v196
    v_mfma_f32_16x16x32_bf16 a[4:7], a[208:211], v[232:235], a[4:7]
    ds_write_b128 v4, v[180:183] offset:19328
    v_mfma_f32_16x16x32_bf16 a[0:3], a[204:207], v[232:235], a[0:3]
    v_lshlrev_b32 v250, 16, v198
    v_lshlrev_b32 v251, 16, v200
    v_mfma_f32_16x16x32_bf16 a[0:3], a[216:219], v[236:239], a[0:3]
    v_and_b32 v194, s22, v194
    v_and_b32 v196, s22, v196
    v_and_b32 v198, s22, v198
    v_mfma_f32_16x16x32_bf16 a[4:7], a[220:223], v[236:239], a[4:7]
    v_cvt_pk_bf16_f32 v188, v188, v189
    v_cvt_pk_bf16_f32 v189, v190, v191
    v_mfma_f32_16x16x32_bf16 a[8:11], a[224:227], v[236:239], a[8:11]
    ds_write_b64 v5, v[188:189] offset:19392
    v_mfma_f32_16x16x32_bf16 a[12:15], a[192:195], v[232:235], 0
    v_and_b32 v200, s22, v200
    v_lshlrev_b32 v252, 16, v192
    v_mfma_f32_16x16x32_bf16 a[12:15], a[204:207], v[236:239], a[12:15]
    s_waitcnt lgkmcnt(2)
    v_and_b32 v192, s22, v192
    v_fmac_f32 v252, s25, v251
    v_mfma_f32_16x16x32_bf16 a[12:15], a[216:219], v[228:231], a[12:15]
    v_fmac_f32 v192, s25, v200
    v_fmac_f32 v252, s28, v249
    v_mfma_f32_16x16x32_bf16 a[16:19], a[220:223], v[228:231], 0
    v_fmac_f32 v192, s28, v196
    v_cvt_pk_bf16_f32 v192, v252, v192
    v_mfma_f32_16x16x32_bf16 a[16:19], a[208:211], v[236:239], a[16:19]
    v_lshlrev_b32 v252, 16, v202
    v_and_b32 v202, s22, v202
    v_fmac_f32 v252, s29, v248
    v_mfma_f32_16x16x32_bf16 a[16:19], a[196:199], v[232:235], a[16:19]
    v_fmac_f32 v202, s29, v194
    v_fmac_f32 v252, s23, v250
    v_mfma_f32_16x16x32_bf16 a[20:23], a[200:203], v[232:235], 0
    ds_read_b128 v[232:235], v253 offset:0
    v_fmac_f32 v202, s23, v198
    v_mfma_f32_16x16x32_bf16 a[20:23], a[212:215], v[236:239], a[20:23]
    s_waitcnt lgkmcnt(0)
    v_cvt_pk_bf16_f32 v202, v252, v202
    v_fma_f32 v252, v249, s24, v251
    v_mfma_f32_16x16x32_bf16 a[20:23], a[224:227], v[228:231], a[20:23]
    s_barrier
    v_mfma_f32_16x16x32_bf16 a[24:27], a[192:195], v[236:239], 0
    ds_read_b128 v[128:131], v6 offset:18688
    v_fmac_f32 v251, -4.0, v249
    v_mfma_f32_16x16x32_bf16 a[24:27], a[204:207], v[228:231], a[24:27]
    v_fma_f32 v249, v248, s24, v250
    v_fmac_f32 v250, -4.0, v248
    v_fma_f32 v248, v250, s26, v251
    v_mfma_f32_16x16x32_bf16 a[24:27], a[216:219], v[232:235], a[24:27]
    v_fmac_f32 v251, s27, v250
    v_fma_f32 v250, v249, 2.0, v252
    v_mfma_f32_16x16x32_bf16 a[28:31], a[220:223], v[232:235], 0
    v_fmac_f32 v252, -2.0, v249
    v_fma_f32 v249, v196, s24, v200
    v_mfma_f32_16x16x32_bf16 a[28:31], a[208:211], v[228:231], a[28:31]
    v_fmac_f32 v200, -4.0, v196
    v_fma_f32 v196, v194, s24, v198
    v_mfma_f32_16x16x32_bf16 a[28:31], a[196:199], v[236:239], a[28:31]
    s_add_u32 s44, s41, 2048
    v_fmac_f32 v198, -4.0, v194
    v_fma_f32 v194, v198, s26, v200
    v_mfma_f32_16x16x32_bf16 a[32:35], a[200:203], v[236:239], 0
    ds_read_b128 v[236:239], v253 offset:1824
    v_fmac_f32 v200, s27, v198
    v_mfma_f32_16x16x32_bf16 a[32:35], a[212:215], v[228:231], a[32:35]
    v_fma_f32 v198, v196, 2.0, v249
    v_fmac_f32 v249, -2.0, v196
    v_mfma_f32_16x16x32_bf16 a[32:35], a[224:227], v[232:235], a[32:35]
    v_cvt_pk_bf16_f32 v194, v248, v194
    v_cvt_pk_bf16_f32 v200, v251, v200
    v_cvt_pk_bf16_f32 v198, v250, v198
    v_mfma_f32_16x16x32_bf16 a[36:39], a[192:195], v[228:231], 0
    v_and_b32 v227, 0x7fff, v255
    v_cvt_pk_bf16_f32 v196, v252, v249
    v_mfma_f32_16x16x32_bf16 a[36:39], a[204:207], v[232:235], a[36:39]
    s_waitcnt lgkmcnt(0)
    v_lshlrev_b32 v248, 16, v195
    v_lshlrev_b32 v249, 16, v197
    v_mfma_f32_16x16x32_bf16 a[36:39], a[216:219], v[236:239], a[36:39]
    buffer_load_dwordx2 v[216:217], v227, s[4:7], s16 offen offset:832
    v_mfma_f32_16x16x32_bf16 a[40:43], a[220:223], v[236:239], 0
    ds_read_b128 v[132:135], v6 offset:21792
    v_mfma_f32_16x16x32_bf16 a[40:43], a[208:211], v[232:235], a[40:43]
    v_lshlrev_b32 v250, 16, v199
    v_lshlrev_b32 v251, 16, v201
    v_mfma_f32_16x16x32_bf16 a[40:43], a[196:199], v[228:231], a[40:43]
    v_and_b32 v195, s22, v195
    v_and_b32 v197, s22, v197
    v_mfma_f32_16x16x32_bf16 a[44:47], a[200:203], v[228:231], 0
    ds_read_b128 v[228:231], v253 offset:1568
    v_and_b32 v199, s22, v199
    v_and_b32 v201, s22, v201
    v_mfma_f32_16x16x32_bf16 a[44:47], a[212:215], v[232:235], a[44:47]
    buffer_load_dwordx2 v[218:219], v227, s[4:7], s17 offen offset:832
    v_mfma_f32_16x16x32_bf16 a[44:47], a[224:227], v[236:239], a[44:47]
    v_lshlrev_b32 v252, 16, v193
    v_and_b32 v193, s22, v193
    v_mfma_f32_16x16x32_bf16 a[48:51], a[192:195], v[232:235], 0
    v_fmac_f32 v252, s25, v251
    v_fmac_f32 v193, s25, v201
    v_mfma_f32_16x16x32_bf16 a[48:51], a[204:207], v[236:239], a[48:51]
    s_waitcnt lgkmcnt(0)
    v_fmac_f32 v252, s28, v249
    v_fmac_f32 v193, s28, v197
    v_mfma_f32_16x16x32_bf16 a[48:51], a[216:219], v[228:231], a[48:51]
    buffer_load_dwordx2 v[220:221], v227, s[4:7], s18 offen offset:832
    v_mfma_f32_16x16x32_bf16 a[52:55], a[220:223], v[228:231], 0
    ds_read_b128 v[136:139], v6 offset:24896
    v_cvt_pk_bf16_f32 v193, v252, v193
    v_lshlrev_b32 v252, 16, v203
    v_mfma_f32_16x16x32_bf16 a[52:55], a[208:211], v[236:239], a[52:55]
    v_and_b32 v203, s22, v203
    v_fmac_f32 v252, s29, v248
    v_mfma_f32_16x16x32_bf16 a[52:55], a[196:199], v[232:235], a[52:55]
    v_fmac_f32 v203, s29, v195
    v_fmac_f32 v252, s23, v250
    v_mfma_f32_16x16x32_bf16 a[56:59], a[200:203], v[232:235], 0
    ds_read_b128 v[232:235], v253 offset:1312
    v_fmac_f32 v203, s23, v199
    v_mfma_f32_16x16x32_bf16 a[56:59], a[212:215], v[236:239], a[56:59]
    buffer_load_dwordx2 v[222:223], v227, s[4:7], s19 offen offset:832
    v_mfma_f32_16x16x32_bf16 a[56:59], a[224:227], v[228:231], a[56:59]
    v_cvt_pk_bf16_f32 v203, v252, v203
    v_fma_f32 v252, v249, s24, v251
    v_mfma_f32_16x16x32_bf16 a[60:63], a[192:195], v[236:239], 0
    v_fmac_f32 v251, -4.0, v249
    v_fma_f32 v249, v248, s24, v250
    v_mfma_f32_16x16x32_bf16 a[60:63], a[204:207], v[228:231], a[60:63]
    s_waitcnt lgkmcnt(0)
    v_fmac_f32 v250, -4.0, v248
    v_fma_f32 v248, v250, s26, v251
    v_fmac_f32 v251, s27, v250
    v_mfma_f32_16x16x32_bf16 a[60:63], a[216:219], v[232:235], a[60:63]
    buffer_load_dwordx2 v[224:225], v227, s[4:7], s20 offen offset:832
    v_mfma_f32_16x16x32_bf16 a[64:67], a[220:223], v[232:235], 0
    v_fma_f32 v250, v249, 2.0, v252
    v_fmac_f32 v252, -2.0, v249
    v_mfma_f32_16x16x32_bf16 a[64:67], a[208:211], v[228:231], a[64:67]
    ds_read_b128 v[140:143], v6 offset:28000
    v_fma_f32 v249, v197, s24, v201
    v_mfma_f32_16x16x32_bf16 a[64:67], a[196:199], v[236:239], a[64:67]
    v_fmac_f32 v201, -4.0, v197
    v_fma_f32 v197, v195, s24, v199
    v_mfma_f32_16x16x32_bf16 a[68:71], a[200:203], v[236:239], 0
    ds_read_b128 v[236:239], v253 offset:1056
    v_fmac_f32 v199, -4.0, v195
    v_mfma_f32_16x16x32_bf16 a[68:71], a[212:215], v[228:231], a[68:71]
    buffer_load_dwordx2 v[226:227], v227, s[4:7], s21 offen offset:832
    v_mfma_f32_16x16x32_bf16 a[68:71], a[224:227], v[232:235], a[68:71]
    v_fma_f32 v195, v199, s26, v201
    v_fmac_f32 v201, s27, v199
    v_fma_f32 v199, v197, 2.0, v249
    v_mfma_f32_16x16x32_bf16 a[72:75], a[192:195], v[228:231], 0
    buffer_store_dwordx4 v[128:131], v254, s[12:15], s44 offen nt
    s_add_u32 s44, s41, 5120
    v_mfma_f32_16x16x32_bf16 a[72:75], a[204:207], v[232:235], a[72:75]
    s_waitcnt lgkmcnt(0)
    v_fmac_f32 v249, -2.0, v197
    v_cvt_pk_bf16_f32 v195, v248, v195
    v_mfma_f32_16x16x32_bf16 a[72:75], a[216:219], v[236:239], a[72:75]
    v_cvt_pk_bf16_f32 v201, v251, v201
    v_cvt_pk_bf16_f32 v199, v250, v199
    v_mfma_f32_16x16x32_bf16 a[76:79], a[220:223], v[236:239], 0
    buffer_store_dwordx4 v[132:135], v254, s[12:15], s44 offen nt
    v_cvt_pk_bf16_f32 v197, v252, v249
    v_lshrrev_b32 v252, 15, v255
    v_mfma_f32_16x16x32_bf16 a[76:79], a[208:211], v[232:235], a[76:79]
    ds_write_b64 v252, v[194:195] offset:9088
    v_mfma_f32_16x16x32_bf16 a[76:79], a[196:199], v[228:231], a[76:79]
    s_waitcnt vmcnt(9)
    v_lshrrev_b32 v194, 15, v255
    v_lshlrev_b32 v248, 16, v206
    v_lshlrev_b32 v249, 16, v208
    v_mfma_f32_16x16x32_bf16 a[80:83], a[200:203], v[228:231], 0
    ds_read_b128 v[228:231], v253 offset:784
    v_lshlrev_b32 v250, 16, v210
    v_mfma_f32_16x16x32_bf16 a[80:83], a[212:215], v[232:235], a[80:83]
    ds_write_b64 v194, v[200:201] offset:11168
    v_mfma_f32_16x16x32_bf16 a[80:83], a[224:227], v[236:239], a[80:83]
    s_mov_b32 s42, 73728
    s_add_u32 s44, s41, 8192
    v_lshlrev_b32 v251, 16, v212
    v_mfma_f32_16x16x32_bf16 a[84:87], a[192:195], v[232:235], 0
    ds_write_b64 v194, v[198:199] offset:13248
    v_mfma_f32_16x16x32_bf16 a[88:91], a[196:199], v[232:235], 0
    v_and_b32 v206, s22, v206
    v_and_b32 v208, s22, v208
    v_mfma_f32_16x16x32_bf16 a[92:95], a[200:203], v[232:235], 0
    ds_read_b128 v[232:235], v253 offset:3120
    v_and_b32 v210, s22, v210
    v_mfma_f32_16x16x32_bf16 a[92:95], a[212:215], v[236:239], a[92:95]
    buffer_load_dwordx4 a[192:195], v254, s[8:11], s42 offen offset:0 sc1
    v_and_b32 v212, s22, v212
    v_mfma_f32_16x16x32_bf16 a[88:91], a[208:211], v[236:239], a[88:91]
    s_waitcnt lgkmcnt(3)
    v_lshlrev_b32 v252, 16, v204
    v_and_b32 v204, s22, v204
    v_mfma_f32_16x16x32_bf16 a[84:87], a[204:207], v[236:239], a[84:87]
    ds_read_b128 v[236:239], v253 offset:2848
    v_mfma_f32_16x16x32_bf16 a[84:87], a[216:219], v[228:231], a[84:87]
    buffer_load_dwordx4 a[196:199], v254, s[8:11], s42 offen offset:1024 sc1
    v_mfma_f32_16x16x32_bf16 a[88:91], a[220:223], v[228:231], a[88:91]
    s_waitcnt vmcnt(11) lgkmcnt(1)
    v_fmac_f32 v252, s25, v251
    v_fmac_f32 v204, s25, v212
    v_mfma_f32_16x16x32_bf16 a[92:95], a[224:227], v[228:231], a[92:95]
    ds_read_b128 v[228:231], v253 offset:2592
    v_fmac_f32 v252, s28, v249
sub1:
    v_mfma_f32_16x16x32_bf16 a[96:99], a[228:231], v[232:235], 0
    buffer_load_dwordx4 a[200:203], v254, s[8:11], s42 offen offset:2048 sc1
    v_mfma_f32_16x16x32_bf16 a[100:103], a[232:235], v[232:235], 0
    s_mov_b32 s42, 76800
    v_fmac_f32 v204, s28, v208
    v_cvt_pk_bf16_f32 v204, v252, v204
    v_lshlrev_b32 v252, 16, v214
    v_mfma_f32_16x16x32_bf16 a[104:107], a[236:239], v[232:235], 0
    ds_read_b128 v[232:235], v253 offset:2336
    s_waitcnt vmcnt(12)
    s_waitcnt lgkmcnt(2)
    v_mfma_f32_16x16x32_bf16 a[104:107], a[248:251], v[236:239], a[104:107]
    ds_write_b64 v194, v[192:193] offset:15328
    v_mfma_f32_16x16x32_bf16 a[100:103], a[244:247], v[236:239], a[100:103]
    buffer_load_dwordx4 a[204:207], v254, s[8:11], s42 offen offset:0 sc1
    v_mfma_f32_16x16x32_bf16 a[96:99], a[240:243], v[236:239], a[96:99]
    s_waitcnt vmcnt(13) lgkmcnt(2)
    v_and_b32 v214, s22, v214
    v_fmac_f32 v252, s29, v248
    v_mfma_f32_16x16x32_bf16 a[96:99], a[252:255], v[228:231], a[96:99]
    buffer_store_dwordx4 v[136:139], v254, s[12:15], s44 offen nt
    v_fmac_f32 v214, s29, v206
    v_fmac_f32 v252, s23, v250
    v_mfma_f32_16x16x32_bf16 a[100:103], v[240:243], v[228:231], a[100:103]
    ds_write_b64 v194, v[202:203] offset:38208
    v_fmac_f32 v214, s23, v210
    v_mfma_f32_16x16x32_bf16 a[104:107], v[244:247], v[228:231], a[104:107]
    buffer_load_dwordx4 a[208:211], v254, s[8:11], s42 offen offset:1024 sc1
    v_mfma_f32_16x16x32_bf16 a[108:111], a[228:231], v[236:239], 0
    s_add_u32 s44, s41, 11264
    v_cvt_pk_bf16_f32 v214, v252, v214
    v_fma_f32 v252, v249, s24, v251
    v_mfma_f32_16x16x32_bf16 a[108:111], a[240:243], v[228:231], a[108:111]
    s_waitcnt lgkmcnt(2)
    v_fmac_f32 v251, -4.0, v249
    v_fma_f32 v249, v248, s24, v250
    v_mfma_f32_16x16x32_bf16 a[108:111], a[252:255], v[232:235], a[108:111]
    ds_write_b64 v194, v[196:197] offset:31968
    v_mfma_f32_16x16x32_bf16 a[112:115], v[240:243], v[232:235], 0
    buffer_load_dwordx4 a[212:215], v254, s[8:11], s42 offen offset:2048 sc1
    v_mfma_f32_16x16x32_bf16 a[112:115], a[244:247], v[228:231], a[112:115]
    s_mov_b32 s42, 79872
    v_fmac_f32 v250, -4.0, v248
    v_fma_f32 v248, v250, s26, v251
    v_mfma_f32_16x16x32_bf16 a[112:115], a[232:235], v[236:239], a[112:115]
    v_fmac_f32 v251, s27, v250
    v_fma_f32 v250, v249, 2.0, v252
    v_fmac_f32 v252, -2.0, v249
    v_mfma_f32_16x16x32_bf16 a[116:119], a[236:239], v[236:239], 0
    ds_read_b128 v[236:239], v253 offset:2080
    v_fma_f32 v249, v208, s24, v212
    v_mfma_f32_16x16x32_bf16 a[116:119], a[248:251], v[228:231], a[116:119]
    buffer_load_dwordx4 a[216:219], v254, s[8:11], s42 offen offset:0 sc1
    v_mfma_f32_16x16x32_bf16 a[116:119], v[244:247], v[232:235], a[116:119]
    v_fmac_f32 v212, -4.0, v208
    v_fma_f32 v208, v206, s24, v210
    v_mfma_f32_16x16x32_bf16 a[120:123], a[228:231], v[228:231], 0
    v_fmac_f32 v210, -4.0, v206
    v_fma_f32 v206, v210, s26, v212
    v_mfma_f32_16x16x32_bf16 a[120:123], a[240:243], v[232:235], a[120:123]
    s_waitcnt lgkmcnt(0)
    v_fmac_f32 v212, s27, v210
    v_fma_f32 v210, v208, 2.0, v249
    v_mfma_f32_16x16x32_bf16 a[120:123], a[252:255], v[236:239], a[120:123]
    v_fmac_f32 v249, -2.0, v208
    v_cvt_pk_bf16_f32 v206, v248, v206
    v_mfma_f32_16x16x32_bf16 a[124:127], v[240:243], v[236:239], 0
    buffer_load_dwordx4 a[220:223], v254, s[8:11], s42 offen offset:1024 sc1
    v_cvt_pk_bf16_f32 v212, v251, v212
    v_mfma_f32_16x16x32_bf16 a[124:127], a[244:247], v[232:235], a[124:127]
    v_cvt_pk_bf16_f32 v210, v250, v210
    v_cvt_pk_bf16_f32 v208, v252, v249
    v_mfma_f32_16x16x32_bf16 a[124:127], a[232:235], v[228:231], a[124:127]
    v_lshlrev_b32 v248, 16, v207
    v_lshlrev_b32 v249, 16, v209
    v_mfma_f32_16x16x32_bf16 a[128:131], a[236:239], v[228:231], 0
    ds_read_b128 v[228:231], v253 offset:3904
    v_lshlrev_b32 v250, 16, v211
    v_mfma_f32_16x16x32_bf16 a[128:131], a[248:251], v[232:235], a[128:131]
    buffer_load_dwordx4 a[224:227], v254, s[8:11], s42 offen offset:2048 sc1
    v_mfma_f32_16x16x32_bf16 a[128:131], v[244:247], v[236:239], a[128:131]
    v_lshlrev_b32 v251, 16, v213
    v_and_b32 v207, s22, v207
    v_mfma_f32_16x16x32_bf16 a[132:135], a[228:231], v[232:235], 0
    buffer_store_dwordx4 v[140:143], v254, s[12:15], s44 offen nt
    v_and_b32 v203, 0x7fff, v255
    v_and_b32 v209, s22, v209
    v_and_b32 v211, s22, v211
    v_mfma_f32_16x16x32_bf16 a[132:135], a[240:243], v[236:239], a[132:135]
    s_waitcnt lgkmcnt(0)
    v_and_b32 v213, s22, v213
    v_lshlrev_b32 v252, 16, v205
    v_mfma_f32_16x16x32_bf16 a[132:135], a[252:255], v[228:231], a[132:135]
    buffer_load_dwordx2 v[192:193], v203, s[4:7], s16 offen offset:1216
    v_mfma_f32_16x16x32_bf16 a[136:139], v[240:243], v[228:231], 0
    v_and_b32 v205, s22, v205
    v_fmac_f32 v252, s25, v251
    v_mfma_f32_16x16x32_bf16 a[136:139], a[244:247], v[236:239], a[136:139]
    v_fmac_f32 v205, s25, v213
    v_fmac_f32 v252, s28, v249
    v_mfma_f32_16x16x32_bf16 a[136:139], a[232:235], v[232:235], a[136:139]
    v_fmac_f32 v205, s28, v209
    v_cvt_pk_bf16_f32 v205, v252, v205
    v_mfma_f32_16x16x32_bf16 a[140:143], a[236:239], v[232:235], 0
    ds_read_b128 v[232:235], v253 offset:3648
    v_lshlrev_b32 v252, 16, v215
    v_mfma_f32_16x16x32_bf16 a[140:143], a[248:251], v[236:239], a[140:143]
    buffer_load_dwordx2 v[194:195], v203, s[4:7], s17 offen offset:1216
    v_and_b32 v215, s22, v215
    v_mfma_f32_16x16x32_bf16 a[140:143], v[244:247], v[228:231], a[140:143]
    v_fmac_f32 v252, s29, v248
    v_fmac_f32 v215, s29, v207
    v_mfma_f32_16x16x32_bf16 a[144:147], a[228:231], v[236:239], 0
    v_fmac_f32 v252, s23, v250
    v_fmac_f32 v215, s23, v211
    v_mfma_f32_16x16x32_bf16 a[144:147], a[240:243], v[228:231], a[144:147]
    s_waitcnt lgkmcnt(0)
    v_cvt_pk_bf16_f32 v215, v252, v215
    v_fma_f32 v252, v249, s24, v251
    v_mfma_f32_16x16x32_bf16 a[144:147], a[252:255], v[232:235], a[144:147]
    buffer_load_dwordx2 v[196:197], v203, s[4:7], s18 offen offset:1216
    v_mfma_f32_16x16x32_bf16 a[148:151], v[240:243], v[232:235], 0
    v_fmac_f32 v251, -4.0, v249
    v_fma_f32 v249, v248, s24, v250
    v_mfma_f32_16x16x32_bf16 a[148:151], a[244:247], v[228:231], a[148:151]
    v_fmac_f32 v250, -4.0, v248
    v_fma_f32 v248, v250, s26, v251
    v_mfma_f32_16x16x32_bf16 a[148:151], a[232:235], v[236:239], a[148:151]
    v_fmac_f32 v251, s27, v250
    v_fma_f32 v250, v249, 2.0, v252
    v_fmac_f32 v252, -2.0, v249
    v_mfma_f32_16x16x32_bf16 a[152:155], a[236:239], v[236:239], 0
    ds_read_b128 v[236:239], v253 offset:3392
    v_fma_f32 v249, v209, s24, v213
    v_mfma_f32_16x16x32_bf16 a[152:155], a[248:251], v[228:231], a[152:155]
    buffer_load_dwordx2 v[198:199], v203, s[4:7], s19 offen offset:1216
    v_mfma_f32_16x16x32_bf16 a[152:155], v[244:247], v[232:235], a[152:155]
    v_fmac_f32 v213, -4.0, v209
    v_fma_f32 v209, v207, s24, v211
    v_mfma_f32_16x16x32_bf16 a[156:159], a[228:231], v[228:231], 0
    v_fmac_f32 v211, -4.0, v207
    v_fma_f32 v207, v211, s26, v213
    v_mfma_f32_16x16x32_bf16 a[156:159], a[240:243], v[232:235], a[156:159]
    s_waitcnt lgkmcnt(0)
    v_fmac_f32 v213, s27, v211
    v_fma_f32 v211, v209, 2.0, v249
    v_mfma_f32_16x16x32_bf16 a[156:159], a[252:255], v[236:239], a[156:159]
    buffer_load_dwordx2 v[200:201], v203, s[4:7], s20 offen offset:1216
    v_fmac_f32 v249, -2.0, v209
    v_mfma_f32_16x16x32_bf16 a[160:163], v[240:243], v[236:239], 0
    v_cvt_pk_bf16_f32 v207, v248, v207
    v_cvt_pk_bf16_f32 v213, v251, v213
    v_mfma_f32_16x16x32_bf16 a[160:163], a[244:247], v[232:235], a[160:163]
    v_cvt_pk_bf16_f32 v211, v250, v211
    v_cvt_pk_bf16_f32 v209, v252, v249
    v_mfma_f32_16x16x32_bf16 a[160:163], a[232:235], v[228:231], a[160:163]
    v_lshrrev_b32 v252, 15, v255
    v_mfma_f32_16x16x32_bf16 a[164:167], a[236:239], v[228:231], 0
    ds_read_b128 v[228:231], v253 offset:3136
    v_mfma_f32_16x16x32_bf16 a[164:167], a[248:251], v[232:235], a[164:167]
    buffer_load_dwordx2 v[202:203], v203, s[4:7], s21 offen offset:1216
    v_mfma_f32_16x16x32_bf16 a[164:167], v[244:247], v[236:239], a[164:167]
    ds_write_b64 v252, v[206:207] offset:8832
    v_mfma_f32_16x16x32_bf16 a[168:171], a[228:231], v[232:235], 0
    s_waitcnt vmcnt(19)
    v_lshrrev_b32 v206, 15, v255
    v_lshlrev_b32 v248, 16, v218
    v_lshlrev_b32 v249, 16, v220
    v_mfma_f32_16x16x32_bf16 a[168:171], a[240:243], v[236:239], a[168:171]
    s_waitcnt lgkmcnt(1)
    v_lshlrev_b32 v250, 16, v222
    v_lshlrev_b32 v251, 16, v224
    v_mfma_f32_16x16x32_bf16 a[168:171], a[252:255], v[228:231], a[168:171]
    ds_write_b64 v206, v[212:213] offset:10912
    v_mfma_f32_16x16x32_bf16 a[172:175], v[240:243], v[228:231], 0
    v_and_b32 v218, s22, v218
    v_and_b32 v220, s22, v220
    v_mfma_f32_16x16x32_bf16 a[172:175], a[244:247], v[236:239], a[172:175]
    ds_write_b64 v206, v[210:211] offset:12992
    v_mfma_f32_16x16x32_bf16 a[172:175], a[232:235], v[232:235], a[172:175]
    v_and_b32 v222, s22, v222
    v_and_b32 v224, s22, v224
    v_mfma_f32_16x16x32_bf16 a[176:179], a[236:239], v[232:235], 0
    ds_read_b128 v[232:235], v253 offset:2864
    v_lshlrev_b32 v252, 16, v216
    v_mfma_f32_16x16x32_bf16 a[176:179], a[248:251], v[236:239], a[176:179]
    ds_write_b64 v206, v[204:205] offset:15072
    v_and_b32 v216, s22, v216
    v_mfma_f32_16x16x32_bf16 a[176:179], v[244:247], v[228:231], a[176:179]
    s_mov_b32 s42, 110592
    v_fmac_f32 v252, s25, v251
    v_fmac_f32 v216, s25, v224
    v_mfma_f32_16x16x32_bf16 a[180:183], a[228:231], v[236:239], 0
    ds_write_b64 v206, v[214:215] offset:37952
    v_mfma_f32_16x16x32_bf16 a[184:187], a[232:235], v[236:239], 0
    v_fmac_f32 v252, s28, v249
    v_fmac_f32 v216, s28, v220
    v_mfma_f32_16x16x32_bf16 a[188:191], a[236:239], v[236:239], 0
    ds_read_b128 v[236:239], v253 offset:5200
    v_cvt_pk_bf16_f32 v216, v252, v216
    v_mfma_f32_16x16x32_bf16 a[188:191], a[248:251], v[228:231], a[188:191]
    buffer_load_dwordx4 a[228:231], v254, s[8:11], s42 offen offset:0 sc1
    v_mfma_f32_16x16x32_bf16 a[184:187], a[244:247], v[228:231], a[184:187]
    s_waitcnt lgkmcnt(3)
    v_lshlrev_b32 v252, 16, v226
    v_and_b32 v226, s22, v226
    v_fmac_f32 v252, s29, v248
    v_mfma_f32_16x16x32_bf16 a[180:183], a[240:243], v[228:231], a[180:183]
    ds_read_b128 v[228:231], v253 offset:4928
    v_fmac_f32 v226, s29, v218
    v_mfma_f32_16x16x32_bf16 a[180:183], a[252:255], v[232:235], a[180:183]
    buffer_load_dwordx4 a[232:235], v254, s[8:11], s42 offen offset:1024 sc1
    v_mfma_f32_16x16x32_bf16 a[184:187], v[240:243], v[232:235], a[184:187]
    s_waitcnt vmcnt(16) lgkmcnt(1)
    v_fmac_f32 v252, s23, v250
    v_fmac_f32 v226, s23, v222
    v_mfma_f32_16x16x32_bf16 a[188:191], v[244:247], v[232:235], a[188:191]
    ds_read_b128 v[232:235], v253 offset:4672
    v_cvt_pk_bf16_f32 v226, v252, v226
sub2:
    v_mfma_f32_16x16x32_bf16 v[0:3], a[192:195], v[236:239], 0
    buffer_load_dwordx4 a[236:239], v254, s[8:11], s42 offen offset:2048 sc1
    v_mfma_f32_16x16x32_bf16 v[4:7], a[196:199], v[236:239], 0
    s_mov_b32 s42, 113664
    v_fma_f32 v252, v249, s24, v251
    v_fmac_f32 v251, -4.0, v249
    v_mfma_f32_16x16x32_bf16 v[8:11], a[200:203], v[236:239], 0
    ds_read_b128 v[236:239], v253 offset:4416
    s_waitcnt vmcnt(13)
    s_waitcnt lgkmcnt(2)
    v_mfma_f32_16x16x32_bf16 v[8:11], a[212:215], v[228:231], v[8:11]
    ds_write_b64 v206, v[208:209] offset:31712
    v_mfma_f32_16x16x32_bf16 v[4:7], a[208:211], v[228:231], v[4:7]
    buffer_load_dwordx4 a[240:243], v254, s[8:11], s42 offen offset:0 sc1
    v_mfma_f32_16x16x32_bf16 v[0:3], a[204:207], v[228:231], v[0:3]
    s_waitcnt vmcnt(11) lgkmcnt(2)
    v_fma_f32 v249, v248, s24, v250
    v_fmac_f32 v250, -4.0, v248
    v_mfma_f32_16x16x32_bf16 v[0:3], a[216:219], v[232:235], v[0:3]
    ds_read_b128 v[204:207], v253 offset:39712
    s_mov_b32 s45, 619910279
    v_mfma_f32_16x16x32_bf16 v[4:7], a[220:223], v[232:235], v[4:7]
    v_bfe_u32 v208, v254, 5, 3
    v_mul_u32_u24 v209, 5, v208
    v_mfma_f32_16x16x32_bf16 v[8:11], a[224:227], v[232:235], v[8:11]
    buffer_load_dwordx4 a[244:247], v254, s[8:11], s42 offen offset:1024 sc1
    v_mfma_f32_16x16x32_bf16 v[12:15], a[192:195], v[228:231], 0
    v_bfe_u32 v209, s45, v209, 5
    v_mul_u32_u24 v209, 65, v209
    v_fma_f32 v248, v250, s26, v251
    v_mfma_f32_16x16x32_bf16 v[12:15], a[204:207], v[232:235], v[12:15]
    s_waitcnt lgkmcnt(2)
    v_sub_u32 v209, v209, v208
    v_lshl_add_u32 v208, v209, 5, v253
    v_mfma_f32_16x16x32_bf16 v[12:15], a[216:219], v[236:239], v[12:15]
    s_waitcnt lgkmcnt(0)
    v_fmac_f32 v251, s27, v250
    v_fma_f32 v250, v249, 2.0, v252
    v_mfma_f32_16x16x32_bf16 v[16:19], a[220:223], v[236:239], 0
    buffer_load_dwordx4 a[248:251], v254, s[8:11], s42 offen offset:2048 sc1
    v_mfma_f32_16x16x32_bf16 v[16:19], a[208:211], v[232:235], v[16:19]
    s_mov_b32 s42, 116736
    v_fmac_f32 v252, -2.0, v249
    v_fma_f32 v249, v220, s24, v224
    v_mfma_f32_16x16x32_bf16 v[16:19], a[196:199], v[228:231], v[16:19]
    s_mov_b64 exec, s[46:47]
    ds_write_b128 v208, v[204:207] offset:1024
    s_mov_b64 exec, -1
    v_mfma_f32_16x16x32_bf16 v[20:23], a[200:203], v[228:231], 0
    ds_read_b128 v[228:231], v253 offset:4160
    v_fmac_f32 v224, -4.0, v220
    v_fma_f32 v220, v218, s24, v222
    v_mfma_f32_16x16x32_bf16 v[20:23], a[212:215], v[232:235], v[20:23]
    buffer_load_dwordx4 a[252:255], v254, s[8:11], s42 offen offset:0 sc1
    v_mfma_f32_16x16x32_bf16 v[20:23], a[224:227], v[236:239], v[20:23]
    v_fmac_f32 v222, -4.0, v218
    v_fma_f32 v218, v222, s26, v224
    v_mfma_f32_16x16x32_bf16 v[24:27], a[192:195], v[232:235], 0
    v_fmac_f32 v224, s27, v222
    v_fma_f32 v222, v220, 2.0, v249
    v_mfma_f32_16x16x32_bf16 v[24:27], a[204:207], v[236:239], v[24:27]
    s_waitcnt lgkmcnt(0)
    v_fmac_f32 v249, -2.0, v220
    v_cvt_pk_bf16_f32 v218, v248, v218
    v_mfma_f32_16x16x32_bf16 v[24:27], a[216:219], v[228:231], v[24:27]
    v_cvt_pk_bf16_f32 v224, v251, v224
    v_cvt_pk_bf16_f32 v222, v250, v222
    v_mfma_f32_16x16x32_bf16 v[28:31], a[220:223], v[228:231], 0
    buffer_load_dwordx4 v[240:243], v254, s[8:11], s42 offen offset:1024 sc1
    v_mfma_f32_16x16x32_bf16 v[28:31], a[208:211], v[236:239], v[28:31]
    v_cvt_pk_bf16_f32 v220, v252, v249
    v_lshlrev_b32 v248, 16, v219
    v_lshlrev_b32 v249, 16, v221
    v_mfma_f32_16x16x32_bf16 v[28:31], a[196:199], v[232:235], v[28:31]
    v_lshlrev_b32 v250, 16, v223
    v_lshlrev_b32 v251, 16, v225
    v_mfma_f32_16x16x32_bf16 v[32:35], a[200:203], v[232:235], 0
    ds_read_b128 v[232:235], v253 offset:5984
    v_and_b32 v219, s22, v219
    v_mfma_f32_16x16x32_bf16 v[32:35], a[212:215], v[236:239], v[32:35]
    buffer_load_dwordx4 v[244:247], v254, s[8:11], s42 offen offset:2048 sc1
    v_mfma_f32_16x16x32_bf16 v[32:35], a[224:227], v[228:231], v[32:35]
    v_and_b32 v221, s22, v221
    v_and_b32 v223, s22, v223
    v_mfma_f32_16x16x32_bf16 v[36:39], a[192:195], v[236:239], 0
    v_and_b32 v215, 0x7fff, v255
    v_and_b32 v225, s22, v225
    v_mfma_f32_16x16x32_bf16 v[36:39], a[204:207], v[228:231], v[36:39]
    s_waitcnt lgkmcnt(0)
    v_lshlrev_b32 v252, 16, v217
    v_and_b32 v217, s22, v217
    v_mfma_f32_16x16x32_bf16 v[36:39], a[216:219], v[232:235], v[36:39]
    buffer_load_dwordx2 v[204:205], v215, s[4:7], s16 offen offset:128
    v_fmac_f32 v252, s25, v251
    v_mfma_f32_16x16x32_bf16 v[40:43], a[220:223], v[232:235], 0
    v_fmac_f32 v217, s25, v225
    v_fmac_f32 v252, s28, v249
    v_mfma_f32_16x16x32_bf16 v[40:43], a[208:211], v[228:231], v[40:43]
    v_fmac_f32 v217, s28, v221
    v_cvt_pk_bf16_f32 v217, v252, v217
    v_mfma_f32_16x16x32_bf16 v[40:43], a[196:199], v[236:239], v[40:43]
    v_lshlrev_b32 v252, 16, v227
    v_and_b32 v227, s22, v227
    v_mfma_f32_16x16x32_bf16 v[44:47], a[200:203], v[236:239], 0
    ds_read_b128 v[236:239], v253 offset:5728
    v_fmac_f32 v252, s29, v248
    v_mfma_f32_16x16x32_bf16 v[44:47], a[212:215], v[228:231], v[44:47]
    buffer_load_dwordx2 v[206:207], v215, s[4:7], s17 offen offset:128
    v_mfma_f32_16x16x32_bf16 v[44:47], a[224:227], v[232:235], v[44:47]
    v_fmac_f32 v227, s29, v219
    v_fmac_f32 v252, s23, v250
    v_fmac_f32 v227, s23, v223
    v_mfma_f32_16x16x32_bf16 v[48:51], a[192:195], v[228:231], 0
    v_cvt_pk_bf16_f32 v227, v252, v227
    v_fma_f32 v252, v249, s24, v251
    v_mfma_f32_16x16x32_bf16 v[48:51], a[204:207], v[232:235], v[48:51]
    s_waitcnt lgkmcnt(0)
    v_fmac_f32 v251, -4.0, v249
    v_fma_f32 v249, v248, s24, v250
    v_mfma_f32_16x16x32_bf16 v[48:51], a[216:219], v[236:239], v[48:51]
    buffer_load_dwordx2 v[208:209], v215, s[4:7], s18 offen offset:128
    v_mfma_f32_16x16x32_bf16 v[52:55], a[220:223], v[236:239], 0
    v_fmac_f32 v250, -4.0, v248
    v_fma_f32 v248, v250, s26, v251
    v_mfma_f32_16x16x32_bf16 v[52:55], a[208:211], v[232:235], v[52:55]
    v_fmac_f32 v251, s27, v250
    v_fma_f32 v250, v249, 2.0, v252
    v_mfma_f32_16x16x32_bf16 v[52:55], a[196:199], v[228:231], v[52:55]
    v_fmac_f32 v252, -2.0, v249
    v_fma_f32 v249, v221, s24, v225
    v_mfma_f32_16x16x32_bf16 v[56:59], a[200:203], v[228:231], 0
    ds_read_b128 v[228:231], v253 offset:5472
    v_fmac_f32 v225, -4.0, v221
    v_fma_f32 v221, v219, s24, v223
    v_mfma_f32_16x16x32_bf16 v[56:59], a[212:215], v[232:235], v[56:59]
    buffer_load_dwordx2 v[210:211], v215, s[4:7], s19 offen offset:128
    v_mfma_f32_16x16x32_bf16 v[56:59], a[224:227], v[236:239], v[56:59]
    v_fmac_f32 v223, -4.0, v219
    v_fma_f32 v219, v223, s26, v225
    v_mfma_f32_16x16x32_bf16 v[60:63], a[192:195], v[232:235], 0
    v_fmac_f32 v225, s27, v223
    v_fma_f32 v223, v221, 2.0, v249
    v_mfma_f32_16x16x32_bf16 v[60:63], a[204:207], v[236:239], v[60:63]
    s_waitcnt lgkmcnt(0)
    v_fmac_f32 v249, -2.0, v221
    v_cvt_pk_bf16_f32 v219, v248, v219
    v_mfma_f32_16x16x32_bf16 v[60:63], a[216:219], v[228:231], v[60:63]
    buffer_load_dwordx2 v[212:213], v215, s[4:7], s20 offen offset:128
    v_mfma_f32_16x16x32_bf16 v[64:67], a[220:223], v[228:231], 0
    v_cvt_pk_bf16_f32 v225, v251, v225
    v_cvt_pk_bf16_f32 v223, v250, v223
    v_mfma_f32_16x16x32_bf16 v[64:67], a[208:211], v[236:239], v[64:67]
    v_cvt_pk_bf16_f32 v221, v252, v249
    v_lshrrev_b32 v252, 15, v255
    v_mfma_f32_16x16x32_bf16 v[64:67], a[196:199], v[232:235], v[64:67]
    ds_write_b64 v252, v[218:219] offset:8576
    v_mfma_f32_16x16x32_bf16 v[68:71], a[200:203], v[232:235], 0
    ds_read_b128 v[232:235], v253 offset:5216
    v_lshrrev_b32 v218, 15, v255
    v_mfma_f32_16x16x32_bf16 v[68:71], a[212:215], v[236:239], v[68:71]
    buffer_load_dwordx2 v[214:215], v215, s[4:7], s21 offen offset:128
    v_mfma_f32_16x16x32_bf16 v[68:71], a[224:227], v[228:231], v[68:71]
    ds_write_b64 v218, v[224:225] offset:10656
    v_mfma_f32_16x16x32_bf16 v[72:75], a[192:195], v[236:239], 0
    s_waitcnt vmcnt(15)
    v_lshlrev_b32 v248, 16, v194
    v_lshlrev_b32 v249, 16, v196
    v_mfma_f32_16x16x32_bf16 v[72:75], a[204:207], v[228:231], v[72:75]
    s_waitcnt lgkmcnt(1)
    v_lshlrev_b32 v250, 16, v198
    v_lshlrev_b32 v251, 16, v200
    v_and_b32 v194, s22, v194
    v_mfma_f32_16x16x32_bf16 v[72:75], a[216:219], v[232:235], v[72:75]
    ds_write_b64 v218, v[222:223] offset:12736
    v_mfma_f32_16x16x32_bf16 v[76:79], a[220:223], v[232:235], 0
    v_and_b32 v196, s22, v196
    v_and_b32 v198, s22, v198
    v_mfma_f32_16x16x32_bf16 v[76:79], a[208:211], v[228:231], v[76:79]
pad1:
    s_cbranch_vccnz pad5
    ds_write_b64 v218, v[216:217] offset:14816
    v_mfma_f32_16x16x32_bf16 v[76:79], a[196:199], v[236:239], v[76:79]
    v_and_b32 v200, s22, v200
    v_lshlrev_b32 v252, 16, v192
    v_mfma_f32_16x16x32_bf16 v[80:83], a[200:203], v[236:239], 0
    ds_read_b128 v[236:239], v253 offset:4944
    v_and_b32 v192, s22, v192
    v_mfma_f32_16x16x32_bf16 v[80:83], a[212:215], v[228:231], v[80:83]
    ds_write_b64 v218, v[226:227] offset:37696
    v_mfma_f32_16x16x32_bf16 v[80:83], a[224:227], v[232:235], v[80:83]
    s_mov_b32 s42, 147456
    v_fmac_f32 v252, s25, v251
    v_fmac_f32 v192, s25, v200
    v_fmac_f32 v252, s28, v249
    v_mfma_f32_16x16x32_bf16 v[84:87], a[192:195], v[228:231], 0
    ds_write_b64 v218, v[220:221] offset:31456
    v_mfma_f32_16x16x32_bf16 v[88:91], a[196:199], v[228:231], 0
    v_fmac_f32 v192, s28, v196
    v_cvt_pk_bf16_f32 v192, v252, v192
    v_mfma_f32_16x16x32_bf16 v[92:95], a[200:203], v[228:231], 0
    ds_read_b128 v[228:231], v253 offset:7280
    v_lshlrev_b32 v252, 16, v202
    v_mfma_f32_16x16x32_bf16 v[92:95], a[212:215], v[232:235], v[92:95]
    buffer_load_dwordx4 a[192:195], v254, s[8:11], s42 offen offset:0 sc1
    v_mfma_f32_16x16x32_bf16 v[88:91], a[208:211], v[232:235], v[88:91]
    s_waitcnt lgkmcnt(3)
    v_and_b32 v202, s22, v202
    v_fmac_f32 v252, s29, v248
    v_mfma_f32_16x16x32_bf16 v[84:87], a[204:207], v[232:235], v[84:87]
    ds_read_b128 v[232:235], v253 offset:7008
    v_fmac_f32 v202, s29, v194
    v_mfma_f32_16x16x32_bf16 v[84:87], a[216:219], v[236:239], v[84:87]
    buffer_load_dwordx4 a[196:199], v254, s[8:11], s42 offen offset:1024 sc1
    v_fmac_f32 v252, s23, v250
    v_mfma_f32_16x16x32_bf16 v[88:91], a[220:223], v[236:239], v[88:91]
    s_waitcnt vmcnt(14) lgkmcnt(1)
    v_fmac_f32 v202, s23, v198
    v_cvt_pk_bf16_f32 v202, v252, v202
    v_mfma_f32_16x16x32_bf16 v[92:95], a[224:227], v[236:239], v[92:95]
    ds_read_b128 v[236:239], v253 offset:6752
    v_fma_f32 v252, v249, s24, v251
sub3:
    v_mfma_f32_16x16x32_bf16 v[96:99], a[228:231], v[228:231], 0
    buffer_load_dwordx4 a[200:203], v254, s[8:11], s42 offen offset:2048 sc1
    v_mfma_f32_16x16x32_bf16 v[100:103], a[232:235], v[228:231], 0
    s_mov_b32 s42, 150528
    v_fmac_f32 v251, -4.0, v249
    v_fma_f32 v249, v248, s24, v250
    v_mfma_f32_16x16x32_bf16 v[104:107], a[236:239], v[228:231], 0
    ds_read_b128 v[228:231], v253 offset:6496
    s_waitcnt vmcnt(12)
    s_waitcnt lgkmcnt(2)
    v_mfma_f32_16x16x32_bf16 v[104:107], a[248:251], v[232:235], v[104:107]
    v_fmac_f32 v250, -4.0, v248
    v_fma_f32 v248, v250, s26, v251
    v_fmac_f32 v251, s27, v250
    v_mfma_f32_16x16x32_bf16 v[100:103], a[244:247], v[232:235], v[100:103]
    buffer_load_dwordx4 a[204:207], v254, s[8:11], s42 offen offset:0 sc1
    v_mfma_f32_16x16x32_bf16 v[96:99], a[240:243], v[232:235], v[96:99]
    s_waitcnt vmcnt(10) lgkmcnt(1)
    v_fma_f32 v250, v249, 2.0, v252
    v_fmac_f32 v252, -2.0, v249
    v_mfma_f32_16x16x32_bf16 v[96:99], a[252:255], v[236:239], v[96:99]
    v_fma_f32 v249, v196, s24, v200
    v_fmac_f32 v200, -4.0, v196
    v_mfma_f32_16x16x32_bf16 v[100:103], v[240:243], v[236:239], v[100:103]
    v_fma_f32 v196, v194, s24, v198
    v_fmac_f32 v198, -4.0, v194
    v_mfma_f32_16x16x32_bf16 v[104:107], v[244:247], v[236:239], v[104:107]
    buffer_load_dwordx4 a[208:211], v254, s[8:11], s42 offen offset:1024 sc1
    v_mfma_f32_16x16x32_bf16 v[108:111], a[228:231], v[232:235], 0
    v_fma_f32 v194, v198, s26, v200
    v_fmac_f32 v200, s27, v198
    v_mfma_f32_16x16x32_bf16 v[108:111], a[240:243], v[236:239], v[108:111]
    s_waitcnt lgkmcnt(0)
    v_fma_f32 v198, v196, 2.0, v249
    v_fmac_f32 v249, -2.0, v196
    v_cvt_pk_bf16_f32 v194, v248, v194
    v_mfma_f32_16x16x32_bf16 v[108:111], a[252:255], v[228:231], v[108:111]
    v_cvt_pk_bf16_f32 v200, v251, v200
    v_cvt_pk_bf16_f32 v198, v250, v198
    v_mfma_f32_16x16x32_bf16 v[112:115], v[240:243], v[228:231], 0
    buffer_load_dwordx4 a[212:215], v254, s[8:11], s42 offen offset:2048 sc1
    v_mfma_f32_16x16x32_bf16 v[112:115], a[244:247], v[236:239], v[112:115]
    s_mov_b32 s42, 153600
    v_cvt_pk_bf16_f32 v196, v252, v249
    v_lshlrev_b32 v248, 16, v195
    v_mfma_f32_16x16x32_bf16 v[112:115], a[232:235], v[232:235], v[112:115]
    v_lshlrev_b32 v249, 16, v197
    v_lshlrev_b32 v250, 16, v199
    v_mfma_f32_16x16x32_bf16 v[116:119], a[236:239], v[232:235], 0
    ds_read_b128 v[232:235], v253 offset:6240
    v_lshlrev_b32 v251, 16, v201
    v_mfma_f32_16x16x32_bf16 v[116:119], a[248:251], v[236:239], v[116:119]
    buffer_load_dwordx4 a[216:219], v254, s[8:11], s42 offen offset:0 sc1
    v_mfma_f32_16x16x32_bf16 v[116:119], v[244:247], v[228:231], v[116:119]
    v_and_b32 v195, s22, v195
    v_and_b32 v197, s22, v197
    v_and_b32 v199, s22, v199
    v_mfma_f32_16x16x32_bf16 v[120:123], a[228:231], v[236:239], 0
    v_and_b32 v201, s22, v201
    v_lshlrev_b32 v252, 16, v193
    v_mfma_f32_16x16x32_bf16 v[120:123], a[240:243], v[228:231], v[120:123]
    s_waitcnt lgkmcnt(0)
    v_and_b32 v193, s22, v193
    v_fmac_f32 v252, s25, v251
    v_mfma_f32_16x16x32_bf16 v[120:123], a[252:255], v[232:235], v[120:123]
    v_fmac_f32 v193, s25, v201
    v_fmac_f32 v252, s28, v249
    v_mfma_f32_16x16x32_bf16 v[124:127], v[240:243], v[232:235], 0
    buffer_load_dwordx4 a[220:223], v254, s[8:11], s42 offen offset:1024 sc1
    v_mfma_f32_16x16x32_bf16 v[124:127], a[244:247], v[228:231], v[124:127]
    v_fmac_f32 v193, s28, v197
    v_cvt_pk_bf16_f32 v193, v252, v193
    v_mfma_f32_16x16x32_bf16 v[124:127], a[232:235], v[236:239], v[124:127]
    v_lshlrev_b32 v252, 16, v203
    v_and_b32 v203, s22, v203
    v_fmac_f32 v252, s29, v248
    v_mfma_f32_16x16x32_bf16 v[128:131], a[236:239], v[236:239], 0
    ds_read_b128 v[236:239], v253 offset:8064
    v_fmac_f32 v203, s29, v195
    v_mfma_f32_16x16x32_bf16 v[128:131], a[248:251], v[228:231], v[128:131]
    buffer_load_dwordx4 a[224:227], v254, s[8:11], s42 offen offset:2048 sc1
    v_mfma_f32_16x16x32_bf16 v[128:131], v[244:247], v[232:235], v[128:131]
    v_fmac_f32 v252, s23, v250
    v_fmac_f32 v203, s23, v199
    v_mfma_f32_16x16x32_bf16 v[132:135], a[228:231], v[228:231], 0
    v_and_b32 v227, 0x7fff, v255
    v_cvt_pk_bf16_f32 v203, v252, v203
    v_mfma_f32_16x16x32_bf16 v[132:135], a[240:243], v[232:235], v[132:135]
    s_waitcnt lgkmcnt(0)
    v_fma_f32 v252, v249, s24, v251
    v_fmac_f32 v251, -4.0, v249
    v_mfma_f32_16x16x32_bf16 v[132:135], a[252:255], v[236:239], v[132:135]
    buffer_load_dwordx2 v[216:217], v227, s[4:7], s16 offen offset:512
    v_mfma_f32_16x16x32_bf16 v[136:139], v[240:243], v[236:239], 0
    v_fma_f32 v249, v248, s24, v250
    v_fmac_f32 v250, -4.0, v248
    v_fma_f32 v248, v250, s26, v251
    v_mfma_f32_16x16x32_bf16 v[136:139], a[244:247], v[232:235], v[136:139]
    v_fmac_f32 v251, s27, v250
    v_fma_f32 v250, v249, 2.0, v252
    v_mfma_f32_16x16x32_bf16 v[136:139], a[232:235], v[228:231], v[136:139]
    v_fmac_f32 v252, -2.0, v249
    v_fma_f32 v249, v197, s24, v201
    v_mfma_f32_16x16x32_bf16 v[140:143], a[236:239], v[228:231], 0
    ds_read_b128 v[228:231], v253 offset:7808
    v_fmac_f32 v201, -4.0, v197
    v_mfma_f32_16x16x32_bf16 v[140:143], a[248:251], v[232:235], v[140:143]
    buffer_load_dwordx2 v[218:219], v227, s[4:7], s17 offen offset:512
    v_mfma_f32_16x16x32_bf16 v[140:143], v[244:247], v[236:239], v[140:143]
    v_fma_f32 v197, v195, s24, v199
    v_fmac_f32 v199, -4.0, v195
    v_mfma_f32_16x16x32_bf16 v[144:147], a[228:231], v[232:235], 0
    v_fma_f32 v195, v199, s26, v201
    v_fmac_f32 v201, s27, v199
    v_mfma_f32_16x16x32_bf16 v[144:147], a[240:243], v[236:239], v[144:147]
    s_waitcnt lgkmcnt(0)
    v_fma_f32 v199, v197, 2.0, v249
    v_fmac_f32 v249, -2.0, v197
    v_cvt_pk_bf16_f32 v195, v248, v195
    v_mfma_f32_16x16x32_bf16 v[144:147], a[252:255], v[228:231], v[144:147]
    buffer_load_dwordx2 v[220:221], v227, s[4:7], s18 offen offset:512
    v_mfma_f32_16x16x32_bf16 v[148:151], v[240:243], v[228:231], 0
    v_cvt_pk_bf16_f32 v201, v251, v201
    v_cvt_pk_bf16_f32 v199, v250, v199
    v_mfma_f32_16x16x32_bf16 v[148:151], a[244:247], v[236:239], v[148:151]
    v_cvt_pk_bf16_f32 v197, v252, v249
    v_lshrrev_b32 v252, 15, v255
    v_mfma_f32_16x16x32_bf16 v[148:151], a[232:235], v[232:235], v[148:151]
    ds_write_b64 v252, v[194:195] offset:8320
    v_mfma_f32_16x16x32_bf16 v[152:155], a[236:239], v[232:235], 0
    ds_read_b128 v[232:235], v253 offset:7552
    v_lshrrev_b32 v194, 15, v255
    v_mfma_f32_16x16x32_bf16 v[152:155], a[248:251], v[236:239], v[152:155]
    buffer_load_dwordx2 v[222:223], v227, s[4:7], s19 offen offset:512
    v_mfma_f32_16x16x32_bf16 v[152:155], v[244:247], v[228:231], v[152:155]
    ds_write_b64 v194, v[200:201] offset:10400
    v_mfma_f32_16x16x32_bf16 v[156:159], a[228:231], v[236:239], 0
    v_mfma_f32_16x16x32_bf16 v[156:159], a[240:243], v[228:231], v[156:159]
    s_waitcnt lgkmcnt(1)
    s_waitcnt vmcnt(13)
    v_lshlrev_b32 v248, 16, v206
    v_mfma_f32_16x16x32_bf16 v[156:159], a[252:255], v[232:235], v[156:159]
    buffer_load_dwordx2 v[224:225], v227, s[4:7], s20 offen offset:512
    v_mfma_f32_16x16x32_bf16 v[160:163], v[240:243], v[232:235], 0
    ds_write_b64 v194, v[198:199] offset:12480
    v_mfma_f32_16x16x32_bf16 v[160:163], a[244:247], v[228:231], v[160:163]
    v_lshlrev_b32 v249, 16, v208
    v_lshlrev_b32 v250, 16, v210
    v_mfma_f32_16x16x32_bf16 v[160:163], a[232:235], v[236:239], v[160:163]
    ds_write_b64 v194, v[192:193] offset:14560
    v_mfma_f32_16x16x32_bf16 v[164:167], a[236:239], v[236:239], 0
    ds_read_b128 v[236:239], v253 offset:7296
    v_lshlrev_b32 v251, 16, v212
    v_mfma_f32_16x16x32_bf16 v[164:167], a[248:251], v[228:231], v[164:167]
    buffer_load_dwordx2 v[226:227], v227, s[4:7], s21 offen offset:512
    v_mfma_f32_16x16x32_bf16 v[164:167], v[244:247], v[232:235], v[164:167]
    ds_write_b64 v194, v[202:203] offset:37440
    v_mfma_f32_16x16x32_bf16 v[168:171], a[228:231], v[228:231], 0
    v_and_b32 v206, s22, v206
    v_and_b32 v208, s22, v208
    v_mfma_f32_16x16x32_bf16 v[168:171], a[240:243], v[232:235], v[168:171]
    s_waitcnt lgkmcnt(1)
    v_and_b32 v210, s22, v210
    v_and_b32 v212, s22, v212
    v_mfma_f32_16x16x32_bf16 v[168:171], a[252:255], v[236:239], v[168:171]
    ds_write_b64 v194, v[196:197] offset:31200
    v_mfma_f32_16x16x32_bf16 v[172:175], v[240:243], v[236:239], 0
    v_lshlrev_b32 v252, 16, v204
    v_and_b32 v204, s22, v204
    v_mfma_f32_16x16x32_bf16 v[172:175], a[244:247], v[232:235], v[172:175]
    v_fmac_f32 v252, s25, v251
    v_fmac_f32 v204, s25, v212
    v_mfma_f32_16x16x32_bf16 v[172:175], a[232:235], v[228:231], v[172:175]
    v_fmac_f32 v252, s28, v249
    v_fmac_f32 v204, s28, v208
    v_mfma_f32_16x16x32_bf16 v[176:179], a[236:239], v[228:231], 0
    ds_read_b128 v[228:231], v253 offset:7024
    v_cvt_pk_bf16_f32 v204, v252, v204
    v_mfma_f32_16x16x32_bf16 v[176:179], a[248:251], v[232:235], v[176:179]
    v_lshlrev_b32 v252, 16, v214
    v_and_b32 v214, s22, v214
    v_mfma_f32_16x16x32_bf16 v[176:179], v[244:247], v[236:239], v[176:179]
    s_mov_b32 s42, 184320
    v_fmac_f32 v252, s29, v248
    v_fmac_f32 v214, s29, v206
    v_mfma_f32_16x16x32_bf16 v[180:183], a[228:231], v[232:235], 0
    s_waitcnt lgkmcnt(0)
    v_fmac_f32 v252, s23, v250
    v_fmac_f32 v214, s23, v210
    v_cvt_pk_bf16_f32 v214, v252, v214
    v_mfma_f32_16x16x32_bf16 v[184:187], a[232:235], v[232:235], 0
    s_barrier
    v_mfma_f32_16x16x32_bf16 v[188:191], a[236:239], v[232:235], 0
    ds_read_b128 v[232:235], v253 offset:9360
    v_fma_f32 v252, v249, s24, v251
    v_mfma_f32_16x16x32_bf16 v[188:191], a[248:251], v[236:239], v[188:191]
    buffer_load_dwordx4 a[228:231], v254, s[8:11], s42 offen offset:0 sc1
    v_mfma_f32_16x16x32_bf16 v[184:187], a[244:247], v[236:239], v[184:187]
    v_fmac_f32 v251, -4.0, v249
    v_fma_f32 v249, v248, s24, v250
    v_mfma_f32_16x16x32_bf16 v[180:183], a[240:243], v[236:239], v[180:183]
    ds_read_b128 v[236:239], v253 offset:9088
    v_fmac_f32 v250, -4.0, v248
    v_mfma_f32_16x16x32_bf16 v[180:183], a[252:255], v[228:231], v[180:183]
    buffer_load_dwordx4 a[232:235], v254, s[8:11], s42 offen offset:1024 sc1
    v_mfma_f32_16x16x32_bf16 v[184:187], v[240:243], v[228:231], v[184:187]
    s_waitcnt vmcnt(14) lgkmcnt(1)
    v_fma_f32 v248, v250, s26, v251
    v_fmac_f32 v251, s27, v250
    v_mfma_f32_16x16x32_bf16 v[188:191], v[244:247], v[228:231], v[188:191]
    ds_read_b128 v[228:231], v253 offset:8832
    v_fma_f32 v250, v249, 2.0, v252
sub4:
    v_mfma_f32_16x16x32_bf16 a[0:3], a[192:195], v[232:235], a[0:3]
    buffer_load_dwordx4 a[236:239], v254, s[8:11], s42 offen offset:2048 sc1
    v_mfma_f32_16x16x32_bf16 a[4:7], a[196:199], v[232:235], a[4:7]
    s_mov_b32 s42, 187392
    v_fmac_f32 v252, -2.0, v249
    v_fma_f32 v249, v208, s24, v212
    v_mfma_f32_16x16x32_bf16 a[8:11], a[200:203], v[232:235], a[8:11]
    ds_read_b128 v[232:235], v253 offset:8576
    s_waitcnt vmcnt(12)
    s_waitcnt lgkmcnt(2)
    v_mfma_f32_16x16x32_bf16 a[8:11], a[212:215], v[236:239], a[8:11]
    v_fmac_f32 v212, -4.0, v208
    v_fma_f32 v208, v206, s24, v210
    v_mfma_f32_16x16x32_bf16 a[4:7], a[208:211], v[236:239], a[4:7]
    buffer_load_dwordx4 a[240:243], v254, s[8:11], s42 offen offset:0 sc1
    v_mfma_f32_16x16x32_bf16 a[0:3], a[204:207], v[236:239], a[0:3]
    s_waitcnt vmcnt(10) lgkmcnt(1)
    v_fmac_f32 v210, -4.0, v206
    v_fma_f32 v206, v210, s26, v212
    v_mfma_f32_16x16x32_bf16 a[0:3], a[216:219], v[228:231], a[0:3]
    v_fmac_f32 v212, s27, v210
    v_fma_f32 v210, v208, 2.0, v249
    v_mfma_f32_16x16x32_bf16 a[4:7], a[220:223], v[228:231], a[4:7]
    v_fmac_f32 v249, -2.0, v208
    v_cvt_pk_bf16_f32 v206, v248, v206
    v_mfma_f32_16x16x32_bf16 a[8:11], a[224:227], v[228:231], a[8:11]
    buffer_load_dwordx4 a[244:247], v254, s[8:11], s42 offen offset:1024 sc1
    v_mfma_f32_16x16x32_bf16 a[12:15], a[192:195], v[236:239], a[12:15]
    v_cvt_pk_bf16_f32 v212, v251, v212
    v_cvt_pk_bf16_f32 v210, v250, v210
    v_mfma_f32_16x16x32_bf16 a[12:15], a[204:207], v[228:231], a[12:15]
    s_waitcnt lgkmcnt(0)
    v_cvt_pk_bf16_f32 v208, v252, v249
    v_lshlrev_b32 v248, 16, v207
    v_mfma_f32_16x16x32_bf16 a[12:15], a[216:219], v[232:235], a[12:15]
    v_lshlrev_b32 v249, 16, v209
    v_lshlrev_b32 v250, 16, v211
    v_mfma_f32_16x16x32_bf16 a[16:19], a[220:223], v[232:235], a[16:19]
    buffer_load_dwordx4 a[248:251], v254, s[8:11], s42 offen offset:2048 sc1
    v_mfma_f32_16x16x32_bf16 a[16:19], a[208:211], v[228:231], a[16:19]
    s_mov_b32 s42, 190464
    v_lshlrev_b32 v251, 16, v213
    v_and_b32 v207, s22, v207
    v_mfma_f32_16x16x32_bf16 a[16:19], a[196:199], v[236:239], a[16:19]
    v_and_b32 v209, s22, v209
    v_and_b32 v211, s22, v211
    v_mfma_f32_16x16x32_bf16 a[20:23], a[200:203], v[236:239], a[20:23]
    ds_read_b128 v[236:239], v253 offset:8320
    v_and_b32 v213, s22, v213
    v_mfma_f32_16x16x32_bf16 a[20:23], a[212:215], v[228:231], a[20:23]
    buffer_load_dwordx4 a[252:255], v254, s[8:11], s42 offen offset:0 sc1
    v_mfma_f32_16x16x32_bf16 a[20:23], a[224:227], v[232:235], a[20:23]
    v_lshlrev_b32 v252, 16, v205
    v_and_b32 v205, s22, v205
    v_mfma_f32_16x16x32_bf16 a[24:27], a[192:195], v[228:231], a[24:27]
    v_fmac_f32 v252, s25, v251
    v_fmac_f32 v205, s25, v213
    v_mfma_f32_16x16x32_bf16 a[24:27], a[204:207], v[232:235], a[24:27]
    s_waitcnt lgkmcnt(0)
    v_fmac_f32 v252, s28, v249
    v_fmac_f32 v205, s28, v209
    v_mfma_f32_16x16x32_bf16 a[24:27], a[216:219], v[236:239], a[24:27]
    v_cvt_pk_bf16_f32 v205, v252, v205
    v_lshlrev_b32 v252, 16, v215
    v_mfma_f32_16x16x32_bf16 a[28:31], a[220:223], v[236:239], a[28:31]
    buffer_load_dwordx4 v[240:243], v254, s[8:11], s42 offen offset:1024 sc1
    v_mfma_f32_16x16x32_bf16 a[28:31], a[208:211], v[232:235], a[28:31]
    v_and_b32 v215, s22, v215
    v_fmac_f32 v252, s29, v248
    v_mfma_f32_16x16x32_bf16 a[28:31], a[196:199], v[228:231], a[28:31]
    v_fmac_f32 v215, s29, v207
    v_fmac_f32 v252, s23, v250
    v_mfma_f32_16x16x32_bf16 a[32:35], a[200:203], v[228:231], a[32:35]
    ds_read_b128 v[228:231], v253 offset:10144
    v_fmac_f32 v215, s23, v211
    v_mfma_f32_16x16x32_bf16 a[32:35], a[212:215], v[232:235], a[32:35]
    buffer_load_dwordx4 v[244:247], v254, s[8:11], s42 offen offset:2048 sc1
    v_mfma_f32_16x16x32_bf16 a[32:35], a[224:227], v[236:239], a[32:35]
    v_cvt_pk_bf16_f32 v215, v252, v215
    v_fma_f32 v252, v249, s24, v251
    v_mfma_f32_16x16x32_bf16 a[36:39], a[192:195], v[232:235], a[36:39]
    v_and_b32 v203, 0x7fff, v255
    v_fmac_f32 v251, -4.0, v249
    v_mfma_f32_16x16x32_bf16 a[36:39], a[204:207], v[236:239], a[36:39]
    s_waitcnt lgkmcnt(0)
    v_fma_f32 v249, v248, s24, v250
    v_fmac_f32 v250, -4.0, v248
    v_mfma_f32_16x16x32_bf16 a[36:39], a[216:219], v[228:231], a[36:39]
    buffer_load_dwordx2 v[192:193], v203, s[4:7], s16 offen offset:896
    v_mfma_f32_16x16x32_bf16 a[40:43], a[220:223], v[228:231], a[40:43]
    v_fma_f32 v248, v250, s26, v251
    v_fmac_f32 v251, s27, v250
    v_mfma_f32_16x16x32_bf16 a[40:43], a[208:211], v[236:239], a[40:43]
    v_fma_f32 v250, v249, 2.0, v252
    v_fmac_f32 v252, -2.0, v249
    v_fma_f32 v249, v209, s24, v213
    v_mfma_f32_16x16x32_bf16 a[40:43], a[196:199], v[232:235], a[40:43]
    v_fmac_f32 v213, -4.0, v209
    v_fma_f32 v209, v207, s24, v211
    v_mfma_f32_16x16x32_bf16 a[44:47], a[200:203], v[232:235], a[44:47]
    ds_read_b128 v[232:235], v253 offset:9888
    v_fmac_f32 v211, -4.0, v207
    v_mfma_f32_16x16x32_bf16 a[44:47], a[212:215], v[236:239], a[44:47]
    buffer_load_dwordx2 v[194:195], v203, s[4:7], s17 offen offset:896
    v_mfma_f32_16x16x32_bf16 a[44:47], a[224:227], v[228:231], a[44:47]
    v_fma_f32 v207, v211, s26, v213
    v_fmac_f32 v213, s27, v211
    v_mfma_f32_16x16x32_bf16 a[48:51], a[192:195], v[236:239], a[48:51]
    v_fma_f32 v211, v209, 2.0, v249
    v_fmac_f32 v249, -2.0, v209
    v_mfma_f32_16x16x32_bf16 a[48:51], a[204:207], v[228:231], a[48:51]
    s_waitcnt lgkmcnt(0)
    v_cvt_pk_bf16_f32 v207, v248, v207
    v_cvt_pk_bf16_f32 v213, v251, v213
    v_mfma_f32_16x16x32_bf16 a[48:51], a[216:219], v[232:235], a[48:51]
    buffer_load_dwordx2 v[196:197], v203, s[4:7], s18 offen offset:896
    v_mfma_f32_16x16x32_bf16 a[52:55], a[220:223], v[232:235], a[52:55]
    v_cvt_pk_bf16_f32 v211, v250, v211
    v_cvt_pk_bf16_f32 v209, v252, v249
    v_mfma_f32_16x16x32_bf16 a[52:55], a[208:211], v[228:231], a[52:55]
    v_lshrrev_b32 v252, 15, v255
    v_mfma_f32_16x16x32_bf16 a[52:55], a[196:199], v[236:239], a[52:55]
    ds_write_b64 v252, v[206:207] offset:768
    v_mfma_f32_16x16x32_bf16 a[56:59], a[200:203], v[236:239], a[56:59]
    ds_read_b128 v[236:239], v253 offset:9632
    v_lshrrev_b32 v206, 15, v255
    v_mfma_f32_16x16x32_bf16 a[56:59], a[212:215], v[228:231], a[56:59]
    buffer_load_dwordx2 v[198:199], v203, s[4:7], s19 offen offset:896
    v_mfma_f32_16x16x32_bf16 a[56:59], a[224:227], v[232:235], a[56:59]
    ds_write_b64 v206, v[212:213] offset:2848
    v_mfma_f32_16x16x32_bf16 a[60:63], a[192:195], v[228:231], a[60:63]
    v_mfma_f32_16x16x32_bf16 a[60:63], a[204:207], v[232:235], a[60:63]
    s_waitcnt lgkmcnt(1)
    s_waitcnt vmcnt(13)
    v_lshlrev_b32 v248, 16, v218
    v_mfma_f32_16x16x32_bf16 a[60:63], a[216:219], v[236:239], a[60:63]
    buffer_load_dwordx2 v[200:201], v203, s[4:7], s20 offen offset:896
    v_mfma_f32_16x16x32_bf16 a[64:67], a[220:223], v[236:239], a[64:67]
    ds_write_b64 v206, v[210:211] offset:4928
    v_mfma_f32_16x16x32_bf16 a[64:67], a[208:211], v[232:235], a[64:67]
    v_lshlrev_b32 v249, 16, v220
    v_lshlrev_b32 v250, 16, v222
    v_mfma_f32_16x16x32_bf16 a[64:67], a[196:199], v[228:231], a[64:67]
    ds_write_b64 v206, v[204:205] offset:17408
    v_mfma_f32_16x16x32_bf16 a[68:71], a[200:203], v[228:231], a[68:71]
    ds_read_b128 v[228:231], v253 offset:9376
    v_lshlrev_b32 v251, 16, v224
    v_mfma_f32_16x16x32_bf16 a[68:71], a[212:215], v[232:235], a[68:71]
    buffer_load_dwordx2 v[202:203], v203, s[4:7], s21 offen offset:896
    v_mfma_f32_16x16x32_bf16 a[68:71], a[224:227], v[236:239], a[68:71]
    ds_write_b64 v206, v[214:215] offset:25728
    v_mfma_f32_16x16x32_bf16 a[72:75], a[192:195], v[232:235], a[72:75]
    v_and_b32 v218, s22, v218
    v_and_b32 v220, s22, v220
    v_mfma_f32_16x16x32_bf16 a[72:75], a[204:207], v[236:239], a[72:75]
    s_waitcnt lgkmcnt(1)
    v_and_b32 v222, s22, v222
    v_and_b32 v224, s22, v224
    v_mfma_f32_16x16x32_bf16 a[72:75], a[216:219], v[228:231], a[72:75]
    ds_write_b64 v206, v[208:209] offset:7008
    v_mfma_f32_16x16x32_bf16 a[76:79], a[220:223], v[228:231], a[76:79]
    v_lshlrev_b32 v252, 16, v216
    v_and_b32 v216, s22, v216
    v_mfma_f32_16x16x32_bf16 a[76:79], a[208:211], v[236:239], a[76:79]
    v_fmac_f32 v252, s25, v251
    v_fmac_f32 v216, s25, v224
    v_mfma_f32_16x16x32_bf16 a[76:79], a[196:199], v[232:235], a[76:79]
    v_fmac_f32 v252, s28, v249
    v_fmac_f32 v216, s28, v220
    v_mfma_f32_16x16x32_bf16 a[80:83], a[200:203], v[232:235], a[80:83]
    ds_read_b128 v[232:235], v253 offset:9104
    v_cvt_pk_bf16_f32 v216, v252, v216
    v_mfma_f32_16x16x32_bf16 a[80:83], a[212:215], v[236:239], a[80:83]
    v_lshlrev_b32 v252, 16, v226
    v_and_b32 v226, s22, v226
    v_mfma_f32_16x16x32_bf16 a[80:83], a[224:227], v[228:231], a[80:83]
    s_mov_b32 s42, 221184
    v_fmac_f32 v252, s29, v248
    v_fmac_f32 v226, s29, v218
    v_mfma_f32_16x16x32_bf16 a[84:87], a[192:195], v[236:239], a[84:87]
    v_fmac_f32 v252, s23, v250
    v_fmac_f32 v226, s23, v222
    v_mfma_f32_16x16x32_bf16 a[88:91], a[196:199], v[236:239], a[88:91]
    v_cvt_pk_bf16_f32 v226, v252, v226
    v_fma_f32 v252, v249, s24, v251
    v_mfma_f32_16x16x32_bf16 a[92:95], a[200:203], v[236:239], a[92:95]
    ds_read_b128 v[236:239], v253 offset:11440
    v_fmac_f32 v251, -4.0, v249
    v_mfma_f32_16x16x32_bf16 a[92:95], a[212:215], v[228:231], a[92:95]
    buffer_load_dwordx4 a[192:195], v254, s[8:11], s42 offen offset:0 sc1
    v_mfma_f32_16x16x32_bf16 a[88:91], a[208:211], v[228:231], a[88:91]
    s_waitcnt lgkmcnt(1)
    v_fma_f32 v249, v248, s24, v250
    v_fmac_f32 v250, -4.0, v248
    v_mfma_f32_16x16x32_bf16 a[84:87], a[204:207], v[228:231], a[84:87]
    ds_read_b128 v[228:231], v253 offset:11168
    v_fma_f32 v248, v250, s26, v251
    v_mfma_f32_16x16x32_bf16 a[84:87], a[216:219], v[232:235], a[84:87]
    buffer_load_dwordx4 a[196:199], v254, s[8:11], s42 offen offset:1024 sc1
    v_mfma_f32_16x16x32_bf16 a[88:91], a[220:223], v[232:235], a[88:91]
    s_waitcnt vmcnt(14) lgkmcnt(1)
    v_fmac_f32 v251, s27, v250
    v_fma_f32 v250, v249, 2.0, v252
    v_mfma_f32_16x16x32_bf16 a[92:95], a[224:227], v[232:235], a[92:95]
    ds_read_b128 v[232:235], v253 offset:10912
    v_fmac_f32 v252, -2.0, v249
    v_fma_f32 v249, v220, s24, v224
sub5:
    v_mfma_f32_16x16x32_bf16 a[96:99], a[228:231], v[236:239], a[96:99]
    buffer_load_dwordx4 a[200:203], v254, s[8:11], s42 offen offset:2048 sc1
    v_mfma_f32_16x16x32_bf16 a[100:103], a[232:235], v[236:239], a[100:103]
    s_mov_b32 s42, 224256
    v_fmac_f32 v224, -4.0, v220
    v_fma_f32 v220, v218, s24, v222
    v_mfma_f32_16x16x32_bf16 a[104:107], a[236:239], v[236:239], a[104:107]
    ds_read_b128 v[236:239], v253 offset:10656
    s_waitcnt vmcnt(12)
    s_waitcnt lgkmcnt(2)
    v_mfma_f32_16x16x32_bf16 a[104:107], a[248:251], v[228:231], a[104:107]
    v_fmac_f32 v222, -4.0, v218
    v_fma_f32 v218, v222, s26, v224
    v_mfma_f32_16x16x32_bf16 a[100:103], a[244:247], v[228:231], a[100:103]
    buffer_load_dwordx4 a[204:207], v254, s[8:11], s42 offen offset:0 sc1
    v_mfma_f32_16x16x32_bf16 a[96:99], a[240:243], v[228:231], a[96:99]
    s_waitcnt vmcnt(10) lgkmcnt(1)
    v_fmac_f32 v224, s27, v222
    v_fma_f32 v222, v220, 2.0, v249
    v_mfma_f32_16x16x32_bf16 a[96:99], a[252:255], v[232:235], a[96:99]
    v_fmac_f32 v249, -2.0, v220
    v_cvt_pk_bf16_f32 v218, v248, v218
    v_mfma_f32_16x16x32_bf16 a[100:103], v[240:243], v[232:235], a[100:103]
    v_cvt_pk_bf16_f32 v224, v251, v224
    v_cvt_pk_bf16_f32 v222, v250, v222
    v_mfma_f32_16x16x32_bf16 a[104:107], v[244:247], v[232:235], a[104:107]
    buffer_load_dwordx4 a[208:211], v254, s[8:11], s42 offen offset:1024 sc1
    v_mfma_f32_16x16x32_bf16 a[108:111], a[228:231], v[228:231], a[108:111]
    v_cvt_pk_bf16_f32 v220, v252, v249
    v_lshlrev_b32 v248, 16, v219
    v_mfma_f32_16x16x32_bf16 a[108:111], a[240:243], v[232:235], a[108:111]
    s_waitcnt lgkmcnt(0)
    v_lshlrev_b32 v249, 16, v221
    v_lshlrev_b32 v250, 16, v223
    v_mfma_f32_16x16x32_bf16 a[108:111], a[252:255], v[236:239], a[108:111]
    v_lshlrev_b32 v251, 16, v225
    v_and_b32 v219, s22, v219
    v_mfma_f32_16x16x32_bf16 a[112:115], v[240:243], v[236:239], a[112:115]
    buffer_load_dwordx4 a[212:215], v254, s[8:11], s42 offen offset:2048 sc1
    v_mfma_f32_16x16x32_bf16 a[112:115], a[244:247], v[232:235], a[112:115]
    s_mov_b32 s42, 227328
    v_and_b32 v221, s22, v221
    v_and_b32 v223, s22, v223
    v_mfma_f32_16x16x32_bf16 a[112:115], a[232:235], v[228:231], a[112:115]
    v_and_b32 v225, s22, v225
    v_lshlrev_b32 v252, 16, v217
    v_mfma_f32_16x16x32_bf16 a[116:119], a[236:239], v[228:231], a[116:119]
    ds_read_b128 v[228:231], v253 offset:10400
    v_and_b32 v217, s22, v217
    v_mfma_f32_16x16x32_bf16 a[116:119], a[248:251], v[232:235], a[116:119]
    buffer_load_dwordx4 a[216:219], v254, s[8:11], s42 offen offset:0 sc1
    v_mfma_f32_16x16x32_bf16 a[116:119], v[244:247], v[236:239], a[116:119]
    v_fmac_f32 v252, s25, v251
    v_fmac_f32 v217, s25, v225
    v_mfma_f32_16x16x32_bf16 a[120:123], a[228:231], v[232:235], a[120:123]
    v_fmac_f32 v252, s28, v249
    v_fmac_f32 v217, s28, v221
    v_mfma_f32_16x16x32_bf16 a[120:123], a[240:243], v[236:239], a[120:123]
    s_waitcnt lgkmcnt(0)
    v_cvt_pk_bf16_f32 v217, v252, v217
    v_lshlrev_b32 v252, 16, v227
    v_mfma_f32_16x16x32_bf16 a[120:123], a[252:255], v[228:231], a[120:123]
    v_and_b32 v227, s22, v227
    v_fmac_f32 v252, s29, v248
    v_mfma_f32_16x16x32_bf16 a[124:127], v[240:243], v[228:231], a[124:127]
    buffer_load_dwordx4 a[220:223], v254, s[8:11], s42 offen offset:1024 sc1
    v_mfma_f32_16x16x32_bf16 a[124:127], a[244:247], v[236:239], a[124:127]
    v_fmac_f32 v227, s29, v219
    v_fmac_f32 v252, s23, v250
    v_mfma_f32_16x16x32_bf16 a[124:127], a[232:235], v[232:235], a[124:127]
    v_fmac_f32 v227, s23, v223
    v_cvt_pk_bf16_f32 v227, v252, v227
    v_mfma_f32_16x16x32_bf16 a[128:131], a[236:239], v[232:235], a[128:131]
    ds_read_b128 v[232:235], v253 offset:12224
    v_fma_f32 v252, v249, s24, v251
    v_mfma_f32_16x16x32_bf16 a[128:131], a[248:251], v[236:239], a[128:131]
    buffer_load_dwordx4 a[224:227], v254, s[8:11], s42 offen offset:2048 sc1
    v_mfma_f32_16x16x32_bf16 a[128:131], v[244:247], v[228:231], a[128:131]
    v_fmac_f32 v251, -4.0, v249
    v_fma_f32 v249, v248, s24, v250
    v_mfma_f32_16x16x32_bf16 a[132:135], a[228:231], v[236:239], a[132:135]
    v_and_b32 v215, 0x7fff, v255
    v_fmac_f32 v250, -4.0, v248
    v_mfma_f32_16x16x32_bf16 a[132:135], a[240:243], v[228:231], a[132:135]
    s_waitcnt lgkmcnt(0)
    v_fma_f32 v248, v250, s26, v251
    v_fmac_f32 v251, s27, v250
    v_mfma_f32_16x16x32_bf16 a[132:135], a[252:255], v[232:235], a[132:135]
    buffer_load_dwordx2 v[204:205], v215, s[4:7], s16 offen offset:1280
    v_mfma_f32_16x16x32_bf16 a[136:139], v[240:243], v[232:235], a[136:139]
    v_fma_f32 v250, v249, 2.0, v252
    v_fmac_f32 v252, -2.0, v249
    v_mfma_f32_16x16x32_bf16 a[136:139], a[244:247], v[228:231], a[136:139]
    v_fma_f32 v249, v221, s24, v225
    v_fmac_f32 v225, -4.0, v221
    v_mfma_f32_16x16x32_bf16 a[136:139], a[232:235], v[236:239], a[136:139]
    v_fma_f32 v221, v219, s24, v223
    v_fmac_f32 v223, -4.0, v219
    v_mfma_f32_16x16x32_bf16 a[140:143], a[236:239], v[236:239], a[140:143]
    ds_read_b128 v[236:239], v253 offset:11968
    v_fma_f32 v219, v223, s26, v225
    v_mfma_f32_16x16x32_bf16 a[140:143], a[248:251], v[228:231], a[140:143]
    buffer_load_dwordx2 v[206:207], v215, s[4:7], s17 offen offset:1280
    v_mfma_f32_16x16x32_bf16 a[140:143], v[244:247], v[232:235], a[140:143]
    v_fmac_f32 v225, s27, v223
    v_fma_f32 v223, v221, 2.0, v249
    v_mfma_f32_16x16x32_bf16 a[144:147], a[228:231], v[228:231], a[144:147]
    v_fmac_f32 v249, -2.0, v221
    v_cvt_pk_bf16_f32 v219, v248, v219
    v_mfma_f32_16x16x32_bf16 a[144:147], a[240:243], v[232:235], a[144:147]
    s_waitcnt lgkmcnt(0)
    v_cvt_pk_bf16_f32 v225, v251, v225
    v_cvt_pk_bf16_f32 v223, v250, v223
    v_mfma_f32_16x16x32_bf16 a[144:147], a[252:255], v[236:239], a[144:147]
    buffer_load_dwordx2 v[208:209], v215, s[4:7], s18 offen offset:1280
    v_mfma_f32_16x16x32_bf16 a[148:151], v[240:243], v[236:239], a[148:151]
    v_cvt_pk_bf16_f32 v221, v252, v249
    v_lshrrev_b32 v252, 15, v255
    v_mfma_f32_16x16x32_bf16 a[148:151], a[244:247], v[232:235], a[148:151]
    ds_write_b64 v252, v[218:219] offset:512
    v_mfma_f32_16x16x32_bf16 a[148:151], a[232:235], v[228:231], a[148:151]
    v_lshrrev_b32 v218, 15, v255
    v_mfma_f32_16x16x32_bf16 a[152:155], a[236:239], v[228:231], a[152:155]
    ds_read_b128 v[228:231], v253 offset:11712
    v_mfma_f32_16x16x32_bf16 a[152:155], a[248:251], v[232:235], a[152:155]
    buffer_load_dwordx2 v[210:211], v215, s[4:7], s19 offen offset:1280
    v_mfma_f32_16x16x32_bf16 a[152:155], v[244:247], v[236:239], a[152:155]
    ds_write_b64 v218, v[224:225] offset:2592
    v_mfma_f32_16x16x32_bf16 a[156:159], a[228:231], v[232:235], a[156:159]
    v_mfma_f32_16x16x32_bf16 a[156:159], a[240:243], v[236:239], a[156:159]
    s_waitcnt lgkmcnt(1)
    s_waitcnt vmcnt(13)
    v_lshlrev_b32 v248, 16, v194
    v_mfma_f32_16x16x32_bf16 a[156:159], a[252:255], v[228:231], a[156:159]
    buffer_load_dwordx2 v[212:213], v215, s[4:7], s20 offen offset:1280
    v_mfma_f32_16x16x32_bf16 a[160:163], v[240:243], v[228:231], a[160:163]
    ds_write_b64 v218, v[222:223] offset:4672
    v_mfma_f32_16x16x32_bf16 a[160:163], a[244:247], v[236:239], a[160:163]
    v_lshlrev_b32 v249, 16, v196
    v_lshlrev_b32 v250, 16, v198
    v_mfma_f32_16x16x32_bf16 a[160:163], a[232:235], v[232:235], a[160:163]
    ds_write_b64 v218, v[216:217] offset:17152
    v_mfma_f32_16x16x32_bf16 a[164:167], a[236:239], v[232:235], a[164:167]
    ds_read_b128 v[232:235], v253 offset:11456
    v_lshlrev_b32 v251, 16, v200
    v_mfma_f32_16x16x32_bf16 a[164:167], a[248:251], v[236:239], a[164:167]
    buffer_load_dwordx2 v[214:215], v215, s[4:7], s21 offen offset:1280
    v_mfma_f32_16x16x32_bf16 a[164:167], v[244:247], v[228:231], a[164:167]
    ds_write_b64 v218, v[226:227] offset:25472
    v_mfma_f32_16x16x32_bf16 a[168:171], a[228:231], v[236:239], a[168:171]
    v_and_b32 v194, s22, v194
    v_and_b32 v196, s22, v196
    v_mfma_f32_16x16x32_bf16 a[168:171], a[240:243], v[228:231], a[168:171]
    s_waitcnt lgkmcnt(1)
    v_and_b32 v198, s22, v198
    v_and_b32 v200, s22, v200
    v_mfma_f32_16x16x32_bf16 a[168:171], a[252:255], v[232:235], a[168:171]
pad2:
    s_cbranch_vccnz pad6
    ds_write_b64 v218, v[220:221] offset:6752
    v_mfma_f32_16x16x32_bf16 a[172:175], v[240:243], v[232:235], a[172:175]
    ds_read_b128 v[216:219], v253 offset:39904
    s_mov_b32 s45, 405865480
    v_mfma_f32_16x16x32_bf16 a[172:175], a[244:247], v[228:231], a[172:175]
    v_bfe_u32 v220, v254, 5, 3
    v_mul_u32_u24 v221, 5, v220
    v_mfma_f32_16x16x32_bf16 a[172:175], a[232:235], v[236:239], a[172:175]
    v_bfe_u32 v221, s45, v221, 5
    v_mul_u32_u24 v221, 65, v221
    v_mfma_f32_16x16x32_bf16 a[176:179], a[236:239], v[236:239], a[176:179]
    ds_read_b128 v[236:239], v253 offset:11184
    v_sub_u32 v221, v221, v220
    v_mfma_f32_16x16x32_bf16 a[176:179], a[248:251], v[228:231], a[176:179]
    v_lshl_add_u32 v220, v221, 5, v253
    s_waitcnt lgkmcnt(1)
    v_mfma_f32_16x16x32_bf16 a[176:179], v[244:247], v[232:235], a[176:179]
    s_mov_b32 s42, 258048
    v_lshlrev_b32 v252, 16, v192
    v_and_b32 v192, s22, v192
    v_mfma_f32_16x16x32_bf16 a[180:183], a[228:231], v[228:231], a[180:183]
    s_mov_b64 exec, s[46:47]
    ds_write_b128 v220, v[216:219] offset:1024
    s_mov_b64 exec, -1
    v_mfma_f32_16x16x32_bf16 a[184:187], a[232:235], v[228:231], a[184:187]
    v_fmac_f32 v252, s25, v251
    v_fmac_f32 v192, s25, v200
    v_mfma_f32_16x16x32_bf16 a[188:191], a[236:239], v[228:231], a[188:191]
    ds_read_b128 v[228:231], v253 offset:13520
    v_fmac_f32 v252, s28, v249
    v_mfma_f32_16x16x32_bf16 a[188:191], a[248:251], v[232:235], a[188:191]
    buffer_load_dwordx4 a[228:231], v254, s[8:11], s42 offen offset:0 sc1
    v_mfma_f32_16x16x32_bf16 a[184:187], a[244:247], v[232:235], a[184:187]
    s_waitcnt lgkmcnt(2)
    v_fmac_f32 v192, s28, v196
    v_cvt_pk_bf16_f32 v192, v252, v192
    v_mfma_f32_16x16x32_bf16 a[180:183], a[240:243], v[232:235], a[180:183]
    ds_read_b128 v[232:235], v253 offset:13248
    v_lshlrev_b32 v252, 16, v202
    v_mfma_f32_16x16x32_bf16 a[180:183], a[252:255], v[236:239], a[180:183]
    buffer_load_dwordx4 a[232:235], v254, s[8:11], s42 offen offset:1024 sc1
    v_mfma_f32_16x16x32_bf16 a[184:187], v[240:243], v[236:239], a[184:187]
    s_waitcnt vmcnt(14) lgkmcnt(1)
    v_and_b32 v202, s22, v202
    v_fmac_f32 v252, s29, v248
    v_mfma_f32_16x16x32_bf16 a[188:191], v[244:247], v[236:239], a[188:191]
    ds_read_b128 v[236:239], v253 offset:12992
    v_fmac_f32 v202, s29, v194
sub6:
    v_mfma_f32_16x16x32_bf16 v[0:3], a[192:195], v[228:231], v[0:3]
    buffer_load_dwordx4 a[236:239], v254, s[8:11], s42 offen offset:2048 sc1
    v_mfma_f32_16x16x32_bf16 v[4:7], a[196:199], v[228:231], v[4:7]
    s_mov_b32 s42, 261120
    v_fmac_f32 v252, s23, v250
    v_fmac_f32 v202, s23, v198
    v_mfma_f32_16x16x32_bf16 v[8:11], a[200:203], v[228:231], v[8:11]
    ds_read_b128 v[228:231], v253 offset:12736
    s_waitcnt vmcnt(12)
    s_waitcnt lgkmcnt(2)
    v_mfma_f32_16x16x32_bf16 v[8:11], a[212:215], v[232:235], v[8:11]
    v_cvt_pk_bf16_f32 v202, v252, v202
    v_fma_f32 v252, v249, s24, v251
    v_mfma_f32_16x16x32_bf16 v[4:7], a[208:211], v[232:235], v[4:7]
    buffer_load_dwordx4 a[240:243], v254, s[8:11], s42 offen offset:0 sc1
    v_mfma_f32_16x16x32_bf16 v[0:3], a[204:207], v[232:235], v[0:3]
    s_waitcnt vmcnt(10) lgkmcnt(1)
    v_fmac_f32 v251, -4.0, v249
    v_fma_f32 v249, v248, s24, v250
    v_mfma_f32_16x16x32_bf16 v[0:3], a[216:219], v[236:239], v[0:3]
    v_fmac_f32 v250, -4.0, v248
    v_fma_f32 v248, v250, s26, v251
    v_mfma_f32_16x16x32_bf16 v[4:7], a[220:223], v[236:239], v[4:7]
    v_fmac_f32 v251, s27, v250
    v_fma_f32 v250, v249, 2.0, v252
    v_fmac_f32 v252, -2.0, v249
    v_mfma_f32_16x16x32_bf16 v[8:11], a[224:227], v[236:239], v[8:11]
    buffer_load_dwordx4 a[244:247], v254, s[8:11], s42 offen offset:1024 sc1
    v_mfma_f32_16x16x32_bf16 v[12:15], a[192:195], v[232:235], v[12:15]
    v_fma_f32 v249, v196, s24, v200
    v_fmac_f32 v200, -4.0, v196
    v_mfma_f32_16x16x32_bf16 v[12:15], a[204:207], v[236:239], v[12:15]
    s_waitcnt lgkmcnt(0)
    v_fma_f32 v196, v194, s24, v198
    v_fmac_f32 v198, -4.0, v194
    v_mfma_f32_16x16x32_bf16 v[12:15], a[216:219], v[228:231], v[12:15]
    v_fma_f32 v194, v198, s26, v200
    v_fmac_f32 v200, s27, v198
    v_mfma_f32_16x16x32_bf16 v[16:19], a[220:223], v[228:231], v[16:19]
    buffer_load_dwordx4 a[248:251], v254, s[8:11], s42 offen offset:2048 sc1
    v_mfma_f32_16x16x32_bf16 v[16:19], a[208:211], v[236:239], v[16:19]
    s_mov_b32 s42, 264192
    v_fma_f32 v198, v196, 2.0, v249
    v_fmac_f32 v249, -2.0, v196
    v_mfma_f32_16x16x32_bf16 v[16:19], a[196:199], v[232:235], v[16:19]
    v_cvt_pk_bf16_f32 v194, v248, v194
    v_cvt_pk_bf16_f32 v200, v251, v200
    v_mfma_f32_16x16x32_bf16 v[20:23], a[200:203], v[232:235], v[20:23]
    ds_read_b128 v[232:235], v253 offset:12480
    v_cvt_pk_bf16_f32 v198, v250, v198
    v_mfma_f32_16x16x32_bf16 v[20:23], a[212:215], v[236:239], v[20:23]
    buffer_load_dwordx4 a[252:255], v254, s[8:11], s42 offen offset:0 sc1
    v_mfma_f32_16x16x32_bf16 v[20:23], a[224:227], v[228:231], v[20:23]
    v_cvt_pk_bf16_f32 v196, v252, v249
    v_lshlrev_b32 v248, 16, v195
    v_mfma_f32_16x16x32_bf16 v[24:27], a[192:195], v[236:239], v[24:27]
    v_lshlrev_b32 v249, 16, v197
    v_lshlrev_b32 v250, 16, v199
    v_mfma_f32_16x16x32_bf16 v[24:27], a[204:207], v[228:231], v[24:27]
    s_waitcnt lgkmcnt(0)
    v_lshlrev_b32 v251, 16, v201
    v_and_b32 v195, s22, v195
    v_mfma_f32_16x16x32_bf16 v[24:27], a[216:219], v[232:235], v[24:27]
    v_and_b32 v197, s22, v197
    v_and_b32 v199, s22, v199
    v_mfma_f32_16x16x32_bf16 v[28:31], a[220:223], v[232:235], v[28:31]
    buffer_load_dwordx4 v[240:243], v254, s[8:11], s42 offen offset:1024 sc1
    v_mfma_f32_16x16x32_bf16 v[28:31], a[208:211], v[228:231], v[28:31]
    v_and_b32 v201, s22, v201
    v_lshlrev_b32 v252, 16, v193
    v_mfma_f32_16x16x32_bf16 v[28:31], a[196:199], v[236:239], v[28:31]
    v_and_b32 v193, s22, v193
    v_fmac_f32 v252, s25, v251
    v_mfma_f32_16x16x32_bf16 v[32:35], a[200:203], v[236:239], v[32:35]
    ds_read_b128 v[236:239], v253 offset:14304
    v_fmac_f32 v193, s25, v201
    v_mfma_f32_16x16x32_bf16 v[32:35], a[212:215], v[228:231], v[32:35]
    buffer_load_dwordx4 v[244:247], v254, s[8:11], s42 offen offset:2048 sc1
    v_mfma_f32_16x16x32_bf16 v[32:35], a[224:227], v[232:235], v[32:35]
    v_fmac_f32 v252, s28, v249
    v_fmac_f32 v193, s28, v197
    v_mfma_f32_16x16x32_bf16 v[36:39], a[192:195], v[228:231], v[36:39]
    v_and_b32 v227, 0x7fff, v255
    v_cvt_pk_bf16_f32 v193, v252, v193
    v_mfma_f32_16x16x32_bf16 v[36:39], a[204:207], v[232:235], v[36:39]
    s_waitcnt lgkmcnt(0)
    v_lshlrev_b32 v252, 16, v203
    v_and_b32 v203, s22, v203
    v_mfma_f32_16x16x32_bf16 v[36:39], a[216:219], v[236:239], v[36:39]
    buffer_load_dwordx2 v[216:217], v227, s[4:7], s16 offen offset:192
    v_mfma_f32_16x16x32_bf16 v[40:43], a[220:223], v[236:239], v[40:43]
    v_fmac_f32 v252, s29, v248
    v_fmac_f32 v203, s29, v195
    v_mfma_f32_16x16x32_bf16 v[40:43], a[208:211], v[232:235], v[40:43]
    v_fmac_f32 v252, s23, v250
    v_fmac_f32 v203, s23, v199
    v_mfma_f32_16x16x32_bf16 v[40:43], a[196:199], v[228:231], v[40:43]
    v_cvt_pk_bf16_f32 v203, v252, v203
    v_fma_f32 v252, v249, s24, v251
    v_mfma_f32_16x16x32_bf16 v[44:47], a[200:203], v[228:231], v[44:47]
    ds_read_b128 v[228:231], v253 offset:14048
    v_fmac_f32 v251, -4.0, v249
    v_mfma_f32_16x16x32_bf16 v[44:47], a[212:215], v[232:235], v[44:47]
    buffer_load_dwordx2 v[218:219], v227, s[4:7], s17 offen offset:192
    v_mfma_f32_16x16x32_bf16 v[44:47], a[224:227], v[236:239], v[44:47]
    v_fma_f32 v249, v248, s24, v250
    v_fmac_f32 v250, -4.0, v248
    v_mfma_f32_16x16x32_bf16 v[48:51], a[192:195], v[232:235], v[48:51]
    v_fma_f32 v248, v250, s26, v251
    v_fmac_f32 v251, s27, v250
    v_mfma_f32_16x16x32_bf16 v[48:51], a[204:207], v[236:239], v[48:51]
    s_waitcnt lgkmcnt(0)
    v_fma_f32 v250, v249, 2.0, v252
    v_fmac_f32 v252, -2.0, v249
    v_mfma_f32_16x16x32_bf16 v[48:51], a[216:219], v[228:231], v[48:51]
    buffer_load_dwordx2 v[220:221], v227, s[4:7], s18 offen offset:192
    v_mfma_f32_16x16x32_bf16 v[52:55], a[220:223], v[228:231], v[52:55]
    v_fma_f32 v249, v197, s24, v201
    v_fmac_f32 v201, -4.0, v197
    v_mfma_f32_16x16x32_bf16 v[52:55], a[208:211], v[236:239], v[52:55]
    v_fma_f32 v197, v195, s24, v199
    v_fmac_f32 v199, -4.0, v195
    v_mfma_f32_16x16x32_bf16 v[52:55], a[196:199], v[232:235], v[52:55]
    v_fma_f32 v195, v199, s26, v201
    v_fmac_f32 v201, s27, v199
    v_mfma_f32_16x16x32_bf16 v[56:59], a[200:203], v[232:235], v[56:59]
    ds_read_b128 v[232:235], v253 offset:13792
    v_fma_f32 v199, v197, 2.0, v249
    v_mfma_f32_16x16x32_bf16 v[56:59], a[212:215], v[236:239], v[56:59]
    buffer_load_dwordx2 v[222:223], v227, s[4:7], s19 offen offset:192
    v_mfma_f32_16x16x32_bf16 v[56:59], a[224:227], v[228:231], v[56:59]
    v_fmac_f32 v249, -2.0, v197
    v_cvt_pk_bf16_f32 v195, v248, v195
    v_mfma_f32_16x16x32_bf16 v[60:63], a[192:195], v[236:239], v[60:63]
    v_cvt_pk_bf16_f32 v201, v251, v201
    v_cvt_pk_bf16_f32 v199, v250, v199
    v_mfma_f32_16x16x32_bf16 v[60:63], a[204:207], v[228:231], v[60:63]
    s_waitcnt lgkmcnt(0)
    v_cvt_pk_bf16_f32 v197, v252, v249
    v_lshrrev_b32 v252, 15, v255
    v_mfma_f32_16x16x32_bf16 v[60:63], a[216:219], v[232:235], v[60:63]
    buffer_load_dwordx2 v[224:225], v227, s[4:7], s20 offen offset:192
    v_mfma_f32_16x16x32_bf16 v[64:67], a[220:223], v[232:235], v[64:67]
    ds_write_b64 v252, v[194:195] offset:256
    v_mfma_f32_16x16x32_bf16 v[64:67], a[208:211], v[228:231], v[64:67]
    s_waitcnt vmcnt(14)
    v_lshrrev_b32 v194, 15, v255
    v_lshlrev_b32 v248, 16, v206
    v_mfma_f32_16x16x32_bf16 v[64:67], a[196:199], v[236:239], v[64:67]
    ds_write_b64 v194, v[200:201] offset:2336
    v_mfma_f32_16x16x32_bf16 v[68:71], a[200:203], v[236:239], v[68:71]
    ds_read_b128 v[236:239], v253 offset:13536
    v_lshlrev_b32 v249, 16, v208
    v_mfma_f32_16x16x32_bf16 v[68:71], a[212:215], v[228:231], v[68:71]
    buffer_load_dwordx2 v[226:227], v227, s[4:7], s21 offen offset:192
    v_mfma_f32_16x16x32_bf16 v[68:71], a[224:227], v[232:235], v[68:71]
    ds_write_b64 v194, v[198:199] offset:4416
    v_mfma_f32_16x16x32_bf16 v[72:75], a[192:195], v[228:231], v[72:75]
    v_lshlrev_b32 v250, 16, v210
    v_lshlrev_b32 v251, 16, v212
    v_mfma_f32_16x16x32_bf16 v[72:75], a[204:207], v[232:235], v[72:75]
    s_waitcnt lgkmcnt(1)
    v_and_b32 v206, s22, v206
    v_and_b32 v208, s22, v208
    v_mfma_f32_16x16x32_bf16 v[72:75], a[216:219], v[236:239], v[72:75]
    ds_write_b64 v194, v[192:193] offset:16896
    v_mfma_f32_16x16x32_bf16 v[76:79], a[220:223], v[236:239], v[76:79]
    v_and_b32 v210, s22, v210
    v_and_b32 v212, s22, v212
    v_mfma_f32_16x16x32_bf16 v[76:79], a[208:211], v[232:235], v[76:79]
    ds_write_b64 v194, v[202:203] offset:25216
    v_mfma_f32_16x16x32_bf16 v[76:79], a[196:199], v[228:231], v[76:79]
    v_lshlrev_b32 v252, 16, v204
    v_and_b32 v204, s22, v204
    v_mfma_f32_16x16x32_bf16 v[80:83], a[200:203], v[228:231], v[80:83]
    ds_read_b128 v[228:231], v253 offset:13264
    v_fmac_f32 v252, s25, v251
    v_mfma_f32_16x16x32_bf16 v[80:83], a[212:215], v[232:235], v[80:83]
    ds_write_b64 v194, v[196:197] offset:6496
    v_mfma_f32_16x16x32_bf16 v[80:83], a[224:227], v[236:239], v[80:83]
    s_mov_b32 s42, 294912
    v_fmac_f32 v204, s25, v212
    v_fmac_f32 v252, s28, v249
    v_mfma_f32_16x16x32_bf16 v[84:87], a[192:195], v[232:235], v[84:87]
    v_fmac_f32 v204, s28, v208
    v_cvt_pk_bf16_f32 v204, v252, v204
    v_mfma_f32_16x16x32_bf16 v[88:91], a[196:199], v[232:235], v[88:91]
    v_lshlrev_b32 v252, 16, v214
    v_and_b32 v214, s22, v214
    v_mfma_f32_16x16x32_bf16 v[92:95], a[200:203], v[232:235], v[92:95]
    ds_read_b128 v[232:235], v253 offset:32240
    v_fmac_f32 v252, s29, v248
    v_mfma_f32_16x16x32_bf16 v[92:95], a[212:215], v[236:239], v[92:95]
    buffer_load_dwordx4 a[192:195], v254, s[8:11], s42 offen offset:0 sc1
    v_mfma_f32_16x16x32_bf16 v[88:91], a[208:211], v[236:239], v[88:91]
    s_waitcnt lgkmcnt(2)
    v_fmac_f32 v214, s29, v206
    v_fmac_f32 v252, s23, v250
    v_mfma_f32_16x16x32_bf16 v[84:87], a[204:207], v[236:239], v[84:87]
    ds_read_b128 v[236:239], v253 offset:31968
    v_fmac_f32 v214, s23, v210
    v_mfma_f32_16x16x32_bf16 v[84:87], a[216:219], v[228:231], v[84:87]
    buffer_load_dwordx4 a[196:199], v254, s[8:11], s42 offen offset:1024 sc1
    v_mfma_f32_16x16x32_bf16 v[88:91], a[220:223], v[228:231], v[88:91]
    s_waitcnt vmcnt(14) lgkmcnt(1)
    v_cvt_pk_bf16_f32 v214, v252, v214
    v_fma_f32 v252, v249, s24, v251
    v_mfma_f32_16x16x32_bf16 v[92:95], a[224:227], v[228:231], v[92:95]
    ds_read_b128 v[228:231], v253 offset:31712
    v_fmac_f32 v251, -4.0, v249
sub7:
    v_mfma_f32_16x16x32_bf16 v[96:99], a[228:231], v[232:235], v[96:99]
    buffer_load_dwordx4 a[200:203], v254, s[8:11], s42 offen offset:2048 sc1
    v_mfma_f32_16x16x32_bf16 v[100:103], a[232:235], v[232:235], v[100:103]
    s_mov_b32 s42, 297984
    v_fma_f32 v249, v248, s24, v250
    v_fmac_f32 v250, -4.0, v248
    v_mfma_f32_16x16x32_bf16 v[104:107], a[236:239], v[232:235], v[104:107]
    ds_read_b128 v[232:235], v253 offset:31456
    s_waitcnt vmcnt(12)
    s_waitcnt lgkmcnt(2)
    v_mfma_f32_16x16x32_bf16 v[104:107], a[248:251], v[236:239], v[104:107]
    v_fma_f32 v248, v250, s26, v251
    v_fmac_f32 v251, s27, v250
    v_mfma_f32_16x16x32_bf16 v[100:103], a[244:247], v[236:239], v[100:103]
    buffer_load_dwordx4 a[204:207], v254, s[8:11], s42 offen offset:0 sc1
    v_mfma_f32_16x16x32_bf16 v[96:99], a[240:243], v[236:239], v[96:99]
    s_waitcnt vmcnt(10) lgkmcnt(1)
    v_fma_f32 v250, v249, 2.0, v252
    v_fmac_f32 v252, -2.0, v249
    v_mfma_f32_16x16x32_bf16 v[96:99], a[252:255], v[228:231], v[96:99]
    v_fma_f32 v249, v208, s24, v212
    v_fmac_f32 v212, -4.0, v208
    v_mfma_f32_16x16x32_bf16 v[100:103], v[240:243], v[228:231], v[100:103]
    v_fma_f32 v208, v206, s24, v210
    v_fmac_f32 v210, -4.0, v206
    v_mfma_f32_16x16x32_bf16 v[104:107], v[244:247], v[228:231], v[104:107]
    buffer_load_dwordx4 a[208:211], v254, s[8:11], s42 offen offset:1024 sc1
    v_mfma_f32_16x16x32_bf16 v[108:111], a[228:231], v[236:239], v[108:111]
    v_fma_f32 v206, v210, s26, v212
    v_fmac_f32 v212, s27, v210
    v_mfma_f32_16x16x32_bf16 v[108:111], a[240:243], v[228:231], v[108:111]
    s_waitcnt lgkmcnt(0)
    v_fma_f32 v210, v208, 2.0, v249
    v_fmac_f32 v249, -2.0, v208
    v_mfma_f32_16x16x32_bf16 v[108:111], a[252:255], v[232:235], v[108:111]
    v_cvt_pk_bf16_f32 v206, v248, v206
    v_cvt_pk_bf16_f32 v212, v251, v212
    v_mfma_f32_16x16x32_bf16 v[112:115], v[240:243], v[232:235], v[112:115]
    buffer_load_dwordx4 a[212:215], v254, s[8:11], s42 offen offset:2048 sc1
    v_mfma_f32_16x16x32_bf16 v[112:115], a[244:247], v[228:231], v[112:115]
    s_mov_b32 s42, 301056
    v_cvt_pk_bf16_f32 v210, v250, v210
    v_cvt_pk_bf16_f32 v208, v252, v249
    v_mfma_f32_16x16x32_bf16 v[112:115], a[232:235], v[236:239], v[112:115]
    v_lshlrev_b32 v248, 16, v207
    v_lshlrev_b32 v249, 16, v209
    v_mfma_f32_16x16x32_bf16 v[116:119], a[236:239], v[236:239], v[116:119]
    ds_read_b128 v[236:239], v253 offset:31200
    v_lshlrev_b32 v250, 16, v211
    v_lshlrev_b32 v251, 16, v213
    v_mfma_f32_16x16x32_bf16 v[116:119], a[248:251], v[228:231], v[116:119]
    buffer_load_dwordx4 a[216:219], v254, s[8:11], s42 offen offset:0 sc1
    v_mfma_f32_16x16x32_bf16 v[116:119], v[244:247], v[232:235], v[116:119]
    v_and_b32 v207, s22, v207
    v_and_b32 v209, s22, v209
    v_mfma_f32_16x16x32_bf16 v[120:123], a[228:231], v[228:231], v[120:123]
    v_and_b32 v211, s22, v211
    v_and_b32 v213, s22, v213
    v_mfma_f32_16x16x32_bf16 v[120:123], a[240:243], v[232:235], v[120:123]
    s_waitcnt lgkmcnt(0)
    v_lshlrev_b32 v252, 16, v205
    v_and_b32 v205, s22, v205
    v_mfma_f32_16x16x32_bf16 v[120:123], a[252:255], v[236:239], v[120:123]
    v_fmac_f32 v252, s25, v251
    v_fmac_f32 v205, s25, v213
    v_mfma_f32_16x16x32_bf16 v[124:127], v[240:243], v[236:239], v[124:127]
    buffer_load_dwordx4 a[220:223], v254, s[8:11], s42 offen offset:1024 sc1
    v_mfma_f32_16x16x32_bf16 v[124:127], a[244:247], v[232:235], v[124:127]
    v_fmac_f32 v252, s28, v249
    v_fmac_f32 v205, s28, v209
    v_mfma_f32_16x16x32_bf16 v[124:127], a[232:235], v[228:231], v[124:127]
    v_cvt_pk_bf16_f32 v205, v252, v205
    v_lshlrev_b32 v252, 16, v215
    v_mfma_f32_16x16x32_bf16 v[128:131], a[236:239], v[228:231], v[128:131]
    ds_read_b128 v[228:231], v253 offset:33024
    v_and_b32 v215, s22, v215
    v_mfma_f32_16x16x32_bf16 v[128:131], a[248:251], v[232:235], v[128:131]
    buffer_load_dwordx4 a[224:227], v254, s[8:11], s42 offen offset:2048 sc1
    v_mfma_f32_16x16x32_bf16 v[128:131], v[244:247], v[236:239], v[128:131]
    v_fmac_f32 v252, s29, v248
    v_fmac_f32 v215, s29, v207
    v_mfma_f32_16x16x32_bf16 v[132:135], a[228:231], v[232:235], v[132:135]
    v_and_b32 v203, 0x7fff, v255
    v_fmac_f32 v252, s23, v250
    v_mfma_f32_16x16x32_bf16 v[132:135], a[240:243], v[236:239], v[132:135]
    s_waitcnt lgkmcnt(0)
    v_fmac_f32 v215, s23, v211
    v_cvt_pk_bf16_f32 v215, v252, v215
    v_mfma_f32_16x16x32_bf16 v[132:135], a[252:255], v[228:231], v[132:135]
    buffer_load_dwordx2 v[192:193], v203, s[4:7], s16 offen offset:576
    v_mfma_f32_16x16x32_bf16 v[136:139], v[240:243], v[228:231], v[136:139]
    v_fma_f32 v252, v249, s24, v251
    v_fmac_f32 v251, -4.0, v249
    v_mfma_f32_16x16x32_bf16 v[136:139], a[244:247], v[236:239], v[136:139]
    v_fma_f32 v249, v248, s24, v250
    v_fmac_f32 v250, -4.0, v248
    v_mfma_f32_16x16x32_bf16 v[136:139], a[232:235], v[232:235], v[136:139]
    v_fma_f32 v248, v250, s26, v251
    v_fmac_f32 v251, s27, v250
    v_mfma_f32_16x16x32_bf16 v[140:143], a[236:239], v[232:235], v[140:143]
    ds_read_b128 v[232:235], v253 offset:32768
    v_fma_f32 v250, v249, 2.0, v252
    v_mfma_f32_16x16x32_bf16 v[140:143], a[248:251], v[236:239], v[140:143]
    buffer_load_dwordx2 v[194:195], v203, s[4:7], s17 offen offset:576
    v_mfma_f32_16x16x32_bf16 v[140:143], v[244:247], v[228:231], v[140:143]
    v_fmac_f32 v252, -2.0, v249
    v_fma_f32 v249, v209, s24, v213
    v_mfma_f32_16x16x32_bf16 v[144:147], a[228:231], v[236:239], v[144:147]
    v_fmac_f32 v213, -4.0, v209
    v_fma_f32 v209, v207, s24, v211
    v_mfma_f32_16x16x32_bf16 v[144:147], a[240:243], v[228:231], v[144:147]
    s_waitcnt lgkmcnt(0)
    v_fmac_f32 v211, -4.0, v207
    v_fma_f32 v207, v211, s26, v213
    v_mfma_f32_16x16x32_bf16 v[144:147], a[252:255], v[232:235], v[144:147]
    buffer_load_dwordx2 v[196:197], v203, s[4:7], s18 offen offset:576
    v_mfma_f32_16x16x32_bf16 v[148:151], v[240:243], v[232:235], v[148:151]
    v_fmac_f32 v213, s27, v211
    v_fma_f32 v211, v209, 2.0, v249
    v_mfma_f32_16x16x32_bf16 v[148:151], a[244:247], v[228:231], v[148:151]
    v_fmac_f32 v249, -2.0, v209
    v_cvt_pk_bf16_f32 v207, v248, v207
    v_mfma_f32_16x16x32_bf16 v[148:151], a[232:235], v[236:239], v[148:151]
    v_cvt_pk_bf16_f32 v213, v251, v213
    v_cvt_pk_bf16_f32 v211, v250, v211
    v_mfma_f32_16x16x32_bf16 v[152:155], a[236:239], v[236:239], v[152:155]
    ds_read_b128 v[236:239], v253 offset:32512
    v_cvt_pk_bf16_f32 v209, v252, v249
    v_mfma_f32_16x16x32_bf16 v[152:155], a[248:251], v[228:231], v[152:155]
    buffer_load_dwordx2 v[198:199], v203, s[4:7], s19 offen offset:576
    v_mfma_f32_16x16x32_bf16 v[152:155], v[244:247], v[232:235], v[152:155]
    v_lshrrev_b32 v252, 15, v255
    v_mfma_f32_16x16x32_bf16 v[156:159], a[228:231], v[228:231], v[156:159]
    ds_write_b64 v252, v[206:207] offset:0
    v_mfma_f32_16x16x32_bf16 v[156:159], a[240:243], v[232:235], v[156:159]
    s_waitcnt lgkmcnt(1)
    v_lshrrev_b32 v206, 15, v255
    s_waitcnt vmcnt(13)
    v_mfma_f32_16x16x32_bf16 v[156:159], a[252:255], v[236:239], v[156:159]
    buffer_load_dwordx2 v[200:201], v203, s[4:7], s20 offen offset:576
    v_mfma_f32_16x16x32_bf16 v[160:163], v[240:243], v[236:239], v[160:163]
    ds_write_b64 v206, v[212:213] offset:2080
    v_mfma_f32_16x16x32_bf16 v[160:163], a[244:247], v[232:235], v[160:163]
    v_lshlrev_b32 v248, 16, v218
    v_lshlrev_b32 v249, 16, v220
    v_mfma_f32_16x16x32_bf16 v[160:163], a[232:235], v[228:231], v[160:163]
    ds_write_b64 v206, v[210:211] offset:4160
    v_mfma_f32_16x16x32_bf16 v[164:167], a[236:239], v[228:231], v[164:167]
    ds_read_b128 v[228:231], v253 offset:32256
    v_lshlrev_b32 v250, 16, v222
    v_mfma_f32_16x16x32_bf16 v[164:167], a[248:251], v[232:235], v[164:167]
    buffer_load_dwordx2 v[202:203], v203, s[4:7], s21 offen offset:576
    v_mfma_f32_16x16x32_bf16 v[164:167], v[244:247], v[236:239], v[164:167]
    ds_write_b64 v206, v[204:205] offset:16640
    v_mfma_f32_16x16x32_bf16 v[168:171], a[228:231], v[232:235], v[168:171]
    v_lshlrev_b32 v251, 16, v224
    v_and_b32 v218, s22, v218
    v_mfma_f32_16x16x32_bf16 v[168:171], a[240:243], v[236:239], v[168:171]
    s_waitcnt lgkmcnt(1)
    v_and_b32 v220, s22, v220
    v_and_b32 v222, s22, v222
    v_and_b32 v224, s22, v224
    v_mfma_f32_16x16x32_bf16 v[168:171], a[252:255], v[228:231], v[168:171]
    ds_write_b64 v206, v[214:215] offset:24960
    v_mfma_f32_16x16x32_bf16 v[172:175], v[240:243], v[228:231], v[172:175]
    v_lshlrev_b32 v252, 16, v216
    v_and_b32 v216, s22, v216
    v_mfma_f32_16x16x32_bf16 v[172:175], a[244:247], v[236:239], v[172:175]
    ds_write_b64 v206, v[208:209] offset:6240
    v_mfma_f32_16x16x32_bf16 v[172:175], a[232:235], v[232:235], v[172:175]
    v_fmac_f32 v252, s25, v251
    v_fmac_f32 v216, s25, v224
    v_mfma_f32_16x16x32_bf16 v[176:179], a[236:239], v[232:235], v[176:179]
    ds_read_b128 v[232:235], v253 offset:31984
    v_fmac_f32 v252, s28, v249
    v_mfma_f32_16x16x32_bf16 v[176:179], a[248:251], v[236:239], v[176:179]
    v_fmac_f32 v216, s28, v220
    v_cvt_pk_bf16_f32 v216, v252, v216
    v_mfma_f32_16x16x32_bf16 v[176:179], v[244:247], v[228:231], v[176:179]
    s_mov_b32 s42, 331776
    v_lshlrev_b32 v252, 16, v226
    v_and_b32 v226, s22, v226
    v_mfma_f32_16x16x32_bf16 v[180:183], a[228:231], v[236:239], v[180:183]
    s_waitcnt lgkmcnt(0)
    v_fmac_f32 v252, s29, v248
    v_fmac_f32 v226, s29, v218
    v_mfma_f32_16x16x32_bf16 v[184:187], a[232:235], v[236:239], v[184:187]
    s_barrier
    v_mfma_f32_16x16x32_bf16 v[188:191], a[236:239], v[236:239], v[188:191]
    ds_read_b128 v[236:239], v253 offset:1040
    v_fmac_f32 v252, s23, v250
    v_mfma_f32_16x16x32_bf16 v[188:191], a[248:251], v[228:231], v[188:191]
    buffer_load_dwordx4 a[228:231], v254, s[8:11], s42 offen offset:0 sc1
    v_mfma_f32_16x16x32_bf16 v[184:187], a[244:247], v[228:231], v[184:187]
    v_fmac_f32 v226, s23, v222
    v_cvt_pk_bf16_f32 v226, v252, v226
    v_mfma_f32_16x16x32_bf16 v[180:183], a[240:243], v[228:231], v[180:183]
    ds_read_b128 v[228:231], v253 offset:768
    v_fma_f32 v252, v249, s24, v251
    v_mfma_f32_16x16x32_bf16 v[180:183], a[252:255], v[232:235], v[180:183]
    buffer_load_dwordx4 a[232:235], v254, s[8:11], s42 offen offset:1024 sc1
    v_mfma_f32_16x16x32_bf16 v[184:187], v[240:243], v[232:235], v[184:187]
    s_waitcnt vmcnt(14) lgkmcnt(1)
    v_fmac_f32 v251, -4.0, v249
    v_fma_f32 v249, v248, s24, v250
    v_mfma_f32_16x16x32_bf16 v[188:191], v[244:247], v[232:235], v[188:191]
    ds_read_b128 v[232:235], v253 offset:512
    v_fmac_f32 v250, -4.0, v248
sub8:
    v_mfma_f32_16x16x32_bf16 a[0:3], a[192:195], v[236:239], a[0:3]
    buffer_load_dwordx4 a[236:239], v254, s[8:11], s42 offen offset:2048 sc1
    v_mfma_f32_16x16x32_bf16 a[4:7], a[196:199], v[236:239], a[4:7]
    s_mov_b32 s42, 334848
    v_fma_f32 v248, v250, s26, v251
    v_fmac_f32 v251, s27, v250
    v_mfma_f32_16x16x32_bf16 a[8:11], a[200:203], v[236:239], a[8:11]
    ds_read_b128 v[236:239], v253 offset:256
    s_waitcnt vmcnt(12)
    s_waitcnt lgkmcnt(2)
    v_mfma_f32_16x16x32_bf16 a[8:11], a[212:215], v[228:231], a[8:11]
    v_fma_f32 v250, v249, 2.0, v252
    v_fmac_f32 v252, -2.0, v249
    v_mfma_f32_16x16x32_bf16 a[4:7], a[208:211], v[228:231], a[4:7]
    buffer_load_dwordx4 a[240:243], v254, s[8:11], s42 offen offset:0 sc1
    v_mfma_f32_16x16x32_bf16 a[0:3], a[204:207], v[228:231], a[0:3]
    s_waitcnt vmcnt(10) lgkmcnt(1)
    v_fma_f32 v249, v220, s24, v224
    v_fmac_f32 v224, -4.0, v220
    v_mfma_f32_16x16x32_bf16 a[0:3], a[216:219], v[232:235], a[0:3]
    v_fma_f32 v220, v218, s24, v222
    v_fmac_f32 v222, -4.0, v218
    v_mfma_f32_16x16x32_bf16 a[4:7], a[220:223], v[232:235], a[4:7]
    v_fma_f32 v218, v222, s26, v224
    v_fmac_f32 v224, s27, v222
    v_mfma_f32_16x16x32_bf16 a[8:11], a[224:227], v[232:235], a[8:11]
    buffer_load_dwordx4 a[244:247], v254, s[8:11], s42 offen offset:1024 sc1
    v_mfma_f32_16x16x32_bf16 a[12:15], a[192:195], v[228:231], a[12:15]
    v_fma_f32 v222, v220, 2.0, v249
    v_fmac_f32 v249, -2.0, v220
    v_mfma_f32_16x16x32_bf16 a[12:15], a[204:207], v[232:235], a[12:15]
    s_waitcnt lgkmcnt(0)
    v_cvt_pk_bf16_f32 v218, v248, v218
    v_cvt_pk_bf16_f32 v224, v251, v224
    v_mfma_f32_16x16x32_bf16 a[12:15], a[216:219], v[236:239], a[12:15]
    v_cvt_pk_bf16_f32 v222, v250, v222
    v_cvt_pk_bf16_f32 v220, v252, v249
    v_mfma_f32_16x16x32_bf16 a[16:19], a[220:223], v[236:239], a[16:19]
    buffer_load_dwordx4 a[248:251], v254, s[8:11], s42 offen offset:2048 sc1
    v_mfma_f32_16x16x32_bf16 a[16:19], a[208:211], v[232:235], a[16:19]
    s_mov_b32 s42, 337920
    v_lshlrev_b32 v248, 16, v219
    v_lshlrev_b32 v249, 16, v221
    v_mfma_f32_16x16x32_bf16 a[16:19], a[196:199], v[228:231], a[16:19]
    v_lshlrev_b32 v250, 16, v223
    v_lshlrev_b32 v251, 16, v225
    v_mfma_f32_16x16x32_bf16 a[20:23], a[200:203], v[228:231], a[20:23]
    ds_read_b128 v[228:231], v253 offset:0
    v_and_b32 v219, s22, v219
    v_mfma_f32_16x16x32_bf16 a[20:23], a[212:215], v[232:235], a[20:23]
    buffer_load_dwordx4 a[252:255], v254, s[8:11], s42 offen offset:0 sc1
    v_mfma_f32_16x16x32_bf16 a[20:23], a[224:227], v[236:239], a[20:23]
    v_and_b32 v221, s22, v221
    v_and_b32 v223, s22, v223
    v_mfma_f32_16x16x32_bf16 a[24:27], a[192:195], v[232:235], a[24:27]
    v_and_b32 v225, s22, v225
    v_lshlrev_b32 v252, 16, v217
    v_mfma_f32_16x16x32_bf16 a[24:27], a[204:207], v[236:239], a[24:27]
    s_waitcnt lgkmcnt(0)
    v_and_b32 v217, s22, v217
    v_fmac_f32 v252, s25, v251
    v_mfma_f32_16x16x32_bf16 a[24:27], a[216:219], v[228:231], a[24:27]
    v_fmac_f32 v217, s25, v225
    v_fmac_f32 v252, s28, v249
    v_mfma_f32_16x16x32_bf16 a[28:31], a[220:223], v[228:231], a[28:31]
    buffer_load_dwordx4 v[240:243], v254, s[8:11], s42 offen offset:1024 sc1
    v_mfma_f32_16x16x32_bf16 a[28:31], a[208:211], v[236:239], a[28:31]
    v_fmac_f32 v217, s28, v221
    v_cvt_pk_bf16_f32 v217, v252, v217
    v_mfma_f32_16x16x32_bf16 a[28:31], a[196:199], v[232:235], a[28:31]
    v_lshlrev_b32 v252, 16, v227
    v_and_b32 v227, s22, v227
    v_fmac_f32 v252, s29, v248
    v_mfma_f32_16x16x32_bf16 a[32:35], a[200:203], v[232:235], a[32:35]
    ds_read_b128 v[232:235], v253 offset:1824
    v_fmac_f32 v227, s29, v219
    v_mfma_f32_16x16x32_bf16 a[32:35], a[212:215], v[236:239], a[32:35]
    buffer_load_dwordx4 v[244:247], v254, s[8:11], s42 offen offset:2048 sc1
    v_mfma_f32_16x16x32_bf16 a[32:35], a[224:227], v[228:231], a[32:35]
    v_fmac_f32 v252, s23, v250
    v_fmac_f32 v227, s23, v223
    v_mfma_f32_16x16x32_bf16 a[36:39], a[192:195], v[236:239], a[36:39]
    v_and_b32 v215, 0x7fff, v255
    v_cvt_pk_bf16_f32 v227, v252, v227
    v_mfma_f32_16x16x32_bf16 a[36:39], a[204:207], v[228:231], a[36:39]
    s_waitcnt lgkmcnt(0)
    v_fma_f32 v252, v249, s24, v251
    v_fmac_f32 v251, -4.0, v249
    v_mfma_f32_16x16x32_bf16 a[36:39], a[216:219], v[232:235], a[36:39]
    buffer_load_dwordx2 v[204:205], v215, s[4:7], s16 offen offset:960
    v_mfma_f32_16x16x32_bf16 a[40:43], a[220:223], v[232:235], a[40:43]
    v_fma_f32 v249, v248, s24, v250
    v_fmac_f32 v250, -4.0, v248
    v_mfma_f32_16x16x32_bf16 a[40:43], a[208:211], v[228:231], a[40:43]
    v_fma_f32 v248, v250, s26, v251
    v_fmac_f32 v251, s27, v250
    v_mfma_f32_16x16x32_bf16 a[40:43], a[196:199], v[236:239], a[40:43]
    v_fma_f32 v250, v249, 2.0, v252
    v_fmac_f32 v252, -2.0, v249
    v_mfma_f32_16x16x32_bf16 a[44:47], a[200:203], v[236:239], a[44:47]
    ds_read_b128 v[236:239], v253 offset:1568
    v_fma_f32 v249, v221, s24, v225
    v_mfma_f32_16x16x32_bf16 a[44:47], a[212:215], v[228:231], a[44:47]
    buffer_load_dwordx2 v[206:207], v215, s[4:7], s17 offen offset:960
    v_mfma_f32_16x16x32_bf16 a[44:47], a[224:227], v[232:235], a[44:47]
    v_fmac_f32 v225, -4.0, v221
    v_fma_f32 v221, v219, s24, v223
    v_mfma_f32_16x16x32_bf16 a[48:51], a[192:195], v[228:231], a[48:51]
    v_fmac_f32 v223, -4.0, v219
    v_fma_f32 v219, v223, s26, v225
    v_mfma_f32_16x16x32_bf16 a[48:51], a[204:207], v[232:235], a[48:51]
    s_waitcnt lgkmcnt(0)
    v_fmac_f32 v225, s27, v223
    v_fma_f32 v223, v221, 2.0, v249
    v_mfma_f32_16x16x32_bf16 a[48:51], a[216:219], v[236:239], a[48:51]
    buffer_load_dwordx2 v[208:209], v215, s[4:7], s18 offen offset:960
    v_mfma_f32_16x16x32_bf16 a[52:55], a[220:223], v[236:239], a[52:55]
    v_fmac_f32 v249, -2.0, v221
    v_cvt_pk_bf16_f32 v219, v248, v219
    v_mfma_f32_16x16x32_bf16 a[52:55], a[208:211], v[232:235], a[52:55]
    v_cvt_pk_bf16_f32 v225, v251, v225
    v_cvt_pk_bf16_f32 v223, v250, v223
    v_mfma_f32_16x16x32_bf16 a[52:55], a[196:199], v[228:231], a[52:55]
    v_cvt_pk_bf16_f32 v221, v252, v249
    v_lshrrev_b32 v252, 15, v255
    v_mfma_f32_16x16x32_bf16 a[56:59], a[200:203], v[228:231], a[56:59]
    ds_read_b128 v[228:231], v253 offset:1312
    v_mfma_f32_16x16x32_bf16 a[56:59], a[212:215], v[232:235], a[56:59]
    buffer_load_dwordx2 v[210:211], v215, s[4:7], s19 offen offset:960
    v_mfma_f32_16x16x32_bf16 a[56:59], a[224:227], v[236:239], a[56:59]
    ds_write_b64 v252, v[218:219] offset:9088
    v_mfma_f32_16x16x32_bf16 a[60:63], a[192:195], v[232:235], a[60:63]
    v_lshrrev_b32 v218, 15, v255
    v_mfma_f32_16x16x32_bf16 a[60:63], a[204:207], v[236:239], a[60:63]
    s_waitcnt lgkmcnt(1)
    s_waitcnt vmcnt(13)
    v_lshlrev_b32 v248, 16, v194
    v_mfma_f32_16x16x32_bf16 a[60:63], a[216:219], v[228:231], a[60:63]
    buffer_load_dwordx2 v[212:213], v215, s[4:7], s20 offen offset:960
    v_mfma_f32_16x16x32_bf16 a[64:67], a[220:223], v[228:231], a[64:67]
    ds_write_b64 v218, v[224:225] offset:11168
    v_mfma_f32_16x16x32_bf16 a[64:67], a[208:211], v[236:239], a[64:67]
    v_lshlrev_b32 v249, 16, v196
    v_lshlrev_b32 v250, 16, v198
    v_mfma_f32_16x16x32_bf16 a[64:67], a[196:199], v[232:235], a[64:67]
    ds_write_b64 v218, v[222:223] offset:13248
    v_mfma_f32_16x16x32_bf16 a[68:71], a[200:203], v[232:235], a[68:71]
    ds_read_b128 v[232:235], v253 offset:1056
    v_lshlrev_b32 v251, 16, v200
    v_mfma_f32_16x16x32_bf16 a[68:71], a[212:215], v[236:239], a[68:71]
    buffer_load_dwordx2 v[214:215], v215, s[4:7], s21 offen offset:960
    v_mfma_f32_16x16x32_bf16 a[68:71], a[224:227], v[228:231], a[68:71]
pad3:
    s_cbranch_vccnz pad7
    ds_write_b64 v218, v[216:217] offset:19488
    v_mfma_f32_16x16x32_bf16 a[72:75], a[192:195], v[236:239], a[72:75]
    v_and_b32 v194, s22, v194
    v_and_b32 v196, s22, v196
    v_mfma_f32_16x16x32_bf16 a[72:75], a[204:207], v[228:231], a[72:75]
    s_waitcnt lgkmcnt(1)
    v_and_b32 v198, s22, v198
    v_and_b32 v200, s22, v200
    v_mfma_f32_16x16x32_bf16 a[72:75], a[216:219], v[232:235], a[72:75]
    ds_write_b64 v218, v[226:227] offset:27808
    v_mfma_f32_16x16x32_bf16 a[76:79], a[220:223], v[232:235], a[76:79]
    v_lshlrev_b32 v252, 16, v192
    v_and_b32 v192, s22, v192
    v_mfma_f32_16x16x32_bf16 a[76:79], a[208:211], v[228:231], a[76:79]
    ds_write_b64 v218, v[220:221] offset:31968
    v_mfma_f32_16x16x32_bf16 a[76:79], a[196:199], v[236:239], a[76:79]
    v_fmac_f32 v252, s25, v251
    v_fmac_f32 v192, s25, v200
    v_mfma_f32_16x16x32_bf16 a[80:83], a[200:203], v[236:239], a[80:83]
    ds_read_b128 v[236:239], v253 offset:784
    v_fmac_f32 v252, s28, v249
    v_mfma_f32_16x16x32_bf16 a[80:83], a[212:215], v[228:231], a[80:83]
    v_fmac_f32 v192, s28, v196
    v_cvt_pk_bf16_f32 v192, v252, v192
    v_mfma_f32_16x16x32_bf16 a[80:83], a[224:227], v[232:235], a[80:83]
    s_mov_b32 s42, 368640
    v_lshlrev_b32 v252, 16, v202
    v_and_b32 v202, s22, v202
    v_mfma_f32_16x16x32_bf16 a[84:87], a[192:195], v[228:231], a[84:87]
    v_fmac_f32 v252, s29, v248
    v_fmac_f32 v202, s29, v194
    v_fmac_f32 v252, s23, v250
    v_mfma_f32_16x16x32_bf16 a[88:91], a[196:199], v[228:231], a[88:91]
    v_fmac_f32 v202, s23, v198
    v_cvt_pk_bf16_f32 v202, v252, v202
    v_mfma_f32_16x16x32_bf16 a[92:95], a[200:203], v[228:231], a[92:95]
    ds_read_b128 v[228:231], v253 offset:3120
    v_fma_f32 v252, v249, s24, v251
    v_mfma_f32_16x16x32_bf16 a[92:95], a[212:215], v[232:235], a[92:95]
    buffer_load_dwordx4 a[192:195], v254, s[8:11], s42 offen offset:0 sc1
    v_mfma_f32_16x16x32_bf16 a[88:91], a[208:211], v[232:235], a[88:91]
    s_waitcnt lgkmcnt(1)
    v_fmac_f32 v251, -4.0, v249
    v_fma_f32 v249, v248, s24, v250
    v_mfma_f32_16x16x32_bf16 a[84:87], a[204:207], v[232:235], a[84:87]
    ds_read_b128 v[232:235], v253 offset:2848
    v_fmac_f32 v250, -4.0, v248
    v_mfma_f32_16x16x32_bf16 a[84:87], a[216:219], v[236:239], a[84:87]
    buffer_load_dwordx4 a[196:199], v254, s[8:11], s42 offen offset:1024 sc1
    v_mfma_f32_16x16x32_bf16 a[88:91], a[220:223], v[236:239], a[88:91]
    s_waitcnt vmcnt(14) lgkmcnt(1)
    v_fma_f32 v248, v250, s26, v251
    v_fmac_f32 v251, s27, v250
    v_mfma_f32_16x16x32_bf16 a[92:95], a[224:227], v[236:239], a[92:95]
    ds_read_b128 v[236:239], v253 offset:2592
    v_fma_f32 v250, v249, 2.0, v252
sub9:
    v_mfma_f32_16x16x32_bf16 a[96:99], a[228:231], v[228:231], a[96:99]
    buffer_load_dwordx4 a[200:203], v254, s[8:11], s42 offen offset:2048 sc1
    v_mfma_f32_16x16x32_bf16 a[100:103], a[232:235], v[228:231], a[100:103]
    s_mov_b32 s42, 371712
    v_fmac_f32 v252, -2.0, v249
    v_fma_f32 v249, v196, s24, v200
    v_mfma_f32_16x16x32_bf16 a[104:107], a[236:239], v[228:231], a[104:107]
    ds_read_b128 v[228:231], v253 offset:2336
    s_waitcnt vmcnt(12)
    s_waitcnt lgkmcnt(2)
    v_mfma_f32_16x16x32_bf16 a[104:107], a[248:251], v[232:235], a[104:107]
    v_fmac_f32 v200, -4.0, v196
    v_fma_f32 v196, v194, s24, v198
    v_mfma_f32_16x16x32_bf16 a[100:103], a[244:247], v[232:235], a[100:103]
    buffer_load_dwordx4 a[204:207], v254, s[8:11], s42 offen offset:0 sc1
    v_mfma_f32_16x16x32_bf16 a[96:99], a[240:243], v[232:235], a[96:99]
    s_waitcnt vmcnt(10) lgkmcnt(1)
    v_fmac_f32 v198, -4.0, v194
    v_fma_f32 v194, v198, s26, v200
    v_mfma_f32_16x16x32_bf16 a[96:99], a[252:255], v[236:239], a[96:99]
    v_fmac_f32 v200, s27, v198
    v_fma_f32 v198, v196, 2.0, v249
    v_mfma_f32_16x16x32_bf16 a[100:103], v[240:243], v[236:239], a[100:103]
    v_fmac_f32 v249, -2.0, v196
    v_cvt_pk_bf16_f32 v194, v248, v194
    v_mfma_f32_16x16x32_bf16 a[104:107], v[244:247], v[236:239], a[104:107]
    buffer_load_dwordx4 a[208:211], v254, s[8:11], s42 offen offset:1024 sc1
    v_mfma_f32_16x16x32_bf16 a[108:111], a[228:231], v[232:235], a[108:111]
    v_cvt_pk_bf16_f32 v200, v251, v200
    v_cvt_pk_bf16_f32 v198, v250, v198
    v_mfma_f32_16x16x32_bf16 a[108:111], a[240:243], v[236:239], a[108:111]
    s_waitcnt lgkmcnt(0)
    v_cvt_pk_bf16_f32 v196, v252, v249
    v_lshlrev_b32 v248, 16, v195
    v_mfma_f32_16x16x32_bf16 a[108:111], a[252:255], v[228:231], a[108:111]
    v_lshlrev_b32 v249, 16, v197
    v_lshlrev_b32 v250, 16, v199
    v_mfma_f32_16x16x32_bf16 a[112:115], v[240:243], v[228:231], a[112:115]
    buffer_load_dwordx4 a[212:215], v254, s[8:11], s42 offen offset:2048 sc1
    v_mfma_f32_16x16x32_bf16 a[112:115], a[244:247], v[236:239], a[112:115]
    s_mov_b32 s42, 374784
    v_lshlrev_b32 v251, 16, v201
    v_and_b32 v195, s22, v195
    v_mfma_f32_16x16x32_bf16 a[112:115], a[232:235], v[232:235], a[112:115]
    v_and_b32 v197, s22, v197
    v_and_b32 v199, s22, v199
    v_mfma_f32_16x16x32_bf16 a[116:119], a[236:239], v[232:235], a[116:119]
    ds_read_b128 v[232:235], v253 offset:2080
    v_and_b32 v201, s22, v201
    v_mfma_f32_16x16x32_bf16 a[116:119], a[248:251], v[236:239], a[116:119]
    buffer_load_dwordx4 a[216:219], v254, s[8:11], s42 offen offset:0 sc1
    v_mfma_f32_16x16x32_bf16 a[116:119], v[244:247], v[228:231], a[116:119]
    v_lshlrev_b32 v252, 16, v193
    v_and_b32 v193, s22, v193
    v_mfma_f32_16x16x32_bf16 a[120:123], a[228:231], v[236:239], a[120:123]
    v_fmac_f32 v252, s25, v251
    v_fmac_f32 v193, s25, v201
    v_mfma_f32_16x16x32_bf16 a[120:123], a[240:243], v[228:231], a[120:123]
    s_waitcnt lgkmcnt(0)
    v_fmac_f32 v252, s28, v249
    v_fmac_f32 v193, s28, v197
    v_mfma_f32_16x16x32_bf16 a[120:123], a[252:255], v[232:235], a[120:123]
    v_cvt_pk_bf16_f32 v193, v252, v193
    v_lshlrev_b32 v252, 16, v203
    v_mfma_f32_16x16x32_bf16 a[124:127], v[240:243], v[232:235], a[124:127]
    buffer_load_dwordx4 a[220:223], v254, s[8:11], s42 offen offset:1024 sc1
    v_mfma_f32_16x16x32_bf16 a[124:127], a[244:247], v[228:231], a[124:127]
    v_and_b32 v203, s22, v203
    v_fmac_f32 v252, s29, v248
    v_mfma_f32_16x16x32_bf16 a[124:127], a[232:235], v[236:239], a[124:127]
    v_fmac_f32 v203, s29, v195
    v_fmac_f32 v252, s23, v250
    v_mfma_f32_16x16x32_bf16 a[128:131], a[236:239], v[236:239], a[128:131]
    ds_read_b128 v[236:239], v253 offset:3904
    v_fmac_f32 v203, s23, v199
    v_mfma_f32_16x16x32_bf16 a[128:131], a[248:251], v[228:231], a[128:131]
    buffer_load_dwordx4 a[224:227], v254, s[8:11], s42 offen offset:2048 sc1
    v_mfma_f32_16x16x32_bf16 a[128:131], v[244:247], v[232:235], a[128:131]
    v_cvt_pk_bf16_f32 v203, v252, v203
    v_fma_f32 v252, v249, s24, v251
    v_mfma_f32_16x16x32_bf16 a[132:135], a[228:231], v[228:231], a[132:135]
    v_and_b32 v227, 0x7fff, v255
    v_fmac_f32 v251, -4.0, v249
    v_mfma_f32_16x16x32_bf16 a[132:135], a[240:243], v[232:235], a[132:135]
    s_waitcnt lgkmcnt(0)
    v_fma_f32 v249, v248, s24, v250
    v_fmac_f32 v250, -4.0, v248
    v_mfma_f32_16x16x32_bf16 a[132:135], a[252:255], v[236:239], a[132:135]
    buffer_load_dwordx2 v[216:217], v227, s[4:7], s16 offen offset:1344
    v_mfma_f32_16x16x32_bf16 a[136:139], v[240:243], v[236:239], a[136:139]
    v_fma_f32 v248, v250, s26, v251
    v_fmac_f32 v251, s27, v250
    v_mfma_f32_16x16x32_bf16 a[136:139], a[244:247], v[232:235], a[136:139]
    v_fma_f32 v250, v249, 2.0, v252
    v_fmac_f32 v252, -2.0, v249
    v_fma_f32 v249, v197, s24, v201
    v_mfma_f32_16x16x32_bf16 a[136:139], a[232:235], v[228:231], a[136:139]
    v_fmac_f32 v201, -4.0, v197
    v_fma_f32 v197, v195, s24, v199
    v_mfma_f32_16x16x32_bf16 a[140:143], a[236:239], v[228:231], a[140:143]
    ds_read_b128 v[228:231], v253 offset:3648
    v_fmac_f32 v199, -4.0, v195
    v_mfma_f32_16x16x32_bf16 a[140:143], a[248:251], v[232:235], a[140:143]
    buffer_load_dwordx2 v[218:219], v227, s[4:7], s17 offen offset:1344
    v_mfma_f32_16x16x32_bf16 a[140:143], v[244:247], v[236:239], a[140:143]
    v_fma_f32 v195, v199, s26, v201
    v_fmac_f32 v201, s27, v199
    v_mfma_f32_16x16x32_bf16 a[144:147], a[228:231], v[232:235], a[144:147]
    v_fma_f32 v199, v197, 2.0, v249
    v_fmac_f32 v249, -2.0, v197
    v_mfma_f32_16x16x32_bf16 a[144:147], a[240:243], v[236:239], a[144:147]
    s_waitcnt lgkmcnt(0)
    v_cvt_pk_bf16_f32 v195, v248, v195
    v_cvt_pk_bf16_f32 v201, v251, v201
    v_mfma_f32_16x16x32_bf16 a[144:147], a[252:255], v[228:231], a[144:147]
    buffer_load_dwordx2 v[220:221], v227, s[4:7], s18 offen offset:1344
    v_mfma_f32_16x16x32_bf16 a[148:151], v[240:243], v[228:231], a[148:151]
    v_cvt_pk_bf16_f32 v199, v250, v199
    v_cvt_pk_bf16_f32 v197, v252, v249
    v_mfma_f32_16x16x32_bf16 a[148:151], a[244:247], v[236:239], a[148:151]
    v_lshrrev_b32 v252, 15, v255
    v_mfma_f32_16x16x32_bf16 a[148:151], a[232:235], v[232:235], a[148:151]
    ds_write_b64 v252, v[194:195] offset:8832
    v_mfma_f32_16x16x32_bf16 a[152:155], a[236:239], v[232:235], a[152:155]
    ds_read_b128 v[232:235], v253 offset:3392
    v_lshrrev_b32 v194, 15, v255
    v_mfma_f32_16x16x32_bf16 a[152:155], a[248:251], v[236:239], a[152:155]
    buffer_load_dwordx2 v[222:223], v227, s[4:7], s19 offen offset:1344
    v_mfma_f32_16x16x32_bf16 a[152:155], v[244:247], v[228:231], a[152:155]
    ds_write_b64 v194, v[200:201] offset:10912
    v_mfma_f32_16x16x32_bf16 a[156:159], a[228:231], v[236:239], a[156:159]
    v_mfma_f32_16x16x32_bf16 a[156:159], a[240:243], v[228:231], a[156:159]
    s_waitcnt lgkmcnt(1)
    s_waitcnt vmcnt(13)
    v_lshlrev_b32 v248, 16, v206
    v_mfma_f32_16x16x32_bf16 a[156:159], a[252:255], v[232:235], a[156:159]
    buffer_load_dwordx2 v[224:225], v227, s[4:7], s20 offen offset:1344
    v_mfma_f32_16x16x32_bf16 a[160:163], v[240:243], v[232:235], a[160:163]
    ds_write_b64 v194, v[198:199] offset:12992
    v_mfma_f32_16x16x32_bf16 a[160:163], a[244:247], v[228:231], a[160:163]
    v_lshlrev_b32 v249, 16, v208
    v_lshlrev_b32 v250, 16, v210
    v_mfma_f32_16x16x32_bf16 a[160:163], a[232:235], v[236:239], a[160:163]
    ds_write_b64 v194, v[192:193] offset:19232
    v_mfma_f32_16x16x32_bf16 a[164:167], a[236:239], v[236:239], a[164:167]
    ds_read_b128 v[236:239], v253 offset:3136
    v_lshlrev_b32 v251, 16, v212
    v_mfma_f32_16x16x32_bf16 a[164:167], a[248:251], v[228:231], a[164:167]
    buffer_load_dwordx2 v[226:227], v227, s[4:7], s21 offen offset:1344
    v_mfma_f32_16x16x32_bf16 a[164:167], v[244:247], v[232:235], a[164:167]
    ds_write_b64 v194, v[202:203] offset:27552
    v_mfma_f32_16x16x32_bf16 a[168:171], a[228:231], v[228:231], a[168:171]
    v_and_b32 v206, s22, v206
    v_and_b32 v208, s22, v208
    v_mfma_f32_16x16x32_bf16 a[168:171], a[240:243], v[232:235], a[168:171]
    s_waitcnt lgkmcnt(1)
    v_and_b32 v210, s22, v210
    v_and_b32 v212, s22, v212
    v_mfma_f32_16x16x32_bf16 a[168:171], a[252:255], v[236:239], a[168:171]
    ds_write_b64 v194, v[196:197] offset:31712
    v_mfma_f32_16x16x32_bf16 a[172:175], v[240:243], v[236:239], a[172:175]
    ds_read_b128 v[192:195], v253 offset:40096
    s_mov_b32 s45, 452138121
    v_mfma_f32_16x16x32_bf16 a[172:175], a[244:247], v[232:235], a[172:175]
    v_bfe_u32 v196, v254, 5, 3
    v_mul_u32_u24 v197, 5, v196
    v_mfma_f32_16x16x32_bf16 a[172:175], a[232:235], v[228:231], a[172:175]
    v_bfe_u32 v197, s45, v197, 5
    v_mul_u32_u24 v197, 65, v197
    v_mfma_f32_16x16x32_bf16 a[176:179], a[236:239], v[228:231], a[176:179]
    ds_read_b128 v[228:231], v253 offset:2864
    v_sub_u32 v197, v197, v196
    v_mfma_f32_16x16x32_bf16 a[176:179], a[248:251], v[232:235], a[176:179]
    v_lshl_add_u32 v196, v197, 5, v253
    s_waitcnt lgkmcnt(1)
    v_mfma_f32_16x16x32_bf16 a[176:179], v[244:247], v[236:239], a[176:179]
    s_mov_b32 s42, 405504
    v_lshlrev_b32 v252, 16, v204
    v_and_b32 v204, s22, v204
    v_mfma_f32_16x16x32_bf16 a[180:183], a[228:231], v[232:235], a[180:183]
    s_mov_b64 exec, s[46:47]
    ds_write_b128 v196, v[192:195] offset:1024
    s_mov_b64 exec, -1
    v_mfma_f32_16x16x32_bf16 a[184:187], a[232:235], v[232:235], a[184:187]
    v_fmac_f32 v252, s25, v251
    v_fmac_f32 v204, s25, v212
    v_mfma_f32_16x16x32_bf16 a[188:191], a[236:239], v[232:235], a[188:191]
    ds_read_b128 v[232:235], v253 offset:5200
    v_fmac_f32 v252, s28, v249
    v_mfma_f32_16x16x32_bf16 a[188:191], a[248:251], v[236:239], a[188:191]
    buffer_load_dwordx4 a[228:231], v254, s[8:11], s42 offen offset:0 sc1
    v_mfma_f32_16x16x32_bf16 a[184:187], a[244:247], v[236:239], a[184:187]
    s_waitcnt lgkmcnt(2)
    v_fmac_f32 v204, s28, v208
    v_cvt_pk_bf16_f32 v204, v252, v204
    v_mfma_f32_16x16x32_bf16 a[180:183], a[240:243], v[236:239], a[180:183]
    ds_read_b128 v[236:239], v253 offset:4928
    v_lshlrev_b32 v252, 16, v214
    v_mfma_f32_16x16x32_bf16 a[180:183], a[252:255], v[228:231], a[180:183]
    buffer_load_dwordx4 a[232:235], v254, s[8:11], s42 offen offset:1024 sc1
    v_mfma_f32_16x16x32_bf16 a[184:187], v[240:243], v[228:231], a[184:187]
    s_waitcnt vmcnt(14) lgkmcnt(1)
    v_and_b32 v214, s22, v214
    v_fmac_f32 v252, s29, v248
    v_mfma_f32_16x16x32_bf16 a[188:191], v[244:247], v[228:231], a[188:191]
    ds_read_b128 v[228:231], v253 offset:4672
    v_fmac_f32 v214, s29, v206
    v_fmac_f32 v252, s23, v250
sub10:
    v_mfma_f32_16x16x32_bf16 v[0:3], a[192:195], v[232:235], v[0:3]
    buffer_load_dwordx4 a[236:239], v254, s[8:11], s42 offen offset:2048 sc1
    v_mfma_f32_16x16x32_bf16 v[4:7], a[196:199], v[232:235], v[4:7]
    s_mov_b32 s42, 408576
    v_fmac_f32 v214, s23, v210
    v_cvt_pk_bf16_f32 v214, v252, v214
    v_mfma_f32_16x16x32_bf16 v[8:11], a[200:203], v[232:235], v[8:11]
    ds_read_b128 v[232:235], v253 offset:4416
    s_waitcnt vmcnt(12)
    s_waitcnt lgkmcnt(2)
    v_mfma_f32_16x16x32_bf16 v[8:11], a[212:215], v[236:239], v[8:11]
    v_fma_f32 v252, v249, s24, v251
    v_fmac_f32 v251, -4.0, v249
    v_mfma_f32_16x16x32_bf16 v[4:7], a[208:211], v[236:239], v[4:7]
    buffer_load_dwordx4 a[240:243], v254, s[8:11], s42 offen offset:0 sc1
    v_mfma_f32_16x16x32_bf16 v[0:3], a[204:207], v[236:239], v[0:3]
    s_waitcnt vmcnt(10) lgkmcnt(1)
    v_fma_f32 v249, v248, s24, v250
    v_fmac_f32 v250, -4.0, v248
    v_mfma_f32_16x16x32_bf16 v[0:3], a[216:219], v[228:231], v[0:3]
    v_fma_f32 v248, v250, s26, v251
    v_fmac_f32 v251, s27, v250
    v_mfma_f32_16x16x32_bf16 v[4:7], a[220:223], v[228:231], v[4:7]
    v_fma_f32 v250, v249, 2.0, v252
    v_fmac_f32 v252, -2.0, v249
    v_mfma_f32_16x16x32_bf16 v[8:11], a[224:227], v[228:231], v[8:11]
    buffer_load_dwordx4 a[244:247], v254, s[8:11], s42 offen offset:1024 sc1
    v_mfma_f32_16x16x32_bf16 v[12:15], a[192:195], v[236:239], v[12:15]
    v_fma_f32 v249, v208, s24, v212
    v_fmac_f32 v212, -4.0, v208
    v_mfma_f32_16x16x32_bf16 v[12:15], a[204:207], v[228:231], v[12:15]
    s_waitcnt lgkmcnt(0)
    v_fma_f32 v208, v206, s24, v210
    v_fmac_f32 v210, -4.0, v206
    v_mfma_f32_16x16x32_bf16 v[12:15], a[216:219], v[232:235], v[12:15]
    v_fma_f32 v206, v210, s26, v212
    v_fmac_f32 v212, s27, v210
    v_mfma_f32_16x16x32_bf16 v[16:19], a[220:223], v[232:235], v[16:19]
    buffer_load_dwordx4 a[248:251], v254, s[8:11], s42 offen offset:2048 sc1
    v_mfma_f32_16x16x32_bf16 v[16:19], a[208:211], v[228:231], v[16:19]
    s_mov_b32 s42, 411648
    v_fma_f32 v210, v208, 2.0, v249
    v_fmac_f32 v249, -2.0, v208
    v_mfma_f32_16x16x32_bf16 v[16:19], a[196:199], v[236:239], v[16:19]
    v_cvt_pk_bf16_f32 v206, v248, v206
    v_cvt_pk_bf16_f32 v212, v251, v212
    v_mfma_f32_16x16x32_bf16 v[20:23], a[200:203], v[236:239], v[20:23]
    ds_read_b128 v[236:239], v253 offset:4160
    v_cvt_pk_bf16_f32 v210, v250, v210
    v_mfma_f32_16x16x32_bf16 v[20:23], a[212:215], v[228:231], v[20:23]
    buffer_load_dwordx4 a[252:255], v254, s[8:11], s42 offen offset:0 sc1
    v_mfma_f32_16x16x32_bf16 v[20:23], a[224:227], v[232:235], v[20:23]
    v_cvt_pk_bf16_f32 v208, v252, v249
    v_lshlrev_b32 v248, 16, v207
    v_mfma_f32_16x16x32_bf16 v[24:27], a[192:195], v[228:231], v[24:27]
    v_lshlrev_b32 v249, 16, v209
    v_lshlrev_b32 v250, 16, v211
    v_mfma_f32_16x16x32_bf16 v[24:27], a[204:207], v[232:235], v[24:27]
    s_waitcnt lgkmcnt(0)
    v_lshlrev_b32 v251, 16, v213
    v_and_b32 v207, s22, v207
    v_mfma_f32_16x16x32_bf16 v[24:27], a[216:219], v[236:239], v[24:27]
    v_and_b32 v209, s22, v209
    v_and_b32 v211, s22, v211
    v_mfma_f32_16x16x32_bf16 v[28:31], a[220:223], v[236:239], v[28:31]
    buffer_load_dwordx4 v[240:243], v254, s[8:11], s42 offen offset:1024 sc1
    v_mfma_f32_16x16x32_bf16 v[28:31], a[208:211], v[232:235], v[28:31]
    v_and_b32 v213, s22, v213
    v_lshlrev_b32 v252, 16, v205
    v_mfma_f32_16x16x32_bf16 v[28:31], a[196:199], v[228:231], v[28:31]
    v_and_b32 v205, s22, v205
    v_fmac_f32 v252, s25, v251
    v_mfma_f32_16x16x32_bf16 v[32:35], a[200:203], v[228:231], v[32:35]
    ds_read_b128 v[228:231], v253 offset:5984
    v_fmac_f32 v205, s25, v213
    v_mfma_f32_16x16x32_bf16 v[32:35], a[212:215], v[232:235], v[32:35]
    buffer_load_dwordx4 v[244:247], v254, s[8:11], s42 offen offset:2048 sc1
    v_mfma_f32_16x16x32_bf16 v[32:35], a[224:227], v[236:239], v[32:35]
    v_fmac_f32 v252, s28, v249
    v_fmac_f32 v205, s28, v209
    v_mfma_f32_16x16x32_bf16 v[36:39], a[192:195], v[232:235], v[36:39]
    v_and_b32 v203, 0x7fff, v255
    v_cvt_pk_bf16_f32 v205, v252, v205
    v_mfma_f32_16x16x32_bf16 v[36:39], a[204:207], v[236:239], v[36:39]
    s_waitcnt lgkmcnt(0)
    v_lshlrev_b32 v252, 16, v215
    v_and_b32 v215, s22, v215
    v_mfma_f32_16x16x32_bf16 v[36:39], a[216:219], v[228:231], v[36:39]
    buffer_load_dwordx2 v[192:193], v203, s[4:7], s16 offen offset:256
    v_mfma_f32_16x16x32_bf16 v[40:43], a[220:223], v[228:231], v[40:43]
    v_fmac_f32 v252, s29, v248
    v_fmac_f32 v215, s29, v207
    v_mfma_f32_16x16x32_bf16 v[40:43], a[208:211], v[236:239], v[40:43]
    v_fmac_f32 v252, s23, v250
    v_fmac_f32 v215, s23, v211
    v_mfma_f32_16x16x32_bf16 v[40:43], a[196:199], v[232:235], v[40:43]
    v_cvt_pk_bf16_f32 v215, v252, v215
    v_fma_f32 v252, v249, s24, v251
    v_mfma_f32_16x16x32_bf16 v[44:47], a[200:203], v[232:235], v[44:47]
    ds_read_b128 v[232:235], v253 offset:5728
    v_fmac_f32 v251, -4.0, v249
    v_mfma_f32_16x16x32_bf16 v[44:47], a[212:215], v[236:239], v[44:47]
    buffer_load_dwordx2 v[194:195], v203, s[4:7], s17 offen offset:256
    v_mfma_f32_16x16x32_bf16 v[44:47], a[224:227], v[228:231], v[44:47]
    v_fma_f32 v249, v248, s24, v250
    v_fmac_f32 v250, -4.0, v248
    v_mfma_f32_16x16x32_bf16 v[48:51], a[192:195], v[236:239], v[48:51]
    v_fma_f32 v248, v250, s26, v251
    v_fmac_f32 v251, s27, v250
    v_mfma_f32_16x16x32_bf16 v[48:51], a[204:207], v[228:231], v[48:51]
    s_waitcnt lgkmcnt(0)
    v_fma_f32 v250, v249, 2.0, v252
    v_fmac_f32 v252, -2.0, v249
    v_mfma_f32_16x16x32_bf16 v[48:51], a[216:219], v[232:235], v[48:51]
    buffer_load_dwordx2 v[196:197], v203, s[4:7], s18 offen offset:256
    v_mfma_f32_16x16x32_bf16 v[52:55], a[220:223], v[232:235], v[52:55]
    v_fma_f32 v249, v209, s24, v213
    v_fmac_f32 v213, -4.0, v209
    v_fma_f32 v209, v207, s24, v211
    v_mfma_f32_16x16x32_bf16 v[52:55], a[208:211], v[228:231], v[52:55]
    v_fmac_f32 v211, -4.0, v207
    v_fma_f32 v207, v211, s26, v213
    v_mfma_f32_16x16x32_bf16 v[52:55], a[196:199], v[236:239], v[52:55]
    v_fmac_f32 v213, s27, v211
    v_fma_f32 v211, v209, 2.0, v249
    v_mfma_f32_16x16x32_bf16 v[56:59], a[200:203], v[236:239], v[56:59]
    ds_read_b128 v[236:239], v253 offset:5472
    v_fmac_f32 v249, -2.0, v209
    v_mfma_f32_16x16x32_bf16 v[56:59], a[212:215], v[228:231], v[56:59]
    buffer_load_dwordx2 v[198:199], v203, s[4:7], s19 offen offset:256
    v_mfma_f32_16x16x32_bf16 v[56:59], a[224:227], v[232:235], v[56:59]
    v_cvt_pk_bf16_f32 v207, v248, v207
    v_cvt_pk_bf16_f32 v213, v251, v213
    v_mfma_f32_16x16x32_bf16 v[60:63], a[192:195], v[228:231], v[60:63]
    v_cvt_pk_bf16_f32 v211, v250, v211
    v_cvt_pk_bf16_f32 v209, v252, v249
    v_mfma_f32_16x16x32_bf16 v[60:63], a[204:207], v[232:235], v[60:63]
    s_waitcnt lgkmcnt(0)
    v_lshrrev_b32 v252, 15, v255
    v_mfma_f32_16x16x32_bf16 v[60:63], a[216:219], v[236:239], v[60:63]
    buffer_load_dwordx2 v[200:201], v203, s[4:7], s20 offen offset:256
    v_mfma_f32_16x16x32_bf16 v[64:67], a[220:223], v[236:239], v[64:67]
    ds_write_b64 v252, v[206:207] offset:8576
    v_mfma_f32_16x16x32_bf16 v[64:67], a[208:211], v[232:235], v[64:67]
    s_waitcnt vmcnt(14)
    v_lshrrev_b32 v206, 15, v255
    v_lshlrev_b32 v248, 16, v218
    v_mfma_f32_16x16x32_bf16 v[64:67], a[196:199], v[228:231], v[64:67]
    ds_write_b64 v206, v[212:213] offset:10656
    v_mfma_f32_16x16x32_bf16 v[68:71], a[200:203], v[228:231], v[68:71]
    ds_read_b128 v[228:231], v253 offset:5216
    v_lshlrev_b32 v249, 16, v220
    v_mfma_f32_16x16x32_bf16 v[68:71], a[212:215], v[232:235], v[68:71]
    buffer_load_dwordx2 v[202:203], v203, s[4:7], s21 offen offset:256
    v_mfma_f32_16x16x32_bf16 v[68:71], a[224:227], v[236:239], v[68:71]
    ds_write_b64 v206, v[210:211] offset:12736
    v_mfma_f32_16x16x32_bf16 v[72:75], a[192:195], v[232:235], v[72:75]
    v_lshlrev_b32 v250, 16, v222
    v_lshlrev_b32 v251, 16, v224
    v_mfma_f32_16x16x32_bf16 v[72:75], a[204:207], v[236:239], v[72:75]
    s_waitcnt lgkmcnt(1)
    v_and_b32 v218, s22, v218
    v_and_b32 v220, s22, v220
    v_mfma_f32_16x16x32_bf16 v[72:75], a[216:219], v[228:231], v[72:75]
    ds_write_b64 v206, v[204:205] offset:18976
    v_mfma_f32_16x16x32_bf16 v[76:79], a[220:223], v[228:231], v[76:79]
    v_and_b32 v222, s22, v222
    v_and_b32 v224, s22, v224
    v_mfma_f32_16x16x32_bf16 v[76:79], a[208:211], v[236:239], v[76:79]
    ds_write_b64 v206, v[214:215] offset:27296
    v_mfma_f32_16x16x32_bf16 v[76:79], a[196:199], v[232:235], v[76:79]
    v_lshlrev_b32 v252, 16, v216
    v_and_b32 v216, s22, v216
    v_mfma_f32_16x16x32_bf16 v[80:83], a[200:203], v[232:235], v[80:83]
    ds_read_b128 v[232:235], v253 offset:4944
    v_fmac_f32 v252, s25, v251
    v_mfma_f32_16x16x32_bf16 v[80:83], a[212:215], v[236:239], v[80:83]
    ds_write_b64 v206, v[208:209] offset:31456
    v_mfma_f32_16x16x32_bf16 v[80:83], a[224:227], v[228:231], v[80:83]
    s_mov_b32 s42, 442368
    v_fmac_f32 v216, s25, v224
    v_fmac_f32 v252, s28, v249
    v_mfma_f32_16x16x32_bf16 v[84:87], a[192:195], v[236:239], v[84:87]
    v_fmac_f32 v216, s28, v220
    v_cvt_pk_bf16_f32 v216, v252, v216
    v_mfma_f32_16x16x32_bf16 v[88:91], a[196:199], v[236:239], v[88:91]
    v_lshlrev_b32 v252, 16, v226
    v_and_b32 v226, s22, v226
    v_mfma_f32_16x16x32_bf16 v[92:95], a[200:203], v[236:239], v[92:95]
    ds_read_b128 v[236:239], v253 offset:7280
    v_fmac_f32 v252, s29, v248
    v_mfma_f32_16x16x32_bf16 v[92:95], a[212:215], v[228:231], v[92:95]
    buffer_load_dwordx4 a[192:195], v254, s[8:11], s42 offen offset:0 sc1
    v_mfma_f32_16x16x32_bf16 v[88:91], a[208:211], v[228:231], v[88:91]
    s_waitcnt lgkmcnt(2)
    v_fmac_f32 v226, s29, v218
    v_fmac_f32 v252, s23, v250
    v_mfma_f32_16x16x32_bf16 v[84:87], a[204:207], v[228:231], v[84:87]
    ds_read_b128 v[228:231], v253 offset:7008
    v_fmac_f32 v226, s23, v222
    v_mfma_f32_16x16x32_bf16 v[84:87], a[216:219], v[232:235], v[84:87]
    buffer_load_dwordx4 a[196:199], v254, s[8:11], s42 offen offset:1024 sc1
    v_mfma_f32_16x16x32_bf16 v[88:91], a[220:223], v[232:235], v[88:91]
    s_waitcnt vmcnt(14) lgkmcnt(1)
    v_cvt_pk_bf16_f32 v226, v252, v226
    v_fma_f32 v252, v249, s24, v251
    v_mfma_f32_16x16x32_bf16 v[92:95], a[224:227], v[232:235], v[92:95]
    ds_read_b128 v[232:235], v253 offset:6752
    v_fmac_f32 v251, -4.0, v249
sub11:
    v_mfma_f32_16x16x32_bf16 v[96:99], a[228:231], v[236:239], v[96:99]
    buffer_load_dwordx4 a[200:203], v254, s[8:11], s42 offen offset:2048 sc1
    v_mfma_f32_16x16x32_bf16 v[100:103], a[232:235], v[236:239], v[100:103]
    s_mov_b32 s42, 445440
    v_fma_f32 v249, v248, s24, v250
    v_fmac_f32 v250, -4.0, v248
    v_mfma_f32_16x16x32_bf16 v[104:107], a[236:239], v[236:239], v[104:107]
    ds_read_b128 v[236:239], v253 offset:6496
    s_waitcnt vmcnt(12)
    s_waitcnt lgkmcnt(2)
    v_mfma_f32_16x16x32_bf16 v[104:107], a[248:251], v[228:231], v[104:107]
    v_fma_f32 v248, v250, s26, v251
    v_fmac_f32 v251, s27, v250
    v_mfma_f32_16x16x32_bf16 v[100:103], a[244:247], v[228:231], v[100:103]
    buffer_load_dwordx4 a[204:207], v254, s[8:11], s42 offen offset:0 sc1
    v_mfma_f32_16x16x32_bf16 v[96:99], a[240:243], v[228:231], v[96:99]
    s_waitcnt vmcnt(10) lgkmcnt(1)
    v_fma_f32 v250, v249, 2.0, v252
    v_fmac_f32 v252, -2.0, v249
    v_mfma_f32_16x16x32_bf16 v[96:99], a[252:255], v[232:235], v[96:99]
    v_fma_f32 v249, v220, s24, v224
    v_fmac_f32 v224, -4.0, v220
    v_mfma_f32_16x16x32_bf16 v[100:103], v[240:243], v[232:235], v[100:103]
    v_fma_f32 v220, v218, s24, v222
    v_fmac_f32 v222, -4.0, v218
    v_fma_f32 v218, v222, s26, v224
    v_mfma_f32_16x16x32_bf16 v[104:107], v[244:247], v[232:235], v[104:107]
    buffer_load_dwordx4 a[208:211], v254, s[8:11], s42 offen offset:1024 sc1
    v_mfma_f32_16x16x32_bf16 v[108:111], a[228:231], v[228:231], v[108:111]
    v_fmac_f32 v224, s27, v222
    v_fma_f32 v222, v220, 2.0, v249
    v_mfma_f32_16x16x32_bf16 v[108:111], a[240:243], v[232:235], v[108:111]
    s_waitcnt lgkmcnt(0)
    v_fmac_f32 v249, -2.0, v220
    v_cvt_pk_bf16_f32 v218, v248, v218
    v_mfma_f32_16x16x32_bf16 v[108:111], a[252:255], v[236:239], v[108:111]
    v_cvt_pk_bf16_f32 v224, v251, v224
    v_cvt_pk_bf16_f32 v222, v250, v222
    v_mfma_f32_16x16x32_bf16 v[112:115], v[240:243], v[236:239], v[112:115]
    buffer_load_dwordx4 a[212:215], v254, s[8:11], s42 offen offset:2048 sc1
    v_mfma_f32_16x16x32_bf16 v[112:115], a[244:247], v[232:235], v[112:115]
    s_mov_b32 s42, 448512
    v_cvt_pk_bf16_f32 v220, v252, v249
    v_lshlrev_b32 v248, 16, v219
    v_mfma_f32_16x16x32_bf16 v[112:115], a[232:235], v[228:231], v[112:115]
    v_lshlrev_b32 v249, 16, v221
    v_lshlrev_b32 v250, 16, v223
    v_mfma_f32_16x16x32_bf16 v[116:119], a[236:239], v[228:231], v[116:119]
    ds_read_b128 v[228:231], v253 offset:6240
    v_lshlrev_b32 v251, 16, v225
    v_mfma_f32_16x16x32_bf16 v[116:119], a[248:251], v[232:235], v[116:119]
    buffer_load_dwordx4 a[216:219], v254, s[8:11], s42 offen offset:0 sc1
    v_mfma_f32_16x16x32_bf16 v[116:119], v[244:247], v[236:239], v[116:119]
    v_and_b32 v219, s22, v219
    v_and_b32 v221, s22, v221
    v_mfma_f32_16x16x32_bf16 v[120:123], a[228:231], v[232:235], v[120:123]
    v_and_b32 v223, s22, v223
    v_and_b32 v225, s22, v225
    v_mfma_f32_16x16x32_bf16 v[120:123], a[240:243], v[236:239], v[120:123]
    s_waitcnt lgkmcnt(0)
    v_lshlrev_b32 v252, 16, v217
    v_and_b32 v217, s22, v217
    v_mfma_f32_16x16x32_bf16 v[120:123], a[252:255], v[228:231], v[120:123]
    v_fmac_f32 v252, s25, v251
    v_fmac_f32 v217, s25, v225
    v_mfma_f32_16x16x32_bf16 v[124:127], v[240:243], v[228:231], v[124:127]
    buffer_load_dwordx4 a[220:223], v254, s[8:11], s42 offen offset:1024 sc1
    v_mfma_f32_16x16x32_bf16 v[124:127], a[244:247], v[236:239], v[124:127]
    v_fmac_f32 v252, s28, v249
    v_fmac_f32 v217, s28, v221
    v_mfma_f32_16x16x32_bf16 v[124:127], a[232:235], v[232:235], v[124:127]
    v_cvt_pk_bf16_f32 v217, v252, v217
    v_lshlrev_b32 v252, 16, v227
    v_mfma_f32_16x16x32_bf16 v[128:131], a[236:239], v[232:235], v[128:131]
    ds_read_b128 v[232:235], v253 offset:8064
    v_and_b32 v227, s22, v227
    v_mfma_f32_16x16x32_bf16 v[128:131], a[248:251], v[236:239], v[128:131]
    buffer_load_dwordx4 a[224:227], v254, s[8:11], s42 offen offset:2048 sc1
    v_mfma_f32_16x16x32_bf16 v[128:131], v[244:247], v[228:231], v[128:131]
    v_fmac_f32 v252, s29, v248
    v_fmac_f32 v227, s29, v219
    v_mfma_f32_16x16x32_bf16 v[132:135], a[228:231], v[236:239], v[132:135]
    v_and_b32 v215, 0x7fff, v255
    v_fmac_f32 v252, s23, v250
    v_mfma_f32_16x16x32_bf16 v[132:135], a[240:243], v[228:231], v[132:135]
    s_waitcnt lgkmcnt(0)
    v_fmac_f32 v227, s23, v223
    v_cvt_pk_bf16_f32 v227, v252, v227
    v_mfma_f32_16x16x32_bf16 v[132:135], a[252:255], v[232:235], v[132:135]
    buffer_load_dwordx2 v[204:205], v215, s[4:7], s16 offen offset:640
    v_mfma_f32_16x16x32_bf16 v[136:139], v[240:243], v[232:235], v[136:139]
    v_fma_f32 v252, v249, s24, v251
    v_fmac_f32 v251, -4.0, v249
    v_mfma_f32_16x16x32_bf16 v[136:139], a[244:247], v[228:231], v[136:139]
    v_fma_f32 v249, v248, s24, v250
    v_fmac_f32 v250, -4.0, v248
    v_mfma_f32_16x16x32_bf16 v[136:139], a[232:235], v[236:239], v[136:139]
    v_fma_f32 v248, v250, s26, v251
    v_fmac_f32 v251, s27, v250
    v_mfma_f32_16x16x32_bf16 v[140:143], a[236:239], v[236:239], v[140:143]
    ds_read_b128 v[236:239], v253 offset:7808
    v_fma_f32 v250, v249, 2.0, v252
    v_mfma_f32_16x16x32_bf16 v[140:143], a[248:251], v[228:231], v[140:143]
    buffer_load_dwordx2 v[206:207], v215, s[4:7], s17 offen offset:640
    v_mfma_f32_16x16x32_bf16 v[140:143], v[244:247], v[232:235], v[140:143]
    v_fmac_f32 v252, -2.0, v249
    v_fma_f32 v249, v221, s24, v225
    v_mfma_f32_16x16x32_bf16 v[144:147], a[228:231], v[228:231], v[144:147]
    v_fmac_f32 v225, -4.0, v221
    v_fma_f32 v221, v219, s24, v223
    v_mfma_f32_16x16x32_bf16 v[144:147], a[240:243], v[232:235], v[144:147]
    s_waitcnt lgkmcnt(0)
    v_fmac_f32 v223, -4.0, v219
    v_fma_f32 v219, v223, s26, v225
    v_mfma_f32_16x16x32_bf16 v[144:147], a[252:255], v[236:239], v[144:147]
    buffer_load_dwordx2 v[208:209], v215, s[4:7], s18 offen offset:640
    v_mfma_f32_16x16x32_bf16 v[148:151], v[240:243], v[236:239], v[148:151]
    v_fmac_f32 v225, s27, v223
    v_fma_f32 v223, v221, 2.0, v249
    v_mfma_f32_16x16x32_bf16 v[148:151], a[244:247], v[232:235], v[148:151]
    v_fmac_f32 v249, -2.0, v221
    v_cvt_pk_bf16_f32 v219, v248, v219
    v_mfma_f32_16x16x32_bf16 v[148:151], a[232:235], v[228:231], v[148:151]
    v_cvt_pk_bf16_f32 v225, v251, v225
    v_cvt_pk_bf16_f32 v223, v250, v223
    v_mfma_f32_16x16x32_bf16 v[152:155], a[236:239], v[228:231], v[152:155]
    ds_read_b128 v[228:231], v253 offset:7552
    v_cvt_pk_bf16_f32 v221, v252, v249
    v_mfma_f32_16x16x32_bf16 v[152:155], a[248:251], v[232:235], v[152:155]
    buffer_load_dwordx2 v[210:211], v215, s[4:7], s19 offen offset:640
    v_mfma_f32_16x16x32_bf16 v[152:155], v[244:247], v[236:239], v[152:155]
    v_lshrrev_b32 v252, 15, v255
    v_mfma_f32_16x16x32_bf16 v[156:159], a[228:231], v[232:235], v[156:159]
    ds_write_b64 v252, v[218:219] offset:8320
    v_mfma_f32_16x16x32_bf16 v[156:159], a[240:243], v[236:239], v[156:159]
    s_waitcnt lgkmcnt(1)
    v_lshrrev_b32 v218, 15, v255
    s_waitcnt vmcnt(13)
    v_mfma_f32_16x16x32_bf16 v[156:159], a[252:255], v[228:231], v[156:159]
    buffer_load_dwordx2 v[212:213], v215, s[4:7], s20 offen offset:640
    v_lshlrev_b32 v248, 16, v194
    v_mfma_f32_16x16x32_bf16 v[160:163], v[240:243], v[228:231], v[160:163]
    ds_write_b64 v218, v[224:225] offset:10400
    v_mfma_f32_16x16x32_bf16 v[160:163], a[244:247], v[236:239], v[160:163]
pad4:
    s_cbranch_vccnz pad8
    v_lshlrev_b32 v249, 16, v196
    v_lshlrev_b32 v250, 16, v198
    v_mfma_f32_16x16x32_bf16 v[160:163], a[232:235], v[232:235], v[160:163]
    ds_write_b64 v218, v[222:223] offset:12480
    v_mfma_f32_16x16x32_bf16 v[164:167], a[236:239], v[232:235], v[164:167]
    ds_read_b128 v[232:235], v253 offset:7296
    v_lshlrev_b32 v251, 16, v200
    v_mfma_f32_16x16x32_bf16 v[164:167], a[248:251], v[236:239], v[164:167]
    buffer_load_dwordx2 v[214:215], v215, s[4:7], s21 offen offset:640
    v_mfma_f32_16x16x32_bf16 v[164:167], v[244:247], v[228:231], v[164:167]
    ds_write_b64 v218, v[216:217] offset:18720
    v_mfma_f32_16x16x32_bf16 v[168:171], a[228:231], v[236:239], v[168:171]
    v_and_b32 v194, s22, v194
    v_and_b32 v196, s22, v196
    v_mfma_f32_16x16x32_bf16 v[168:171], a[240:243], v[228:231], v[168:171]
    s_waitcnt lgkmcnt(1)
    v_and_b32 v198, s22, v198
    v_and_b32 v200, s22, v200
    v_mfma_f32_16x16x32_bf16 v[168:171], a[252:255], v[232:235], v[168:171]
    ds_write_b64 v218, v[226:227] offset:27040
    v_mfma_f32_16x16x32_bf16 v[172:175], v[240:243], v[232:235], v[172:175]
    v_lshlrev_b32 v252, 16, v192
    v_and_b32 v192, s22, v192
    v_mfma_f32_16x16x32_bf16 v[172:175], a[244:247], v[228:231], v[172:175]
    ds_write_b64 v218, v[220:221] offset:31200
    v_mfma_f32_16x16x32_bf16 v[172:175], a[232:235], v[236:239], v[172:175]
    v_fmac_f32 v252, s25, v251
    v_fmac_f32 v192, s25, v200
    v_mfma_f32_16x16x32_bf16 v[176:179], a[236:239], v[236:239], v[176:179]
    ds_read_b128 v[236:239], v253 offset:7024
    v_fmac_f32 v252, s28, v249
    v_mfma_f32_16x16x32_bf16 v[176:179], a[248:251], v[228:231], v[176:179]
    v_fmac_f32 v192, s28, v196
    v_cvt_pk_bf16_f32 v192, v252, v192
    v_mfma_f32_16x16x32_bf16 v[176:179], v[244:247], v[232:235], v[176:179]
    s_mov_b32 s42, 479232
    v_lshlrev_b32 v252, 16, v202
    v_and_b32 v202, s22, v202
    v_mfma_f32_16x16x32_bf16 v[180:183], a[228:231], v[228:231], v[180:183]
    s_waitcnt lgkmcnt(0)
    v_fmac_f32 v252, s29, v248
    v_fmac_f32 v202, s29, v194
    v_mfma_f32_16x16x32_bf16 v[184:187], a[232:235], v[228:231], v[184:187]
    s_barrier
    v_mfma_f32_16x16x32_bf16 v[188:191], a[236:239], v[228:231], v[188:191]
    ds_read_b128 v[228:231], v253 offset:9360
    v_fmac_f32 v252, s23, v250
    v_mfma_f32_16x16x32_bf16 v[188:191], a[248:251], v[232:235], v[188:191]
    buffer_load_dwordx4 a[228:231], v254, s[8:11], s42 offen offset:0 sc1
    v_mfma_f32_16x16x32_bf16 v[184:187], a[244:247], v[232:235], v[184:187]
    v_fmac_f32 v202, s23, v198
    v_cvt_pk_bf16_f32 v202, v252, v202
    v_mfma_f32_16x16x32_bf16 v[180:183], a[240:243], v[232:235], v[180:183]
    ds_read_b128 v[232:235], v253 offset:9088
    v_fma_f32 v252, v249, s24, v251
    v_mfma_f32_16x16x32_bf16 v[180:183], a[252:255], v[236:239], v[180:183]
    buffer_load_dwordx4 a[232:235], v254, s[8:11], s42 offen offset:1024 sc1
    v_mfma_f32_16x16x32_bf16 v[184:187], v[240:243], v[236:239], v[184:187]
    s_waitcnt vmcnt(14) lgkmcnt(1)
    v_fmac_f32 v251, -4.0, v249
    v_fma_f32 v249, v248, s24, v250
    v_mfma_f32_16x16x32_bf16 v[188:191], v[244:247], v[236:239], v[188:191]
    ds_read_b128 v[236:239], v253 offset:8832
    v_fmac_f32 v250, -4.0, v248
sub12:
    v_mfma_f32_16x16x32_bf16 a[0:3], a[192:195], v[228:231], a[0:3]
    buffer_load_dwordx4 a[236:239], v254, s[8:11], s42 offen offset:2048 sc1
    v_mfma_f32_16x16x32_bf16 a[4:7], a[196:199], v[228:231], a[4:7]
    s_mov_b32 s42, 482304
    v_fma_f32 v248, v250, s26, v251
    v_fmac_f32 v251, s27, v250
    v_mfma_f32_16x16x32_bf16 a[8:11], a[200:203], v[228:231], a[8:11]
    ds_read_b128 v[228:231], v253 offset:8576
    s_waitcnt vmcnt(12)
    s_waitcnt lgkmcnt(2)
    v_mfma_f32_16x16x32_bf16 a[8:11], a[212:215], v[232:235], a[8:11]
    v_fma_f32 v250, v249, 2.0, v252
    v_fmac_f32 v252, -2.0, v249
    v_mfma_f32_16x16x32_bf16 a[4:7], a[208:211], v[232:235], a[4:7]
    buffer_load_dwordx4 a[240:243], v254, s[8:11], s42 offen offset:0 sc1
    v_mfma_f32_16x16x32_bf16 a[0:3], a[204:207], v[232:235], a[0:3]
    s_waitcnt vmcnt(10) lgkmcnt(1)
    v_fma_f32 v249, v196, s24, v200
    v_fmac_f32 v200, -4.0, v196
    v_mfma_f32_16x16x32_bf16 a[0:3], a[216:219], v[236:239], a[0:3]
    v_fma_f32 v196, v194, s24, v198
    v_fmac_f32 v198, -4.0, v194
    v_mfma_f32_16x16x32_bf16 a[4:7], a[220:223], v[236:239], a[4:7]
    v_fma_f32 v194, v198, s26, v200
    v_fmac_f32 v200, s27, v198
    v_mfma_f32_16x16x32_bf16 a[8:11], a[224:227], v[236:239], a[8:11]
    buffer_load_dwordx4 a[244:247], v254, s[8:11], s42 offen offset:1024 sc1
    v_mfma_f32_16x16x32_bf16 a[12:15], a[192:195], v[232:235], a[12:15]
    v_fma_f32 v198, v196, 2.0, v249
    v_fmac_f32 v249, -2.0, v196
    v_mfma_f32_16x16x32_bf16 a[12:15], a[204:207], v[236:239], a[12:15]
    s_waitcnt lgkmcnt(0)
    v_cvt_pk_bf16_f32 v194, v248, v194
    v_cvt_pk_bf16_f32 v200, v251, v200
    v_mfma_f32_16x16x32_bf16 a[12:15], a[216:219], v[228:231], a[12:15]
    v_cvt_pk_bf16_f32 v198, v250, v198
    v_cvt_pk_bf16_f32 v196, v252, v249
    v_mfma_f32_16x16x32_bf16 a[16:19], a[220:223], v[228:231], a[16:19]
    buffer_load_dwordx4 a[248:251], v254, s[8:11], s42 offen offset:2048 sc1
    v_mfma_f32_16x16x32_bf16 a[16:19], a[208:211], v[236:239], a[16:19]
    s_mov_b32 s42, 485376
    v_lshlrev_b32 v248, 16, v195
    v_lshlrev_b32 v249, 16, v197
    v_mfma_f32_16x16x32_bf16 a[16:19], a[196:199], v[232:235], a[16:19]
    v_lshlrev_b32 v250, 16, v199
    v_lshlrev_b32 v251, 16, v201
    v_mfma_f32_16x16x32_bf16 a[20:23], a[200:203], v[232:235], a[20:23]
    ds_read_b128 v[232:235], v253 offset:8320
    v_and_b32 v195, s22, v195
    v_and_b32 v197, s22, v197
    v_mfma_f32_16x16x32_bf16 a[20:23], a[212:215], v[236:239], a[20:23]
    buffer_load_dwordx4 a[252:255], v254, s[8:11], s42 offen offset:0 sc1
    v_mfma_f32_16x16x32_bf16 a[20:23], a[224:227], v[228:231], a[20:23]
    v_and_b32 v199, s22, v199
    v_and_b32 v201, s22, v201
    v_mfma_f32_16x16x32_bf16 a[24:27], a[192:195], v[236:239], a[24:27]
    v_lshlrev_b32 v252, 16, v193
    v_and_b32 v193, s22, v193
    v_mfma_f32_16x16x32_bf16 a[24:27], a[204:207], v[228:231], a[24:27]
    s_waitcnt lgkmcnt(0)
    v_fmac_f32 v252, s25, v251
    v_fmac_f32 v193, s25, v201
    v_mfma_f32_16x16x32_bf16 a[24:27], a[216:219], v[232:235], a[24:27]
    v_fmac_f32 v252, s28, v249
    v_fmac_f32 v193, s28, v197
    v_mfma_f32_16x16x32_bf16 a[28:31], a[220:223], v[232:235], a[28:31]
    buffer_load_dwordx4 v[240:243], v254, s[8:11], s42 offen offset:1024 sc1
    v_mfma_f32_16x16x32_bf16 a[28:31], a[208:211], v[228:231], a[28:31]
    v_cvt_pk_bf16_f32 v193, v252, v193
    v_lshlrev_b32 v252, 16, v203
    v_mfma_f32_16x16x32_bf16 a[28:31], a[196:199], v[236:239], a[28:31]
    v_and_b32 v203, s22, v203
    v_fmac_f32 v252, s29, v248
    v_mfma_f32_16x16x32_bf16 a[32:35], a[200:203], v[236:239], a[32:35]
    ds_read_b128 v[236:239], v253 offset:10144
    v_fmac_f32 v203, s29, v195
    v_mfma_f32_16x16x32_bf16 a[32:35], a[212:215], v[228:231], a[32:35]
    buffer_load_dwordx4 v[244:247], v254, s[8:11], s42 offen offset:2048 sc1
    v_mfma_f32_16x16x32_bf16 a[32:35], a[224:227], v[232:235], a[32:35]
    v_fmac_f32 v252, s23, v250
    v_fmac_f32 v203, s23, v199
    v_mfma_f32_16x16x32_bf16 a[36:39], a[192:195], v[228:231], a[36:39]
    v_and_b32 v227, 0x7fff, v255
    v_cvt_pk_bf16_f32 v203, v252, v203
    v_mfma_f32_16x16x32_bf16 a[36:39], a[204:207], v[232:235], a[36:39]
    s_waitcnt lgkmcnt(0)
    v_fma_f32 v252, v249, s24, v251
    v_fmac_f32 v251, -4.0, v249
    v_mfma_f32_16x16x32_bf16 a[36:39], a[216:219], v[236:239], a[36:39]
    buffer_load_dwordx2 v[216:217], v227, s[4:7], s16 offen offset:1024
    v_mfma_f32_16x16x32_bf16 a[40:43], a[220:223], v[236:239], a[40:43]
    v_fma_f32 v249, v248, s24, v250
    v_fmac_f32 v250, -4.0, v248
    v_mfma_f32_16x16x32_bf16 a[40:43], a[208:211], v[232:235], a[40:43]
    v_fma_f32 v248, v250, s26, v251
    v_fmac_f32 v251, s27, v250
    v_mfma_f32_16x16x32_bf16 a[40:43], a[196:199], v[228:231], a[40:43]
    v_fma_f32 v250, v249, 2.0, v252
    v_fmac_f32 v252, -2.0, v249
    v_mfma_f32_16x16x32_bf16 a[44:47], a[200:203], v[228:231], a[44:47]
    ds_read_b128 v[228:231], v253 offset:9888
    v_fma_f32 v249, v197, s24, v201
    v_mfma_f32_16x16x32_bf16 a[44:47], a[212:215], v[232:235], a[44:47]
    buffer_load_dwordx2 v[218:219], v227, s[4:7], s17 offen offset:1024
    v_mfma_f32_16x16x32_bf16 a[44:47], a[224:227], v[236:239], a[44:47]
    v_fmac_f32 v201, -4.0, v197
    v_fma_f32 v197, v195, s24, v199
    v_mfma_f32_16x16x32_bf16 a[48:51], a[192:195], v[232:235], a[48:51]
    v_fmac_f32 v199, -4.0, v195
    v_fma_f32 v195, v199, s26, v201
    v_mfma_f32_16x16x32_bf16 a[48:51], a[204:207], v[236:239], a[48:51]
    s_waitcnt lgkmcnt(0)
    v_fmac_f32 v201, s27, v199
    v_fma_f32 v199, v197, 2.0, v249
    v_mfma_f32_16x16x32_bf16 a[48:51], a[216:219], v[228:231], a[48:51]
    buffer_load_dwordx2 v[220:221], v227, s[4:7], s18 offen offset:1024
    v_mfma_f32_16x16x32_bf16 a[52:55], a[220:223], v[228:231], a[52:55]
    v_fmac_f32 v249, -2.0, v197
    v_cvt_pk_bf16_f32 v195, v248, v195
    v_mfma_f32_16x16x32_bf16 a[52:55], a[208:211], v[236:239], a[52:55]
    v_cvt_pk_bf16_f32 v201, v251, v201
    v_cvt_pk_bf16_f32 v199, v250, v199
    v_mfma_f32_16x16x32_bf16 a[52:55], a[196:199], v[232:235], a[52:55]
    v_cvt_pk_bf16_f32 v197, v252, v249
    v_lshrrev_b32 v252, 15, v255
    v_mfma_f32_16x16x32_bf16 a[56:59], a[200:203], v[232:235], a[56:59]
    ds_read_b128 v[232:235], v253 offset:9632
    v_mfma_f32_16x16x32_bf16 a[56:59], a[212:215], v[236:239], a[56:59]
    buffer_load_dwordx2 v[222:223], v227, s[4:7], s19 offen offset:1024
    v_mfma_f32_16x16x32_bf16 a[56:59], a[224:227], v[228:231], a[56:59]
    ds_write_b64 v252, v[194:195] offset:768
    v_mfma_f32_16x16x32_bf16 a[60:63], a[192:195], v[236:239], a[60:63]
    v_lshrrev_b32 v194, 15, v255
    v_mfma_f32_16x16x32_bf16 a[60:63], a[204:207], v[228:231], a[60:63]
    s_waitcnt lgkmcnt(1)
    s_waitcnt vmcnt(13)
    v_lshlrev_b32 v248, 16, v206
    v_mfma_f32_16x16x32_bf16 a[60:63], a[216:219], v[232:235], a[60:63]
    buffer_load_dwordx2 v[224:225], v227, s[4:7], s20 offen offset:1024
    v_mfma_f32_16x16x32_bf16 a[64:67], a[220:223], v[232:235], a[64:67]
    ds_write_b64 v194, v[200:201] offset:2848
    v_mfma_f32_16x16x32_bf16 a[64:67], a[208:211], v[228:231], a[64:67]
    v_lshlrev_b32 v249, 16, v208
    v_lshlrev_b32 v250, 16, v210
    v_mfma_f32_16x16x32_bf16 a[64:67], a[196:199], v[236:239], a[64:67]
    ds_write_b64 v194, v[198:199] offset:4928
    v_mfma_f32_16x16x32_bf16 a[68:71], a[200:203], v[236:239], a[68:71]
    ds_read_b128 v[236:239], v253 offset:9376
    v_lshlrev_b32 v251, 16, v212
    v_mfma_f32_16x16x32_bf16 a[68:71], a[212:215], v[228:231], a[68:71]
    buffer_load_dwordx2 v[226:227], v227, s[4:7], s21 offen offset:1024
    v_mfma_f32_16x16x32_bf16 a[68:71], a[224:227], v[232:235], a[68:71]
    ds_write_b64 v194, v[192:193] offset:21568
    v_mfma_f32_16x16x32_bf16 a[72:75], a[192:195], v[228:231], a[72:75]
    v_and_b32 v206, s22, v206
    v_and_b32 v208, s22, v208
    v_mfma_f32_16x16x32_bf16 a[72:75], a[204:207], v[232:235], a[72:75]
    s_waitcnt lgkmcnt(1)
    v_and_b32 v210, s22, v210
    v_and_b32 v212, s22, v212
    v_lshlrev_b32 v252, 16, v204
    v_mfma_f32_16x16x32_bf16 a[72:75], a[216:219], v[236:239], a[72:75]
    ds_write_b64 v194, v[202:203] offset:29888
    v_mfma_f32_16x16x32_bf16 a[76:79], a[220:223], v[236:239], a[76:79]
    v_and_b32 v204, s22, v204
    v_fmac_f32 v252, s25, v251
    v_mfma_f32_16x16x32_bf16 a[76:79], a[208:211], v[232:235], a[76:79]
    ds_write_b64 v194, v[196:197] offset:7008
    v_mfma_f32_16x16x32_bf16 a[76:79], a[196:199], v[228:231], a[76:79]
    v_fmac_f32 v204, s25, v212
    v_fmac_f32 v252, s28, v249
    v_mfma_f32_16x16x32_bf16 a[80:83], a[200:203], v[228:231], a[80:83]
    ds_read_b128 v[228:231], v253 offset:9104
    v_fmac_f32 v204, s28, v208
    v_mfma_f32_16x16x32_bf16 a[80:83], a[212:215], v[232:235], a[80:83]
    v_cvt_pk_bf16_f32 v204, v252, v204
    v_lshlrev_b32 v252, 16, v214
    v_mfma_f32_16x16x32_bf16 a[80:83], a[224:227], v[236:239], a[80:83]
    s_mov_b32 s42, 516096
    v_and_b32 v214, s22, v214
    v_fmac_f32 v252, s29, v248
    v_mfma_f32_16x16x32_bf16 a[84:87], a[192:195], v[232:235], a[84:87]
    v_fmac_f32 v214, s29, v206
    v_fmac_f32 v252, s23, v250
    v_mfma_f32_16x16x32_bf16 a[88:91], a[196:199], v[232:235], a[88:91]
    v_fmac_f32 v214, s23, v210
    v_cvt_pk_bf16_f32 v214, v252, v214
    v_mfma_f32_16x16x32_bf16 a[92:95], a[200:203], v[232:235], a[92:95]
    ds_read_b128 v[232:235], v253 offset:11440
    v_fma_f32 v252, v249, s24, v251
    v_mfma_f32_16x16x32_bf16 a[92:95], a[212:215], v[236:239], a[92:95]
    buffer_load_dwordx4 a[192:195], v254, s[8:11], s42 offen offset:0 sc1
    v_mfma_f32_16x16x32_bf16 a[88:91], a[208:211], v[236:239], a[88:91]
    s_waitcnt lgkmcnt(1)
    v_fmac_f32 v251, -4.0, v249
    v_fma_f32 v249, v248, s24, v250
    v_mfma_f32_16x16x32_bf16 a[84:87], a[204:207], v[236:239], a[84:87]
    ds_read_b128 v[236:239], v253 offset:11168
    v_fmac_f32 v250, -4.0, v248
    v_mfma_f32_16x16x32_bf16 a[84:87], a[216:219], v[228:231], a[84:87]
    buffer_load_dwordx4 a[196:199], v254, s[8:11], s42 offen offset:1024 sc1
    v_mfma_f32_16x16x32_bf16 a[88:91], a[220:223], v[228:231], a[88:91]
    s_waitcnt vmcnt(14) lgkmcnt(1)
    v_fma_f32 v248, v250, s26, v251
    v_fmac_f32 v251, s27, v250
    v_mfma_f32_16x16x32_bf16 a[92:95], a[224:227], v[228:231], a[92:95]
    ds_read_b128 v[228:231], v253 offset:10912
    v_fma_f32 v250, v249, 2.0, v252
sub13:
    v_mfma_f32_16x16x32_bf16 a[96:99], a[228:231], v[232:235], a[96:99]
    buffer_load_dwordx4 a[200:203], v254, s[8:11], s42 offen offset:2048 sc1
    v_mfma_f32_16x16x32_bf16 a[100:103], a[232:235], v[232:235], a[100:103]
    s_mov_b32 s42, 519168
    v_fmac_f32 v252, -2.0, v249
    v_fma_f32 v249, v208, s24, v212
    v_mfma_f32_16x16x32_bf16 a[104:107], a[236:239], v[232:235], a[104:107]
    ds_read_b128 v[232:235], v253 offset:10656
    s_waitcnt vmcnt(12)
    s_waitcnt lgkmcnt(2)
    v_mfma_f32_16x16x32_bf16 a[104:107], a[248:251], v[236:239], a[104:107]
    v_fmac_f32 v212, -4.0, v208
    v_fma_f32 v208, v206, s24, v210
    v_mfma_f32_16x16x32_bf16 a[100:103], a[244:247], v[236:239], a[100:103]
    buffer_load_dwordx4 a[204:207], v254, s[8:11], s42 offen offset:0 sc1
    v_mfma_f32_16x16x32_bf16 a[96:99], a[240:243], v[236:239], a[96:99]
    s_waitcnt vmcnt(10) lgkmcnt(1)
    v_fmac_f32 v210, -4.0, v206
    v_fma_f32 v206, v210, s26, v212
    v_mfma_f32_16x16x32_bf16 a[96:99], a[252:255], v[228:231], a[96:99]
    v_fmac_f32 v212, s27, v210
    v_fma_f32 v210, v208, 2.0, v249
    v_mfma_f32_16x16x32_bf16 a[100:103], v[240:243], v[228:231], a[100:103]
    v_fmac_f32 v249, -2.0, v208
    v_cvt_pk_bf16_f32 v206, v248, v206
    v_mfma_f32_16x16x32_bf16 a[104:107], v[244:247], v[228:231], a[104:107]
    buffer_load_dwordx4 a[208:211], v254, s[8:11], s42 offen offset:1024 sc1
    v_mfma_f32_16x16x32_bf16 a[108:111], a[228:231], v[236:239], a[108:111]
    v_cvt_pk_bf16_f32 v212, v251, v212
    v_cvt_pk_bf16_f32 v210, v250, v210
    v_mfma_f32_16x16x32_bf16 a[108:111], a[240:243], v[228:231], a[108:111]
    s_waitcnt lgkmcnt(0)
    v_cvt_pk_bf16_f32 v208, v252, v249
    v_lshlrev_b32 v248, 16, v207
    v_mfma_f32_16x16x32_bf16 a[108:111], a[252:255], v[232:235], a[108:111]
    v_lshlrev_b32 v249, 16, v209
    v_lshlrev_b32 v250, 16, v211
    v_mfma_f32_16x16x32_bf16 a[112:115], v[240:243], v[232:235], a[112:115]
    buffer_load_dwordx4 a[212:215], v254, s[8:11], s42 offen offset:2048 sc1
    v_mfma_f32_16x16x32_bf16 a[112:115], a[244:247], v[228:231], a[112:115]
    s_mov_b32 s42, 522240
    v_lshlrev_b32 v251, 16, v213
    v_and_b32 v207, s22, v207
    v_mfma_f32_16x16x32_bf16 a[112:115], a[232:235], v[236:239], a[112:115]
    v_and_b32 v209, s22, v209
    v_and_b32 v211, s22, v211
    v_mfma_f32_16x16x32_bf16 a[116:119], a[236:239], v[236:239], a[116:119]
    ds_read_b128 v[236:239], v253 offset:10400
    v_and_b32 v213, s22, v213
    v_mfma_f32_16x16x32_bf16 a[116:119], a[248:251], v[228:231], a[116:119]
    buffer_load_dwordx4 a[216:219], v254, s[8:11], s42 offen offset:0 sc1
    v_mfma_f32_16x16x32_bf16 a[116:119], v[244:247], v[232:235], a[116:119]
    v_lshlrev_b32 v252, 16, v205
    v_and_b32 v205, s22, v205
    v_mfma_f32_16x16x32_bf16 a[120:123], a[228:231], v[228:231], a[120:123]
    v_fmac_f32 v252, s25, v251
    v_fmac_f32 v205, s25, v213
    v_mfma_f32_16x16x32_bf16 a[120:123], a[240:243], v[232:235], a[120:123]
    s_waitcnt lgkmcnt(0)
    v_fmac_f32 v252, s28, v249
    v_fmac_f32 v205, s28, v209
    v_mfma_f32_16x16x32_bf16 a[120:123], a[252:255], v[236:239], a[120:123]
    v_cvt_pk_bf16_f32 v205, v252, v205
    v_lshlrev_b32 v252, 16, v215
    v_mfma_f32_16x16x32_bf16 a[124:127], v[240:243], v[236:239], a[124:127]
    buffer_load_dwordx4 a[220:223], v254, s[8:11], s42 offen offset:1024 sc1
    v_mfma_f32_16x16x32_bf16 a[124:127], a[244:247], v[232:235], a[124:127]
    v_and_b32 v215, s22, v215
    v_fmac_f32 v252, s29, v248
    v_mfma_f32_16x16x32_bf16 a[124:127], a[232:235], v[228:231], a[124:127]
    v_fmac_f32 v215, s29, v207
    v_fmac_f32 v252, s23, v250
    v_fmac_f32 v215, s23, v211
    v_mfma_f32_16x16x32_bf16 a[128:131], a[236:239], v[228:231], a[128:131]
    ds_read_b128 v[228:231], v253 offset:12224
    v_cvt_pk_bf16_f32 v215, v252, v215
    v_mfma_f32_16x16x32_bf16 a[128:131], a[248:251], v[232:235], a[128:131]
    buffer_load_dwordx4 a[224:227], v254, s[8:11], s42 offen offset:2048 sc1
    v_mfma_f32_16x16x32_bf16 a[128:131], v[244:247], v[236:239], a[128:131]
    v_fma_f32 v252, v249, s24, v251
    v_fmac_f32 v251, -4.0, v249
    v_mfma_f32_16x16x32_bf16 a[132:135], a[228:231], v[232:235], a[132:135]
    v_and_b32 v203, 0x7fff, v255
    v_fma_f32 v249, v248, s24, v250
    v_mfma_f32_16x16x32_bf16 a[132:135], a[240:243], v[236:239], a[132:135]
    s_waitcnt lgkmcnt(0)
    v_fmac_f32 v250, -4.0, v248
    v_fma_f32 v248, v250, s26, v251
    v_mfma_f32_16x16x32_bf16 a[132:135], a[252:255], v[228:231], a[132:135]
    buffer_load_dwordx2 v[192:193], v203, s[4:7], s16 offen offset:1408
    v_mfma_f32_16x16x32_bf16 a[136:139], v[240:243], v[228:231], a[136:139]
    v_fmac_f32 v251, s27, v250
    v_fma_f32 v250, v249, 2.0, v252
    v_mfma_f32_16x16x32_bf16 a[136:139], a[244:247], v[236:239], a[136:139]
    v_fmac_f32 v252, -2.0, v249
    v_fma_f32 v249, v209, s24, v213
    v_mfma_f32_16x16x32_bf16 a[136:139], a[232:235], v[232:235], a[136:139]
    v_fmac_f32 v213, -4.0, v209
    v_fma_f32 v209, v207, s24, v211
    v_mfma_f32_16x16x32_bf16 a[140:143], a[236:239], v[232:235], a[140:143]
    ds_read_b128 v[232:235], v253 offset:11968
    v_fmac_f32 v211, -4.0, v207
    v_mfma_f32_16x16x32_bf16 a[140:143], a[248:251], v[236:239], a[140:143]
    buffer_load_dwordx2 v[194:195], v203, s[4:7], s17 offen offset:1408
    v_mfma_f32_16x16x32_bf16 a[140:143], v[244:247], v[228:231], a[140:143]
    v_fma_f32 v207, v211, s26, v213
    v_fmac_f32 v213, s27, v211
    v_mfma_f32_16x16x32_bf16 a[144:147], a[228:231], v[236:239], a[144:147]
    v_fma_f32 v211, v209, 2.0, v249
    v_fmac_f32 v249, -2.0, v209
    v_mfma_f32_16x16x32_bf16 a[144:147], a[240:243], v[228:231], a[144:147]
    s_waitcnt lgkmcnt(0)
    v_cvt_pk_bf16_f32 v207, v248, v207
    v_cvt_pk_bf16_f32 v213, v251, v213
    v_mfma_f32_16x16x32_bf16 a[144:147], a[252:255], v[232:235], a[144:147]
    buffer_load_dwordx2 v[196:197], v203, s[4:7], s18 offen offset:1408
    v_mfma_f32_16x16x32_bf16 a[148:151], v[240:243], v[232:235], a[148:151]
    v_cvt_pk_bf16_f32 v211, v250, v211
    v_cvt_pk_bf16_f32 v209, v252, v249
    v_mfma_f32_16x16x32_bf16 a[148:151], a[244:247], v[228:231], a[148:151]
    v_lshrrev_b32 v252, 15, v255
    v_mfma_f32_16x16x32_bf16 a[148:151], a[232:235], v[236:239], a[148:151]
    ds_write_b64 v252, v[206:207] offset:512
    v_mfma_f32_16x16x32_bf16 a[152:155], a[236:239], v[236:239], a[152:155]
    ds_read_b128 v[236:239], v253 offset:11712
    v_lshrrev_b32 v206, 15, v255
    v_mfma_f32_16x16x32_bf16 a[152:155], a[248:251], v[228:231], a[152:155]
    buffer_load_dwordx2 v[198:199], v203, s[4:7], s19 offen offset:1408
    v_mfma_f32_16x16x32_bf16 a[152:155], v[244:247], v[232:235], a[152:155]
    ds_write_b64 v206, v[212:213] offset:2592
    v_mfma_f32_16x16x32_bf16 a[156:159], a[228:231], v[228:231], a[156:159]
    v_mfma_f32_16x16x32_bf16 a[156:159], a[240:243], v[232:235], a[156:159]
    s_waitcnt lgkmcnt(1)
    s_waitcnt vmcnt(13)
    v_lshlrev_b32 v248, 16, v218
    v_mfma_f32_16x16x32_bf16 a[156:159], a[252:255], v[236:239], a[156:159]
    buffer_load_dwordx2 v[200:201], v203, s[4:7], s20 offen offset:1408
    v_mfma_f32_16x16x32_bf16 a[160:163], v[240:243], v[236:239], a[160:163]
    ds_write_b64 v206, v[210:211] offset:4672
    v_mfma_f32_16x16x32_bf16 a[160:163], a[244:247], v[232:235], a[160:163]
    v_lshlrev_b32 v249, 16, v220
    v_lshlrev_b32 v250, 16, v222
    v_mfma_f32_16x16x32_bf16 a[160:163], a[232:235], v[228:231], a[160:163]
    ds_write_b64 v206, v[204:205] offset:21312
    v_mfma_f32_16x16x32_bf16 a[164:167], a[236:239], v[228:231], a[164:167]
    ds_read_b128 v[228:231], v253 offset:11456
    v_lshlrev_b32 v251, 16, v224
    v_mfma_f32_16x16x32_bf16 a[164:167], a[248:251], v[232:235], a[164:167]
    buffer_load_dwordx2 v[202:203], v203, s[4:7], s21 offen offset:1408
    v_mfma_f32_16x16x32_bf16 a[164:167], v[244:247], v[236:239], a[164:167]
    ds_write_b64 v206, v[214:215] offset:29632
    v_mfma_f32_16x16x32_bf16 a[168:171], a[228:231], v[232:235], a[168:171]
    v_and_b32 v218, s22, v218
    v_and_b32 v220, s22, v220
    v_mfma_f32_16x16x32_bf16 a[168:171], a[240:243], v[236:239], a[168:171]
    s_waitcnt lgkmcnt(1)
    v_and_b32 v222, s22, v222
    v_and_b32 v224, s22, v224
    v_mfma_f32_16x16x32_bf16 a[168:171], a[252:255], v[228:231], a[168:171]
    ds_write_b64 v206, v[208:209] offset:6752
    v_mfma_f32_16x16x32_bf16 a[172:175], v[240:243], v[228:231], a[172:175]
    ds_read_b128 v[204:207], v253 offset:40288
    s_mov_b32 s45, 472974346
    v_mfma_f32_16x16x32_bf16 a[172:175], a[244:247], v[236:239], a[172:175]
    v_bfe_u32 v208, v254, 5, 3
    v_mul_u32_u24 v209, 5, v208
    v_mfma_f32_16x16x32_bf16 a[172:175], a[232:235], v[232:235], a[172:175]
    v_bfe_u32 v209, s45, v209, 5
    v_mul_u32_u24 v209, 65, v209
    v_mfma_f32_16x16x32_bf16 a[176:179], a[236:239], v[232:235], a[176:179]
    ds_read_b128 v[232:235], v253 offset:11184
    v_sub_u32 v209, v209, v208
    v_mfma_f32_16x16x32_bf16 a[176:179], a[248:251], v[236:239], a[176:179]
    v_lshl_add_u32 v208, v209, 5, v253
    s_waitcnt lgkmcnt(1)
    v_mfma_f32_16x16x32_bf16 a[176:179], v[244:247], v[228:231], a[176:179]
    s_mov_b32 s42, 552960
    v_lshlrev_b32 v252, 16, v216
    v_and_b32 v216, s22, v216
    v_mfma_f32_16x16x32_bf16 a[180:183], a[228:231], v[236:239], a[180:183]
    s_mov_b64 exec, s[46:47]
    ds_write_b128 v208, v[204:207] offset:1024
    s_mov_b64 exec, -1
    v_fmac_f32 v252, s25, v251
    v_mfma_f32_16x16x32_bf16 a[184:187], a[232:235], v[236:239], a[184:187]
    v_fmac_f32 v216, s25, v224
    v_fmac_f32 v252, s28, v249
    v_mfma_f32_16x16x32_bf16 a[188:191], a[236:239], v[236:239], a[188:191]
    ds_read_b128 v[236:239], v253 offset:13520
    v_fmac_f32 v216, s28, v220
    v_mfma_f32_16x16x32_bf16 a[188:191], a[248:251], v[228:231], a[188:191]
    buffer_load_dwordx4 a[228:231], v254, s[8:11], s42 offen offset:0 sc1
    v_mfma_f32_16x16x32_bf16 a[184:187], a[244:247], v[228:231], a[184:187]
    s_waitcnt lgkmcnt(2)
    v_cvt_pk_bf16_f32 v216, v252, v216
    v_lshlrev_b32 v252, 16, v226
    v_mfma_f32_16x16x32_bf16 a[180:183], a[240:243], v[228:231], a[180:183]
    ds_read_b128 v[228:231], v253 offset:13248
    v_and_b32 v226, s22, v226
    v_mfma_f32_16x16x32_bf16 a[180:183], a[252:255], v[232:235], a[180:183]
    buffer_load_dwordx4 a[232:235], v254, s[8:11], s42 offen offset:1024 sc1
    v_mfma_f32_16x16x32_bf16 a[184:187], v[240:243], v[232:235], a[184:187]
    s_waitcnt vmcnt(14) lgkmcnt(1)
    v_fmac_f32 v252, s29, v248
    v_fmac_f32 v226, s29, v218
    v_mfma_f32_16x16x32_bf16 a[188:191], v[244:247], v[232:235], a[188:191]
    ds_read_b128 v[232:235], v253 offset:12992
    v_fmac_f32 v252, s23, v250
sub14:
    v_mfma_f32_16x16x32_bf16 v[0:3], a[192:195], v[236:239], v[0:3]
    buffer_load_dwordx4 a[236:239], v254, s[8:11], s42 offen offset:2048 sc1
    v_mfma_f32_16x16x32_bf16 v[4:7], a[196:199], v[236:239], v[4:7]
    s_mov_b32 s42, 556032
    v_fmac_f32 v226, s23, v222
    v_cvt_pk_bf16_f32 v226, v252, v226
    v_mfma_f32_16x16x32_bf16 v[8:11], a[200:203], v[236:239], v[8:11]
    ds_read_b128 v[236:239], v253 offset:12736
    s_waitcnt vmcnt(12)
    s_waitcnt lgkmcnt(2)
    v_mfma_f32_16x16x32_bf16 v[8:11], a[212:215], v[228:231], v[8:11]
    v_fma_f32 v252, v249, s24, v251
    v_fmac_f32 v251, -4.0, v249
    v_mfma_f32_16x16x32_bf16 v[4:7], a[208:211], v[228:231], v[4:7]
    buffer_load_dwordx4 a[240:243], v254, s[8:11], s42 offen offset:0 sc1
    v_mfma_f32_16x16x32_bf16 v[0:3], a[204:207], v[228:231], v[0:3]
    s_waitcnt vmcnt(10) lgkmcnt(1)
    v_fma_f32 v249, v248, s24, v250
    v_fmac_f32 v250, -4.0, v248
    v_mfma_f32_16x16x32_bf16 v[0:3], a[216:219], v[232:235], v[0:3]
    v_fma_f32 v248, v250, s26, v251
    v_fmac_f32 v251, s27, v250
    v_mfma_f32_16x16x32_bf16 v[4:7], a[220:223], v[232:235], v[4:7]
    v_fma_f32 v250, v249, 2.0, v252
    v_fmac_f32 v252, -2.0, v249
    v_mfma_f32_16x16x32_bf16 v[8:11], a[224:227], v[232:235], v[8:11]
    buffer_load_dwordx4 a[244:247], v254, s[8:11], s42 offen offset:1024 sc1
    v_mfma_f32_16x16x32_bf16 v[12:15], a[192:195], v[228:231], v[12:15]
    v_fma_f32 v249, v220, s24, v224
    v_fmac_f32 v224, -4.0, v220
    v_mfma_f32_16x16x32_bf16 v[12:15], a[204:207], v[232:235], v[12:15]
    s_waitcnt lgkmcnt(0)
    v_fma_f32 v220, v218, s24, v222
    v_fmac_f32 v222, -4.0, v218
    v_mfma_f32_16x16x32_bf16 v[12:15], a[216:219], v[236:239], v[12:15]
    v_fma_f32 v218, v222, s26, v224
    v_fmac_f32 v224, s27, v222
    v_mfma_f32_16x16x32_bf16 v[16:19], a[220:223], v[236:239], v[16:19]
    buffer_load_dwordx4 a[248:251], v254, s[8:11], s42 offen offset:2048 sc1
    v_mfma_f32_16x16x32_bf16 v[16:19], a[208:211], v[232:235], v[16:19]
    s_mov_b32 s42, 559104
    v_fma_f32 v222, v220, 2.0, v249
    v_fmac_f32 v249, -2.0, v220
    v_mfma_f32_16x16x32_bf16 v[16:19], a[196:199], v[228:231], v[16:19]
    v_cvt_pk_bf16_f32 v218, v248, v218
    v_cvt_pk_bf16_f32 v224, v251, v224
    v_mfma_f32_16x16x32_bf16 v[20:23], a[200:203], v[228:231], v[20:23]
    ds_read_b128 v[228:231], v253 offset:12480
    v_cvt_pk_bf16_f32 v222, v250, v222
    v_mfma_f32_16x16x32_bf16 v[20:23], a[212:215], v[232:235], v[20:23]
    buffer_load_dwordx4 a[252:255], v254, s[8:11], s42 offen offset:0 sc1
    v_mfma_f32_16x16x32_bf16 v[20:23], a[224:227], v[236:239], v[20:23]
    v_cvt_pk_bf16_f32 v220, v252, v249
    v_lshlrev_b32 v248, 16, v219
    v_mfma_f32_16x16x32_bf16 v[24:27], a[192:195], v[232:235], v[24:27]
    v_lshlrev_b32 v249, 16, v221
    v_lshlrev_b32 v250, 16, v223
    v_mfma_f32_16x16x32_bf16 v[24:27], a[204:207], v[236:239], v[24:27]
    s_waitcnt lgkmcnt(0)
    v_lshlrev_b32 v251, 16, v225
    v_and_b32 v219, s22, v219
    v_mfma_f32_16x16x32_bf16 v[24:27], a[216:219], v[228:231], v[24:27]
    v_and_b32 v221, s22, v221
    v_and_b32 v223, s22, v223
    v_mfma_f32_16x16x32_bf16 v[28:31], a[220:223], v[228:231], v[28:31]
    buffer_load_dwordx4 v[240:243], v254, s[8:11], s42 offen offset:1024 sc1
    v_mfma_f32_16x16x32_bf16 v[28:31], a[208:211], v[236:239], v[28:31]
    v_and_b32 v225, s22, v225
    v_lshlrev_b32 v252, 16, v217
    v_mfma_f32_16x16x32_bf16 v[28:31], a[196:199], v[232:235], v[28:31]
    v_and_b32 v217, s22, v217
    v_fmac_f32 v252, s25, v251
    v_mfma_f32_16x16x32_bf16 v[32:35], a[200:203], v[232:235], v[32:35]
    ds_read_b128 v[232:235], v253 offset:14304
    v_fmac_f32 v217, s25, v225
    v_mfma_f32_16x16x32_bf16 v[32:35], a[212:215], v[236:239], v[32:35]
    buffer_load_dwordx4 v[244:247], v254, s[8:11], s42 offen offset:2048 sc1
    v_mfma_f32_16x16x32_bf16 v[32:35], a[224:227], v[228:231], v[32:35]
    v_fmac_f32 v252, s28, v249
    v_fmac_f32 v217, s28, v221
    v_mfma_f32_16x16x32_bf16 v[36:39], a[192:195], v[236:239], v[36:39]
    v_and_b32 v215, 0x7fff, v255
    v_cvt_pk_bf16_f32 v217, v252, v217
    v_mfma_f32_16x16x32_bf16 v[36:39], a[204:207], v[228:231], v[36:39]
    s_waitcnt lgkmcnt(0)
    v_lshlrev_b32 v252, 16, v227
    v_and_b32 v227, s22, v227
    v_mfma_f32_16x16x32_bf16 v[36:39], a[216:219], v[232:235], v[36:39]
    buffer_load_dwordx2 v[204:205], v215, s[4:7], s16 offen offset:320
    v_mfma_f32_16x16x32_bf16 v[40:43], a[220:223], v[232:235], v[40:43]
    v_fmac_f32 v252, s29, v248
    v_fmac_f32 v227, s29, v219
    v_mfma_f32_16x16x32_bf16 v[40:43], a[208:211], v[228:231], v[40:43]
    v_fmac_f32 v252, s23, v250
    v_fmac_f32 v227, s23, v223
    v_cvt_pk_bf16_f32 v227, v252, v227
    v_mfma_f32_16x16x32_bf16 v[40:43], a[196:199], v[236:239], v[40:43]
    v_fma_f32 v252, v249, s24, v251
    v_fmac_f32 v251, -4.0, v249
    v_mfma_f32_16x16x32_bf16 v[44:47], a[200:203], v[236:239], v[44:47]
    ds_read_b128 v[236:239], v253 offset:14048
    v_fma_f32 v249, v248, s24, v250
    v_mfma_f32_16x16x32_bf16 v[44:47], a[212:215], v[228:231], v[44:47]
    buffer_load_dwordx2 v[206:207], v215, s[4:7], s17 offen offset:320
    v_mfma_f32_16x16x32_bf16 v[44:47], a[224:227], v[232:235], v[44:47]
    v_fmac_f32 v250, -4.0, v248
    v_fma_f32 v248, v250, s26, v251
    v_mfma_f32_16x16x32_bf16 v[48:51], a[192:195], v[228:231], v[48:51]
    v_fmac_f32 v251, s27, v250
    v_fma_f32 v250, v249, 2.0, v252
    v_mfma_f32_16x16x32_bf16 v[48:51], a[204:207], v[232:235], v[48:51]
    s_waitcnt lgkmcnt(0)
    v_fmac_f32 v252, -2.0, v249
    v_fma_f32 v249, v221, s24, v225
    v_mfma_f32_16x16x32_bf16 v[48:51], a[216:219], v[236:239], v[48:51]
    buffer_load_dwordx2 v[208:209], v215, s[4:7], s18 offen offset:320
    v_mfma_f32_16x16x32_bf16 v[52:55], a[220:223], v[236:239], v[52:55]
    v_fmac_f32 v225, -4.0, v221
    v_fma_f32 v221, v219, s24, v223
    v_mfma_f32_16x16x32_bf16 v[52:55], a[208:211], v[232:235], v[52:55]
    v_fmac_f32 v223, -4.0, v219
    v_fma_f32 v219, v223, s26, v225
    v_mfma_f32_16x16x32_bf16 v[52:55], a[196:199], v[228:231], v[52:55]
    v_fmac_f32 v225, s27, v223
    v_fma_f32 v223, v221, 2.0, v249
    v_mfma_f32_16x16x32_bf16 v[56:59], a[200:203], v[228:231], v[56:59]
    ds_read_b128 v[228:231], v253 offset:13792
    v_fmac_f32 v249, -2.0, v221
    v_mfma_f32_16x16x32_bf16 v[56:59], a[212:215], v[232:235], v[56:59]
    buffer_load_dwordx2 v[210:211], v215, s[4:7], s19 offen offset:320
    v_mfma_f32_16x16x32_bf16 v[56:59], a[224:227], v[236:239], v[56:59]
    v_cvt_pk_bf16_f32 v219, v248, v219
    v_cvt_pk_bf16_f32 v225, v251, v225
    v_mfma_f32_16x16x32_bf16 v[60:63], a[192:195], v[232:235], v[60:63]
    v_cvt_pk_bf16_f32 v223, v250, v223
    v_cvt_pk_bf16_f32 v221, v252, v249
    v_mfma_f32_16x16x32_bf16 v[60:63], a[204:207], v[236:239], v[60:63]
pad5:
    s_cbranch_vccnz pad9
    s_waitcnt lgkmcnt(0)
    v_lshrrev_b32 v252, 15, v255
    v_mfma_f32_16x16x32_bf16 v[60:63], a[216:219], v[228:231], v[60:63]
    buffer_load_dwordx2 v[212:213], v215, s[4:7], s20 offen offset:320
    v_mfma_f32_16x16x32_bf16 v[64:67], a[220:223], v[228:231], v[64:67]
    ds_write_b64 v252, v[218:219] offset:256
    v_mfma_f32_16x16x32_bf16 v[64:67], a[208:211], v[236:239], v[64:67]
    s_waitcnt vmcnt(14)
    v_lshrrev_b32 v218, 15, v255
    v_lshlrev_b32 v248, 16, v194
    v_mfma_f32_16x16x32_bf16 v[64:67], a[196:199], v[232:235], v[64:67]
    ds_write_b64 v218, v[224:225] offset:2336
    v_mfma_f32_16x16x32_bf16 v[68:71], a[200:203], v[232:235], v[68:71]
    ds_read_b128 v[232:235], v253 offset:13536
    v_lshlrev_b32 v249, 16, v196
    v_mfma_f32_16x16x32_bf16 v[68:71], a[212:215], v[236:239], v[68:71]
    buffer_load_dwordx2 v[214:215], v215, s[4:7], s21 offen offset:320
    v_mfma_f32_16x16x32_bf16 v[68:71], a[224:227], v[228:231], v[68:71]
    ds_write_b64 v218, v[222:223] offset:4416
    v_mfma_f32_16x16x32_bf16 v[72:75], a[192:195], v[236:239], v[72:75]
    v_lshlrev_b32 v250, 16, v198
    v_lshlrev_b32 v251, 16, v200
    v_mfma_f32_16x16x32_bf16 v[72:75], a[204:207], v[228:231], v[72:75]
    s_waitcnt lgkmcnt(1)
    v_and_b32 v194, s22, v194
    v_and_b32 v196, s22, v196
    v_mfma_f32_16x16x32_bf16 v[72:75], a[216:219], v[232:235], v[72:75]
    ds_write_b64 v218, v[216:217] offset:21056
    v_mfma_f32_16x16x32_bf16 v[76:79], a[220:223], v[232:235], v[76:79]
    v_and_b32 v198, s22, v198
    v_and_b32 v200, s22, v200
    v_mfma_f32_16x16x32_bf16 v[76:79], a[208:211], v[228:231], v[76:79]
    ds_write_b64 v218, v[226:227] offset:29376
    v_mfma_f32_16x16x32_bf16 v[76:79], a[196:199], v[236:239], v[76:79]
    v_lshlrev_b32 v252, 16, v192
    v_and_b32 v192, s22, v192
    v_mfma_f32_16x16x32_bf16 v[80:83], a[200:203], v[236:239], v[80:83]
    ds_read_b128 v[236:239], v253 offset:13264
    v_fmac_f32 v252, s25, v251
    v_mfma_f32_16x16x32_bf16 v[80:83], a[212:215], v[228:231], v[80:83]
    ds_write_b64 v218, v[220:221] offset:6496
    v_mfma_f32_16x16x32_bf16 v[80:83], a[224:227], v[232:235], v[80:83]
    s_mov_b32 s42, 589824
    v_fmac_f32 v192, s25, v200
    v_fmac_f32 v252, s28, v249
    v_mfma_f32_16x16x32_bf16 v[84:87], a[192:195], v[228:231], v[84:87]
    v_fmac_f32 v192, s28, v196
    v_cvt_pk_bf16_f32 v192, v252, v192
    v_mfma_f32_16x16x32_bf16 v[88:91], a[196:199], v[228:231], v[88:91]
    v_lshlrev_b32 v252, 16, v202
    v_and_b32 v202, s22, v202
    v_mfma_f32_16x16x32_bf16 v[92:95], a[200:203], v[228:231], v[92:95]
    ds_read_b128 v[228:231], v253 offset:32240
    v_fmac_f32 v252, s29, v248
    v_mfma_f32_16x16x32_bf16 v[92:95], a[212:215], v[232:235], v[92:95]
    buffer_load_dwordx4 a[192:195], v254, s[8:11], s42 offen offset:0 sc1
    v_mfma_f32_16x16x32_bf16 v[88:91], a[208:211], v[232:235], v[88:91]
    s_waitcnt lgkmcnt(2)
    v_fmac_f32 v202, s29, v194
    v_fmac_f32 v252, s23, v250
    v_mfma_f32_16x16x32_bf16 v[84:87], a[204:207], v[232:235], v[84:87]
    ds_read_b128 v[232:235], v253 offset:31968
    v_fmac_f32 v202, s23, v198
    v_mfma_f32_16x16x32_bf16 v[84:87], a[216:219], v[236:239], v[84:87]
    buffer_load_dwordx4 a[196:199], v254, s[8:11], s42 offen offset:1024 sc1
    v_mfma_f32_16x16x32_bf16 v[88:91], a[220:223], v[236:239], v[88:91]
    s_waitcnt vmcnt(14) lgkmcnt(1)
    v_cvt_pk_bf16_f32 v202, v252, v202
    v_fma_f32 v252, v249, s24, v251
    v_mfma_f32_16x16x32_bf16 v[92:95], a[224:227], v[236:239], v[92:95]
    ds_read_b128 v[236:239], v253 offset:31712
    v_fmac_f32 v251, -4.0, v249
    v_fma_f32 v249, v248, s24, v250
sub15:
    v_mfma_f32_16x16x32_bf16 v[96:99], a[228:231], v[228:231], v[96:99]
    buffer_load_dwordx4 a[200:203], v254, s[8:11], s42 offen offset:2048 sc1
    v_mfma_f32_16x16x32_bf16 v[100:103], a[232:235], v[228:231], v[100:103]
    s_mov_b32 s42, 592896
    v_fmac_f32 v250, -4.0, v248
    v_fma_f32 v248, v250, s26, v251
    v_mfma_f32_16x16x32_bf16 v[104:107], a[236:239], v[228:231], v[104:107]
    ds_read_b128 v[228:231], v253 offset:31456
    s_waitcnt vmcnt(12)
    s_waitcnt lgkmcnt(2)
    v_mfma_f32_16x16x32_bf16 v[104:107], a[248:251], v[232:235], v[104:107]
    v_fmac_f32 v251, s27, v250
    v_fma_f32 v250, v249, 2.0, v252
    v_mfma_f32_16x16x32_bf16 v[100:103], a[244:247], v[232:235], v[100:103]
    buffer_load_dwordx4 a[204:207], v254, s[8:11], s42 offen offset:0 sc1
    v_mfma_f32_16x16x32_bf16 v[96:99], a[240:243], v[232:235], v[96:99]
    s_waitcnt vmcnt(10) lgkmcnt(1)
    v_fmac_f32 v252, -2.0, v249
    v_fma_f32 v249, v196, s24, v200
    v_mfma_f32_16x16x32_bf16 v[96:99], a[252:255], v[236:239], v[96:99]
    v_fmac_f32 v200, -4.0, v196
    v_fma_f32 v196, v194, s24, v198
    v_mfma_f32_16x16x32_bf16 v[100:103], v[240:243], v[236:239], v[100:103]
    v_fmac_f32 v198, -4.0, v194
    v_fma_f32 v194, v198, s26, v200
    v_mfma_f32_16x16x32_bf16 v[104:107], v[244:247], v[236:239], v[104:107]
    buffer_load_dwordx4 a[208:211], v254, s[8:11], s42 offen offset:1024 sc1
    v_mfma_f32_16x16x32_bf16 v[108:111], a[228:231], v[232:235], v[108:111]
    v_fmac_f32 v200, s27, v198
    v_fma_f32 v198, v196, 2.0, v249
    v_mfma_f32_16x16x32_bf16 v[108:111], a[240:243], v[236:239], v[108:111]
    s_waitcnt lgkmcnt(0)
    v_fmac_f32 v249, -2.0, v196
    v_cvt_pk_bf16_f32 v194, v248, v194
    v_mfma_f32_16x16x32_bf16 v[108:111], a[252:255], v[228:231], v[108:111]
    v_cvt_pk_bf16_f32 v200, v251, v200
    v_cvt_pk_bf16_f32 v198, v250, v198
    v_mfma_f32_16x16x32_bf16 v[112:115], v[240:243], v[228:231], v[112:115]
    buffer_load_dwordx4 a[212:215], v254, s[8:11], s42 offen offset:2048 sc1
    v_mfma_f32_16x16x32_bf16 v[112:115], a[244:247], v[236:239], v[112:115]
    s_mov_b32 s42, 595968
    v_cvt_pk_bf16_f32 v196, v252, v249
    v_lshlrev_b32 v248, 16, v195
    v_mfma_f32_16x16x32_bf16 v[112:115], a[232:235], v[232:235], v[112:115]
    v_lshlrev_b32 v249, 16, v197
    v_lshlrev_b32 v250, 16, v199
    v_mfma_f32_16x16x32_bf16 v[116:119], a[236:239], v[232:235], v[116:119]
    ds_read_b128 v[232:235], v253 offset:31200
    v_lshlrev_b32 v251, 16, v201
    v_mfma_f32_16x16x32_bf16 v[116:119], a[248:251], v[236:239], v[116:119]
    buffer_load_dwordx4 a[216:219], v254, s[8:11], s42 offen offset:0 sc1
    v_mfma_f32_16x16x32_bf16 v[116:119], v[244:247], v[228:231], v[116:119]
    v_and_b32 v195, s22, v195
    v_and_b32 v197, s22, v197
    v_mfma_f32_16x16x32_bf16 v[120:123], a[228:231], v[236:239], v[120:123]
    v_and_b32 v199, s22, v199
    v_and_b32 v201, s22, v201
    v_mfma_f32_16x16x32_bf16 v[120:123], a[240:243], v[228:231], v[120:123]
    s_waitcnt lgkmcnt(0)
    v_lshlrev_b32 v252, 16, v193
    v_and_b32 v193, s22, v193
    v_mfma_f32_16x16x32_bf16 v[120:123], a[252:255], v[232:235], v[120:123]
    v_fmac_f32 v252, s25, v251
    v_fmac_f32 v193, s25, v201
    v_mfma_f32_16x16x32_bf16 v[124:127], v[240:243], v[232:235], v[124:127]
    buffer_load_dwordx4 a[220:223], v254, s[8:11], s42 offen offset:1024 sc1
    v_mfma_f32_16x16x32_bf16 v[124:127], a[244:247], v[228:231], v[124:127]
    v_fmac_f32 v252, s28, v249
    v_fmac_f32 v193, s28, v197
    v_mfma_f32_16x16x32_bf16 v[124:127], a[232:235], v[236:239], v[124:127]
    v_cvt_pk_bf16_f32 v193, v252, v193
    v_lshlrev_b32 v252, 16, v203
    v_mfma_f32_16x16x32_bf16 v[128:131], a[236:239], v[236:239], v[128:131]
    ds_read_b128 v[236:239], v253 offset:33024
    v_and_b32 v203, s22, v203
    v_mfma_f32_16x16x32_bf16 v[128:131], a[248:251], v[228:231], v[128:131]
    buffer_load_dwordx4 a[224:227], v254, s[8:11], s42 offen offset:2048 sc1
    v_mfma_f32_16x16x32_bf16 v[128:131], v[244:247], v[232:235], v[128:131]
    v_fmac_f32 v252, s29, v248
    v_fmac_f32 v203, s29, v195
    v_mfma_f32_16x16x32_bf16 v[132:135], a[228:231], v[228:231], v[132:135]
    v_and_b32 v227, 0x7fff, v255
    v_fmac_f32 v252, s23, v250
    v_mfma_f32_16x16x32_bf16 v[132:135], a[240:243], v[232:235], v[132:135]
    s_waitcnt lgkmcnt(0)
    v_fmac_f32 v203, s23, v199
    v_cvt_pk_bf16_f32 v203, v252, v203
    v_mfma_f32_16x16x32_bf16 v[132:135], a[252:255], v[236:239], v[132:135]
    buffer_load_dwordx2 v[216:217], v227, s[4:7], s16 offen offset:704
    v_mfma_f32_16x16x32_bf16 v[136:139], v[240:243], v[236:239], v[136:139]
    v_fma_f32 v252, v249, s24, v251
    v_fmac_f32 v251, -4.0, v249
    v_mfma_f32_16x16x32_bf16 v[136:139], a[244:247], v[232:235], v[136:139]
    v_fma_f32 v249, v248, s24, v250
    v_fmac_f32 v250, -4.0, v248
    v_mfma_f32_16x16x32_bf16 v[136:139], a[232:235], v[228:231], v[136:139]
    v_fma_f32 v248, v250, s26, v251
    v_fmac_f32 v251, s27, v250
    v_mfma_f32_16x16x32_bf16 v[140:143], a[236:239], v[228:231], v[140:143]
    ds_read_b128 v[228:231], v253 offset:32768
    v_fma_f32 v250, v249, 2.0, v252
    v_mfma_f32_16x16x32_bf16 v[140:143], a[248:251], v[232:235], v[140:143]
    buffer_load_dwordx2 v[218:219], v227, s[4:7], s17 offen offset:704
    v_mfma_f32_16x16x32_bf16 v[140:143], v[244:247], v[236:239], v[140:143]
    v_fmac_f32 v252, -2.0, v249
    v_fma_f32 v249, v197, s24, v201
    v_mfma_f32_16x16x32_bf16 v[144:147], a[228:231], v[232:235], v[144:147]
    v_fmac_f32 v201, -4.0, v197
    v_fma_f32 v197, v195, s24, v199
    v_mfma_f32_16x16x32_bf16 v[144:147], a[240:243], v[236:239], v[144:147]
    s_waitcnt lgkmcnt(0)
    v_fmac_f32 v199, -4.0, v195
    v_fma_f32 v195, v199, s26, v201
    v_mfma_f32_16x16x32_bf16 v[144:147], a[252:255], v[228:231], v[144:147]
    buffer_load_dwordx2 v[220:221], v227, s[4:7], s18 offen offset:704
    v_mfma_f32_16x16x32_bf16 v[148:151], v[240:243], v[228:231], v[148:151]
    v_fmac_f32 v201, s27, v199
    v_fma_f32 v199, v197, 2.0, v249
    v_fmac_f32 v249, -2.0, v197
    v_mfma_f32_16x16x32_bf16 v[148:151], a[244:247], v[236:239], v[148:151]
    v_cvt_pk_bf16_f32 v195, v248, v195
    v_cvt_pk_bf16_f32 v201, v251, v201
    v_mfma_f32_16x16x32_bf16 v[148:151], a[232:235], v[232:235], v[148:151]
    v_cvt_pk_bf16_f32 v199, v250, v199
    v_cvt_pk_bf16_f32 v197, v252, v249
    v_mfma_f32_16x16x32_bf16 v[152:155], a[236:239], v[232:235], v[152:155]
    ds_read_b128 v[232:235], v253 offset:32512
    v_lshrrev_b32 v252, 15, v255
    v_mfma_f32_16x16x32_bf16 v[152:155], a[248:251], v[236:239], v[152:155]
    buffer_load_dwordx2 v[222:223], v227, s[4:7], s19 offen offset:704
    v_mfma_f32_16x16x32_bf16 v[152:155], v[244:247], v[228:231], v[152:155]
    ds_write_b64 v252, v[194:195] offset:0
    v_mfma_f32_16x16x32_bf16 v[156:159], a[228:231], v[236:239], v[156:159]
    v_lshrrev_b32 v194, 15, v255
    v_mfma_f32_16x16x32_bf16 v[156:159], a[240:243], v[228:231], v[156:159]
    s_waitcnt lgkmcnt(1)
    s_waitcnt vmcnt(13)
    v_lshlrev_b32 v248, 16, v206
    v_mfma_f32_16x16x32_bf16 v[156:159], a[252:255], v[232:235], v[156:159]
    buffer_load_dwordx2 v[224:225], v227, s[4:7], s20 offen offset:704
    v_mfma_f32_16x16x32_bf16 v[160:163], v[240:243], v[232:235], v[160:163]
    ds_write_b64 v194, v[200:201] offset:2080
    v_mfma_f32_16x16x32_bf16 v[160:163], a[244:247], v[228:231], v[160:163]
    v_lshlrev_b32 v249, 16, v208
    v_lshlrev_b32 v250, 16, v210
    v_mfma_f32_16x16x32_bf16 v[160:163], a[232:235], v[236:239], v[160:163]
    ds_write_b64 v194, v[198:199] offset:4160
    v_mfma_f32_16x16x32_bf16 v[164:167], a[236:239], v[236:239], v[164:167]
    ds_read_b128 v[236:239], v253 offset:32256
    v_lshlrev_b32 v251, 16, v212
    v_mfma_f32_16x16x32_bf16 v[164:167], a[248:251], v[228:231], v[164:167]
    buffer_load_dwordx2 v[226:227], v227, s[4:7], s21 offen offset:704
    v_mfma_f32_16x16x32_bf16 v[164:167], v[244:247], v[232:235], v[164:167]
    ds_write_b64 v194, v[192:193] offset:20800
    v_mfma_f32_16x16x32_bf16 v[168:171], a[228:231], v[228:231], v[168:171]
    v_and_b32 v206, s22, v206
    v_and_b32 v208, s22, v208
    v_mfma_f32_16x16x32_bf16 v[168:171], a[240:243], v[232:235], v[168:171]
    s_waitcnt lgkmcnt(1)
    v_and_b32 v210, s22, v210
    v_and_b32 v212, s22, v212
    v_mfma_f32_16x16x32_bf16 v[168:171], a[252:255], v[236:239], v[168:171]
    ds_write_b64 v194, v[202:203] offset:29120
    v_mfma_f32_16x16x32_bf16 v[172:175], v[240:243], v[236:239], v[172:175]
    v_lshlrev_b32 v252, 16, v204
    v_and_b32 v204, s22, v204
    v_mfma_f32_16x16x32_bf16 v[172:175], a[244:247], v[232:235], v[172:175]
    ds_write_b64 v194, v[196:197] offset:6240
    v_mfma_f32_16x16x32_bf16 v[172:175], a[232:235], v[228:231], v[172:175]
    v_fmac_f32 v252, s25, v251
    v_fmac_f32 v204, s25, v212
    v_fmac_f32 v252, s28, v249
    v_mfma_f32_16x16x32_bf16 v[176:179], a[236:239], v[228:231], v[176:179]
    ds_read_b128 v[228:231], v253 offset:31984
    v_fmac_f32 v204, s28, v208
    v_mfma_f32_16x16x32_bf16 v[176:179], a[248:251], v[232:235], v[176:179]
    v_cvt_pk_bf16_f32 v204, v252, v204
    v_lshlrev_b32 v252, 16, v214
    v_mfma_f32_16x16x32_bf16 v[176:179], v[244:247], v[236:239], v[176:179]
    s_mov_b32 s42, 626688
    v_and_b32 v214, s22, v214
    v_fmac_f32 v252, s29, v248
    v_mfma_f32_16x16x32_bf16 v[180:183], a[228:231], v[232:235], v[180:183]
    s_waitcnt lgkmcnt(0)
    v_fmac_f32 v214, s29, v206
    v_fmac_f32 v252, s23, v250
    v_mfma_f32_16x16x32_bf16 v[184:187], a[232:235], v[232:235], v[184:187]
    s_barrier
    v_mfma_f32_16x16x32_bf16 v[188:191], a[236:239], v[232:235], v[188:191]
    ds_read_b128 v[232:235], v253 offset:1040
    v_fmac_f32 v214, s23, v210
    v_mfma_f32_16x16x32_bf16 v[188:191], a[248:251], v[236:239], v[188:191]
    buffer_load_dwordx4 a[228:231], v254, s[8:11], s42 offen offset:0 sc1
    v_mfma_f32_16x16x32_bf16 v[184:187], a[244:247], v[236:239], v[184:187]
    v_cvt_pk_bf16_f32 v214, v252, v214
    v_fma_f32 v252, v249, s24, v251
    v_mfma_f32_16x16x32_bf16 v[180:183], a[240:243], v[236:239], v[180:183]
    ds_read_b128 v[236:239], v253 offset:768
    v_fmac_f32 v251, -4.0, v249
    v_mfma_f32_16x16x32_bf16 v[180:183], a[252:255], v[228:231], v[180:183]
    buffer_load_dwordx4 a[232:235], v254, s[8:11], s42 offen offset:1024 sc1
    v_mfma_f32_16x16x32_bf16 v[184:187], v[240:243], v[228:231], v[184:187]
    s_waitcnt vmcnt(14) lgkmcnt(1)
    v_fma_f32 v249, v248, s24, v250
    v_fmac_f32 v250, -4.0, v248
    v_mfma_f32_16x16x32_bf16 v[188:191], v[244:247], v[228:231], v[188:191]
    ds_read_b128 v[228:231], v253 offset:512
    v_fma_f32 v248, v250, s26, v251
sub16:
    v_mfma_f32_16x16x32_bf16 a[0:3], a[192:195], v[232:235], a[0:3]
    buffer_load_dwordx4 a[236:239], v254, s[8:11], s42 offen offset:2048 sc1
    v_mfma_f32_16x16x32_bf16 a[4:7], a[196:199], v[232:235], a[4:7]
    s_mov_b32 s42, 629760
    v_fmac_f32 v251, s27, v250
    v_fma_f32 v250, v249, 2.0, v252
    v_mfma_f32_16x16x32_bf16 a[8:11], a[200:203], v[232:235], a[8:11]
    ds_read_b128 v[232:235], v253 offset:256
    s_waitcnt vmcnt(12)
    s_waitcnt lgkmcnt(2)
    v_mfma_f32_16x16x32_bf16 a[8:11], a[212:215], v[236:239], a[8:11]
    v_fmac_f32 v252, -2.0, v249
    v_fma_f32 v249, v208, s24, v212
    v_mfma_f32_16x16x32_bf16 a[4:7], a[208:211], v[236:239], a[4:7]
    buffer_load_dwordx4 a[240:243], v254, s[8:11], s42 offen offset:0 sc1
    v_mfma_f32_16x16x32_bf16 a[0:3], a[204:207], v[236:239], a[0:3]
    s_waitcnt vmcnt(10) lgkmcnt(1)
    v_fmac_f32 v212, -4.0, v208
    v_fma_f32 v208, v206, s24, v210
    v_mfma_f32_16x16x32_bf16 a[0:3], a[216:219], v[228:231], a[0:3]
    v_fmac_f32 v210, -4.0, v206
    v_fma_f32 v206, v210, s26, v212
    v_mfma_f32_16x16x32_bf16 a[4:7], a[220:223], v[228:231], a[4:7]
    v_fmac_f32 v212, s27, v210
    v_fma_f32 v210, v208, 2.0, v249
    v_fmac_f32 v249, -2.0, v208
    v_mfma_f32_16x16x32_bf16 a[8:11], a[224:227], v[228:231], a[8:11]
    buffer_load_dwordx4 a[244:247], v254, s[8:11], s42 offen offset:1024 sc1
    v_mfma_f32_16x16x32_bf16 a[12:15], a[192:195], v[236:239], a[12:15]
    v_cvt_pk_bf16_f32 v206, v248, v206
    v_cvt_pk_bf16_f32 v212, v251, v212
    v_mfma_f32_16x16x32_bf16 a[12:15], a[204:207], v[228:231], a[12:15]
    s_waitcnt lgkmcnt(0)
    v_cvt_pk_bf16_f32 v210, v250, v210
    v_cvt_pk_bf16_f32 v208, v252, v249
    v_mfma_f32_16x16x32_bf16 a[12:15], a[216:219], v[232:235], a[12:15]
    v_lshlrev_b32 v248, 16, v207
    v_lshlrev_b32 v249, 16, v209
    v_mfma_f32_16x16x32_bf16 a[16:19], a[220:223], v[232:235], a[16:19]
    buffer_load_dwordx4 a[248:251], v254, s[8:11], s42 offen offset:2048 sc1
    v_mfma_f32_16x16x32_bf16 a[16:19], a[208:211], v[228:231], a[16:19]
    s_mov_b32 s42, 632832
    v_lshlrev_b32 v250, 16, v211
    v_lshlrev_b32 v251, 16, v213
    v_mfma_f32_16x16x32_bf16 a[16:19], a[196:199], v[236:239], a[16:19]
    v_and_b32 v207, s22, v207
    v_and_b32 v209, s22, v209
    v_mfma_f32_16x16x32_bf16 a[20:23], a[200:203], v[236:239], a[20:23]
    ds_read_b128 v[236:239], v253 offset:0
    v_and_b32 v211, s22, v211
    v_mfma_f32_16x16x32_bf16 a[20:23], a[212:215], v[228:231], a[20:23]
    buffer_load_dwordx4 a[252:255], v254, s[8:11], s42 offen offset:0 sc1
    v_mfma_f32_16x16x32_bf16 a[20:23], a[224:227], v[232:235], a[20:23]
    v_and_b32 v213, s22, v213
    v_lshlrev_b32 v252, 16, v205
    v_mfma_f32_16x16x32_bf16 a[24:27], a[192:195], v[228:231], a[24:27]
    v_and_b32 v205, s22, v205
    v_fmac_f32 v252, s25, v251
    v_mfma_f32_16x16x32_bf16 a[24:27], a[204:207], v[232:235], a[24:27]
    s_waitcnt lgkmcnt(0)
    v_fmac_f32 v205, s25, v213
    v_fmac_f32 v252, s28, v249
    v_mfma_f32_16x16x32_bf16 a[24:27], a[216:219], v[236:239], a[24:27]
    v_fmac_f32 v205, s28, v209
    v_cvt_pk_bf16_f32 v205, v252, v205
    v_mfma_f32_16x16x32_bf16 a[28:31], a[220:223], v[236:239], a[28:31]
    buffer_load_dwordx4 v[240:243], v254, s[8:11], s42 offen offset:1024 sc1
    v_mfma_f32_16x16x32_bf16 a[28:31], a[208:211], v[232:235], a[28:31]
    v_lshlrev_b32 v252, 16, v215
    v_and_b32 v215, s22, v215
    v_mfma_f32_16x16x32_bf16 a[28:31], a[196:199], v[228:231], a[28:31]
    v_fmac_f32 v252, s29, v248
    v_fmac_f32 v215, s29, v207
    v_mfma_f32_16x16x32_bf16 a[32:35], a[200:203], v[228:231], a[32:35]
    ds_read_b128 v[228:231], v253 offset:1824
    v_fmac_f32 v252, s23, v250
    v_mfma_f32_16x16x32_bf16 a[32:35], a[212:215], v[232:235], a[32:35]
    buffer_load_dwordx4 v[244:247], v254, s[8:11], s42 offen offset:2048 sc1
    v_mfma_f32_16x16x32_bf16 a[32:35], a[224:227], v[236:239], a[32:35]
    v_fmac_f32 v215, s23, v211
    v_cvt_pk_bf16_f32 v215, v252, v215
    v_mfma_f32_16x16x32_bf16 a[36:39], a[192:195], v[232:235], a[36:39]
    v_and_b32 v203, 0x7fff, v255
    v_fma_f32 v252, v249, s24, v251
    v_fmac_f32 v251, -4.0, v249
    v_mfma_f32_16x16x32_bf16 a[36:39], a[204:207], v[236:239], a[36:39]
    s_waitcnt lgkmcnt(0)
    v_fma_f32 v249, v248, s24, v250
    v_fmac_f32 v250, -4.0, v248
    v_mfma_f32_16x16x32_bf16 a[36:39], a[216:219], v[228:231], a[36:39]
    buffer_load_dwordx2 v[192:193], v203, s[4:7], s16 offen offset:1088
    v_mfma_f32_16x16x32_bf16 a[40:43], a[220:223], v[228:231], a[40:43]
    v_fma_f32 v248, v250, s26, v251
    v_fmac_f32 v251, s27, v250
    v_mfma_f32_16x16x32_bf16 a[40:43], a[208:211], v[236:239], a[40:43]
    v_fma_f32 v250, v249, 2.0, v252
    v_fmac_f32 v252, -2.0, v249
    v_mfma_f32_16x16x32_bf16 a[40:43], a[196:199], v[232:235], a[40:43]
    v_fma_f32 v249, v209, s24, v213
    v_fmac_f32 v213, -4.0, v209
    v_mfma_f32_16x16x32_bf16 a[44:47], a[200:203], v[232:235], a[44:47]
    ds_read_b128 v[232:235], v253 offset:1568
    v_fma_f32 v209, v207, s24, v211
    v_mfma_f32_16x16x32_bf16 a[44:47], a[212:215], v[236:239], a[44:47]
    buffer_load_dwordx2 v[194:195], v203, s[4:7], s17 offen offset:1088
    v_mfma_f32_16x16x32_bf16 a[44:47], a[224:227], v[228:231], a[44:47]
    v_fmac_f32 v211, -4.0, v207
    v_fma_f32 v207, v211, s26, v213
    v_mfma_f32_16x16x32_bf16 a[48:51], a[192:195], v[236:239], a[48:51]
    v_fmac_f32 v213, s27, v211
    v_fma_f32 v211, v209, 2.0, v249
    v_mfma_f32_16x16x32_bf16 a[48:51], a[204:207], v[228:231], a[48:51]
    s_waitcnt lgkmcnt(0)
    v_fmac_f32 v249, -2.0, v209
    v_cvt_pk_bf16_f32 v207, v248, v207
    v_mfma_f32_16x16x32_bf16 a[48:51], a[216:219], v[232:235], a[48:51]
    buffer_load_dwordx2 v[196:197], v203, s[4:7], s18 offen offset:1088
    v_mfma_f32_16x16x32_bf16 a[52:55], a[220:223], v[232:235], a[52:55]
    v_cvt_pk_bf16_f32 v213, v251, v213
    v_cvt_pk_bf16_f32 v211, v250, v211
    v_mfma_f32_16x16x32_bf16 a[52:55], a[208:211], v[228:231], a[52:55]
    v_cvt_pk_bf16_f32 v209, v252, v249
    v_lshrrev_b32 v252, 15, v255
    v_mfma_f32_16x16x32_bf16 a[52:55], a[196:199], v[236:239], a[52:55]
    ds_write_b64 v252, v[206:207] offset:9088
    v_mfma_f32_16x16x32_bf16 a[56:59], a[200:203], v[236:239], a[56:59]
    ds_read_b128 v[236:239], v253 offset:1312
    v_lshrrev_b32 v206, 15, v255
    v_mfma_f32_16x16x32_bf16 a[56:59], a[212:215], v[228:231], a[56:59]
    buffer_load_dwordx2 v[198:199], v203, s[4:7], s19 offen offset:1088
    v_mfma_f32_16x16x32_bf16 a[56:59], a[224:227], v[232:235], a[56:59]
    ds_write_b64 v206, v[212:213] offset:11168
    v_mfma_f32_16x16x32_bf16 a[60:63], a[192:195], v[228:231], a[60:63]
    v_mfma_f32_16x16x32_bf16 a[60:63], a[204:207], v[232:235], a[60:63]
    s_waitcnt lgkmcnt(1)
    s_waitcnt vmcnt(13)
    v_lshlrev_b32 v248, 16, v218
    v_mfma_f32_16x16x32_bf16 a[60:63], a[216:219], v[236:239], a[60:63]
    buffer_load_dwordx2 v[200:201], v203, s[4:7], s20 offen offset:1088
    v_lshlrev_b32 v249, 16, v220
    v_mfma_f32_16x16x32_bf16 a[64:67], a[220:223], v[236:239], a[64:67]
    ds_write_b64 v206, v[210:211] offset:13248
    v_mfma_f32_16x16x32_bf16 a[64:67], a[208:211], v[232:235], a[64:67]
    v_lshlrev_b32 v250, 16, v222
    v_lshlrev_b32 v251, 16, v224
    v_mfma_f32_16x16x32_bf16 a[64:67], a[196:199], v[228:231], a[64:67]
    ds_write_b64 v206, v[204:205] offset:23648
    v_mfma_f32_16x16x32_bf16 a[68:71], a[200:203], v[228:231], a[68:71]
    ds_read_b128 v[228:231], v253 offset:1056
    v_and_b32 v218, s22, v218
    v_mfma_f32_16x16x32_bf16 a[68:71], a[212:215], v[232:235], a[68:71]
    buffer_load_dwordx2 v[202:203], v203, s[4:7], s21 offen offset:1088
    v_mfma_f32_16x16x32_bf16 a[68:71], a[224:227], v[236:239], a[68:71]
    ds_write_b64 v206, v[214:215] offset:31968
    v_mfma_f32_16x16x32_bf16 a[72:75], a[192:195], v[232:235], a[72:75]
    v_and_b32 v220, s22, v220
    v_and_b32 v222, s22, v222
    v_mfma_f32_16x16x32_bf16 a[72:75], a[204:207], v[236:239], a[72:75]
    s_waitcnt lgkmcnt(1)
    v_and_b32 v224, s22, v224
    v_lshlrev_b32 v252, 16, v216
    v_mfma_f32_16x16x32_bf16 a[72:75], a[216:219], v[228:231], a[72:75]
    v_and_b32 v216, s22, v216
    v_fmac_f32 v252, s25, v251
    v_mfma_f32_16x16x32_bf16 a[76:79], a[220:223], v[228:231], a[76:79]
    v_fmac_f32 v216, s25, v224
    v_fmac_f32 v252, s28, v249
    v_mfma_f32_16x16x32_bf16 a[76:79], a[208:211], v[236:239], a[76:79]
    v_fmac_f32 v216, s28, v220
    v_cvt_pk_bf16_f32 v216, v252, v216
    v_mfma_f32_16x16x32_bf16 a[76:79], a[196:199], v[232:235], a[76:79]
    v_lshlrev_b32 v252, 16, v226
    v_and_b32 v226, s22, v226
    v_mfma_f32_16x16x32_bf16 a[80:83], a[200:203], v[232:235], a[80:83]
    ds_read_b128 v[232:235], v253 offset:784
    v_fmac_f32 v252, s29, v248
    v_mfma_f32_16x16x32_bf16 a[80:83], a[212:215], v[236:239], a[80:83]
    v_fmac_f32 v226, s29, v218
    v_fmac_f32 v252, s23, v250
    v_mfma_f32_16x16x32_bf16 a[80:83], a[224:227], v[228:231], a[80:83]
    s_mov_b32 s42, 663552
    v_fmac_f32 v226, s23, v222
    v_cvt_pk_bf16_f32 v226, v252, v226
    v_mfma_f32_16x16x32_bf16 a[84:87], a[192:195], v[236:239], a[84:87]
    s_waitcnt lgkmcnt(0)
    v_fma_f32 v252, v249, s24, v251
    v_fmac_f32 v251, -4.0, v249
    v_mfma_f32_16x16x32_bf16 a[88:91], a[196:199], v[236:239], a[88:91]
    s_barrier
    v_mfma_f32_16x16x32_bf16 a[92:95], a[200:203], v[236:239], a[92:95]
    ds_read_b128 v[236:239], v253 offset:3120
    v_fma_f32 v249, v248, s24, v250
    v_mfma_f32_16x16x32_bf16 a[92:95], a[212:215], v[228:231], a[92:95]
    buffer_load_dwordx4 a[192:195], v254, s[8:11], s42 offen offset:0 sc1
    v_mfma_f32_16x16x32_bf16 a[88:91], a[208:211], v[228:231], a[88:91]
    v_fmac_f32 v250, -4.0, v248
    v_fma_f32 v248, v250, s26, v251
    v_fmac_f32 v251, s27, v250
    v_mfma_f32_16x16x32_bf16 a[84:87], a[204:207], v[228:231], a[84:87]
    ds_read_b128 v[228:231], v253 offset:2848
    v_fma_f32 v250, v249, 2.0, v252
    v_mfma_f32_16x16x32_bf16 a[84:87], a[216:219], v[232:235], a[84:87]
    buffer_load_dwordx4 a[196:199], v254, s[8:11], s42 offen offset:1024 sc1
    v_mfma_f32_16x16x32_bf16 a[88:91], a[220:223], v[232:235], a[88:91]
    s_waitcnt vmcnt(14) lgkmcnt(1)
    v_fmac_f32 v252, -2.0, v249
    v_fma_f32 v249, v220, s24, v224
    v_mfma_f32_16x16x32_bf16 a[92:95], a[224:227], v[232:235], a[92:95]
    ds_read_b128 v[232:235], v253 offset:2592
    v_fmac_f32 v224, -4.0, v220
sub17:
    v_mfma_f32_16x16x32_bf16 a[96:99], a[228:231], v[236:239], a[96:99]
    buffer_load_dwordx4 a[200:203], v254, s[8:11], s42 offen offset:2048 sc1
    v_mfma_f32_16x16x32_bf16 a[100:103], a[232:235], v[236:239], a[100:103]
    s_mov_b32 s42, 666624
    v_fma_f32 v220, v218, s24, v222
    v_fmac_f32 v222, -4.0, v218
    v_mfma_f32_16x16x32_bf16 a[104:107], a[236:239], v[236:239], a[104:107]
    ds_read_b128 v[236:239], v253 offset:2336
    s_waitcnt vmcnt(12)
    s_waitcnt lgkmcnt(2)
    v_mfma_f32_16x16x32_bf16 a[104:107], a[248:251], v[228:231], a[104:107]
    ds_write_b64 v206, v[208:209] offset:768
    v_mfma_f32_16x16x32_bf16 a[100:103], a[244:247], v[228:231], a[100:103]
    buffer_load_dwordx4 a[204:207], v254, s[8:11], s42 offen offset:0 sc1
    v_mfma_f32_16x16x32_bf16 a[96:99], a[240:243], v[228:231], a[96:99]
    s_waitcnt vmcnt(10) lgkmcnt(2)
    v_fma_f32 v218, v222, s26, v224
    v_fmac_f32 v224, s27, v222
    v_mfma_f32_16x16x32_bf16 a[96:99], a[252:255], v[232:235], a[96:99]
    v_fma_f32 v222, v220, 2.0, v249
    v_fmac_f32 v249, -2.0, v220
    v_mfma_f32_16x16x32_bf16 a[100:103], v[240:243], v[232:235], a[100:103]
    v_cvt_pk_bf16_f32 v218, v248, v218
    v_cvt_pk_bf16_f32 v224, v251, v224
    v_mfma_f32_16x16x32_bf16 a[104:107], v[244:247], v[232:235], a[104:107]
    buffer_load_dwordx4 a[208:211], v254, s[8:11], s42 offen offset:1024 sc1
    v_mfma_f32_16x16x32_bf16 a[108:111], a[228:231], v[228:231], a[108:111]
    v_cvt_pk_bf16_f32 v222, v250, v222
    v_cvt_pk_bf16_f32 v220, v252, v249
    v_mfma_f32_16x16x32_bf16 a[108:111], a[240:243], v[232:235], a[108:111]
    s_waitcnt lgkmcnt(1)
    v_lshlrev_b32 v248, 16, v219
    v_lshlrev_b32 v249, 16, v221
    v_mfma_f32_16x16x32_bf16 a[108:111], a[252:255], v[236:239], a[108:111]
    v_lshlrev_b32 v250, 16, v223
    v_lshlrev_b32 v251, 16, v225
    v_mfma_f32_16x16x32_bf16 a[112:115], v[240:243], v[236:239], a[112:115]
    buffer_load_dwordx4 a[212:215], v254, s[8:11], s42 offen offset:2048 sc1
    v_mfma_f32_16x16x32_bf16 a[112:115], a[244:247], v[232:235], a[112:115]
    s_mov_b32 s42, 669696
    v_and_b32 v219, s22, v219
    v_and_b32 v221, s22, v221
    v_mfma_f32_16x16x32_bf16 a[112:115], a[232:235], v[228:231], a[112:115]
    v_and_b32 v223, s22, v223
    v_and_b32 v225, s22, v225
    v_mfma_f32_16x16x32_bf16 a[116:119], a[236:239], v[228:231], a[116:119]
    ds_read_b128 v[228:231], v253 offset:2080
    v_lshlrev_b32 v252, 16, v217
    v_and_b32 v217, s22, v217
    v_mfma_f32_16x16x32_bf16 a[116:119], a[248:251], v[232:235], a[116:119]
    buffer_load_dwordx4 a[216:219], v254, s[8:11], s42 offen offset:0 sc1
    v_mfma_f32_16x16x32_bf16 a[116:119], v[244:247], v[236:239], a[116:119]
    v_fmac_f32 v252, s25, v251
    v_fmac_f32 v217, s25, v225
    v_mfma_f32_16x16x32_bf16 a[120:123], a[228:231], v[232:235], a[120:123]
    v_fmac_f32 v252, s28, v249
    v_fmac_f32 v217, s28, v221
    v_mfma_f32_16x16x32_bf16 a[120:123], a[240:243], v[236:239], a[120:123]
    s_waitcnt lgkmcnt(0)
    v_cvt_pk_bf16_f32 v217, v252, v217
    v_lshlrev_b32 v252, 16, v227
    v_mfma_f32_16x16x32_bf16 a[120:123], a[252:255], v[228:231], a[120:123]
    v_and_b32 v227, s22, v227
    v_fmac_f32 v252, s29, v248
    v_mfma_f32_16x16x32_bf16 a[124:127], v[240:243], v[228:231], a[124:127]
    buffer_load_dwordx4 a[220:223], v254, s[8:11], s42 offen offset:1024 sc1
    v_mfma_f32_16x16x32_bf16 a[124:127], a[244:247], v[236:239], a[124:127]
    v_fmac_f32 v227, s29, v219
    v_fmac_f32 v252, s23, v250
    v_mfma_f32_16x16x32_bf16 a[124:127], a[232:235], v[232:235], a[124:127]
    v_fmac_f32 v227, s23, v223
    v_cvt_pk_bf16_f32 v227, v252, v227
    v_mfma_f32_16x16x32_bf16 a[128:131], a[236:239], v[232:235], a[128:131]
    ds_read_b128 v[232:235], v253 offset:3904
    v_fma_f32 v252, v249, s24, v251
    v_mfma_f32_16x16x32_bf16 a[128:131], a[248:251], v[236:239], a[128:131]
    buffer_load_dwordx4 a[224:227], v254, s[8:11], s42 offen offset:2048 sc1
    v_mfma_f32_16x16x32_bf16 a[128:131], v[244:247], v[228:231], a[128:131]
    v_fmac_f32 v251, -4.0, v249
    v_fma_f32 v249, v248, s24, v250
    v_mfma_f32_16x16x32_bf16 a[132:135], a[228:231], v[236:239], a[132:135]
    v_and_b32 v215, 0x7fff, v255
    v_fmac_f32 v250, -4.0, v248
    v_mfma_f32_16x16x32_bf16 a[132:135], a[240:243], v[228:231], a[132:135]
    s_waitcnt lgkmcnt(0)
    v_fma_f32 v248, v250, s26, v251
    v_fmac_f32 v251, s27, v250
    v_mfma_f32_16x16x32_bf16 a[132:135], a[252:255], v[232:235], a[132:135]
    buffer_load_dwordx2 v[204:205], v215, s[4:7], s16 offen offset:1472
    v_mfma_f32_16x16x32_bf16 a[136:139], v[240:243], v[232:235], a[136:139]
    v_fma_f32 v250, v249, 2.0, v252
    v_fmac_f32 v252, -2.0, v249
    v_mfma_f32_16x16x32_bf16 a[136:139], a[244:247], v[228:231], a[136:139]
    v_fma_f32 v249, v221, s24, v225
    v_fmac_f32 v225, -4.0, v221
    v_mfma_f32_16x16x32_bf16 a[136:139], a[232:235], v[236:239], a[136:139]
    v_fma_f32 v221, v219, s24, v223
    v_fmac_f32 v223, -4.0, v219
    v_mfma_f32_16x16x32_bf16 a[140:143], a[236:239], v[236:239], a[140:143]
    ds_read_b128 v[236:239], v253 offset:3648
    v_fma_f32 v219, v223, s26, v225
    v_mfma_f32_16x16x32_bf16 a[140:143], a[248:251], v[228:231], a[140:143]
    buffer_load_dwordx2 v[206:207], v215, s[4:7], s17 offen offset:1472
    v_mfma_f32_16x16x32_bf16 a[140:143], v[244:247], v[232:235], a[140:143]
    v_fmac_f32 v225, s27, v223
    v_fma_f32 v223, v221, 2.0, v249
    v_fmac_f32 v249, -2.0, v221
    v_mfma_f32_16x16x32_bf16 a[144:147], a[228:231], v[228:231], a[144:147]
    v_cvt_pk_bf16_f32 v219, v248, v219
    v_cvt_pk_bf16_f32 v225, v251, v225
    v_mfma_f32_16x16x32_bf16 a[144:147], a[240:243], v[232:235], a[144:147]
    s_waitcnt lgkmcnt(0)
    v_cvt_pk_bf16_f32 v223, v250, v223
    v_cvt_pk_bf16_f32 v221, v252, v249
    v_mfma_f32_16x16x32_bf16 a[144:147], a[252:255], v[236:239], a[144:147]
    buffer_load_dwordx2 v[208:209], v215, s[4:7], s18 offen offset:1472
    v_mfma_f32_16x16x32_bf16 a[148:151], v[240:243], v[236:239], a[148:151]
    v_lshrrev_b32 v252, 15, v255
    v_mfma_f32_16x16x32_bf16 a[148:151], a[244:247], v[232:235], a[148:151]
    ds_write_b64 v252, v[218:219] offset:8832
    v_mfma_f32_16x16x32_bf16 a[148:151], a[232:235], v[228:231], a[148:151]
    v_lshrrev_b32 v218, 15, v255
    v_mfma_f32_16x16x32_bf16 a[152:155], a[236:239], v[228:231], a[152:155]
    ds_read_b128 v[228:231], v253 offset:3392
    v_mfma_f32_16x16x32_bf16 a[152:155], a[248:251], v[232:235], a[152:155]
    buffer_load_dwordx2 v[210:211], v215, s[4:7], s19 offen offset:1472
    v_mfma_f32_16x16x32_bf16 a[152:155], v[244:247], v[236:239], a[152:155]
pad6:
    s_cbranch_vccnz pad10
    ds_write_b64 v218, v[224:225] offset:10912
    v_mfma_f32_16x16x32_bf16 a[156:159], a[228:231], v[232:235], a[156:159]
    v_mfma_f32_16x16x32_bf16 a[156:159], a[240:243], v[236:239], a[156:159]
    s_waitcnt lgkmcnt(1)
    s_waitcnt vmcnt(13)
    v_lshlrev_b32 v248, 16, v194
    v_mfma_f32_16x16x32_bf16 a[156:159], a[252:255], v[228:231], a[156:159]
    buffer_load_dwordx2 v[212:213], v215, s[4:7], s20 offen offset:1472
    v_mfma_f32_16x16x32_bf16 a[160:163], v[240:243], v[228:231], a[160:163]
    ds_write_b64 v218, v[222:223] offset:12992
    v_mfma_f32_16x16x32_bf16 a[160:163], a[244:247], v[236:239], a[160:163]
    v_lshlrev_b32 v249, 16, v196
    v_lshlrev_b32 v250, 16, v198
    v_mfma_f32_16x16x32_bf16 a[160:163], a[232:235], v[232:235], a[160:163]
    ds_write_b64 v218, v[216:217] offset:23392
    v_mfma_f32_16x16x32_bf16 a[164:167], a[236:239], v[232:235], a[164:167]
    ds_read_b128 v[232:235], v253 offset:3136
    v_lshlrev_b32 v251, 16, v200
    v_mfma_f32_16x16x32_bf16 a[164:167], a[248:251], v[236:239], a[164:167]
    buffer_load_dwordx2 v[214:215], v215, s[4:7], s21 offen offset:1472
    v_mfma_f32_16x16x32_bf16 a[164:167], v[244:247], v[228:231], a[164:167]
    s_add_u32 s49, s49, 8
    v_and_b32 v194, s22, v194
    v_and_b32 v196, s22, v196
    v_mfma_f32_16x16x32_bf16 a[168:171], a[228:231], v[236:239], a[168:171]
    ds_write_b64 v218, v[226:227] offset:31712
    v_mfma_f32_16x16x32_bf16 a[168:171], a[240:243], v[228:231], a[168:171]
    s_waitcnt lgkmcnt(1)
    v_and_b32 v198, s22, v198
    v_and_b32 v200, s22, v200
    v_lshlrev_b32 v252, 16, v192
    v_mfma_f32_16x16x32_bf16 a[168:171], a[252:255], v[232:235], a[168:171]
    s_cmp_eq_u32 s39, 1
    s_cselect_b32 s49, 128, s49
    s_cselect_b32 s36, 2130706432, 0
    v_mfma_f32_16x16x32_bf16 a[172:175], v[240:243], v[232:235], a[172:175]
    ds_write_b64 v218, v[220:221] offset:512
    v_mfma_f32_16x16x32_bf16 a[172:175], a[244:247], v[228:231], a[172:175]
    ds_read_b128 v[216:219], v253 offset:40480
    s_mov_b32 s45, 503518347
    v_mfma_f32_16x16x32_bf16 a[172:175], a[232:235], v[236:239], a[172:175]
    s_mul_i32 s43, s49, 786432
    v_bfe_u32 v220, v254, 5, 3
    v_mul_u32_u24 v221, 5, v220
    v_mfma_f32_16x16x32_bf16 a[176:179], a[236:239], v[236:239], a[176:179]
    ds_read_b128 v[236:239], v253 offset:2864
    v_bfe_u32 v221, s45, v221, 5
    v_mfma_f32_16x16x32_bf16 a[176:179], a[248:251], v[228:231], a[176:179]
    v_mul_u32_u24 v221, 65, v221
    v_sub_u32 v221, v221, v220
    v_mfma_f32_16x16x32_bf16 a[176:179], v[244:247], v[232:235], a[176:179]
    s_mov_b32 s42, 700416
    s_add_u32 s43, s43, s53
    v_lshl_add_u32 v220, v221, 5, v253
    v_mfma_f32_16x16x32_bf16 a[180:183], a[228:231], v[228:231], a[180:183]
    s_waitcnt lgkmcnt(1)
    v_and_b32 v192, s22, v192
    v_fmac_f32 v252, s25, v251
    v_mfma_f32_16x16x32_bf16 a[184:187], a[232:235], v[228:231], a[184:187]
    s_mov_b64 exec, s[46:47]
    ds_write_b128 v220, v[216:219] offset:1024
    s_mov_b64 exec, -1
    v_mfma_f32_16x16x32_bf16 a[188:191], a[236:239], v[228:231], a[188:191]
    ds_read_b128 v[228:231], v253 offset:5200
    v_fmac_f32 v192, s25, v200
    v_mfma_f32_16x16x32_bf16 a[188:191], a[248:251], v[232:235], a[188:191]
    buffer_load_dwordx4 a[228:231], v254, s[8:11], s42 offen offset:0 sc1
    v_mfma_f32_16x16x32_bf16 a[184:187], a[244:247], v[232:235], a[184:187]
    s_waitcnt lgkmcnt(2)
    v_fmac_f32 v252, s28, v249
    v_fmac_f32 v192, s28, v196
    v_mfma_f32_16x16x32_bf16 a[180:183], a[240:243], v[232:235], a[180:183]
    ds_read_b128 v[232:235], v253 offset:4928
    v_cvt_pk_bf16_f32 v192, v252, v192
    v_mfma_f32_16x16x32_bf16 a[180:183], a[252:255], v[236:239], a[180:183]
    buffer_load_dwordx4 a[232:235], v254, s[8:11], s42 offen offset:1024 sc1
    v_mfma_f32_16x16x32_bf16 a[184:187], v[240:243], v[236:239], a[184:187]
    s_waitcnt vmcnt(14) lgkmcnt(1)
    v_lshlrev_b32 v252, 16, v202
    v_and_b32 v202, s22, v202
    v_mfma_f32_16x16x32_bf16 a[188:191], v[244:247], v[236:239], a[188:191]
    ds_read_b128 v[236:239], v253 offset:4672
    v_fmac_f32 v252, s29, v248
sub18:
    v_mfma_f32_16x16x32_bf16 v[0:3], a[192:195], v[228:231], v[0:3]
    buffer_load_dwordx4 a[236:239], v254, s[8:11], s42 offen offset:2048 sc1
    v_mfma_f32_16x16x32_bf16 v[4:7], a[196:199], v[228:231], v[4:7]
    s_mov_b32 s42, 703488
    v_fmac_f32 v202, s29, v194
    v_fmac_f32 v252, s23, v250
    v_mfma_f32_16x16x32_bf16 v[8:11], a[200:203], v[228:231], v[8:11]
    ds_read_b128 v[228:231], v253 offset:4416
    s_waitcnt vmcnt(12)
    s_waitcnt lgkmcnt(2)
    v_mfma_f32_16x16x32_bf16 v[8:11], a[212:215], v[232:235], v[8:11]
    s_cmp_ge_u32 s49, 128
    s_cselect_b32 s43, 2130706432, s43
    s_sub_u32 s16, s43, 196608
    v_fmac_f32 v202, s23, v198
    v_mfma_f32_16x16x32_bf16 v[4:7], a[208:211], v[232:235], v[4:7]
    buffer_load_dwordx4 a[240:243], v254, s[8:11], s42 offen offset:0 sc1
    v_mfma_f32_16x16x32_bf16 v[0:3], a[204:207], v[232:235], v[0:3]
    s_waitcnt vmcnt(10) lgkmcnt(1)
    v_cvt_pk_bf16_f32 v202, v252, v202
    v_fma_f32 v252, v249, s24, v251
    v_mfma_f32_16x16x32_bf16 v[0:3], a[216:219], v[236:239], v[0:3]
    s_cmp_eq_u32 s49, 0
    s_cselect_b32 s16, 2130706432, s16
    s_mov_b32 s17, s43
    v_mfma_f32_16x16x32_bf16 v[4:7], a[220:223], v[236:239], v[4:7]
    s_add_u32 s18, s43, 196608
    v_fmac_f32 v251, -4.0, v249
    v_fma_f32 v249, v248, s24, v250
    v_mfma_f32_16x16x32_bf16 v[8:11], a[224:227], v[236:239], v[8:11]
    buffer_load_dwordx4 a[244:247], v254, s[8:11], s42 offen offset:1024 sc1
    v_mfma_f32_16x16x32_bf16 v[12:15], a[192:195], v[232:235], v[12:15]
    s_add_u32 s19, s43, 393216
    v_fmac_f32 v250, -4.0, v248
    v_fma_f32 v248, v250, s26, v251
    v_mfma_f32_16x16x32_bf16 v[12:15], a[204:207], v[236:239], v[12:15]
    s_waitcnt lgkmcnt(0)
    v_fmac_f32 v251, s27, v250
    v_fma_f32 v250, v249, 2.0, v252
    v_mfma_f32_16x16x32_bf16 v[12:15], a[216:219], v[228:231], v[12:15]
    v_fmac_f32 v252, -2.0, v249
    v_fma_f32 v249, v196, s24, v200
    v_mfma_f32_16x16x32_bf16 v[16:19], a[220:223], v[228:231], v[16:19]
    buffer_load_dwordx4 a[248:251], v254, s[8:11], s42 offen offset:2048 sc1
    v_mfma_f32_16x16x32_bf16 v[16:19], a[208:211], v[236:239], v[16:19]
    s_mov_b32 s42, 706560
    s_add_u32 s20, s43, 589824
    v_fmac_f32 v200, -4.0, v196
    v_mfma_f32_16x16x32_bf16 v[16:19], a[196:199], v[232:235], v[16:19]
    v_fma_f32 v196, v194, s24, v198
    v_fmac_f32 v198, -4.0, v194
    v_mfma_f32_16x16x32_bf16 v[20:23], a[200:203], v[232:235], v[20:23]
    ds_read_b128 v[232:235], v253 offset:4160
    v_fma_f32 v194, v198, s26, v200
    v_mfma_f32_16x16x32_bf16 v[20:23], a[212:215], v[236:239], v[20:23]
    buffer_load_dwordx4 a[252:255], v254, s[8:11], s42 offen offset:0 sc1
    v_mfma_f32_16x16x32_bf16 v[20:23], a[224:227], v[228:231], v[20:23]
    s_add_u32 s21, s43, 786432
    v_fmac_f32 v200, s27, v198
    v_fma_f32 v198, v196, 2.0, v249
    v_mfma_f32_16x16x32_bf16 v[24:27], a[192:195], v[236:239], v[24:27]
    v_fmac_f32 v249, -2.0, v196
    v_cvt_pk_bf16_f32 v194, v248, v194
    v_mfma_f32_16x16x32_bf16 v[24:27], a[204:207], v[228:231], v[24:27]
    s_waitcnt lgkmcnt(0)
    s_add_u32 s100, s43, s101
    v_cvt_pk_bf16_f32 v200, v251, v200
    v_mfma_f32_16x16x32_bf16 v[24:27], a[216:219], v[232:235], v[24:27]
    v_cvt_pk_bf16_f32 v198, v250, v198
    v_cvt_pk_bf16_f32 v196, v252, v249
    v_mfma_f32_16x16x32_bf16 v[28:31], a[220:223], v[232:235], v[28:31]
    buffer_load_dwordx4 v[240:243], v254, s[8:11], s42 offen offset:1024 sc1
    v_mfma_f32_16x16x32_bf16 v[28:31], a[208:211], v[228:231], v[28:31]
    s_add_u32 s37, s43, s33
    v_lshlrev_b32 v248, 16, v195
    v_lshlrev_b32 v249, 16, v197
    v_mfma_f32_16x16x32_bf16 v[28:31], a[196:199], v[236:239], v[28:31]
    v_lshlrev_b32 v250, 16, v199
    v_lshlrev_b32 v251, 16, v201
    v_and_b32 v195, s22, v195
    v_mfma_f32_16x16x32_bf16 v[32:35], a[200:203], v[236:239], v[32:35]
    ds_read_b128 v[236:239], v253 offset:5984
    v_and_b32 v197, s22, v197
    v_mfma_f32_16x16x32_bf16 v[32:35], a[212:215], v[228:231], v[32:35]
    buffer_load_dwordx4 v[244:247], v254, s[8:11], s42 offen offset:2048 sc1
    v_mfma_f32_16x16x32_bf16 v[32:35], a[224:227], v[232:235], v[32:35]
    v_and_b32 v199, s22, v199
    v_and_b32 v201, s22, v201
    v_mfma_f32_16x16x32_bf16 v[36:39], a[192:195], v[228:231], v[36:39]
    v_and_b32 v224, 0x1f0, v254
    v_mul_u32_u24 v224, 96, v224
    v_mfma_f32_16x16x32_bf16 v[36:39], a[204:207], v[232:235], v[36:39]
    s_waitcnt lgkmcnt(0)
    v_lshlrev_b32 v252, 16, v193
    v_and_b32 v193, s22, v193
    v_mfma_f32_16x16x32_bf16 v[36:39], a[216:219], v[236:239], v[36:39]
    buffer_load_dword v224, v224, s[4:7], s100 offen offset:0
    v_mfma_f32_16x16x32_bf16 v[40:43], a[220:223], v[236:239], v[40:43]
    v_and_b32 v227, 0xf0, v254
    v_lshrrev_b32 v227, 1, v227
    v_mfma_f32_16x16x32_bf16 v[40:43], a[208:211], v[232:235], v[40:43]
    v_add_u32 v227, s52, v227
    v_mov_b32 v226, s54
    v_mfma_f32_16x16x32_bf16 v[40:43], a[196:199], v[228:231], v[40:43]
    v_mov_b32 v225, s55
    v_cndmask_b32 v226, v226, v225, s[56:57]
    v_mfma_f32_16x16x32_bf16 v[44:47], a[200:203], v[228:231], v[44:47]
    ds_read_b128 v[228:231], v253 offset:5728
    v_add_u32 v227, v227, v226
    v_mfma_f32_16x16x32_bf16 v[44:47], a[212:215], v[232:235], v[44:47]
    s_sub_u32 s45, s16, s50
    v_fmac_f32 v252, s25, v251
    v_fmac_f32 v193, s25, v201
    v_mfma_f32_16x16x32_bf16 v[44:47], a[224:227], v[236:239], v[44:47]
    buffer_load_dwordx2 v[216:217], v227, s[4:7], s45 offen
    v_mfma_f32_16x16x32_bf16 v[48:51], a[192:195], v[232:235], v[48:51]
    s_sub_u32 s45, s17, s50
    v_fmac_f32 v252, s28, v249
    v_fmac_f32 v193, s28, v197
    v_mfma_f32_16x16x32_bf16 v[48:51], a[204:207], v[236:239], v[48:51]
    s_waitcnt lgkmcnt(0)
    v_cvt_pk_bf16_f32 v193, v252, v193
    v_lshlrev_b32 v252, 16, v203
    v_mfma_f32_16x16x32_bf16 v[48:51], a[216:219], v[228:231], v[48:51]
    v_and_b32 v203, s22, v203
    v_fmac_f32 v252, s29, v248
    v_mfma_f32_16x16x32_bf16 v[52:55], a[220:223], v[228:231], v[52:55]
    buffer_load_dwordx2 v[218:219], v227, s[4:7], s45 offen
    v_mfma_f32_16x16x32_bf16 v[52:55], a[208:211], v[236:239], v[52:55]
    s_sub_u32 s45, s18, s50
    v_fmac_f32 v203, s29, v195
    v_fmac_f32 v252, s23, v250
    v_mfma_f32_16x16x32_bf16 v[52:55], a[196:199], v[232:235], v[52:55]
    v_fmac_f32 v203, s23, v199
    v_cvt_pk_bf16_f32 v203, v252, v203
    v_mfma_f32_16x16x32_bf16 v[56:59], a[200:203], v[232:235], v[56:59]
    ds_read_b128 v[232:235], v253 offset:5472
    v_fma_f32 v252, v249, s24, v251
    v_mfma_f32_16x16x32_bf16 v[56:59], a[212:215], v[236:239], v[56:59]
    buffer_load_dwordx2 v[220:221], v227, s[4:7], s45 offen
    v_fmac_f32 v251, -4.0, v249
    v_mfma_f32_16x16x32_bf16 v[56:59], a[224:227], v[228:231], v[56:59]
    s_sub_u32 s45, s19, s50
    v_fma_f32 v249, v248, s24, v250
    v_fmac_f32 v250, -4.0, v248
    v_mfma_f32_16x16x32_bf16 v[60:63], a[192:195], v[236:239], v[60:63]
    v_fma_f32 v248, v250, s26, v251
    v_fmac_f32 v251, s27, v250
    v_mfma_f32_16x16x32_bf16 v[60:63], a[204:207], v[228:231], v[60:63]
    s_waitcnt lgkmcnt(0)
    v_fma_f32 v250, v249, 2.0, v252
    v_fmac_f32 v252, -2.0, v249
    v_mfma_f32_16x16x32_bf16 v[60:63], a[216:219], v[232:235], v[60:63]
    buffer_load_dwordx2 v[222:223], v227, s[4:7], s45 offen
    v_mfma_f32_16x16x32_bf16 v[64:67], a[220:223], v[232:235], v[64:67]
    s_sub_u32 s45, s20, s50
    v_fma_f32 v249, v197, s24, v201
    v_fmac_f32 v201, -4.0, v197
    v_mfma_f32_16x16x32_bf16 v[64:67], a[208:211], v[228:231], v[64:67]
    v_fma_f32 v197, v195, s24, v199
    v_fmac_f32 v199, -4.0, v195
    v_mfma_f32_16x16x32_bf16 v[64:67], a[196:199], v[236:239], v[64:67]
    v_fma_f32 v195, v199, s26, v201
    v_fmac_f32 v201, s27, v199
    v_mfma_f32_16x16x32_bf16 v[68:71], a[200:203], v[236:239], v[68:71]
    ds_read_b128 v[236:239], v253 offset:5216
    v_fma_f32 v199, v197, 2.0, v249
    v_mfma_f32_16x16x32_bf16 v[68:71], a[212:215], v[228:231], v[68:71]
    buffer_load_dwordx2 v[224:225], v227, s[4:7], s45 offen
    v_mfma_f32_16x16x32_bf16 v[68:71], a[224:227], v[232:235], v[68:71]
    s_sub_u32 s45, s21, s50
    v_fmac_f32 v249, -2.0, v197
    v_cvt_pk_bf16_f32 v195, v248, v195
    v_mfma_f32_16x16x32_bf16 v[72:75], a[192:195], v[228:231], v[72:75]
    v_cvt_pk_bf16_f32 v201, v251, v201
    v_cvt_pk_bf16_f32 v199, v250, v199
    v_mfma_f32_16x16x32_bf16 v[72:75], a[204:207], v[232:235], v[72:75]
    s_waitcnt lgkmcnt(0)
    v_cvt_pk_bf16_f32 v197, v252, v249
    v_lshrrev_b32 v252, 15, v255
    v_mfma_f32_16x16x32_bf16 v[72:75], a[216:219], v[236:239], v[72:75]
    buffer_load_dwordx2 v[226:227], v227, s[4:7], s45 offen
    v_mfma_f32_16x16x32_bf16 v[76:79], a[220:223], v[236:239], v[76:79]
    ds_write_b64 v252, v[194:195] offset:8576
    v_mfma_f32_16x16x32_bf16 v[76:79], a[208:211], v[232:235], v[76:79]
    s_waitcnt vmcnt(16)
    v_lshrrev_b32 v194, 15, v255
    v_lshlrev_b32 v248, 16, v206
    v_mfma_f32_16x16x32_bf16 v[76:79], a[196:199], v[228:231], v[76:79]
    ds_write_b64 v194, v[200:201] offset:10656
    v_mfma_f32_16x16x32_bf16 v[80:83], a[200:203], v[228:231], v[80:83]
    ds_read_b128 v[228:231], v253 offset:4944
    v_lshlrev_b32 v249, 16, v208
    v_mfma_f32_16x16x32_bf16 v[80:83], a[212:215], v[232:235], v[80:83]
    ds_write_b64 v194, v[198:199] offset:12736
    v_mfma_f32_16x16x32_bf16 v[80:83], a[224:227], v[236:239], v[80:83]
    s_mov_b32 s42, 737280
    v_lshlrev_b32 v250, 16, v210
    v_lshlrev_b32 v251, 16, v212
    v_mfma_f32_16x16x32_bf16 v[84:87], a[192:195], v[232:235], v[84:87]
    ds_write_b64 v194, v[192:193] offset:23136
    v_and_b32 v206, s22, v206
    v_mfma_f32_16x16x32_bf16 v[88:91], a[196:199], v[232:235], v[88:91]
    v_and_b32 v208, s22, v208
    v_and_b32 v210, s22, v210
    v_mfma_f32_16x16x32_bf16 v[92:95], a[200:203], v[232:235], v[92:95]
    ds_read_b128 v[232:235], v253 offset:7280
    v_and_b32 v212, s22, v212
    v_mfma_f32_16x16x32_bf16 v[92:95], a[212:215], v[236:239], v[92:95]
    buffer_load_dwordx4 a[192:195], v254, s[8:11], s42 offen offset:0 sc1
    v_mfma_f32_16x16x32_bf16 v[88:91], a[208:211], v[236:239], v[88:91]
    s_waitcnt lgkmcnt(3)
    v_lshlrev_b32 v252, 16, v204
    v_and_b32 v204, s22, v204
    v_mfma_f32_16x16x32_bf16 v[84:87], a[204:207], v[236:239], v[84:87]
    ds_read_b128 v[236:239], v253 offset:7008
    v_fmac_f32 v252, s25, v251
    v_mfma_f32_16x16x32_bf16 v[84:87], a[216:219], v[228:231], v[84:87]
    buffer_load_dwordx4 a[196:199], v254, s[8:11], s42 offen offset:1024 sc1
    v_mfma_f32_16x16x32_bf16 v[88:91], a[220:223], v[228:231], v[88:91]
    s_waitcnt vmcnt(15) lgkmcnt(1)
    v_fmac_f32 v204, s25, v212
    v_fmac_f32 v252, s28, v249
    v_mfma_f32_16x16x32_bf16 v[92:95], a[224:227], v[228:231], v[92:95]
    ds_read_b128 v[228:231], v253 offset:6752
    v_fmac_f32 v204, s28, v208
sub19:
    v_mfma_f32_16x16x32_bf16 v[96:99], a[228:231], v[232:235], v[96:99]
    buffer_load_dwordx4 a[200:203], v254, s[8:11], s42 offen offset:2048 sc1
    v_mfma_f32_16x16x32_bf16 v[100:103], a[232:235], v[232:235], v[100:103]
    s_mov_b32 s42, 740352
    v_cvt_pk_bf16_f32 v204, v252, v204
    v_lshlrev_b32 v252, 16, v214
    v_mfma_f32_16x16x32_bf16 v[104:107], a[236:239], v[232:235], v[104:107]
    ds_read_b128 v[232:235], v253 offset:6496
    s_waitcnt vmcnt(13)
    s_waitcnt lgkmcnt(2)
    v_mfma_f32_16x16x32_bf16 v[104:107], a[248:251], v[236:239], v[104:107]
    ds_write_b64 v194, v[202:203] offset:31456
    v_mfma_f32_16x16x32_bf16 v[100:103], a[244:247], v[236:239], v[100:103]
    buffer_load_dwordx4 a[204:207], v254, s[8:11], s42 offen offset:0 sc1
    v_mfma_f32_16x16x32_bf16 v[96:99], a[240:243], v[236:239], v[96:99]
    s_waitcnt vmcnt(11) lgkmcnt(2)
    v_and_b32 v214, s22, v214
    v_fmac_f32 v252, s29, v248
    v_mfma_f32_16x16x32_bf16 v[96:99], a[252:255], v[228:231], v[96:99]
    ds_write_b64 v194, v[196:197] offset:256
    v_mfma_f32_16x16x32_bf16 v[100:103], v[240:243], v[228:231], v[100:103]
    v_fmac_f32 v214, s29, v206
    v_fmac_f32 v252, s23, v250
    v_mfma_f32_16x16x32_bf16 v[104:107], v[244:247], v[228:231], v[104:107]
    buffer_load_dwordx4 a[208:211], v254, s[8:11], s42 offen offset:1024 sc1
    v_mfma_f32_16x16x32_bf16 v[108:111], a[228:231], v[236:239], v[108:111]
    v_fmac_f32 v214, s23, v210
    v_cvt_pk_bf16_f32 v214, v252, v214
    v_mfma_f32_16x16x32_bf16 v[108:111], a[240:243], v[228:231], v[108:111]
    s_waitcnt lgkmcnt(2)
    v_fma_f32 v252, v249, s24, v251
    v_fmac_f32 v251, -4.0, v249
    v_mfma_f32_16x16x32_bf16 v[108:111], a[252:255], v[232:235], v[108:111]
    v_fma_f32 v249, v248, s24, v250
    v_fmac_f32 v250, -4.0, v248
    v_fma_f32 v248, v250, s26, v251
    v_mfma_f32_16x16x32_bf16 v[112:115], v[240:243], v[232:235], v[112:115]
    buffer_load_dwordx4 a[212:215], v254, s[8:11], s42 offen offset:2048 sc1
    v_mfma_f32_16x16x32_bf16 v[112:115], a[244:247], v[228:231], v[112:115]
    s_mov_b32 s42, 743424
    v_fmac_f32 v251, s27, v250
    v_fma_f32 v250, v249, 2.0, v252
    v_mfma_f32_16x16x32_bf16 v[112:115], a[232:235], v[236:239], v[112:115]
    v_fmac_f32 v252, -2.0, v249
    v_fma_f32 v249, v208, s24, v212
    v_mfma_f32_16x16x32_bf16 v[116:119], a[236:239], v[236:239], v[116:119]
    ds_read_b128 v[236:239], v253 offset:6240
    v_fmac_f32 v212, -4.0, v208
    v_mfma_f32_16x16x32_bf16 v[116:119], a[248:251], v[228:231], v[116:119]
    buffer_load_dwordx4 a[216:219], v254, s[8:11], s42 offen offset:0 sc1
    v_mfma_f32_16x16x32_bf16 v[116:119], v[244:247], v[232:235], v[116:119]
    v_fma_f32 v208, v206, s24, v210
    v_fmac_f32 v210, -4.0, v206
    v_mfma_f32_16x16x32_bf16 v[120:123], a[228:231], v[228:231], v[120:123]
    v_fma_f32 v206, v210, s26, v212
    v_fmac_f32 v212, s27, v210
    v_mfma_f32_16x16x32_bf16 v[120:123], a[240:243], v[232:235], v[120:123]
    s_waitcnt lgkmcnt(0)
    v_fma_f32 v210, v208, 2.0, v249
    v_fmac_f32 v249, -2.0, v208
    v_mfma_f32_16x16x32_bf16 v[120:123], a[252:255], v[236:239], v[120:123]
    v_cvt_pk_bf16_f32 v206, v248, v206
    v_cvt_pk_bf16_f32 v212, v251, v212
    v_mfma_f32_16x16x32_bf16 v[124:127], v[240:243], v[236:239], v[124:127]
    buffer_load_dwordx4 a[220:223], v254, s[8:11], s42 offen offset:1024 sc1
    v_mfma_f32_16x16x32_bf16 v[124:127], a[244:247], v[232:235], v[124:127]
    v_cvt_pk_bf16_f32 v210, v250, v210
    v_cvt_pk_bf16_f32 v208, v252, v249
    v_mfma_f32_16x16x32_bf16 v[124:127], a[232:235], v[228:231], v[124:127]
    v_lshlrev_b32 v248, 16, v207
    v_lshlrev_b32 v249, 16, v209
    v_mfma_f32_16x16x32_bf16 v[128:131], a[236:239], v[228:231], v[128:131]
    ds_read_b128 v[228:231], v253 offset:8064
    v_lshlrev_b32 v250, 16, v211
    v_mfma_f32_16x16x32_bf16 v[128:131], a[248:251], v[232:235], v[128:131]
    buffer_load_dwordx4 a[224:227], v254, s[8:11], s42 offen offset:2048 sc1
    v_mfma_f32_16x16x32_bf16 v[128:131], v[244:247], v[236:239], v[128:131]
    v_lshlrev_b32 v251, 16, v213
    v_and_b32 v207, s22, v207
    v_mfma_f32_16x16x32_bf16 v[132:135], a[228:231], v[232:235], v[132:135]
    v_and_b32 v209, s22, v209
    v_and_b32 v211, s22, v211
    v_mfma_f32_16x16x32_bf16 v[132:135], a[240:243], v[236:239], v[132:135]
    s_waitcnt lgkmcnt(0)
    v_and_b32 v213, s22, v213
    v_lshlrev_b32 v252, 16, v205
    v_mfma_f32_16x16x32_bf16 v[132:135], a[252:255], v[228:231], v[132:135]
    v_and_b32 v205, s22, v205
    v_fmac_f32 v252, s25, v251
    v_mfma_f32_16x16x32_bf16 v[136:139], v[240:243], v[228:231], v[136:139]
    v_fmac_f32 v205, s25, v213
    v_fmac_f32 v252, s28, v249
    v_mfma_f32_16x16x32_bf16 v[136:139], a[244:247], v[236:239], v[136:139]
    v_fmac_f32 v205, s28, v209
    v_cvt_pk_bf16_f32 v205, v252, v205
    v_lshlrev_b32 v252, 16, v215
    v_mfma_f32_16x16x32_bf16 v[136:139], a[232:235], v[232:235], v[136:139]
    v_and_b32 v215, s22, v215
    v_fmac_f32 v252, s29, v248
    v_mfma_f32_16x16x32_bf16 v[140:143], a[236:239], v[232:235], v[140:143]
    ds_read_b128 v[232:235], v253 offset:7808
    v_fmac_f32 v215, s29, v207
    v_mfma_f32_16x16x32_bf16 v[140:143], a[248:251], v[236:239], v[140:143]
    v_fmac_f32 v252, s23, v250
    v_fmac_f32 v215, s23, v211
    v_mfma_f32_16x16x32_bf16 v[140:143], v[244:247], v[228:231], v[140:143]
    v_cvt_pk_bf16_f32 v215, v252, v215
    v_fma_f32 v252, v249, s24, v251
    v_mfma_f32_16x16x32_bf16 v[144:147], a[228:231], v[236:239], v[144:147]
    v_fmac_f32 v251, -4.0, v249
    v_fma_f32 v249, v248, s24, v250
    v_mfma_f32_16x16x32_bf16 v[144:147], a[240:243], v[228:231], v[144:147]
    s_waitcnt lgkmcnt(0)
    v_fmac_f32 v250, -4.0, v248
    v_fma_f32 v248, v250, s26, v251
    v_mfma_f32_16x16x32_bf16 v[144:147], a[252:255], v[232:235], v[144:147]
    v_fmac_f32 v251, s27, v250
    v_fma_f32 v250, v249, 2.0, v252
    v_mfma_f32_16x16x32_bf16 v[148:151], v[240:243], v[232:235], v[148:151]
    v_fmac_f32 v252, -2.0, v249
    v_fma_f32 v249, v209, s24, v213
    v_mfma_f32_16x16x32_bf16 v[148:151], a[244:247], v[228:231], v[148:151]
    v_fmac_f32 v213, -4.0, v209
    v_fma_f32 v209, v207, s24, v211
    v_mfma_f32_16x16x32_bf16 v[148:151], a[232:235], v[236:239], v[148:151]
    v_fmac_f32 v211, -4.0, v207
    v_fma_f32 v207, v211, s26, v213
    v_mfma_f32_16x16x32_bf16 v[152:155], a[236:239], v[236:239], v[152:155]
    ds_read_b128 v[236:239], v253 offset:7552
    v_fmac_f32 v213, s27, v211
    v_mfma_f32_16x16x32_bf16 v[152:155], a[248:251], v[228:231], v[152:155]
    v_fma_f32 v211, v209, 2.0, v249
    v_fmac_f32 v249, -2.0, v209
    v_mfma_f32_16x16x32_bf16 v[152:155], v[244:247], v[232:235], v[152:155]
    v_cvt_pk_bf16_f32 v207, v248, v207
    v_cvt_pk_bf16_f32 v213, v251, v213
    v_mfma_f32_16x16x32_bf16 v[156:159], a[228:231], v[228:231], v[156:159]
    v_cvt_pk_bf16_f32 v211, v250, v211
    v_cvt_pk_bf16_f32 v209, v252, v249
    v_mfma_f32_16x16x32_bf16 v[156:159], a[240:243], v[232:235], v[156:159]
    s_waitcnt lgkmcnt(0)
    v_lshrrev_b32 v252, 15, v255
    v_mfma_f32_16x16x32_bf16 v[156:159], a[252:255], v[236:239], v[156:159]
    ds_write_b64 v252, v[206:207] offset:8320
    v_mfma_f32_16x16x32_bf16 v[160:163], v[240:243], v[236:239], v[160:163]
    v_lshrrev_b32 v206, 15, v255
    v_mfma_f32_16x16x32_bf16 v[160:163], a[244:247], v[232:235], v[160:163]
    ds_write_b64 v206, v[212:213] offset:10400
    v_mfma_f32_16x16x32_bf16 v[160:163], a[232:235], v[228:231], v[160:163]
    s_waitcnt vmcnt(9)
    v_lshlrev_b32 v248, 16, v218
    v_lshlrev_b32 v249, 16, v220
    v_mfma_f32_16x16x32_bf16 v[164:167], a[236:239], v[228:231], v[164:167]
    ds_read_b128 v[228:231], v253 offset:7296
    v_lshlrev_b32 v250, 16, v222
    v_mfma_f32_16x16x32_bf16 v[164:167], a[248:251], v[232:235], v[164:167]
    ds_write_b64 v206, v[210:211] offset:12480
    v_mfma_f32_16x16x32_bf16 v[164:167], v[244:247], v[236:239], v[164:167]
    v_lshlrev_b32 v251, 16, v224
    v_and_b32 v218, s22, v218
    v_mfma_f32_16x16x32_bf16 v[168:171], a[228:231], v[232:235], v[168:171]
    ds_write_b64 v206, v[204:205] offset:22880
    v_mfma_f32_16x16x32_bf16 v[168:171], a[240:243], v[236:239], v[168:171]
    s_waitcnt lgkmcnt(2)
    v_and_b32 v220, s22, v220
    v_and_b32 v222, s22, v222
    v_mfma_f32_16x16x32_bf16 v[168:171], a[252:255], v[228:231], v[168:171]
    ds_write_b64 v206, v[214:215] offset:31200
    v_mfma_f32_16x16x32_bf16 v[172:175], v[240:243], v[228:231], v[172:175]
    v_and_b32 v224, s22, v224
    v_lshlrev_b32 v252, 16, v216
    v_mfma_f32_16x16x32_bf16 v[172:175], a[244:247], v[236:239], v[172:175]
    ds_write_b64 v206, v[208:209] offset:0
    v_mfma_f32_16x16x32_bf16 v[172:175], a[232:235], v[232:235], v[172:175]
    v_and_b32 v216, s22, v216
    v_fmac_f32 v252, s25, v251
    v_mfma_f32_16x16x32_bf16 v[176:179], a[236:239], v[232:235], v[176:179]
    ds_read_b128 v[232:235], v253 offset:7024
    v_fmac_f32 v216, s25, v224
    v_mfma_f32_16x16x32_bf16 v[176:179], a[248:251], v[236:239], v[176:179]
    v_fmac_f32 v252, s28, v249
    v_fmac_f32 v216, s28, v220
    v_mfma_f32_16x16x32_bf16 v[176:179], v[244:247], v[228:231], v[176:179]
    s_mov_b32 s42, 774144
    v_cvt_pk_bf16_f32 v216, v252, v216
    v_lshlrev_b32 v252, 16, v226
    v_mfma_f32_16x16x32_bf16 v[180:183], a[228:231], v[236:239], v[180:183]
    s_waitcnt lgkmcnt(0)
    v_and_b32 v226, s22, v226
    v_fmac_f32 v252, s29, v248
    v_mfma_f32_16x16x32_bf16 v[184:187], a[232:235], v[236:239], v[184:187]
    s_barrier
    v_mfma_f32_16x16x32_bf16 v[188:191], a[236:239], v[236:239], v[188:191]
    ds_read_b128 v[236:239], v253 offset:9360
    v_fmac_f32 v226, s29, v218
    v_mfma_f32_16x16x32_bf16 v[188:191], a[248:251], v[228:231], v[188:191]
    buffer_load_dwordx4 a[228:231], v254, s[8:11], s42 offen offset:0 sc1
    v_mfma_f32_16x16x32_bf16 v[184:187], a[244:247], v[228:231], v[184:187]
    v_fmac_f32 v252, s23, v250
    v_fmac_f32 v226, s23, v222
    v_mfma_f32_16x16x32_bf16 v[180:183], a[240:243], v[228:231], v[180:183]
    ds_read_b128 v[228:231], v253 offset:9088
    v_cvt_pk_bf16_f32 v226, v252, v226
    v_mfma_f32_16x16x32_bf16 v[180:183], a[252:255], v[232:235], v[180:183]
    buffer_load_dwordx4 a[232:235], v254, s[8:11], s42 offen offset:1024 sc1
    v_mfma_f32_16x16x32_bf16 v[184:187], v[240:243], v[232:235], v[184:187]
    s_waitcnt vmcnt(8) lgkmcnt(1)
    v_fma_f32 v252, v249, s24, v251
    v_fmac_f32 v251, -4.0, v249
    v_mfma_f32_16x16x32_bf16 v[188:191], v[244:247], v[232:235], v[188:191]
    ds_read_b128 v[232:235], v253 offset:8832
    v_fma_f32 v249, v248, s24, v250
sub20:
    v_mfma_f32_16x16x32_bf16 a[0:3], a[192:195], v[236:239], a[0:3]
    buffer_load_dwordx4 a[236:239], v254, s[8:11], s42 offen offset:2048 sc1
    v_mfma_f32_16x16x32_bf16 a[4:7], a[196:199], v[236:239], a[4:7]
    s_mov_b32 s42, 777216
    v_fmac_f32 v250, -4.0, v248
    v_fma_f32 v248, v250, s26, v251
    v_mfma_f32_16x16x32_bf16 a[8:11], a[200:203], v[236:239], a[8:11]
    ds_read_b128 v[236:239], v253 offset:8576
    s_waitcnt vmcnt(6)
    s_waitcnt lgkmcnt(2)
    v_mfma_f32_16x16x32_bf16 a[8:11], a[212:215], v[228:231], a[8:11]
    v_fmac_f32 v251, s27, v250
    v_fma_f32 v250, v249, 2.0, v252
    v_mfma_f32_16x16x32_bf16 a[4:7], a[208:211], v[228:231], a[4:7]
    buffer_load_dwordx4 a[240:243], v254, s[8:11], s42 offen offset:0 sc1
    v_mfma_f32_16x16x32_bf16 a[0:3], a[204:207], v[228:231], a[0:3]
    s_waitcnt vmcnt(4) lgkmcnt(1)
    v_fmac_f32 v252, -2.0, v249
    v_fma_f32 v249, v220, s24, v224
    v_mfma_f32_16x16x32_bf16 a[0:3], a[216:219], v[232:235], a[0:3]
    v_fmac_f32 v224, -4.0, v220
    v_fma_f32 v220, v218, s24, v222
    v_mfma_f32_16x16x32_bf16 a[4:7], a[220:223], v[232:235], a[4:7]
    v_fmac_f32 v222, -4.0, v218
    v_fma_f32 v218, v222, s26, v224
    v_mfma_f32_16x16x32_bf16 a[8:11], a[224:227], v[232:235], a[8:11]
    buffer_load_dwordx4 a[244:247], v254, s[8:11], s42 offen offset:1024 sc1
    v_mfma_f32_16x16x32_bf16 a[12:15], a[192:195], v[228:231], a[12:15]
    v_fmac_f32 v224, s27, v222
    v_fma_f32 v222, v220, 2.0, v249
    v_mfma_f32_16x16x32_bf16 a[12:15], a[204:207], v[232:235], a[12:15]
    s_waitcnt lgkmcnt(0)
    v_fmac_f32 v249, -2.0, v220
    v_cvt_pk_bf16_f32 v218, v248, v218
    v_mfma_f32_16x16x32_bf16 a[12:15], a[216:219], v[236:239], a[12:15]
    v_cvt_pk_bf16_f32 v224, v251, v224
    v_cvt_pk_bf16_f32 v222, v250, v222
    v_mfma_f32_16x16x32_bf16 a[16:19], a[220:223], v[236:239], a[16:19]
    buffer_load_dwordx4 a[248:251], v254, s[8:11], s42 offen offset:2048 sc1
    v_mfma_f32_16x16x32_bf16 a[16:19], a[208:211], v[232:235], a[16:19]
    s_mov_b32 s42, 780288
    v_cvt_pk_bf16_f32 v220, v252, v249
    v_lshlrev_b32 v248, 16, v219
    v_mfma_f32_16x16x32_bf16 a[16:19], a[196:199], v[228:231], a[16:19]
    v_lshlrev_b32 v249, 16, v221
    v_lshlrev_b32 v250, 16, v223
    v_mfma_f32_16x16x32_bf16 a[20:23], a[200:203], v[228:231], a[20:23]
    ds_read_b128 v[228:231], v253 offset:8320
    v_lshlrev_b32 v251, 16, v225
    v_mfma_f32_16x16x32_bf16 a[20:23], a[212:215], v[232:235], a[20:23]
    buffer_load_dwordx4 a[252:255], v254, s[8:11], s42 offen offset:0 sc1
    v_mfma_f32_16x16x32_bf16 a[20:23], a[224:227], v[236:239], a[20:23]
    v_and_b32 v219, s22, v219
    v_and_b32 v221, s22, v221
    v_mfma_f32_16x16x32_bf16 a[24:27], a[192:195], v[232:235], a[24:27]
    v_and_b32 v223, s22, v223
    v_and_b32 v225, s22, v225
    v_mfma_f32_16x16x32_bf16 a[24:27], a[204:207], v[236:239], a[24:27]
    s_waitcnt lgkmcnt(0)
    v_lshlrev_b32 v252, 16, v217
    v_and_b32 v217, s22, v217
    v_mfma_f32_16x16x32_bf16 a[24:27], a[216:219], v[228:231], a[24:27]
    v_fmac_f32 v252, s25, v251
    v_fmac_f32 v217, s25, v225
    v_mfma_f32_16x16x32_bf16 a[28:31], a[220:223], v[228:231], a[28:31]
    buffer_load_dwordx4 v[240:243], v254, s[8:11], s42 offen offset:1024 sc1
    v_mfma_f32_16x16x32_bf16 a[28:31], a[208:211], v[236:239], a[28:31]
    v_fmac_f32 v252, s28, v249
    v_fmac_f32 v217, s28, v221
    v_mfma_f32_16x16x32_bf16 a[28:31], a[196:199], v[232:235], a[28:31]
    v_cvt_pk_bf16_f32 v217, v252, v217
    v_lshlrev_b32 v252, 16, v227
    v_mfma_f32_16x16x32_bf16 a[32:35], a[200:203], v[232:235], a[32:35]
    ds_read_b128 v[232:235], v253 offset:10144
    v_and_b32 v227, s22, v227
    v_mfma_f32_16x16x32_bf16 a[32:35], a[212:215], v[236:239], a[32:35]
    buffer_load_dwordx4 v[244:247], v254, s[8:11], s42 offen offset:2048 sc1
    v_mfma_f32_16x16x32_bf16 a[32:35], a[224:227], v[228:231], a[32:35]
    v_fmac_f32 v252, s29, v248
    v_fmac_f32 v227, s29, v219
    v_mfma_f32_16x16x32_bf16 a[36:39], a[192:195], v[236:239], a[36:39]
    v_and_b32 v192, 0x1f0, v254
    v_mul_u32_u24 v192, 96, v192
    v_mfma_f32_16x16x32_bf16 a[36:39], a[204:207], v[228:231], a[36:39]
    s_waitcnt lgkmcnt(0)
    v_fmac_f32 v252, s23, v250
    v_fmac_f32 v227, s23, v223
    v_mfma_f32_16x16x32_bf16 a[36:39], a[216:219], v[232:235], a[36:39]
    buffer_load_dword v192, v192, s[4:7], s100 offen offset:384
    v_mfma_f32_16x16x32_bf16 a[40:43], a[220:223], v[232:235], a[40:43]
    v_cvt_pk_bf16_f32 v227, v252, v227
    v_fma_f32 v252, v249, s24, v251
    v_mfma_f32_16x16x32_bf16 a[40:43], a[208:211], v[228:231], a[40:43]
    v_fmac_f32 v251, -4.0, v249
    v_fma_f32 v249, v248, s24, v250
    v_mfma_f32_16x16x32_bf16 a[40:43], a[196:199], v[236:239], a[40:43]
    v_fmac_f32 v250, -4.0, v248
    v_fma_f32 v248, v250, s26, v251
    v_mfma_f32_16x16x32_bf16 a[44:47], a[200:203], v[236:239], a[44:47]
    ds_read_b128 v[236:239], v253 offset:9888
    v_fmac_f32 v251, s27, v250
    v_mfma_f32_16x16x32_bf16 a[44:47], a[212:215], v[228:231], a[44:47]
    v_fma_f32 v250, v249, 2.0, v252
    v_fmac_f32 v252, -2.0, v249
    v_mfma_f32_16x16x32_bf16 a[44:47], a[224:227], v[232:235], a[44:47]
pad7:
    s_cbranch_vccnz pad11
    v_fma_f32 v249, v221, s24, v225
    v_fmac_f32 v225, -4.0, v221
    v_mfma_f32_16x16x32_bf16 a[48:51], a[192:195], v[228:231], a[48:51]
    v_fma_f32 v221, v219, s24, v223
    v_fmac_f32 v223, -4.0, v219
    v_mfma_f32_16x16x32_bf16 a[48:51], a[204:207], v[232:235], a[48:51]
    s_waitcnt lgkmcnt(0)
    v_fma_f32 v219, v223, s26, v225
    v_fmac_f32 v225, s27, v223
    v_mfma_f32_16x16x32_bf16 a[48:51], a[216:219], v[236:239], a[48:51]
    v_fma_f32 v223, v221, 2.0, v249
    v_fmac_f32 v249, -2.0, v221
    v_mfma_f32_16x16x32_bf16 a[52:55], a[220:223], v[236:239], a[52:55]
    v_cvt_pk_bf16_f32 v219, v248, v219
    v_cvt_pk_bf16_f32 v225, v251, v225
    v_mfma_f32_16x16x32_bf16 a[52:55], a[208:211], v[232:235], a[52:55]
    v_cvt_pk_bf16_f32 v223, v250, v223
    v_cvt_pk_bf16_f32 v221, v252, v249
    v_mfma_f32_16x16x32_bf16 a[52:55], a[196:199], v[228:231], a[52:55]
    v_and_b32 v248, 0xf0, v254
    v_lshrrev_b32 v248, 1, v248
    v_mfma_f32_16x16x32_bf16 a[56:59], a[200:203], v[228:231], a[56:59]
    ds_read_b128 v[228:231], v253 offset:9632
    v_add_u32 v248, s52, v248
    v_mfma_f32_16x16x32_bf16 a[56:59], a[212:215], v[232:235], a[56:59]
    v_and_b32 v252, 8, v248
    v_lshrrev_b32 v249, 6, v248
    v_mfma_f32_16x16x32_bf16 a[56:59], a[224:227], v[236:239], a[56:59]
    v_mul_u32_u24 v249, 192, v249
    v_add_u32 v252, v252, v249
    v_mfma_f32_16x16x32_bf16 a[60:63], a[192:195], v[232:235], a[60:63]
    v_bfe_u32 v249, v248, 4, 2
    v_mul_u32_u24 v249, 40704, v249
    v_mfma_f32_16x16x32_bf16 a[60:63], a[204:207], v[236:239], a[60:63]
    s_waitcnt lgkmcnt(0)
    v_add_u32 v252, v252, v249
    v_and_b32 v249, 32, v248
    v_mfma_f32_16x16x32_bf16 a[60:63], a[216:219], v[228:231], a[60:63]
    v_lshl_add_u32 v252, v249, 1, v252
    v_bfe_u32 v249, v254, 8, 1
    v_mfma_f32_16x16x32_bf16 a[64:67], a[220:223], v[228:231], a[64:67]
    v_lshl_add_u32 v252, v249, 4, v252
    v_mov_b32 v249, 123328
    v_mfma_f32_16x16x32_bf16 a[64:67], a[208:211], v[236:239], a[64:67]
    v_cndmask_b32 v252, v249, v252, s[58:59]
    v_mfma_f32_16x16x32_bf16 a[64:67], a[196:199], v[232:235], a[64:67]
    ds_write_b64 v252, v[216:217] offset:39520
    v_mfma_f32_16x16x32_bf16 a[68:71], a[200:203], v[232:235], a[68:71]
    ds_read_b128 v[232:235], v253 offset:9376
    v_mfma_f32_16x16x32_bf16 a[68:71], a[212:215], v[236:239], a[68:71]
    ds_write_b64 v252, v[218:219] offset:39552
    v_mfma_f32_16x16x32_bf16 a[68:71], a[224:227], v[228:231], a[68:71]
    v_mfma_f32_16x16x32_bf16 a[72:75], a[192:195], v[236:239], a[72:75]
    ds_write_b64 v252, v[224:225] offset:39584
    v_mfma_f32_16x16x32_bf16 a[72:75], a[204:207], v[228:231], a[72:75]
    s_waitcnt lgkmcnt(2)
    v_mfma_f32_16x16x32_bf16 a[72:75], a[216:219], v[232:235], a[72:75]
    ds_write_b64 v252, v[222:223] offset:39616
    v_mfma_f32_16x16x32_bf16 a[76:79], a[220:223], v[232:235], a[76:79]
    v_mfma_f32_16x16x32_bf16 a[76:79], a[208:211], v[228:231], a[76:79]
    ds_write_b64 v252, v[220:221] offset:39648
    v_mfma_f32_16x16x32_bf16 a[76:79], a[196:199], v[236:239], a[76:79]
    v_mfma_f32_16x16x32_bf16 a[80:83], a[200:203], v[236:239], a[80:83]
    ds_read_b128 v[236:239], v253 offset:9104
    v_mfma_f32_16x16x32_bf16 a[80:83], a[212:215], v[228:231], a[80:83]
    ds_write_b64 v252, v[226:227] offset:39680
    v_mfma_f32_16x16x32_bf16 a[80:83], a[224:227], v[232:235], a[80:83]
    s_mov_b32 s42, 811008
    v_mfma_f32_16x16x32_bf16 a[84:87], a[192:195], v[228:231], a[84:87]
    v_mfma_f32_16x16x32_bf16 a[88:91], a[196:199], v[228:231], a[88:91]
    v_mfma_f32_16x16x32_bf16 a[92:95], a[200:203], v[228:231], a[92:95]
    ds_read_b128 v[228:231], v253 offset:11440
    v_mfma_f32_16x16x32_bf16 a[92:95], a[212:215], v[232:235], a[92:95]
    buffer_load_dwordx4 a[192:195], v254, s[8:11], s42 offen offset:0 sc1
    v_mfma_f32_16x16x32_bf16 a[88:91], a[208:211], v[232:235], a[88:91]
    s_waitcnt lgkmcnt(2)
    v_mfma_f32_16x16x32_bf16 a[84:87], a[204:207], v[232:235], a[84:87]
    ds_read_b128 v[232:235], v253 offset:11168
    v_mfma_f32_16x16x32_bf16 a[84:87], a[216:219], v[236:239], a[84:87]
    buffer_load_dwordx4 a[196:199], v254, s[8:11], s42 offen offset:1024 sc1
    v_mfma_f32_16x16x32_bf16 a[88:91], a[220:223], v[236:239], a[88:91]
    s_waitcnt vmcnt(9) lgkmcnt(1)
    v_mfma_f32_16x16x32_bf16 a[92:95], a[224:227], v[236:239], a[92:95]
    ds_read_b128 v[236:239], v253 offset:10912
sub21:
    v_mfma_f32_16x16x32_bf16 a[96:99], a[228:231], v[228:231], a[96:99]
    buffer_load_dwordx4 a[200:203], v254, s[8:11], s42 offen offset:2048 sc1
    v_mfma_f32_16x16x32_bf16 a[100:103], a[232:235], v[228:231], a[100:103]
    s_mov_b32 s42, 814080
    v_mfma_f32_16x16x32_bf16 a[104:107], a[236:239], v[228:231], a[104:107]
    ds_read_b128 v[228:231], v253 offset:10656
    s_waitcnt vmcnt(7)
    s_waitcnt lgkmcnt(2)
    v_mfma_f32_16x16x32_bf16 a[104:107], a[248:251], v[232:235], a[104:107]
    v_bfe_u32 v251, v254, 6, 2
    v_mul_u32_u24 v248, 40704, v251
    v_mfma_f32_16x16x32_bf16 a[100:103], a[244:247], v[232:235], a[100:103]
    buffer_load_dwordx4 a[204:207], v254, s[8:11], s42 offen offset:0 sc1
    v_mfma_f32_16x16x32_bf16 a[96:99], a[240:243], v[232:235], a[96:99]
    s_waitcnt vmcnt(5) lgkmcnt(1)
    v_and_b32 v251, 0x80, v254
    v_lshrrev_b32 v251, 1, v251
    v_mfma_f32_16x16x32_bf16 a[96:99], a[252:255], v[236:239], a[96:99]
    v_add_u32 v248, v248, v251
    v_and_b32 v251, 0x40, v254
    v_mfma_f32_16x16x32_bf16 a[100:103], v[240:243], v[236:239], a[100:103]
    v_lshrrev_b32 v251, 2, v251
    v_add_u32 v248, v248, v251
    v_mfma_f32_16x16x32_bf16 a[104:107], v[244:247], v[236:239], a[104:107]
    buffer_load_dwordx4 a[208:211], v254, s[8:11], s42 offen offset:1024 sc1
    v_mfma_f32_16x16x32_bf16 a[108:111], a[228:231], v[232:235], a[108:111]
    v_bfe_u32 v251, v254, 4, 2
    v_mul_u32_u24 v251, 3104, v251
    v_mfma_f32_16x16x32_bf16 a[108:111], a[240:243], v[236:239], a[108:111]
    s_waitcnt lgkmcnt(0)
    v_add_u32 v248, v248, v251
    v_add_u32 v248, s52, v248
    v_mfma_f32_16x16x32_bf16 a[108:111], a[252:255], v[228:231], a[108:111]
    v_lshrrev_b32 v251, 8, v254
    v_lshl_add_u32 v249, v251, 3, v248
    v_mfma_f32_16x16x32_bf16 a[112:115], v[240:243], v[228:231], a[112:115]
    buffer_load_dwordx4 a[212:215], v254, s[8:11], s42 offen offset:2048 sc1
    v_mfma_f32_16x16x32_bf16 a[112:115], a[244:247], v[236:239], a[112:115]
    s_mov_b32 s42, 817152
    v_lshl_add_u32 v248, v251, 4, v248
    v_add_u32 v250, s51, v254
    v_mfma_f32_16x16x32_bf16 a[112:115], a[232:235], v[232:235], a[112:115]
    v_accvgpr_read_b32 v204, a0
    v_accvgpr_read_b32 v205, a1
    v_mfma_f32_16x16x32_bf16 a[116:119], a[236:239], v[232:235], a[116:119]
    ds_read_b128 v[232:235], v253 offset:10400
    v_accvgpr_read_b32 v206, a2
    v_mfma_f32_16x16x32_bf16 a[116:119], a[248:251], v[236:239], a[116:119]
    buffer_load_dwordx4 a[216:219], v254, s[8:11], s42 offen offset:0 sc1
    v_mfma_f32_16x16x32_bf16 a[116:119], v[244:247], v[228:231], a[116:119]
    v_accvgpr_read_b32 v207, a3
    v_accvgpr_read_b32 v208, a96
    v_mfma_f32_16x16x32_bf16 a[120:123], a[228:231], v[236:239], a[120:123]
    v_accvgpr_read_b32 v209, a97
    v_accvgpr_read_b32 v210, a98
    v_mfma_f32_16x16x32_bf16 a[120:123], a[240:243], v[228:231], a[120:123]
    s_waitcnt lgkmcnt(0)
    v_accvgpr_read_b32 v211, a99
    v_add_f32 v212, v204, v208
    v_mfma_f32_16x16x32_bf16 a[120:123], a[252:255], v[232:235], a[120:123]
    v_add_f32 v213, v205, v209
    v_add_f32 v214, v206, v210
    v_mfma_f32_16x16x32_bf16 a[124:127], v[240:243], v[232:235], a[124:127]
    buffer_load_dwordx4 a[220:223], v254, s[8:11], s42 offen offset:1024 sc1
    v_mfma_f32_16x16x32_bf16 a[124:127], a[244:247], v[228:231], a[124:127]
    v_add_f32 v215, v207, v211
    v_sub_f32 v204, v204, v208
    v_mfma_f32_16x16x32_bf16 a[124:127], a[232:235], v[236:239], a[124:127]
    v_sub_f32 v205, v205, v209
    v_sub_f32 v206, v206, v210
    v_mfma_f32_16x16x32_bf16 a[128:131], a[236:239], v[236:239], a[128:131]
    ds_read_b128 v[236:239], v253 offset:12224
    v_sub_f32 v207, v207, v211
    v_mfma_f32_16x16x32_bf16 a[128:131], a[248:251], v[228:231], a[128:131]
    buffer_load_dwordx4 a[224:227], v254, s[8:11], s42 offen offset:2048 sc1
    v_mfma_f32_16x16x32_bf16 a[128:131], v[244:247], v[232:235], a[128:131]
    v_accvgpr_write_b32 a0, v212
    v_accvgpr_write_b32 a1, v213
    v_mfma_f32_16x16x32_bf16 a[132:135], a[228:231], v[228:231], a[132:135]
    v_and_b32 v193, 0x1f0, v254
    v_mul_u32_u24 v193, 96, v193
    v_mfma_f32_16x16x32_bf16 a[132:135], a[240:243], v[232:235], a[132:135]
    s_waitcnt lgkmcnt(0)
    v_accvgpr_write_b32 a2, v214
    v_accvgpr_write_b32 a3, v215
    v_mfma_f32_16x16x32_bf16 a[132:135], a[252:255], v[236:239], a[132:135]
    buffer_load_dword v193, v193, s[4:7], s100 offen offset:768
    v_mfma_f32_16x16x32_bf16 a[136:139], v[240:243], v[236:239], a[136:139]
    v_accvgpr_write_b32 a96, v204
    v_accvgpr_write_b32 a97, v205
    v_mfma_f32_16x16x32_bf16 a[136:139], a[244:247], v[232:235], a[136:139]
    v_accvgpr_write_b32 a98, v206
    v_accvgpr_write_b32 a99, v207
    v_mfma_f32_16x16x32_bf16 a[136:139], a[232:235], v[228:231], a[136:139]
    v_accvgpr_read_b32 v204, a4
    v_accvgpr_read_b32 v205, a5
    v_mfma_f32_16x16x32_bf16 a[140:143], a[236:239], v[228:231], a[140:143]
    ds_read_b128 v[228:231], v253 offset:11968
    v_accvgpr_read_b32 v206, a6
    v_mfma_f32_16x16x32_bf16 a[140:143], a[248:251], v[232:235], a[140:143]
    v_accvgpr_read_b32 v207, a7
    v_accvgpr_read_b32 v208, a100
    v_mfma_f32_16x16x32_bf16 a[140:143], v[244:247], v[236:239], a[140:143]
    v_accvgpr_read_b32 v209, a101
    v_accvgpr_read_b32 v210, a102
    v_mfma_f32_16x16x32_bf16 a[144:147], a[228:231], v[232:235], a[144:147]
    v_accvgpr_read_b32 v211, a103
    v_add_f32 v212, v204, v208
    v_mfma_f32_16x16x32_bf16 a[144:147], a[240:243], v[236:239], a[144:147]
    s_waitcnt lgkmcnt(0)
    v_add_f32 v213, v205, v209
    v_add_f32 v214, v206, v210
    v_mfma_f32_16x16x32_bf16 a[144:147], a[252:255], v[228:231], a[144:147]
    v_add_f32 v215, v207, v211
    v_sub_f32 v204, v204, v208
    v_mfma_f32_16x16x32_bf16 a[148:151], v[240:243], v[228:231], a[148:151]
    v_sub_f32 v205, v205, v209
    v_sub_f32 v206, v206, v210
    v_mfma_f32_16x16x32_bf16 a[148:151], a[244:247], v[236:239], a[148:151]
    v_sub_f32 v207, v207, v211
    v_accvgpr_write_b32 a4, v212
    v_mfma_f32_16x16x32_bf16 a[148:151], a[232:235], v[232:235], a[148:151]
    v_accvgpr_write_b32 a5, v213
    v_accvgpr_write_b32 a6, v214
    v_mfma_f32_16x16x32_bf16 a[152:155], a[236:239], v[232:235], a[152:155]
    ds_read_b128 v[232:235], v253 offset:11712
    v_accvgpr_write_b32 a7, v215
    v_mfma_f32_16x16x32_bf16 a[152:155], a[248:251], v[236:239], a[152:155]
    v_accvgpr_write_b32 a100, v204
    v_accvgpr_write_b32 a101, v205
    v_mfma_f32_16x16x32_bf16 a[152:155], v[244:247], v[228:231], a[152:155]
    v_accvgpr_write_b32 a102, v206
    v_accvgpr_write_b32 a103, v207
    v_mfma_f32_16x16x32_bf16 a[156:159], a[228:231], v[236:239], a[156:159]
    v_accvgpr_read_b32 v204, a8
    v_accvgpr_read_b32 v205, a9
    v_mfma_f32_16x16x32_bf16 a[156:159], a[240:243], v[228:231], a[156:159]
    s_waitcnt lgkmcnt(0)
    v_accvgpr_read_b32 v206, a10
    v_accvgpr_read_b32 v207, a11
    v_mfma_f32_16x16x32_bf16 a[156:159], a[252:255], v[232:235], a[156:159]
    v_accvgpr_read_b32 v208, a104
    v_accvgpr_read_b32 v209, a105
    v_mfma_f32_16x16x32_bf16 a[160:163], v[240:243], v[232:235], a[160:163]
    v_accvgpr_read_b32 v210, a106
    v_accvgpr_read_b32 v211, a107
    v_mfma_f32_16x16x32_bf16 a[160:163], a[244:247], v[228:231], a[160:163]
    v_add_f32 v212, v204, v208
    v_add_f32 v213, v205, v209
    v_mfma_f32_16x16x32_bf16 a[160:163], a[232:235], v[236:239], a[160:163]
    v_add_f32 v214, v206, v210
    v_add_f32 v215, v207, v211
    v_mfma_f32_16x16x32_bf16 a[164:167], a[236:239], v[236:239], a[164:167]
    ds_read_b128 v[236:239], v253 offset:11456
    v_sub_f32 v204, v204, v208
    v_mfma_f32_16x16x32_bf16 a[164:167], a[248:251], v[228:231], a[164:167]
    v_sub_f32 v205, v205, v209
    v_sub_f32 v206, v206, v210
    v_mfma_f32_16x16x32_bf16 a[164:167], v[244:247], v[232:235], a[164:167]
    v_sub_f32 v207, v207, v211
    v_accvgpr_write_b32 a8, v212
    v_mfma_f32_16x16x32_bf16 a[168:171], a[228:231], v[228:231], a[168:171]
    v_accvgpr_write_b32 a9, v213
    v_accvgpr_write_b32 a10, v214
    v_mfma_f32_16x16x32_bf16 a[168:171], a[240:243], v[232:235], a[168:171]
    s_waitcnt lgkmcnt(0)
    v_accvgpr_write_b32 a11, v215
    v_accvgpr_write_b32 a104, v204
    v_mfma_f32_16x16x32_bf16 a[168:171], a[252:255], v[236:239], a[168:171]
    v_accvgpr_write_b32 a105, v205
    v_accvgpr_write_b32 a106, v206
    v_mfma_f32_16x16x32_bf16 a[172:175], v[240:243], v[236:239], a[172:175]
    v_accvgpr_write_b32 a107, v207
    v_accvgpr_read_b32 v204, a12
    v_mfma_f32_16x16x32_bf16 a[172:175], a[244:247], v[232:235], a[172:175]
    v_accvgpr_read_b32 v205, a13
    v_accvgpr_read_b32 v206, a14
    v_mfma_f32_16x16x32_bf16 a[172:175], a[232:235], v[228:231], a[172:175]
    v_accvgpr_read_b32 v207, a15
    v_accvgpr_read_b32 v208, a108
    v_mfma_f32_16x16x32_bf16 a[176:179], a[236:239], v[228:231], a[176:179]
    ds_read_b128 v[228:231], v253 offset:11184
    v_accvgpr_read_b32 v209, a109
    v_mfma_f32_16x16x32_bf16 a[176:179], a[248:251], v[232:235], a[176:179]
    v_accvgpr_read_b32 v210, a110
    v_accvgpr_read_b32 v211, a111
    v_mfma_f32_16x16x32_bf16 a[176:179], v[244:247], v[236:239], a[176:179]
    s_mov_b32 s42, 847872
    v_add_f32 v212, v204, v208
    v_add_f32 v213, v205, v209
    v_mfma_f32_16x16x32_bf16 a[180:183], a[228:231], v[232:235], a[180:183]
    v_add_f32 v214, v206, v210
    v_add_f32 v215, v207, v211
    v_mfma_f32_16x16x32_bf16 a[184:187], a[232:235], v[232:235], a[184:187]
    v_sub_f32 v204, v204, v208
    v_sub_f32 v205, v205, v209
    v_mfma_f32_16x16x32_bf16 a[188:191], a[236:239], v[232:235], a[188:191]
    ds_read_b128 v[232:235], v253 offset:13520
    v_sub_f32 v206, v206, v210
    v_mfma_f32_16x16x32_bf16 a[188:191], a[248:251], v[236:239], a[188:191]
    buffer_load_dwordx4 a[228:231], v254, s[8:11], s42 offen offset:0 sc1
    v_mfma_f32_16x16x32_bf16 a[184:187], a[244:247], v[236:239], a[184:187]
    s_waitcnt lgkmcnt(1)
    v_sub_f32 v207, v207, v211
    v_accvgpr_write_b32 a12, v212
    v_mfma_f32_16x16x32_bf16 a[180:183], a[240:243], v[236:239], a[180:183]
    ds_read_b128 v[236:239], v253 offset:13248
    v_accvgpr_write_b32 a13, v213
    v_mfma_f32_16x16x32_bf16 a[180:183], a[252:255], v[228:231], a[180:183]
    buffer_load_dwordx4 a[232:235], v254, s[8:11], s42 offen offset:1024 sc1
    v_mfma_f32_16x16x32_bf16 a[184:187], v[240:243], v[228:231], a[184:187]
    s_waitcnt vmcnt(9) lgkmcnt(1)
    v_accvgpr_write_b32 a14, v214
    v_accvgpr_write_b32 a15, v215
    v_mfma_f32_16x16x32_bf16 a[188:191], v[244:247], v[228:231], a[188:191]
    ds_read_b128 v[228:231], v253 offset:12992
    v_accvgpr_write_b32 a108, v204
sub22:
    v_mfma_f32_16x16x32_bf16 v[0:3], a[192:195], v[232:235], v[0:3]
    buffer_load_dwordx4 a[236:239], v254, s[8:11], s42 offen offset:2048 sc1
    v_mfma_f32_16x16x32_bf16 v[4:7], a[196:199], v[232:235], v[4:7]
    s_mov_b32 s42, 850944
    v_accvgpr_write_b32 a109, v205
    v_accvgpr_write_b32 a110, v206
    v_mfma_f32_16x16x32_bf16 v[8:11], a[200:203], v[232:235], v[8:11]
    ds_read_b128 v[232:235], v253 offset:12736
    s_waitcnt vmcnt(7)
    s_waitcnt lgkmcnt(2)
    v_mfma_f32_16x16x32_bf16 v[8:11], a[212:215], v[236:239], v[8:11]
    v_accvgpr_write_b32 a111, v207
    v_accvgpr_read_b32 v204, a16
    v_mfma_f32_16x16x32_bf16 v[4:7], a[208:211], v[236:239], v[4:7]
    buffer_load_dwordx4 a[240:243], v254, s[8:11], s42 offen offset:0 sc1
    v_mfma_f32_16x16x32_bf16 v[0:3], a[204:207], v[236:239], v[0:3]
    s_waitcnt vmcnt(5) lgkmcnt(1)
    v_accvgpr_read_b32 v205, a17
    v_accvgpr_read_b32 v206, a18
    v_mfma_f32_16x16x32_bf16 v[0:3], a[216:219], v[228:231], v[0:3]
    v_accvgpr_read_b32 v207, a19
    v_accvgpr_read_b32 v208, a112
    v_mfma_f32_16x16x32_bf16 v[4:7], a[220:223], v[228:231], v[4:7]
    v_accvgpr_read_b32 v209, a113
    v_accvgpr_read_b32 v210, a114
    v_mfma_f32_16x16x32_bf16 v[8:11], a[224:227], v[228:231], v[8:11]
    buffer_load_dwordx4 a[244:247], v254, s[8:11], s42 offen offset:1024 sc1
    v_mfma_f32_16x16x32_bf16 v[12:15], a[192:195], v[236:239], v[12:15]
    v_accvgpr_read_b32 v211, a115
    v_add_f32 v212, v204, v208
    v_mfma_f32_16x16x32_bf16 v[12:15], a[204:207], v[228:231], v[12:15]
    s_waitcnt lgkmcnt(0)
    v_add_f32 v213, v205, v209
    v_add_f32 v214, v206, v210
    v_mfma_f32_16x16x32_bf16 v[12:15], a[216:219], v[232:235], v[12:15]
    v_add_f32 v215, v207, v211
    v_sub_f32 v204, v204, v208
    v_mfma_f32_16x16x32_bf16 v[16:19], a[220:223], v[232:235], v[16:19]
    buffer_load_dwordx4 a[248:251], v254, s[8:11], s42 offen offset:2048 sc1
    v_mfma_f32_16x16x32_bf16 v[16:19], a[208:211], v[228:231], v[16:19]
    s_mov_b32 s42, 854016
    v_sub_f32 v205, v205, v209
    v_sub_f32 v206, v206, v210
    v_mfma_f32_16x16x32_bf16 v[16:19], a[196:199], v[236:239], v[16:19]
    v_sub_f32 v207, v207, v211
    v_accvgpr_write_b32 a16, v212
    v_mfma_f32_16x16x32_bf16 v[20:23], a[200:203], v[236:239], v[20:23]
    ds_read_b128 v[236:239], v253 offset:12480
    v_accvgpr_write_b32 a17, v213
    v_mfma_f32_16x16x32_bf16 v[20:23], a[212:215], v[228:231], v[20:23]
    buffer_load_dwordx4 a[252:255], v254, s[8:11], s42 offen offset:0 sc1
    v_mfma_f32_16x16x32_bf16 v[20:23], a[224:227], v[232:235], v[20:23]
    v_accvgpr_write_b32 a18, v214
    v_accvgpr_write_b32 a19, v215
    v_mfma_f32_16x16x32_bf16 v[24:27], a[192:195], v[228:231], v[24:27]
    v_accvgpr_write_b32 a112, v204
    v_accvgpr_write_b32 a113, v205
    v_mfma_f32_16x16x32_bf16 v[24:27], a[204:207], v[232:235], v[24:27]
    s_waitcnt lgkmcnt(0)
    v_accvgpr_write_b32 a114, v206
    v_accvgpr_write_b32 a115, v207
    v_mfma_f32_16x16x32_bf16 v[24:27], a[216:219], v[236:239], v[24:27]
    v_accvgpr_read_b32 v204, a20
    v_accvgpr_read_b32 v205, a21
    v_mfma_f32_16x16x32_bf16 v[28:31], a[220:223], v[236:239], v[28:31]
    buffer_load_dwordx4 v[240:243], v254, s[8:11], s42 offen offset:1024 sc1
    v_mfma_f32_16x16x32_bf16 v[28:31], a[208:211], v[232:235], v[28:31]
    v_accvgpr_read_b32 v206, a22
    v_accvgpr_read_b32 v207, a23
    v_mfma_f32_16x16x32_bf16 v[28:31], a[196:199], v[228:231], v[28:31]
    v_accvgpr_read_b32 v208, a116
    v_accvgpr_read_b32 v209, a117
    v_mfma_f32_16x16x32_bf16 v[32:35], a[200:203], v[228:231], v[32:35]
    ds_read_b128 v[228:231], v253 offset:14304
    v_accvgpr_read_b32 v210, a118
    v_mfma_f32_16x16x32_bf16 v[32:35], a[212:215], v[232:235], v[32:35]
    buffer_load_dwordx4 v[244:247], v254, s[8:11], s42 offen offset:2048 sc1
    v_mfma_f32_16x16x32_bf16 v[32:35], a[224:227], v[236:239], v[32:35]
    v_accvgpr_read_b32 v211, a119
    v_add_f32 v212, v204, v208
    v_mfma_f32_16x16x32_bf16 v[36:39], a[192:195], v[232:235], v[36:39]
    v_add_f32 v213, v205, v209
    v_add_f32 v214, v206, v210
    v_mfma_f32_16x16x32_bf16 v[36:39], a[204:207], v[236:239], v[36:39]
    s_waitcnt lgkmcnt(0)
    v_add_f32 v215, v207, v211
    v_sub_f32 v204, v204, v208
    v_mfma_f32_16x16x32_bf16 v[36:39], a[216:219], v[228:231], v[36:39]
    v_sub_f32 v205, v205, v209
    v_sub_f32 v206, v206, v210
    v_mfma_f32_16x16x32_bf16 v[40:43], a[220:223], v[228:231], v[40:43]
    v_sub_f32 v207, v207, v211
    v_accvgpr_write_b32 a20, v212
    v_mfma_f32_16x16x32_bf16 v[40:43], a[208:211], v[236:239], v[40:43]
    v_accvgpr_write_b32 a21, v213
    v_accvgpr_write_b32 a22, v214
    v_mfma_f32_16x16x32_bf16 v[40:43], a[196:199], v[232:235], v[40:43]
    v_accvgpr_write_b32 a23, v215
    v_accvgpr_write_b32 a116, v204
    v_mfma_f32_16x16x32_bf16 v[44:47], a[200:203], v[232:235], v[44:47]
    ds_read_b128 v[232:235], v253 offset:14048
    v_accvgpr_write_b32 a117, v205
    v_mfma_f32_16x16x32_bf16 v[44:47], a[212:215], v[236:239], v[44:47]
    v_accvgpr_write_b32 a118, v206
    v_accvgpr_write_b32 a119, v207
    v_mfma_f32_16x16x32_bf16 v[44:47], a[224:227], v[228:231], v[44:47]
    v_accvgpr_read_b32 v204, a24
    v_accvgpr_read_b32 v205, a25
    v_mfma_f32_16x16x32_bf16 v[48:51], a[192:195], v[236:239], v[48:51]
    v_accvgpr_read_b32 v206, a26
    v_accvgpr_read_b32 v207, a27
    v_mfma_f32_16x16x32_bf16 v[48:51], a[204:207], v[228:231], v[48:51]
    s_waitcnt lgkmcnt(0)
    v_accvgpr_read_b32 v208, a120
    v_accvgpr_read_b32 v209, a121
    v_mfma_f32_16x16x32_bf16 v[48:51], a[216:219], v[232:235], v[48:51]
    v_accvgpr_read_b32 v210, a122
    v_accvgpr_read_b32 v211, a123
    v_mfma_f32_16x16x32_bf16 v[52:55], a[220:223], v[232:235], v[52:55]
    v_add_f32 v212, v204, v208
    v_add_f32 v213, v205, v209
    v_mfma_f32_16x16x32_bf16 v[52:55], a[208:211], v[228:231], v[52:55]
    v_add_f32 v214, v206, v210
    v_add_f32 v215, v207, v211
    v_mfma_f32_16x16x32_bf16 v[52:55], a[196:199], v[236:239], v[52:55]
    v_sub_f32 v204, v204, v208
    v_sub_f32 v205, v205, v209
    v_mfma_f32_16x16x32_bf16 v[56:59], a[200:203], v[236:239], v[56:59]
    ds_read_b128 v[236:239], v253 offset:13792
    v_sub_f32 v206, v206, v210
    v_mfma_f32_16x16x32_bf16 v[56:59], a[212:215], v[228:231], v[56:59]
    v_sub_f32 v207, v207, v211
    v_accvgpr_write_b32 a24, v212
    v_mfma_f32_16x16x32_bf16 v[56:59], a[224:227], v[232:235], v[56:59]
    v_accvgpr_write_b32 a25, v213
    v_accvgpr_write_b32 a26, v214
    v_mfma_f32_16x16x32_bf16 v[60:63], a[192:195], v[228:231], v[60:63]
    v_accvgpr_write_b32 a27, v215
    v_accvgpr_write_b32 a120, v204
    v_mfma_f32_16x16x32_bf16 v[60:63], a[204:207], v[232:235], v[60:63]
    s_waitcnt lgkmcnt(0)
    v_accvgpr_write_b32 a121, v205
    v_accvgpr_write_b32 a122, v206
    v_mfma_f32_16x16x32_bf16 v[60:63], a[216:219], v[236:239], v[60:63]
    v_accvgpr_write_b32 a123, v207
    v_accvgpr_read_b32 v204, a84
    v_mfma_f32_16x16x32_bf16 v[64:67], a[220:223], v[236:239], v[64:67]
    v_accvgpr_read_b32 v205, a85
    v_accvgpr_read_b32 v206, a86
    v_mfma_f32_16x16x32_bf16 v[64:67], a[208:211], v[232:235], v[64:67]
    v_accvgpr_read_b32 v207, a87
    v_accvgpr_read_b32 v208, a180
    v_mfma_f32_16x16x32_bf16 v[64:67], a[196:199], v[228:231], v[64:67]
    v_accvgpr_read_b32 v209, a181
    v_accvgpr_read_b32 v210, a182
    v_mfma_f32_16x16x32_bf16 v[68:71], a[200:203], v[228:231], v[68:71]
    ds_read_b128 v[228:231], v253 offset:13536
    v_accvgpr_read_b32 v211, a183
    v_mfma_f32_16x16x32_bf16 v[68:71], a[212:215], v[232:235], v[68:71]
    v_add_f32 v212, v204, v208
    v_add_f32 v213, v205, v209
    v_mfma_f32_16x16x32_bf16 v[68:71], a[224:227], v[236:239], v[68:71]
    v_add_f32 v214, v206, v210
    v_add_f32 v215, v207, v211
    v_mfma_f32_16x16x32_bf16 v[72:75], a[192:195], v[232:235], v[72:75]
    v_sub_f32 v204, v204, v208
    v_sub_f32 v205, v205, v209
    v_mfma_f32_16x16x32_bf16 v[72:75], a[204:207], v[236:239], v[72:75]
    s_waitcnt lgkmcnt(0)
    v_sub_f32 v206, v206, v210
    v_sub_f32 v207, v207, v211
    v_mfma_f32_16x16x32_bf16 v[72:75], a[216:219], v[228:231], v[72:75]
    v_accvgpr_write_b32 a84, v212
    v_accvgpr_write_b32 a85, v213
    v_mfma_f32_16x16x32_bf16 v[76:79], a[220:223], v[228:231], v[76:79]
    v_accvgpr_write_b32 a86, v214
    v_accvgpr_write_b32 a87, v215
    v_mfma_f32_16x16x32_bf16 v[76:79], a[208:211], v[236:239], v[76:79]
    v_accvgpr_write_b32 a180, v204
    v_accvgpr_write_b32 a181, v205
    v_mfma_f32_16x16x32_bf16 v[76:79], a[196:199], v[232:235], v[76:79]
    v_accvgpr_write_b32 a182, v206
    v_accvgpr_write_b32 a183, v207
    v_mfma_f32_16x16x32_bf16 v[80:83], a[200:203], v[232:235], v[80:83]
    ds_read_b128 v[232:235], v253 offset:13264
    v_accvgpr_read_b32 v204, a88
    v_mfma_f32_16x16x32_bf16 v[80:83], a[212:215], v[236:239], v[80:83]
    v_accvgpr_read_b32 v205, a89
    v_accvgpr_read_b32 v206, a90
    v_mfma_f32_16x16x32_bf16 v[80:83], a[224:227], v[228:231], v[80:83]
    s_mov_b32 s42, 921600
    v_accvgpr_read_b32 v207, a91
    v_accvgpr_read_b32 v208, a184
    v_mfma_f32_16x16x32_bf16 v[84:87], a[192:195], v[236:239], v[84:87]
    v_accvgpr_read_b32 v209, a185
    v_accvgpr_read_b32 v210, a186
    v_mfma_f32_16x16x32_bf16 v[88:91], a[196:199], v[236:239], v[88:91]
    v_accvgpr_read_b32 v211, a187
    v_add_f32 v212, v204, v208
    v_mfma_f32_16x16x32_bf16 v[92:95], a[200:203], v[236:239], v[92:95]
    ds_read_b128 v[236:239], v253 offset:1040
    v_add_f32 v213, v205, v209
    v_mfma_f32_16x16x32_bf16 v[92:95], a[212:215], v[228:231], v[92:95]
    buffer_load_dwordx4 a[192:195], v254, s[8:11], s42 offen offset:0 sc1
    v_mfma_f32_16x16x32_bf16 v[88:91], a[208:211], v[228:231], v[88:91]
    s_waitcnt lgkmcnt(1)
    v_add_f32 v214, v206, v210
    v_add_f32 v215, v207, v211
    v_mfma_f32_16x16x32_bf16 v[84:87], a[204:207], v[228:231], v[84:87]
    ds_read_b128 v[228:231], v253 offset:768
    v_sub_f32 v204, v204, v208
    v_mfma_f32_16x16x32_bf16 v[84:87], a[216:219], v[232:235], v[84:87]
    buffer_load_dwordx4 a[196:199], v254, s[8:11], s42 offen offset:1024 sc1
    v_mfma_f32_16x16x32_bf16 v[88:91], a[220:223], v[232:235], v[88:91]
    s_waitcnt vmcnt(8) lgkmcnt(1)
    v_sub_f32 v205, v205, v209
    v_sub_f32 v206, v206, v210
    v_mfma_f32_16x16x32_bf16 v[92:95], a[224:227], v[232:235], v[92:95]
    ds_read_b128 v[232:235], v253 offset:512
    v_sub_f32 v207, v207, v211
sub23:
    v_mfma_f32_16x16x32_bf16 v[96:99], a[228:231], v[236:239], v[96:99]
    buffer_load_dwordx4 a[200:203], v254, s[8:11], s42 offen offset:2048 sc1
    v_mfma_f32_16x16x32_bf16 v[100:103], a[232:235], v[236:239], v[100:103]
    s_mov_b32 s42, 924672
    v_accvgpr_write_b32 a88, v212
    v_accvgpr_write_b32 a89, v213
    v_mfma_f32_16x16x32_bf16 v[104:107], a[236:239], v[236:239], v[104:107]
    ds_read_b128 v[236:239], v253 offset:256
    s_waitcnt vmcnt(6)
    s_waitcnt lgkmcnt(2)
    v_mfma_f32_16x16x32_bf16 v[104:107], a[248:251], v[228:231], v[104:107]
    v_accvgpr_write_b32 a90, v214
    v_accvgpr_write_b32 a91, v215
    v_mfma_f32_16x16x32_bf16 v[100:103], a[244:247], v[228:231], v[100:103]
    buffer_load_dwordx4 a[204:207], v254, s[8:11], s42 offen offset:0 sc1
    v_mfma_f32_16x16x32_bf16 v[96:99], a[240:243], v[228:231], v[96:99]
    s_waitcnt vmcnt(4) lgkmcnt(1)
    v_accvgpr_write_b32 a184, v204
    v_accvgpr_write_b32 a185, v205
    v_mfma_f32_16x16x32_bf16 v[96:99], a[252:255], v[232:235], v[96:99]
    v_accvgpr_write_b32 a186, v206
    v_accvgpr_write_b32 a187, v207
    v_mfma_f32_16x16x32_bf16 v[100:103], v[240:243], v[232:235], v[100:103]
    v_accvgpr_read_b32 v204, a92
    v_accvgpr_read_b32 v205, a93
    v_mfma_f32_16x16x32_bf16 v[104:107], v[244:247], v[232:235], v[104:107]
    buffer_load_dwordx4 a[208:211], v254, s[8:11], s42 offen offset:1024 sc1
    v_mfma_f32_16x16x32_bf16 v[108:111], a[228:231], v[228:231], v[108:111]
    v_accvgpr_read_b32 v206, a94
    v_accvgpr_read_b32 v207, a95
    v_mfma_f32_16x16x32_bf16 v[108:111], a[240:243], v[232:235], v[108:111]
    s_waitcnt lgkmcnt(0)
    v_accvgpr_read_b32 v208, a188
    v_accvgpr_read_b32 v209, a189
    v_mfma_f32_16x16x32_bf16 v[108:111], a[252:255], v[236:239], v[108:111]
    v_accvgpr_read_b32 v210, a190
    v_accvgpr_read_b32 v211, a191
    v_mfma_f32_16x16x32_bf16 v[112:115], v[240:243], v[236:239], v[112:115]
    buffer_load_dwordx4 a[212:215], v254, s[8:11], s42 offen offset:2048 sc1
    v_mfma_f32_16x16x32_bf16 v[112:115], a[244:247], v[232:235], v[112:115]
    s_mov_b32 s42, 927744
    v_add_f32 v212, v204, v208
    v_add_f32 v213, v205, v209
    v_mfma_f32_16x16x32_bf16 v[112:115], a[232:235], v[228:231], v[112:115]
    v_add_f32 v214, v206, v210
    v_add_f32 v215, v207, v211
    v_mfma_f32_16x16x32_bf16 v[116:119], a[236:239], v[228:231], v[116:119]
    ds_read_b128 v[228:231], v253 offset:0
    v_sub_f32 v204, v204, v208
    v_mfma_f32_16x16x32_bf16 v[116:119], a[248:251], v[232:235], v[116:119]
    buffer_load_dwordx4 a[216:219], v254, s[8:11], s42 offen offset:0 sc1
    v_mfma_f32_16x16x32_bf16 v[116:119], v[244:247], v[236:239], v[116:119]
    v_sub_f32 v205, v205, v209
    v_sub_f32 v206, v206, v210
    v_mfma_f32_16x16x32_bf16 v[120:123], a[228:231], v[232:235], v[120:123]
pad8:
    s_cbranch_vccnz pad12
    v_sub_f32 v207, v207, v211
    v_accvgpr_write_b32 a92, v212
    v_mfma_f32_16x16x32_bf16 v[120:123], a[240:243], v[236:239], v[120:123]
    s_waitcnt lgkmcnt(0)
    v_accvgpr_write_b32 a93, v213
    v_accvgpr_write_b32 a94, v214
    v_mfma_f32_16x16x32_bf16 v[120:123], a[252:255], v[228:231], v[120:123]
    v_accvgpr_write_b32 a95, v215
    v_accvgpr_write_b32 a188, v204
    v_mfma_f32_16x16x32_bf16 v[124:127], v[240:243], v[228:231], v[124:127]
    buffer_load_dwordx4 a[220:223], v254, s[8:11], s42 offen offset:1024 sc1
    v_mfma_f32_16x16x32_bf16 v[124:127], a[244:247], v[236:239], v[124:127]
    v_accvgpr_write_b32 a189, v205
    v_accvgpr_write_b32 a190, v206
    v_mfma_f32_16x16x32_bf16 v[124:127], a[232:235], v[232:235], v[124:127]
    v_accvgpr_write_b32 a191, v207
    v_accvgpr_read_b32 v204, a0
    v_mfma_f32_16x16x32_bf16 v[128:131], a[236:239], v[232:235], v[128:131]
    ds_read_b128 v[232:235], v253 offset:1824
    v_accvgpr_read_b32 v205, a1
    v_mfma_f32_16x16x32_bf16 v[128:131], a[248:251], v[236:239], v[128:131]
    buffer_load_dwordx4 a[224:227], v254, s[8:11], s42 offen offset:2048 sc1
    v_mfma_f32_16x16x32_bf16 v[128:131], v[244:247], v[228:231], v[128:131]
    v_accvgpr_read_b32 v206, a2
    v_accvgpr_read_b32 v207, a3
    v_mfma_f32_16x16x32_bf16 v[132:135], a[228:231], v[236:239], v[132:135]
    v_and_b32 v252, 0x1f0, v254
    v_mul_u32_u24 v252, 96, v252
    v_mfma_f32_16x16x32_bf16 v[132:135], a[240:243], v[228:231], v[132:135]
    s_waitcnt lgkmcnt(0)
    v_add_f32 v208, v0, v96
    v_add_f32 v209, v1, v97
    v_mfma_f32_16x16x32_bf16 v[132:135], a[252:255], v[232:235], v[132:135]
    buffer_load_dword v252, v252, s[4:7], s100 offen offset:1152
    v_mfma_f32_16x16x32_bf16 v[136:139], v[240:243], v[232:235], v[136:139]
    v_add_f32 v210, v2, v98
    v_add_f32 v211, v3, v99
    v_mfma_f32_16x16x32_bf16 v[136:139], a[244:247], v[228:231], v[136:139]
    v_sub_f32 v96, v0, v96
    v_sub_f32 v97, v1, v97
    v_mfma_f32_16x16x32_bf16 v[136:139], a[232:235], v[236:239], v[136:139]
    v_sub_f32 v98, v2, v98
    v_sub_f32 v99, v3, v99
    v_mfma_f32_16x16x32_bf16 v[140:143], a[236:239], v[236:239], v[140:143]
    ds_read_b128 v[236:239], v253 offset:1568
    v_fma_f32 v0, v208, s31, v204
    v_mfma_f32_16x16x32_bf16 v[140:143], a[248:251], v[228:231], v[140:143]
    v_fma_f32 v1, v209, s31, v205
    v_fma_f32 v2, v210, s31, v206
    v_mfma_f32_16x16x32_bf16 v[140:143], v[244:247], v[232:235], v[140:143]
    v_fma_f32 v3, v211, s31, v207
    v_fmac_f32 v208, s30, v204
    v_mfma_f32_16x16x32_bf16 v[144:147], a[228:231], v[228:231], v[144:147]
    v_fmac_f32 v209, s30, v205
    v_fmac_f32 v210, s30, v206
    v_mfma_f32_16x16x32_bf16 v[144:147], a[240:243], v[232:235], v[144:147]
    s_waitcnt lgkmcnt(0)
    v_fmac_f32 v211, s30, v207
    v_cvt_pk_bf16_f32 v194, v208, v209
    v_mfma_f32_16x16x32_bf16 v[144:147], a[252:255], v[236:239], v[144:147]
    v_cvt_pk_bf16_f32 v195, v210, v211
    v_accvgpr_read_b32 v204, a4
    v_mfma_f32_16x16x32_bf16 v[148:151], v[240:243], v[236:239], v[148:151]
    v_accvgpr_read_b32 v205, a5
    v_accvgpr_read_b32 v206, a6
    v_mfma_f32_16x16x32_bf16 v[148:151], a[244:247], v[232:235], v[148:151]
    v_accvgpr_read_b32 v207, a7
    v_add_f32 v208, v4, v100
    v_mfma_f32_16x16x32_bf16 v[148:151], a[232:235], v[228:231], v[148:151]
    v_add_f32 v209, v5, v101
    v_add_f32 v210, v6, v102
    v_mfma_f32_16x16x32_bf16 v[152:155], a[236:239], v[228:231], v[152:155]
    ds_read_b128 v[228:231], v253 offset:1312
    v_add_f32 v211, v7, v103
    v_mfma_f32_16x16x32_bf16 v[152:155], a[248:251], v[232:235], v[152:155]
    v_sub_f32 v100, v4, v100
    v_sub_f32 v101, v5, v101
    v_mfma_f32_16x16x32_bf16 v[152:155], v[244:247], v[236:239], v[152:155]
    v_sub_f32 v102, v6, v102
    v_sub_f32 v103, v7, v103
    v_mfma_f32_16x16x32_bf16 v[156:159], a[228:231], v[232:235], v[156:159]
    v_fma_f32 v4, v208, s31, v204
    v_fma_f32 v5, v209, s31, v205
    v_mfma_f32_16x16x32_bf16 v[156:159], a[240:243], v[236:239], v[156:159]
    s_waitcnt lgkmcnt(0)
    v_fma_f32 v6, v210, s31, v206
    v_fma_f32 v7, v211, s31, v207
    v_mfma_f32_16x16x32_bf16 v[156:159], a[252:255], v[228:231], v[156:159]
    v_fmac_f32 v208, s30, v204
    v_fmac_f32 v209, s30, v205
    v_mfma_f32_16x16x32_bf16 v[160:163], v[240:243], v[228:231], v[160:163]
    v_fmac_f32 v210, s30, v206
    v_fmac_f32 v211, s30, v207
    v_mfma_f32_16x16x32_bf16 v[160:163], a[244:247], v[236:239], v[160:163]
    v_cvt_pk_bf16_f32 v196, v208, v209
    v_cvt_pk_bf16_f32 v197, v210, v211
    v_mfma_f32_16x16x32_bf16 v[160:163], a[232:235], v[232:235], v[160:163]
    v_accvgpr_read_b32 v204, a8
    v_accvgpr_read_b32 v205, a9
    v_mfma_f32_16x16x32_bf16 v[164:167], a[236:239], v[232:235], v[164:167]
    ds_read_b128 v[232:235], v253 offset:1056
    v_accvgpr_read_b32 v206, a10
    v_mfma_f32_16x16x32_bf16 v[164:167], a[248:251], v[236:239], v[164:167]
    v_accvgpr_read_b32 v207, a11
    v_add_f32 v208, v8, v104
    v_mfma_f32_16x16x32_bf16 v[164:167], v[244:247], v[228:231], v[164:167]
    v_add_f32 v209, v9, v105
    v_add_f32 v210, v10, v106
    v_mfma_f32_16x16x32_bf16 v[168:171], a[228:231], v[236:239], v[168:171]
    v_add_f32 v211, v11, v107
    v_sub_f32 v104, v8, v104
    v_mfma_f32_16x16x32_bf16 v[168:171], a[240:243], v[228:231], v[168:171]
    s_waitcnt lgkmcnt(0)
    v_sub_f32 v105, v9, v105
    v_sub_f32 v106, v10, v106
    v_mfma_f32_16x16x32_bf16 v[168:171], a[252:255], v[232:235], v[168:171]
    v_sub_f32 v107, v11, v107
    v_fma_f32 v8, v208, s31, v204
    v_mfma_f32_16x16x32_bf16 v[172:175], v[240:243], v[232:235], v[172:175]
    v_fma_f32 v9, v209, s31, v205
    v_fma_f32 v10, v210, s31, v206
    v_mfma_f32_16x16x32_bf16 v[172:175], a[244:247], v[228:231], v[172:175]
    v_fma_f32 v11, v211, s31, v207
    v_fmac_f32 v208, s30, v204
    v_mfma_f32_16x16x32_bf16 v[172:175], a[232:235], v[236:239], v[172:175]
    v_fmac_f32 v209, s30, v205
    v_fmac_f32 v210, s30, v206
    v_mfma_f32_16x16x32_bf16 v[176:179], a[236:239], v[236:239], v[176:179]
    ds_read_b128 v[236:239], v253 offset:784
    v_fmac_f32 v211, s30, v207
    v_mfma_f32_16x16x32_bf16 v[176:179], a[248:251], v[228:231], v[176:179]
    v_cvt_pk_bf16_f32 v198, v208, v209
    v_cvt_pk_bf16_f32 v199, v210, v211
    v_mfma_f32_16x16x32_bf16 v[176:179], v[244:247], v[232:235], v[176:179]
    s_mov_b32 s42, 958464
    v_mfma_f32_16x16x32_bf16 v[180:183], a[228:231], v[228:231], v[180:183]
    s_waitcnt lgkmcnt(0)
    v_mfma_f32_16x16x32_bf16 v[184:187], a[232:235], v[228:231], v[184:187]
    s_barrier
    v_mfma_f32_16x16x32_bf16 v[188:191], a[236:239], v[228:231], v[188:191]
    ds_read_b128 v[228:231], v253 offset:15600
    v_mfma_f32_16x16x32_bf16 v[188:191], a[248:251], v[232:235], v[188:191]
    buffer_load_dwordx4 a[228:231], v254, s[8:11], s42 offen offset:0 sc1
    v_mfma_f32_16x16x32_bf16 v[184:187], a[244:247], v[232:235], v[184:187]
    v_mfma_f32_16x16x32_bf16 v[180:183], a[240:243], v[232:235], v[180:183]
    ds_read_b128 v[232:235], v253 offset:15328
    v_mfma_f32_16x16x32_bf16 v[180:183], a[252:255], v[236:239], v[180:183]
    buffer_load_dwordx4 a[232:235], v254, s[8:11], s42 offen offset:1024 sc1
    v_mfma_f32_16x16x32_bf16 v[184:187], v[240:243], v[236:239], v[184:187]
    s_waitcnt vmcnt(9) lgkmcnt(1)
    v_mfma_f32_16x16x32_bf16 v[188:191], v[244:247], v[236:239], v[188:191]
    ds_read_b128 v[236:239], v253 offset:15072
    s_nop 0
    ds_write_b128 v248, v[194:197] offset:0
    v_accvgpr_read_b32 v204, a12
    v_accvgpr_read_b32 v205, a13
    v_accvgpr_read_b32 v206, a14
    v_accvgpr_read_b32 v207, a15
    v_pk_add_f32 v[208:209], v[12:13], v[108:109]
    v_pk_add_f32 v[210:211], v[14:15], v[110:111]
    v_pk_add_f32 v[108:109], v[12:13], v[108:109] neg_lo:[0,1] neg_hi:[0,1]
    v_pk_add_f32 v[110:111], v[14:15], v[110:111] neg_lo:[0,1] neg_hi:[0,1]
    v_pk_fma_f32 v[12:13], v[208:209], s[30:31], v[204:205] op_sel:[0,1,0]
    v_pk_fma_f32 v[14:15], v[210:211], s[30:31], v[206:207] op_sel:[0,1,0]
    v_pk_fma_f32 v[204:205], v[204:205], s[30:31], v[208:209] op_sel_hi:[1,0,1]
    v_pk_fma_f32 v[206:207], v[206:207], s[30:31], v[210:211] op_sel_hi:[1,0,1]
    v_cvt_pk_bf16_f32 v220, v204, v205
    v_cvt_pk_bf16_f32 v221, v206, v207
    ds_write_b64 v249, v[198:199] offset:64
    v_accvgpr_read_b32 v212, a16
    v_accvgpr_read_b32 v213, a17
    v_accvgpr_read_b32 v214, a18
    v_accvgpr_read_b32 v215, a19
    v_pk_add_f32 v[216:217], v[16:17], v[112:113]
    v_pk_add_f32 v[218:219], v[18:19], v[114:115]
    v_pk_add_f32 v[112:113], v[16:17], v[112:113] neg_lo:[0,1] neg_hi:[0,1]
    v_pk_add_f32 v[114:115], v[18:19], v[114:115] neg_lo:[0,1] neg_hi:[0,1]
    v_pk_fma_f32 v[16:17], v[216:217], s[30:31], v[212:213] op_sel:[0,1,0]
    v_pk_fma_f32 v[18:19], v[218:219], s[30:31], v[214:215] op_sel:[0,1,0]
    v_pk_fma_f32 v[212:213], v[212:213], s[30:31], v[216:217] op_sel_hi:[1,0,1]
    v_pk_fma_f32 v[214:215], v[214:215], s[30:31], v[218:219] op_sel_hi:[1,0,1]
    v_cvt_pk_bf16_f32 v222, v212, v213
    v_cvt_pk_bf16_f32 v223, v214, v215
    ds_write_b128 v248, v[220:223] offset:384
    v_accvgpr_read_b32 v204, a20
    v_accvgpr_read_b32 v205, a21
    v_accvgpr_read_b32 v206, a22
    v_accvgpr_read_b32 v207, a23
    v_pk_add_f32 v[208:209], v[20:21], v[116:117]
    v_pk_add_f32 v[210:211], v[22:23], v[118:119]
    v_pk_add_f32 v[116:117], v[20:21], v[116:117] neg_lo:[0,1] neg_hi:[0,1]
    v_pk_add_f32 v[118:119], v[22:23], v[118:119] neg_lo:[0,1] neg_hi:[0,1]
    v_pk_fma_f32 v[20:21], v[208:209], s[30:31], v[204:205] op_sel:[0,1,0]
    v_pk_fma_f32 v[22:23], v[210:211], s[30:31], v[206:207] op_sel:[0,1,0]
    v_pk_fma_f32 v[204:205], v[204:205], s[30:31], v[208:209] op_sel_hi:[1,0,1]
    v_pk_fma_f32 v[206:207], v[206:207], s[30:31], v[210:211] op_sel_hi:[1,0,1]
    v_cvt_pk_bf16_f32 v224, v204, v205
    v_cvt_pk_bf16_f32 v225, v206, v207
    v_accvgpr_read_b32 v204, a24
    v_accvgpr_read_b32 v205, a25
    v_accvgpr_read_b32 v206, a26
    v_accvgpr_read_b32 v207, a27
    v_pk_add_f32 v[208:209], v[24:25], v[120:121]
    v_pk_add_f32 v[210:211], v[26:27], v[122:123]
    v_pk_add_f32 v[120:121], v[24:25], v[120:121] neg_lo:[0,1] neg_hi:[0,1]
    v_pk_add_f32 v[122:123], v[26:27], v[122:123] neg_lo:[0,1] neg_hi:[0,1]
    v_pk_fma_f32 v[24:25], v[208:209], s[30:31], v[204:205] op_sel:[0,1,0]
    v_pk_fma_f32 v[26:27], v[210:211], s[30:31], v[206:207] op_sel:[0,1,0]
    v_pk_fma_f32 v[204:205], v[204:205], s[30:31], v[208:209] op_sel_hi:[1,0,1]
    v_pk_fma_f32 v[206:207], v[206:207], s[30:31], v[210:211] op_sel_hi:[1,0,1]
    v_cvt_pk_bf16_f32 v194, v204, v205
    v_cvt_pk_bf16_f32 v195, v206, v207
    ds_write_b64 v249, v[224:225] offset:448
    v_accvgpr_read_b32 v212, a28
    v_accvgpr_read_b32 v213, a29
    v_accvgpr_read_b32 v214, a30
    v_accvgpr_read_b32 v215, a31
    v_accvgpr_read_b32 v216, a124
    v_accvgpr_read_b32 v217, a125
    v_accvgpr_read_b32 v218, a126
    v_accvgpr_read_b32 v219, a127
    v_pk_add_f32 v[212:213], v[212:213], v[216:217]
    v_pk_add_f32 v[214:215], v[214:215], v[218:219]
    v_pk_add_f32 v[216:217], v[28:29], v[124:125]
    v_pk_add_f32 v[218:219], v[30:31], v[126:127]
    v_pk_add_f32 v[124:125], v[28:29], v[124:125] neg_lo:[0,1] neg_hi:[0,1]
    v_pk_add_f32 v[126:127], v[30:31], v[126:127] neg_lo:[0,1] neg_hi:[0,1]
    v_pk_fma_f32 v[28:29], v[216:217], s[30:31], v[212:213] op_sel:[0,1,0]
    v_pk_fma_f32 v[30:31], v[218:219], s[30:31], v[214:215] op_sel:[0,1,0]
    v_pk_fma_f32 v[212:213], v[212:213], s[30:31], v[216:217] op_sel_hi:[1,0,1]
    v_pk_fma_f32 v[214:215], v[214:215], s[30:31], v[218:219] op_sel_hi:[1,0,1]
    v_cvt_pk_bf16_f32 v196, v212, v213
    v_cvt_pk_bf16_f32 v197, v214, v215
    ds_write_b128 v248, v[194:197] offset:768
    v_accvgpr_read_b32 v204, a32
    v_accvgpr_read_b32 v205, a33
    v_accvgpr_read_b32 v206, a34
    v_accvgpr_read_b32 v207, a35
    v_accvgpr_read_b32 v208, a128
    v_accvgpr_read_b32 v209, a129
    v_accvgpr_read_b32 v210, a130
    v_accvgpr_read_b32 v211, a131
    v_pk_add_f32 v[204:205], v[204:205], v[208:209]
    v_pk_add_f32 v[206:207], v[206:207], v[210:211]
    v_pk_add_f32 v[208:209], v[32:33], v[128:129]
    v_pk_add_f32 v[210:211], v[34:35], v[130:131]
    v_pk_add_f32 v[128:129], v[32:33], v[128:129] neg_lo:[0,1] neg_hi:[0,1]
    v_pk_add_f32 v[130:131], v[34:35], v[130:131] neg_lo:[0,1] neg_hi:[0,1]
    v_pk_fma_f32 v[32:33], v[208:209], s[30:31], v[204:205] op_sel:[0,1,0]
    v_pk_fma_f32 v[34:35], v[210:211], s[30:31], v[206:207] op_sel:[0,1,0]
    v_pk_fma_f32 v[204:205], v[204:205], s[30:31], v[208:209] op_sel_hi:[1,0,1]
    v_pk_fma_f32 v[206:207], v[206:207], s[30:31], v[210:211] op_sel_hi:[1,0,1]
    v_cvt_pk_bf16_f32 v198, v204, v205
    v_cvt_pk_bf16_f32 v199, v206, v207
    v_accvgpr_read_b32 v204, a36
    v_accvgpr_read_b32 v205, a37
    v_accvgpr_read_b32 v206, a38
    v_accvgpr_read_b32 v207, a39
    v_accvgpr_read_b32 v208, a132
    v_accvgpr_read_b32 v209, a133
    v_accvgpr_read_b32 v210, a134
    v_accvgpr_read_b32 v211, a135
    v_pk_add_f32 v[204:205], v[204:205], v[208:209]
    v_pk_add_f32 v[206:207], v[206:207], v[210:211]
    v_pk_add_f32 v[208:209], v[36:37], v[132:133]
    v_pk_add_f32 v[210:211], v[38:39], v[134:135]
    v_pk_add_f32 v[132:133], v[36:37], v[132:133] neg_lo:[0,1] neg_hi:[0,1]
    v_pk_add_f32 v[134:135], v[38:39], v[134:135] neg_lo:[0,1] neg_hi:[0,1]
    v_pk_fma_f32 v[36:37], v[208:209], s[30:31], v[204:205] op_sel:[0,1,0]
    v_pk_fma_f32 v[38:39], v[210:211], s[30:31], v[206:207] op_sel:[0,1,0]
    v_pk_fma_f32 v[204:205], v[204:205], s[30:31], v[208:209] op_sel_hi:[1,0,1]
    v_pk_fma_f32 v[206:207], v[206:207], s[30:31], v[210:211] op_sel_hi:[1,0,1]
    v_cvt_pk_bf16_f32 v220, v204, v205
    v_cvt_pk_bf16_f32 v221, v206, v207
    ds_write_b64 v249, v[198:199] offset:832
    v_accvgpr_read_b32 v212, a40
    v_accvgpr_read_b32 v213, a41
    v_accvgpr_read_b32 v214, a42
    v_accvgpr_read_b32 v215, a43
    v_accvgpr_read_b32 v216, a136
    v_accvgpr_read_b32 v217, a137
    v_accvgpr_read_b32 v218, a138
    v_accvgpr_read_b32 v219, a139
    v_pk_add_f32 v[212:213], v[212:213], v[216:217]
    v_pk_add_f32 v[214:215], v[214:215], v[218:219]
    v_pk_add_f32 v[216:217], v[40:41], v[136:137]
    v_pk_add_f32 v[218:219], v[42:43], v[138:139]
    v_pk_add_f32 v[136:137], v[40:41], v[136:137] neg_lo:[0,1] neg_hi:[0,1]
    v_pk_add_f32 v[138:139], v[42:43], v[138:139] neg_lo:[0,1] neg_hi:[0,1]
    v_pk_fma_f32 v[40:41], v[216:217], s[30:31], v[212:213] op_sel:[0,1,0]
    v_pk_fma_f32 v[42:43], v[218:219], s[30:31], v[214:215] op_sel:[0,1,0]
    v_pk_fma_f32 v[212:213], v[212:213], s[30:31], v[216:217] op_sel_hi:[1,0,1]
    v_pk_fma_f32 v[214:215], v[214:215], s[30:31], v[218:219] op_sel_hi:[1,0,1]
    v_cvt_pk_bf16_f32 v222, v212, v213
    v_cvt_pk_bf16_f32 v223, v214, v215
    ds_write_b128 v248, v[220:223] offset:1152
    v_accvgpr_read_b32 v204, a44
    v_accvgpr_read_b32 v205, a45
    v_accvgpr_read_b32 v206, a46
    v_accvgpr_read_b32 v207, a47
    v_accvgpr_read_b32 v208, a140
    v_accvgpr_read_b32 v209, a141
    v_accvgpr_read_b32 v210, a142
    v_accvgpr_read_b32 v211, a143
    v_pk_add_f32 v[204:205], v[204:205], v[208:209]
    v_pk_add_f32 v[206:207], v[206:207], v[210:211]
    v_pk_add_f32 v[208:209], v[44:45], v[140:141]
    v_pk_add_f32 v[210:211], v[46:47], v[142:143]
    v_pk_add_f32 v[140:141], v[44:45], v[140:141] neg_lo:[0,1] neg_hi:[0,1]
    v_pk_add_f32 v[142:143], v[46:47], v[142:143] neg_lo:[0,1] neg_hi:[0,1]
    v_pk_fma_f32 v[44:45], v[208:209], s[30:31], v[204:205] op_sel:[0,1,0]
    v_pk_fma_f32 v[46:47], v[210:211], s[30:31], v[206:207] op_sel:[0,1,0]
    v_pk_fma_f32 v[204:205], v[204:205], s[30:31], v[208:209] op_sel_hi:[1,0,1]
    v_pk_fma_f32 v[206:207], v[206:207], s[30:31], v[210:211] op_sel_hi:[1,0,1]
    v_cvt_pk_bf16_f32 v224, v204, v205
    v_cvt_pk_bf16_f32 v225, v206, v207
    v_accvgpr_read_b32 v204, a48
    v_accvgpr_read_b32 v205, a49
    v_accvgpr_read_b32 v206, a50
    v_accvgpr_read_b32 v207, a51
    v_accvgpr_read_b32 v208, a144
    v_accvgpr_read_b32 v209, a145
    v_accvgpr_read_b32 v210, a146
    v_accvgpr_read_b32 v211, a147
    v_pk_add_f32 v[204:205], v[204:205], v[208:209]
    v_pk_add_f32 v[206:207], v[206:207], v[210:211]
    v_pk_add_f32 v[208:209], v[48:49], v[144:145]
    v_pk_add_f32 v[210:211], v[50:51], v[146:147]
    v_pk_add_f32 v[144:145], v[48:49], v[144:145] neg_lo:[0,1] neg_hi:[0,1]
    v_pk_add_f32 v[146:147], v[50:51], v[146:147] neg_lo:[0,1] neg_hi:[0,1]
    v_pk_fma_f32 v[48:49], v[208:209], s[30:31], v[204:205] op_sel:[0,1,0]
    v_pk_fma_f32 v[50:51], v[210:211], s[30:31], v[206:207] op_sel:[0,1,0]
    v_pk_fma_f32 v[204:205], v[204:205], s[30:31], v[208:209] op_sel_hi:[1,0,1]
    v_pk_fma_f32 v[206:207], v[206:207], s[30:31], v[210:211] op_sel_hi:[1,0,1]
    v_cvt_pk_bf16_f32 v194, v204, v205
    v_cvt_pk_bf16_f32 v195, v206, v207
    ds_write_b64 v249, v[224:225] offset:1216
    v_accvgpr_read_b32 v212, a52
    v_accvgpr_read_b32 v213, a53
    v_accvgpr_read_b32 v214, a54
    v_accvgpr_read_b32 v215, a55
    v_accvgpr_read_b32 v216, a148
    v_accvgpr_read_b32 v217, a149
    v_accvgpr_read_b32 v218, a150
    v_accvgpr_read_b32 v219, a151
    v_pk_add_f32 v[212:213], v[212:213], v[216:217]
    v_pk_add_f32 v[214:215], v[214:215], v[218:219]
    v_pk_add_f32 v[216:217], v[52:53], v[148:149]
    v_pk_add_f32 v[218:219], v[54:55], v[150:151]
    v_pk_add_f32 v[148:149], v[52:53], v[148:149] neg_lo:[0,1] neg_hi:[0,1]
    v_pk_add_f32 v[150:151], v[54:55], v[150:151] neg_lo:[0,1] neg_hi:[0,1]
    v_pk_fma_f32 v[52:53], v[216:217], s[30:31], v[212:213] op_sel:[0,1,0]
    v_pk_fma_f32 v[54:55], v[218:219], s[30:31], v[214:215] op_sel:[0,1,0]
    v_pk_fma_f32 v[212:213], v[212:213], s[30:31], v[216:217] op_sel_hi:[1,0,1]
    v_pk_fma_f32 v[214:215], v[214:215], s[30:31], v[218:219] op_sel_hi:[1,0,1]
    v_cvt_pk_bf16_f32 v196, v212, v213
    v_cvt_pk_bf16_f32 v197, v214, v215
    ds_write_b128 v248, v[194:197] offset:1536
    v_accvgpr_read_b32 v204, a56
    v_accvgpr_read_b32 v205, a57
    v_accvgpr_read_b32 v206, a58
    v_accvgpr_read_b32 v207, a59
    v_accvgpr_read_b32 v208, a152
    v_accvgpr_read_b32 v209, a153
    v_accvgpr_read_b32 v210, a154
    v_accvgpr_read_b32 v211, a155
    v_pk_add_f32 v[204:205], v[204:205], v[208:209]
    v_pk_add_f32 v[206:207], v[206:207], v[210:211]
    v_pk_add_f32 v[208:209], v[56:57], v[152:153]
    v_pk_add_f32 v[210:211], v[58:59], v[154:155]
    v_pk_add_f32 v[152:153], v[56:57], v[152:153] neg_lo:[0,1] neg_hi:[0,1]
    v_pk_add_f32 v[154:155], v[58:59], v[154:155] neg_lo:[0,1] neg_hi:[0,1]
    v_pk_fma_f32 v[56:57], v[208:209], s[30:31], v[204:205] op_sel:[0,1,0]
    v_pk_fma_f32 v[58:59], v[210:211], s[30:31], v[206:207] op_sel:[0,1,0]
    v_pk_fma_f32 v[204:205], v[204:205], s[30:31], v[208:209] op_sel_hi:[1,0,1]
    v_pk_fma_f32 v[206:207], v[206:207], s[30:31], v[210:211] op_sel_hi:[1,0,1]
    v_cvt_pk_bf16_f32 v198, v204, v205
    v_cvt_pk_bf16_f32 v199, v206, v207
    v_accvgpr_read_b32 v204, a60
    v_accvgpr_read_b32 v205, a61
    v_accvgpr_read_b32 v206, a62
    v_accvgpr_read_b32 v207, a63
    v_accvgpr_read_b32 v208, a156
    v_accvgpr_read_b32 v209, a157
    v_accvgpr_read_b32 v210, a158
    v_accvgpr_read_b32 v211, a159
    v_pk_add_f32 v[204:205], v[204:205], v[208:209]
    v_pk_add_f32 v[206:207], v[206:207], v[210:211]
    v_pk_add_f32 v[208:209], v[60:61], v[156:157]
    v_pk_add_f32 v[210:211], v[62:63], v[158:159]
    v_pk_add_f32 v[156:157], v[60:61], v[156:157] neg_lo:[0,1] neg_hi:[0,1]
    v_pk_add_f32 v[158:159], v[62:63], v[158:159] neg_lo:[0,1] neg_hi:[0,1]
    v_pk_fma_f32 v[60:61], v[208:209], s[30:31], v[204:205] op_sel:[0,1,0]
    v_pk_fma_f32 v[62:63], v[210:211], s[30:31], v[206:207] op_sel:[0,1,0]
    v_pk_fma_f32 v[204:205], v[204:205], s[30:31], v[208:209] op_sel_hi:[1,0,1]
    v_pk_fma_f32 v[206:207], v[206:207], s[30:31], v[210:211] op_sel_hi:[1,0,1]
    v_cvt_pk_bf16_f32 v220, v204, v205
    v_cvt_pk_bf16_f32 v221, v206, v207
    ds_write_b64 v249, v[198:199] offset:1600
    v_accvgpr_read_b32 v212, a64
    v_accvgpr_read_b32 v213, a65
    v_accvgpr_read_b32 v214, a66
    v_accvgpr_read_b32 v215, a67
    v_accvgpr_read_b32 v216, a160
    v_accvgpr_read_b32 v217, a161
    v_accvgpr_read_b32 v218, a162
    v_accvgpr_read_b32 v219, a163
    v_pk_add_f32 v[212:213], v[212:213], v[216:217]
    v_pk_add_f32 v[214:215], v[214:215], v[218:219]
    v_pk_add_f32 v[216:217], v[64:65], v[160:161]
    v_pk_add_f32 v[218:219], v[66:67], v[162:163]
    v_pk_add_f32 v[160:161], v[64:65], v[160:161] neg_lo:[0,1] neg_hi:[0,1]
    v_pk_add_f32 v[162:163], v[66:67], v[162:163] neg_lo:[0,1] neg_hi:[0,1]
    v_pk_fma_f32 v[64:65], v[216:217], s[30:31], v[212:213] op_sel:[0,1,0]
    v_pk_fma_f32 v[66:67], v[218:219], s[30:31], v[214:215] op_sel:[0,1,0]
    v_pk_fma_f32 v[212:213], v[212:213], s[30:31], v[216:217] op_sel_hi:[1,0,1]
    v_pk_fma_f32 v[214:215], v[214:215], s[30:31], v[218:219] op_sel_hi:[1,0,1]
    v_cvt_pk_bf16_f32 v222, v212, v213
    v_cvt_pk_bf16_f32 v223, v214, v215
    ds_write_b128 v248, v[220:223] offset:1920
    v_accvgpr_read_b32 v204, a68
    v_accvgpr_read_b32 v205, a69
    v_accvgpr_read_b32 v206, a70
    v_accvgpr_read_b32 v207, a71
    v_accvgpr_read_b32 v208, a164
    v_accvgpr_read_b32 v209, a165
    v_accvgpr_read_b32 v210, a166
    v_accvgpr_read_b32 v211, a167
    v_pk_add_f32 v[204:205], v[204:205], v[208:209]
    v_pk_add_f32 v[206:207], v[206:207], v[210:211]
    v_pk_add_f32 v[208:209], v[68:69], v[164:165]
    v_pk_add_f32 v[210:211], v[70:71], v[166:167]
    v_pk_add_f32 v[164:165], v[68:69], v[164:165] neg_lo:[0,1] neg_hi:[0,1]
    v_pk_add_f32 v[166:167], v[70:71], v[166:167] neg_lo:[0,1] neg_hi:[0,1]
    v_pk_fma_f32 v[68:69], v[208:209], s[30:31], v[204:205] op_sel:[0,1,0]
    v_pk_fma_f32 v[70:71], v[210:211], s[30:31], v[206:207] op_sel:[0,1,0]
    v_pk_fma_f32 v[204:205], v[204:205], s[30:31], v[208:209] op_sel_hi:[1,0,1]
    v_pk_fma_f32 v[206:207], v[206:207], s[30:31], v[210:211] op_sel_hi:[1,0,1]
    v_cvt_pk_bf16_f32 v224, v204, v205
    v_cvt_pk_bf16_f32 v225, v206, v207
    v_accvgpr_read_b32 v204, a72
    v_accvgpr_read_b32 v205, a73
    v_accvgpr_read_b32 v206, a74
    v_accvgpr_read_b32 v207, a75
    v_accvgpr_read_b32 v208, a168
    v_accvgpr_read_b32 v209, a169
    v_accvgpr_read_b32 v210, a170
    v_accvgpr_read_b32 v211, a171
    v_pk_add_f32 v[204:205], v[204:205], v[208:209]
    v_pk_add_f32 v[206:207], v[206:207], v[210:211]
    v_pk_add_f32 v[208:209], v[72:73], v[168:169]
    v_pk_add_f32 v[210:211], v[74:75], v[170:171]
    v_pk_add_f32 v[168:169], v[72:73], v[168:169] neg_lo:[0,1] neg_hi:[0,1]
    v_pk_add_f32 v[170:171], v[74:75], v[170:171] neg_lo:[0,1] neg_hi:[0,1]
    v_pk_fma_f32 v[72:73], v[208:209], s[30:31], v[204:205] op_sel:[0,1,0]
    v_pk_fma_f32 v[74:75], v[210:211], s[30:31], v[206:207] op_sel:[0,1,0]
    v_pk_fma_f32 v[204:205], v[204:205], s[30:31], v[208:209] op_sel_hi:[1,0,1]
    v_pk_fma_f32 v[206:207], v[206:207], s[30:31], v[210:211] op_sel_hi:[1,0,1]
    v_cvt_pk_bf16_f32 v194, v204, v205
    v_cvt_pk_bf16_f32 v195, v206, v207
    ds_write_b64 v249, v[224:225] offset:1984
    v_accvgpr_read_b32 v212, a76
    v_accvgpr_read_b32 v213, a77
    v_accvgpr_read_b32 v214, a78
    v_accvgpr_read_b32 v215, a79
    v_accvgpr_read_b32 v216, a172
    v_accvgpr_read_b32 v217, a173
    v_accvgpr_read_b32 v218, a174
    v_accvgpr_read_b32 v219, a175
    v_pk_add_f32 v[212:213], v[212:213], v[216:217]
    v_pk_add_f32 v[214:215], v[214:215], v[218:219]
    v_pk_add_f32 v[216:217], v[76:77], v[172:173]
    v_pk_add_f32 v[218:219], v[78:79], v[174:175]
    v_pk_add_f32 v[172:173], v[76:77], v[172:173] neg_lo:[0,1] neg_hi:[0,1]
    v_pk_add_f32 v[174:175], v[78:79], v[174:175] neg_lo:[0,1] neg_hi:[0,1]
    v_pk_fma_f32 v[76:77], v[216:217], s[30:31], v[212:213] op_sel:[0,1,0]
    v_pk_fma_f32 v[78:79], v[218:219], s[30:31], v[214:215] op_sel:[0,1,0]
    v_pk_fma_f32 v[212:213], v[212:213], s[30:31], v[216:217] op_sel_hi:[1,0,1]
    v_pk_fma_f32 v[214:215], v[214:215], s[30:31], v[218:219] op_sel_hi:[1,0,1]
    v_cvt_pk_bf16_f32 v196, v212, v213
    v_cvt_pk_bf16_f32 v197, v214, v215
    ds_write_b128 v248, v[194:197] offset:2304
    v_accvgpr_read_b32 v204, a80
    v_accvgpr_read_b32 v205, a81
    v_accvgpr_read_b32 v206, a82
    v_accvgpr_read_b32 v207, a83
    v_accvgpr_read_b32 v208, a176
    v_accvgpr_read_b32 v209, a177
    v_accvgpr_read_b32 v210, a178
    v_accvgpr_read_b32 v211, a179
    v_pk_add_f32 v[204:205], v[204:205], v[208:209]
    v_pk_add_f32 v[206:207], v[206:207], v[210:211]
    v_pk_add_f32 v[208:209], v[80:81], v[176:177]
    v_pk_add_f32 v[210:211], v[82:83], v[178:179]
    v_pk_add_f32 v[176:177], v[80:81], v[176:177] neg_lo:[0,1] neg_hi:[0,1]
    v_pk_add_f32 v[178:179], v[82:83], v[178:179] neg_lo:[0,1] neg_hi:[0,1]
    v_pk_fma_f32 v[80:81], v[208:209], s[30:31], v[204:205] op_sel:[0,1,0]
    v_pk_fma_f32 v[82:83], v[210:211], s[30:31], v[206:207] op_sel:[0,1,0]
    v_pk_fma_f32 v[204:205], v[204:205], s[30:31], v[208:209] op_sel_hi:[1,0,1]
    v_pk_fma_f32 v[206:207], v[206:207], s[30:31], v[210:211] op_sel_hi:[1,0,1]
    v_cvt_pk_bf16_f32 v198, v204, v205
    v_cvt_pk_bf16_f32 v199, v206, v207
    ds_write_b64 v249, v[198:199] offset:2368
    s_waitcnt lgkmcnt(0)
    s_barrier
sub24:
    v_mfma_f32_16x16x32_bf16 v[0:3], a[192:195], v[228:231], v[0:3]
    buffer_load_dwordx4 a[236:239], v254, s[8:11], s42 offen offset:2048 sc1
    v_mfma_f32_16x16x32_bf16 v[4:7], a[196:199], v[228:231], v[4:7]
    s_mov_b32 s42, 961536
    v_accvgpr_read_b32 v204, a84
    v_accvgpr_read_b32 v205, a85
    v_mfma_f32_16x16x32_bf16 v[8:11], a[200:203], v[228:231], v[8:11]
    ds_read_b128 v[228:231], v253 offset:14816
    s_waitcnt vmcnt(7)
    v_mfma_f32_16x16x32_bf16 v[8:11], a[212:215], v[232:235], v[8:11]
    ds_read_b128 v[212:215], v250 offset:0
    v_accvgpr_read_b32 v206, a86
    v_mfma_f32_16x16x32_bf16 v[4:7], a[208:211], v[232:235], v[4:7]
    buffer_load_dwordx4 a[240:243], v254, s[8:11], s42 offen offset:0 sc1
    v_mfma_f32_16x16x32_bf16 v[0:3], a[204:207], v[232:235], v[0:3]
    s_waitcnt vmcnt(5)
    v_accvgpr_read_b32 v207, a87
    v_add_f32 v208, v84, v180
    v_mfma_f32_16x16x32_bf16 v[0:3], a[216:219], v[236:239], v[0:3]
    ds_read_b128 v[216:219], v250 offset:3104
    v_add_f32 v209, v85, v181
    v_mfma_f32_16x16x32_bf16 v[4:7], a[220:223], v[236:239], v[4:7]
    ds_read_b128 v[220:223], v250 offset:6208
    s_add_u32 s44, s40, 393216
    v_mfma_f32_16x16x32_bf16 v[8:11], a[224:227], v[236:239], v[8:11]
    buffer_load_dwordx4 a[244:247], v254, s[8:11], s42 offen offset:1024 sc1
    v_mfma_f32_16x16x32_bf16 v[12:15], a[192:195], v[232:235], v[12:15]
    ds_read_b128 v[224:227], v250 offset:9312
    v_add_f32 v210, v86, v182
    v_mfma_f32_16x16x32_bf16 v[12:15], a[204:207], v[236:239], v[12:15]
    s_waitcnt lgkmcnt(4)
    v_add_f32 v211, v87, v183
    v_sub_f32 v180, v84, v180
    v_mfma_f32_16x16x32_bf16 v[12:15], a[216:219], v[228:231], v[12:15]
pad9:
    s_cbranch_vccnz pad13
    s_waitcnt lgkmcnt(3)
    v_sub_f32 v181, v85, v181
    v_sub_f32 v182, v86, v182
    v_mfma_f32_16x16x32_bf16 v[16:19], a[220:223], v[228:231], v[16:19]
    buffer_load_dwordx4 a[248:251], v254, s[8:11], s42 offen offset:2048 sc1
    v_mfma_f32_16x16x32_bf16 v[16:19], a[208:211], v[236:239], v[16:19]
    s_mov_b32 s42, 964608
    v_sub_f32 v183, v87, v183
    v_fma_f32 v84, v208, s31, v204
    v_mfma_f32_16x16x32_bf16 v[16:19], a[196:199], v[232:235], v[16:19]
    v_fma_f32 v85, v209, s31, v205
    v_fma_f32 v86, v210, s31, v206
    v_mfma_f32_16x16x32_bf16 v[20:23], a[200:203], v[232:235], v[20:23]
    ds_read_b128 v[232:235], v253 offset:14560
    v_fma_f32 v87, v211, s31, v207
    v_mfma_f32_16x16x32_bf16 v[20:23], a[212:215], v[236:239], v[20:23]
    buffer_load_dwordx4 a[252:255], v254, s[8:11], s42 offen offset:0 sc1
    v_mfma_f32_16x16x32_bf16 v[20:23], a[224:227], v[228:231], v[20:23]
    v_fmac_f32 v208, s30, v204
    v_fmac_f32 v209, s30, v205
    v_mfma_f32_16x16x32_bf16 v[24:27], a[192:195], v[236:239], v[24:27]
    v_fmac_f32 v210, s30, v206
    v_fmac_f32 v211, s30, v207
    v_mfma_f32_16x16x32_bf16 v[24:27], a[204:207], v[228:231], v[24:27]
    s_waitcnt lgkmcnt(0)
    v_cvt_pk_bf16_f32 v192, v208, v209
    v_cvt_pk_bf16_f32 v193, v210, v211
    v_mfma_f32_16x16x32_bf16 v[24:27], a[216:219], v[232:235], v[24:27]
    v_accvgpr_read_b32 v204, a88
    v_accvgpr_read_b32 v205, a89
    v_mfma_f32_16x16x32_bf16 v[28:31], a[220:223], v[232:235], v[28:31]
    buffer_load_dwordx4 v[240:243], v254, s[8:11], s42 offen offset:1024 sc1
    v_mfma_f32_16x16x32_bf16 v[28:31], a[208:211], v[228:231], v[28:31]
    v_accvgpr_read_b32 v206, a90
    v_accvgpr_read_b32 v207, a91
    v_mfma_f32_16x16x32_bf16 v[28:31], a[196:199], v[236:239], v[28:31]
    v_add_f32 v208, v88, v184
    v_add_f32 v209, v89, v185
    v_mfma_f32_16x16x32_bf16 v[32:35], a[200:203], v[236:239], v[32:35]
    ds_read_b128 v[236:239], v253 offset:16384
    v_add_f32 v210, v90, v186
    v_mfma_f32_16x16x32_bf16 v[32:35], a[212:215], v[228:231], v[32:35]
    buffer_load_dwordx4 v[244:247], v254, s[8:11], s42 offen offset:2048 sc1
    v_mfma_f32_16x16x32_bf16 v[32:35], a[224:227], v[232:235], v[32:35]
    v_add_f32 v211, v91, v187
    v_sub_f32 v184, v88, v184
    v_mfma_f32_16x16x32_bf16 v[36:39], a[192:195], v[228:231], v[36:39]
    v_sub_f32 v185, v89, v185
    v_sub_f32 v186, v90, v186
    v_mfma_f32_16x16x32_bf16 v[36:39], a[204:207], v[232:235], v[36:39]
    s_waitcnt lgkmcnt(0)
    v_sub_f32 v187, v91, v187
    v_fma_f32 v88, v208, s31, v204
    v_mfma_f32_16x16x32_bf16 v[36:39], a[216:219], v[236:239], v[36:39]
    buffer_store_dwordx4 v[212:215], v254, s[12:15], s44 offen nt
    s_add_u32 s44, s40, 396288
    v_mfma_f32_16x16x32_bf16 v[40:43], a[220:223], v[236:239], v[40:43]
    v_fma_f32 v89, v209, s31, v205
    v_fma_f32 v90, v210, s31, v206
    v_mfma_f32_16x16x32_bf16 v[40:43], a[208:211], v[232:235], v[40:43]
    v_fma_f32 v91, v211, s31, v207
    v_fmac_f32 v208, s30, v204
    v_mfma_f32_16x16x32_bf16 v[40:43], a[196:199], v[228:231], v[40:43]
    buffer_store_dwordx4 v[216:219], v254, s[12:15], s44 offen nt
    v_fmac_f32 v209, s30, v205
    v_fmac_f32 v210, s30, v206
    v_mfma_f32_16x16x32_bf16 v[44:47], a[200:203], v[228:231], v[44:47]
    ds_read_b128 v[228:231], v253 offset:16128
    v_fmac_f32 v211, s30, v207
    v_mfma_f32_16x16x32_bf16 v[44:47], a[212:215], v[232:235], v[44:47]
    ds_read_b128 v[212:215], v250 offset:1024
    v_cvt_pk_bf16_f32 v194, v208, v209
    v_mfma_f32_16x16x32_bf16 v[44:47], a[224:227], v[236:239], v[44:47]
    s_add_u32 s44, s40, 399360
    v_cvt_pk_bf16_f32 v195, v210, v211
    v_accvgpr_read_b32 v204, a92
    v_mfma_f32_16x16x32_bf16 v[48:51], a[192:195], v[232:235], v[48:51]
    ds_read_b128 v[216:219], v250 offset:4128
    v_accvgpr_read_b32 v205, a93
    v_mfma_f32_16x16x32_bf16 v[48:51], a[204:207], v[236:239], v[48:51]
    s_waitcnt lgkmcnt(2)
    v_accvgpr_read_b32 v206, a94
    v_accvgpr_read_b32 v207, a95
    v_mfma_f32_16x16x32_bf16 v[48:51], a[216:219], v[228:231], v[48:51]
    v_add_f32 v208, v92, v188
    v_add_f32 v209, v93, v189
    v_mfma_f32_16x16x32_bf16 v[52:55], a[220:223], v[228:231], v[52:55]
    v_add_f32 v210, v94, v190
    v_add_f32 v211, v95, v191
    v_mfma_f32_16x16x32_bf16 v[52:55], a[208:211], v[236:239], v[52:55]
    v_sub_f32 v188, v92, v188
    v_sub_f32 v189, v93, v189
    v_mfma_f32_16x16x32_bf16 v[52:55], a[196:199], v[232:235], v[52:55]
    v_sub_f32 v190, v94, v190
    v_sub_f32 v191, v95, v191
    v_mfma_f32_16x16x32_bf16 v[56:59], a[200:203], v[232:235], v[56:59]
    ds_read_b128 v[232:235], v253 offset:15872
    v_fma_f32 v92, v208, s31, v204
    v_mfma_f32_16x16x32_bf16 v[56:59], a[212:215], v[236:239], v[56:59]
    v_fma_f32 v93, v209, s31, v205
    v_fma_f32 v94, v210, s31, v206
    v_mfma_f32_16x16x32_bf16 v[56:59], a[224:227], v[228:231], v[56:59]
    buffer_store_dwordx4 v[220:223], v254, s[12:15], s44 offen nt
    v_fma_f32 v95, v211, s31, v207
    v_fmac_f32 v208, s30, v204
    v_mfma_f32_16x16x32_bf16 v[60:63], a[192:195], v[236:239], v[60:63]
    v_fmac_f32 v209, s30, v205
    v_fmac_f32 v210, s30, v206
    v_mfma_f32_16x16x32_bf16 v[60:63], a[204:207], v[228:231], v[60:63]
    s_waitcnt lgkmcnt(0)
    v_fmac_f32 v211, s30, v207
    v_cvt_pk_bf16_f32 v196, v208, v209
    v_mfma_f32_16x16x32_bf16 v[60:63], a[216:219], v[232:235], v[60:63]
    v_cvt_pk_bf16_f32 v197, v210, v211
    v_accvgpr_read_b32 v204, a96
    v_mfma_f32_16x16x32_bf16 v[64:67], a[220:223], v[232:235], v[64:67]
    ds_write_b64 v249, v[196:197] offset:2752
    v_mfma_f32_16x16x32_bf16 v[64:67], a[208:211], v[228:231], v[64:67]
    s_add_u32 s44, s40, 402432
    v_accvgpr_read_b32 v205, a97
    v_accvgpr_read_b32 v206, a98
    v_mfma_f32_16x16x32_bf16 v[64:67], a[196:199], v[236:239], v[64:67]
    ds_write_b128 v248, v[192:195] offset:2688
    v_mfma_f32_16x16x32_bf16 v[68:71], a[200:203], v[236:239], v[68:71]
    ds_read_b128 v[236:239], v253 offset:15616
    v_accvgpr_read_b32 v207, a99
    v_fma_f32 v208, v204, s34, v96 div:2
    v_mfma_f32_16x16x32_bf16 v[68:71], a[212:215], v[228:231], v[68:71]
    v_fma_f32 v209, v205, s34, v97 div:2
    v_fma_f32 v210, v206, s34, v98 div:2
    v_mfma_f32_16x16x32_bf16 v[68:71], a[224:227], v[232:235], v[68:71]
    v_fma_f32 v211, v207, s34, v99 div:2
    v_fma_f32 v96, v204, s35, v96 mul:2
    v_mfma_f32_16x16x32_bf16 v[72:75], a[192:195], v[228:231], v[72:75]
    v_fma_f32 v97, v205, s35, v97 mul:2
    v_fma_f32 v98, v206, s35, v98 mul:2
    v_mfma_f32_16x16x32_bf16 v[72:75], a[204:207], v[232:235], v[72:75]
    s_waitcnt lgkmcnt(0)
    v_fma_f32 v99, v207, s35, v99 mul:2
    v_cvt_pk_bf16_f32 v198, v208, v209
    v_mfma_f32_16x16x32_bf16 v[72:75], a[216:219], v[236:239], v[72:75]
    v_cvt_pk_bf16_f32 v199, v210, v211
    v_accvgpr_write_b32 a0, v198
    v_mfma_f32_16x16x32_bf16 v[76:79], a[220:223], v[236:239], v[76:79]
    v_accvgpr_write_b32 a1, v199
    v_accvgpr_read_b32 v204, a100
    v_mfma_f32_16x16x32_bf16 v[76:79], a[208:211], v[232:235], v[76:79]
    buffer_store_dwordx4 v[224:227], v254, s[12:15], s44 offen nt
    v_accvgpr_read_b32 v205, a101
    v_accvgpr_read_b32 v206, a102
    v_mfma_f32_16x16x32_bf16 v[76:79], a[196:199], v[228:231], v[76:79]
    v_accvgpr_read_b32 v207, a103
    v_fma_f32 v208, v204, s34, v100 div:2
    v_mfma_f32_16x16x32_bf16 v[80:83], a[200:203], v[228:231], v[80:83]
    ds_read_b128 v[228:231], v253 offset:15344
    v_fma_f32 v209, v205, s34, v101 div:2
    v_mfma_f32_16x16x32_bf16 v[80:83], a[212:215], v[232:235], v[80:83]
    v_fma_f32 v210, v206, s34, v102 div:2
    v_fma_f32 v211, v207, s34, v103 div:2
    v_fma_f32 v100, v204, s35, v100 mul:2
    v_mfma_f32_16x16x32_bf16 v[80:83], a[224:227], v[236:239], v[80:83]
    s_mov_b32 s42, 995328
    v_fma_f32 v101, v205, s35, v101 mul:2
    v_fma_f32 v102, v206, s35, v102 mul:2
    v_mfma_f32_16x16x32_bf16 v[84:87], a[192:195], v[232:235], v[84:87]
    s_waitcnt lgkmcnt(0)
    v_fma_f32 v103, v207, s35, v103 mul:2
    v_cvt_pk_bf16_f32 v200, v208, v209
    v_mfma_f32_16x16x32_bf16 v[88:91], a[196:199], v[232:235], v[88:91]
    s_barrier
    v_mfma_f32_16x16x32_bf16 v[92:95], a[200:203], v[232:235], v[92:95]
    ds_read_b128 v[232:235], v253 offset:17680
    v_cvt_pk_bf16_f32 v201, v210, v211
    v_mfma_f32_16x16x32_bf16 v[92:95], a[212:215], v[236:239], v[92:95]
    buffer_load_dwordx4 a[192:195], v254, s[8:11], s42 offen offset:0 sc1
    v_mfma_f32_16x16x32_bf16 v[88:91], a[208:211], v[236:239], v[88:91]
    v_accvgpr_write_b32 a2, v200
    v_accvgpr_write_b32 a3, v201
    v_mfma_f32_16x16x32_bf16 v[84:87], a[204:207], v[236:239], v[84:87]
    ds_read_b128 v[236:239], v253 offset:17408
    v_accvgpr_read_b32 v204, a104
    v_mfma_f32_16x16x32_bf16 v[84:87], a[216:219], v[228:231], v[84:87]
    buffer_load_dwordx4 a[196:199], v254, s[8:11], s42 offen offset:1024 sc1
    v_mfma_f32_16x16x32_bf16 v[88:91], a[220:223], v[228:231], v[88:91]
    s_waitcnt vmcnt(12) lgkmcnt(1)
    v_accvgpr_read_b32 v205, a105
    v_accvgpr_read_b32 v206, a106
    v_mfma_f32_16x16x32_bf16 v[92:95], a[224:227], v[228:231], v[92:95]
    ds_read_b128 v[228:231], v253 offset:17152
    v_accvgpr_read_b32 v207, a107
    v_fma_f32 v208, v204, s34, v104 div:2
sub25:
    v_mfma_f32_16x16x32_bf16 v[0:3], a[228:231], v[232:235], v[0:3]
    buffer_load_dwordx4 a[200:203], v254, s[8:11], s42 offen offset:2048 sc1
    v_mfma_f32_16x16x32_bf16 v[4:7], a[232:235], v[232:235], v[4:7]
    s_mov_b32 s42, 998400
    v_fma_f32 v209, v205, s34, v105 div:2
    v_fma_f32 v210, v206, s34, v106 div:2
    v_mfma_f32_16x16x32_bf16 v[8:11], a[236:239], v[232:235], v[8:11]
    ds_read_b128 v[232:235], v253 offset:16896
    s_waitcnt vmcnt(10)
    s_waitcnt lgkmcnt(2)
    v_mfma_f32_16x16x32_bf16 v[8:11], a[248:251], v[236:239], v[8:11]
    v_fma_f32 v211, v207, s34, v107 div:2
    v_fma_f32 v104, v204, s35, v104 mul:2
    v_mfma_f32_16x16x32_bf16 v[4:7], a[244:247], v[236:239], v[4:7]
    buffer_load_dwordx4 a[204:207], v254, s[8:11], s42 offen offset:0 sc1
    v_mfma_f32_16x16x32_bf16 v[0:3], a[240:243], v[236:239], v[0:3]
    s_waitcnt vmcnt(8) lgkmcnt(1)
    v_fma_f32 v105, v205, s35, v105 mul:2
    v_fma_f32 v106, v206, s35, v106 mul:2
    v_mfma_f32_16x16x32_bf16 v[0:3], a[252:255], v[228:231], v[0:3]
    s_add_u32 s44, s40, 394240
    v_fma_f32 v107, v207, s35, v107 mul:2
    v_cvt_pk_bf16_f32 v202, v208, v209
    v_mfma_f32_16x16x32_bf16 v[4:7], v[240:243], v[228:231], v[4:7]
    v_cvt_pk_bf16_f32 v203, v210, v211
    v_accvgpr_write_b32 a4, v202
    v_mfma_f32_16x16x32_bf16 v[8:11], v[244:247], v[228:231], v[8:11]
    buffer_load_dwordx4 a[208:211], v254, s[8:11], s42 offen offset:1024 sc1
    v_mfma_f32_16x16x32_bf16 v[12:15], a[228:231], v[236:239], v[12:15]
    v_accvgpr_write_b32 a5, v203
    v_accvgpr_read_b32 v204, a108
    v_accvgpr_read_b32 v205, a109
    v_mfma_f32_16x16x32_bf16 v[12:15], a[240:243], v[228:231], v[12:15]
    s_waitcnt lgkmcnt(0)
    v_accvgpr_read_b32 v206, a110
    v_accvgpr_read_b32 v207, a111
    v_mfma_f32_16x16x32_bf16 v[12:15], a[252:255], v[232:235], v[12:15]
    v_fma_f32 v208, v204, s34, v108 div:2
    v_fma_f32 v209, v205, s34, v109 div:2
    v_mfma_f32_16x16x32_bf16 v[16:19], v[240:243], v[232:235], v[16:19]
    buffer_load_dwordx4 a[212:215], v254, s[8:11], s42 offen offset:2048 sc1
    v_mfma_f32_16x16x32_bf16 v[16:19], a[244:247], v[228:231], v[16:19]
    s_mov_b32 s42, 1001472
    v_fma_f32 v210, v206, s34, v110 div:2
    v_fma_f32 v211, v207, s34, v111 div:2
    v_mfma_f32_16x16x32_bf16 v[16:19], a[232:235], v[236:239], v[16:19]
    v_fma_f32 v108, v204, s35, v108 mul:2
    v_fma_f32 v109, v205, s35, v109 mul:2
    v_mfma_f32_16x16x32_bf16 v[20:23], a[236:239], v[236:239], v[20:23]
    ds_read_b128 v[236:239], v253 offset:16640
    v_fma_f32 v110, v206, s35, v110 mul:2
    v_mfma_f32_16x16x32_bf16 v[20:23], a[248:251], v[228:231], v[20:23]
    buffer_load_dwordx4 a[216:219], v254, s[8:11], s42 offen offset:0 sc1
    v_mfma_f32_16x16x32_bf16 v[20:23], v[244:247], v[232:235], v[20:23]
    v_fma_f32 v111, v207, s35, v111 mul:2
    v_cvt_pk_bf16_f32 v192, v208, v209
    v_mfma_f32_16x16x32_bf16 v[24:27], a[228:231], v[228:231], v[24:27]
    v_cvt_pk_bf16_f32 v193, v210, v211
    v_accvgpr_write_b32 a12, v192
    v_mfma_f32_16x16x32_bf16 v[24:27], a[240:243], v[232:235], v[24:27]
    s_waitcnt lgkmcnt(0)
    v_accvgpr_write_b32 a13, v193
    v_accvgpr_read_b32 v204, a112
    v_accvgpr_read_b32 v205, a113
    v_mfma_f32_16x16x32_bf16 v[24:27], a[252:255], v[236:239], v[24:27]
    ds_read_b128 a[84:87], v250 offset:7232
    v_accvgpr_read_b32 v206, a114
    v_mfma_f32_16x16x32_bf16 v[28:31], v[240:243], v[236:239], v[28:31]
    buffer_load_dwordx4 a[220:223], v254, s[8:11], s42 offen offset:1024 sc1
    v_mfma_f32_16x16x32_bf16 v[28:31], a[244:247], v[232:235], v[28:31]
    v_accvgpr_read_b32 v207, a115
    v_fma_f32 v208, v204, s34, v112 div:2
    v_mfma_f32_16x16x32_bf16 v[28:31], a[232:235], v[228:231], v[28:31]
    v_fma_f32 v209, v205, s34, v113 div:2
    v_fma_f32 v210, v206, s34, v114 div:2
    v_mfma_f32_16x16x32_bf16 v[32:35], a[236:239], v[228:231], v[32:35]
    ds_read_b128 v[228:231], v253 offset:18464
    v_fma_f32 v211, v207, s34, v115 div:2
    v_mfma_f32_16x16x32_bf16 v[32:35], a[248:251], v[232:235], v[32:35]
    buffer_load_dwordx4 a[224:227], v254, s[8:11], s42 offen offset:2048 sc1
    v_mfma_f32_16x16x32_bf16 v[32:35], v[244:247], v[236:239], v[32:35]
    ds_read_b128 a[88:91], v250 offset:10336
    v_fma_f32 v112, v204, s35, v112 mul:2
    v_mfma_f32_16x16x32_bf16 v[36:39], a[228:231], v[232:235], v[36:39]
    v_fma_f32 v113, v205, s35, v113 mul:2
    v_fma_f32 v114, v206, s35, v114 mul:2
    v_mfma_f32_16x16x32_bf16 v[36:39], a[240:243], v[236:239], v[36:39]
    s_waitcnt lgkmcnt(1)
    v_fma_f32 v115, v207, s35, v115 mul:2
    v_cvt_pk_bf16_f32 v194, v208, v209
    v_mfma_f32_16x16x32_bf16 v[36:39], a[252:255], v[228:231], v[36:39]
    buffer_store_dwordx4 v[212:215], v254, s[12:15], s44 offen nt
    s_add_u32 s44, s40, 397312
    v_cvt_pk_bf16_f32 v195, v210, v211
    v_mfma_f32_16x16x32_bf16 v[40:43], v[240:243], v[228:231], v[40:43]
    v_accvgpr_write_b32 a14, v194
    v_accvgpr_write_b32 a15, v195
    v_mfma_f32_16x16x32_bf16 v[40:43], a[244:247], v[236:239], v[40:43]
    v_accvgpr_read_b32 v204, a116
    v_accvgpr_read_b32 v205, a117
    v_mfma_f32_16x16x32_bf16 v[40:43], a[232:235], v[232:235], v[40:43]
    buffer_store_dwordx4 v[216:219], v254, s[12:15], s44 offen nt
    v_accvgpr_read_b32 v206, a118
    v_accvgpr_read_b32 v207, a119
    v_mfma_f32_16x16x32_bf16 v[44:47], a[236:239], v[232:235], v[44:47]
    ds_read_b128 v[232:235], v253 offset:18208
    v_fma_f32 v208, v204, s34, v116 div:2
    v_mfma_f32_16x16x32_bf16 v[44:47], a[248:251], v[236:239], v[44:47]
    ds_read_b128 a[92:95], v250 offset:2048
    v_fma_f32 v209, v205, s34, v117 div:2
    v_mfma_f32_16x16x32_bf16 v[44:47], v[244:247], v[228:231], v[44:47]
    v_fma_f32 v210, v206, s34, v118 div:2
    v_fma_f32 v211, v207, s34, v119 div:2
    v_mfma_f32_16x16x32_bf16 v[48:51], a[228:231], v[236:239], v[48:51]
    v_fma_f32 v116, v204, s35, v116 mul:2
    v_fma_f32 v117, v205, s35, v117 mul:2
    v_mfma_f32_16x16x32_bf16 v[48:51], a[240:243], v[228:231], v[48:51]
    s_waitcnt lgkmcnt(1)
    s_add_u32 s44, s40, 400384
    v_fma_f32 v118, v206, s35, v118 mul:2
    v_mfma_f32_16x16x32_bf16 v[48:51], a[252:255], v[232:235], v[48:51]
    v_fma_f32 v119, v207, s35, v119 mul:2
    v_cvt_pk_bf16_f32 v196, v208, v209
    v_mfma_f32_16x16x32_bf16 v[52:55], v[240:243], v[232:235], v[52:55]
    ds_read_b128 a[96:99], v250 offset:5152
    v_cvt_pk_bf16_f32 v197, v210, v211
    v_accvgpr_write_b32 a16, v196
    v_mfma_f32_16x16x32_bf16 v[52:55], a[244:247], v[228:231], v[52:55]
    v_accvgpr_write_b32 a17, v197
    v_accvgpr_read_b32 v204, a120
    v_mfma_f32_16x16x32_bf16 v[52:55], a[232:235], v[236:239], v[52:55]
    v_accvgpr_read_b32 v205, a121
    v_accvgpr_read_b32 v206, a122
    v_mfma_f32_16x16x32_bf16 v[56:59], a[236:239], v[236:239], v[56:59]
    ds_read_b128 v[236:239], v253 offset:17952
    v_mfma_f32_16x16x32_bf16 v[56:59], a[248:251], v[228:231], v[56:59]
    v_accvgpr_read_b32 v207, a123
    v_fma_f32 v208, v204, s34, v120 div:2
    v_mfma_f32_16x16x32_bf16 v[56:59], v[244:247], v[232:235], v[56:59]
    v_fma_f32 v209, v205, s34, v121 div:2
    v_fma_f32 v210, v206, s34, v122 div:2
    v_mfma_f32_16x16x32_bf16 v[60:63], a[228:231], v[228:231], v[60:63]
    v_fma_f32 v211, v207, s34, v123 div:2
    v_fma_f32 v120, v204, s35, v120 mul:2
    v_mfma_f32_16x16x32_bf16 v[60:63], a[240:243], v[232:235], v[60:63]
    s_waitcnt lgkmcnt(0)
    v_fma_f32 v121, v205, s35, v121 mul:2
    v_fma_f32 v122, v206, s35, v122 mul:2
    v_mfma_f32_16x16x32_bf16 v[60:63], a[252:255], v[236:239], v[60:63]
    ds_read_b128 a[100:103], v250 offset:8256
    v_fma_f32 v123, v207, s35, v123 mul:2
    v_mfma_f32_16x16x32_bf16 v[64:67], v[240:243], v[236:239], v[64:67]
    buffer_store_dwordx4 a[84:87], v254, s[12:15], s44 offen nt
    v_cvt_pk_bf16_f32 v198, v208, v209
    v_cvt_pk_bf16_f32 v199, v210, v211
    v_mfma_f32_16x16x32_bf16 v[64:67], a[244:247], v[232:235], v[64:67]
    v_accvgpr_read_b32 v204, a28
    v_accvgpr_read_b32 v205, a29
    v_accvgpr_read_b32 v206, a30
    v_mfma_f32_16x16x32_bf16 v[64:67], a[232:235], v[228:231], v[64:67]
    v_accvgpr_read_b32 v207, a31
    v_accvgpr_read_b32 v208, a124
    v_mfma_f32_16x16x32_bf16 v[68:71], a[236:239], v[228:231], v[68:71]
    ds_read_b128 v[228:231], v253 offset:17696
    v_accvgpr_read_b32 v209, a125
    v_mfma_f32_16x16x32_bf16 v[68:71], a[248:251], v[232:235], v[68:71]
    ds_read_b128 a[104:107], v250 offset:11360
    s_add_u32 s44, s40, 403456
    v_mfma_f32_16x16x32_bf16 v[68:71], v[244:247], v[236:239], v[68:71]
    v_accvgpr_read_b32 v210, a126
    v_accvgpr_read_b32 v211, a127
    v_mfma_f32_16x16x32_bf16 v[72:75], a[228:231], v[232:235], v[72:75]
    v_sub_f32 v204, v204, v208
    v_sub_f32 v205, v205, v209
    v_mfma_f32_16x16x32_bf16 v[72:75], a[240:243], v[236:239], v[72:75]
    s_waitcnt lgkmcnt(1)
    v_sub_f32 v206, v206, v210
    v_sub_f32 v207, v207, v211
    v_mfma_f32_16x16x32_bf16 v[72:75], a[252:255], v[228:231], v[72:75]
    v_fma_f32 v208, v204, s34, v124 div:2
    v_fma_f32 v209, v205, s34, v125 div:2
    v_mfma_f32_16x16x32_bf16 v[76:79], v[240:243], v[228:231], v[76:79]
    v_fma_f32 v210, v206, s34, v126 div:2
    v_fma_f32 v211, v207, s34, v127 div:2
    v_mfma_f32_16x16x32_bf16 v[76:79], a[244:247], v[236:239], v[76:79]
    v_fma_f32 v124, v204, s35, v124 mul:2
    v_fma_f32 v125, v205, s35, v125 mul:2
    v_mfma_f32_16x16x32_bf16 v[76:79], a[232:235], v[232:235], v[76:79]
    v_fma_f32 v126, v206, s35, v126 mul:2
    v_fma_f32 v127, v207, s35, v127 mul:2
    v_cvt_pk_bf16_f32 v200, v208, v209
    v_mfma_f32_16x16x32_bf16 v[80:83], a[236:239], v[232:235], v[80:83]
    ds_read_b128 v[232:235], v253 offset:17424
    v_cvt_pk_bf16_f32 v201, v210, v211
    v_mfma_f32_16x16x32_bf16 v[80:83], a[248:251], v[236:239], v[80:83]
    v_accvgpr_read_b32 v204, a32
    v_accvgpr_read_b32 v205, a33
    v_mfma_f32_16x16x32_bf16 v[80:83], v[244:247], v[228:231], v[80:83]
    s_mov_b32 s42, 1032192
    v_accvgpr_read_b32 v206, a34
    v_accvgpr_read_b32 v207, a35
    v_mfma_f32_16x16x32_bf16 v[84:87], a[228:231], v[236:239], v[84:87]
    s_waitcnt lgkmcnt(0)
    v_accvgpr_read_b32 v208, a128
    v_accvgpr_read_b32 v209, a129
    v_mfma_f32_16x16x32_bf16 v[88:91], a[232:235], v[236:239], v[88:91]
    s_barrier
    v_mfma_f32_16x16x32_bf16 v[92:95], a[236:239], v[236:239], v[92:95]
    ds_read_b128 v[236:239], v253 offset:19760
    v_accvgpr_read_b32 v210, a130
    v_mfma_f32_16x16x32_bf16 v[92:95], a[248:251], v[228:231], v[92:95]
    buffer_load_dwordx4 a[228:231], v254, s[8:11], s42 offen offset:0 sc1
    v_mfma_f32_16x16x32_bf16 v[88:91], a[244:247], v[228:231], v[88:91]
    v_accvgpr_read_b32 v211, a131
    v_sub_f32 v204, v204, v208
    v_mfma_f32_16x16x32_bf16 v[84:87], a[240:243], v[228:231], v[84:87]
    ds_read_b128 v[228:231], v253 offset:19488
    v_sub_f32 v205, v205, v209
    v_mfma_f32_16x16x32_bf16 v[84:87], a[252:255], v[232:235], v[84:87]
    buffer_load_dwordx4 a[232:235], v254, s[8:11], s42 offen offset:1024 sc1
    v_sub_f32 v206, v206, v210
    v_mfma_f32_16x16x32_bf16 v[88:91], v[240:243], v[232:235], v[88:91]
    s_waitcnt vmcnt(11) lgkmcnt(1)
    v_sub_f32 v207, v207, v211
    v_fma_f32 v208, v204, s34, v128 div:2
    v_mfma_f32_16x16x32_bf16 v[92:95], v[244:247], v[232:235], v[92:95]
    ds_read_b128 v[232:235], v253 offset:19232
    v_fma_f32 v209, v205, s34, v129 div:2
sub26:
    v_mfma_f32_16x16x32_bf16 v[0:3], a[192:195], v[236:239], v[0:3]
    buffer_load_dwordx4 a[236:239], v254, s[8:11], s42 offen offset:2048 sc1
    v_mfma_f32_16x16x32_bf16 v[4:7], a[196:199], v[236:239], v[4:7]
    s_mov_b32 s42, 1035264
    v_fma_f32 v210, v206, s34, v130 div:2
    v_fma_f32 v211, v207, s34, v131 div:2
    v_mfma_f32_16x16x32_bf16 v[8:11], a[200:203], v[236:239], v[8:11]
    ds_read_b128 v[236:239], v253 offset:18976
    s_waitcnt vmcnt(9)
    s_waitcnt lgkmcnt(2)
    v_mfma_f32_16x16x32_bf16 v[8:11], a[212:215], v[228:231], v[8:11]
    ds_write_b128 v248, a[0:3] offset:0
    v_mfma_f32_16x16x32_bf16 v[4:7], a[208:211], v[228:231], v[4:7]
    buffer_load_dwordx4 a[240:243], v254, s[8:11], s42 offen offset:0 sc1
    v_mfma_f32_16x16x32_bf16 v[0:3], a[204:207], v[228:231], v[0:3]
    s_waitcnt vmcnt(7) lgkmcnt(2)
    v_fma_f32 v128, v204, s35, v128 mul:2
    v_fma_f32 v129, v205, s35, v129 mul:2
    v_mfma_f32_16x16x32_bf16 v[0:3], a[216:219], v[232:235], v[0:3]
    v_fma_f32 v130, v206, s35, v130 mul:2
    v_fma_f32 v131, v207, s35, v131 mul:2
    v_mfma_f32_16x16x32_bf16 v[4:7], a[220:223], v[232:235], v[4:7]
    ds_write_b64 v249, a[4:5] offset:64
    v_cvt_pk_bf16_f32 v202, v208, v209
    v_mfma_f32_16x16x32_bf16 v[8:11], a[224:227], v[232:235], v[8:11]
    buffer_load_dwordx4 a[244:247], v254, s[8:11], s42 offen offset:1024 sc1
    v_mfma_f32_16x16x32_bf16 v[12:15], a[192:195], v[228:231], v[12:15]
    ds_write_b128 v248, v[198:201] offset:768
    v_mfma_f32_16x16x32_bf16 v[12:15], a[204:207], v[232:235], v[12:15]
    s_waitcnt lgkmcnt(3)
    v_cvt_pk_bf16_f32 v203, v210, v211
    v_accvgpr_read_b32 v204, a36
    v_mfma_f32_16x16x32_bf16 v[12:15], a[216:219], v[236:239], v[12:15]
    v_accvgpr_read_b32 v205, a37
    v_accvgpr_read_b32 v206, a38
    v_mfma_f32_16x16x32_bf16 v[16:19], a[220:223], v[236:239], v[16:19]
    buffer_load_dwordx4 a[248:251], v254, s[8:11], s42 offen offset:2048 sc1
    v_mfma_f32_16x16x32_bf16 v[16:19], a[208:211], v[232:235], v[16:19]
    s_mov_b32 s42, 1038336
    v_accvgpr_read_b32 v207, a39
    v_accvgpr_read_b32 v208, a132
    v_mfma_f32_16x16x32_bf16 v[16:19], a[196:199], v[228:231], v[16:19]
    ds_write_b128 v248, a[12:15] offset:384
    v_mfma_f32_16x16x32_bf16 v[20:23], a[200:203], v[228:231], v[20:23]
    ds_read_b128 v[228:231], v253 offset:18720
    v_accvgpr_read_b32 v209, a133
    v_mfma_f32_16x16x32_bf16 v[20:23], a[212:215], v[232:235], v[20:23]
    buffer_load_dwordx4 a[252:255], v254, s[8:11], s42 offen offset:0 sc1
    v_mfma_f32_16x16x32_bf16 v[20:23], a[224:227], v[236:239], v[20:23]
    v_accvgpr_read_b32 v210, a134
    v_accvgpr_read_b32 v211, a135
    v_sub_f32 v204, v204, v208
    v_mfma_f32_16x16x32_bf16 v[24:27], a[192:195], v[232:235], v[24:27]
    ds_write_b64 v249, v[202:203] offset:832
    v_mfma_f32_16x16x32_bf16 v[24:27], a[204:207], v[236:239], v[24:27]
    s_waitcnt lgkmcnt(1)
    v_sub_f32 v205, v205, v209
    v_sub_f32 v206, v206, v210
    v_mfma_f32_16x16x32_bf16 v[24:27], a[216:219], v[228:231], v[24:27]
    v_sub_f32 v207, v207, v211
    v_fma_f32 v208, v204, s34, v132 div:2
    v_mfma_f32_16x16x32_bf16 v[28:31], a[220:223], v[228:231], v[28:31]
    buffer_load_dwordx4 v[240:243], v254, s[8:11], s42 offen offset:1024 sc1
    v_mfma_f32_16x16x32_bf16 v[28:31], a[208:211], v[236:239], v[28:31]
    ds_write_b64 v249, a[16:17] offset:448
    v_mfma_f32_16x16x32_bf16 v[28:31], a[196:199], v[232:235], v[28:31]
    v_fma_f32 v209, v205, s34, v133 div:2
    v_fma_f32 v210, v206, s34, v134 div:2
    v_mfma_f32_16x16x32_bf16 v[32:35], a[200:203], v[232:235], v[32:35]
    ds_read_b128 v[232:235], v253 offset:20544
    v_fma_f32 v211, v207, s34, v135 div:2
    v_mfma_f32_16x16x32_bf16 v[32:35], a[212:215], v[236:239], v[32:35]
    buffer_load_dwordx4 v[244:247], v254, s[8:11], s42 offen offset:2048 sc1
    v_mfma_f32_16x16x32_bf16 v[32:35], a[224:227], v[228:231], v[32:35]
    v_fma_f32 v132, v204, s35, v132 mul:2
    v_fma_f32 v133, v205, s35, v133 mul:2
    v_mfma_f32_16x16x32_bf16 v[36:39], a[192:195], v[236:239], v[36:39]
    v_fma_f32 v134, v206, s35, v134 mul:2
    v_fma_f32 v135, v207, s35, v135 mul:2
    v_cvt_pk_bf16_f32 v192, v208, v209
    v_mfma_f32_16x16x32_bf16 v[36:39], a[204:207], v[228:231], v[36:39]
    s_waitcnt lgkmcnt(0)
    v_cvt_pk_bf16_f32 v193, v210, v211
    v_accvgpr_read_b32 v204, a40
    v_mfma_f32_16x16x32_bf16 v[36:39], a[216:219], v[232:235], v[36:39]
    buffer_store_dwordx4 a[88:91], v254, s[12:15], s44 offen nt
    s_add_u32 s44, s40, 395264
    v_mfma_f32_16x16x32_bf16 v[40:43], a[220:223], v[232:235], v[40:43]
    v_accvgpr_read_b32 v205, a41
    v_accvgpr_read_b32 v206, a42
    v_mfma_f32_16x16x32_bf16 v[40:43], a[208:211], v[228:231], v[40:43]
    v_accvgpr_read_b32 v207, a43
    v_accvgpr_read_b32 v208, a136
    v_mfma_f32_16x16x32_bf16 v[40:43], a[196:199], v[236:239], v[40:43]
    buffer_store_dwordx4 a[92:95], v254, s[12:15], s44 offen nt
    s_add_u32 s44, s40, 398336
    v_mfma_f32_16x16x32_bf16 v[44:47], a[200:203], v[236:239], v[44:47]
    ds_read_b128 v[236:239], v253 offset:20288
    v_accvgpr_read_b32 v209, a137
    v_mfma_f32_16x16x32_bf16 v[44:47], a[212:215], v[228:231], v[44:47]
    v_accvgpr_read_b32 v210, a138
    v_accvgpr_read_b32 v211, a139
    v_mfma_f32_16x16x32_bf16 v[44:47], a[224:227], v[232:235], v[44:47]
    buffer_store_dwordx4 a[96:99], v254, s[12:15], s44 offen nt
    s_add_u32 s44, s40, 401408
    v_mfma_f32_16x16x32_bf16 v[48:51], a[192:195], v[228:231], v[48:51]
    v_sub_f32 v204, v204, v208
    v_sub_f32 v205, v205, v209
    v_mfma_f32_16x16x32_bf16 v[48:51], a[204:207], v[232:235], v[48:51]
    s_waitcnt lgkmcnt(0)
    v_sub_f32 v206, v206, v210
    v_sub_f32 v207, v207, v211
    v_fma_f32 v208, v204, s34, v136 div:2
    v_mfma_f32_16x16x32_bf16 v[48:51], a[216:219], v[236:239], v[48:51]
    buffer_store_dwordx4 a[100:103], v254, s[12:15], s44 offen nt
    v_fma_f32 v209, v205, s34, v137 div:2
    v_fma_f32 v210, v206, s34, v138 div:2
    v_mfma_f32_16x16x32_bf16 v[52:55], a[220:223], v[236:239], v[52:55]
    v_fma_f32 v211, v207, s34, v139 div:2
    v_fma_f32 v136, v204, s35, v136 mul:2
    v_mfma_f32_16x16x32_bf16 v[52:55], a[208:211], v[232:235], v[52:55]
    v_fma_f32 v137, v205, s35, v137 mul:2
    v_fma_f32 v138, v206, s35, v138 mul:2
    v_mfma_f32_16x16x32_bf16 v[52:55], a[196:199], v[228:231], v[52:55]
    v_fma_f32 v139, v207, s35, v139 mul:2
    v_cvt_pk_bf16_f32 v194, v208, v209
    v_mfma_f32_16x16x32_bf16 v[56:59], a[200:203], v[228:231], v[56:59]
    ds_read_b128 v[228:231], v253 offset:20032
    s_add_u32 s44, s40, 404480
    v_mfma_f32_16x16x32_bf16 v[56:59], a[212:215], v[232:235], v[56:59]
pad10:
    s_cbranch_vccnz warm_ret
    v_cvt_pk_bf16_f32 v195, v210, v211
    v_accvgpr_read_b32 v204, a44
    v_mfma_f32_16x16x32_bf16 v[56:59], a[224:227], v[236:239], v[56:59]
    ds_write_b128 v248, v[192:195] offset:1152
    v_mfma_f32_16x16x32_bf16 v[60:63], a[192:195], v[232:235], v[60:63]
    v_accvgpr_read_b32 v205, a45
    v_accvgpr_read_b32 v206, a46
    v_mfma_f32_16x16x32_bf16 v[60:63], a[204:207], v[236:239], v[60:63]
    s_waitcnt lgkmcnt(1)
    v_accvgpr_read_b32 v207, a47
    v_accvgpr_read_b32 v208, a140
    v_mfma_f32_16x16x32_bf16 v[60:63], a[216:219], v[228:231], v[60:63]
    v_accvgpr_read_b32 v209, a141
    v_accvgpr_read_b32 v210, a142
    v_accvgpr_read_b32 v211, a143
    v_mfma_f32_16x16x32_bf16 v[64:67], a[220:223], v[228:231], v[64:67]
    v_sub_f32 v204, v204, v208
    v_sub_f32 v205, v205, v209
    v_mfma_f32_16x16x32_bf16 v[64:67], a[208:211], v[236:239], v[64:67]
    v_sub_f32 v206, v206, v210
    v_sub_f32 v207, v207, v211
    v_mfma_f32_16x16x32_bf16 v[64:67], a[196:199], v[232:235], v[64:67]
    v_fma_f32 v208, v204, s34, v140 div:2
    v_fma_f32 v209, v205, s34, v141 div:2
    v_mfma_f32_16x16x32_bf16 v[68:71], a[200:203], v[232:235], v[68:71]
    ds_read_b128 v[232:235], v253 offset:19776
    v_fma_f32 v210, v206, s34, v142 div:2
    v_mfma_f32_16x16x32_bf16 v[68:71], a[212:215], v[236:239], v[68:71]
    v_fma_f32 v211, v207, s34, v143 div:2
    v_fma_f32 v140, v204, s35, v140 mul:2
    v_mfma_f32_16x16x32_bf16 v[68:71], a[224:227], v[228:231], v[68:71]
    buffer_store_dwordx4 a[104:107], v254, s[12:15], s44 offen nt
    v_fma_f32 v141, v205, s35, v141 mul:2
    v_fma_f32 v142, v206, s35, v142 mul:2
    v_mfma_f32_16x16x32_bf16 v[72:75], a[192:195], v[236:239], v[72:75]
    v_fma_f32 v143, v207, s35, v143 mul:2
    v_cvt_pk_bf16_f32 v196, v208, v209
    v_mfma_f32_16x16x32_bf16 v[72:75], a[204:207], v[228:231], v[72:75]
    s_waitcnt lgkmcnt(0)
    v_cvt_pk_bf16_f32 v197, v210, v211
    v_accvgpr_read_b32 v204, a48
    v_mfma_f32_16x16x32_bf16 v[72:75], a[216:219], v[232:235], v[72:75]
    ds_write_b64 v249, v[196:197] offset:1216
    v_mfma_f32_16x16x32_bf16 v[76:79], a[220:223], v[232:235], v[76:79]
    v_accvgpr_read_b32 v205, a49
    v_accvgpr_read_b32 v206, a50
    v_accvgpr_read_b32 v207, a51
    v_mfma_f32_16x16x32_bf16 v[76:79], a[208:211], v[228:231], v[76:79]
    v_accvgpr_read_b32 v208, a144
    v_accvgpr_read_b32 v209, a145
    v_mfma_f32_16x16x32_bf16 v[76:79], a[196:199], v[236:239], v[76:79]
    v_accvgpr_read_b32 v210, a146
    v_accvgpr_read_b32 v211, a147
    v_mfma_f32_16x16x32_bf16 v[80:83], a[200:203], v[236:239], v[80:83]
    ds_read_b128 v[236:239], v253 offset:19504
    v_sub_f32 v204, v204, v208
    v_mfma_f32_16x16x32_bf16 v[80:83], a[212:215], v[228:231], v[80:83]
    v_sub_f32 v205, v205, v209
    v_sub_f32 v206, v206, v210
    v_mfma_f32_16x16x32_bf16 v[80:83], a[224:227], v[232:235], v[80:83]
    s_mov_b32 s42, 1069056
    v_sub_f32 v207, v207, v211
    v_fma_f32 v208, v204, s34, v144 div:2
    v_mfma_f32_16x16x32_bf16 v[84:87], a[192:195], v[228:231], v[84:87]
    s_waitcnt lgkmcnt(0)
    v_fma_f32 v209, v205, s34, v145 div:2
    v_fma_f32 v210, v206, s34, v146 div:2
    v_mfma_f32_16x16x32_bf16 v[88:91], a[196:199], v[228:231], v[88:91]
    s_barrier
    v_mfma_f32_16x16x32_bf16 v[92:95], a[200:203], v[228:231], v[92:95]
    ds_read_b128 v[228:231], v253 offset:21840
    v_fma_f32 v211, v207, s34, v147 div:2
    v_mfma_f32_16x16x32_bf16 v[92:95], a[212:215], v[232:235], v[92:95]
    buffer_load_dwordx4 a[192:195], v254, s[8:11], s42 offen offset:0 sc1
    v_mfma_f32_16x16x32_bf16 v[88:91], a[208:211], v[232:235], v[88:91]
    v_fma_f32 v144, v204, s35, v144 mul:2
    v_fma_f32 v145, v205, s35, v145 mul:2
    v_fma_f32 v146, v206, s35, v146 mul:2
    v_mfma_f32_16x16x32_bf16 v[84:87], a[204:207], v[232:235], v[84:87]
    ds_read_b128 v[232:235], v253 offset:21568
    v_fma_f32 v147, v207, s35, v147 mul:2
    v_mfma_f32_16x16x32_bf16 v[84:87], a[216:219], v[236:239], v[84:87]
    buffer_load_dwordx4 a[196:199], v254, s[8:11], s42 offen offset:1024 sc1
    v_mfma_f32_16x16x32_bf16 v[88:91], a[220:223], v[236:239], v[88:91]
    s_waitcnt vmcnt(13) lgkmcnt(1)
    v_cvt_pk_bf16_f32 v198, v208, v209
    v_cvt_pk_bf16_f32 v199, v210, v211
    v_mfma_f32_16x16x32_bf16 v[92:95], a[224:227], v[236:239], v[92:95]
    ds_read_b128 v[236:239], v253 offset:21312
    v_accvgpr_read_b32 v204, a52
sub27:
    v_mfma_f32_16x16x32_bf16 v[0:3], a[228:231], v[228:231], v[0:3]
    buffer_load_dwordx4 a[200:203], v254, s[8:11], s42 offen offset:2048 sc1
    v_mfma_f32_16x16x32_bf16 v[4:7], a[232:235], v[228:231], v[4:7]
    s_mov_b32 s42, 1072128
    s_add_u32 s44, s40, 196608
    v_accvgpr_read_b32 v205, a53
    v_mfma_f32_16x16x32_bf16 v[8:11], a[236:239], v[228:231], v[8:11]
    ds_read_b128 v[228:231], v253 offset:21056
    s_waitcnt vmcnt(11)
    s_waitcnt lgkmcnt(2)
    v_mfma_f32_16x16x32_bf16 v[8:11], a[248:251], v[232:235], v[8:11]
    ds_read_b128 a[108:111], v250 offset:0
    v_accvgpr_read_b32 v206, a54
    v_mfma_f32_16x16x32_bf16 v[4:7], a[244:247], v[232:235], v[4:7]
    buffer_load_dwordx4 a[204:207], v254, s[8:11], s42 offen offset:0 sc1
    v_mfma_f32_16x16x32_bf16 v[0:3], a[240:243], v[232:235], v[0:3]
    s_waitcnt vmcnt(9) lgkmcnt(2)
    v_accvgpr_read_b32 v207, a55
    v_accvgpr_read_b32 v208, a148
    v_accvgpr_read_b32 v209, a149
    v_mfma_f32_16x16x32_bf16 v[0:3], a[252:255], v[236:239], v[0:3]
    ds_read_b128 a[112:115], v250 offset:3104
    v_accvgpr_read_b32 v210, a150
    v_mfma_f32_16x16x32_bf16 v[4:7], v[240:243], v[236:239], v[4:7]
    v_accvgpr_read_b32 v211, a151
    v_sub_f32 v204, v204, v208
    v_mfma_f32_16x16x32_bf16 v[8:11], v[244:247], v[236:239], v[8:11]
    buffer_load_dwordx4 a[208:211], v254, s[8:11], s42 offen offset:1024 sc1
    v_mfma_f32_16x16x32_bf16 v[12:15], a[228:231], v[232:235], v[12:15]
    s_waitcnt lgkmcnt(1)
    v_sub_f32 v205, v205, v209
    v_sub_f32 v206, v206, v210
    v_mfma_f32_16x16x32_bf16 v[12:15], a[240:243], v[236:239], v[12:15]
    v_sub_f32 v207, v207, v211
    v_fma_f32 v208, v204, s34, v148 div:2
    v_mfma_f32_16x16x32_bf16 v[12:15], a[252:255], v[228:231], v[12:15]
    v_fma_f32 v209, v205, s34, v149 div:2
    v_fma_f32 v210, v206, s34, v150 div:2
    v_mfma_f32_16x16x32_bf16 v[16:19], v[240:243], v[228:231], v[16:19]
    buffer_load_dwordx4 a[212:215], v254, s[8:11], s42 offen offset:2048 sc1
    v_mfma_f32_16x16x32_bf16 v[16:19], a[244:247], v[236:239], v[16:19]
    s_mov_b32 s42, 1075200
    v_fma_f32 v211, v207, s34, v151 div:2
    v_fma_f32 v148, v204, s35, v148 mul:2
    v_mfma_f32_16x16x32_bf16 v[16:19], a[232:235], v[232:235], v[16:19]
    ds_read_b128 a[116:119], v250 offset:6208
    v_fma_f32 v149, v205, s35, v149 mul:2
    v_mfma_f32_16x16x32_bf16 v[20:23], a[236:239], v[232:235], v[20:23]
    ds_read_b128 v[232:235], v253 offset:20800
    v_fma_f32 v150, v206, s35, v150 mul:2
    v_fma_f32 v151, v207, s35, v151 mul:2
    v_mfma_f32_16x16x32_bf16 v[20:23], a[248:251], v[236:239], v[20:23]
    buffer_load_dwordx4 a[216:219], v254, s[8:11], s42 offen offset:0 sc1
    v_mfma_f32_16x16x32_bf16 v[20:23], v[244:247], v[228:231], v[20:23]
    v_cvt_pk_bf16_f32 v200, v208, v209
    v_cvt_pk_bf16_f32 v201, v210, v211
    v_mfma_f32_16x16x32_bf16 v[24:27], a[228:231], v[236:239], v[24:27]
    ds_write_b128 v248, v[198:201] offset:1536
    v_mfma_f32_16x16x32_bf16 v[24:27], a[240:243], v[228:231], v[24:27]
    s_waitcnt lgkmcnt(1)
    v_accvgpr_read_b32 v204, a56
    v_accvgpr_read_b32 v205, a57
    v_mfma_f32_16x16x32_bf16 v[24:27], a[252:255], v[232:235], v[24:27]
    v_accvgpr_read_b32 v206, a58
    v_accvgpr_read_b32 v207, a59
    v_mfma_f32_16x16x32_bf16 v[28:31], v[240:243], v[232:235], v[28:31]
    buffer_load_dwordx4 a[220:223], v254, s[8:11], s42 offen offset:1024 sc1
    v_mfma_f32_16x16x32_bf16 v[28:31], a[244:247], v[228:231], v[28:31]
    ds_read_b128 a[120:123], v250 offset:9312
    v_accvgpr_read_b32 v208, a152
    v_mfma_f32_16x16x32_bf16 v[28:31], a[232:235], v[236:239], v[28:31]
    v_accvgpr_read_b32 v209, a153
    v_accvgpr_read_b32 v210, a154
    v_mfma_f32_16x16x32_bf16 v[32:35], a[236:239], v[236:239], v[32:35]
    ds_read_b128 v[236:239], v253 offset:22624
    v_accvgpr_read_b32 v211, a155
    v_mfma_f32_16x16x32_bf16 v[32:35], a[248:251], v[228:231], v[32:35]
    buffer_load_dwordx4 a[224:227], v254, s[8:11], s42 offen offset:2048 sc1
    v_sub_f32 v204, v204, v208
    v_mfma_f32_16x16x32_bf16 v[32:35], v[244:247], v[232:235], v[32:35]
    v_sub_f32 v205, v205, v209
    v_sub_f32 v206, v206, v210
    v_mfma_f32_16x16x32_bf16 v[36:39], a[228:231], v[228:231], v[36:39]
    v_sub_f32 v207, v207, v211
    v_fma_f32 v208, v204, s34, v152 div:2
    v_mfma_f32_16x16x32_bf16 v[36:39], a[240:243], v[232:235], v[36:39]
    s_waitcnt lgkmcnt(0)
    v_fma_f32 v209, v205, s34, v153 div:2
    v_fma_f32 v210, v206, s34, v154 div:2
    v_mfma_f32_16x16x32_bf16 v[36:39], a[252:255], v[236:239], v[36:39]
    buffer_store_dwordx4 a[108:111], v254, s[12:15], s44 offen nt
    s_add_u32 s44, s40, 199680
    v_fma_f32 v211, v207, s34, v155 div:2
    v_mfma_f32_16x16x32_bf16 v[40:43], v[240:243], v[236:239], v[40:43]
    v_fma_f32 v152, v204, s35, v152 mul:2
    v_fma_f32 v153, v205, s35, v153 mul:2
    v_mfma_f32_16x16x32_bf16 v[40:43], a[244:247], v[232:235], v[40:43]
    v_fma_f32 v154, v206, s35, v154 mul:2
    v_fma_f32 v155, v207, s35, v155 mul:2
    v_mfma_f32_16x16x32_bf16 v[40:43], a[232:235], v[228:231], v[40:43]
    v_cvt_pk_bf16_f32 v202, v208, v209
    v_cvt_pk_bf16_f32 v203, v210, v211
    v_mfma_f32_16x16x32_bf16 v[44:47], a[236:239], v[228:231], v[44:47]
    ds_read_b128 v[228:231], v253 offset:22368
    v_mfma_f32_16x16x32_bf16 v[44:47], a[248:251], v[232:235], v[44:47]
    ds_write_b64 v249, v[202:203] offset:1600
    v_mfma_f32_16x16x32_bf16 v[44:47], v[244:247], v[236:239], v[44:47]
    v_accvgpr_read_b32 v204, a60
    v_accvgpr_read_b32 v205, a61
    v_accvgpr_read_b32 v206, a62
    v_mfma_f32_16x16x32_bf16 v[48:51], a[228:231], v[232:235], v[48:51]
    v_accvgpr_read_b32 v207, a63
    v_accvgpr_read_b32 v208, a156
    v_mfma_f32_16x16x32_bf16 v[48:51], a[240:243], v[236:239], v[48:51]
    s_waitcnt lgkmcnt(1)
    v_accvgpr_read_b32 v209, a157
    v_accvgpr_read_b32 v210, a158
    v_mfma_f32_16x16x32_bf16 v[48:51], a[252:255], v[228:231], v[48:51]
    v_accvgpr_read_b32 v211, a159
    v_sub_f32 v204, v204, v208
    v_mfma_f32_16x16x32_bf16 v[52:55], v[240:243], v[228:231], v[52:55]
    v_sub_f32 v205, v205, v209
    v_sub_f32 v206, v206, v210
    v_mfma_f32_16x16x32_bf16 v[52:55], a[244:247], v[236:239], v[52:55]
    v_sub_f32 v207, v207, v211
    v_fma_f32 v208, v204, s34, v156 div:2
    v_mfma_f32_16x16x32_bf16 v[52:55], a[232:235], v[232:235], v[52:55]
    buffer_store_dwordx4 a[112:115], v254, s[12:15], s44 offen nt
    v_fma_f32 v209, v205, s34, v157 div:2
    v_fma_f32 v210, v206, s34, v158 div:2
    v_mfma_f32_16x16x32_bf16 v[56:59], a[236:239], v[232:235], v[56:59]
    ds_read_b128 v[232:235], v253 offset:22112
    v_fma_f32 v211, v207, s34, v159 div:2
    v_mfma_f32_16x16x32_bf16 v[56:59], a[248:251], v[236:239], v[56:59]
    v_fma_f32 v156, v204, s35, v156 mul:2
    v_fma_f32 v157, v205, s35, v157 mul:2
    v_mfma_f32_16x16x32_bf16 v[56:59], v[244:247], v[228:231], v[56:59]
    v_fma_f32 v158, v206, s35, v158 mul:2
    v_fma_f32 v159, v207, s35, v159 mul:2
    v_mfma_f32_16x16x32_bf16 v[60:63], a[228:231], v[236:239], v[60:63]
    v_cvt_pk_bf16_f32 v192, v208, v209
    v_cvt_pk_bf16_f32 v193, v210, v211
    v_accvgpr_read_b32 v204, a64
    v_mfma_f32_16x16x32_bf16 v[60:63], a[240:243], v[228:231], v[60:63]
    s_waitcnt lgkmcnt(0)
    v_accvgpr_read_b32 v205, a65
    v_accvgpr_read_b32 v206, a66
    v_mfma_f32_16x16x32_bf16 v[60:63], a[252:255], v[232:235], v[60:63]
    v_accvgpr_read_b32 v207, a67
    v_accvgpr_read_b32 v208, a160
    v_mfma_f32_16x16x32_bf16 v[64:67], v[240:243], v[232:235], v[64:67]
    v_accvgpr_read_b32 v209, a161
    v_accvgpr_read_b32 v210, a162
    v_mfma_f32_16x16x32_bf16 v[64:67], a[244:247], v[228:231], v[64:67]
    v_accvgpr_read_b32 v211, a163
    v_sub_f32 v204, v204, v208
    v_mfma_f32_16x16x32_bf16 v[64:67], a[232:235], v[236:239], v[64:67]
    s_add_u32 s44, s40, 202752
    v_sub_f32 v205, v205, v209
    v_sub_f32 v206, v206, v210
    v_mfma_f32_16x16x32_bf16 v[68:71], a[236:239], v[236:239], v[68:71]
    ds_read_b128 v[236:239], v253 offset:21856
    v_sub_f32 v207, v207, v211
    v_mfma_f32_16x16x32_bf16 v[68:71], a[248:251], v[228:231], v[68:71]
    v_fma_f32 v208, v204, s34, v160 div:2
    v_fma_f32 v209, v205, s34, v161 div:2
    v_mfma_f32_16x16x32_bf16 v[68:71], v[244:247], v[232:235], v[68:71]
    v_fma_f32 v210, v206, s34, v162 div:2
    v_fma_f32 v211, v207, s34, v163 div:2
    v_mfma_f32_16x16x32_bf16 v[72:75], a[228:231], v[228:231], v[72:75]
    v_fma_f32 v160, v204, s35, v160 mul:2
    v_fma_f32 v161, v205, s35, v161 mul:2
    v_mfma_f32_16x16x32_bf16 v[72:75], a[240:243], v[232:235], v[72:75]
    s_waitcnt lgkmcnt(0)
    v_fma_f32 v162, v206, s35, v162 mul:2
    v_fma_f32 v163, v207, s35, v163 mul:2
    v_cvt_pk_bf16_f32 v194, v208, v209
    v_mfma_f32_16x16x32_bf16 v[72:75], a[252:255], v[236:239], v[72:75]
    v_cvt_pk_bf16_f32 v195, v210, v211
    v_accvgpr_read_b32 v204, a68
    v_mfma_f32_16x16x32_bf16 v[76:79], v[240:243], v[236:239], v[76:79]
    ds_write_b128 v248, v[192:195] offset:1920
    v_mfma_f32_16x16x32_bf16 v[76:79], a[244:247], v[232:235], v[76:79]
    v_accvgpr_read_b32 v205, a69
    v_accvgpr_read_b32 v206, a70
    v_mfma_f32_16x16x32_bf16 v[76:79], a[232:235], v[228:231], v[76:79]
    v_accvgpr_read_b32 v207, a71
    v_accvgpr_read_b32 v208, a164
    v_mfma_f32_16x16x32_bf16 v[80:83], a[236:239], v[228:231], v[80:83]
    ds_read_b128 v[228:231], v253 offset:21584
    v_accvgpr_read_b32 v209, a165
    v_mfma_f32_16x16x32_bf16 v[80:83], a[248:251], v[232:235], v[80:83]
    v_accvgpr_read_b32 v210, a166
    v_accvgpr_read_b32 v211, a167
    v_mfma_f32_16x16x32_bf16 v[80:83], v[244:247], v[236:239], v[80:83]
    s_mov_b32 s42, 884736
    v_sub_f32 v204, v204, v208
    v_sub_f32 v205, v205, v209
    v_mfma_f32_16x16x32_bf16 v[84:87], a[228:231], v[232:235], v[84:87]
    v_sub_f32 v206, v206, v210
    v_sub_f32 v207, v207, v211
    v_mfma_f32_16x16x32_bf16 v[88:91], a[232:235], v[232:235], v[88:91]
    v_fma_f32 v208, v204, s34, v164 div:2
    v_fma_f32 v209, v205, s34, v165 div:2
    v_mfma_f32_16x16x32_bf16 v[92:95], a[236:239], v[232:235], v[92:95]
    ds_read_b128 v[232:235], v253 offset:23920
    v_fma_f32 v210, v206, s34, v166 div:2
    v_fma_f32 v211, v207, s34, v167 div:2
    v_mfma_f32_16x16x32_bf16 v[92:95], a[248:251], v[236:239], v[92:95]
    buffer_load_dwordx4 a[228:231], v254, s[8:11], s42 offen offset:0 sc1
    v_mfma_f32_16x16x32_bf16 v[88:91], a[244:247], v[236:239], v[88:91]
    s_waitcnt lgkmcnt(1)
    v_fma_f32 v164, v204, s35, v164 mul:2
    v_fma_f32 v165, v205, s35, v165 mul:2
    v_mfma_f32_16x16x32_bf16 v[84:87], a[240:243], v[236:239], v[84:87]
    ds_read_b128 v[236:239], v253 offset:23648
    v_fma_f32 v166, v206, s35, v166 mul:2
    v_mfma_f32_16x16x32_bf16 v[84:87], a[252:255], v[228:231], v[84:87]
    buffer_load_dwordx4 a[232:235], v254, s[8:11], s42 offen offset:1024 sc1
    v_mfma_f32_16x16x32_bf16 v[88:91], v[240:243], v[228:231], v[88:91]
    s_waitcnt vmcnt(10) lgkmcnt(1)
    v_fma_f32 v167, v207, s35, v167 mul:2
    v_cvt_pk_bf16_f32 v196, v208, v209
    v_mfma_f32_16x16x32_bf16 v[92:95], v[244:247], v[228:231], v[92:95]
    ds_read_b128 v[228:231], v253 offset:23392
    v_cvt_pk_bf16_f32 v197, v210, v211
sub28:
    v_mfma_f32_16x16x32_bf16 v[0:3], a[192:195], v[232:235], v[0:3]
    buffer_load_dwordx4 a[236:239], v254, s[8:11], s42 offen offset:2048 sc1
    v_mfma_f32_16x16x32_bf16 v[4:7], a[196:199], v[232:235], v[4:7]
    s_mov_b32 s42, 887808
    v_accvgpr_read_b32 v204, a72
    v_accvgpr_read_b32 v205, a73
    v_mfma_f32_16x16x32_bf16 v[8:11], a[200:203], v[232:235], v[8:11]
    ds_read_b128 v[232:235], v253 offset:23136
    s_waitcnt vmcnt(8)
    s_waitcnt lgkmcnt(2)
    v_mfma_f32_16x16x32_bf16 v[8:11], a[212:215], v[236:239], v[8:11]
    ds_write_b64 v249, v[196:197] offset:1984
    v_accvgpr_read_b32 v206, a74
    v_mfma_f32_16x16x32_bf16 v[4:7], a[208:211], v[236:239], v[4:7]
    buffer_load_dwordx4 a[240:243], v254, s[8:11], s42 offen offset:0 sc1
    v_mfma_f32_16x16x32_bf16 v[0:3], a[204:207], v[236:239], v[0:3]
    s_waitcnt vmcnt(6) lgkmcnt(2)
    v_accvgpr_read_b32 v207, a75
    v_accvgpr_read_b32 v208, a168
    v_mfma_f32_16x16x32_bf16 v[0:3], a[216:219], v[228:231], v[0:3]
    v_accvgpr_read_b32 v209, a169
    v_accvgpr_read_b32 v210, a170
    v_mfma_f32_16x16x32_bf16 v[4:7], a[220:223], v[228:231], v[4:7]
    v_accvgpr_read_b32 v211, a171
    v_sub_f32 v204, v204, v208
    v_mfma_f32_16x16x32_bf16 v[8:11], a[224:227], v[228:231], v[8:11]
    buffer_load_dwordx4 a[244:247], v254, s[8:11], s42 offen offset:1024 sc1
    v_mfma_f32_16x16x32_bf16 v[12:15], a[192:195], v[236:239], v[12:15]
    v_sub_f32 v205, v205, v209
    v_sub_f32 v206, v206, v210
    v_mfma_f32_16x16x32_bf16 v[12:15], a[204:207], v[228:231], v[12:15]
    s_waitcnt lgkmcnt(1)
    v_sub_f32 v207, v207, v211
    v_fma_f32 v208, v204, s34, v168 div:2
    v_mfma_f32_16x16x32_bf16 v[12:15], a[216:219], v[232:235], v[12:15]
    v_fma_f32 v209, v205, s34, v169 div:2
    v_fma_f32 v210, v206, s34, v170 div:2
    v_mfma_f32_16x16x32_bf16 v[16:19], a[220:223], v[232:235], v[16:19]
    buffer_load_dwordx4 a[248:251], v254, s[8:11], s42 offen offset:2048 sc1
    v_mfma_f32_16x16x32_bf16 v[16:19], a[208:211], v[228:231], v[16:19]
    s_mov_b32 s42, 890880
    v_fma_f32 v211, v207, s34, v171 div:2
    v_fma_f32 v168, v204, s35, v168 mul:2
    v_fma_f32 v169, v205, s35, v169 mul:2
    v_mfma_f32_16x16x32_bf16 v[16:19], a[196:199], v[236:239], v[16:19]
    v_fma_f32 v170, v206, s35, v170 mul:2
    v_fma_f32 v171, v207, s35, v171 mul:2
    v_mfma_f32_16x16x32_bf16 v[20:23], a[200:203], v[236:239], v[20:23]
    ds_read_b128 v[236:239], v253 offset:22880
    v_cvt_pk_bf16_f32 v198, v208, v209
    v_mfma_f32_16x16x32_bf16 v[20:23], a[212:215], v[228:231], v[20:23]
    buffer_load_dwordx4 a[252:255], v254, s[8:11], s42 offen offset:0 sc1
    v_mfma_f32_16x16x32_bf16 v[20:23], a[224:227], v[232:235], v[20:23]
    v_cvt_pk_bf16_f32 v199, v210, v211
    v_accvgpr_read_b32 v204, a76
    v_mfma_f32_16x16x32_bf16 v[24:27], a[192:195], v[228:231], v[24:27]
    v_accvgpr_read_b32 v205, a77
    v_accvgpr_read_b32 v206, a78
    v_mfma_f32_16x16x32_bf16 v[24:27], a[204:207], v[232:235], v[24:27]
    s_waitcnt lgkmcnt(0)
    v_accvgpr_read_b32 v207, a79
    v_accvgpr_read_b32 v208, a172
    v_mfma_f32_16x16x32_bf16 v[24:27], a[216:219], v[236:239], v[24:27]
    v_accvgpr_read_b32 v209, a173
    v_accvgpr_read_b32 v210, a174
    v_mfma_f32_16x16x32_bf16 v[28:31], a[220:223], v[236:239], v[28:31]
    buffer_load_dwordx4 v[240:243], v254, s[8:11], s42 offen offset:1024 sc1
    v_mfma_f32_16x16x32_bf16 v[28:31], a[208:211], v[232:235], v[28:31]
    v_accvgpr_read_b32 v211, a175
    v_sub_f32 v204, v204, v208
    v_mfma_f32_16x16x32_bf16 v[28:31], a[196:199], v[228:231], v[28:31]
    v_sub_f32 v205, v205, v209
    v_sub_f32 v206, v206, v210
    v_sub_f32 v207, v207, v211
    v_mfma_f32_16x16x32_bf16 v[32:35], a[200:203], v[228:231], v[32:35]
    ds_read_b128 v[228:231], v253 offset:24704
    v_fma_f32 v208, v204, s34, v172 div:2
    v_mfma_f32_16x16x32_bf16 v[32:35], a[212:215], v[232:235], v[32:35]
    buffer_load_dwordx4 v[244:247], v254, s[8:11], s42 offen offset:2048 sc1
    v_mfma_f32_16x16x32_bf16 v[32:35], a[224:227], v[236:239], v[32:35]
    v_fma_f32 v209, v205, s34, v173 div:2
    v_fma_f32 v210, v206, s34, v174 div:2
    v_mfma_f32_16x16x32_bf16 v[36:39], a[192:195], v[232:235], v[36:39]
    v_fma_f32 v211, v207, s34, v175 div:2
    v_fma_f32 v172, v204, s35, v172 mul:2
    v_mfma_f32_16x16x32_bf16 v[36:39], a[204:207], v[236:239], v[36:39]
    s_waitcnt lgkmcnt(0)
    v_fma_f32 v173, v205, s35, v173 mul:2
    v_fma_f32 v174, v206, s35, v174 mul:2
    v_mfma_f32_16x16x32_bf16 v[36:39], a[216:219], v[228:231], v[36:39]
    buffer_store_dwordx4 a[116:119], v254, s[12:15], s44 offen nt
    s_add_u32 s44, s40, 205824
    v_mfma_f32_16x16x32_bf16 v[40:43], a[220:223], v[228:231], v[40:43]
    v_fma_f32 v175, v207, s35, v175 mul:2
    v_cvt_pk_bf16_f32 v200, v208, v209
    v_mfma_f32_16x16x32_bf16 v[40:43], a[208:211], v[236:239], v[40:43]
    v_cvt_pk_bf16_f32 v201, v210, v211
    v_accvgpr_read_b32 v204, a80
    v_mfma_f32_16x16x32_bf16 v[40:43], a[196:199], v[232:235], v[40:43]
    buffer_store_dwordx4 a[120:123], v254, s[12:15], s44 offen nt
    s_add_u32 s44, s40, 197632
    v_accvgpr_read_b32 v205, a81
    v_mfma_f32_16x16x32_bf16 v[44:47], a[200:203], v[232:235], v[44:47]
    ds_read_b128 v[232:235], v253 offset:24448
    v_accvgpr_read_b32 v206, a82
    v_accvgpr_read_b32 v207, a83
    v_mfma_f32_16x16x32_bf16 v[44:47], a[212:215], v[236:239], v[44:47]
    ds_write_b128 v248, v[198:201] offset:2304
    v_mfma_f32_16x16x32_bf16 v[44:47], a[224:227], v[228:231], v[44:47]
    v_accvgpr_read_b32 v208, a176
    v_accvgpr_read_b32 v209, a177
    v_mfma_f32_16x16x32_bf16 v[48:51], a[192:195], v[236:239], v[48:51]
    v_accvgpr_read_b32 v210, a178
    v_accvgpr_read_b32 v211, a179
    v_mfma_f32_16x16x32_bf16 v[48:51], a[204:207], v[228:231], v[48:51]
    s_waitcnt lgkmcnt(1)
    v_sub_f32 v204, v204, v208
    v_sub_f32 v205, v205, v209
    v_mfma_f32_16x16x32_bf16 v[48:51], a[216:219], v[232:235], v[48:51]
    v_sub_f32 v206, v206, v210
    v_sub_f32 v207, v207, v211
    v_mfma_f32_16x16x32_bf16 v[52:55], a[220:223], v[232:235], v[52:55]
    v_fma_f32 v208, v204, s34, v176 div:2
    v_fma_f32 v209, v205, s34, v177 div:2
    v_mfma_f32_16x16x32_bf16 v[52:55], a[208:211], v[228:231], v[52:55]
    v_fma_f32 v210, v206, s34, v178 div:2
    v_fma_f32 v211, v207, s34, v179 div:2
    v_mfma_f32_16x16x32_bf16 v[52:55], a[196:199], v[236:239], v[52:55]
    v_fma_f32 v176, v204, s35, v176 mul:2
    v_fma_f32 v177, v205, s35, v177 mul:2
    v_mfma_f32_16x16x32_bf16 v[56:59], a[200:203], v[236:239], v[56:59]
    ds_read_b128 v[236:239], v253 offset:24192
    v_fma_f32 v178, v206, s35, v178 mul:2
    v_mfma_f32_16x16x32_bf16 v[56:59], a[212:215], v[228:231], v[56:59]
    v_fma_f32 v179, v207, s35, v179 mul:2
    v_cvt_pk_bf16_f32 v202, v208, v209
    v_cvt_pk_bf16_f32 v203, v210, v211
    v_mfma_f32_16x16x32_bf16 v[56:59], a[224:227], v[232:235], v[56:59]
    ds_write_b64 v249, v[202:203] offset:2368
    v_mfma_f32_16x16x32_bf16 v[60:63], a[192:195], v[228:231], v[60:63]
    v_accvgpr_read_b32 v204, a180
    v_accvgpr_read_b32 v205, a181
    v_mfma_f32_16x16x32_bf16 v[60:63], a[204:207], v[232:235], v[60:63]
    s_waitcnt lgkmcnt(1)
    v_accvgpr_read_b32 v206, a182
    v_accvgpr_read_b32 v207, a183
    v_mfma_f32_16x16x32_bf16 v[60:63], a[216:219], v[236:239], v[60:63]
    v_fma_f32 v208, v204, s34, v180 div:2
    v_fma_f32 v209, v205, s34, v181 div:2
    v_mfma_f32_16x16x32_bf16 v[64:67], a[220:223], v[236:239], v[64:67]
    v_fma_f32 v210, v206, s34, v182 div:2
    v_fma_f32 v211, v207, s34, v183 div:2
    v_mfma_f32_16x16x32_bf16 v[64:67], a[208:211], v[232:235], v[64:67]
    v_fma_f32 v180, v204, s35, v180 mul:2
    v_fma_f32 v181, v205, s35, v181 mul:2
    v_mfma_f32_16x16x32_bf16 v[64:67], a[196:199], v[228:231], v[64:67]
    v_fma_f32 v182, v206, s35, v182 mul:2
    v_fma_f32 v183, v207, s35, v183 mul:2
    v_mfma_f32_16x16x32_bf16 v[68:71], a[200:203], v[228:231], v[68:71]
    ds_read_b128 v[228:231], v253 offset:23936
    v_cvt_pk_bf16_f32 v192, v208, v209
    v_mfma_f32_16x16x32_bf16 v[68:71], a[212:215], v[232:235], v[68:71]
    v_cvt_pk_bf16_f32 v193, v210, v211
    v_accvgpr_read_b32 v204, a184
    v_mfma_f32_16x16x32_bf16 v[68:71], a[224:227], v[236:239], v[68:71]
    v_accvgpr_read_b32 v205, a185
    v_accvgpr_read_b32 v206, a186
    v_accvgpr_read_b32 v207, a187
    v_mfma_f32_16x16x32_bf16 v[72:75], a[192:195], v[232:235], v[72:75]
    v_fma_f32 v208, v204, s34, v184 div:2
    v_fma_f32 v209, v205, s34, v185 div:2
    v_mfma_f32_16x16x32_bf16 v[72:75], a[204:207], v[236:239], v[72:75]
    s_waitcnt lgkmcnt(0)
    v_fma_f32 v210, v206, s34, v186 div:2
    v_fma_f32 v211, v207, s34, v187 div:2
    v_mfma_f32_16x16x32_bf16 v[72:75], a[216:219], v[228:231], v[72:75]
    v_fma_f32 v184, v204, s35, v184 mul:2
    v_fma_f32 v185, v205, s35, v185 mul:2
    v_mfma_f32_16x16x32_bf16 v[76:79], a[220:223], v[228:231], v[76:79]
    v_fma_f32 v186, v206, s35, v186 mul:2
    v_fma_f32 v187, v207, s35, v187 mul:2
    v_mfma_f32_16x16x32_bf16 v[76:79], a[208:211], v[236:239], v[76:79]
    v_cvt_pk_bf16_f32 v194, v208, v209
    v_cvt_pk_bf16_f32 v195, v210, v211
    v_mfma_f32_16x16x32_bf16 v[76:79], a[196:199], v[232:235], v[76:79]
    ds_write_b128 v248, v[192:195] offset:2688
    v_mfma_f32_16x16x32_bf16 v[80:83], a[200:203], v[232:235], v[80:83]
    ds_read_b128 v[232:235], v253 offset:23664
    v_accvgpr_read_b32 v204, a188
    v_mfma_f32_16x16x32_bf16 v[80:83], a[212:215], v[236:239], v[80:83]
    v_accvgpr_read_b32 v205, a189
    v_accvgpr_read_b32 v206, a190
    v_mfma_f32_16x16x32_bf16 v[80:83], a[224:227], v[228:231], v[80:83]
    s_mov_b32 s42, 1105920
    v_accvgpr_read_b32 v207, a191
    v_fma_f32 v208, v204, s34, v188 div:2
    v_mfma_f32_16x16x32_bf16 v[84:87], a[192:195], v[236:239], v[84:87]
    s_waitcnt lgkmcnt(0)
    v_fma_f32 v209, v205, s34, v189 div:2
    v_fma_f32 v210, v206, s34, v190 div:2
    v_fma_f32 v211, v207, s34, v191 div:2
    v_mfma_f32_16x16x32_bf16 v[88:91], a[196:199], v[236:239], v[88:91]
    s_barrier
    v_mfma_f32_16x16x32_bf16 v[92:95], a[200:203], v[236:239], v[92:95]
    ds_read_b128 v[236:239], v253 offset:34320
    v_fma_f32 v188, v204, s35, v188 mul:2
    v_mfma_f32_16x16x32_bf16 v[92:95], a[212:215], v[228:231], v[92:95]
    buffer_load_dwordx4 a[192:195], v254, s[8:11], s42 offen offset:0 sc1
    v_mfma_f32_16x16x32_bf16 v[88:91], a[208:211], v[228:231], v[88:91]
    v_fma_f32 v189, v205, s35, v189 mul:2
    v_fma_f32 v190, v206, s35, v190 mul:2
    v_mfma_f32_16x16x32_bf16 v[84:87], a[204:207], v[228:231], v[84:87]
    ds_read_b128 v[228:231], v253 offset:34048
    v_fma_f32 v191, v207, s35, v191 mul:2
    v_mfma_f32_16x16x32_bf16 v[84:87], a[216:219], v[232:235], v[84:87]
    buffer_load_dwordx4 a[196:199], v254, s[8:11], s42 offen offset:1024 sc1
    v_mfma_f32_16x16x32_bf16 v[88:91], a[220:223], v[232:235], v[88:91]
    s_waitcnt vmcnt(10) lgkmcnt(1)
    v_cvt_pk_bf16_f32 v196, v208, v209
    v_cvt_pk_bf16_f32 v197, v210, v211
    v_mfma_f32_16x16x32_bf16 v[92:95], a[224:227], v[232:235], v[92:95]
    ds_read_b128 v[232:235], v253 offset:33792
sub29:
    v_mfma_f32_16x16x32_bf16 v[0:3], a[228:231], v[236:239], v[0:3]
    buffer_load_dwordx4 a[200:203], v254, s[8:11], s42 offen offset:2048 sc1
    v_mfma_f32_16x16x32_bf16 v[4:7], a[232:235], v[236:239], v[4:7]
    s_mov_b32 s42, 1108992
    v_mfma_f32_16x16x32_bf16 v[8:11], a[236:239], v[236:239], v[8:11]
    ds_read_b128 v[236:239], v253 offset:33536
    s_waitcnt vmcnt(8)
    s_waitcnt lgkmcnt(2)
    v_mfma_f32_16x16x32_bf16 v[8:11], a[248:251], v[228:231], v[8:11]
pad11:
    s_cbranch_vccnz warm_ret
    ds_read_b128 a[124:127], v250 offset:1024
    v_mfma_f32_16x16x32_bf16 v[4:7], a[244:247], v[228:231], v[4:7]
    buffer_load_dwordx4 a[204:207], v254, s[8:11], s42 offen offset:0 sc1
    v_mfma_f32_16x16x32_bf16 v[0:3], a[240:243], v[228:231], v[0:3]
    s_waitcnt vmcnt(6) lgkmcnt(2)
    v_mfma_f32_16x16x32_bf16 v[0:3], a[252:255], v[232:235], v[0:3]
    ds_write_b64 v249, v[196:197] offset:2752
    v_mfma_f32_16x16x32_bf16 v[4:7], v[240:243], v[232:235], v[4:7]
    ds_read_b128 a[128:131], v250 offset:4128
    v_mfma_f32_16x16x32_bf16 v[8:11], v[244:247], v[232:235], v[8:11]
    buffer_load_dwordx4 a[208:211], v254, s[8:11], s42 offen offset:1024 sc1
    v_mfma_f32_16x16x32_bf16 v[12:15], a[228:231], v[228:231], v[12:15]
    ds_read_b128 a[132:135], v250 offset:7232
    s_waitcnt lgkmcnt(3)
    v_mfma_f32_16x16x32_bf16 v[12:15], a[240:243], v[232:235], v[12:15]
    v_mfma_f32_16x16x32_bf16 v[12:15], a[252:255], v[236:239], v[12:15]
    v_mfma_f32_16x16x32_bf16 v[16:19], v[240:243], v[236:239], v[16:19]
    buffer_load_dwordx4 a[212:215], v254, s[8:11], s42 offen offset:2048 sc1
    v_mfma_f32_16x16x32_bf16 v[16:19], a[244:247], v[232:235], v[16:19]
    s_mov_b32 s42, 1112064
    v_mfma_f32_16x16x32_bf16 v[16:19], a[232:235], v[228:231], v[16:19]
    buffer_store_dwordx4 a[124:127], v254, s[12:15], s44 offen nt
    s_add_u32 s44, s40, 200704
    s_waitcnt lgkmcnt(1)
    v_mfma_f32_16x16x32_bf16 v[20:23], a[236:239], v[228:231], v[20:23]
    ds_read_b128 v[228:231], v253 offset:33280
    v_mfma_f32_16x16x32_bf16 v[20:23], a[248:251], v[232:235], v[20:23]
    buffer_load_dwordx4 a[216:219], v254, s[8:11], s42 offen offset:0 sc1
    v_mfma_f32_16x16x32_bf16 v[20:23], v[244:247], v[236:239], v[20:23]
    ds_read_b128 a[136:139], v250 offset:10336
    v_mfma_f32_16x16x32_bf16 v[24:27], a[228:231], v[232:235], v[24:27]
    buffer_store_dwordx4 a[128:131], v254, s[12:15], s44 offen nt
    s_add_u32 s44, s40, 203776
    s_waitcnt lgkmcnt(2)
    v_mfma_f32_16x16x32_bf16 v[24:27], a[240:243], v[236:239], v[24:27]
    s_waitcnt lgkmcnt(1)
    v_mfma_f32_16x16x32_bf16 v[24:27], a[252:255], v[228:231], v[24:27]
    v_cvt_pk_bf16_f32 v8, v8, v9
    v_cvt_pk_bf16_f32 v9, v10, v11
    v_mfma_f32_16x16x32_bf16 v[28:31], v[240:243], v[228:231], v[28:31]
    buffer_load_dwordx4 a[220:223], v254, s[8:11], s42 offen offset:1024 sc1
    v_mfma_f32_16x16x32_bf16 v[28:31], a[244:247], v[236:239], v[28:31]
    ds_write_b64 v249, v[8:9] offset:12544
    v_mfma_f32_16x16x32_bf16 v[28:31], a[232:235], v[232:235], v[28:31]
    v_cvt_pk_bf16_f32 v0, v0, v1
    v_cvt_pk_bf16_f32 v1, v2, v3
    v_mfma_f32_16x16x32_bf16 v[32:35], a[236:239], v[232:235], v[32:35]
    ds_read_b128 v[232:235], v253 offset:35104
    v_cvt_pk_bf16_f32 v2, v4, v5
    v_mfma_f32_16x16x32_bf16 v[32:35], a[248:251], v[236:239], v[32:35]
    buffer_load_dwordx4 a[224:227], v254, s[8:11], s42 offen offset:2048 sc1
    v_mfma_f32_16x16x32_bf16 v[32:35], v[244:247], v[228:231], v[32:35]
    v_cvt_pk_bf16_f32 v3, v6, v7
    v_mov_b32 v4, v248
    v_mfma_f32_16x16x32_bf16 v[36:39], a[228:231], v[236:239], v[36:39]
    buffer_store_dwordx4 a[132:135], v254, s[12:15], s44 offen nt
    v_and_b32 v227, 0x7fff, v255
    v_mov_b32 v5, v249
    v_mfma_f32_16x16x32_bf16 v[36:39], a[240:243], v[228:231], v[36:39]
    s_waitcnt lgkmcnt(0)
    s_add_u32 s44, s40, 206848
    v_mov_b32 v6, v250
    v_mfma_f32_16x16x32_bf16 v[36:39], a[252:255], v[232:235], v[36:39]
    buffer_load_dwordx2 v[216:217], v227, s[4:7], s16 offen offset:0
    v_mfma_f32_16x16x32_bf16 v[40:43], v[240:243], v[232:235], v[40:43]
    ds_write_b128 v248, v[0:3] offset:12480
    v_mfma_f32_16x16x32_bf16 v[40:43], a[244:247], v[228:231], v[40:43]
    v_cvt_pk_bf16_f32 v20, v20, v21
    v_cvt_pk_bf16_f32 v21, v22, v23
    v_mfma_f32_16x16x32_bf16 v[40:43], a[232:235], v[236:239], v[40:43]
    v_cvt_pk_bf16_f32 v12, v12, v13
    v_cvt_pk_bf16_f32 v13, v14, v15
    v_mfma_f32_16x16x32_bf16 v[44:47], a[236:239], v[236:239], v[44:47]
    ds_read_b128 v[236:239], v253 offset:34848
    v_cvt_pk_bf16_f32 v14, v16, v17
    v_mfma_f32_16x16x32_bf16 v[44:47], a[248:251], v[228:231], v[44:47]
    buffer_load_dwordx2 v[218:219], v227, s[4:7], s17 offen offset:0
    v_mfma_f32_16x16x32_bf16 v[44:47], v[244:247], v[232:235], v[44:47]
    ds_write_b64 v5, v[20:21] offset:12928
    v_mfma_f32_16x16x32_bf16 v[48:51], a[228:231], v[228:231], v[48:51]
    v_cvt_pk_bf16_f32 v15, v18, v19
    v_cvt_pk_bf16_f32 v32, v32, v33
    v_mfma_f32_16x16x32_bf16 v[48:51], a[240:243], v[232:235], v[48:51]
    s_waitcnt lgkmcnt(1)
    v_cvt_pk_bf16_f32 v33, v34, v35
    v_cvt_pk_bf16_f32 v24, v24, v25
    v_mfma_f32_16x16x32_bf16 v[48:51], a[252:255], v[236:239], v[48:51]
    buffer_load_dwordx2 v[220:221], v227, s[4:7], s18 offen offset:0
    v_mfma_f32_16x16x32_bf16 v[52:55], v[240:243], v[236:239], v[52:55]
    ds_write_b128 v4, v[12:15] offset:12864
    v_mfma_f32_16x16x32_bf16 v[52:55], a[244:247], v[232:235], v[52:55]
    v_cvt_pk_bf16_f32 v25, v26, v27
    v_cvt_pk_bf16_f32 v26, v28, v29
    v_mfma_f32_16x16x32_bf16 v[52:55], a[232:235], v[228:231], v[52:55]
    v_cvt_pk_bf16_f32 v27, v30, v31
    v_cvt_pk_bf16_f32 v44, v44, v45
    v_mfma_f32_16x16x32_bf16 v[56:59], a[236:239], v[228:231], v[56:59]
    ds_read_b128 v[228:231], v253 offset:34592
    v_cvt_pk_bf16_f32 v45, v46, v47
    v_mfma_f32_16x16x32_bf16 v[56:59], a[248:251], v[232:235], v[56:59]
    buffer_load_dwordx2 v[222:223], v227, s[4:7], s19 offen offset:0
    v_mfma_f32_16x16x32_bf16 v[56:59], v[244:247], v[236:239], v[56:59]
    ds_write_b64 v5, v[32:33] offset:13312
    v_mfma_f32_16x16x32_bf16 v[60:63], a[228:231], v[232:235], v[60:63]
    v_cvt_pk_bf16_f32 v36, v36, v37
    v_cvt_pk_bf16_f32 v37, v38, v39
    v_mfma_f32_16x16x32_bf16 v[60:63], a[240:243], v[236:239], v[60:63]
    s_waitcnt lgkmcnt(1)
    v_cvt_pk_bf16_f32 v38, v40, v41
    v_cvt_pk_bf16_f32 v39, v42, v43
    v_mfma_f32_16x16x32_bf16 v[60:63], a[252:255], v[228:231], v[60:63]
    buffer_load_dwordx2 v[224:225], v227, s[4:7], s20 offen offset:0
    v_mfma_f32_16x16x32_bf16 v[64:67], v[240:243], v[228:231], v[64:67]
    ds_write_b128 v4, v[24:27] offset:13248
    v_mfma_f32_16x16x32_bf16 v[64:67], a[244:247], v[236:239], v[64:67]
    v_mfma_f32_16x16x32_bf16 v[64:67], a[232:235], v[232:235], v[64:67]
    v_cvt_pk_bf16_f32 v56, v56, v57
    v_cvt_pk_bf16_f32 v57, v58, v59
    v_mfma_f32_16x16x32_bf16 v[68:71], a[236:239], v[232:235], v[68:71]
    ds_read_b128 v[232:235], v253 offset:34336
    v_cvt_pk_bf16_f32 v48, v48, v49
    v_mfma_f32_16x16x32_bf16 v[68:71], a[248:251], v[236:239], v[68:71]
    buffer_load_dwordx2 v[226:227], v227, s[4:7], s21 offen offset:0
    v_mfma_f32_16x16x32_bf16 v[68:71], v[244:247], v[228:231], v[68:71]
    ds_write_b64 v5, v[44:45] offset:13696
    v_mfma_f32_16x16x32_bf16 v[72:75], a[228:231], v[236:239], v[72:75]
    buffer_store_dwordx4 a[136:139], v254, s[12:15], s44 offen nt
    s_add_u32 s44, s40, 198656
    v_cvt_pk_bf16_f32 v49, v50, v51
    v_mfma_f32_16x16x32_bf16 v[72:75], a[240:243], v[228:231], v[72:75]
    s_waitcnt lgkmcnt(1)
    v_cvt_pk_bf16_f32 v50, v52, v53
    v_cvt_pk_bf16_f32 v51, v54, v55
    v_mfma_f32_16x16x32_bf16 v[72:75], a[252:255], v[232:235], v[72:75]
    ds_write_b128 v4, v[36:39] offset:13632
    v_mfma_f32_16x16x32_bf16 v[76:79], v[240:243], v[232:235], v[76:79]
    v_mfma_f32_16x16x32_bf16 v[76:79], a[244:247], v[228:231], v[76:79]
    v_mfma_f32_16x16x32_bf16 v[76:79], a[232:235], v[236:239], v[76:79]
    v_cvt_pk_bf16_f32 v68, v68, v69
    v_cvt_pk_bf16_f32 v69, v70, v71
    v_mfma_f32_16x16x32_bf16 v[80:83], a[236:239], v[236:239], v[80:83]
    ds_read_b128 v[236:239], v253 offset:34064
    v_cvt_pk_bf16_f32 v60, v60, v61
    v_mfma_f32_16x16x32_bf16 v[80:83], a[248:251], v[228:231], v[80:83]
    v_cvt_pk_bf16_f32 v61, v62, v63
    v_cvt_pk_bf16_f32 v62, v64, v65
    v_mfma_f32_16x16x32_bf16 v[80:83], v[244:247], v[232:235], v[80:83]
    s_mov_b32 s42, 1142784
    v_cvt_pk_bf16_f32 v63, v66, v67
    v_mfma_f32_16x16x32_bf16 v[84:87], a[228:231], v[228:231], v[84:87]
    s_waitcnt lgkmcnt(0)
    v_mfma_f32_16x16x32_bf16 v[88:91], a[232:235], v[228:231], v[88:91]
    s_barrier
    v_mfma_f32_16x16x32_bf16 v[92:95], a[236:239], v[228:231], v[92:95]
    ds_read_b128 v[228:231], v253 offset:36400
    v_mfma_f32_16x16x32_bf16 v[92:95], a[248:251], v[232:235], v[92:95]
    buffer_load_dwordx4 a[228:231], v254, s[8:11], s42 offen offset:0 sc1
    v_mfma_f32_16x16x32_bf16 v[88:91], a[244:247], v[232:235], v[88:91]
    v_mfma_f32_16x16x32_bf16 v[84:87], a[240:243], v[232:235], v[84:87]
    ds_read_b128 v[232:235], v253 offset:36128
    v_cvt_pk_bf16_f32 v80, v80, v81
    v_mfma_f32_16x16x32_bf16 v[84:87], a[252:255], v[236:239], v[84:87]
    buffer_load_dwordx4 a[232:235], v254, s[8:11], s42 offen offset:1024 sc1
    v_mfma_f32_16x16x32_bf16 v[88:91], v[240:243], v[236:239], v[88:91]
    s_waitcnt vmcnt(18) lgkmcnt(1)
    v_cvt_pk_bf16_f32 v81, v82, v83
    v_cvt_pk_bf16_f32 v72, v72, v73
    v_mfma_f32_16x16x32_bf16 v[92:95], v[244:247], v[236:239], v[92:95]
    ds_read_b128 v[236:239], v253 offset:35872
    v_cvt_pk_bf16_f32 v73, v74, v75
sub30:
    v_mfma_f32_16x16x32_bf16 v[96:99], a[192:195], v[228:231], v[96:99]
    buffer_load_dwordx4 a[236:239], v254, s[8:11], s42 offen offset:2048 sc1
    v_mfma_f32_16x16x32_bf16 v[100:103], a[196:199], v[228:231], v[100:103]
    s_mov_b32 s42, 1145856
    v_cvt_pk_bf16_f32 v74, v76, v77
    v_cvt_pk_bf16_f32 v75, v78, v79
    v_mfma_f32_16x16x32_bf16 v[104:107], a[200:203], v[228:231], v[104:107]
    ds_read_b128 v[228:231], v253 offset:35616
    s_waitcnt vmcnt(16)
    s_waitcnt lgkmcnt(2)
    v_mfma_f32_16x16x32_bf16 v[104:107], a[212:215], v[232:235], v[104:107]
    ds_read_b128 a[140:143], v6 offset:2048
    v_mfma_f32_16x16x32_bf16 v[100:103], a[208:211], v[232:235], v[100:103]
    buffer_load_dwordx4 a[240:243], v254, s[8:11], s42 offen offset:0 sc1
    v_mfma_f32_16x16x32_bf16 v[96:99], a[204:207], v[232:235], v[96:99]
    s_waitcnt vmcnt(12) lgkmcnt(2)
    v_cvt_pk_bf16_f32 v92, v92, v93
    v_cvt_pk_bf16_f32 v93, v94, v95
    v_mfma_f32_16x16x32_bf16 v[96:99], a[216:219], v[236:239], v[96:99]
    v_cvt_pk_bf16_f32 v84, v84, v85
    v_cvt_pk_bf16_f32 v85, v86, v87
    v_mfma_f32_16x16x32_bf16 v[100:103], a[220:223], v[236:239], v[100:103]
    ds_read_b128 a[144:147], v6 offset:5152
    v_cvt_pk_bf16_f32 v86, v88, v89
    v_mfma_f32_16x16x32_bf16 v[104:107], a[224:227], v[236:239], v[104:107]
    buffer_load_dwordx4 a[244:247], v254, s[8:11], s42 offen offset:1024 sc1
    v_mfma_f32_16x16x32_bf16 v[108:111], a[192:195], v[232:235], v[108:111]
    s_waitcnt lgkmcnt(1)
    v_cvt_pk_bf16_f32 v87, v90, v91
    v_mfma_f32_16x16x32_bf16 v[108:111], a[204:207], v[236:239], v[108:111]
    v_mfma_f32_16x16x32_bf16 v[108:111], a[216:219], v[228:231], v[108:111]
    ds_write_b64 v5, v[56:57] offset:14080
    v_mfma_f32_16x16x32_bf16 v[112:115], a[220:223], v[228:231], v[112:115]
    buffer_load_dwordx4 a[248:251], v254, s[8:11], s42 offen offset:2048 sc1
    v_mfma_f32_16x16x32_bf16 v[112:115], a[208:211], v[236:239], v[112:115]
    s_mov_b32 s42, 1148928
    v_mfma_f32_16x16x32_bf16 v[112:115], a[196:199], v[232:235], v[112:115]
    buffer_store_dwordx4 a[140:143], v254, s[12:15], s44 offen nt
    s_add_u32 s44, s40, 201728
    s_waitcnt lgkmcnt(1)
    v_mfma_f32_16x16x32_bf16 v[116:119], a[200:203], v[232:235], v[116:119]
    ds_read_b128 v[232:235], v253 offset:35360
    v_mfma_f32_16x16x32_bf16 v[116:119], a[212:215], v[236:239], v[116:119]
    buffer_load_dwordx4 a[252:255], v254, s[8:11], s42 offen offset:0 sc1
    v_mfma_f32_16x16x32_bf16 v[116:119], a[224:227], v[228:231], v[116:119]
    ds_read_b128 a[148:151], v6 offset:8256
    v_mfma_f32_16x16x32_bf16 v[120:123], a[192:195], v[236:239], v[120:123]
    v_mfma_f32_16x16x32_bf16 v[120:123], a[204:207], v[228:231], v[120:123]
    s_waitcnt lgkmcnt(1)
    v_mfma_f32_16x16x32_bf16 v[120:123], a[216:219], v[232:235], v[120:123]
    ds_write_b128 v4, v[48:51] offset:14016
    v_mfma_f32_16x16x32_bf16 v[124:127], a[220:223], v[232:235], v[124:127]
    buffer_load_dwordx4 v[240:243], v254, s[8:11], s42 offen offset:1024 sc1
    v_mfma_f32_16x16x32_bf16 v[124:127], a[208:211], v[228:231], v[124:127]
    ds_read_b128 a[152:155], v6 offset:11360
    v_mfma_f32_16x16x32_bf16 v[124:127], a[196:199], v[236:239], v[124:127]
    v_mfma_f32_16x16x32_bf16 v[128:131], a[200:203], v[236:239], v[128:131]
    ds_read_b128 v[236:239], v253 offset:37184
    v_mfma_f32_16x16x32_bf16 v[128:131], a[212:215], v[228:231], v[128:131]
    buffer_load_dwordx4 v[244:247], v254, s[8:11], s42 offen offset:2048 sc1
    v_mfma_f32_16x16x32_bf16 v[128:131], a[224:227], v[232:235], v[128:131]
    ds_write_b64 v5, v[68:69] offset:14464
    v_mfma_f32_16x16x32_bf16 v[132:135], a[192:195], v[228:231], v[132:135]
    buffer_store_dwordx4 a[144:147], v254, s[12:15], s44 offen nt
    v_and_b32 v203, 0x7fff, v255
    s_waitcnt vmcnt(12)
    v_mfma_f32_16x16x32_bf16 v[132:135], a[204:207], v[232:235], v[132:135]
    s_waitcnt lgkmcnt(1)
    v_lshlrev_b32 v248, 16, v218
    v_lshlrev_b32 v249, 16, v220
    v_mfma_f32_16x16x32_bf16 v[132:135], a[216:219], v[236:239], v[132:135]
    buffer_load_dwordx2 v[192:193], v203, s[4:7], s16 offen offset:384
    v_mfma_f32_16x16x32_bf16 v[136:139], a[220:223], v[236:239], v[136:139]
    s_add_u32 s44, s40, 204800
    v_lshlrev_b32 v250, 16, v222
    v_lshlrev_b32 v251, 16, v224
    v_mfma_f32_16x16x32_bf16 v[136:139], a[208:211], v[232:235], v[136:139]
    ds_write_b128 v4, v[60:63] offset:14400
    v_mfma_f32_16x16x32_bf16 v[136:139], a[196:199], v[228:231], v[136:139]
    v_and_b32 v218, s22, v218
    v_and_b32 v220, s22, v220
    v_mfma_f32_16x16x32_bf16 v[140:143], a[200:203], v[228:231], v[140:143]
    ds_read_b128 v[228:231], v253 offset:36928
    v_and_b32 v222, s22, v222
    v_mfma_f32_16x16x32_bf16 v[140:143], a[212:215], v[232:235], v[140:143]
    buffer_load_dwordx2 v[194:195], v203, s[4:7], s17 offen offset:384
    v_mfma_f32_16x16x32_bf16 v[140:143], a[224:227], v[236:239], v[140:143]
    ds_write_b64 v5, v[80:81] offset:14848
    v_mfma_f32_16x16x32_bf16 v[144:147], a[192:195], v[232:235], v[144:147]
    v_and_b32 v224, s22, v224
    v_lshlrev_b32 v252, 16, v216
    v_mfma_f32_16x16x32_bf16 v[144:147], a[204:207], v[236:239], v[144:147]
    s_waitcnt lgkmcnt(1)
    v_and_b32 v216, s22, v216
    v_fmac_f32 v252, s25, v251
    v_mfma_f32_16x16x32_bf16 v[144:147], a[216:219], v[228:231], v[144:147]
    buffer_load_dwordx2 v[196:197], v203, s[4:7], s18 offen offset:384
    v_mfma_f32_16x16x32_bf16 v[148:151], a[220:223], v[228:231], v[148:151]
    v_fmac_f32 v216, s25, v224
    v_fmac_f32 v252, s28, v249
    v_mfma_f32_16x16x32_bf16 v[148:151], a[208:211], v[236:239], v[148:151]
    ds_write_b128 v4, v[72:75] offset:14784
    v_mfma_f32_16x16x32_bf16 v[148:151], a[196:199], v[232:235], v[148:151]
    v_fmac_f32 v216, s28, v220
    v_cvt_pk_bf16_f32 v216, v252, v216
    v_mfma_f32_16x16x32_bf16 v[152:155], a[200:203], v[232:235], v[152:155]
    ds_read_b128 v[232:235], v253 offset:36672
    v_lshlrev_b32 v252, 16, v226
    v_mfma_f32_16x16x32_bf16 v[152:155], a[212:215], v[236:239], v[152:155]
    buffer_load_dwordx2 v[198:199], v203, s[4:7], s19 offen offset:384
    v_mfma_f32_16x16x32_bf16 v[152:155], a[224:227], v[228:231], v[152:155]
    ds_write_b64 v5, v[92:93] offset:15232
    v_mfma_f32_16x16x32_bf16 v[156:159], a[192:195], v[236:239], v[156:159]
    v_and_b32 v226, s22, v226
    v_fmac_f32 v252, s29, v248
    v_mfma_f32_16x16x32_bf16 v[156:159], a[204:207], v[228:231], v[156:159]
    s_waitcnt lgkmcnt(1)
    v_fmac_f32 v226, s29, v218
    v_fmac_f32 v252, s23, v250
    v_mfma_f32_16x16x32_bf16 v[156:159], a[216:219], v[232:235], v[156:159]
    buffer_load_dwordx2 v[200:201], v203, s[4:7], s20 offen offset:384
    v_mfma_f32_16x16x32_bf16 v[160:163], a[220:223], v[232:235], v[160:163]
    ds_write_b128 v4, v[84:87] offset:15168
    v_mfma_f32_16x16x32_bf16 v[160:163], a[208:211], v[228:231], v[160:163]
    v_fmac_f32 v226, s23, v222
    v_cvt_pk_bf16_f32 v226, v252, v226
    v_mfma_f32_16x16x32_bf16 v[160:163], a[196:199], v[236:239], v[160:163]
    v_fma_f32 v252, v249, s24, v251
    v_fmac_f32 v251, -4.0, v249
    v_mfma_f32_16x16x32_bf16 v[164:167], a[200:203], v[236:239], v[164:167]
    ds_read_b128 v[236:239], v253 offset:36416
    v_fma_f32 v249, v248, s24, v250
    v_mfma_f32_16x16x32_bf16 v[164:167], a[212:215], v[228:231], v[164:167]
    buffer_load_dwordx2 v[202:203], v203, s[4:7], s21 offen offset:384
    v_mfma_f32_16x16x32_bf16 v[164:167], a[224:227], v[232:235], v[164:167]
    v_fmac_f32 v250, -4.0, v248
    v_fma_f32 v248, v250, s26, v251
    v_mfma_f32_16x16x32_bf16 v[168:171], a[192:195], v[228:231], v[168:171]
    buffer_store_dwordx4 a[148:151], v254, s[12:15], s44 offen nt
    s_add_u32 s44, s40, 207872
    v_fmac_f32 v251, s27, v250
    v_mfma_f32_16x16x32_bf16 v[168:171], a[204:207], v[232:235], v[168:171]
    s_waitcnt lgkmcnt(0)
    v_fma_f32 v250, v249, 2.0, v252
    v_fmac_f32 v252, -2.0, v249
    v_mfma_f32_16x16x32_bf16 v[168:171], a[216:219], v[236:239], v[168:171]
    v_fma_f32 v249, v220, s24, v224
    v_fmac_f32 v224, -4.0, v220
    v_mfma_f32_16x16x32_bf16 v[172:175], a[220:223], v[236:239], v[172:175]
    v_fma_f32 v220, v218, s24, v222
    v_fmac_f32 v222, -4.0, v218
    v_mfma_f32_16x16x32_bf16 v[172:175], a[208:211], v[232:235], v[172:175]
    v_fma_f32 v218, v222, s26, v224
    v_fmac_f32 v224, s27, v222
    v_mfma_f32_16x16x32_bf16 v[172:175], a[196:199], v[228:231], v[172:175]
    v_fma_f32 v222, v220, 2.0, v249
    v_fmac_f32 v249, -2.0, v220
    v_mfma_f32_16x16x32_bf16 v[176:179], a[200:203], v[228:231], v[176:179]
    ds_read_b128 v[228:231], v253 offset:36144
    v_cvt_pk_bf16_f32 v218, v248, v218
    v_mfma_f32_16x16x32_bf16 v[176:179], a[212:215], v[232:235], v[176:179]
    v_cvt_pk_bf16_f32 v224, v251, v224
    v_cvt_pk_bf16_f32 v222, v250, v222
    v_mfma_f32_16x16x32_bf16 v[176:179], a[224:227], v[236:239], v[176:179]
    s_mov_b32 s42, 1179648
    v_cvt_pk_bf16_f32 v220, v252, v249
    v_mfma_f32_16x16x32_bf16 v[180:183], a[192:195], v[232:235], v[180:183]
    s_waitcnt lgkmcnt(0)
    v_lshlrev_b32 v248, 16, v219
    v_lshlrev_b32 v249, 16, v221
    v_mfma_f32_16x16x32_bf16 v[184:187], a[196:199], v[232:235], v[184:187]
    s_barrier
    v_mfma_f32_16x16x32_bf16 v[188:191], a[200:203], v[232:235], v[188:191]
    ds_read_b128 v[232:235], v253 offset:38480
    v_lshlrev_b32 v250, 16, v223
    v_mfma_f32_16x16x32_bf16 v[188:191], a[212:215], v[236:239], v[188:191]
    buffer_load_dwordx4 a[192:195], v254, s[8:11], s42 offen offset:0 sc1
    v_mfma_f32_16x16x32_bf16 v[184:187], a[208:211], v[236:239], v[184:187]
    v_lshlrev_b32 v251, 16, v225
    v_and_b32 v219, s22, v219
    v_mfma_f32_16x16x32_bf16 v[180:183], a[204:207], v[236:239], v[180:183]
    ds_read_b128 v[236:239], v253 offset:38208
    v_and_b32 v221, s22, v221
    v_mfma_f32_16x16x32_bf16 v[180:183], a[216:219], v[228:231], v[180:183]
    buffer_load_dwordx4 a[196:199], v254, s[8:11], s42 offen offset:1024 sc1
    v_mfma_f32_16x16x32_bf16 v[184:187], a[220:223], v[228:231], v[184:187]
    s_waitcnt vmcnt(17) lgkmcnt(1)
    v_and_b32 v223, s22, v223
    v_and_b32 v225, s22, v225
    v_mfma_f32_16x16x32_bf16 v[188:191], a[224:227], v[228:231], v[188:191]
    ds_read_b128 v[228:231], v253 offset:37952
    v_lshlrev_b32 v252, 16, v217
sub31:
    v_mfma_f32_16x16x32_bf16 v[96:99], a[228:231], v[232:235], v[96:99]
    buffer_load_dwordx4 a[200:203], v254, s[8:11], s42 offen offset:2048 sc1
    v_mfma_f32_16x16x32_bf16 v[100:103], a[232:235], v[232:235], v[100:103]
    s_mov_b32 s42, 1182720
    v_and_b32 v217, s22, v217
    v_fmac_f32 v252, s25, v251
    v_mfma_f32_16x16x32_bf16 v[104:107], a[236:239], v[232:235], v[104:107]
    ds_read_b128 v[232:235], v253 offset:37696
    s_waitcnt vmcnt(15)
    s_waitcnt lgkmcnt(2)
    v_mfma_f32_16x16x32_bf16 v[104:107], a[248:251], v[236:239], v[104:107]
    ds_read_b128 a[0:3], v6 offset:12480
    v_fmac_f32 v217, s25, v225
    v_mfma_f32_16x16x32_bf16 v[100:103], a[244:247], v[236:239], v[100:103]
    buffer_load_dwordx4 a[204:207], v254, s[8:11], s42 offen offset:0 sc1
    v_mfma_f32_16x16x32_bf16 v[96:99], a[240:243], v[236:239], v[96:99]
    s_waitcnt vmcnt(12) lgkmcnt(2)
    v_fmac_f32 v252, s28, v249
    v_fmac_f32 v217, s28, v221
    v_mfma_f32_16x16x32_bf16 v[96:99], a[252:255], v[228:231], v[96:99]
    buffer_store_dwordx4 a[152:155], v254, s[12:15], s44 offen nt
    v_cvt_pk_bf16_f32 v217, v252, v217
    v_lshlrev_b32 v252, 16, v227
    v_mfma_f32_16x16x32_bf16 v[100:103], v[240:243], v[228:231], v[100:103]
    v_and_b32 v227, s22, v227
    v_fmac_f32 v252, s29, v248
    v_mfma_f32_16x16x32_bf16 v[104:107], v[244:247], v[228:231], v[104:107]
    buffer_load_dwordx4 a[208:211], v254, s[8:11], s42 offen offset:1024 sc1
    v_mfma_f32_16x16x32_bf16 v[108:111], a[228:231], v[236:239], v[108:111]
    ds_read_b128 a[4:7], v6 offset:13504
    s_add_u32 s44, s40, 0
    v_mfma_f32_16x16x32_bf16 v[108:111], a[240:243], v[228:231], v[108:111]
    s_waitcnt lgkmcnt(2)
    v_fmac_f32 v227, s29, v219
    v_fmac_f32 v252, s23, v250
    v_mfma_f32_16x16x32_bf16 v[108:111], a[252:255], v[232:235], v[108:111]
    v_fmac_f32 v227, s23, v223
    v_cvt_pk_bf16_f32 v227, v252, v227
    v_mfma_f32_16x16x32_bf16 v[112:115], v[240:243], v[232:235], v[112:115]
    buffer_load_dwordx4 a[212:215], v254, s[8:11], s42 offen offset:2048 sc1
    v_mfma_f32_16x16x32_bf16 v[112:115], a[244:247], v[228:231], v[112:115]
    s_mov_b32 s42, 1185792
    v_fma_f32 v252, v249, s24, v251
    v_fmac_f32 v251, -4.0, v249
    v_mfma_f32_16x16x32_bf16 v[112:115], a[232:235], v[236:239], v[112:115]
    s_waitcnt lgkmcnt(1)
    v_fma_f32 v249, v248, s24, v250
    v_mfma_f32_16x16x32_bf16 v[116:119], a[236:239], v[236:239], v[116:119]
    ds_read_b128 v[236:239], v253 offset:37440
    v_fmac_f32 v250, -4.0, v248
    v_mfma_f32_16x16x32_bf16 v[116:119], a[248:251], v[228:231], v[116:119]
    buffer_load_dwordx4 a[216:219], v254, s[8:11], s42 offen offset:0 sc1
    v_mfma_f32_16x16x32_bf16 v[116:119], v[244:247], v[232:235], v[116:119]
    v_fma_f32 v248, v250, s26, v251
    v_fmac_f32 v251, s27, v250
    v_mfma_f32_16x16x32_bf16 v[120:123], a[228:231], v[228:231], v[120:123]
    v_fma_f32 v250, v249, 2.0, v252
    v_fmac_f32 v252, -2.0, v249
    v_mfma_f32_16x16x32_bf16 v[120:123], a[240:243], v[232:235], v[120:123]
    s_waitcnt lgkmcnt(0)
    v_fma_f32 v249, v221, s24, v225
    v_fmac_f32 v225, -4.0, v221
    v_mfma_f32_16x16x32_bf16 v[120:123], a[252:255], v[236:239], v[120:123]
    v_fma_f32 v221, v219, s24, v223
    v_fmac_f32 v223, -4.0, v219
    v_mfma_f32_16x16x32_bf16 v[124:127], v[240:243], v[236:239], v[124:127]
    buffer_load_dwordx4 a[220:223], v254, s[8:11], s42 offen offset:1024 sc1
    v_mfma_f32_16x16x32_bf16 v[124:127], a[244:247], v[232:235], v[124:127]
    ds_read_b128 a[8:11], v6 offset:14528
    v_fma_f32 v219, v223, s26, v225
    v_mfma_f32_16x16x32_bf16 v[124:127], a[232:235], v[228:231], v[124:127]
    v_fmac_f32 v225, s27, v223
    v_fma_f32 v223, v221, 2.0, v249
    v_mfma_f32_16x16x32_bf16 v[128:131], a[236:239], v[228:231], v[128:131]
    ds_read_b128 v[228:231], v253 offset:39264
    v_fmac_f32 v249, -2.0, v221
    v_mfma_f32_16x16x32_bf16 v[128:131], a[248:251], v[232:235], v[128:131]
    buffer_load_dwordx4 a[224:227], v254, s[8:11], s42 offen offset:2048 sc1
    v_mfma_f32_16x16x32_bf16 v[128:131], v[244:247], v[236:239], v[128:131]
    v_cvt_pk_bf16_f32 v219, v248, v219
    v_cvt_pk_bf16_f32 v225, v251, v225
    v_mfma_f32_16x16x32_bf16 v[132:135], a[228:231], v[232:235], v[132:135]
    buffer_store_dwordx4 a[0:3], v254, s[12:15], s44 offen nt
    v_and_b32 v215, 0x7fff, v255
    v_cvt_pk_bf16_f32 v223, v250, v223
    v_mfma_f32_16x16x32_bf16 v[132:135], a[240:243], v[236:239], v[132:135]
    s_waitcnt lgkmcnt(0)
    s_add_u32 s44, s40, 1024
    v_cvt_pk_bf16_f32 v221, v252, v249
    v_mfma_f32_16x16x32_bf16 v[132:135], a[252:255], v[228:231], v[132:135]
    buffer_load_dwordx2 v[204:205], v215, s[4:7], s16 offen offset:768
    v_mfma_f32_16x16x32_bf16 v[136:139], v[240:243], v[228:231], v[136:139]
    v_lshrrev_b32 v252, 15, v255
    v_mfma_f32_16x16x32_bf16 v[136:139], a[244:247], v[236:239], v[136:139]
    ds_write_b64 v252, v[218:219] offset:768
    v_mfma_f32_16x16x32_bf16 v[136:139], a[232:235], v[232:235], v[136:139]
    s_waitcnt vmcnt(13)
    v_lshrrev_b32 v218, 15, v255
    v_lshlrev_b32 v248, 16, v194
    v_mfma_f32_16x16x32_bf16 v[140:143], a[236:239], v[232:235], v[140:143]
    ds_read_b128 v[232:235], v253 offset:39008
    v_lshlrev_b32 v249, 16, v196
    v_mfma_f32_16x16x32_bf16 v[140:143], a[248:251], v[236:239], v[140:143]
    buffer_load_dwordx2 v[206:207], v215, s[4:7], s17 offen offset:768
    v_mfma_f32_16x16x32_bf16 v[140:143], v[244:247], v[228:231], v[140:143]
    v_lshlrev_b32 v250, 16, v198
    v_lshlrev_b32 v251, 16, v200
    v_mfma_f32_16x16x32_bf16 v[144:147], a[228:231], v[236:239], v[144:147]
    ds_read_b128 a[12:15], v6 offset:15584
    v_and_b32 v194, s22, v194
    v_mfma_f32_16x16x32_bf16 v[144:147], a[240:243], v[228:231], v[144:147]
    s_waitcnt lgkmcnt(1)
    v_and_b32 v196, s22, v196
    v_and_b32 v198, s22, v198
    v_mfma_f32_16x16x32_bf16 v[144:147], a[252:255], v[232:235], v[144:147]
    buffer_load_dwordx2 v[208:209], v215, s[4:7], s18 offen offset:768
    v_mfma_f32_16x16x32_bf16 v[148:151], v[240:243], v[232:235], v[148:151]
    ds_write_b64 v218, v[224:225] offset:2848
    v_mfma_f32_16x16x32_bf16 v[148:151], a[244:247], v[228:231], v[148:151]
    v_and_b32 v200, s22, v200
    v_lshlrev_b32 v252, 16, v192
    v_mfma_f32_16x16x32_bf16 v[148:151], a[232:235], v[236:239], v[148:151]
    ds_write_b64 v218, v[222:223] offset:4928
    v_mfma_f32_16x16x32_bf16 v[152:155], a[236:239], v[236:239], v[152:155]
    ds_read_b128 v[236:239], v253 offset:38752
    v_and_b32 v192, s22, v192
    v_mfma_f32_16x16x32_bf16 v[152:155], a[248:251], v[228:231], v[152:155]
    buffer_load_dwordx2 v[210:211], v215, s[4:7], s19 offen offset:768
    v_mfma_f32_16x16x32_bf16 v[152:155], v[244:247], v[232:235], v[152:155]
    ds_write_b64 v218, v[216:217] offset:34048
    v_mfma_f32_16x16x32_bf16 v[156:159], a[228:231], v[228:231], v[156:159]
    v_fmac_f32 v252, s25, v251
    v_fmac_f32 v192, s25, v200
    v_mfma_f32_16x16x32_bf16 v[156:159], a[240:243], v[232:235], v[156:159]
    s_waitcnt lgkmcnt(1)
    v_fmac_f32 v252, s28, v249
    v_fmac_f32 v192, s28, v196
    v_mfma_f32_16x16x32_bf16 v[156:159], a[252:255], v[236:239], v[156:159]
    buffer_load_dwordx2 v[212:213], v215, s[4:7], s20 offen offset:768
    v_mfma_f32_16x16x32_bf16 v[160:163], v[240:243], v[236:239], v[160:163]
    ds_write_b64 v218, v[226:227] offset:36128
    v_mfma_f32_16x16x32_bf16 v[160:163], a[244:247], v[232:235], v[160:163]
    v_cvt_pk_bf16_f32 v192, v252, v192
    v_lshlrev_b32 v252, 16, v202
    v_mfma_f32_16x16x32_bf16 v[160:163], a[232:235], v[228:231], v[160:163]
    ds_read_b128 a[16:19], v6 offset:16608
    v_and_b32 v202, s22, v202
    v_mfma_f32_16x16x32_bf16 v[164:167], a[236:239], v[228:231], v[164:167]
    ds_read_b128 v[228:231], v253 offset:38496
    v_fmac_f32 v252, s29, v248
    v_mfma_f32_16x16x32_bf16 v[164:167], a[248:251], v[232:235], v[164:167]
    buffer_load_dwordx2 v[214:215], v215, s[4:7], s21 offen offset:768
    v_mfma_f32_16x16x32_bf16 v[164:167], v[244:247], v[236:239], v[164:167]
    ds_write_b64 v218, v[220:221] offset:7008
    v_mfma_f32_16x16x32_bf16 v[168:171], a[228:231], v[232:235], v[168:171]
    buffer_store_dwordx4 a[4:7], v254, s[12:15], s44 offen nt
    s_add_u32 s44, s40, 2048
    v_fmac_f32 v202, s29, v194
    v_mfma_f32_16x16x32_bf16 v[168:171], a[240:243], v[236:239], v[168:171]
    s_waitcnt lgkmcnt(1)
    v_fmac_f32 v252, s23, v250
    v_fmac_f32 v202, s23, v198
    v_mfma_f32_16x16x32_bf16 v[168:171], a[252:255], v[228:231], v[168:171]
    v_cvt_pk_bf16_f32 v202, v252, v202
    v_fma_f32 v252, v249, s24, v251
    v_mfma_f32_16x16x32_bf16 v[172:175], v[240:243], v[228:231], v[172:175]
    v_fmac_f32 v251, -4.0, v249
    v_fma_f32 v249, v248, s24, v250
    v_mfma_f32_16x16x32_bf16 v[172:175], a[244:247], v[236:239], v[172:175]
    v_fmac_f32 v250, -4.0, v248
    v_fma_f32 v248, v250, s26, v251
    v_mfma_f32_16x16x32_bf16 v[172:175], a[232:235], v[232:235], v[172:175]
    v_fmac_f32 v251, s27, v250
    v_fma_f32 v250, v249, 2.0, v252
    v_mfma_f32_16x16x32_bf16 v[176:179], a[236:239], v[232:235], v[176:179]
    ds_read_b128 v[232:235], v253 offset:38224
    v_fmac_f32 v252, -2.0, v249
    v_mfma_f32_16x16x32_bf16 v[176:179], a[248:251], v[236:239], v[176:179]
    v_fma_f32 v249, v196, s24, v200
    v_fmac_f32 v200, -4.0, v196
    v_mfma_f32_16x16x32_bf16 v[176:179], v[244:247], v[228:231], v[176:179]
    s_mov_b32 s42, 1216512
    v_fma_f32 v196, v194, s24, v198
    v_fmac_f32 v198, -4.0, v194
    v_mfma_f32_16x16x32_bf16 v[180:183], a[228:231], v[236:239], v[180:183]
    v_fma_f32 v194, v198, s26, v200
    v_fmac_f32 v200, s27, v198
    v_mfma_f32_16x16x32_bf16 v[184:187], a[232:235], v[236:239], v[184:187]
    ds_read_b128 a[20:23], v6 offset:17632
    v_fma_f32 v198, v196, 2.0, v249
    v_mfma_f32_16x16x32_bf16 v[188:191], a[236:239], v[236:239], v[188:191]
    ds_read_b128 v[236:239], v253 offset:26000
    v_fmac_f32 v249, -2.0, v196
    v_mfma_f32_16x16x32_bf16 v[188:191], a[248:251], v[228:231], v[188:191]
    buffer_load_dwordx4 a[228:231], v254, s[8:11], s42 offen offset:0 sc1
    v_mfma_f32_16x16x32_bf16 v[184:187], a[244:247], v[228:231], v[184:187]
    s_waitcnt lgkmcnt(2)
    v_cvt_pk_bf16_f32 v194, v248, v194
    v_cvt_pk_bf16_f32 v200, v251, v200
    v_mfma_f32_16x16x32_bf16 v[180:183], a[240:243], v[228:231], v[180:183]
    ds_read_b128 v[228:231], v253 offset:25728
    v_cvt_pk_bf16_f32 v198, v250, v198
    v_mfma_f32_16x16x32_bf16 v[180:183], a[252:255], v[232:235], v[180:183]
    buffer_load_dwordx4 a[232:235], v254, s[8:11], s42 offen offset:1024 sc1
    v_mfma_f32_16x16x32_bf16 v[184:187], v[240:243], v[232:235], v[184:187]
    s_waitcnt vmcnt(17) lgkmcnt(1)
    v_cvt_pk_bf16_f32 v196, v252, v249
    v_lshlrev_b32 v248, 16, v195
    v_mfma_f32_16x16x32_bf16 v[188:191], v[244:247], v[232:235], v[188:191]
    ds_read_b128 v[232:235], v253 offset:25472
    v_lshlrev_b32 v249, 16, v197
sub32:
    v_mfma_f32_16x16x32_bf16 v[96:99], a[192:195], v[236:239], v[96:99]
    buffer_load_dwordx4 a[236:239], v254, s[8:11], s42 offen offset:2048 sc1
    v_mfma_f32_16x16x32_bf16 v[100:103], a[196:199], v[236:239], v[100:103]
    s_mov_b32 s42, 1219584
    v_lshlrev_b32 v250, 16, v199
    v_lshlrev_b32 v251, 16, v201
    v_mfma_f32_16x16x32_bf16 v[104:107], a[200:203], v[236:239], v[104:107]
pad12:
    s_cbranch_vccnz warm_ret
    ds_read_b128 v[236:239], v253 offset:25216
    s_waitcnt vmcnt(14)
    s_waitcnt lgkmcnt(2)
    v_mfma_f32_16x16x32_bf16 v[104:107], a[212:215], v[228:231], v[104:107]
    v_and_b32 v195, s22, v195
    v_and_b32 v197, s22, v197
    v_mfma_f32_16x16x32_bf16 v[100:103], a[208:211], v[228:231], v[100:103]
    buffer_load_dwordx4 a[240:243], v254, s[8:11], s42 offen offset:0 sc1
    v_mfma_f32_16x16x32_bf16 v[96:99], a[204:207], v[228:231], v[96:99]
    s_waitcnt vmcnt(12) lgkmcnt(1)
    v_and_b32 v199, s22, v199
    v_and_b32 v201, s22, v201
    v_mfma_f32_16x16x32_bf16 v[96:99], a[216:219], v[232:235], v[96:99]
    buffer_store_dwordx4 a[8:11], v254, s[12:15], s44 offen nt
    s_add_u32 s44, s40, 3072
    v_mfma_f32_16x16x32_bf16 v[100:103], a[220:223], v[232:235], v[100:103]
    ds_read_b128 a[24:27], v6 offset:18688
    v_lshlrev_b32 v252, 16, v193
    v_mfma_f32_16x16x32_bf16 v[104:107], a[224:227], v[232:235], v[104:107]
    buffer_load_dwordx4 a[244:247], v254, s[8:11], s42 offen offset:1024 sc1
    v_mfma_f32_16x16x32_bf16 v[108:111], a[192:195], v[228:231], v[108:111]
    v_and_b32 v193, s22, v193
    v_fmac_f32 v252, s25, v251
    v_mfma_f32_16x16x32_bf16 v[108:111], a[204:207], v[232:235], v[108:111]
    s_waitcnt lgkmcnt(1)
    v_fmac_f32 v193, s25, v201
    v_fmac_f32 v252, s28, v249
    v_mfma_f32_16x16x32_bf16 v[108:111], a[216:219], v[236:239], v[108:111]
    v_fmac_f32 v193, s28, v197
    v_cvt_pk_bf16_f32 v193, v252, v193
    v_mfma_f32_16x16x32_bf16 v[112:115], a[220:223], v[236:239], v[112:115]
    buffer_load_dwordx4 a[248:251], v254, s[8:11], s42 offen offset:2048 sc1
    v_mfma_f32_16x16x32_bf16 v[112:115], a[208:211], v[232:235], v[112:115]
    s_mov_b32 s42, 1222656
    v_lshlrev_b32 v252, 16, v203
    v_and_b32 v203, s22, v203
    v_mfma_f32_16x16x32_bf16 v[112:115], a[196:199], v[228:231], v[112:115]
    buffer_store_dwordx4 a[12:15], v254, s[12:15], s44 offen nt
    v_fmac_f32 v252, s29, v248
    v_fmac_f32 v203, s29, v195
    v_mfma_f32_16x16x32_bf16 v[116:119], a[200:203], v[228:231], v[116:119]
    ds_read_b128 v[228:231], v253 offset:24960
    v_fmac_f32 v252, s23, v250
    v_mfma_f32_16x16x32_bf16 v[116:119], a[212:215], v[232:235], v[116:119]
    buffer_load_dwordx4 a[252:255], v254, s[8:11], s42 offen offset:0 sc1
    v_mfma_f32_16x16x32_bf16 v[116:119], a[224:227], v[236:239], v[116:119]
    v_fmac_f32 v203, s23, v199
    v_cvt_pk_bf16_f32 v203, v252, v203
    v_mfma_f32_16x16x32_bf16 v[120:123], a[192:195], v[232:235], v[120:123]
    v_fma_f32 v252, v249, s24, v251
    v_fmac_f32 v251, -4.0, v249
    v_mfma_f32_16x16x32_bf16 v[120:123], a[204:207], v[236:239], v[120:123]
    s_waitcnt lgkmcnt(0)
    s_add_u32 s44, s40, 4096
    v_fma_f32 v249, v248, s24, v250
    v_mfma_f32_16x16x32_bf16 v[120:123], a[216:219], v[228:231], v[120:123]
    ds_read_b128 a[28:31], v6 offset:19712
    v_fmac_f32 v250, -4.0, v248
    v_mfma_f32_16x16x32_bf16 v[124:127], a[220:223], v[228:231], v[124:127]
    buffer_load_dwordx4 v[240:243], v254, s[8:11], s42 offen offset:1024 sc1
    v_mfma_f32_16x16x32_bf16 v[124:127], a[208:211], v[236:239], v[124:127]
    v_fma_f32 v248, v250, s26, v251
    v_fmac_f32 v251, s27, v250
    v_mfma_f32_16x16x32_bf16 v[124:127], a[196:199], v[232:235], v[124:127]
    v_fma_f32 v250, v249, 2.0, v252
    v_fmac_f32 v252, -2.0, v249
    v_mfma_f32_16x16x32_bf16 v[128:131], a[200:203], v[232:235], v[128:131]
    ds_read_b128 v[232:235], v253 offset:26784
    v_fma_f32 v249, v197, s24, v201
    v_mfma_f32_16x16x32_bf16 v[128:131], a[212:215], v[236:239], v[128:131]
    buffer_load_dwordx4 v[244:247], v254, s[8:11], s42 offen offset:2048 sc1
    v_mfma_f32_16x16x32_bf16 v[128:131], a[224:227], v[228:231], v[128:131]
    v_fmac_f32 v201, -4.0, v197
    v_fma_f32 v197, v195, s24, v199
    v_mfma_f32_16x16x32_bf16 v[132:135], a[192:195], v[236:239], v[132:135]
    v_and_b32 v227, 0x7fff, v255
    v_fmac_f32 v199, -4.0, v195
    v_mfma_f32_16x16x32_bf16 v[132:135], a[204:207], v[228:231], v[132:135]
    s_waitcnt lgkmcnt(0)
    v_fma_f32 v195, v199, s26, v201
    v_fmac_f32 v201, s27, v199
    v_mfma_f32_16x16x32_bf16 v[132:135], a[216:219], v[232:235], v[132:135]
    buffer_load_dwordx2 v[216:217], v227, s[4:7], s16 offen offset:1152
    v_mfma_f32_16x16x32_bf16 v[136:139], a[220:223], v[232:235], v[136:139]
    v_fma_f32 v199, v197, 2.0, v249
    v_fmac_f32 v249, -2.0, v197
    v_mfma_f32_16x16x32_bf16 v[136:139], a[208:211], v[228:231], v[136:139]
    v_cvt_pk_bf16_f32 v195, v248, v195
    v_cvt_pk_bf16_f32 v201, v251, v201
    v_mfma_f32_16x16x32_bf16 v[136:139], a[196:199], v[236:239], v[136:139]
    v_cvt_pk_bf16_f32 v199, v250, v199
    v_cvt_pk_bf16_f32 v197, v252, v249
    v_mfma_f32_16x16x32_bf16 v[140:143], a[200:203], v[236:239], v[140:143]
    ds_read_b128 v[236:239], v253 offset:26528
    v_lshrrev_b32 v252, 15, v255
    v_mfma_f32_16x16x32_bf16 v[140:143], a[212:215], v[228:231], v[140:143]
    buffer_load_dwordx2 v[218:219], v227, s[4:7], s17 offen offset:1152
    v_mfma_f32_16x16x32_bf16 v[140:143], a[224:227], v[232:235], v[140:143]
    ds_read_b128 a[32:35], v6 offset:20736
    v_mfma_f32_16x16x32_bf16 v[144:147], a[192:195], v[228:231], v[144:147]
    ds_write_b64 v252, v[194:195] offset:512
    v_mfma_f32_16x16x32_bf16 v[144:147], a[204:207], v[232:235], v[144:147]
    s_waitcnt lgkmcnt(2)
    v_lshrrev_b32 v194, 15, v255
    s_waitcnt vmcnt(14)
    v_mfma_f32_16x16x32_bf16 v[144:147], a[216:219], v[236:239], v[144:147]
    buffer_load_dwordx2 v[220:221], v227, s[4:7], s18 offen offset:1152
    v_mfma_f32_16x16x32_bf16 v[148:151], a[220:223], v[236:239], v[148:151]
    ds_write_b64 v194, v[200:201] offset:2592
    v_mfma_f32_16x16x32_bf16 v[148:151], a[208:211], v[232:235], v[148:151]
    v_lshlrev_b32 v248, 16, v206
    v_lshlrev_b32 v249, 16, v208
    v_mfma_f32_16x16x32_bf16 v[148:151], a[196:199], v[228:231], v[148:151]
    ds_write_b64 v194, v[198:199] offset:4672
    v_mfma_f32_16x16x32_bf16 v[152:155], a[200:203], v[228:231], v[152:155]
    ds_read_b128 v[228:231], v253 offset:26272
    v_lshlrev_b32 v250, 16, v210
    v_mfma_f32_16x16x32_bf16 v[152:155], a[212:215], v[232:235], v[152:155]
    buffer_load_dwordx2 v[222:223], v227, s[4:7], s19 offen offset:1152
    v_mfma_f32_16x16x32_bf16 v[152:155], a[224:227], v[236:239], v[152:155]
    ds_write_b64 v194, v[192:193] offset:33792
    v_mfma_f32_16x16x32_bf16 v[156:159], a[192:195], v[232:235], v[156:159]
    v_lshlrev_b32 v251, 16, v212
    v_and_b32 v206, s22, v206
    v_mfma_f32_16x16x32_bf16 v[156:159], a[204:207], v[236:239], v[156:159]
    s_waitcnt lgkmcnt(1)
    v_and_b32 v208, s22, v208
    v_and_b32 v210, s22, v210
    v_mfma_f32_16x16x32_bf16 v[156:159], a[216:219], v[228:231], v[156:159]
    buffer_load_dwordx2 v[224:225], v227, s[4:7], s20 offen offset:1152
    v_mfma_f32_16x16x32_bf16 v[160:163], a[220:223], v[228:231], v[160:163]
    ds_read_b128 a[36:39], v6 offset:21792
    v_and_b32 v212, s22, v212
    v_mfma_f32_16x16x32_bf16 v[160:163], a[208:211], v[236:239], v[160:163]
    ds_write_b64 v194, v[202:203] offset:35872
    v_mfma_f32_16x16x32_bf16 v[160:163], a[196:199], v[232:235], v[160:163]
    v_lshlrev_b32 v252, 16, v204
    v_and_b32 v204, s22, v204
    v_mfma_f32_16x16x32_bf16 v[164:167], a[200:203], v[232:235], v[164:167]
    ds_read_b128 v[232:235], v253 offset:26016
    v_fmac_f32 v252, s25, v251
    v_mfma_f32_16x16x32_bf16 v[164:167], a[212:215], v[236:239], v[164:167]
    buffer_load_dwordx2 v[226:227], v227, s[4:7], s21 offen offset:1152
    v_mfma_f32_16x16x32_bf16 v[164:167], a[224:227], v[228:231], v[164:167]
    ds_write_b64 v194, v[196:197] offset:6752
    v_mfma_f32_16x16x32_bf16 v[168:171], a[192:195], v[236:239], v[168:171]
    buffer_store_dwordx4 a[16:19], v254, s[12:15], s44 offen nt
    s_add_u32 s44, s40, 5120
    v_mfma_f32_16x16x32_bf16 v[168:171], a[204:207], v[228:231], v[168:171]
    s_waitcnt lgkmcnt(1)
    v_fmac_f32 v204, s25, v212
    v_fmac_f32 v252, s28, v249
    v_mfma_f32_16x16x32_bf16 v[168:171], a[216:219], v[232:235], v[168:171]
    ds_read_b128 v[192:195], v253 offset:39520
    s_mov_b32 s45, 573637648
    v_mfma_f32_16x16x32_bf16 v[172:175], a[220:223], v[232:235], v[172:175]
    buffer_store_dwordx4 a[20:23], v254, s[12:15], s44 offen nt
    v_bfe_u32 v196, v254, 5, 3
    v_mul_u32_u24 v197, 5, v196
    v_mfma_f32_16x16x32_bf16 v[172:175], a[208:211], v[228:231], v[172:175]
    v_bfe_u32 v197, s45, v197, 5
    v_mul_u32_u24 v197, 65, v197
    v_mfma_f32_16x16x32_bf16 v[172:175], a[196:199], v[236:239], v[172:175]
    v_sub_u32 v197, v197, v196
    v_lshl_add_u32 v196, v197, 5, v253
    v_mfma_f32_16x16x32_bf16 v[176:179], a[200:203], v[236:239], v[176:179]
    ds_read_b128 v[236:239], v253 offset:25744
    s_waitcnt lgkmcnt(1)
    v_mfma_f32_16x16x32_bf16 v[176:179], a[212:215], v[228:231], v[176:179]
    s_add_u32 s44, s40, 6144
    v_fmac_f32 v204, s28, v208
    v_mfma_f32_16x16x32_bf16 v[176:179], a[224:227], v[232:235], v[176:179]
    s_mov_b32 s42, 1253376
    v_cvt_pk_bf16_f32 v204, v252, v204
    v_lshlrev_b32 v252, 16, v214
    v_mfma_f32_16x16x32_bf16 v[180:183], a[192:195], v[228:231], v[180:183]
    ds_read_b128 a[40:43], v6 offset:22816
    v_and_b32 v214, s22, v214
    v_mfma_f32_16x16x32_bf16 v[184:187], a[196:199], v[228:231], v[184:187]
    s_mov_b64 exec, s[46:47]
    ds_write_b128 v196, v[192:195] offset:1024
    s_mov_b64 exec, -1
    v_mfma_f32_16x16x32_bf16 v[188:191], a[200:203], v[228:231], v[188:191]
    ds_read_b128 v[228:231], v253 offset:28080
    v_fmac_f32 v252, s29, v248
    v_mfma_f32_16x16x32_bf16 v[188:191], a[212:215], v[232:235], v[188:191]
    buffer_load_dwordx4 a[96:99], v254, s[8:11], s42 offen offset:0 sc1
    v_mfma_f32_16x16x32_bf16 v[184:187], a[208:211], v[232:235], v[184:187]
    s_waitcnt lgkmcnt(3)
    v_fmac_f32 v214, s29, v206
    v_fmac_f32 v252, s23, v250
    v_mfma_f32_16x16x32_bf16 v[180:183], a[204:207], v[232:235], v[180:183]
    ds_read_b128 v[232:235], v253 offset:27808
    v_mfma_f32_16x16x32_bf16 v[180:183], a[216:219], v[236:239], v[180:183]
    buffer_load_dwordx4 a[100:103], v254, s[8:11], s42 offen offset:1024 sc1
    v_mfma_f32_16x16x32_bf16 v[184:187], a[220:223], v[236:239], v[184:187]
    s_waitcnt vmcnt(18) lgkmcnt(1)
    v_fmac_f32 v214, s23, v210
    v_cvt_pk_bf16_f32 v214, v252, v214
    v_mfma_f32_16x16x32_bf16 v[188:191], a[224:227], v[236:239], v[188:191]
    ds_read_b128 v[236:239], v253 offset:27552
    v_fma_f32 v252, v249, s24, v251
sub33:
    v_mfma_f32_16x16x32_bf16 v[96:99], a[228:231], v[228:231], v[96:99]
    buffer_load_dwordx4 a[104:107], v254, s[8:11], s42 offen offset:2048 sc1
    v_mfma_f32_16x16x32_bf16 v[100:103], a[232:235], v[228:231], v[100:103]
    s_mov_b32 s42, 1256448
    v_fmac_f32 v251, -4.0, v249
    v_fma_f32 v249, v248, s24, v250
    v_mfma_f32_16x16x32_bf16 v[104:107], a[236:239], v[228:231], v[104:107]
    ds_read_b128 v[228:231], v253 offset:27296
    s_waitcnt vmcnt(15)
    s_waitcnt lgkmcnt(2)
    v_mfma_f32_16x16x32_bf16 v[104:107], a[248:251], v[232:235], v[104:107]
    v_fmac_f32 v250, -4.0, v248
    v_fma_f32 v248, v250, s26, v251
    v_mfma_f32_16x16x32_bf16 v[100:103], a[244:247], v[232:235], v[100:103]
    buffer_load_dwordx4 a[108:111], v254, s[8:11], s42 offen offset:0 sc1
    v_mfma_f32_16x16x32_bf16 v[96:99], a[240:243], v[232:235], v[96:99]
    s_waitcnt vmcnt(12) lgkmcnt(1)
    v_fmac_f32 v251, s27, v250
    v_fma_f32 v250, v249, 2.0, v252
    v_mfma_f32_16x16x32_bf16 v[96:99], a[252:255], v[236:239], v[96:99]
    buffer_store_dwordx4 a[24:27], v254, s[12:15], s44 offen nt
    v_fmac_f32 v252, -2.0, v249
    v_fma_f32 v249, v208, s24, v212
    v_mfma_f32_16x16x32_bf16 v[100:103], v[240:243], v[236:239], v[100:103]
    ds_read_b128 a[44:47], v6 offset:23840
    v_fmac_f32 v212, -4.0, v208
    v_mfma_f32_16x16x32_bf16 v[104:107], v[244:247], v[236:239], v[104:107]
    buffer_load_dwordx4 a[112:115], v254, s[8:11], s42 offen offset:1024 sc1
    v_mfma_f32_16x16x32_bf16 v[108:111], a[228:231], v[232:235], v[108:111]
    s_add_u32 s44, s40, 7168
    v_fma_f32 v208, v206, s24, v210
    v_fmac_f32 v210, -4.0, v206
    v_mfma_f32_16x16x32_bf16 v[108:111], a[240:243], v[236:239], v[108:111]
    s_waitcnt lgkmcnt(1)
    v_fma_f32 v206, v210, s26, v212
    v_fmac_f32 v212, s27, v210
    v_mfma_f32_16x16x32_bf16 v[108:111], a[252:255], v[228:231], v[108:111]
    v_fma_f32 v210, v208, 2.0, v249
    v_fmac_f32 v249, -2.0, v208
    v_mfma_f32_16x16x32_bf16 v[112:115], v[240:243], v[228:231], v[112:115]
    buffer_load_dwordx4 a[116:119], v254, s[8:11], s42 offen offset:2048 sc1
    v_mfma_f32_16x16x32_bf16 v[112:115], a[244:247], v[236:239], v[112:115]
    s_mov_b32 s42, 1259520
    v_cvt_pk_bf16_f32 v206, v248, v206
    v_cvt_pk_bf16_f32 v212, v251, v212
    v_mfma_f32_16x16x32_bf16 v[112:115], a[232:235], v[232:235], v[112:115]
    v_cvt_pk_bf16_f32 v210, v250, v210
    v_cvt_pk_bf16_f32 v208, v252, v249
    v_mfma_f32_16x16x32_bf16 v[116:119], a[236:239], v[232:235], v[116:119]
    ds_read_b128 v[232:235], v253 offset:27040
    v_lshlrev_b32 v248, 16, v207
    v_mfma_f32_16x16x32_bf16 v[116:119], a[248:251], v[236:239], v[116:119]
    buffer_load_dwordx4 a[120:123], v254, s[8:11], s42 offen offset:0 sc1
    v_mfma_f32_16x16x32_bf16 v[116:119], v[244:247], v[228:231], v[116:119]
    v_lshlrev_b32 v249, 16, v209
    v_lshlrev_b32 v250, 16, v211
    v_mfma_f32_16x16x32_bf16 v[120:123], a[228:231], v[236:239], v[120:123]
    v_lshlrev_b32 v251, 16, v213
    v_and_b32 v207, s22, v207
    v_mfma_f32_16x16x32_bf16 v[120:123], a[240:243], v[228:231], v[120:123]
    s_waitcnt lgkmcnt(0)
    v_and_b32 v209, s22, v209
    v_and_b32 v211, s22, v211
    v_mfma_f32_16x16x32_bf16 v[120:123], a[252:255], v[232:235], v[120:123]
    v_and_b32 v213, s22, v213
    v_lshlrev_b32 v252, 16, v205
    v_mfma_f32_16x16x32_bf16 v[124:127], v[240:243], v[232:235], v[124:127]
    buffer_load_dwordx4 a[124:127], v254, s[8:11], s42 offen offset:1024 sc1
    v_mfma_f32_16x16x32_bf16 v[124:127], a[244:247], v[228:231], v[124:127]
    v_and_b32 v205, s22, v205
    v_fmac_f32 v252, s25, v251
    v_mfma_f32_16x16x32_bf16 v[124:127], a[232:235], v[236:239], v[124:127]
    v_fmac_f32 v205, s25, v213
    v_fmac_f32 v252, s28, v249
    v_mfma_f32_16x16x32_bf16 v[128:131], a[236:239], v[236:239], v[128:131]
    ds_read_b128 v[236:239], v253 offset:28864
    v_fmac_f32 v205, s28, v209
    v_mfma_f32_16x16x32_bf16 v[128:131], a[248:251], v[228:231], v[128:131]
    buffer_load_dwordx4 a[128:131], v254, s[8:11], s42 offen offset:2048 sc1
    v_mfma_f32_16x16x32_bf16 v[128:131], v[244:247], v[232:235], v[128:131]
    s_mov_b32 s42, 1290240
    v_cvt_pk_bf16_f32 v205, v252, v205
    v_lshlrev_b32 v252, 16, v215
    v_mfma_f32_16x16x32_bf16 v[132:135], a[228:231], v[228:231], v[132:135]
    ds_read_b128 a[48:51], v253 offset:30160
    v_and_b32 v215, s22, v215
    v_mfma_f32_16x16x32_bf16 v[132:135], a[240:243], v[232:235], v[132:135]
    s_waitcnt lgkmcnt(1)
    v_fmac_f32 v252, s29, v248
    v_fmac_f32 v215, s29, v207
    v_mfma_f32_16x16x32_bf16 v[132:135], a[252:255], v[236:239], v[132:135]
    buffer_load_dwordx4 a[132:135], v254, s[8:11], s42 offen offset:0 sc1
    v_mfma_f32_16x16x32_bf16 v[136:139], v[240:243], v[236:239], v[136:139]
    v_fmac_f32 v252, s23, v250
    v_fmac_f32 v215, s23, v211
    v_mfma_f32_16x16x32_bf16 v[136:139], a[244:247], v[232:235], v[136:139]
    ds_read_b128 a[64:67], v253 offset:32240
    v_cvt_pk_bf16_f32 v215, v252, v215
    v_mfma_f32_16x16x32_bf16 v[136:139], a[232:235], v[228:231], v[136:139]
    buffer_load_dwordx4 a[136:139], v254, s[8:11], s42 offen offset:1024 sc1
    v_mfma_f32_16x16x32_bf16 v[140:143], a[236:239], v[228:231], v[140:143]
    ds_read_b128 v[228:231], v253 offset:28608
    v_fma_f32 v252, v249, s24, v251
    v_mfma_f32_16x16x32_bf16 v[140:143], a[248:251], v[232:235], v[140:143]
    v_fmac_f32 v251, -4.0, v249
    v_fma_f32 v249, v248, s24, v250
    v_mfma_f32_16x16x32_bf16 v[140:143], v[244:247], v[236:239], v[140:143]
    ds_read_b128 a[52:55], v253 offset:29888
    v_fmac_f32 v250, -4.0, v248
    v_mfma_f32_16x16x32_bf16 v[144:147], a[228:231], v[232:235], v[144:147]
    buffer_load_dwordx4 a[140:143], v254, s[8:11], s42 offen offset:2048 sc1
    v_mfma_f32_16x16x32_bf16 v[144:147], a[240:243], v[236:239], v[144:147]
    s_mov_b32 s42, 1293312
    s_waitcnt lgkmcnt(1)
    v_fma_f32 v248, v250, s26, v251
    v_mfma_f32_16x16x32_bf16 v[144:147], a[252:255], v[228:231], v[144:147]
    v_fmac_f32 v251, s27, v250
    v_fma_f32 v250, v249, 2.0, v252
    v_mfma_f32_16x16x32_bf16 v[148:151], v[240:243], v[228:231], v[148:151]
    ds_read_b128 a[68:71], v253 offset:31968
    v_fmac_f32 v252, -2.0, v249
    v_mfma_f32_16x16x32_bf16 v[148:151], a[244:247], v[236:239], v[148:151]
    buffer_load_dwordx4 a[144:147], v254, s[8:11], s42 offen offset:0 sc1
    v_mfma_f32_16x16x32_bf16 v[148:151], a[232:235], v[232:235], v[148:151]
    v_fma_f32 v249, v209, s24, v213
    v_fmac_f32 v213, -4.0, v209
    v_mfma_f32_16x16x32_bf16 v[152:155], a[236:239], v[232:235], v[152:155]
    ds_read_b128 v[232:235], v253 offset:28352
    v_fma_f32 v209, v207, s24, v211
    v_mfma_f32_16x16x32_bf16 v[152:155], a[248:251], v[236:239], v[152:155]
    ds_read_b128 a[56:59], v253 offset:29632
    v_fmac_f32 v211, -4.0, v207
    v_mfma_f32_16x16x32_bf16 v[152:155], v[244:247], v[228:231], v[152:155]
    buffer_load_dwordx4 a[148:151], v254, s[8:11], s42 offen offset:1024 sc1
    v_mfma_f32_16x16x32_bf16 v[156:159], a[228:231], v[236:239], v[156:159]
    v_fma_f32 v207, v211, s26, v213
    v_fmac_f32 v213, s27, v211
    v_mfma_f32_16x16x32_bf16 v[156:159], a[240:243], v[228:231], v[156:159]
    s_waitcnt lgkmcnt(1)
    v_fma_f32 v211, v209, 2.0, v249
    v_fmac_f32 v249, -2.0, v209
    v_mfma_f32_16x16x32_bf16 v[156:159], a[252:255], v[232:235], v[156:159]
    ds_read_b128 a[72:75], v253 offset:31712
    v_cvt_pk_bf16_f32 v207, v248, v207
    v_mfma_f32_16x16x32_bf16 v[160:163], v[240:243], v[232:235], v[160:163]
    buffer_load_dwordx4 a[152:155], v254, s[8:11], s42 offen offset:2048 sc1
    v_mfma_f32_16x16x32_bf16 v[160:163], a[244:247], v[228:231], v[160:163]
    s_mov_b32 s42, 1296384
    v_cvt_pk_bf16_f32 v213, v251, v213
    v_cvt_pk_bf16_f32 v211, v250, v211
    v_mfma_f32_16x16x32_bf16 v[160:163], a[232:235], v[236:239], v[160:163]
    v_cvt_pk_bf16_f32 v209, v252, v249
    v_lshrrev_b32 v252, 15, v255
    v_mfma_f32_16x16x32_bf16 v[164:167], a[236:239], v[236:239], v[164:167]
    ds_read_b128 v[236:239], v253 offset:28096
    v_mfma_f32_16x16x32_bf16 v[164:167], a[248:251], v[228:231], v[164:167]
    buffer_load_dwordx4 a[156:159], v254, s[8:11], s42 offen offset:0 sc1
    v_mfma_f32_16x16x32_bf16 v[164:167], v[244:247], v[232:235], v[164:167]
    ds_read_b128 a[60:63], v253 offset:29376
    v_mfma_f32_16x16x32_bf16 v[168:171], a[228:231], v[228:231], v[168:171]
    buffer_store_dwordx4 a[28:31], v254, s[12:15], s44 offen nt
    s_add_u32 s44, s40, 8192
    v_mfma_f32_16x16x32_bf16 v[168:171], a[240:243], v[232:235], v[168:171]
    buffer_load_dwordx4 a[160:163], v254, s[8:11], s42 offen offset:1024 sc1
    s_waitcnt lgkmcnt(1)
    v_mfma_f32_16x16x32_bf16 v[168:171], a[252:255], v[236:239], v[168:171]
    ds_write_b64 v252, v[206:207] offset:256
    v_mfma_f32_16x16x32_bf16 v[172:175], v[240:243], v[236:239], v[172:175]
    ds_read_b128 a[76:79], v253 offset:31456
    v_lshrrev_b32 v206, 15, v255
    v_mfma_f32_16x16x32_bf16 v[172:175], a[244:247], v[232:235], v[172:175]
    ds_write_b64 v206, v[212:213] offset:2336
    s_waitcnt vmcnt(21)
    v_mfma_f32_16x16x32_bf16 v[172:175], a[232:235], v[228:231], v[172:175]
    buffer_load_dwordx4 a[164:167], v254, s[8:11], s42 offen offset:2048 sc1
    v_mfma_f32_16x16x32_bf16 v[176:179], a[236:239], v[228:231], v[176:179]
    ds_read_b128 v[228:231], v253 offset:27824
    v_lshlrev_b32 v248, 16, v218
    v_mfma_f32_16x16x32_bf16 v[176:179], a[248:251], v[232:235], v[176:179]
    buffer_store_dwordx4 a[32:35], v254, s[12:15], s44 offen nt
    s_add_u32 s44, s40, 9216
    v_mfma_f32_16x16x32_bf16 v[176:179], v[244:247], v[236:239], v[176:179]
    s_add_u32 s42, s36, 0
    v_lshlrev_b32 v249, 16, v220
    v_lshlrev_b32 v250, 16, v222
    v_mfma_f32_16x16x32_bf16 v[180:183], a[228:231], v[232:235], v[180:183]
    s_waitcnt lgkmcnt(0)
    v_lshlrev_b32 v251, 16, v224
    v_and_b32 v218, s22, v218
    v_and_b32 v220, s22, v220
    v_mfma_f32_16x16x32_bf16 v[184:187], a[232:235], v[232:235], v[184:187]
    s_barrier
    v_mfma_f32_16x16x32_bf16 v[188:191], a[236:239], v[232:235], v[188:191]
    ds_write_b64 v206, v[210:211] offset:4416
    v_mfma_f32_16x16x32_bf16 v[188:191], a[248:251], v[236:239], v[188:191]
    buffer_load_dwordx4 a[192:195], v254, s[8:11], s42 offen offset:0 sc1
    v_mfma_f32_16x16x32_bf16 v[184:187], a[244:247], v[236:239], v[184:187]
    ds_write_b64 v206, v[204:205] offset:33536
    v_mfma_f32_16x16x32_bf16 v[180:183], a[240:243], v[236:239], v[180:183]
    v_and_b32 v222, s22, v222
    v_and_b32 v224, s22, v224
    v_lshlrev_b32 v252, 16, v216
    v_mfma_f32_16x16x32_bf16 v[180:183], a[252:255], v[228:231], v[180:183]
    buffer_load_dwordx4 a[196:199], v254, s[8:11], s42 offen offset:1024 sc1
    v_mfma_f32_16x16x32_bf16 v[184:187], v[240:243], v[228:231], v[184:187]
    ds_write_b64 v206, v[214:215] offset:35616
    v_mfma_f32_16x16x32_bf16 v[188:191], v[244:247], v[228:231], v[188:191]
    s_waitcnt vmcnt(13)
    v_and_b32 v216, s22, v216
    v_fmac_f32 v252, s25, v251
sub34:
    v_mfma_f32_16x16x32_bf16 v[96:99], a[96:99], a[48:51], v[96:99]
    buffer_load_dwordx4 a[200:203], v254, s[8:11], s42 offen offset:2048 sc1
    v_mfma_f32_16x16x32_bf16 v[96:99], a[108:111], a[52:55], v[96:99]
    s_add_u32 s42, s36, 3072
    v_fmac_f32 v216, s25, v224
    v_fmac_f32 v252, s28, v249
    v_fmac_f32 v216, s28, v220
    v_mfma_f32_16x16x32_bf16 v[96:99], a[120:123], a[56:59], v[96:99]
    ds_write_b64 v206, v[208:209] offset:6496
    v_mfma_f32_16x16x32_bf16 v[100:103], a[124:127], a[56:59], v[100:103]
    v_cvt_pk_bf16_f32 v216, v252, v216
    v_lshlrev_b32 v252, 16, v226
    v_mfma_f32_16x16x32_bf16 v[100:103], a[112:115], a[52:55], v[100:103]
    buffer_load_dwordx4 a[204:207], v254, s[8:11], s42 offen offset:0 sc1
    v_mfma_f32_16x16x32_bf16 v[100:103], a[100:103], a[48:51], v[100:103]
    v_and_b32 v226, s22, v226
    v_fmac_f32 v252, s29, v248
    v_mfma_f32_16x16x32_bf16 v[104:107], a[104:107], a[48:51], v[104:107]
    ds_read_b128 a[48:51], v253 offset:29120
    v_fmac_f32 v226, s29, v218
    v_fmac_f32 v252, s23, v250
    v_mfma_f32_16x16x32_bf16 v[104:107], a[116:119], a[52:55], v[104:107]
    v_fmac_f32 v226, s23, v222
    v_cvt_pk_bf16_f32 v226, v252, v226
    v_mfma_f32_16x16x32_bf16 v[104:107], a[128:131], a[56:59], v[104:107]
    buffer_load_dwordx4 a[208:211], v254, s[8:11], s42 offen offset:1024 sc1
    v_mfma_f32_16x16x32_bf16 v[108:111], a[96:99], a[52:55], v[108:111]
    v_fma_f32 v252, v249, s24, v251
    v_fmac_f32 v251, -4.0, v249
    v_mfma_f32_16x16x32_bf16 v[108:111], a[108:111], a[56:59], v[108:111]
    v_fma_f32 v249, v248, s24, v250
    v_fmac_f32 v250, -4.0, v248
    v_mfma_f32_16x16x32_bf16 v[108:111], a[120:123], a[60:63], v[108:111]
    v_fma_f32 v248, v250, s26, v251
    v_fmac_f32 v251, s27, v250
    v_fma_f32 v250, v249, 2.0, v252
    v_mfma_f32_16x16x32_bf16 v[112:115], a[124:127], a[60:63], v[112:115]
    buffer_load_dwordx4 a[212:215], v254, s[8:11], s42 offen offset:2048 sc1
    v_mfma_f32_16x16x32_bf16 v[112:115], a[112:115], a[56:59], v[112:115]
    s_add_u32 s42, s36, 6144
    v_fmac_f32 v252, -2.0, v249
    v_fma_f32 v249, v220, s24, v224
    v_mfma_f32_16x16x32_bf16 v[112:115], a[100:103], a[52:55], v[112:115]
    buffer_store_dwordx4 a[36:39], v254, s[12:15], s44 offen nt
    s_add_u32 s44, s40, 10240
    v_mfma_f32_16x16x32_bf16 v[116:119], a[104:107], a[52:55], v[116:119]
    ds_read_b128 a[52:55], v253 offset:30944
    v_fmac_f32 v224, -4.0, v220
    v_mfma_f32_16x16x32_bf16 v[116:119], a[116:119], a[56:59], v[116:119]
    buffer_load_dwordx4 a[216:219], v254, s[8:11], s42 offen offset:0 sc1
    v_fma_f32 v220, v218, s24, v222
    v_mfma_f32_16x16x32_bf16 v[116:119], a[128:131], a[60:63], v[116:119]
    s_waitcnt vmcnt(16)
    v_fmac_f32 v222, -4.0, v218
    v_fma_f32 v218, v222, s26, v224
    v_mfma_f32_16x16x32_bf16 v[96:99], a[132:135], a[64:67], v[96:99]
    s_waitcnt vmcnt(13)
    v_fmac_f32 v224, s27, v222
    v_fma_f32 v222, v220, 2.0, v249
    v_mfma_f32_16x16x32_bf16 v[96:99], a[144:147], a[68:71], v[96:99]
    s_waitcnt vmcnt(9)
    v_fmac_f32 v249, -2.0, v220
    v_cvt_pk_bf16_f32 v218, v248, v218
    v_mfma_f32_16x16x32_bf16 v[96:99], a[156:159], a[72:75], v[96:99]
    v_cvt_pk_bf16_f32 v224, v251, v224
    v_cvt_pk_bf16_f32 v222, v250, v222
    v_mfma_f32_16x16x32_bf16 v[100:103], a[160:163], a[72:75], v[100:103]
    buffer_load_dwordx4 a[220:223], v254, s[8:11], s42 offen offset:1024 sc1
    v_cvt_pk_bf16_f32 v220, v252, v249
    v_mfma_f32_16x16x32_bf16 v[100:103], a[148:151], a[68:71], v[100:103]
    v_lshlrev_b32 v248, 16, v219
    v_lshlrev_b32 v249, 16, v221
    v_mfma_f32_16x16x32_bf16 v[100:103], a[136:139], a[64:67], v[100:103]
    v_lshlrev_b32 v250, 16, v223
    v_lshlrev_b32 v251, 16, v225
    v_mfma_f32_16x16x32_bf16 v[104:107], a[140:143], a[64:67], v[104:107]
    ds_read_b128 a[64:67], v253 offset:31200
    v_and_b32 v219, s22, v219
    v_mfma_f32_16x16x32_bf16 v[104:107], a[152:155], a[68:71], v[104:107]
    buffer_load_dwordx4 a[224:227], v254, s[8:11], s42 offen offset:2048 sc1
    v_mfma_f32_16x16x32_bf16 v[104:107], a[164:167], a[72:75], v[104:107]
    v_and_b32 v221, s22, v221
    v_and_b32 v223, s22, v223
    v_and_b32 v225, s22, v225
    v_mfma_f32_16x16x32_bf16 v[108:111], a[132:135], a[68:71], v[108:111]
    buffer_store_dwordx4 a[40:43], v254, s[12:15], s44 offen nt
    v_and_b32 v203, 0x7fff, v255
    s_add_u32 s44, s40, 11264
    v_mfma_f32_16x16x32_bf16 v[108:111], a[144:147], a[72:75], v[108:111]
    v_lshlrev_b32 v252, 16, v217
    v_mfma_f32_16x16x32_bf16 v[108:111], a[156:159], a[76:79], v[108:111]
    buffer_load_dwordx2 v[192:193], v203, s[4:7], s16 offen offset:64
    v_mfma_f32_16x16x32_bf16 v[112:115], a[160:163], a[76:79], v[112:115]
    v_and_b32 v217, s22, v217
    v_fmac_f32 v252, s25, v251
    v_mfma_f32_16x16x32_bf16 v[112:115], a[148:151], a[72:75], v[112:115]
    v_cvt_pk_bf16_f32 v96, v96, v97
    v_cvt_pk_bf16_f32 v97, v98, v99
    v_fmac_f32 v217, s25, v225
    v_mfma_f32_16x16x32_bf16 v[112:115], a[136:139], a[68:71], v[112:115]
    v_cvt_pk_bf16_f32 v98, v100, v101
    v_cvt_pk_bf16_f32 v99, v102, v103
    v_mfma_f32_16x16x32_bf16 v[116:119], a[140:143], a[68:71], v[116:119]
    ds_read_b128 a[68:71], v253 offset:33024
    v_fmac_f32 v252, s28, v249
    v_mfma_f32_16x16x32_bf16 v[116:119], a[152:155], a[72:75], v[116:119]
    buffer_load_dwordx2 v[194:195], v203, s[4:7], s17 offen offset:64
    v_mfma_f32_16x16x32_bf16 v[116:119], a[164:167], a[76:79], v[116:119]
    ds_write_b128 v4, v[96:99] offset:16640
    v_mfma_f32_16x16x32_bf16 v[120:123], a[96:99], a[56:59], v[120:123]
    v_fmac_f32 v217, s28, v221
    v_cvt_pk_bf16_f32 v217, v252, v217
    v_lshlrev_b32 v252, 16, v227
    v_mfma_f32_16x16x32_bf16 v[120:123], a[108:111], a[60:63], v[120:123]
    s_waitcnt lgkmcnt(4)
    v_cvt_pk_bf16_f32 v104, v104, v105
    v_cvt_pk_bf16_f32 v105, v106, v107
    v_mfma_f32_16x16x32_bf16 v[120:123], a[120:123], a[48:51], v[120:123]
    buffer_load_dwordx2 v[196:197], v203, s[4:7], s18 offen offset:64
    v_mfma_f32_16x16x32_bf16 v[120:123], a[132:135], a[72:75], v[120:123]
    ds_write_b64 v5, v[104:105] offset:16704
    v_mfma_f32_16x16x32_bf16 v[120:123], a[144:147], a[76:79], v[120:123]
    s_waitcnt lgkmcnt(3)
    v_cvt_pk_bf16_f32 v108, v108, v109
    v_cvt_pk_bf16_f32 v109, v110, v111
    v_mfma_f32_16x16x32_bf16 v[120:123], a[156:159], a[64:67], v[120:123]
    v_cvt_pk_bf16_f32 v110, v112, v113
    v_cvt_pk_bf16_f32 v111, v114, v115
    v_and_b32 v227, s22, v227
    v_mfma_f32_16x16x32_bf16 v[124:127], a[160:163], a[64:67], v[124:127]
    buffer_load_dwordx2 v[198:199], v203, s[4:7], s19 offen offset:64
    v_mfma_f32_16x16x32_bf16 v[124:127], a[148:151], a[76:79], v[124:127]
    ds_write_b128 v4, v[108:111] offset:17024
    v_mfma_f32_16x16x32_bf16 v[124:127], a[136:139], a[72:75], v[124:127]
    v_fmac_f32 v252, s29, v248
    v_fmac_f32 v227, s29, v219
    v_mfma_f32_16x16x32_bf16 v[124:127], a[124:127], a[48:51], v[124:127]
    v_fmac_f32 v252, s23, v250
    v_fmac_f32 v227, s23, v223
    v_mfma_f32_16x16x32_bf16 v[124:127], a[112:115], a[60:63], v[124:127]
    buffer_load_dwordx2 v[200:201], v203, s[4:7], s20 offen offset:64
    v_cvt_pk_bf16_f32 v227, v252, v227
    v_mfma_f32_16x16x32_bf16 v[124:127], a[100:103], a[56:59], v[124:127]
    v_cvt_pk_bf16_f32 v116, v116, v117
    v_cvt_pk_bf16_f32 v117, v118, v119
    v_mfma_f32_16x16x32_bf16 v[128:131], a[104:107], a[56:59], v[128:131]
    ds_read_b128 a[56:59], v253 offset:30688
    v_fma_f32 v252, v249, s24, v251
    v_mfma_f32_16x16x32_bf16 v[128:131], a[116:119], a[60:63], v[128:131]
    ds_write_b64 v5, v[116:117] offset:17088
    v_mfma_f32_16x16x32_bf16 v[128:131], a[128:131], a[48:51], v[128:131]
    buffer_load_dwordx2 v[202:203], v203, s[4:7], s21 offen offset:64
    v_mfma_f32_16x16x32_bf16 v[128:131], a[140:143], a[72:75], v[128:131]
    ds_read_b128 a[72:75], v253 offset:32768
    v_fmac_f32 v251, -4.0, v249
    v_fma_f32 v249, v248, s24, v250
    v_mfma_f32_16x16x32_bf16 v[128:131], a[152:155], a[76:79], v[128:131]
    v_fmac_f32 v250, -4.0, v248
    v_fma_f32 v248, v250, s26, v251
    v_mfma_f32_16x16x32_bf16 v[128:131], a[164:167], a[64:67], v[128:131]
    v_fmac_f32 v251, s27, v250
    v_fma_f32 v250, v249, 2.0, v252
    v_mfma_f32_16x16x32_bf16 v[132:135], a[96:99], a[60:63], v[132:135]
    buffer_store_dwordx4 a[44:47], v254, s[12:15], s44 offen nt
    v_fmac_f32 v252, -2.0, v249
    v_fma_f32 v249, v221, s24, v225
    v_mfma_f32_16x16x32_bf16 v[132:135], a[108:111], a[48:51], v[132:135]
    v_cvt_pk_bf16_f32 v120, v120, v121
    v_cvt_pk_bf16_f32 v121, v122, v123
    v_mfma_f32_16x16x32_bf16 v[132:135], a[120:123], a[52:55], v[132:135]
    v_cvt_pk_bf16_f32 v122, v124, v125
    v_cvt_pk_bf16_f32 v123, v126, v127
    v_fmac_f32 v225, -4.0, v221
    v_mfma_f32_16x16x32_bf16 v[132:135], a[132:135], a[76:79], v[132:135]
    v_fma_f32 v221, v219, s24, v223
    v_fmac_f32 v223, -4.0, v219
    v_mfma_f32_16x16x32_bf16 v[132:135], a[144:147], a[64:67], v[132:135]
    s_waitcnt lgkmcnt(6)
    v_fma_f32 v219, v223, s26, v225
    v_fmac_f32 v225, s27, v223
    v_mfma_f32_16x16x32_bf16 v[132:135], a[156:159], a[68:71], v[132:135]
    ds_write_b128 v4, v[120:123] offset:17408
    v_mfma_f32_16x16x32_bf16 v[136:139], a[160:163], a[68:71], v[136:139]
    v_fma_f32 v223, v221, 2.0, v249
    v_fmac_f32 v249, -2.0, v221
    v_mfma_f32_16x16x32_bf16 v[136:139], a[148:151], a[64:67], v[136:139]
pad13:
    s_cbranch_vccnz warm_ret
    v_cvt_pk_bf16_f32 v128, v128, v129
    v_cvt_pk_bf16_f32 v129, v130, v131
    v_cvt_pk_bf16_f32 v219, v248, v219
    v_mfma_f32_16x16x32_bf16 v[136:139], a[136:139], a[76:79], v[136:139]
    s_add_u32 s42, s36, 36864
    v_cvt_pk_bf16_f32 v225, v251, v225
    v_cvt_pk_bf16_f32 v223, v250, v223
    v_mfma_f32_16x16x32_bf16 v[136:139], a[124:127], a[52:55], v[136:139]
    ds_write_b64 v5, v[128:129] offset:17472
    v_mfma_f32_16x16x32_bf16 v[136:139], a[112:115], a[48:51], v[136:139]
    v_cvt_pk_bf16_f32 v221, v252, v249
    v_lshrrev_b32 v252, 15, v255
    v_mfma_f32_16x16x32_bf16 v[136:139], a[100:103], a[60:63], v[136:139]
    ds_write_b64 v252, v[218:219] offset:0
    v_mfma_f32_16x16x32_bf16 v[140:143], a[104:107], a[60:63], v[140:143]
    buffer_load_dwordx4 a[228:231], v254, s[8:11], s42 offen offset:0 sc1
    v_mfma_f32_16x16x32_bf16 v[140:143], a[116:119], a[48:51], v[140:143]
    ds_read_b128 a[60:63], v253 offset:30432
    v_lshrrev_b32 v218, 15, v255
    v_mfma_f32_16x16x32_bf16 v[140:143], a[128:131], a[52:55], v[140:143]
    ds_write_b64 v218, v[224:225] offset:2080
    v_mfma_f32_16x16x32_bf16 v[140:143], a[140:143], a[76:79], v[140:143]
    buffer_load_dwordx4 a[232:235], v254, s[8:11], s42 offen offset:1024 sc1
    v_mfma_f32_16x16x32_bf16 v[140:143], a[152:155], a[64:67], v[140:143]
    ds_read_b128 a[76:79], v253 offset:32512
    v_mfma_f32_16x16x32_bf16 v[140:143], a[164:167], a[68:71], v[140:143]
    s_waitcnt lgkmcnt(6)
    s_add_u32 s44, s40, 589824
sub35:
    v_mfma_f32_16x16x32_bf16 v[144:147], a[96:99], a[48:51], v[144:147]
    buffer_load_dwordx4 a[236:239], v254, s[8:11], s42 offen offset:2048 sc1
    v_mfma_f32_16x16x32_bf16 v[144:147], a[108:111], a[52:55], v[144:147]
    s_add_u32 s42, s36, 39936
    v_mfma_f32_16x16x32_bf16 v[144:147], a[120:123], a[56:59], v[144:147]
    s_waitcnt lgkmcnt(0)
    v_mfma_f32_16x16x32_bf16 v[144:147], a[132:135], a[64:67], v[144:147]
    s_barrier
    v_mfma_f32_16x16x32_bf16 v[144:147], a[144:147], a[68:71], v[144:147]
    buffer_load_dwordx4 a[240:243], v254, s[8:11], s42 offen offset:0 sc1
    v_mfma_f32_16x16x32_bf16 v[144:147], a[156:159], a[72:75], v[144:147]
    v_cvt_pk_bf16_f32 v132, v132, v133
    v_cvt_pk_bf16_f32 v133, v134, v135
    v_mfma_f32_16x16x32_bf16 v[148:151], a[160:163], a[72:75], v[148:151]
    v_cvt_pk_bf16_f32 v134, v136, v137
    v_cvt_pk_bf16_f32 v135, v138, v139
    v_mfma_f32_16x16x32_bf16 v[148:151], a[148:151], a[68:71], v[148:151]
    ds_write_b128 v4, v[132:135] offset:17792
    v_mfma_f32_16x16x32_bf16 v[148:151], a[136:139], a[64:67], v[148:151]
    buffer_load_dwordx4 a[244:247], v254, s[8:11], s42 offen offset:1024 sc1
    v_mfma_f32_16x16x32_bf16 v[148:151], a[124:127], a[56:59], v[148:151]
    ds_read_b128 v[96:99], v6 offset:16640
    v_cvt_pk_bf16_f32 v140, v140, v141
    v_cvt_pk_bf16_f32 v141, v142, v143
    v_mfma_f32_16x16x32_bf16 v[148:151], a[112:115], a[52:55], v[148:151]
    ds_read_b128 v[100:103], v6 offset:19744
    v_mfma_f32_16x16x32_bf16 v[148:151], a[100:103], a[48:51], v[148:151]
    ds_write_b64 v5, v[140:141] offset:17856
    v_mfma_f32_16x16x32_bf16 v[152:155], a[104:107], a[48:51], v[152:155]
    buffer_load_dwordx4 a[248:251], v254, s[8:11], s42 offen offset:2048 sc1
    v_mfma_f32_16x16x32_bf16 v[152:155], a[116:119], a[52:55], v[152:155]
    s_add_u32 s42, s36, 43008
    v_mfma_f32_16x16x32_bf16 v[152:155], a[128:131], a[56:59], v[152:155]
    ds_read_b128 a[48:51], v253 offset:30176
    s_waitcnt lgkmcnt(3)
    v_mfma_f32_16x16x32_bf16 v[152:155], a[140:143], a[64:67], v[152:155]
    ds_read_b128 a[64:67], v253 offset:32256
    v_mfma_f32_16x16x32_bf16 v[152:155], a[152:155], a[68:71], v[152:155]
    buffer_load_dwordx4 a[252:255], v254, s[8:11], s42 offen offset:0 sc1
    v_mfma_f32_16x16x32_bf16 v[152:155], a[164:167], a[72:75], v[152:155]
    ds_read_b128 v[104:107], v6 offset:22848
    v_mfma_f32_16x16x32_bf16 v[156:159], a[96:99], a[52:55], v[156:159]
    buffer_store_dwordx4 v[96:99], v254, s[12:15], s44 offen nt
    s_add_u32 s44, s40, 592896
    s_waitcnt lgkmcnt(4)
    v_mfma_f32_16x16x32_bf16 v[156:159], a[108:111], a[56:59], v[156:159]
    v_cvt_pk_bf16_f32 v144, v144, v145
    v_cvt_pk_bf16_f32 v145, v146, v147
    v_mfma_f32_16x16x32_bf16 v[156:159], a[120:123], a[60:63], v[156:159]
    v_cvt_pk_bf16_f32 v146, v148, v149
    v_cvt_pk_bf16_f32 v147, v150, v151
    v_mfma_f32_16x16x32_bf16 v[156:159], a[132:135], a[68:71], v[156:159]
    buffer_load_dwordx4 v[240:243], v254, s[8:11], s42 offen offset:1024 sc1
    v_mfma_f32_16x16x32_bf16 v[156:159], a[144:147], a[72:75], v[156:159]
    v_mfma_f32_16x16x32_bf16 v[156:159], a[156:159], a[76:79], v[156:159]
    ds_write_b128 v4, v[144:147] offset:18176
    v_mfma_f32_16x16x32_bf16 v[160:163], a[160:163], a[76:79], v[160:163]
    ds_read_b128 v[108:111], v6 offset:25952
    v_mfma_f32_16x16x32_bf16 v[160:163], a[148:151], a[72:75], v[160:163]
    buffer_load_dwordx4 v[244:247], v254, s[8:11], s42 offen offset:2048 sc1
    v_mfma_f32_16x16x32_bf16 v[160:163], a[136:139], a[68:71], v[160:163]
    v_cvt_pk_bf16_f32 v152, v152, v153
    v_cvt_pk_bf16_f32 v153, v154, v155
    v_mfma_f32_16x16x32_bf16 v[160:163], a[124:127], a[60:63], v[160:163]
    buffer_store_dwordx4 v[100:103], v254, s[12:15], s44 offen nt
    v_and_b32 v215, 0x7fff, v255
    s_add_u32 s44, s40, 595968
    v_mfma_f32_16x16x32_bf16 v[160:163], a[112:115], a[56:59], v[160:163]
    buffer_load_dwordx2 v[204:205], v215, s[4:7], s16 offen offset:448
    v_mfma_f32_16x16x32_bf16 v[160:163], a[100:103], a[52:55], v[160:163]
    ds_write_b64 v5, v[152:153] offset:18240
    v_mfma_f32_16x16x32_bf16 v[164:167], a[104:107], a[52:55], v[164:167]
    ds_read_b128 a[52:55], v253 offset:29904
    s_waitcnt lgkmcnt(4)
    v_mfma_f32_16x16x32_bf16 v[164:167], a[116:119], a[56:59], v[164:167]
    ds_write_b64 v218, v[222:223] offset:4160
    v_mfma_f32_16x16x32_bf16 v[164:167], a[128:131], a[60:63], v[164:167]
    buffer_load_dwordx2 v[206:207], v215, s[4:7], s17 offen offset:448
    v_mfma_f32_16x16x32_bf16 v[164:167], a[140:143], a[68:71], v[164:167]
    ds_read_b128 a[68:71], v253 offset:31984
    v_mfma_f32_16x16x32_bf16 v[164:167], a[152:155], a[72:75], v[164:167]
    ds_write_b64 v218, v[216:217] offset:33280
    v_mfma_f32_16x16x32_bf16 v[164:167], a[164:167], a[76:79], v[164:167]
    v_mfma_f32_16x16x32_bf16 v[168:171], a[96:99], a[56:59], v[168:171]
    buffer_load_dwordx2 v[208:209], v215, s[4:7], s18 offen offset:448
    v_mfma_f32_16x16x32_bf16 v[168:171], a[108:111], a[60:63], v[168:171]
    v_cvt_pk_bf16_f32 v156, v156, v157
    v_cvt_pk_bf16_f32 v157, v158, v159
    v_mfma_f32_16x16x32_bf16 v[168:171], a[120:123], a[48:51], v[168:171]
    v_cvt_pk_bf16_f32 v158, v160, v161
    v_cvt_pk_bf16_f32 v159, v162, v163
    v_mfma_f32_16x16x32_bf16 v[168:171], a[132:135], a[72:75], v[168:171]
    ds_write_b128 v4, v[156:159] offset:18560
    v_mfma_f32_16x16x32_bf16 v[168:171], a[144:147], a[76:79], v[168:171]
    v_mfma_f32_16x16x32_bf16 v[168:171], a[156:159], a[64:67], v[168:171]
    buffer_load_dwordx2 v[210:211], v215, s[4:7], s19 offen offset:448
    v_mfma_f32_16x16x32_bf16 v[172:175], a[160:163], a[64:67], v[172:175]
    v_mfma_f32_16x16x32_bf16 v[172:175], a[148:151], a[76:79], v[172:175]
    v_cvt_pk_bf16_f32 v164, v164, v165
    v_cvt_pk_bf16_f32 v165, v166, v167
    v_mfma_f32_16x16x32_bf16 v[172:175], a[136:139], a[72:75], v[172:175]
    ds_write_b64 v5, v[164:165] offset:18624
    v_mfma_f32_16x16x32_bf16 v[172:175], a[124:127], a[48:51], v[172:175]
    buffer_load_dwordx2 v[212:213], v215, s[4:7], s20 offen offset:448
    v_mfma_f32_16x16x32_bf16 v[172:175], a[112:115], a[60:63], v[172:175]
    ds_write_b64 v218, v[226:227] offset:35360
    v_mfma_f32_16x16x32_bf16 v[172:175], a[100:103], a[56:59], v[172:175]
    v_mfma_f32_16x16x32_bf16 v[176:179], a[104:107], a[56:59], v[176:179]
    ds_write_b64 v218, v[220:221] offset:6240
    v_mfma_f32_16x16x32_bf16 v[176:179], a[116:119], a[60:63], v[176:179]
    buffer_load_dwordx2 v[214:215], v215, s[4:7], s21 offen offset:448
    v_mfma_f32_16x16x32_bf16 v[176:179], a[128:131], a[48:51], v[176:179]
    s_waitcnt lgkmcnt(0)
    v_mfma_f32_16x16x32_bf16 v[176:179], a[140:143], a[72:75], v[176:179]
    s_barrier
    v_mfma_f32_16x16x32_bf16 v[176:179], a[152:155], a[76:79], v[176:179]
    ds_read_b128 v[228:231], v253 offset:1040
    v_mfma_f32_16x16x32_bf16 v[176:179], a[164:167], a[64:67], v[176:179]
    ds_read_b128 v[232:235], v253 offset:768
    v_mfma_f32_16x16x32_bf16 v[180:183], a[96:99], a[60:63], v[180:183]
    ds_read_b128 v[236:239], v253 offset:512
    v_mfma_f32_16x16x32_bf16 v[180:183], a[108:111], a[48:51], v[180:183]
    v_cvt_pk_bf16_f32 v168, v168, v169
    v_cvt_pk_bf16_f32 v169, v170, v171
    v_mfma_f32_16x16x32_bf16 v[180:183], a[120:123], a[52:55], v[180:183]
    buffer_store_dwordx4 v[104:107], v254, s[12:15], s44 offen nt
    v_cvt_pk_bf16_f32 v170, v172, v173
    v_cvt_pk_bf16_f32 v171, v174, v175
    v_mfma_f32_16x16x32_bf16 v[180:183], a[132:135], a[76:79], v[180:183]
    ds_write_b128 v4, v[168:171] offset:18944
    v_mfma_f32_16x16x32_bf16 v[180:183], a[144:147], a[64:67], v[180:183]
    s_add_u32 s44, s40, 599040
    v_mfma_f32_16x16x32_bf16 v[180:183], a[156:159], a[68:71], v[180:183]
    ds_read_b128 v[112:115], v6 offset:17664
    v_mfma_f32_16x16x32_bf16 v[184:187], a[160:163], a[68:71], v[184:187]
    ds_read_b128 v[116:119], v6 offset:20768
    v_mfma_f32_16x16x32_bf16 v[184:187], a[148:151], a[64:67], v[184:187]
    buffer_store_dwordx4 v[108:111], v254, s[12:15], s44 offen nt
    v_cvt_pk_bf16_f32 v176, v176, v177
    v_cvt_pk_bf16_f32 v177, v178, v179
    v_mfma_f32_16x16x32_bf16 v[184:187], a[136:139], a[76:79], v[184:187]
    ds_write_b64 v5, v[176:177] offset:19008
    v_mfma_f32_16x16x32_bf16 v[184:187], a[124:127], a[52:55], v[184:187]
    ds_read_b128 v[120:123], v6 offset:23872
    s_add_u32 s44, s40, 590848
    v_mfma_f32_16x16x32_bf16 v[184:187], a[112:115], a[48:51], v[184:187]
    ds_read_b128 v[124:127], v6 offset:26976
    s_waitcnt lgkmcnt(4)
    v_mfma_f32_16x16x32_bf16 v[184:187], a[100:103], a[60:63], v[184:187]
    buffer_store_dwordx4 v[112:115], v254, s[12:15], s44 offen nt
    s_add_u32 s44, s40, 593920
    s_waitcnt lgkmcnt(3)
    v_mfma_f32_16x16x32_bf16 v[188:191], a[104:107], a[60:63], v[188:191]
    v_mfma_f32_16x16x32_bf16 v[188:191], a[116:119], a[48:51], v[188:191]
    buffer_store_dwordx4 v[116:119], v254, s[12:15], s44 offen nt
    s_add_u32 s44, s40, 596992
    v_mfma_f32_16x16x32_bf16 v[188:191], a[128:131], a[52:55], v[188:191]
    s_waitcnt lgkmcnt(1)
    v_mfma_f32_16x16x32_bf16 v[188:191], a[140:143], a[76:79], v[188:191]
    buffer_store_dwordx4 v[120:123], v254, s[12:15], s44 offen nt
    v_mfma_f32_16x16x32_bf16 v[188:191], a[152:155], a[64:67], v[188:191]
    v_mfma_f32_16x16x32_bf16 v[188:191], a[164:167], a[68:71], v[188:191]
    s_waitcnt vmcnt(37)
    s_add_u32 s41, s40, 589824
    s_add_u32 s40, s40, 6291456
    s_add_u32 s39, s39, 1
    s_cmp_lt_u32 s39, 2
    s_cbranch_scc1 blk_loop
    s_add_u32 s44, s41, 10240
    s_waitcnt lgkmcnt(0)
    buffer_store_dwordx4 v[124:127], v254, s[12:15], s44 offen nt
    v_cvt_pk_bf16_f32 v180, v180, v181
    v_cvt_pk_bf16_f32 v181, v182, v183
    v_cvt_pk_bf16_f32 v182, v184, v185
    v_cvt_pk_bf16_f32 v183, v186, v187
    ds_write_b128 v4, v[180:183] offset:19328
    v_cvt_pk_bf16_f32 v188, v188, v189
    v_cvt_pk_bf16_f32 v189, v190, v191
    ds_write_b64 v5, v[188:189] offset:19392
    s_waitcnt lgkmcnt(0)
    s_barrier
    ds_read_b128 v[32:35], v6 offset:18688
    ds_read_b128 v[36:39], v6 offset:21792
    ds_read_b128 v[40:43], v6 offset:24896
    ds_read_b128 v[44:47], v6 offset:28000
    s_add_u32 s44, s41, 2048
    s_waitcnt lgkmcnt(3)
    buffer_store_dwordx4 v[32:35], v254, s[12:15], s44 offen nt
    s_add_u32 s44, s41, 5120
    s_waitcnt lgkmcnt(2)
    buffer_store_dwordx4 v[36:39], v254, s[12:15], s44 offen nt
    s_add_u32 s44, s41, 8192
    s_waitcnt lgkmcnt(1)
    buffer_store_dwordx4 v[40:43], v254, s[12:15], s44 offen nt
    s_add_u32 s44, s41, 11264
    s_waitcnt lgkmcnt(0)
    buffer_store_dwordx4 v[44:47], v254, s[12:15], s44 offen nt
main_done:
    s_endpgm
code_end:
wt_loop:
    s_mul_i32 s73, s70, 43691
    s_lshr_b32 s73, s73, 17
    s_mul_i32 s74, s73, 3
    s_sub_u32 s74, s70, s74
    s_mul_i32 s75, s73, 43691
    s_lshr_b32 s75, s75, 17
    s_mul_i32 s76, s75, 3
    s_sub_u32 s76, s73, s76
    v_and_b32 v101, 14, v2
    v_lshrrev_b32 v102, 4, v2
    v_and_b32 v103, 12, v101
    v_and_b32 v105, 1, v2
    s_lshl_b32 s78, s74, 2
    s_cmp_lt_u32 s74, 2
    s_cselect_b32 s77, 1, 0
    s_cselect_b32 s78, s78, 32
    v_mul_u32_u24 v103, s77, v103
    v_add_u32 v103, v103, v101
    v_add_u32 v103, s78, v103
    v_lshl_add_u32 v103, v103, 1, s52
    v_lshl_add_u32 v102, v102, 1, v105
    v_mul_u32_u24 v104, 1536, v102
    v_add_u32 v103, v103, v104
    s_mul_i32 s79, s76, 73728
    s_mul_i32 s80, s75, 12288
    s_add_u32 s79, s79, s80
    s_add_u32 s80, s79, 221184
    s_add_u32 s81, s79, 442368
    buffer_load_dword v136, v103, s[60:63], s79 offen offset:0
    buffer_load_dword v137, v103, s[60:63], s79 offen offset:384
    buffer_load_dword v138, v103, s[60:63], s79 offen offset:768
    buffer_load_dword v139, v103, s[60:63], s79 offen offset:1152
    buffer_load_dword v140, v103, s[60:63], s80 offen offset:0
    buffer_load_dword v141, v103, s[60:63], s80 offen offset:384
    buffer_load_dword v142, v103, s[60:63], s80 offen offset:768
    buffer_load_dword v143, v103, s[60:63], s80 offen offset:1152
    buffer_load_dword v144, v103, s[60:63], s81 offen offset:0
    buffer_load_dword v145, v103, s[60:63], s81 offen offset:384
    buffer_load_dword v146, v103, s[60:63], s81 offen offset:768
    buffer_load_dword v147, v103, s[60:63], s81 offen offset:1152
    v_mul_u32_u24 v106, 0x0202, v105
    v_sub_u32 v106, 0x0504, v106
    v_mul_u32_u24 v107, 0x0606, v105
    v_add_u32 v107, 0x0100, v107
    v_mov_b32 v108, 0x0c0c
    v_lshl_or_b32 v106, v106, 16, v108
    v_lshl_or_b32 v107, v107, 16, v108
    s_mul_i32 s82, s76, 3072
    s_lshl_b32 s83, s74, 10
    s_add_u32 s82, s82, s83
    s_mul_i32 s83, s75, 36864
    s_lshl_b32 s84, s83, 2
    s_add_u32 s83, s83, s82
    s_add_u32 s84, s84, s82
    s_waitcnt vmcnt(0)
    v_mov_b32_dpp v152, v136 quad_perm:[1,0,3,2] row_mask:0xf bank_mask:0xf
    v_mov_b32_dpp v153, v137 quad_perm:[1,0,3,2] row_mask:0xf bank_mask:0xf
    v_mov_b32_dpp v154, v138 quad_perm:[1,0,3,2] row_mask:0xf bank_mask:0xf
    v_mov_b32_dpp v155, v139 quad_perm:[1,0,3,2] row_mask:0xf bank_mask:0xf
    v_mov_b32_dpp v156, v140 quad_perm:[1,0,3,2] row_mask:0xf bank_mask:0xf
    v_mov_b32_dpp v157, v141 quad_perm:[1,0,3,2] row_mask:0xf bank_mask:0xf
    v_mov_b32_dpp v158, v142 quad_perm:[1,0,3,2] row_mask:0xf bank_mask:0xf
    v_mov_b32_dpp v159, v143 quad_perm:[1,0,3,2] row_mask:0xf bank_mask:0xf
    v_mov_b32_dpp v160, v144 quad_perm:[1,0,3,2] row_mask:0xf bank_mask:0xf
    v_mov_b32_dpp v161, v145 quad_perm:[1,0,3,2] row_mask:0xf bank_mask:0xf
    v_mov_b32_dpp v162, v146 quad_perm:[1,0,3,2] row_mask:0xf bank_mask:0xf
    v_mov_b32_dpp v163, v147 quad_perm:[1,0,3,2] row_mask:0xf bank_mask:0xf
    v_perm_b32 v110, v136, v152, v106
    v_perm_b32 v114, v136, v152, v107
    v_perm_b32 v111, v137, v153, v106
    v_perm_b32 v115, v137, v153, v107
    v_perm_b32 v112, v138, v154, v106
    v_perm_b32 v116, v138, v154, v107
    v_perm_b32 v113, v139, v155, v106
    v_perm_b32 v117, v139, v155, v107
    v_perm_b32 v118, v140, v156, v106
    v_perm_b32 v122, v140, v156, v107
    v_perm_b32 v119, v141, v157, v106
    v_perm_b32 v123, v141, v157, v107
    v_perm_b32 v120, v142, v158, v106
    v_perm_b32 v124, v142, v158, v107
    v_perm_b32 v121, v143, v159, v106
    v_perm_b32 v125, v143, v159, v107
    v_perm_b32 v126, v144, v160, v106
    v_perm_b32 v130, v144, v160, v107
    v_perm_b32 v127, v145, v161, v106
    v_perm_b32 v131, v145, v161, v107
    v_perm_b32 v128, v146, v162, v106
    v_perm_b32 v132, v146, v162, v107
    v_perm_b32 v129, v147, v163, v106
    v_perm_b32 v133, v147, v163, v107
    v_mul_f32 v136, 0xbedba55c, v110
    v_fmac_f32 v136, 0xbe0afea5, v126
    v_fmamk_f32 v144, v118, 0xbe771a08, v136
    v_fmac_f32 v136, 0x3e771a08, v118
    v_mul_f32 v137, 0xbedba55c, v111
    v_fmac_f32 v137, 0xbe0afea5, v127
    v_fmamk_f32 v145, v119, 0xbe771a08, v137
    v_fmac_f32 v137, 0x3e771a08, v119
    v_mul_f32 v138, 0xbedba55c, v112
    v_fmac_f32 v138, 0xbe0afea5, v128
    v_fmamk_f32 v146, v120, 0xbe771a08, v138
    v_fmac_f32 v138, 0x3e771a08, v120
    v_mul_f32 v139, 0xbedba55c, v113
    v_fmac_f32 v139, 0xbe0afea5, v129
    v_fmamk_f32 v147, v121, 0xbe771a08, v139
    v_fmac_f32 v139, 0x3e771a08, v121
    v_mul_f32 v140, 0xbedba55c, v114
    v_fmac_f32 v140, 0xbe0afea5, v130
    v_fmamk_f32 v148, v122, 0xbe771a08, v140
    v_fmac_f32 v140, 0x3e771a08, v122
    v_mul_f32 v141, 0xbedba55c, v115
    v_fmac_f32 v141, 0xbe0afea5, v131
    v_fmamk_f32 v149, v123, 0xbe771a08, v141
    v_fmac_f32 v141, 0x3e771a08, v123
    v_mul_f32 v142, 0xbedba55c, v116
    v_fmac_f32 v142, 0xbe0afea5, v132
    v_fmamk_f32 v150, v124, 0xbe771a08, v142
    v_fmac_f32 v142, 0x3e771a08, v124
    v_mul_f32 v143, 0xbedba55c, v117
    v_fmac_f32 v143, 0xbe0afea5, v133
    v_fmamk_f32 v151, v125, 0xbe771a08, v143
    v_fmac_f32 v143, 0x3e771a08, v125
    v_cvt_pk_bf16_f32 v156, v144, v145
    v_cvt_pk_bf16_f32 v157, v146, v147
    v_cvt_pk_bf16_f32 v158, v148, v149
    v_cvt_pk_bf16_f32 v159, v150, v151
    s_add_u32 s85, s84, 0
    buffer_store_dwordx4 v[156:159], v254, s[8:11], s85 offen sc1
    v_cvt_pk_bf16_f32 v160, v136, v137
    v_cvt_pk_bf16_f32 v161, v138, v139
    v_cvt_pk_bf16_f32 v162, v140, v141
    v_cvt_pk_bf16_f32 v163, v142, v143
    s_add_u32 s85, s84, 36864
    buffer_store_dwordx4 v[160:163], v254, s[8:11], s85 offen sc1
    v_mul_f32 v136, 0x3e0afea5, v110
    v_fmac_f32 v136, 0x3f0afea5, v126
    v_fmamk_f32 v144, v118, 0x3e8afea5, v136
    v_fmac_f32 v136, 0xbe8afea5, v118
    v_mul_f32 v137, 0x3e0afea5, v111
    v_fmac_f32 v137, 0x3f0afea5, v127
    v_fmamk_f32 v145, v119, 0x3e8afea5, v137
    v_fmac_f32 v137, 0xbe8afea5, v119
    v_mul_f32 v138, 0x3e0afea5, v112
    v_fmac_f32 v138, 0x3f0afea5, v128
    v_fmamk_f32 v146, v120, 0x3e8afea5, v138
    v_fmac_f32 v138, 0xbe8afea5, v120
    v_mul_f32 v139, 0x3e0afea5, v113
    v_fmac_f32 v139, 0x3f0afea5, v129
    v_fmamk_f32 v147, v121, 0x3e8afea5, v139
    v_fmac_f32 v139, 0xbe8afea5, v121
    v_mul_f32 v140, 0x3e0afea5, v114
    v_fmac_f32 v140, 0x3f0afea5, v130
    v_fmamk_f32 v148, v122, 0x3e8afea5, v140
    v_fmac_f32 v140, 0xbe8afea5, v122
    v_mul_f32 v141, 0x3e0afea5, v115
    v_fmac_f32 v141, 0x3f0afea5, v131
    v_fmamk_f32 v149, v123, 0x3e8afea5, v141
    v_fmac_f32 v141, 0xbe8afea5, v123
    v_mul_f32 v142, 0x3e0afea5, v116
    v_fmac_f32 v142, 0x3f0afea5, v132
    v_fmamk_f32 v150, v124, 0x3e8afea5, v142
    v_fmac_f32 v142, 0xbe8afea5, v124
    v_mul_f32 v143, 0x3e0afea5, v117
    v_fmac_f32 v143, 0x3f0afea5, v133
    v_fmamk_f32 v151, v125, 0x3e8afea5, v143
    v_fmac_f32 v143, 0xbe8afea5, v125
    v_cvt_pk_bf16_f32 v164, v144, v145
    v_cvt_pk_bf16_f32 v165, v146, v147
    v_cvt_pk_bf16_f32 v166, v148, v149
    v_cvt_pk_bf16_f32 v167, v150, v151
    s_add_u32 s85, s84, 73728
    buffer_store_dwordx4 v[164:167], v254, s[8:11], s85 offen sc1
    v_cvt_pk_bf16_f32 v168, v136, v137
    v_cvt_pk_bf16_f32 v169, v138, v139
    v_cvt_pk_bf16_f32 v170, v140, v141
    v_cvt_pk_bf16_f32 v171, v142, v143
    s_add_u32 s85, s84, 110592
    buffer_store_dwordx4 v[168:171], v254, s[8:11], s85 offen sc1
    v_cvt_pk_bf16_f32 v152, v110, v111
    v_cvt_pk_bf16_f32 v153, v112, v113
    v_cvt_pk_bf16_f32 v154, v114, v115
    v_cvt_pk_bf16_f32 v155, v116, v117
    s_add_u32 s85, s83, 884736
    buffer_store_dwordx4 v[152:155], v254, s[8:11], s85 offen sc1
    v_cvt_pk_bf16_f32 v172, v126, v127
    v_cvt_pk_bf16_f32 v173, v128, v129
    v_cvt_pk_bf16_f32 v174, v130, v131
    v_cvt_pk_bf16_f32 v175, v132, v133
    s_add_u32 s85, s83, 1105920
    buffer_store_dwordx4 v[172:175], v254, s[8:11], s85 offen sc1
    s_add_u32 s70, s70, 1
    s_cmp_lt_u32 s70, 54
    s_cbranch_scc1 wt_loop
    s_waitcnt vmcnt(0)
    s_branch u_ready
.section .rodata,"a"
.p2align 6
.amdhsa_kernel standalone__winograd__vision_kernel
  .amdhsa_next_free_vgpr 512
  .amdhsa_next_free_sgpr 102
  .amdhsa_accum_offset 256
  .amdhsa_group_segment_fixed_size 0
  .amdhsa_kernarg_size 40
  .amdhsa_user_sgpr_count 2
  .amdhsa_user_sgpr_kernarg_segment_ptr 1
  .amdhsa_system_sgpr_workgroup_id_x 1
  .amdhsa_ieee_mode 0
.end_amdhsa_kernel
```

```asm
; @launch grid=(256,1,1) block=(256,1,1) lds=163840
.amdgcn_target "amdgcn-amd-amdhsa--gfx950"
.text
.globl standalone__winograd__vision_kernel
.p2align 8
.type standalone__winograd__vision_kernel,@function
standalone__winograd__vision_kernel:
    s_cmp_ge_u32 s2, 256
    s_cbranch_scc1 main_done
    s_load_dwordx2 s[60:61], s[0:1], 8
    s_load_dwordx2 s[4:5], s[0:1], 0
    s_load_dwordx4 s[12:15], s[0:1], 16
    s_load_dwordx2 s[8:9], s[0:1], 32
    s_getpc_b64 s[92:93]
pcref:
    v_and_b32 v70, 3, v0
    v_lshrrev_b32 v71, 6, v0
    v_lshl_add_u32 v70, v70, 7, v71
    s_lshr_b32 s94, s2, 3
    s_lshl_b32 s94, s94, 2
    v_add_lshl_u32 v70, v70, s94, 7
    v_min_u32 v70, code_end-pcref-4, v70
    v_add_co_u32 v72, vcc, s92, v70
    v_mov_b32 v73, s93
    s_nop 0
    v_addc_co_u32 v73, vcc, 0, v73, vcc
    global_load_dword v76, v[72:73], off
    v_lshrrev_b32 v1, 6, v0
    v_and_b32 v2, 63, v0
    v_readfirstlane_b32 s38, v1
    s_mov_b32 s62, 663552
    s_mov_b32 s63, 0x20000
    s_mov_b32 s70, s2
    s_mul_i32 s52, s38, 96
    s_cmp_lt_u32 s2, 54
    s_cbranch_scc1 wl_far
wl_skip:
    v_lshlrev_b32 v254, 4, v2
    v_mov_b32 v98, 0
    v_lshrrev_b32 v3, 3, v2
    v_and_b32 v4, 7, v2
    v_mul_u32_u24 v5, 3072, v3
    v_lshl_add_u32 v255, v4, 3, v5
    s_lshr_b32 s44, s2, 3
    s_and_b32 s48, s44, 3
    s_lshr_b32 s44, s44, 2
    s_and_b32 s49, s2, 7
    s_lshl_b32 s49, s49, 4
    s_add_u32 s49, s49, s44
    s_and_b32 s90, s38, 1
    s_lshr_b32 s91, s38, 1
    s_mul_i32 s50, s90, 24576
    s_mul_i32 s45, s91, 1536
    s_add_u32 s50, s50, s45
    s_mul_i32 s101, s38, 196608
    s_sub_u32 s101, s101, s50
    s_mul_i32 s53, s48, 49152
    s_add_u32 s53, s53, s50
    s_mul_i32 s43, s49, 786432
    s_add_u32 s43, s43, s53
    s_cmp_ge_u32 s49, 128
    s_cselect_b32 s43, 2130706432, s43
    s_sub_u32 s16, s43, 196608
    s_cmp_eq_u32 s49, 0
    s_cselect_b32 s16, 2130706432, s16
    s_mov_b32 s17, s43
    s_add_u32 s18, s43, 196608
    s_add_u32 s19, s43, 393216
    s_add_u32 s20, s43, 589824
    s_add_u32 s21, s43, 786432
    s_add_u32 s100, s43, s101
    v_mov_b32 v80, v255
    s_mov_b32 s6, 100663296
    s_mov_b32 s7, 0x20000
    s_waitcnt lgkmcnt(0)
    s_and_b32 s5, s5, 0xffff
    s_cmp_lt_u32 s2, 54
    s_cbranch_scc1 wt_path
    buffer_load_dwordx2 v[8:9], v80, s[4:7], s16 offen offset:0
    buffer_load_dwordx2 v[10:11], v80, s[4:7], s17 offen offset:0
    buffer_load_dwordx2 v[12:13], v80, s[4:7], s18 offen offset:0
    buffer_load_dwordx2 v[14:15], v80, s[4:7], s19 offen offset:0
    buffer_load_dwordx2 v[16:17], v80, s[4:7], s20 offen offset:0
    buffer_load_dwordx2 v[18:19], v80, s[4:7], s21 offen offset:0
    buffer_load_dwordx2 v[20:21], v80, s[4:7], s16 offen offset:384
    buffer_load_dwordx2 v[22:23], v80, s[4:7], s17 offen offset:384
    buffer_load_dwordx2 v[24:25], v80, s[4:7], s18 offen offset:384
    buffer_load_dwordx2 v[26:27], v80, s[4:7], s19 offen offset:384
    buffer_load_dwordx2 v[28:29], v80, s[4:7], s20 offen offset:384
    buffer_load_dwordx2 v[30:31], v80, s[4:7], s21 offen offset:384
    s_and_b32 s61, s61, 0xffff
    s_mul_i32 s44, s38, 9216
    s_add_u32 s8, s8, s44
    s_addc_u32 s9, s9, 0
    s_and_b32 s9, s9, 0xffff
    s_mov_b32 s10, 1299456
    s_mov_b32 s11, 0x20000
    s_mov_b32 s64, s14
    s_and_b32 s65, s15, 0xffff
    s_mov_b32 s66, 256
    s_mov_b32 s67, 0x20000
    s_mov_b64 s[68:69], s[14:15]
    s_branch wt_join
wl_far:
    s_mul_i32 s73, s70, 43691
    s_lshr_b32 s73, s73, 17
    s_mul_i32 s74, s73, 3
    s_sub_u32 s74, s70, s74
    s_mul_i32 s75, s73, 43691
    s_lshr_b32 s75, s75, 17
    s_mul_i32 s76, s75, 3
    s_sub_u32 s76, s73, s76
    v_and_b32 v101, 14, v2
    v_lshrrev_b32 v102, 4, v2
    v_and_b32 v103, 12, v101
    v_and_b32 v105, 1, v2
    s_lshl_b32 s78, s74, 2
    s_cmp_lt_u32 s74, 2
    s_cselect_b32 s77, 1, 0
    s_cselect_b32 s78, s78, 32
    v_mul_u32_u24 v103, s77, v103
    v_add_u32 v103, v103, v101
    v_add_u32 v103, s78, v103
    v_lshl_add_u32 v103, v103, 1, s52
    v_lshl_add_u32 v102, v102, 1, v105
    v_mul_u32_u24 v104, 1536, v102
    v_add_u32 v103, v103, v104
    s_mul_i32 s79, s76, 73728
    s_mul_i32 s80, s75, 12288
    s_add_u32 s79, s79, s80
    s_add_u32 s80, s79, 221184
    s_add_u32 s81, s79, 442368
    s_waitcnt lgkmcnt(0)
    s_and_b32 s61, s61, 0xffff
    buffer_load_dword v136, v103, s[60:63], s79 offen offset:0
    buffer_load_dword v137, v103, s[60:63], s79 offen offset:384
    buffer_load_dword v138, v103, s[60:63], s79 offen offset:768
    buffer_load_dword v139, v103, s[60:63], s79 offen offset:1152
    buffer_load_dword v140, v103, s[60:63], s80 offen offset:0
    buffer_load_dword v141, v103, s[60:63], s80 offen offset:384
    buffer_load_dword v142, v103, s[60:63], s80 offen offset:768
    buffer_load_dword v143, v103, s[60:63], s80 offen offset:1152
    buffer_load_dword v144, v103, s[60:63], s81 offen offset:0
    buffer_load_dword v145, v103, s[60:63], s81 offen offset:384
    buffer_load_dword v146, v103, s[60:63], s81 offen offset:768
    buffer_load_dword v147, v103, s[60:63], s81 offen offset:1152
    v_mul_u32_u24 v106, 0x0202, v105
    v_sub_u32 v106, 0x0504, v106
    v_mul_u32_u24 v107, 0x0606, v105
    v_add_u32 v107, 0x0100, v107
    v_mov_b32 v108, 0x0c0c
    v_lshl_or_b32 v106, v106, 16, v108
    v_lshl_or_b32 v107, v107, 16, v108
    s_mul_i32 s82, s76, 3072
    s_lshl_b32 s83, s74, 10
    s_add_u32 s82, s82, s83
    s_mul_i32 s83, s75, 36864
    s_lshl_b32 s84, s83, 2
    s_add_u32 s83, s83, s82
    s_add_u32 s84, s84, s82
    s_branch wl_skip
wt_path:
    s_and_b32 s61, s61, 0xffff
    s_mul_i32 s44, s38, 9216
    s_add_u32 s8, s8, s44
    s_addc_u32 s9, s9, 0
    s_and_b32 s9, s9, 0xffff
    s_mov_b32 s10, 1299456
    s_mov_b32 s11, 0x20000
    s_mov_b32 s64, s14
    s_and_b32 s65, s15, 0xffff
    s_mov_b32 s66, 256
    s_mov_b32 s67, 0x20000
    s_mov_b64 s[68:69], s[14:15]
    s_waitcnt vmcnt(0)
    v_mov_b32_dpp v152, v136 quad_perm:[1,0,3,2] row_mask:0xf bank_mask:0xf
    v_mov_b32_dpp v153, v137 quad_perm:[1,0,3,2] row_mask:0xf bank_mask:0xf
    v_mov_b32_dpp v154, v138 quad_perm:[1,0,3,2] row_mask:0xf bank_mask:0xf
    v_mov_b32_dpp v155, v139 quad_perm:[1,0,3,2] row_mask:0xf bank_mask:0xf
    v_mov_b32_dpp v156, v140 quad_perm:[1,0,3,2] row_mask:0xf bank_mask:0xf
    v_mov_b32_dpp v157, v141 quad_perm:[1,0,3,2] row_mask:0xf bank_mask:0xf
    v_mov_b32_dpp v158, v142 quad_perm:[1,0,3,2] row_mask:0xf bank_mask:0xf
    v_mov_b32_dpp v159, v143 quad_perm:[1,0,3,2] row_mask:0xf bank_mask:0xf
    v_mov_b32_dpp v160, v144 quad_perm:[1,0,3,2] row_mask:0xf bank_mask:0xf
    v_mov_b32_dpp v161, v145 quad_perm:[1,0,3,2] row_mask:0xf bank_mask:0xf
    v_mov_b32_dpp v162, v146 quad_perm:[1,0,3,2] row_mask:0xf bank_mask:0xf
    v_mov_b32_dpp v163, v147 quad_perm:[1,0,3,2] row_mask:0xf bank_mask:0xf
    v_perm_b32 v110, v136, v152, v106
    v_perm_b32 v114, v136, v152, v107
    v_perm_b32 v111, v137, v153, v106
    v_perm_b32 v115, v137, v153, v107
    v_perm_b32 v112, v138, v154, v106
    v_perm_b32 v116, v138, v154, v107
    v_perm_b32 v113, v139, v155, v106
    v_perm_b32 v117, v139, v155, v107
    v_perm_b32 v118, v140, v156, v106
    v_perm_b32 v122, v140, v156, v107
    v_perm_b32 v119, v141, v157, v106
    v_perm_b32 v123, v141, v157, v107
    v_perm_b32 v120, v142, v158, v106
    v_perm_b32 v124, v142, v158, v107
    v_perm_b32 v121, v143, v159, v106
    v_perm_b32 v125, v143, v159, v107
    v_perm_b32 v126, v144, v160, v106
    v_perm_b32 v130, v144, v160, v107
    v_perm_b32 v127, v145, v161, v106
    v_perm_b32 v131, v145, v161, v107
    v_perm_b32 v128, v146, v162, v106
    v_perm_b32 v132, v146, v162, v107
    v_perm_b32 v129, v147, v163, v106
    v_perm_b32 v133, v147, v163, v107
    v_mul_f32 v136, 0xbedba55c, v110
    v_fmac_f32 v136, 0xbe0afea5, v126
    v_fmamk_f32 v144, v118, 0xbe771a08, v136
    v_fmac_f32 v136, 0x3e771a08, v118
    v_mul_f32 v137, 0xbedba55c, v111
    v_fmac_f32 v137, 0xbe0afea5, v127
    v_fmamk_f32 v145, v119, 0xbe771a08, v137
    v_fmac_f32 v137, 0x3e771a08, v119
    v_mul_f32 v138, 0xbedba55c, v112
    v_fmac_f32 v138, 0xbe0afea5, v128
    v_fmamk_f32 v146, v120, 0xbe771a08, v138
    v_fmac_f32 v138, 0x3e771a08, v120
    v_mul_f32 v139, 0xbedba55c, v113
    v_fmac_f32 v139, 0xbe0afea5, v129
    v_fmamk_f32 v147, v121, 0xbe771a08, v139
    v_fmac_f32 v139, 0x3e771a08, v121
    v_mul_f32 v140, 0xbedba55c, v114
    v_fmac_f32 v140, 0xbe0afea5, v130
    v_fmamk_f32 v148, v122, 0xbe771a08, v140
    v_fmac_f32 v140, 0x3e771a08, v122
    v_mul_f32 v141, 0xbedba55c, v115
    v_fmac_f32 v141, 0xbe0afea5, v131
    v_fmamk_f32 v149, v123, 0xbe771a08, v141
    v_fmac_f32 v141, 0x3e771a08, v123
    v_mul_f32 v142, 0xbedba55c, v116
    v_fmac_f32 v142, 0xbe0afea5, v132
    v_fmamk_f32 v150, v124, 0xbe771a08, v142
    v_fmac_f32 v142, 0x3e771a08, v124
    v_mul_f32 v143, 0xbedba55c, v117
    v_fmac_f32 v143, 0xbe0afea5, v133
    v_fmamk_f32 v151, v125, 0xbe771a08, v143
    v_fmac_f32 v143, 0x3e771a08, v125
    v_cvt_pk_bf16_f32 v156, v144, v145
    v_cvt_pk_bf16_f32 v157, v146, v147
    v_cvt_pk_bf16_f32 v158, v148, v149
    v_cvt_pk_bf16_f32 v159, v150, v151
    s_add_u32 s85, s84, 0
    buffer_store_dwordx4 v[156:159], v254, s[8:11], s85 offen sc1
    v_cvt_pk_bf16_f32 v160, v136, v137
    v_cvt_pk_bf16_f32 v161, v138, v139
    v_cvt_pk_bf16_f32 v162, v140, v141
    v_cvt_pk_bf16_f32 v163, v142, v143
    s_add_u32 s85, s84, 36864
    buffer_store_dwordx4 v[160:163], v254, s[8:11], s85 offen sc1
    v_mul_f32 v136, 0x3e0afea5, v110
    v_fmac_f32 v136, 0x3f0afea5, v126
    v_fmamk_f32 v144, v118, 0x3e8afea5, v136
    v_fmac_f32 v136, 0xbe8afea5, v118
    v_mul_f32 v137, 0x3e0afea5, v111
    v_fmac_f32 v137, 0x3f0afea5, v127
    v_fmamk_f32 v145, v119, 0x3e8afea5, v137
    v_fmac_f32 v137, 0xbe8afea5, v119
    v_mul_f32 v138, 0x3e0afea5, v112
    v_fmac_f32 v138, 0x3f0afea5, v128
    v_fmamk_f32 v146, v120, 0x3e8afea5, v138
    v_fmac_f32 v138, 0xbe8afea5, v120
    v_mul_f32 v139, 0x3e0afea5, v113
    v_fmac_f32 v139, 0x3f0afea5, v129
    v_fmamk_f32 v147, v121, 0x3e8afea5, v139
    v_fmac_f32 v139, 0xbe8afea5, v121
    v_mul_f32 v140, 0x3e0afea5, v114
    v_fmac_f32 v140, 0x3f0afea5, v130
    v_fmamk_f32 v148, v122, 0x3e8afea5, v140
    v_fmac_f32 v140, 0xbe8afea5, v122
    v_mul_f32 v141, 0x3e0afea5, v115
    v_fmac_f32 v141, 0x3f0afea5, v131
    v_fmamk_f32 v149, v123, 0x3e8afea5, v141
    v_fmac_f32 v141, 0xbe8afea5, v123
    v_mul_f32 v142, 0x3e0afea5, v116
    v_fmac_f32 v142, 0x3f0afea5, v132
    v_fmamk_f32 v150, v124, 0x3e8afea5, v142
    v_fmac_f32 v142, 0xbe8afea5, v124
    v_mul_f32 v143, 0x3e0afea5, v117
    v_fmac_f32 v143, 0x3f0afea5, v133
    v_fmamk_f32 v151, v125, 0x3e8afea5, v143
    v_fmac_f32 v143, 0xbe8afea5, v125
    v_cvt_pk_bf16_f32 v164, v144, v145
    v_cvt_pk_bf16_f32 v165, v146, v147
    v_cvt_pk_bf16_f32 v166, v148, v149
    v_cvt_pk_bf16_f32 v167, v150, v151
    s_add_u32 s85, s84, 73728
    buffer_store_dwordx4 v[164:167], v254, s[8:11], s85 offen sc1
    v_cvt_pk_bf16_f32 v168, v136, v137
    v_cvt_pk_bf16_f32 v169, v138, v139
    v_cvt_pk_bf16_f32 v170, v140, v141
    v_cvt_pk_bf16_f32 v171, v142, v143
    s_add_u32 s85, s84, 110592
    buffer_store_dwordx4 v[168:171], v254, s[8:11], s85 offen sc1
    v_cvt_pk_bf16_f32 v152, v110, v111
    v_cvt_pk_bf16_f32 v153, v112, v113
    v_cvt_pk_bf16_f32 v154, v114, v115
    v_cvt_pk_bf16_f32 v155, v116, v117
    s_add_u32 s85, s83, 884736
    buffer_store_dwordx4 v[152:155], v254, s[8:11], s85 offen sc1
    v_cvt_pk_bf16_f32 v172, v126, v127
    v_cvt_pk_bf16_f32 v173, v128, v129
    v_cvt_pk_bf16_f32 v174, v130, v131
    v_cvt_pk_bf16_f32 v175, v132, v133
    s_add_u32 s85, s83, 1105920
    buffer_store_dwordx4 v[172:175], v254, s[8:11], s85 offen sc1
wt_join:
    s_and_b32 s13, s13, 0xffff
    s_mov_b32 s14, 100663296
    s_mov_b32 s15, 0x20000
    v_lshrrev_b32 v5, 4, v2
    v_mul_u32_u24 v6, 40704, v5
    v_lshrrev_b32 v5, 1, v5
    v_lshl_add_u32 v6, v5, 6, v6
    v_and_b32 v5, 0xf0, v254
    v_add_u32 v253, v6, v5
    v_lshrrev_b32 v6, 1, v4
    v_mul_u32_u24 v7, 40704, v6
    v_lshrrev_b32 v6, 1, v6
    v_lshl_add_u32 v7, v6, 6, v7
    v_and_b32 v6, 1, v2
    v_lshl_add_u32 v7, v6, 3, v7
    v_lshl_add_u32 v7, v3, 4, v7
    s_lshl_b32 s44, s90, 7
    s_mul_i32 s45, s91, 1056
    s_add_u32 s44, s44, s45
    v_add_u32 v7, s44, v7
    v_lshl_or_b32 v255, v7, 15, v255
    s_mul_i32 s51, s38, 40704
    s_lshl_b32 s45, s91, 6
    s_add_u32 s51, s51, s45
    s_lshl_b32 s45, s90, 4
    s_add_u32 s51, s51, s45
    s_mul_i32 s40, s49, 786432
    s_mul_i32 s45, s48, 49152
    s_add_u32 s40, s40, s45
    s_mul_i32 s45, s38, 12288
    s_add_u32 s40, s40, s45
    s_mov_b32 s41, 2130706432
    s_mov_b32 s39, 0
    s_mov_b32 s36, 0
    s_lshl_b32 s45, s38, 4
    s_mov_b32 s46, 0xfff
    s_mov_b32 s47, 0
    s_lshl_b64 s[46:47], s[46:47], s45
    s_mov_b32 s58, 0x0fff0fff
    s_mov_b32 s59, 0
    s_mov_b32 s23, 0xc08a2000
    s_mov_b32 s24, 0xbea20000
    s_mov_b32 s25, 0x3f4a4588
    s_mov_b32 s26, 0x3f100000
    s_mov_b32 s27, 0xbf100000
    s_mov_b32 s28, 0xc05a4588
    s_mov_b32 s29, 0x3fa20000
    s_mov_b32 s30, 0x3ea20000
    s_mov_b32 s31, 0x3e800000
    s_mov_b32 s34, 0x3f900000
    s_mov_b32 s35, 0x3db64000
    s_mov_b32 s22, 0xffff0000
    s_and_b32 s45, s49, 7
    s_cmp_eq_u32 s45, 0
    s_cselect_b32 s33, 4294770688, 0x40000000
    s_cmp_eq_u32 s45, 7
    s_cselect_b32 s33, 786432, s33
    s_mul_i32 s45, s38, 196224
    s_sub_u32 s45, s101, s45
    s_add_u32 s33, s33, s45
    s_mov_b32 s37, 2130706432
    v_bfe_u32 v6, v254, 6, 2
    v_mul_u32_u24 v4, 40704, v6
    v_and_b32 v6, 0x80, v254
    v_lshrrev_b32 v6, 1, v6
    v_add_u32 v4, v4, v6
    v_and_b32 v6, 0x40, v254
    v_lshrrev_b32 v6, 2, v6
    v_add_u32 v4, v4, v6
    v_bfe_u32 v6, v254, 4, 2
    v_mul_u32_u24 v6, 3104, v6
    v_add_u32 v4, v4, v6
    v_add_u32 v4, s52, v4
    v_lshrrev_b32 v6, 8, v254
    v_lshl_add_u32 v5, v6, 3, v4
    v_lshl_add_u32 v4, v6, 4, v4
    v_add_u32 v6, s51, v254
    v_mov_b32 v192, 0
    v_mov_b32 v193, 0
    v_mov_b32 v203, 0
    v_mov_b32 v215, 0
    v_mov_b32 v224, 0
    v_mov_b32 v227, 0
    v_mov_b32 v252, 0
    s_mov_b32 s42, 0
    s_cmp_gt_u32 s48, 0
    s_cselect_b32 s45, 384, 0
    s_cselect_b32 s55, 0, 2130706432
    s_add_u32 s50, s50, s45
    s_add_u32 s54, s45, 49152
    s_cmp_eq_u32 s48, 3
    s_cselect_b32 s54, 2130706432, s54
    s_mov_b32 s56, 0xffff0000
    s_mov_b32 s57, 0
    s_cmp_ge_u32 s2, 54
    s_cbranch_scc1 pub_skip
    s_branch do_warm
wt_ret:
    s_mov_b32 s87, 1
    s_cmp_lg_u32 s38, 0
    s_waitcnt vmcnt(0)
    s_barrier
    s_cbranch_scc1 wt_pub
    s_atomic_add s87, s[68:69], 0 glc
    s_waitcnt lgkmcnt(0)
    s_cmp_lg_u32 s87, 53
    s_cbranch_scc1 wt_pub
    s_atomic_add s87, s[68:69], 128
wt_pub:
    buffer_load_dwordx2 v[8:9], v80, s[4:7], s16 offen offset:0
    buffer_load_dwordx2 v[10:11], v80, s[4:7], s17 offen offset:0
    buffer_load_dwordx2 v[12:13], v80, s[4:7], s18 offen offset:0
    buffer_load_dwordx2 v[14:15], v80, s[4:7], s19 offen offset:0
    buffer_load_dwordx2 v[16:17], v80, s[4:7], s20 offen offset:0
    buffer_load_dwordx2 v[18:19], v80, s[4:7], s21 offen offset:0
    buffer_load_dwordx2 v[20:21], v80, s[4:7], s16 offen offset:384
    buffer_load_dwordx2 v[22:23], v80, s[4:7], s17 offen offset:384
    buffer_load_dwordx2 v[24:25], v80, s[4:7], s18 offen offset:384
    buffer_load_dwordx2 v[26:27], v80, s[4:7], s19 offen offset:384
    buffer_load_dwordx2 v[28:29], v80, s[4:7], s20 offen offset:384
    buffer_load_dwordx2 v[30:31], v80, s[4:7], s21 offen offset:384
pub_skip:
    v_and_b32 v67, 0xf0, v254
    v_lshrrev_b32 v67, 1, v67
    v_add_u32 v67, s52, v67
    v_mov_b32 v66, s54
    v_mov_b32 v65, s55
    v_cndmask_b32 v66, v66, v65, s[56:57]
    v_add_u32 v67, v67, v66
    s_sub_u32 s45, s16, s50
    buffer_load_dwordx2 v[56:57], v67, s[4:7], s45 offen
    s_sub_u32 s45, s17, s50
    buffer_load_dwordx2 v[58:59], v67, s[4:7], s45 offen
    s_sub_u32 s45, s18, s50
    buffer_load_dwordx2 v[60:61], v67, s[4:7], s45 offen
    s_sub_u32 s45, s19, s50
    buffer_load_dwordx2 v[62:63], v67, s[4:7], s45 offen
    s_sub_u32 s45, s20, s50
    buffer_load_dwordx2 v[64:65], v67, s[4:7], s45 offen
    s_sub_u32 s45, s21, s50
    buffer_load_dwordx2 v[66:67], v67, s[4:7], s45 offen
    buffer_load_dwordx2 v[32:33], v80, s[4:7], s16 offen offset:768
    buffer_load_dwordx2 v[34:35], v80, s[4:7], s17 offen offset:768
    buffer_load_dwordx2 v[36:37], v80, s[4:7], s18 offen offset:768
    buffer_load_dwordx2 v[38:39], v80, s[4:7], s19 offen offset:768
    buffer_load_dwordx2 v[40:41], v80, s[4:7], s20 offen offset:768
    buffer_load_dwordx2 v[42:43], v80, s[4:7], s21 offen offset:768
    buffer_load_dwordx2 v[44:45], v80, s[4:7], s16 offen offset:1152
    buffer_load_dwordx2 v[46:47], v80, s[4:7], s17 offen offset:1152
    buffer_load_dwordx2 v[48:49], v80, s[4:7], s18 offen offset:1152
    buffer_load_dwordx2 v[50:51], v80, s[4:7], s19 offen offset:1152
    buffer_load_dwordx2 v[52:53], v80, s[4:7], s20 offen offset:1152
    buffer_load_dwordx2 v[54:55], v80, s[4:7], s21 offen offset:1152
    s_waitcnt vmcnt(24)
    v_lshlrev_b32 v176, 16, v8
    v_and_b32 v177, s22, v8
    v_lshlrev_b32 v178, 16, v10
    v_and_b32 v179, s22, v10
    v_lshlrev_b32 v180, 16, v12
    v_and_b32 v181, s22, v12
    v_lshlrev_b32 v182, 16, v14
    v_and_b32 v183, s22, v14
    v_lshlrev_b32 v184, 16, v16
    v_and_b32 v185, s22, v16
    v_lshlrev_b32 v186, 16, v18
    v_and_b32 v187, s22, v18
    v_pk_fma_f32 v[176:177], v[184:185], s[24:25], v[176:177] op_sel:[0,1,0]
    v_pk_fma_f32 v[186:187], v[178:179], s[28:29], v[186:187] op_sel:[0,1,0]
    v_pk_fma_f32 v[176:177], v[180:181], s[28:29], v[176:177] op_sel_hi:[1,0,1]
    v_pk_fma_f32 v[186:187], v[182:183], s[22:23], v[186:187] op_sel:[0,1,0]
    v_pk_fma_f32 v[188:189], v[180:181], s[24:25], v[184:185] op_sel_hi:[1,0,1]
    v_pk_fma_f32 v[184:185], v[180:181], -4.0, v[184:185] op_sel_hi:[1,0,1]
    v_pk_fma_f32 v[180:181], v[178:179], s[24:25], v[182:183] op_sel_hi:[1,0,1]
    v_pk_fma_f32 v[182:183], v[178:179], -4.0, v[182:183] op_sel_hi:[1,0,1]
    v_pk_fma_f32 v[178:179], v[182:183], s[26:27], v[184:185] op_sel_hi:[1,0,1]
    v_pk_fma_f32 v[184:185], v[182:183], s[26:27], v[184:185] op_sel:[0,1,0]
    v_pk_fma_f32 v[182:183], v[180:181], 2.0, v[188:189] op_sel_hi:[1,0,1]
    v_pk_fma_f32 v[180:181], v[180:181], -2.0, v[188:189] op_sel_hi:[1,0,1]
    v_cvt_pk_bf16_f32 v8, v176, v177
    v_cvt_pk_bf16_f32 v10, v178, v179
    v_cvt_pk_bf16_f32 v12, v180, v181
    v_cvt_pk_bf16_f32 v14, v182, v183
    v_cvt_pk_bf16_f32 v16, v184, v185
    v_cvt_pk_bf16_f32 v18, v186, v187
    v_lshlrev_b32 v176, 16, v9
    v_and_b32 v177, s22, v9
    v_lshlrev_b32 v178, 16, v11
    v_and_b32 v179, s22, v11
    v_lshlrev_b32 v180, 16, v13
    v_and_b32 v181, s22, v13
    v_lshlrev_b32 v182, 16, v15
    v_and_b32 v183, s22, v15
    v_lshlrev_b32 v184, 16, v17
    v_and_b32 v185, s22, v17
    v_lshlrev_b32 v186, 16, v19
    v_and_b32 v187, s22, v19
    v_pk_fma_f32 v[176:177], v[184:185], s[24:25], v[176:177] op_sel:[0,1,0]
    v_pk_fma_f32 v[186:187], v[178:179], s[28:29], v[186:187] op_sel:[0,1,0]
    v_pk_fma_f32 v[176:177], v[180:181], s[28:29], v[176:177] op_sel_hi:[1,0,1]
    v_pk_fma_f32 v[186:187], v[182:183], s[22:23], v[186:187] op_sel:[0,1,0]
    v_pk_fma_f32 v[188:189], v[180:181], s[24:25], v[184:185] op_sel_hi:[1,0,1]
    v_pk_fma_f32 v[184:185], v[180:181], -4.0, v[184:185] op_sel_hi:[1,0,1]
    v_pk_fma_f32 v[180:181], v[178:179], s[24:25], v[182:183] op_sel_hi:[1,0,1]
    v_pk_fma_f32 v[182:183], v[178:179], -4.0, v[182:183] op_sel_hi:[1,0,1]
    v_pk_fma_f32 v[178:179], v[182:183], s[26:27], v[184:185] op_sel_hi:[1,0,1]
    v_pk_fma_f32 v[184:185], v[182:183], s[26:27], v[184:185] op_sel:[0,1,0]
    v_pk_fma_f32 v[182:183], v[180:181], 2.0, v[188:189] op_sel_hi:[1,0,1]
    v_pk_fma_f32 v[180:181], v[180:181], -2.0, v[188:189] op_sel_hi:[1,0,1]
    v_cvt_pk_bf16_f32 v9, v176, v177
    v_cvt_pk_bf16_f32 v11, v178, v179
    v_cvt_pk_bf16_f32 v13, v180, v181
    v_cvt_pk_bf16_f32 v15, v182, v183
    v_cvt_pk_bf16_f32 v17, v184, v185
    v_cvt_pk_bf16_f32 v19, v186, v187
    v_lshrrev_b32 v252, 15, v255
    ds_write_b64 v252, v[8:9] offset:34048
    ds_write_b64 v252, v[10:11] offset:768
    ds_write_b64 v252, v[16:17] offset:2848
    ds_write_b64 v252, v[14:15] offset:4928
    ds_write_b64 v252, v[12:13] offset:7008
    ds_write_b64 v252, v[18:19] offset:36128
    s_waitcnt vmcnt(18)
    v_lshlrev_b32 v176, 16, v20
    v_and_b32 v177, s22, v20
    v_lshlrev_b32 v178, 16, v22
    v_and_b32 v179, s22, v22
    v_lshlrev_b32 v180, 16, v24
    v_and_b32 v181, s22, v24
    v_lshlrev_b32 v182, 16, v26
    v_and_b32 v183, s22, v26
    v_lshlrev_b32 v184, 16, v28
    v_and_b32 v185, s22, v28
    v_lshlrev_b32 v186, 16, v30
    v_and_b32 v187, s22, v30
    v_pk_fma_f32 v[176:177], v[184:185], s[24:25], v[176:177] op_sel:[0,1,0]
    v_pk_fma_f32 v[186:187], v[178:179], s[28:29], v[186:187] op_sel:[0,1,0]
    v_pk_fma_f32 v[176:177], v[180:181], s[28:29], v[176:177] op_sel_hi:[1,0,1]
    v_pk_fma_f32 v[186:187], v[182:183], s[22:23], v[186:187] op_sel:[0,1,0]
    v_pk_fma_f32 v[188:189], v[180:181], s[24:25], v[184:185] op_sel_hi:[1,0,1]
    v_pk_fma_f32 v[184:185], v[180:181], -4.0, v[184:185] op_sel_hi:[1,0,1]
    v_pk_fma_f32 v[180:181], v[178:179], s[24:25], v[182:183] op_sel_hi:[1,0,1]
    v_pk_fma_f32 v[182:183], v[178:179], -4.0, v[182:183] op_sel_hi:[1,0,1]
    v_pk_fma_f32 v[178:179], v[182:183], s[26:27], v[184:185] op_sel_hi:[1,0,1]
    v_pk_fma_f32 v[184:185], v[182:183], s[26:27], v[184:185] op_sel:[0,1,0]
    v_pk_fma_f32 v[182:183], v[180:181], 2.0, v[188:189] op_sel_hi:[1,0,1]
    v_pk_fma_f32 v[180:181], v[180:181], -2.0, v[188:189] op_sel_hi:[1,0,1]
    v_cvt_pk_bf16_f32 v20, v176, v177
    v_cvt_pk_bf16_f32 v22, v178, v179
    v_cvt_pk_bf16_f32 v24, v180, v181
    v_cvt_pk_bf16_f32 v26, v182, v183
    v_cvt_pk_bf16_f32 v28, v184, v185
    v_cvt_pk_bf16_f32 v30, v186, v187
    v_lshlrev_b32 v176, 16, v21
    v_and_b32 v177, s22, v21
    v_lshlrev_b32 v178, 16, v23
    v_and_b32 v179, s22, v23
    v_lshlrev_b32 v180, 16, v25
    v_and_b32 v181, s22, v25
    v_lshlrev_b32 v182, 16, v27
    v_and_b32 v183, s22, v27
    v_lshlrev_b32 v184, 16, v29
    v_and_b32 v185, s22, v29
    v_lshlrev_b32 v186, 16, v31
    v_and_b32 v187, s22, v31
    v_pk_fma_f32 v[176:177], v[184:185], s[24:25], v[176:177] op_sel:[0,1,0]
    v_pk_fma_f32 v[186:187], v[178:179], s[28:29], v[186:187] op_sel:[0,1,0]
    v_pk_fma_f32 v[176:177], v[180:181], s[28:29], v[176:177] op_sel_hi:[1,0,1]
    v_pk_fma_f32 v[186:187], v[182:183], s[22:23], v[186:187] op_sel:[0,1,0]
    v_pk_fma_f32 v[188:189], v[180:181], s[24:25], v[184:185] op_sel_hi:[1,0,1]
    v_pk_fma_f32 v[184:185], v[180:181], -4.0, v[184:185] op_sel_hi:[1,0,1]
    v_pk_fma_f32 v[180:181], v[178:179], s[24:25], v[182:183] op_sel_hi:[1,0,1]
    v_pk_fma_f32 v[182:183], v[178:179], -4.0, v[182:183] op_sel_hi:[1,0,1]
    v_pk_fma_f32 v[178:179], v[182:183], s[26:27], v[184:185] op_sel_hi:[1,0,1]
    v_pk_fma_f32 v[184:185], v[182:183], s[26:27], v[184:185] op_sel:[0,1,0]
    v_pk_fma_f32 v[182:183], v[180:181], 2.0, v[188:189] op_sel_hi:[1,0,1]
    v_pk_fma_f32 v[180:181], v[180:181], -2.0, v[188:189] op_sel_hi:[1,0,1]
    v_cvt_pk_bf16_f32 v21, v176, v177
    v_cvt_pk_bf16_f32 v23, v178, v179
    v_cvt_pk_bf16_f32 v25, v180, v181
    v_cvt_pk_bf16_f32 v27, v182, v183
    v_cvt_pk_bf16_f32 v29, v184, v185
    v_cvt_pk_bf16_f32 v31, v186, v187
    v_lshrrev_b32 v252, 15, v255
    ds_write_b64 v252, v[20:21] offset:33792
    ds_write_b64 v252, v[22:23] offset:512
    ds_write_b64 v252, v[28:29] offset:2592
    ds_write_b64 v252, v[26:27] offset:4672
    ds_write_b64 v252, v[24:25] offset:6752
    ds_write_b64 v252, v[30:31] offset:35872
    s_waitcnt vmcnt(12)
    v_lshlrev_b32 v176, 16, v56
    v_and_b32 v177, s22, v56
    v_lshlrev_b32 v178, 16, v58
    v_and_b32 v179, s22, v58
    v_lshlrev_b32 v180, 16, v60
    v_and_b32 v181, s22, v60
    v_lshlrev_b32 v182, 16, v62
    v_and_b32 v183, s22, v62
    v_lshlrev_b32 v184, 16, v64
    v_and_b32 v185, s22, v64
    v_lshlrev_b32 v186, 16, v66
    v_and_b32 v187, s22, v66
    v_pk_fma_f32 v[176:177], v[184:185], s[24:25], v[176:177] op_sel:[0,1,0]
    v_pk_fma_f32 v[186:187], v[178:179], s[28:29], v[186:187] op_sel:[0,1,0]
    v_pk_fma_f32 v[176:177], v[180:181], s[28:29], v[176:177] op_sel_hi:[1,0,1]
    v_pk_fma_f32 v[186:187], v[182:183], s[22:23], v[186:187] op_sel:[0,1,0]
    v_pk_fma_f32 v[188:189], v[180:181], s[24:25], v[184:185] op_sel_hi:[1,0,1]
    v_pk_fma_f32 v[184:185], v[180:181], -4.0, v[184:185] op_sel_hi:[1,0,1]
    v_pk_fma_f32 v[180:181], v[178:179], s[24:25], v[182:183] op_sel_hi:[1,0,1]
    v_pk_fma_f32 v[182:183], v[178:179], -4.0, v[182:183] op_sel_hi:[1,0,1]
    v_pk_fma_f32 v[178:179], v[182:183], s[26:27], v[184:185] op_sel_hi:[1,0,1]
    v_pk_fma_f32 v[184:185], v[182:183], s[26:27], v[184:185] op_sel:[0,1,0]
    v_pk_fma_f32 v[182:183], v[180:181], 2.0, v[188:189] op_sel_hi:[1,0,1]
    v_pk_fma_f32 v[180:181], v[180:181], -2.0, v[188:189] op_sel_hi:[1,0,1]
    v_cvt_pk_bf16_f32 v56, v176, v177
    v_cvt_pk_bf16_f32 v58, v178, v179
    v_cvt_pk_bf16_f32 v60, v180, v181
    v_cvt_pk_bf16_f32 v62, v182, v183
    v_cvt_pk_bf16_f32 v64, v184, v185
    v_cvt_pk_bf16_f32 v66, v186, v187
    v_lshlrev_b32 v176, 16, v57
    v_and_b32 v177, s22, v57
    v_lshlrev_b32 v178, 16, v59
    v_and_b32 v179, s22, v59
    v_lshlrev_b32 v180, 16, v61
    v_and_b32 v181, s22, v61
    v_lshlrev_b32 v182, 16, v63
    v_and_b32 v183, s22, v63
    v_lshlrev_b32 v184, 16, v65
    v_and_b32 v185, s22, v65
    v_lshlrev_b32 v186, 16, v67
    v_and_b32 v187, s22, v67
    v_pk_fma_f32 v[176:177], v[184:185], s[24:25], v[176:177] op_sel:[0,1,0]
    v_pk_fma_f32 v[186:187], v[178:179], s[28:29], v[186:187] op_sel:[0,1,0]
    v_pk_fma_f32 v[176:177], v[180:181], s[28:29], v[176:177] op_sel_hi:[1,0,1]
    v_pk_fma_f32 v[186:187], v[182:183], s[22:23], v[186:187] op_sel:[0,1,0]
    v_pk_fma_f32 v[188:189], v[180:181], s[24:25], v[184:185] op_sel_hi:[1,0,1]
    v_pk_fma_f32 v[184:185], v[180:181], -4.0, v[184:185] op_sel_hi:[1,0,1]
    v_pk_fma_f32 v[180:181], v[178:179], s[24:25], v[182:183] op_sel_hi:[1,0,1]
    v_pk_fma_f32 v[182:183], v[178:179], -4.0, v[182:183] op_sel_hi:[1,0,1]
    v_pk_fma_f32 v[178:179], v[182:183], s[26:27], v[184:185] op_sel_hi:[1,0,1]
    v_pk_fma_f32 v[184:185], v[182:183], s[26:27], v[184:185] op_sel:[0,1,0]
    v_pk_fma_f32 v[182:183], v[180:181], 2.0, v[188:189] op_sel_hi:[1,0,1]
    v_pk_fma_f32 v[180:181], v[180:181], -2.0, v[188:189] op_sel_hi:[1,0,1]
    v_cvt_pk_bf16_f32 v57, v176, v177
    v_cvt_pk_bf16_f32 v59, v178, v179
    v_cvt_pk_bf16_f32 v61, v180, v181
    v_cvt_pk_bf16_f32 v63, v182, v183
    v_cvt_pk_bf16_f32 v65, v184, v185
    v_cvt_pk_bf16_f32 v67, v186, v187
    v_and_b32 v248, 0xf0, v254
    v_lshrrev_b32 v248, 1, v248
    v_add_u32 v248, s52, v248
    v_and_b32 v252, 8, v248
    v_lshrrev_b32 v249, 6, v248
    v_mul_u32_u24 v249, 192, v249
    v_cmp_eq_u32 s[92:93], 0, v249
    v_add_u32 v252, v252, v249
    v_bfe_u32 v249, v248, 4, 2
    v_mul_u32_u24 v249, 40704, v249
    v_add_u32 v252, v252, v249
    v_and_b32 v249, 32, v248
    v_lshl_add_u32 v252, v249, 1, v252
    v_bfe_u32 v249, v254, 8, 1
    v_lshl_add_u32 v252, v249, 4, v252
    v_mov_b32 v249, 123328
    v_cndmask_b32 v252, v249, v252, s[58:59]
    ds_write_b64 v252, v[56:57] offset:39520
    ds_write_b64 v252, v[58:59] offset:39552
    ds_write_b64 v252, v[64:65] offset:39584
    ds_write_b64 v252, v[62:63] offset:39616
    ds_write_b64 v252, v[60:61] offset:39648
    ds_write_b64 v252, v[66:67] offset:39680
    s_and_b64 exec, s[92:93], s[58:59]
    ds_write_b64 v252, v[56:57] offset:34304
    ds_write_b64 v252, v[58:59] offset:1024
    ds_write_b64 v252, v[64:65] offset:3104
    ds_write_b64 v252, v[62:63] offset:5184
    ds_write_b64 v252, v[60:61] offset:7264
    ds_write_b64 v252, v[66:67] offset:36384
    s_mov_b64 exec, -1
    v_and_b32 v203, 0x7fff, v255
    buffer_load_dwordx2 v[192:193], v203, s[4:7], s16 offen offset:64
    buffer_load_dwordx2 v[194:195], v203, s[4:7], s17 offen offset:64
    buffer_load_dwordx2 v[196:197], v203, s[4:7], s18 offen offset:64
    buffer_load_dwordx2 v[198:199], v203, s[4:7], s19 offen offset:64
    buffer_load_dwordx2 v[200:201], v203, s[4:7], s20 offen offset:64
    buffer_load_dwordx2 v[202:203], v203, s[4:7], s21 offen offset:64
    v_and_b32 v215, 0x7fff, v255
    buffer_load_dwordx2 v[204:205], v215, s[4:7], s16 offen offset:448
    buffer_load_dwordx2 v[206:207], v215, s[4:7], s17 offen offset:448
    buffer_load_dwordx2 v[208:209], v215, s[4:7], s18 offen offset:448
    buffer_load_dwordx2 v[210:211], v215, s[4:7], s19 offen offset:448
    buffer_load_dwordx2 v[212:213], v215, s[4:7], s20 offen offset:448
    buffer_load_dwordx2 v[214:215], v215, s[4:7], s21 offen offset:448
    s_waitcnt vmcnt(18)
    v_lshlrev_b32 v176, 16, v32
    v_and_b32 v177, s22, v32
    v_lshlrev_b32 v178, 16, v34
    v_and_b32 v179, s22, v34
    v_lshlrev_b32 v180, 16, v36
    v_and_b32 v181, s22, v36
    v_lshlrev_b32 v182, 16, v38
    v_and_b32 v183, s22, v38
    v_lshlrev_b32 v184, 16, v40
    v_and_b32 v185, s22, v40
    v_lshlrev_b32 v186, 16, v42
    v_and_b32 v187, s22, v42
    v_pk_fma_f32 v[176:177], v[184:185], s[24:25], v[176:177] op_sel:[0,1,0]
    v_pk_fma_f32 v[186:187], v[178:179], s[28:29], v[186:187] op_sel:[0,1,0]
    v_pk_fma_f32 v[176:177], v[180:181], s[28:29], v[176:177] op_sel_hi:[1,0,1]
    v_pk_fma_f32 v[186:187], v[182:183], s[22:23], v[186:187] op_sel:[0,1,0]
    v_pk_fma_f32 v[188:189], v[180:181], s[24:25], v[184:185] op_sel_hi:[1,0,1]
    v_pk_fma_f32 v[184:185], v[180:181], -4.0, v[184:185] op_sel_hi:[1,0,1]
    v_pk_fma_f32 v[180:181], v[178:179], s[24:25], v[182:183] op_sel_hi:[1,0,1]
    v_pk_fma_f32 v[182:183], v[178:179], -4.0, v[182:183] op_sel_hi:[1,0,1]
    v_pk_fma_f32 v[178:179], v[182:183], s[26:27], v[184:185] op_sel_hi:[1,0,1]
    v_pk_fma_f32 v[184:185], v[182:183], s[26:27], v[184:185] op_sel:[0,1,0]
    v_pk_fma_f32 v[182:183], v[180:181], 2.0, v[188:189] op_sel_hi:[1,0,1]
    v_pk_fma_f32 v[180:181], v[180:181], -2.0, v[188:189] op_sel_hi:[1,0,1]
    v_cvt_pk_bf16_f32 v32, v176, v177
    v_cvt_pk_bf16_f32 v34, v178, v179
    v_cvt_pk_bf16_f32 v36, v180, v181
    v_cvt_pk_bf16_f32 v38, v182, v183
    v_cvt_pk_bf16_f32 v40, v184, v185
    v_cvt_pk_bf16_f32 v42, v186, v187
    v_lshlrev_b32 v176, 16, v33
    v_and_b32 v177, s22, v33
    v_lshlrev_b32 v178, 16, v35
    v_and_b32 v179, s22, v35
    v_lshlrev_b32 v180, 16, v37
    v_and_b32 v181, s22, v37
    v_lshlrev_b32 v182, 16, v39
    v_and_b32 v183, s22, v39
    v_lshlrev_b32 v184, 16, v41
    v_and_b32 v185, s22, v41
    v_lshlrev_b32 v186, 16, v43
    v_and_b32 v187, s22, v43
    v_pk_fma_f32 v[176:177], v[184:185], s[24:25], v[176:177] op_sel:[0,1,0]
    v_pk_fma_f32 v[186:187], v[178:179], s[28:29], v[186:187] op_sel:[0,1,0]
    v_pk_fma_f32 v[176:177], v[180:181], s[28:29], v[176:177] op_sel_hi:[1,0,1]
    v_pk_fma_f32 v[186:187], v[182:183], s[22:23], v[186:187] op_sel:[0,1,0]
    v_pk_fma_f32 v[188:189], v[180:181], s[24:25], v[184:185] op_sel_hi:[1,0,1]
    v_pk_fma_f32 v[184:185], v[180:181], -4.0, v[184:185] op_sel_hi:[1,0,1]
    v_pk_fma_f32 v[180:181], v[178:179], s[24:25], v[182:183] op_sel_hi:[1,0,1]
    v_pk_fma_f32 v[182:183], v[178:179], -4.0, v[182:183] op_sel_hi:[1,0,1]
    v_pk_fma_f32 v[178:179], v[182:183], s[26:27], v[184:185] op_sel_hi:[1,0,1]
    v_pk_fma_f32 v[184:185], v[182:183], s[26:27], v[184:185] op_sel:[0,1,0]
    v_pk_fma_f32 v[182:183], v[180:181], 2.0, v[188:189] op_sel_hi:[1,0,1]
    v_pk_fma_f32 v[180:181], v[180:181], -2.0, v[188:189] op_sel_hi:[1,0,1]
    v_cvt_pk_bf16_f32 v33, v176, v177
    v_cvt_pk_bf16_f32 v35, v178, v179
    v_cvt_pk_bf16_f32 v37, v180, v181
    v_cvt_pk_bf16_f32 v39, v182, v183
    v_cvt_pk_bf16_f32 v41, v184, v185
    v_cvt_pk_bf16_f32 v43, v186, v187
    v_lshrrev_b32 v252, 15, v255
    ds_write_b64 v252, v[32:33] offset:33536
    ds_write_b64 v252, v[34:35] offset:256
    ds_write_b64 v252, v[40:41] offset:2336
    ds_write_b64 v252, v[38:39] offset:4416
    ds_write_b64 v252, v[36:37] offset:6496
    ds_write_b64 v252, v[42:43] offset:35616
    s_waitcnt vmcnt(12)
    v_lshlrev_b32 v176, 16, v44
    v_and_b32 v177, s22, v44
    v_lshlrev_b32 v178, 16, v46
    v_and_b32 v179, s22, v46
    v_lshlrev_b32 v180, 16, v48
    v_and_b32 v181, s22, v48
    v_lshlrev_b32 v182, 16, v50
    v_and_b32 v183, s22, v50
    v_lshlrev_b32 v184, 16, v52
    v_and_b32 v185, s22, v52
    v_lshlrev_b32 v186, 16, v54
    v_and_b32 v187, s22, v54
    v_pk_fma_f32 v[176:177], v[184:185], s[24:25], v[176:177] op_sel:[0,1,0]
    v_pk_fma_f32 v[186:187], v[178:179], s[28:29], v[186:187] op_sel:[0,1,0]
    v_pk_fma_f32 v[176:177], v[180:181], s[28:29], v[176:177] op_sel_hi:[1,0,1]
    v_pk_fma_f32 v[186:187], v[182:183], s[22:23], v[186:187] op_sel:[0,1,0]
    v_pk_fma_f32 v[188:189], v[180:181], s[24:25], v[184:185] op_sel_hi:[1,0,1]
    v_pk_fma_f32 v[184:185], v[180:181], -4.0, v[184:185] op_sel_hi:[1,0,1]
    v_pk_fma_f32 v[180:181], v[178:179], s[24:25], v[182:183] op_sel_hi:[1,0,1]
    v_pk_fma_f32 v[182:183], v[178:179], -4.0, v[182:183] op_sel_hi:[1,0,1]
    v_pk_fma_f32 v[178:179], v[182:183], s[26:27], v[184:185] op_sel_hi:[1,0,1]
    v_pk_fma_f32 v[184:185], v[182:183], s[26:27], v[184:185] op_sel:[0,1,0]
    v_pk_fma_f32 v[182:183], v[180:181], 2.0, v[188:189] op_sel_hi:[1,0,1]
    v_pk_fma_f32 v[180:181], v[180:181], -2.0, v[188:189] op_sel_hi:[1,0,1]
    v_cvt_pk_bf16_f32 v44, v176, v177
    v_cvt_pk_bf16_f32 v46, v178, v179
    v_cvt_pk_bf16_f32 v48, v180, v181
    v_cvt_pk_bf16_f32 v50, v182, v183
    v_cvt_pk_bf16_f32 v52, v184, v185
    v_cvt_pk_bf16_f32 v54, v186, v187
    v_lshlrev_b32 v176, 16, v45
    v_and_b32 v177, s22, v45
    v_lshlrev_b32 v178, 16, v47
    v_and_b32 v179, s22, v47
    v_lshlrev_b32 v180, 16, v49
    v_and_b32 v181, s22, v49
    v_lshlrev_b32 v182, 16, v51
    v_and_b32 v183, s22, v51
    v_lshlrev_b32 v184, 16, v53
    v_and_b32 v185, s22, v53
    v_lshlrev_b32 v186, 16, v55
    v_and_b32 v187, s22, v55
    v_pk_fma_f32 v[176:177], v[184:185], s[24:25], v[176:177] op_sel:[0,1,0]
    v_pk_fma_f32 v[186:187], v[178:179], s[28:29], v[186:187] op_sel:[0,1,0]
    v_pk_fma_f32 v[176:177], v[180:181], s[28:29], v[176:177] op_sel_hi:[1,0,1]
    v_pk_fma_f32 v[186:187], v[182:183], s[22:23], v[186:187] op_sel:[0,1,0]
    v_pk_fma_f32 v[188:189], v[180:181], s[24:25], v[184:185] op_sel_hi:[1,0,1]
    v_pk_fma_f32 v[184:185], v[180:181], -4.0, v[184:185] op_sel_hi:[1,0,1]
    v_pk_fma_f32 v[180:181], v[178:179], s[24:25], v[182:183] op_sel_hi:[1,0,1]
    v_pk_fma_f32 v[182:183], v[178:179], -4.0, v[182:183] op_sel_hi:[1,0,1]
    v_pk_fma_f32 v[178:179], v[182:183], s[26:27], v[184:185] op_sel_hi:[1,0,1]
    v_pk_fma_f32 v[184:185], v[182:183], s[26:27], v[184:185] op_sel:[0,1,0]
    v_pk_fma_f32 v[182:183], v[180:181], 2.0, v[188:189] op_sel_hi:[1,0,1]
    v_pk_fma_f32 v[180:181], v[180:181], -2.0, v[188:189] op_sel_hi:[1,0,1]
    v_cvt_pk_bf16_f32 v45, v176, v177
    v_cvt_pk_bf16_f32 v47, v178, v179
    v_cvt_pk_bf16_f32 v49, v180, v181
    v_cvt_pk_bf16_f32 v51, v182, v183
    v_cvt_pk_bf16_f32 v53, v184, v185
    v_cvt_pk_bf16_f32 v55, v186, v187
    v_lshrrev_b32 v252, 15, v255
    ds_write_b64 v252, v[44:45] offset:33280
    ds_write_b64 v252, v[46:47] offset:0
    ds_write_b64 v252, v[52:53] offset:2080
    ds_write_b64 v252, v[50:51] offset:4160
    ds_write_b64 v252, v[48:49] offset:6240
    ds_write_b64 v252, v[54:55] offset:35360
    buffer_load_dword v97, v98, s[64:67], 0 offen offset:128 sc1
    s_cmp_lt_u32 s2, 54
    s_cbranch_scc1 warm_done
do_warm:
    s_mov_b64 vcc, -1
    s_cmp_eq_u32 s38, 0
    s_cbranch_scc1 pad0
    s_cmp_eq_u32 s38, 1
    s_cbranch_scc1 pad1
    s_cmp_eq_u32 s38, 2
    s_cbranch_scc1 pad2
    s_branch pad3
warm_ret:
    s_mov_b64 vcc, 0
    s_cmp_lt_u32 s2, 54
    s_cbranch_scc1 wt_ret
warm_done:
    s_mov_b32 s86, 0
    s_waitcnt vmcnt(0)
poll_loop:
    v_readfirstlane_b32 s87, v97
    s_add_u32 s86, s86, 1
    s_cmp_lg_u32 s87, 0
    s_cbranch_scc1 u_ready
    buffer_load_dword v97, v98, s[64:67], 0 offen offset:128 sc1
    s_cmp_lt_u32 s86, 512
    s_waitcnt vmcnt(0)
    s_cbranch_scc1 poll_loop
    s_mov_b32 s70, 0
    s_branch wt_loop
u_ready:
    s_mov_b32 s42, 0
    buffer_load_dwordx4 a[192:195], v254, s[8:11], s42 offen offset:0 sc1
    buffer_load_dwordx4 a[196:199], v254, s[8:11], s42 offen offset:1024 sc1
    buffer_load_dwordx4 a[200:203], v254, s[8:11], s42 offen offset:2048 sc1
    s_mov_b32 s42, 3072
    buffer_load_dwordx4 a[204:207], v254, s[8:11], s42 offen offset:0 sc1
    buffer_load_dwordx4 a[208:211], v254, s[8:11], s42 offen offset:1024 sc1
    buffer_load_dwordx4 a[212:215], v254, s[8:11], s42 offen offset:2048 sc1
    s_mov_b32 s42, 6144
    buffer_load_dwordx4 a[216:219], v254, s[8:11], s42 offen offset:0 sc1
    buffer_load_dwordx4 a[220:223], v254, s[8:11], s42 offen offset:1024 sc1
    buffer_load_dwordx4 a[224:227], v254, s[8:11], s42 offen offset:2048 sc1
u_done:
    s_mov_b32 s42, 36864
    buffer_load_dwordx4 a[228:231], v254, s[8:11], s42 offen offset:0 sc1
    buffer_load_dwordx4 a[232:235], v254, s[8:11], s42 offen offset:1024 sc1
    buffer_load_dwordx4 a[236:239], v254, s[8:11], s42 offen offset:2048 sc1
    s_mov_b32 s42, 39936
    buffer_load_dwordx4 a[240:243], v254, s[8:11], s42 offen offset:0 sc1
    buffer_load_dwordx4 a[244:247], v254, s[8:11], s42 offen offset:1024 sc1
    buffer_load_dwordx4 a[248:251], v254, s[8:11], s42 offen offset:2048 sc1
    s_mov_b32 s42, 43008
    buffer_load_dwordx4 a[252:255], v254, s[8:11], s42 offen offset:0 sc1
    buffer_load_dwordx4 v[240:243], v254, s[8:11], s42 offen offset:1024 sc1
    buffer_load_dwordx4 v[244:247], v254, s[8:11], s42 offen offset:2048 sc1
    s_waitcnt lgkmcnt(0)
    s_barrier
    ds_read_b128 v[228:231], v253 offset:1040
    ds_read_b128 v[232:235], v253 offset:768
    ds_read_b128 v[236:239], v253 offset:512
    s_waitcnt vmcnt(9) lgkmcnt(0)
    s_branch blk_loop
.p2align 12
blk_loop:
sub0:
    v_mfma_f32_16x16x32_bf16 a[0:3], a[192:195], v[228:231], 0
pad0:
    s_cbranch_vccnz pad4
    s_add_u32 s44, s41, 10240
    s_waitcnt vmcnt(23)
    v_lshlrev_b32 v248, 16, v194
    v_mfma_f32_16x16x32_bf16 a[4:7], a[196:199], v[228:231], 0
    v_cvt_pk_bf16_f32 v180, v180, v181
    v_cvt_pk_bf16_f32 v181, v182, v183
    v_mfma_f32_16x16x32_bf16 a[8:11], a[200:203], v[228:231], 0
    ds_read_b128 v[228:231], v253 offset:256
    v_cvt_pk_bf16_f32 v182, v184, v185
    v_mfma_f32_16x16x32_bf16 a[8:11], a[212:215], v[232:235], a[8:11]
    s_waitcnt lgkmcnt(1)
    buffer_store_dwordx4 v[124:127], v254, s[12:15], s44 offen nt
    v_cvt_pk_bf16_f32 v183, v186, v187
    v_lshlrev_b32 v249, 16, v196
    v_mfma_f32_16x16x32_bf16 a[4:7], a[208:211], v[232:235], a[4:7]
    ds_write_b128 v4, v[180:183] offset:19328
    v_mfma_f32_16x16x32_bf16 a[0:3], a[204:207], v[232:235], a[0:3]
    v_lshlrev_b32 v250, 16, v198
    v_lshlrev_b32 v251, 16, v200
    v_mfma_f32_16x16x32_bf16 a[0:3], a[216:219], v[236:239], a[0:3]
    v_and_b32 v194, s22, v194
    v_and_b32 v196, s22, v196
    v_and_b32 v198, s22, v198
    v_mfma_f32_16x16x32_bf16 a[4:7], a[220:223], v[236:239], a[4:7]
    v_cvt_pk_bf16_f32 v188, v188, v189
    v_cvt_pk_bf16_f32 v189, v190, v191
    v_mfma_f32_16x16x32_bf16 a[8:11], a[224:227], v[236:239], a[8:11]
    ds_write_b64 v5, v[188:189] offset:19392
    v_mfma_f32_16x16x32_bf16 a[12:15], a[192:195], v[232:235], 0
    v_and_b32 v200, s22, v200
    v_lshlrev_b32 v252, 16, v192
    v_mfma_f32_16x16x32_bf16 a[12:15], a[204:207], v[236:239], a[12:15]
    s_waitcnt lgkmcnt(2)
    v_and_b32 v192, s22, v192
    v_fmac_f32 v252, s25, v251
    v_mfma_f32_16x16x32_bf16 a[12:15], a[216:219], v[228:231], a[12:15]
    v_fmac_f32 v192, s25, v200
    v_fmac_f32 v252, s28, v249
    v_mfma_f32_16x16x32_bf16 a[16:19], a[220:223], v[228:231], 0
    v_fmac_f32 v192, s28, v196
    v_cvt_pk_bf16_f32 v192, v252, v192
    v_mfma_f32_16x16x32_bf16 a[16:19], a[208:211], v[236:239], a[16:19]
    v_lshlrev_b32 v252, 16, v202
    v_and_b32 v202, s22, v202
    v_fmac_f32 v252, s29, v248
    v_mfma_f32_16x16x32_bf16 a[16:19], a[196:199], v[232:235], a[16:19]
    v_fmac_f32 v202, s29, v194
    v_fmac_f32 v252, s23, v250
    v_mfma_f32_16x16x32_bf16 a[20:23], a[200:203], v[232:235], 0
    ds_read_b128 v[232:235], v253 offset:0
    v_fmac_f32 v202, s23, v198
    v_mfma_f32_16x16x32_bf16 a[20:23], a[212:215], v[236:239], a[20:23]
    s_waitcnt lgkmcnt(0)
    v_cvt_pk_bf16_f32 v202, v252, v202
    v_fma_f32 v252, v249, s24, v251
    v_mfma_f32_16x16x32_bf16 a[20:23], a[224:227], v[228:231], a[20:23]
    s_barrier
    v_mfma_f32_16x16x32_bf16 a[24:27], a[192:195], v[236:239], 0
    ds_read_b128 v[128:131], v6 offset:18688
    v_fmac_f32 v251, -4.0, v249
    v_mfma_f32_16x16x32_bf16 a[24:27], a[204:207], v[228:231], a[24:27]
    v_fma_f32 v249, v248, s24, v250
    v_fmac_f32 v250, -4.0, v248
    v_fma_f32 v248, v250, s26, v251
    v_mfma_f32_16x16x32_bf16 a[24:27], a[216:219], v[232:235], a[24:27]
    v_fmac_f32 v251, s27, v250
    v_fma_f32 v250, v249, 2.0, v252
    v_mfma_f32_16x16x32_bf16 a[28:31], a[220:223], v[232:235], 0
    v_fmac_f32 v252, -2.0, v249
    v_fma_f32 v249, v196, s24, v200
    v_mfma_f32_16x16x32_bf16 a[28:31], a[208:211], v[228:231], a[28:31]
    v_fmac_f32 v200, -4.0, v196
    v_fma_f32 v196, v194, s24, v198
    v_mfma_f32_16x16x32_bf16 a[28:31], a[196:199], v[236:239], a[28:31]
    s_add_u32 s44, s41, 2048
    v_fmac_f32 v198, -4.0, v194
    v_fma_f32 v194, v198, s26, v200
    v_mfma_f32_16x16x32_bf16 a[32:35], a[200:203], v[236:239], 0
    ds_read_b128 v[236:239], v253 offset:1824
    v_fmac_f32 v200, s27, v198
    v_mfma_f32_16x16x32_bf16 a[32:35], a[212:215], v[228:231], a[32:35]
    v_fma_f32 v198, v196, 2.0, v249
    v_fmac_f32 v249, -2.0, v196
    v_mfma_f32_16x16x32_bf16 a[32:35], a[224:227], v[232:235], a[32:35]
    v_cvt_pk_bf16_f32 v194, v248, v194
    v_cvt_pk_bf16_f32 v200, v251, v200
    v_cvt_pk_bf16_f32 v198, v250, v198
    v_mfma_f32_16x16x32_bf16 a[36:39], a[192:195], v[228:231], 0
    v_and_b32 v227, 0x7fff, v255
    v_cvt_pk_bf16_f32 v196, v252, v249
    v_mfma_f32_16x16x32_bf16 a[36:39], a[204:207], v[232:235], a[36:39]
    s_waitcnt lgkmcnt(0)
    v_lshlrev_b32 v248, 16, v195
    v_lshlrev_b32 v249, 16, v197
    v_mfma_f32_16x16x32_bf16 a[36:39], a[216:219], v[236:239], a[36:39]
    buffer_load_dwordx2 v[216:217], v227, s[4:7], s16 offen offset:832
    v_mfma_f32_16x16x32_bf16 a[40:43], a[220:223], v[236:239], 0
    ds_read_b128 v[132:135], v6 offset:21792
    v_mfma_f32_16x16x32_bf16 a[40:43], a[208:211], v[232:235], a[40:43]
    v_lshlrev_b32 v250, 16, v199
    v_lshlrev_b32 v251, 16, v201
    v_mfma_f32_16x16x32_bf16 a[40:43], a[196:199], v[228:231], a[40:43]
    v_and_b32 v195, s22, v195
    v_and_b32 v197, s22, v197
    v_mfma_f32_16x16x32_bf16 a[44:47], a[200:203], v[228:231], 0
    ds_read_b128 v[228:231], v253 offset:1568
    v_and_b32 v199, s22, v199
    v_and_b32 v201, s22, v201
    v_mfma_f32_16x16x32_bf16 a[44:47], a[212:215], v[232:235], a[44:47]
    buffer_load_dwordx2 v[218:219], v227, s[4:7], s17 offen offset:832
    v_mfma_f32_16x16x32_bf16 a[44:47], a[224:227], v[236:239], a[44:47]
    v_lshlrev_b32 v252, 16, v193
    v_and_b32 v193, s22, v193
    v_mfma_f32_16x16x32_bf16 a[48:51], a[192:195], v[232:235], 0
    v_fmac_f32 v252, s25, v251
    v_fmac_f32 v193, s25, v201
    v_mfma_f32_16x16x32_bf16 a[48:51], a[204:207], v[236:239], a[48:51]
    s_waitcnt lgkmcnt(0)
    v_fmac_f32 v252, s28, v249
    v_fmac_f32 v193, s28, v197
    v_mfma_f32_16x16x32_bf16 a[48:51], a[216:219], v[228:231], a[48:51]
    buffer_load_dwordx2 v[220:221], v227, s[4:7], s18 offen offset:832
    v_mfma_f32_16x16x32_bf16 a[52:55], a[220:223], v[228:231], 0
    ds_read_b128 v[136:139], v6 offset:24896
    v_cvt_pk_bf16_f32 v193, v252, v193
    v_lshlrev_b32 v252, 16, v203
    v_mfma_f32_16x16x32_bf16 a[52:55], a[208:211], v[236:239], a[52:55]
    v_and_b32 v203, s22, v203
    v_fmac_f32 v252, s29, v248
    v_mfma_f32_16x16x32_bf16 a[52:55], a[196:199], v[232:235], a[52:55]
    v_fmac_f32 v203, s29, v195
    v_fmac_f32 v252, s23, v250
    v_mfma_f32_16x16x32_bf16 a[56:59], a[200:203], v[232:235], 0
    ds_read_b128 v[232:235], v253 offset:1312
    v_fmac_f32 v203, s23, v199
    v_mfma_f32_16x16x32_bf16 a[56:59], a[212:215], v[236:239], a[56:59]
    buffer_load_dwordx2 v[222:223], v227, s[4:7], s19 offen offset:832
    v_mfma_f32_16x16x32_bf16 a[56:59], a[224:227], v[228:231], a[56:59]
    v_cvt_pk_bf16_f32 v203, v252, v203
    v_fma_f32 v252, v249, s24, v251
    v_mfma_f32_16x16x32_bf16 a[60:63], a[192:195], v[236:239], 0
    v_fmac_f32 v251, -4.0, v249
    v_fma_f32 v249, v248, s24, v250
    v_mfma_f32_16x16x32_bf16 a[60:63], a[204:207], v[228:231], a[60:63]
    s_waitcnt lgkmcnt(0)
    v_fmac_f32 v250, -4.0, v248
    v_fma_f32 v248, v250, s26, v251
    v_fmac_f32 v251, s27, v250
    v_mfma_f32_16x16x32_bf16 a[60:63], a[216:219], v[232:235], a[60:63]
    buffer_load_dwordx2 v[224:225], v227, s[4:7], s20 offen offset:832
    v_mfma_f32_16x16x32_bf16 a[64:67], a[220:223], v[232:235], 0
    v_fma_f32 v250, v249, 2.0, v252
    v_fmac_f32 v252, -2.0, v249
    v_mfma_f32_16x16x32_bf16 a[64:67], a[208:211], v[228:231], a[64:67]
    ds_read_b128 v[140:143], v6 offset:28000
    v_fma_f32 v249, v197, s24, v201
    v_mfma_f32_16x16x32_bf16 a[64:67], a[196:199], v[236:239], a[64:67]
    v_fmac_f32 v201, -4.0, v197
    v_fma_f32 v197, v195, s24, v199
    v_mfma_f32_16x16x32_bf16 a[68:71], a[200:203], v[236:239], 0
    ds_read_b128 v[236:239], v253 offset:1056
    v_fmac_f32 v199, -4.0, v195
    v_mfma_f32_16x16x32_bf16 a[68:71], a[212:215], v[228:231], a[68:71]
    buffer_load_dwordx2 v[226:227], v227, s[4:7], s21 offen offset:832
    v_mfma_f32_16x16x32_bf16 a[68:71], a[224:227], v[232:235], a[68:71]
    v_fma_f32 v195, v199, s26, v201
    v_fmac_f32 v201, s27, v199
    v_fma_f32 v199, v197, 2.0, v249
    v_mfma_f32_16x16x32_bf16 a[72:75], a[192:195], v[228:231], 0
    buffer_store_dwordx4 v[128:131], v254, s[12:15], s44 offen nt
    s_add_u32 s44, s41, 5120
    v_mfma_f32_16x16x32_bf16 a[72:75], a[204:207], v[232:235], a[72:75]
    s_waitcnt lgkmcnt(0)
    v_fmac_f32 v249, -2.0, v197
    v_cvt_pk_bf16_f32 v195, v248, v195
    v_mfma_f32_16x16x32_bf16 a[72:75], a[216:219], v[236:239], a[72:75]
    v_cvt_pk_bf16_f32 v201, v251, v201
    v_cvt_pk_bf16_f32 v199, v250, v199
    v_mfma_f32_16x16x32_bf16 a[76:79], a[220:223], v[236:239], 0
    buffer_store_dwordx4 v[132:135], v254, s[12:15], s44 offen nt
    v_cvt_pk_bf16_f32 v197, v252, v249
    v_lshrrev_b32 v252, 15, v255
    v_mfma_f32_16x16x32_bf16 a[76:79], a[208:211], v[232:235], a[76:79]
    ds_write_b64 v252, v[194:195] offset:9088
    v_mfma_f32_16x16x32_bf16 a[76:79], a[196:199], v[228:231], a[76:79]
    s_waitcnt vmcnt(9)
    v_lshrrev_b32 v194, 15, v255
    v_lshlrev_b32 v248, 16, v206
    v_lshlrev_b32 v249, 16, v208
    v_mfma_f32_16x16x32_bf16 a[80:83], a[200:203], v[228:231], 0
    ds_read_b128 v[228:231], v253 offset:784
    v_lshlrev_b32 v250, 16, v210
    v_mfma_f32_16x16x32_bf16 a[80:83], a[212:215], v[232:235], a[80:83]
    ds_write_b64 v194, v[200:201] offset:11168
    v_mfma_f32_16x16x32_bf16 a[80:83], a[224:227], v[236:239], a[80:83]
    s_mov_b32 s42, 73728
    s_add_u32 s44, s41, 8192
    v_lshlrev_b32 v251, 16, v212
    v_mfma_f32_16x16x32_bf16 a[84:87], a[192:195], v[232:235], 0
    ds_write_b64 v194, v[198:199] offset:13248
    v_mfma_f32_16x16x32_bf16 a[88:91], a[196:199], v[232:235], 0
    v_and_b32 v206, s22, v206
    v_and_b32 v208, s22, v208
    v_mfma_f32_16x16x32_bf16 a[92:95], a[200:203], v[232:235], 0
    ds_read_b128 v[232:235], v253 offset:3120
    v_and_b32 v210, s22, v210
    v_mfma_f32_16x16x32_bf16 a[92:95], a[212:215], v[236:239], a[92:95]
    buffer_load_dwordx4 a[192:195], v254, s[8:11], s42 offen offset:0 sc1
    v_and_b32 v212, s22, v212
    v_mfma_f32_16x16x32_bf16 a[88:91], a[208:211], v[236:239], a[88:91]
    s_waitcnt lgkmcnt(3)
    v_lshlrev_b32 v252, 16, v204
    v_and_b32 v204, s22, v204
    v_mfma_f32_16x16x32_bf16 a[84:87], a[204:207], v[236:239], a[84:87]
    ds_read_b128 v[236:239], v253 offset:2848
    v_mfma_f32_16x16x32_bf16 a[84:87], a[216:219], v[228:231], a[84:87]
    buffer_load_dwordx4 a[196:199], v254, s[8:11], s42 offen offset:1024 sc1
    v_mfma_f32_16x16x32_bf16 a[88:91], a[220:223], v[228:231], a[88:91]
    s_waitcnt vmcnt(11) lgkmcnt(1)
    v_fmac_f32 v252, s25, v251
    v_fmac_f32 v204, s25, v212
    v_mfma_f32_16x16x32_bf16 a[92:95], a[224:227], v[228:231], a[92:95]
    ds_read_b128 v[228:231], v253 offset:2592
    v_fmac_f32 v252, s28, v249
sub1:
    v_mfma_f32_16x16x32_bf16 a[96:99], a[228:231], v[232:235], 0
    buffer_load_dwordx4 a[200:203], v254, s[8:11], s42 offen offset:2048 sc1
    v_mfma_f32_16x16x32_bf16 a[100:103], a[232:235], v[232:235], 0
    s_mov_b32 s42, 76800
    v_fmac_f32 v204, s28, v208
    v_cvt_pk_bf16_f32 v204, v252, v204
    v_lshlrev_b32 v252, 16, v214
    v_mfma_f32_16x16x32_bf16 a[104:107], a[236:239], v[232:235], 0
    ds_read_b128 v[232:235], v253 offset:2336
    s_waitcnt vmcnt(12)
    s_waitcnt lgkmcnt(2)
    v_mfma_f32_16x16x32_bf16 a[104:107], a[248:251], v[236:239], a[104:107]
    ds_write_b64 v194, v[192:193] offset:15328
    v_mfma_f32_16x16x32_bf16 a[100:103], a[244:247], v[236:239], a[100:103]
    buffer_load_dwordx4 a[204:207], v254, s[8:11], s42 offen offset:0 sc1
    v_mfma_f32_16x16x32_bf16 a[96:99], a[240:243], v[236:239], a[96:99]
    s_waitcnt vmcnt(13) lgkmcnt(2)
    v_and_b32 v214, s22, v214
    v_fmac_f32 v252, s29, v248
    v_mfma_f32_16x16x32_bf16 a[96:99], a[252:255], v[228:231], a[96:99]
    buffer_store_dwordx4 v[136:139], v254, s[12:15], s44 offen nt
    v_fmac_f32 v214, s29, v206
    v_fmac_f32 v252, s23, v250
    v_mfma_f32_16x16x32_bf16 a[100:103], v[240:243], v[228:231], a[100:103]
    ds_write_b64 v194, v[202:203] offset:38208
    v_fmac_f32 v214, s23, v210
    v_mfma_f32_16x16x32_bf16 a[104:107], v[244:247], v[228:231], a[104:107]
    buffer_load_dwordx4 a[208:211], v254, s[8:11], s42 offen offset:1024 sc1
    v_mfma_f32_16x16x32_bf16 a[108:111], a[228:231], v[236:239], 0
    s_add_u32 s44, s41, 11264
    v_cvt_pk_bf16_f32 v214, v252, v214
    v_fma_f32 v252, v249, s24, v251
    v_mfma_f32_16x16x32_bf16 a[108:111], a[240:243], v[228:231], a[108:111]
    s_waitcnt lgkmcnt(2)
    v_fmac_f32 v251, -4.0, v249
    v_fma_f32 v249, v248, s24, v250
    v_mfma_f32_16x16x32_bf16 a[108:111], a[252:255], v[232:235], a[108:111]
    ds_write_b64 v194, v[196:197] offset:31968
    v_mfma_f32_16x16x32_bf16 a[112:115], v[240:243], v[232:235], 0
    buffer_load_dwordx4 a[212:215], v254, s[8:11], s42 offen offset:2048 sc1
    v_mfma_f32_16x16x32_bf16 a[112:115], a[244:247], v[228:231], a[112:115]
    s_mov_b32 s42, 79872
    v_fmac_f32 v250, -4.0, v248
    v_fma_f32 v248, v250, s26, v251
    v_mfma_f32_16x16x32_bf16 a[112:115], a[232:235], v[236:239], a[112:115]
    v_fmac_f32 v251, s27, v250
    v_fma_f32 v250, v249, 2.0, v252
    v_fmac_f32 v252, -2.0, v249
    v_mfma_f32_16x16x32_bf16 a[116:119], a[236:239], v[236:239], 0
    ds_read_b128 v[236:239], v253 offset:2080
    v_fma_f32 v249, v208, s24, v212
    v_mfma_f32_16x16x32_bf16 a[116:119], a[248:251], v[228:231], a[116:119]
    buffer_load_dwordx4 a[216:219], v254, s[8:11], s42 offen offset:0 sc1
    v_mfma_f32_16x16x32_bf16 a[116:119], v[244:247], v[232:235], a[116:119]
    v_fmac_f32 v212, -4.0, v208
    v_fma_f32 v208, v206, s24, v210
    v_mfma_f32_16x16x32_bf16 a[120:123], a[228:231], v[228:231], 0
    v_fmac_f32 v210, -4.0, v206
    v_fma_f32 v206, v210, s26, v212
    v_mfma_f32_16x16x32_bf16 a[120:123], a[240:243], v[232:235], a[120:123]
    s_waitcnt lgkmcnt(0)
    v_fmac_f32 v212, s27, v210
    v_fma_f32 v210, v208, 2.0, v249
    v_mfma_f32_16x16x32_bf16 a[120:123], a[252:255], v[236:239], a[120:123]
    v_fmac_f32 v249, -2.0, v208
    v_cvt_pk_bf16_f32 v206, v248, v206
    v_mfma_f32_16x16x32_bf16 a[124:127], v[240:243], v[236:239], 0
    buffer_load_dwordx4 a[220:223], v254, s[8:11], s42 offen offset:1024 sc1
    v_cvt_pk_bf16_f32 v212, v251, v212
    v_mfma_f32_16x16x32_bf16 a[124:127], a[244:247], v[232:235], a[124:127]
    v_cvt_pk_bf16_f32 v210, v250, v210
    v_cvt_pk_bf16_f32 v208, v252, v249
    v_mfma_f32_16x16x32_bf16 a[124:127], a[232:235], v[228:231], a[124:127]
    v_lshlrev_b32 v248, 16, v207
    v_lshlrev_b32 v249, 16, v209
    v_mfma_f32_16x16x32_bf16 a[128:131], a[236:239], v[228:231], 0
    ds_read_b128 v[228:231], v253 offset:3904
    v_lshlrev_b32 v250, 16, v211
    v_mfma_f32_16x16x32_bf16 a[128:131], a[248:251], v[232:235], a[128:131]
    buffer_load_dwordx4 a[224:227], v254, s[8:11], s42 offen offset:2048 sc1
    v_mfma_f32_16x16x32_bf16 a[128:131], v[244:247], v[236:239], a[128:131]
    v_lshlrev_b32 v251, 16, v213
    v_and_b32 v207, s22, v207
    v_mfma_f32_16x16x32_bf16 a[132:135], a[228:231], v[232:235], 0
    buffer_store_dwordx4 v[140:143], v254, s[12:15], s44 offen nt
    v_and_b32 v203, 0x7fff, v255
    v_and_b32 v209, s22, v209
    v_and_b32 v211, s22, v211
    v_mfma_f32_16x16x32_bf16 a[132:135], a[240:243], v[236:239], a[132:135]
    s_waitcnt lgkmcnt(0)
    v_and_b32 v213, s22, v213
    v_lshlrev_b32 v252, 16, v205
    v_mfma_f32_16x16x32_bf16 a[132:135], a[252:255], v[228:231], a[132:135]
    buffer_load_dwordx2 v[192:193], v203, s[4:7], s16 offen offset:1216
    v_mfma_f32_16x16x32_bf16 a[136:139], v[240:243], v[228:231], 0
    v_and_b32 v205, s22, v205
    v_fmac_f32 v252, s25, v251
    v_mfma_f32_16x16x32_bf16 a[136:139], a[244:247], v[236:239], a[136:139]
    v_fmac_f32 v205, s25, v213
    v_fmac_f32 v252, s28, v249
    v_mfma_f32_16x16x32_bf16 a[136:139], a[232:235], v[232:235], a[136:139]
    v_fmac_f32 v205, s28, v209
    v_cvt_pk_bf16_f32 v205, v252, v205
    v_mfma_f32_16x16x32_bf16 a[140:143], a[236:239], v[232:235], 0
    ds_read_b128 v[232:235], v253 offset:3648
    v_lshlrev_b32 v252, 16, v215
    v_mfma_f32_16x16x32_bf16 a[140:143], a[248:251], v[236:239], a[140:143]
    buffer_load_dwordx2 v[194:195], v203, s[4:7], s17 offen offset:1216
    v_and_b32 v215, s22, v215
    v_mfma_f32_16x16x32_bf16 a[140:143], v[244:247], v[228:231], a[140:143]
    v_fmac_f32 v252, s29, v248
    v_fmac_f32 v215, s29, v207
    v_mfma_f32_16x16x32_bf16 a[144:147], a[228:231], v[236:239], 0
    v_fmac_f32 v252, s23, v250
    v_fmac_f32 v215, s23, v211
    v_mfma_f32_16x16x32_bf16 a[144:147], a[240:243], v[228:231], a[144:147]
    s_waitcnt lgkmcnt(0)
    v_cvt_pk_bf16_f32 v215, v252, v215
    v_fma_f32 v252, v249, s24, v251
    v_mfma_f32_16x16x32_bf16 a[144:147], a[252:255], v[232:235], a[144:147]
    buffer_load_dwordx2 v[196:197], v203, s[4:7], s18 offen offset:1216
    v_mfma_f32_16x16x32_bf16 a[148:151], v[240:243], v[232:235], 0
    v_fmac_f32 v251, -4.0, v249
    v_fma_f32 v249, v248, s24, v250
    v_mfma_f32_16x16x32_bf16 a[148:151], a[244:247], v[228:231], a[148:151]
    v_fmac_f32 v250, -4.0, v248
    v_fma_f32 v248, v250, s26, v251
    v_mfma_f32_16x16x32_bf16 a[148:151], a[232:235], v[236:239], a[148:151]
    v_fmac_f32 v251, s27, v250
    v_fma_f32 v250, v249, 2.0, v252
    v_fmac_f32 v252, -2.0, v249
    v_mfma_f32_16x16x32_bf16 a[152:155], a[236:239], v[236:239], 0
    ds_read_b128 v[236:239], v253 offset:3392
    v_fma_f32 v249, v209, s24, v213
    v_mfma_f32_16x16x32_bf16 a[152:155], a[248:251], v[228:231], a[152:155]
    buffer_load_dwordx2 v[198:199], v203, s[4:7], s19 offen offset:1216
    v_mfma_f32_16x16x32_bf16 a[152:155], v[244:247], v[232:235], a[152:155]
    v_fmac_f32 v213, -4.0, v209
    v_fma_f32 v209, v207, s24, v211
    v_mfma_f32_16x16x32_bf16 a[156:159], a[228:231], v[228:231], 0
    v_fmac_f32 v211, -4.0, v207
    v_fma_f32 v207, v211, s26, v213
    v_mfma_f32_16x16x32_bf16 a[156:159], a[240:243], v[232:235], a[156:159]
    s_waitcnt lgkmcnt(0)
    v_fmac_f32 v213, s27, v211
    v_fma_f32 v211, v209, 2.0, v249
    v_mfma_f32_16x16x32_bf16 a[156:159], a[252:255], v[236:239], a[156:159]
    buffer_load_dwordx2 v[200:201], v203, s[4:7], s20 offen offset:1216
    v_fmac_f32 v249, -2.0, v209
    v_mfma_f32_16x16x32_bf16 a[160:163], v[240:243], v[236:239], 0
    v_cvt_pk_bf16_f32 v207, v248, v207
    v_cvt_pk_bf16_f32 v213, v251, v213
    v_mfma_f32_16x16x32_bf16 a[160:163], a[244:247], v[232:235], a[160:163]
    v_cvt_pk_bf16_f32 v211, v250, v211
    v_cvt_pk_bf16_f32 v209, v252, v249
    v_mfma_f32_16x16x32_bf16 a[160:163], a[232:235], v[228:231], a[160:163]
    v_lshrrev_b32 v252, 15, v255
    v_mfma_f32_16x16x32_bf16 a[164:167], a[236:239], v[228:231], 0
    ds_read_b128 v[228:231], v253 offset:3136
    v_mfma_f32_16x16x32_bf16 a[164:167], a[248:251], v[232:235], a[164:167]
    buffer_load_dwordx2 v[202:203], v203, s[4:7], s21 offen offset:1216
    v_mfma_f32_16x16x32_bf16 a[164:167], v[244:247], v[236:239], a[164:167]
    ds_write_b64 v252, v[206:207] offset:8832
    v_mfma_f32_16x16x32_bf16 a[168:171], a[228:231], v[232:235], 0
    s_waitcnt vmcnt(19)
    v_lshrrev_b32 v206, 15, v255
    v_lshlrev_b32 v248, 16, v218
    v_lshlrev_b32 v249, 16, v220
    v_mfma_f32_16x16x32_bf16 a[168:171], a[240:243], v[236:239], a[168:171]
    s_waitcnt lgkmcnt(1)
    v_lshlrev_b32 v250, 16, v222
    v_lshlrev_b32 v251, 16, v224
    v_mfma_f32_16x16x32_bf16 a[168:171], a[252:255], v[228:231], a[168:171]
    ds_write_b64 v206, v[212:213] offset:10912
    v_mfma_f32_16x16x32_bf16 a[172:175], v[240:243], v[228:231], 0
    v_and_b32 v218, s22, v218
    v_and_b32 v220, s22, v220
    v_mfma_f32_16x16x32_bf16 a[172:175], a[244:247], v[236:239], a[172:175]
    ds_write_b64 v206, v[210:211] offset:12992
    v_mfma_f32_16x16x32_bf16 a[172:175], a[232:235], v[232:235], a[172:175]
    v_and_b32 v222, s22, v222
    v_and_b32 v224, s22, v224
    v_mfma_f32_16x16x32_bf16 a[176:179], a[236:239], v[232:235], 0
    ds_read_b128 v[232:235], v253 offset:2864
    v_lshlrev_b32 v252, 16, v216
    v_mfma_f32_16x16x32_bf16 a[176:179], a[248:251], v[236:239], a[176:179]
    ds_write_b64 v206, v[204:205] offset:15072
    v_and_b32 v216, s22, v216
    v_mfma_f32_16x16x32_bf16 a[176:179], v[244:247], v[228:231], a[176:179]
    s_mov_b32 s42, 110592
    v_fmac_f32 v252, s25, v251
    v_fmac_f32 v216, s25, v224
    v_mfma_f32_16x16x32_bf16 a[180:183], a[228:231], v[236:239], 0
    ds_write_b64 v206, v[214:215] offset:37952
    v_mfma_f32_16x16x32_bf16 a[184:187], a[232:235], v[236:239], 0
    v_fmac_f32 v252, s28, v249
    v_fmac_f32 v216, s28, v220
    v_mfma_f32_16x16x32_bf16 a[188:191], a[236:239], v[236:239], 0
    ds_read_b128 v[236:239], v253 offset:5200
    v_cvt_pk_bf16_f32 v216, v252, v216
    v_mfma_f32_16x16x32_bf16 a[188:191], a[248:251], v[228:231], a[188:191]
    buffer_load_dwordx4 a[228:231], v254, s[8:11], s42 offen offset:0 sc1
    v_mfma_f32_16x16x32_bf16 a[184:187], a[244:247], v[228:231], a[184:187]
    s_waitcnt lgkmcnt(3)
    v_lshlrev_b32 v252, 16, v226
    v_and_b32 v226, s22, v226
    v_fmac_f32 v252, s29, v248
    v_mfma_f32_16x16x32_bf16 a[180:183], a[240:243], v[228:231], a[180:183]
    ds_read_b128 v[228:231], v253 offset:4928
    v_fmac_f32 v226, s29, v218
    v_mfma_f32_16x16x32_bf16 a[180:183], a[252:255], v[232:235], a[180:183]
    buffer_load_dwordx4 a[232:235], v254, s[8:11], s42 offen offset:1024 sc1
    v_mfma_f32_16x16x32_bf16 a[184:187], v[240:243], v[232:235], a[184:187]
    s_waitcnt vmcnt(16) lgkmcnt(1)
    v_fmac_f32 v252, s23, v250
    v_fmac_f32 v226, s23, v222
    v_mfma_f32_16x16x32_bf16 a[188:191], v[244:247], v[232:235], a[188:191]
    ds_read_b128 v[232:235], v253 offset:4672
    v_cvt_pk_bf16_f32 v226, v252, v226
sub2:
    v_mfma_f32_16x16x32_bf16 v[0:3], a[192:195], v[236:239], 0
    buffer_load_dwordx4 a[236:239], v254, s[8:11], s42 offen offset:2048 sc1
    v_mfma_f32_16x16x32_bf16 v[4:7], a[196:199], v[236:239], 0
    s_mov_b32 s42, 113664
    v_fma_f32 v252, v249, s24, v251
    v_fmac_f32 v251, -4.0, v249
    v_mfma_f32_16x16x32_bf16 v[8:11], a[200:203], v[236:239], 0
    ds_read_b128 v[236:239], v253 offset:4416
    s_waitcnt vmcnt(13)
    s_waitcnt lgkmcnt(2)
    v_mfma_f32_16x16x32_bf16 v[8:11], a[212:215], v[228:231], v[8:11]
    ds_write_b64 v206, v[208:209] offset:31712
    v_mfma_f32_16x16x32_bf16 v[4:7], a[208:211], v[228:231], v[4:7]
    buffer_load_dwordx4 a[240:243], v254, s[8:11], s42 offen offset:0 sc1
    v_mfma_f32_16x16x32_bf16 v[0:3], a[204:207], v[228:231], v[0:3]
    s_waitcnt vmcnt(11) lgkmcnt(2)
    v_fma_f32 v249, v248, s24, v250
    v_fmac_f32 v250, -4.0, v248
    v_mfma_f32_16x16x32_bf16 v[0:3], a[216:219], v[232:235], v[0:3]
    ds_read_b128 v[204:207], v253 offset:39712
    s_mov_b32 s45, 619910279
    v_mfma_f32_16x16x32_bf16 v[4:7], a[220:223], v[232:235], v[4:7]
    v_bfe_u32 v208, v254, 5, 3
    v_mul_u32_u24 v209, 5, v208
    v_mfma_f32_16x16x32_bf16 v[8:11], a[224:227], v[232:235], v[8:11]
    buffer_load_dwordx4 a[244:247], v254, s[8:11], s42 offen offset:1024 sc1
    v_mfma_f32_16x16x32_bf16 v[12:15], a[192:195], v[228:231], 0
    v_bfe_u32 v209, s45, v209, 5
    v_mul_u32_u24 v209, 65, v209
    v_fma_f32 v248, v250, s26, v251
    v_mfma_f32_16x16x32_bf16 v[12:15], a[204:207], v[232:235], v[12:15]
    s_waitcnt lgkmcnt(2)
    v_sub_u32 v209, v209, v208
    v_lshl_add_u32 v208, v209, 5, v253
    v_mfma_f32_16x16x32_bf16 v[12:15], a[216:219], v[236:239], v[12:15]
    s_waitcnt lgkmcnt(0)
    v_fmac_f32 v251, s27, v250
    v_fma_f32 v250, v249, 2.0, v252
    v_mfma_f32_16x16x32_bf16 v[16:19], a[220:223], v[236:239], 0
    buffer_load_dwordx4 a[248:251], v254, s[8:11], s42 offen offset:2048 sc1
    v_mfma_f32_16x16x32_bf16 v[16:19], a[208:211], v[232:235], v[16:19]
    s_mov_b32 s42, 116736
    v_fmac_f32 v252, -2.0, v249
    v_fma_f32 v249, v220, s24, v224
    v_mfma_f32_16x16x32_bf16 v[16:19], a[196:199], v[228:231], v[16:19]
    s_mov_b64 exec, s[46:47]
    ds_write_b128 v208, v[204:207] offset:1024
    s_mov_b64 exec, -1
    v_mfma_f32_16x16x32_bf16 v[20:23], a[200:203], v[228:231], 0
    ds_read_b128 v[228:231], v253 offset:4160
    v_fmac_f32 v224, -4.0, v220
    v_fma_f32 v220, v218, s24, v222
    v_mfma_f32_16x16x32_bf16 v[20:23], a[212:215], v[232:235], v[20:23]
    buffer_load_dwordx4 a[252:255], v254, s[8:11], s42 offen offset:0 sc1
    v_mfma_f32_16x16x32_bf16 v[20:23], a[224:227], v[236:239], v[20:23]
    v_fmac_f32 v222, -4.0, v218
    v_fma_f32 v218, v222, s26, v224
    v_mfma_f32_16x16x32_bf16 v[24:27], a[192:195], v[232:235], 0
    v_fmac_f32 v224, s27, v222
    v_fma_f32 v222, v220, 2.0, v249
    v_mfma_f32_16x16x32_bf16 v[24:27], a[204:207], v[236:239], v[24:27]
    s_waitcnt lgkmcnt(0)
    v_fmac_f32 v249, -2.0, v220
    v_cvt_pk_bf16_f32 v218, v248, v218
    v_mfma_f32_16x16x32_bf16 v[24:27], a[216:219], v[228:231], v[24:27]
    v_cvt_pk_bf16_f32 v224, v251, v224
    v_cvt_pk_bf16_f32 v222, v250, v222
    v_mfma_f32_16x16x32_bf16 v[28:31], a[220:223], v[228:231], 0
    buffer_load_dwordx4 v[240:243], v254, s[8:11], s42 offen offset:1024 sc1
    v_mfma_f32_16x16x32_bf16 v[28:31], a[208:211], v[236:239], v[28:31]
    v_cvt_pk_bf16_f32 v220, v252, v249
    v_lshlrev_b32 v248, 16, v219
    v_lshlrev_b32 v249, 16, v221
    v_mfma_f32_16x16x32_bf16 v[28:31], a[196:199], v[232:235], v[28:31]
    v_lshlrev_b32 v250, 16, v223
    v_lshlrev_b32 v251, 16, v225
    v_mfma_f32_16x16x32_bf16 v[32:35], a[200:203], v[232:235], 0
    ds_read_b128 v[232:235], v253 offset:5984
    v_and_b32 v219, s22, v219
    v_mfma_f32_16x16x32_bf16 v[32:35], a[212:215], v[236:239], v[32:35]
    buffer_load_dwordx4 v[244:247], v254, s[8:11], s42 offen offset:2048 sc1
    v_mfma_f32_16x16x32_bf16 v[32:35], a[224:227], v[228:231], v[32:35]
    v_and_b32 v221, s22, v221
    v_and_b32 v223, s22, v223
    v_mfma_f32_16x16x32_bf16 v[36:39], a[192:195], v[236:239], 0
    v_and_b32 v215, 0x7fff, v255
    v_and_b32 v225, s22, v225
    v_mfma_f32_16x16x32_bf16 v[36:39], a[204:207], v[228:231], v[36:39]
    s_waitcnt lgkmcnt(0)
    v_lshlrev_b32 v252, 16, v217
    v_and_b32 v217, s22, v217
    v_mfma_f32_16x16x32_bf16 v[36:39], a[216:219], v[232:235], v[36:39]
    buffer_load_dwordx2 v[204:205], v215, s[4:7], s16 offen offset:128
    v_fmac_f32 v252, s25, v251
    v_mfma_f32_16x16x32_bf16 v[40:43], a[220:223], v[232:235], 0
    v_fmac_f32 v217, s25, v225
    v_fmac_f32 v252, s28, v249
    v_mfma_f32_16x16x32_bf16 v[40:43], a[208:211], v[228:231], v[40:43]
    v_fmac_f32 v217, s28, v221
    v_cvt_pk_bf16_f32 v217, v252, v217
    v_mfma_f32_16x16x32_bf16 v[40:43], a[196:199], v[236:239], v[40:43]
    v_lshlrev_b32 v252, 16, v227
    v_and_b32 v227, s22, v227
    v_mfma_f32_16x16x32_bf16 v[44:47], a[200:203], v[236:239], 0
    ds_read_b128 v[236:239], v253 offset:5728
    v_fmac_f32 v252, s29, v248
    v_mfma_f32_16x16x32_bf16 v[44:47], a[212:215], v[228:231], v[44:47]
    buffer_load_dwordx2 v[206:207], v215, s[4:7], s17 offen offset:128
    v_mfma_f32_16x16x32_bf16 v[44:47], a[224:227], v[232:235], v[44:47]
    v_fmac_f32 v227, s29, v219
    v_fmac_f32 v252, s23, v250
    v_fmac_f32 v227, s23, v223
    v_mfma_f32_16x16x32_bf16 v[48:51], a[192:195], v[228:231], 0
    v_cvt_pk_bf16_f32 v227, v252, v227
    v_fma_f32 v252, v249, s24, v251
    v_mfma_f32_16x16x32_bf16 v[48:51], a[204:207], v[232:235], v[48:51]
    s_waitcnt lgkmcnt(0)
    v_fmac_f32 v251, -4.0, v249
    v_fma_f32 v249, v248, s24, v250
    v_mfma_f32_16x16x32_bf16 v[48:51], a[216:219], v[236:239], v[48:51]
    buffer_load_dwordx2 v[208:209], v215, s[4:7], s18 offen offset:128
    v_mfma_f32_16x16x32_bf16 v[52:55], a[220:223], v[236:239], 0
    v_fmac_f32 v250, -4.0, v248
    v_fma_f32 v248, v250, s26, v251
    v_mfma_f32_16x16x32_bf16 v[52:55], a[208:211], v[232:235], v[52:55]
    v_fmac_f32 v251, s27, v250
    v_fma_f32 v250, v249, 2.0, v252
    v_mfma_f32_16x16x32_bf16 v[52:55], a[196:199], v[228:231], v[52:55]
    v_fmac_f32 v252, -2.0, v249
    v_fma_f32 v249, v221, s24, v225
    v_mfma_f32_16x16x32_bf16 v[56:59], a[200:203], v[228:231], 0
    ds_read_b128 v[228:231], v253 offset:5472
    v_fmac_f32 v225, -4.0, v221
    v_fma_f32 v221, v219, s24, v223
    v_mfma_f32_16x16x32_bf16 v[56:59], a[212:215], v[232:235], v[56:59]
    buffer_load_dwordx2 v[210:211], v215, s[4:7], s19 offen offset:128
    v_mfma_f32_16x16x32_bf16 v[56:59], a[224:227], v[236:239], v[56:59]
    v_fmac_f32 v223, -4.0, v219
    v_fma_f32 v219, v223, s26, v225
    v_mfma_f32_16x16x32_bf16 v[60:63], a[192:195], v[232:235], 0
    v_fmac_f32 v225, s27, v223
    v_fma_f32 v223, v221, 2.0, v249
    v_mfma_f32_16x16x32_bf16 v[60:63], a[204:207], v[236:239], v[60:63]
    s_waitcnt lgkmcnt(0)
    v_fmac_f32 v249, -2.0, v221
    v_cvt_pk_bf16_f32 v219, v248, v219
    v_mfma_f32_16x16x32_bf16 v[60:63], a[216:219], v[228:231], v[60:63]
    buffer_load_dwordx2 v[212:213], v215, s[4:7], s20 offen offset:128
    v_mfma_f32_16x16x32_bf16 v[64:67], a[220:223], v[228:231], 0
    v_cvt_pk_bf16_f32 v225, v251, v225
    v_cvt_pk_bf16_f32 v223, v250, v223
    v_mfma_f32_16x16x32_bf16 v[64:67], a[208:211], v[236:239], v[64:67]
    v_cvt_pk_bf16_f32 v221, v252, v249
    v_lshrrev_b32 v252, 15, v255
    v_mfma_f32_16x16x32_bf16 v[64:67], a[196:199], v[232:235], v[64:67]
    ds_write_b64 v252, v[218:219] offset:8576
    v_mfma_f32_16x16x32_bf16 v[68:71], a[200:203], v[232:235], 0
    ds_read_b128 v[232:235], v253 offset:5216
    v_lshrrev_b32 v218, 15, v255
    v_mfma_f32_16x16x32_bf16 v[68:71], a[212:215], v[236:239], v[68:71]
    buffer_load_dwordx2 v[214:215], v215, s[4:7], s21 offen offset:128
    v_mfma_f32_16x16x32_bf16 v[68:71], a[224:227], v[228:231], v[68:71]
    ds_write_b64 v218, v[224:225] offset:10656
    v_mfma_f32_16x16x32_bf16 v[72:75], a[192:195], v[236:239], 0
    s_waitcnt vmcnt(15)
    v_lshlrev_b32 v248, 16, v194
    v_lshlrev_b32 v249, 16, v196
    v_mfma_f32_16x16x32_bf16 v[72:75], a[204:207], v[228:231], v[72:75]
    s_waitcnt lgkmcnt(1)
    v_lshlrev_b32 v250, 16, v198
    v_lshlrev_b32 v251, 16, v200
    v_and_b32 v194, s22, v194
    v_mfma_f32_16x16x32_bf16 v[72:75], a[216:219], v[232:235], v[72:75]
    ds_write_b64 v218, v[222:223] offset:12736
    v_mfma_f32_16x16x32_bf16 v[76:79], a[220:223], v[232:235], 0
    v_and_b32 v196, s22, v196
    v_and_b32 v198, s22, v198
    v_mfma_f32_16x16x32_bf16 v[76:79], a[208:211], v[228:231], v[76:79]
pad1:
    s_cbranch_vccnz pad5
    ds_write_b64 v218, v[216:217] offset:14816
    v_mfma_f32_16x16x32_bf16 v[76:79], a[196:199], v[236:239], v[76:79]
    v_and_b32 v200, s22, v200
    v_lshlrev_b32 v252, 16, v192
    v_mfma_f32_16x16x32_bf16 v[80:83], a[200:203], v[236:239], 0
    ds_read_b128 v[236:239], v253 offset:4944
    v_and_b32 v192, s22, v192
    v_mfma_f32_16x16x32_bf16 v[80:83], a[212:215], v[228:231], v[80:83]
    ds_write_b64 v218, v[226:227] offset:37696
    v_mfma_f32_16x16x32_bf16 v[80:83], a[224:227], v[232:235], v[80:83]
    s_mov_b32 s42, 147456
    v_fmac_f32 v252, s25, v251
    v_fmac_f32 v192, s25, v200
    v_fmac_f32 v252, s28, v249
    v_mfma_f32_16x16x32_bf16 v[84:87], a[192:195], v[228:231], 0
    ds_write_b64 v218, v[220:221] offset:31456
    v_mfma_f32_16x16x32_bf16 v[88:91], a[196:199], v[228:231], 0
    v_fmac_f32 v192, s28, v196
    v_cvt_pk_bf16_f32 v192, v252, v192
    v_mfma_f32_16x16x32_bf16 v[92:95], a[200:203], v[228:231], 0
    ds_read_b128 v[228:231], v253 offset:7280
    v_lshlrev_b32 v252, 16, v202
    v_mfma_f32_16x16x32_bf16 v[92:95], a[212:215], v[232:235], v[92:95]
    buffer_load_dwordx4 a[192:195], v254, s[8:11], s42 offen offset:0 sc1
    v_mfma_f32_16x16x32_bf16 v[88:91], a[208:211], v[232:235], v[88:91]
    s_waitcnt lgkmcnt(3)
    v_and_b32 v202, s22, v202
    v_fmac_f32 v252, s29, v248
    v_mfma_f32_16x16x32_bf16 v[84:87], a[204:207], v[232:235], v[84:87]
    ds_read_b128 v[232:235], v253 offset:7008
    v_fmac_f32 v202, s29, v194
    v_mfma_f32_16x16x32_bf16 v[84:87], a[216:219], v[236:239], v[84:87]
    buffer_load_dwordx4 a[196:199], v254, s[8:11], s42 offen offset:1024 sc1
    v_fmac_f32 v252, s23, v250
    v_mfma_f32_16x16x32_bf16 v[88:91], a[220:223], v[236:239], v[88:91]
    s_waitcnt vmcnt(14) lgkmcnt(1)
    v_fmac_f32 v202, s23, v198
    v_cvt_pk_bf16_f32 v202, v252, v202
    v_mfma_f32_16x16x32_bf16 v[92:95], a[224:227], v[236:239], v[92:95]
    ds_read_b128 v[236:239], v253 offset:6752
    v_fma_f32 v252, v249, s24, v251
sub3:
    v_mfma_f32_16x16x32_bf16 v[96:99], a[228:231], v[228:231], 0
    buffer_load_dwordx4 a[200:203], v254, s[8:11], s42 offen offset:2048 sc1
    v_mfma_f32_16x16x32_bf16 v[100:103], a[232:235], v[228:231], 0
    s_mov_b32 s42, 150528
    v_fmac_f32 v251, -4.0, v249
    v_fma_f32 v249, v248, s24, v250
    v_mfma_f32_16x16x32_bf16 v[104:107], a[236:239], v[228:231], 0
    ds_read_b128 v[228:231], v253 offset:6496
    s_waitcnt vmcnt(12)
    s_waitcnt lgkmcnt(2)
    v_mfma_f32_16x16x32_bf16 v[104:107], a[248:251], v[232:235], v[104:107]
    v_fmac_f32 v250, -4.0, v248
    v_fma_f32 v248, v250, s26, v251
    v_fmac_f32 v251, s27, v250
    v_mfma_f32_16x16x32_bf16 v[100:103], a[244:247], v[232:235], v[100:103]
    buffer_load_dwordx4 a[204:207], v254, s[8:11], s42 offen offset:0 sc1
    v_mfma_f32_16x16x32_bf16 v[96:99], a[240:243], v[232:235], v[96:99]
    s_waitcnt vmcnt(10) lgkmcnt(1)
    v_fma_f32 v250, v249, 2.0, v252
    v_fmac_f32 v252, -2.0, v249
    v_mfma_f32_16x16x32_bf16 v[96:99], a[252:255], v[236:239], v[96:99]
    v_fma_f32 v249, v196, s24, v200
    v_fmac_f32 v200, -4.0, v196
    v_mfma_f32_16x16x32_bf16 v[100:103], v[240:243], v[236:239], v[100:103]
    v_fma_f32 v196, v194, s24, v198
    v_fmac_f32 v198, -4.0, v194
    v_mfma_f32_16x16x32_bf16 v[104:107], v[244:247], v[236:239], v[104:107]
    buffer_load_dwordx4 a[208:211], v254, s[8:11], s42 offen offset:1024 sc1
    v_mfma_f32_16x16x32_bf16 v[108:111], a[228:231], v[232:235], 0
    v_fma_f32 v194, v198, s26, v200
    v_fmac_f32 v200, s27, v198
    v_mfma_f32_16x16x32_bf16 v[108:111], a[240:243], v[236:239], v[108:111]
    s_waitcnt lgkmcnt(0)
    v_fma_f32 v198, v196, 2.0, v249
    v_fmac_f32 v249, -2.0, v196
    v_cvt_pk_bf16_f32 v194, v248, v194
    v_mfma_f32_16x16x32_bf16 v[108:111], a[252:255], v[228:231], v[108:111]
    v_cvt_pk_bf16_f32 v200, v251, v200
    v_cvt_pk_bf16_f32 v198, v250, v198
    v_mfma_f32_16x16x32_bf16 v[112:115], v[240:243], v[228:231], 0
    buffer_load_dwordx4 a[212:215], v254, s[8:11], s42 offen offset:2048 sc1
    v_mfma_f32_16x16x32_bf16 v[112:115], a[244:247], v[236:239], v[112:115]
    s_mov_b32 s42, 153600
    v_cvt_pk_bf16_f32 v196, v252, v249
    v_lshlrev_b32 v248, 16, v195
    v_mfma_f32_16x16x32_bf16 v[112:115], a[232:235], v[232:235], v[112:115]
    v_lshlrev_b32 v249, 16, v197
    v_lshlrev_b32 v250, 16, v199
    v_mfma_f32_16x16x32_bf16 v[116:119], a[236:239], v[232:235], 0
    ds_read_b128 v[232:235], v253 offset:6240
    v_lshlrev_b32 v251, 16, v201
    v_mfma_f32_16x16x32_bf16 v[116:119], a[248:251], v[236:239], v[116:119]
    buffer_load_dwordx4 a[216:219], v254, s[8:11], s42 offen offset:0 sc1
    v_mfma_f32_16x16x32_bf16 v[116:119], v[244:247], v[228:231], v[116:119]
    v_and_b32 v195, s22, v195
    v_and_b32 v197, s22, v197
    v_and_b32 v199, s22, v199
    v_mfma_f32_16x16x32_bf16 v[120:123], a[228:231], v[236:239], 0
    v_and_b32 v201, s22, v201
    v_lshlrev_b32 v252, 16, v193
    v_mfma_f32_16x16x32_bf16 v[120:123], a[240:243], v[228:231], v[120:123]
    s_waitcnt lgkmcnt(0)
    v_and_b32 v193, s22, v193
    v_fmac_f32 v252, s25, v251
    v_mfma_f32_16x16x32_bf16 v[120:123], a[252:255], v[232:235], v[120:123]
    v_fmac_f32 v193, s25, v201
    v_fmac_f32 v252, s28, v249
    v_mfma_f32_16x16x32_bf16 v[124:127], v[240:243], v[232:235], 0
    buffer_load_dwordx4 a[220:223], v254, s[8:11], s42 offen offset:1024 sc1
    v_mfma_f32_16x16x32_bf16 v[124:127], a[244:247], v[228:231], v[124:127]
    v_fmac_f32 v193, s28, v197
    v_cvt_pk_bf16_f32 v193, v252, v193
    v_mfma_f32_16x16x32_bf16 v[124:127], a[232:235], v[236:239], v[124:127]
    v_lshlrev_b32 v252, 16, v203
    v_and_b32 v203, s22, v203
    v_fmac_f32 v252, s29, v248
    v_mfma_f32_16x16x32_bf16 v[128:131], a[236:239], v[236:239], 0
    ds_read_b128 v[236:239], v253 offset:8064
    v_fmac_f32 v203, s29, v195
    v_mfma_f32_16x16x32_bf16 v[128:131], a[248:251], v[228:231], v[128:131]
    buffer_load_dwordx4 a[224:227], v254, s[8:11], s42 offen offset:2048 sc1
    v_mfma_f32_16x16x32_bf16 v[128:131], v[244:247], v[232:235], v[128:131]
    v_fmac_f32 v252, s23, v250
    v_fmac_f32 v203, s23, v199
    v_mfma_f32_16x16x32_bf16 v[132:135], a[228:231], v[228:231], 0
    v_and_b32 v227, 0x7fff, v255
    v_cvt_pk_bf16_f32 v203, v252, v203
    v_mfma_f32_16x16x32_bf16 v[132:135], a[240:243], v[232:235], v[132:135]
    s_waitcnt lgkmcnt(0)
    v_fma_f32 v252, v249, s24, v251
    v_fmac_f32 v251, -4.0, v249
    v_mfma_f32_16x16x32_bf16 v[132:135], a[252:255], v[236:239], v[132:135]
    buffer_load_dwordx2 v[216:217], v227, s[4:7], s16 offen offset:512
    v_mfma_f32_16x16x32_bf16 v[136:139], v[240:243], v[236:239], 0
    v_fma_f32 v249, v248, s24, v250
    v_fmac_f32 v250, -4.0, v248
    v_fma_f32 v248, v250, s26, v251
    v_mfma_f32_16x16x32_bf16 v[136:139], a[244:247], v[232:235], v[136:139]
    v_fmac_f32 v251, s27, v250
    v_fma_f32 v250, v249, 2.0, v252
    v_mfma_f32_16x16x32_bf16 v[136:139], a[232:235], v[228:231], v[136:139]
    v_fmac_f32 v252, -2.0, v249
    v_fma_f32 v249, v197, s24, v201
    v_mfma_f32_16x16x32_bf16 v[140:143], a[236:239], v[228:231], 0
    ds_read_b128 v[228:231], v253 offset:7808
    v_fmac_f32 v201, -4.0, v197
    v_mfma_f32_16x16x32_bf16 v[140:143], a[248:251], v[232:235], v[140:143]
    buffer_load_dwordx2 v[218:219], v227, s[4:7], s17 offen offset:512
    v_mfma_f32_16x16x32_bf16 v[140:143], v[244:247], v[236:239], v[140:143]
    v_fma_f32 v197, v195, s24, v199
    v_fmac_f32 v199, -4.0, v195
    v_mfma_f32_16x16x32_bf16 v[144:147], a[228:231], v[232:235], 0
    v_fma_f32 v195, v199, s26, v201
    v_fmac_f32 v201, s27, v199
    v_mfma_f32_16x16x32_bf16 v[144:147], a[240:243], v[236:239], v[144:147]
    s_waitcnt lgkmcnt(0)
    v_fma_f32 v199, v197, 2.0, v249
    v_fmac_f32 v249, -2.0, v197
    v_cvt_pk_bf16_f32 v195, v248, v195
    v_mfma_f32_16x16x32_bf16 v[144:147], a[252:255], v[228:231], v[144:147]
    buffer_load_dwordx2 v[220:221], v227, s[4:7], s18 offen offset:512
    v_mfma_f32_16x16x32_bf16 v[148:151], v[240:243], v[228:231], 0
    v_cvt_pk_bf16_f32 v201, v251, v201
    v_cvt_pk_bf16_f32 v199, v250, v199
    v_mfma_f32_16x16x32_bf16 v[148:151], a[244:247], v[236:239], v[148:151]
    v_cvt_pk_bf16_f32 v197, v252, v249
    v_lshrrev_b32 v252, 15, v255
    v_mfma_f32_16x16x32_bf16 v[148:151], a[232:235], v[232:235], v[148:151]
    ds_write_b64 v252, v[194:195] offset:8320
    v_mfma_f32_16x16x32_bf16 v[152:155], a[236:239], v[232:235], 0
    ds_read_b128 v[232:235], v253 offset:7552
    v_lshrrev_b32 v194, 15, v255
    v_mfma_f32_16x16x32_bf16 v[152:155], a[248:251], v[236:239], v[152:155]
    buffer_load_dwordx2 v[222:223], v227, s[4:7], s19 offen offset:512
    v_mfma_f32_16x16x32_bf16 v[152:155], v[244:247], v[228:231], v[152:155]
    ds_write_b64 v194, v[200:201] offset:10400
    v_mfma_f32_16x16x32_bf16 v[156:159], a[228:231], v[236:239], 0
    v_mfma_f32_16x16x32_bf16 v[156:159], a[240:243], v[228:231], v[156:159]
    s_waitcnt lgkmcnt(1)
    s_waitcnt vmcnt(13)
    v_lshlrev_b32 v248, 16, v206
    v_mfma_f32_16x16x32_bf16 v[156:159], a[252:255], v[232:235], v[156:159]
    buffer_load_dwordx2 v[224:225], v227, s[4:7], s20 offen offset:512
    v_mfma_f32_16x16x32_bf16 v[160:163], v[240:243], v[232:235], 0
    ds_write_b64 v194, v[198:199] offset:12480
    v_mfma_f32_16x16x32_bf16 v[160:163], a[244:247], v[228:231], v[160:163]
    v_lshlrev_b32 v249, 16, v208
    v_lshlrev_b32 v250, 16, v210
    v_mfma_f32_16x16x32_bf16 v[160:163], a[232:235], v[236:239], v[160:163]
    ds_write_b64 v194, v[192:193] offset:14560
    v_mfma_f32_16x16x32_bf16 v[164:167], a[236:239], v[236:239], 0
    ds_read_b128 v[236:239], v253 offset:7296
    v_lshlrev_b32 v251, 16, v212
    v_mfma_f32_16x16x32_bf16 v[164:167], a[248:251], v[228:231], v[164:167]
    buffer_load_dwordx2 v[226:227], v227, s[4:7], s21 offen offset:512
    v_mfma_f32_16x16x32_bf16 v[164:167], v[244:247], v[232:235], v[164:167]
    ds_write_b64 v194, v[202:203] offset:37440
    v_mfma_f32_16x16x32_bf16 v[168:171], a[228:231], v[228:231], 0
    v_and_b32 v206, s22, v206
    v_and_b32 v208, s22, v208
    v_mfma_f32_16x16x32_bf16 v[168:171], a[240:243], v[232:235], v[168:171]
    s_waitcnt lgkmcnt(1)
    v_and_b32 v210, s22, v210
    v_and_b32 v212, s22, v212
    v_mfma_f32_16x16x32_bf16 v[168:171], a[252:255], v[236:239], v[168:171]
    ds_write_b64 v194, v[196:197] offset:31200
    v_mfma_f32_16x16x32_bf16 v[172:175], v[240:243], v[236:239], 0
    v_lshlrev_b32 v252, 16, v204
    v_and_b32 v204, s22, v204
    v_mfma_f32_16x16x32_bf16 v[172:175], a[244:247], v[232:235], v[172:175]
    v_fmac_f32 v252, s25, v251
    v_fmac_f32 v204, s25, v212
    v_mfma_f32_16x16x32_bf16 v[172:175], a[232:235], v[228:231], v[172:175]
    v_fmac_f32 v252, s28, v249
    v_fmac_f32 v204, s28, v208
    v_mfma_f32_16x16x32_bf16 v[176:179], a[236:239], v[228:231], 0
    ds_read_b128 v[228:231], v253 offset:7024
    v_cvt_pk_bf16_f32 v204, v252, v204
    v_mfma_f32_16x16x32_bf16 v[176:179], a[248:251], v[232:235], v[176:179]
    v_lshlrev_b32 v252, 16, v214
    v_and_b32 v214, s22, v214
    v_mfma_f32_16x16x32_bf16 v[176:179], v[244:247], v[236:239], v[176:179]
    s_mov_b32 s42, 184320
    v_fmac_f32 v252, s29, v248
    v_fmac_f32 v214, s29, v206
    v_mfma_f32_16x16x32_bf16 v[180:183], a[228:231], v[232:235], 0
    s_waitcnt lgkmcnt(0)
    v_fmac_f32 v252, s23, v250
    v_fmac_f32 v214, s23, v210
    v_cvt_pk_bf16_f32 v214, v252, v214
    v_mfma_f32_16x16x32_bf16 v[184:187], a[232:235], v[232:235], 0
    s_barrier
    v_mfma_f32_16x16x32_bf16 v[188:191], a[236:239], v[232:235], 0
    ds_read_b128 v[232:235], v253 offset:9360
    v_fma_f32 v252, v249, s24, v251
    v_mfma_f32_16x16x32_bf16 v[188:191], a[248:251], v[236:239], v[188:191]
    buffer_load_dwordx4 a[228:231], v254, s[8:11], s42 offen offset:0 sc1
    v_mfma_f32_16x16x32_bf16 v[184:187], a[244:247], v[236:239], v[184:187]
    v_fmac_f32 v251, -4.0, v249
    v_fma_f32 v249, v248, s24, v250
    v_mfma_f32_16x16x32_bf16 v[180:183], a[240:243], v[236:239], v[180:183]
    ds_read_b128 v[236:239], v253 offset:9088
    v_fmac_f32 v250, -4.0, v248
    v_mfma_f32_16x16x32_bf16 v[180:183], a[252:255], v[228:231], v[180:183]
    buffer_load_dwordx4 a[232:235], v254, s[8:11], s42 offen offset:1024 sc1
    v_mfma_f32_16x16x32_bf16 v[184:187], v[240:243], v[228:231], v[184:187]
    s_waitcnt vmcnt(14) lgkmcnt(1)
    v_fma_f32 v248, v250, s26, v251
    v_fmac_f32 v251, s27, v250
    v_mfma_f32_16x16x32_bf16 v[188:191], v[244:247], v[228:231], v[188:191]
    ds_read_b128 v[228:231], v253 offset:8832
    v_fma_f32 v250, v249, 2.0, v252
sub4:
    v_mfma_f32_16x16x32_bf16 a[0:3], a[192:195], v[232:235], a[0:3]
    buffer_load_dwordx4 a[236:239], v254, s[8:11], s42 offen offset:2048 sc1
    v_mfma_f32_16x16x32_bf16 a[4:7], a[196:199], v[232:235], a[4:7]
    s_mov_b32 s42, 187392
    v_fmac_f32 v252, -2.0, v249
    v_fma_f32 v249, v208, s24, v212
    v_mfma_f32_16x16x32_bf16 a[8:11], a[200:203], v[232:235], a[8:11]
    ds_read_b128 v[232:235], v253 offset:8576
    s_waitcnt vmcnt(12)
    s_waitcnt lgkmcnt(2)
    v_mfma_f32_16x16x32_bf16 a[8:11], a[212:215], v[236:239], a[8:11]
    v_fmac_f32 v212, -4.0, v208
    v_fma_f32 v208, v206, s24, v210
    v_mfma_f32_16x16x32_bf16 a[4:7], a[208:211], v[236:239], a[4:7]
    buffer_load_dwordx4 a[240:243], v254, s[8:11], s42 offen offset:0 sc1
    v_mfma_f32_16x16x32_bf16 a[0:3], a[204:207], v[236:239], a[0:3]
    s_waitcnt vmcnt(10) lgkmcnt(1)
    v_fmac_f32 v210, -4.0, v206
    v_fma_f32 v206, v210, s26, v212
    v_mfma_f32_16x16x32_bf16 a[0:3], a[216:219], v[228:231], a[0:3]
    v_fmac_f32 v212, s27, v210
    v_fma_f32 v210, v208, 2.0, v249
    v_mfma_f32_16x16x32_bf16 a[4:7], a[220:223], v[228:231], a[4:7]
    v_fmac_f32 v249, -2.0, v208
    v_cvt_pk_bf16_f32 v206, v248, v206
    v_mfma_f32_16x16x32_bf16 a[8:11], a[224:227], v[228:231], a[8:11]
    buffer_load_dwordx4 a[244:247], v254, s[8:11], s42 offen offset:1024 sc1
    v_mfma_f32_16x16x32_bf16 a[12:15], a[192:195], v[236:239], a[12:15]
    v_cvt_pk_bf16_f32 v212, v251, v212
    v_cvt_pk_bf16_f32 v210, v250, v210
    v_mfma_f32_16x16x32_bf16 a[12:15], a[204:207], v[228:231], a[12:15]
    s_waitcnt lgkmcnt(0)
    v_cvt_pk_bf16_f32 v208, v252, v249
    v_lshlrev_b32 v248, 16, v207
    v_mfma_f32_16x16x32_bf16 a[12:15], a[216:219], v[232:235], a[12:15]
    v_lshlrev_b32 v249, 16, v209
    v_lshlrev_b32 v250, 16, v211
    v_mfma_f32_16x16x32_bf16 a[16:19], a[220:223], v[232:235], a[16:19]
    buffer_load_dwordx4 a[248:251], v254, s[8:11], s42 offen offset:2048 sc1
    v_mfma_f32_16x16x32_bf16 a[16:19], a[208:211], v[228:231], a[16:19]
    s_mov_b32 s42, 190464
    v_lshlrev_b32 v251, 16, v213
    v_and_b32 v207, s22, v207
    v_mfma_f32_16x16x32_bf16 a[16:19], a[196:199], v[236:239], a[16:19]
    v_and_b32 v209, s22, v209
    v_and_b32 v211, s22, v211
    v_mfma_f32_16x16x32_bf16 a[20:23], a[200:203], v[236:239], a[20:23]
    ds_read_b128 v[236:239], v253 offset:8320
    v_and_b32 v213, s22, v213
    v_mfma_f32_16x16x32_bf16 a[20:23], a[212:215], v[228:231], a[20:23]
    buffer_load_dwordx4 a[252:255], v254, s[8:11], s42 offen offset:0 sc1
    v_mfma_f32_16x16x32_bf16 a[20:23], a[224:227], v[232:235], a[20:23]
    v_lshlrev_b32 v252, 16, v205
    v_and_b32 v205, s22, v205
    v_mfma_f32_16x16x32_bf16 a[24:27], a[192:195], v[228:231], a[24:27]
    v_fmac_f32 v252, s25, v251
    v_fmac_f32 v205, s25, v213
    v_mfma_f32_16x16x32_bf16 a[24:27], a[204:207], v[232:235], a[24:27]
    s_waitcnt lgkmcnt(0)
    v_fmac_f32 v252, s28, v249
    v_fmac_f32 v205, s28, v209
    v_mfma_f32_16x16x32_bf16 a[24:27], a[216:219], v[236:239], a[24:27]
    v_cvt_pk_bf16_f32 v205, v252, v205
    v_lshlrev_b32 v252, 16, v215
    v_mfma_f32_16x16x32_bf16 a[28:31], a[220:223], v[236:239], a[28:31]
    buffer_load_dwordx4 v[240:243], v254, s[8:11], s42 offen offset:1024 sc1
    v_mfma_f32_16x16x32_bf16 a[28:31], a[208:211], v[232:235], a[28:31]
    v_and_b32 v215, s22, v215
    v_fmac_f32 v252, s29, v248
    v_mfma_f32_16x16x32_bf16 a[28:31], a[196:199], v[228:231], a[28:31]
    v_fmac_f32 v215, s29, v207
    v_fmac_f32 v252, s23, v250
    v_mfma_f32_16x16x32_bf16 a[32:35], a[200:203], v[228:231], a[32:35]
    ds_read_b128 v[228:231], v253 offset:10144
    v_fmac_f32 v215, s23, v211
    v_mfma_f32_16x16x32_bf16 a[32:35], a[212:215], v[232:235], a[32:35]
    buffer_load_dwordx4 v[244:247], v254, s[8:11], s42 offen offset:2048 sc1
    v_mfma_f32_16x16x32_bf16 a[32:35], a[224:227], v[236:239], a[32:35]
    v_cvt_pk_bf16_f32 v215, v252, v215
    v_fma_f32 v252, v249, s24, v251
    v_mfma_f32_16x16x32_bf16 a[36:39], a[192:195], v[232:235], a[36:39]
    v_and_b32 v203, 0x7fff, v255
    v_fmac_f32 v251, -4.0, v249
    v_mfma_f32_16x16x32_bf16 a[36:39], a[204:207], v[236:239], a[36:39]
    s_waitcnt lgkmcnt(0)
    v_fma_f32 v249, v248, s24, v250
    v_fmac_f32 v250, -4.0, v248
    v_mfma_f32_16x16x32_bf16 a[36:39], a[216:219], v[228:231], a[36:39]
    buffer_load_dwordx2 v[192:193], v203, s[4:7], s16 offen offset:896
    v_mfma_f32_16x16x32_bf16 a[40:43], a[220:223], v[228:231], a[40:43]
    v_fma_f32 v248, v250, s26, v251
    v_fmac_f32 v251, s27, v250
    v_mfma_f32_16x16x32_bf16 a[40:43], a[208:211], v[236:239], a[40:43]
    v_fma_f32 v250, v249, 2.0, v252
    v_fmac_f32 v252, -2.0, v249
    v_fma_f32 v249, v209, s24, v213
    v_mfma_f32_16x16x32_bf16 a[40:43], a[196:199], v[232:235], a[40:43]
    v_fmac_f32 v213, -4.0, v209
    v_fma_f32 v209, v207, s24, v211
    v_mfma_f32_16x16x32_bf16 a[44:47], a[200:203], v[232:235], a[44:47]
    ds_read_b128 v[232:235], v253 offset:9888
    v_fmac_f32 v211, -4.0, v207
    v_mfma_f32_16x16x32_bf16 a[44:47], a[212:215], v[236:239], a[44:47]
    buffer_load_dwordx2 v[194:195], v203, s[4:7], s17 offen offset:896
    v_mfma_f32_16x16x32_bf16 a[44:47], a[224:227], v[228:231], a[44:47]
    v_fma_f32 v207, v211, s26, v213
    v_fmac_f32 v213, s27, v211
    v_mfma_f32_16x16x32_bf16 a[48:51], a[192:195], v[236:239], a[48:51]
    v_fma_f32 v211, v209, 2.0, v249
    v_fmac_f32 v249, -2.0, v209
    v_mfma_f32_16x16x32_bf16 a[48:51], a[204:207], v[228:231], a[48:51]
    s_waitcnt lgkmcnt(0)
    v_cvt_pk_bf16_f32 v207, v248, v207
    v_cvt_pk_bf16_f32 v213, v251, v213
    v_mfma_f32_16x16x32_bf16 a[48:51], a[216:219], v[232:235], a[48:51]
    buffer_load_dwordx2 v[196:197], v203, s[4:7], s18 offen offset:896
    v_mfma_f32_16x16x32_bf16 a[52:55], a[220:223], v[232:235], a[52:55]
    v_cvt_pk_bf16_f32 v211, v250, v211
    v_cvt_pk_bf16_f32 v209, v252, v249
    v_mfma_f32_16x16x32_bf16 a[52:55], a[208:211], v[228:231], a[52:55]
    v_lshrrev_b32 v252, 15, v255
    v_mfma_f32_16x16x32_bf16 a[52:55], a[196:199], v[236:239], a[52:55]
    ds_write_b64 v252, v[206:207] offset:768
    v_mfma_f32_16x16x32_bf16 a[56:59], a[200:203], v[236:239], a[56:59]
    ds_read_b128 v[236:239], v253 offset:9632
    v_lshrrev_b32 v206, 15, v255
    v_mfma_f32_16x16x32_bf16 a[56:59], a[212:215], v[228:231], a[56:59]
    buffer_load_dwordx2 v[198:199], v203, s[4:7], s19 offen offset:896
    v_mfma_f32_16x16x32_bf16 a[56:59], a[224:227], v[232:235], a[56:59]
    ds_write_b64 v206, v[212:213] offset:2848
    v_mfma_f32_16x16x32_bf16 a[60:63], a[192:195], v[228:231], a[60:63]
    v_mfma_f32_16x16x32_bf16 a[60:63], a[204:207], v[232:235], a[60:63]
    s_waitcnt lgkmcnt(1)
    s_waitcnt vmcnt(13)
    v_lshlrev_b32 v248, 16, v218
    v_mfma_f32_16x16x32_bf16 a[60:63], a[216:219], v[236:239], a[60:63]
    buffer_load_dwordx2 v[200:201], v203, s[4:7], s20 offen offset:896
    v_mfma_f32_16x16x32_bf16 a[64:67], a[220:223], v[236:239], a[64:67]
    ds_write_b64 v206, v[210:211] offset:4928
    v_mfma_f32_16x16x32_bf16 a[64:67], a[208:211], v[232:235], a[64:67]
    v_lshlrev_b32 v249, 16, v220
    v_lshlrev_b32 v250, 16, v222
    v_mfma_f32_16x16x32_bf16 a[64:67], a[196:199], v[228:231], a[64:67]
    ds_write_b64 v206, v[204:205] offset:17408
    v_mfma_f32_16x16x32_bf16 a[68:71], a[200:203], v[228:231], a[68:71]
    ds_read_b128 v[228:231], v253 offset:9376
    v_lshlrev_b32 v251, 16, v224
    v_mfma_f32_16x16x32_bf16 a[68:71], a[212:215], v[232:235], a[68:71]
    buffer_load_dwordx2 v[202:203], v203, s[4:7], s21 offen offset:896
    v_mfma_f32_16x16x32_bf16 a[68:71], a[224:227], v[236:239], a[68:71]
    ds_write_b64 v206, v[214:215] offset:25728
    v_mfma_f32_16x16x32_bf16 a[72:75], a[192:195], v[232:235], a[72:75]
    v_and_b32 v218, s22, v218
    v_and_b32 v220, s22, v220
    v_mfma_f32_16x16x32_bf16 a[72:75], a[204:207], v[236:239], a[72:75]
    s_waitcnt lgkmcnt(1)
    v_and_b32 v222, s22, v222
    v_and_b32 v224, s22, v224
    v_mfma_f32_16x16x32_bf16 a[72:75], a[216:219], v[228:231], a[72:75]
    ds_write_b64 v206, v[208:209] offset:7008
    v_mfma_f32_16x16x32_bf16 a[76:79], a[220:223], v[228:231], a[76:79]
    v_lshlrev_b32 v252, 16, v216
    v_and_b32 v216, s22, v216
    v_mfma_f32_16x16x32_bf16 a[76:79], a[208:211], v[236:239], a[76:79]
    v_fmac_f32 v252, s25, v251
    v_fmac_f32 v216, s25, v224
    v_mfma_f32_16x16x32_bf16 a[76:79], a[196:199], v[232:235], a[76:79]
    v_fmac_f32 v252, s28, v249
    v_fmac_f32 v216, s28, v220
    v_mfma_f32_16x16x32_bf16 a[80:83], a[200:203], v[232:235], a[80:83]
    ds_read_b128 v[232:235], v253 offset:9104
    v_cvt_pk_bf16_f32 v216, v252, v216
    v_mfma_f32_16x16x32_bf16 a[80:83], a[212:215], v[236:239], a[80:83]
    v_lshlrev_b32 v252, 16, v226
    v_and_b32 v226, s22, v226
    v_mfma_f32_16x16x32_bf16 a[80:83], a[224:227], v[228:231], a[80:83]
    s_mov_b32 s42, 221184
    v_fmac_f32 v252, s29, v248
    v_fmac_f32 v226, s29, v218
    v_mfma_f32_16x16x32_bf16 a[84:87], a[192:195], v[236:239], a[84:87]
    v_fmac_f32 v252, s23, v250
    v_fmac_f32 v226, s23, v222
    v_mfma_f32_16x16x32_bf16 a[88:91], a[196:199], v[236:239], a[88:91]
    v_cvt_pk_bf16_f32 v226, v252, v226
    v_fma_f32 v252, v249, s24, v251
    v_mfma_f32_16x16x32_bf16 a[92:95], a[200:203], v[236:239], a[92:95]
    ds_read_b128 v[236:239], v253 offset:11440
    v_fmac_f32 v251, -4.0, v249
    v_mfma_f32_16x16x32_bf16 a[92:95], a[212:215], v[228:231], a[92:95]
    buffer_load_dwordx4 a[192:195], v254, s[8:11], s42 offen offset:0 sc1
    v_mfma_f32_16x16x32_bf16 a[88:91], a[208:211], v[228:231], a[88:91]
    s_waitcnt lgkmcnt(1)
    v_fma_f32 v249, v248, s24, v250
    v_fmac_f32 v250, -4.0, v248
    v_mfma_f32_16x16x32_bf16 a[84:87], a[204:207], v[228:231], a[84:87]
    ds_read_b128 v[228:231], v253 offset:11168
    v_fma_f32 v248, v250, s26, v251
    v_mfma_f32_16x16x32_bf16 a[84:87], a[216:219], v[232:235], a[84:87]
    buffer_load_dwordx4 a[196:199], v254, s[8:11], s42 offen offset:1024 sc1
    v_mfma_f32_16x16x32_bf16 a[88:91], a[220:223], v[232:235], a[88:91]
    s_waitcnt vmcnt(14) lgkmcnt(1)
    v_fmac_f32 v251, s27, v250
    v_fma_f32 v250, v249, 2.0, v252
    v_mfma_f32_16x16x32_bf16 a[92:95], a[224:227], v[232:235], a[92:95]
    ds_read_b128 v[232:235], v253 offset:10912
    v_fmac_f32 v252, -2.0, v249
    v_fma_f32 v249, v220, s24, v224
sub5:
    v_mfma_f32_16x16x32_bf16 a[96:99], a[228:231], v[236:239], a[96:99]
    buffer_load_dwordx4 a[200:203], v254, s[8:11], s42 offen offset:2048 sc1
    v_mfma_f32_16x16x32_bf16 a[100:103], a[232:235], v[236:239], a[100:103]
    s_mov_b32 s42, 224256
    v_fmac_f32 v224, -4.0, v220
    v_fma_f32 v220, v218, s24, v222
    v_mfma_f32_16x16x32_bf16 a[104:107], a[236:239], v[236:239], a[104:107]
    ds_read_b128 v[236:239], v253 offset:10656
    s_waitcnt vmcnt(12)
    s_waitcnt lgkmcnt(2)
    v_mfma_f32_16x16x32_bf16 a[104:107], a[248:251], v[228:231], a[104:107]
    v_fmac_f32 v222, -4.0, v218
    v_fma_f32 v218, v222, s26, v224
    v_mfma_f32_16x16x32_bf16 a[100:103], a[244:247], v[228:231], a[100:103]
    buffer_load_dwordx4 a[204:207], v254, s[8:11], s42 offen offset:0 sc1
    v_mfma_f32_16x16x32_bf16 a[96:99], a[240:243], v[228:231], a[96:99]
    s_waitcnt vmcnt(10) lgkmcnt(1)
    v_fmac_f32 v224, s27, v222
    v_fma_f32 v222, v220, 2.0, v249
    v_mfma_f32_16x16x32_bf16 a[96:99], a[252:255], v[232:235], a[96:99]
    v_fmac_f32 v249, -2.0, v220
    v_cvt_pk_bf16_f32 v218, v248, v218
    v_mfma_f32_16x16x32_bf16 a[100:103], v[240:243], v[232:235], a[100:103]
    v_cvt_pk_bf16_f32 v224, v251, v224
    v_cvt_pk_bf16_f32 v222, v250, v222
    v_mfma_f32_16x16x32_bf16 a[104:107], v[244:247], v[232:235], a[104:107]
    buffer_load_dwordx4 a[208:211], v254, s[8:11], s42 offen offset:1024 sc1
    v_mfma_f32_16x16x32_bf16 a[108:111], a[228:231], v[228:231], a[108:111]
    v_cvt_pk_bf16_f32 v220, v252, v249
    v_lshlrev_b32 v248, 16, v219
    v_mfma_f32_16x16x32_bf16 a[108:111], a[240:243], v[232:235], a[108:111]
    s_waitcnt lgkmcnt(0)
    v_lshlrev_b32 v249, 16, v221
    v_lshlrev_b32 v250, 16, v223
    v_mfma_f32_16x16x32_bf16 a[108:111], a[252:255], v[236:239], a[108:111]
    v_lshlrev_b32 v251, 16, v225
    v_and_b32 v219, s22, v219
    v_mfma_f32_16x16x32_bf16 a[112:115], v[240:243], v[236:239], a[112:115]
    buffer_load_dwordx4 a[212:215], v254, s[8:11], s42 offen offset:2048 sc1
    v_mfma_f32_16x16x32_bf16 a[112:115], a[244:247], v[232:235], a[112:115]
    s_mov_b32 s42, 227328
    v_and_b32 v221, s22, v221
    v_and_b32 v223, s22, v223
    v_mfma_f32_16x16x32_bf16 a[112:115], a[232:235], v[228:231], a[112:115]
    v_and_b32 v225, s22, v225
    v_lshlrev_b32 v252, 16, v217
    v_mfma_f32_16x16x32_bf16 a[116:119], a[236:239], v[228:231], a[116:119]
    ds_read_b128 v[228:231], v253 offset:10400
    v_and_b32 v217, s22, v217
    v_mfma_f32_16x16x32_bf16 a[116:119], a[248:251], v[232:235], a[116:119]
    buffer_load_dwordx4 a[216:219], v254, s[8:11], s42 offen offset:0 sc1
    v_mfma_f32_16x16x32_bf16 a[116:119], v[244:247], v[236:239], a[116:119]
    v_fmac_f32 v252, s25, v251
    v_fmac_f32 v217, s25, v225
    v_mfma_f32_16x16x32_bf16 a[120:123], a[228:231], v[232:235], a[120:123]
    v_fmac_f32 v252, s28, v249
    v_fmac_f32 v217, s28, v221
    v_mfma_f32_16x16x32_bf16 a[120:123], a[240:243], v[236:239], a[120:123]
    s_waitcnt lgkmcnt(0)
    v_cvt_pk_bf16_f32 v217, v252, v217
    v_lshlrev_b32 v252, 16, v227
    v_mfma_f32_16x16x32_bf16 a[120:123], a[252:255], v[228:231], a[120:123]
    v_and_b32 v227, s22, v227
    v_fmac_f32 v252, s29, v248
    v_mfma_f32_16x16x32_bf16 a[124:127], v[240:243], v[228:231], a[124:127]
    buffer_load_dwordx4 a[220:223], v254, s[8:11], s42 offen offset:1024 sc1
    v_mfma_f32_16x16x32_bf16 a[124:127], a[244:247], v[236:239], a[124:127]
    v_fmac_f32 v227, s29, v219
    v_fmac_f32 v252, s23, v250
    v_mfma_f32_16x16x32_bf16 a[124:127], a[232:235], v[232:235], a[124:127]
    v_fmac_f32 v227, s23, v223
    v_cvt_pk_bf16_f32 v227, v252, v227
    v_mfma_f32_16x16x32_bf16 a[128:131], a[236:239], v[232:235], a[128:131]
    ds_read_b128 v[232:235], v253 offset:12224
    v_fma_f32 v252, v249, s24, v251
    v_mfma_f32_16x16x32_bf16 a[128:131], a[248:251], v[236:239], a[128:131]
    buffer_load_dwordx4 a[224:227], v254, s[8:11], s42 offen offset:2048 sc1
    v_mfma_f32_16x16x32_bf16 a[128:131], v[244:247], v[228:231], a[128:131]
    v_fmac_f32 v251, -4.0, v249
    v_fma_f32 v249, v248, s24, v250
    v_mfma_f32_16x16x32_bf16 a[132:135], a[228:231], v[236:239], a[132:135]
    v_and_b32 v215, 0x7fff, v255
    v_fmac_f32 v250, -4.0, v248
    v_mfma_f32_16x16x32_bf16 a[132:135], a[240:243], v[228:231], a[132:135]
    s_waitcnt lgkmcnt(0)
    v_fma_f32 v248, v250, s26, v251
    v_fmac_f32 v251, s27, v250
    v_mfma_f32_16x16x32_bf16 a[132:135], a[252:255], v[232:235], a[132:135]
    buffer_load_dwordx2 v[204:205], v215, s[4:7], s16 offen offset:1280
    v_mfma_f32_16x16x32_bf16 a[136:139], v[240:243], v[232:235], a[136:139]
    v_fma_f32 v250, v249, 2.0, v252
    v_fmac_f32 v252, -2.0, v249
    v_mfma_f32_16x16x32_bf16 a[136:139], a[244:247], v[228:231], a[136:139]
    v_fma_f32 v249, v221, s24, v225
    v_fmac_f32 v225, -4.0, v221
    v_mfma_f32_16x16x32_bf16 a[136:139], a[232:235], v[236:239], a[136:139]
    v_fma_f32 v221, v219, s24, v223
    v_fmac_f32 v223, -4.0, v219
    v_mfma_f32_16x16x32_bf16 a[140:143], a[236:239], v[236:239], a[140:143]
    ds_read_b128 v[236:239], v253 offset:11968
    v_fma_f32 v219, v223, s26, v225
    v_mfma_f32_16x16x32_bf16 a[140:143], a[248:251], v[228:231], a[140:143]
    buffer_load_dwordx2 v[206:207], v215, s[4:7], s17 offen offset:1280
    v_mfma_f32_16x16x32_bf16 a[140:143], v[244:247], v[232:235], a[140:143]
    v_fmac_f32 v225, s27, v223
    v_fma_f32 v223, v221, 2.0, v249
    v_mfma_f32_16x16x32_bf16 a[144:147], a[228:231], v[228:231], a[144:147]
    v_fmac_f32 v249, -2.0, v221
    v_cvt_pk_bf16_f32 v219, v248, v219
    v_mfma_f32_16x16x32_bf16 a[144:147], a[240:243], v[232:235], a[144:147]
    s_waitcnt lgkmcnt(0)
    v_cvt_pk_bf16_f32 v225, v251, v225
    v_cvt_pk_bf16_f32 v223, v250, v223
    v_mfma_f32_16x16x32_bf16 a[144:147], a[252:255], v[236:239], a[144:147]
    buffer_load_dwordx2 v[208:209], v215, s[4:7], s18 offen offset:1280
    v_mfma_f32_16x16x32_bf16 a[148:151], v[240:243], v[236:239], a[148:151]
    v_cvt_pk_bf16_f32 v221, v252, v249
    v_lshrrev_b32 v252, 15, v255
    v_mfma_f32_16x16x32_bf16 a[148:151], a[244:247], v[232:235], a[148:151]
    ds_write_b64 v252, v[218:219] offset:512
    v_mfma_f32_16x16x32_bf16 a[148:151], a[232:235], v[228:231], a[148:151]
    v_lshrrev_b32 v218, 15, v255
    v_mfma_f32_16x16x32_bf16 a[152:155], a[236:239], v[228:231], a[152:155]
    ds_read_b128 v[228:231], v253 offset:11712
    v_mfma_f32_16x16x32_bf16 a[152:155], a[248:251], v[232:235], a[152:155]
    buffer_load_dwordx2 v[210:211], v215, s[4:7], s19 offen offset:1280
    v_mfma_f32_16x16x32_bf16 a[152:155], v[244:247], v[236:239], a[152:155]
    ds_write_b64 v218, v[224:225] offset:2592
    v_mfma_f32_16x16x32_bf16 a[156:159], a[228:231], v[232:235], a[156:159]
    v_mfma_f32_16x16x32_bf16 a[156:159], a[240:243], v[236:239], a[156:159]
    s_waitcnt lgkmcnt(1)
    s_waitcnt vmcnt(13)
    v_lshlrev_b32 v248, 16, v194
    v_mfma_f32_16x16x32_bf16 a[156:159], a[252:255], v[228:231], a[156:159]
    buffer_load_dwordx2 v[212:213], v215, s[4:7], s20 offen offset:1280
    v_mfma_f32_16x16x32_bf16 a[160:163], v[240:243], v[228:231], a[160:163]
    ds_write_b64 v218, v[222:223] offset:4672
    v_mfma_f32_16x16x32_bf16 a[160:163], a[244:247], v[236:239], a[160:163]
    v_lshlrev_b32 v249, 16, v196
    v_lshlrev_b32 v250, 16, v198
    v_mfma_f32_16x16x32_bf16 a[160:163], a[232:235], v[232:235], a[160:163]
    ds_write_b64 v218, v[216:217] offset:17152
    v_mfma_f32_16x16x32_bf16 a[164:167], a[236:239], v[232:235], a[164:167]
    ds_read_b128 v[232:235], v253 offset:11456
    v_lshlrev_b32 v251, 16, v200
    v_mfma_f32_16x16x32_bf16 a[164:167], a[248:251], v[236:239], a[164:167]
    buffer_load_dwordx2 v[214:215], v215, s[4:7], s21 offen offset:1280
    v_mfma_f32_16x16x32_bf16 a[164:167], v[244:247], v[228:231], a[164:167]
    ds_write_b64 v218, v[226:227] offset:25472
    v_mfma_f32_16x16x32_bf16 a[168:171], a[228:231], v[236:239], a[168:171]
    v_and_b32 v194, s22, v194
    v_and_b32 v196, s22, v196
    v_mfma_f32_16x16x32_bf16 a[168:171], a[240:243], v[228:231], a[168:171]
    s_waitcnt lgkmcnt(1)
    v_and_b32 v198, s22, v198
    v_and_b32 v200, s22, v200
    v_mfma_f32_16x16x32_bf16 a[168:171], a[252:255], v[232:235], a[168:171]
pad2:
    s_cbranch_vccnz pad6
    ds_write_b64 v218, v[220:221] offset:6752
    v_mfma_f32_16x16x32_bf16 a[172:175], v[240:243], v[232:235], a[172:175]
    ds_read_b128 v[216:219], v253 offset:39904
    s_mov_b32 s45, 405865480
    v_mfma_f32_16x16x32_bf16 a[172:175], a[244:247], v[228:231], a[172:175]
    v_bfe_u32 v220, v254, 5, 3
    v_mul_u32_u24 v221, 5, v220
    v_mfma_f32_16x16x32_bf16 a[172:175], a[232:235], v[236:239], a[172:175]
    v_bfe_u32 v221, s45, v221, 5
    v_mul_u32_u24 v221, 65, v221
    v_mfma_f32_16x16x32_bf16 a[176:179], a[236:239], v[236:239], a[176:179]
    ds_read_b128 v[236:239], v253 offset:11184
    v_sub_u32 v221, v221, v220
    v_mfma_f32_16x16x32_bf16 a[176:179], a[248:251], v[228:231], a[176:179]
    v_lshl_add_u32 v220, v221, 5, v253
    s_waitcnt lgkmcnt(1)
    v_mfma_f32_16x16x32_bf16 a[176:179], v[244:247], v[232:235], a[176:179]
    s_mov_b32 s42, 258048
    v_lshlrev_b32 v252, 16, v192
    v_and_b32 v192, s22, v192
    v_mfma_f32_16x16x32_bf16 a[180:183], a[228:231], v[228:231], a[180:183]
    s_mov_b64 exec, s[46:47]
    ds_write_b128 v220, v[216:219] offset:1024
    s_mov_b64 exec, -1
    v_mfma_f32_16x16x32_bf16 a[184:187], a[232:235], v[228:231], a[184:187]
    v_fmac_f32 v252, s25, v251
    v_fmac_f32 v192, s25, v200
    v_mfma_f32_16x16x32_bf16 a[188:191], a[236:239], v[228:231], a[188:191]
    ds_read_b128 v[228:231], v253 offset:13520
    v_fmac_f32 v252, s28, v249
    v_mfma_f32_16x16x32_bf16 a[188:191], a[248:251], v[232:235], a[188:191]
    buffer_load_dwordx4 a[228:231], v254, s[8:11], s42 offen offset:0 sc1
    v_mfma_f32_16x16x32_bf16 a[184:187], a[244:247], v[232:235], a[184:187]
    s_waitcnt lgkmcnt(2)
    v_fmac_f32 v192, s28, v196
    v_cvt_pk_bf16_f32 v192, v252, v192
    v_mfma_f32_16x16x32_bf16 a[180:183], a[240:243], v[232:235], a[180:183]
    ds_read_b128 v[232:235], v253 offset:13248
    v_lshlrev_b32 v252, 16, v202
    v_mfma_f32_16x16x32_bf16 a[180:183], a[252:255], v[236:239], a[180:183]
    buffer_load_dwordx4 a[232:235], v254, s[8:11], s42 offen offset:1024 sc1
    v_mfma_f32_16x16x32_bf16 a[184:187], v[240:243], v[236:239], a[184:187]
    s_waitcnt vmcnt(14) lgkmcnt(1)
    v_and_b32 v202, s22, v202
    v_fmac_f32 v252, s29, v248
    v_mfma_f32_16x16x32_bf16 a[188:191], v[244:247], v[236:239], a[188:191]
    ds_read_b128 v[236:239], v253 offset:12992
    v_fmac_f32 v202, s29, v194
sub6:
    v_mfma_f32_16x16x32_bf16 v[0:3], a[192:195], v[228:231], v[0:3]
    buffer_load_dwordx4 a[236:239], v254, s[8:11], s42 offen offset:2048 sc1
    v_mfma_f32_16x16x32_bf16 v[4:7], a[196:199], v[228:231], v[4:7]
    s_mov_b32 s42, 261120
    v_fmac_f32 v252, s23, v250
    v_fmac_f32 v202, s23, v198
    v_mfma_f32_16x16x32_bf16 v[8:11], a[200:203], v[228:231], v[8:11]
    ds_read_b128 v[228:231], v253 offset:12736
    s_waitcnt vmcnt(12)
    s_waitcnt lgkmcnt(2)
    v_mfma_f32_16x16x32_bf16 v[8:11], a[212:215], v[232:235], v[8:11]
    v_cvt_pk_bf16_f32 v202, v252, v202
    v_fma_f32 v252, v249, s24, v251
    v_mfma_f32_16x16x32_bf16 v[4:7], a[208:211], v[232:235], v[4:7]
    buffer_load_dwordx4 a[240:243], v254, s[8:11], s42 offen offset:0 sc1
    v_mfma_f32_16x16x32_bf16 v[0:3], a[204:207], v[232:235], v[0:3]
    s_waitcnt vmcnt(10) lgkmcnt(1)
    v_fmac_f32 v251, -4.0, v249
    v_fma_f32 v249, v248, s24, v250
    v_mfma_f32_16x16x32_bf16 v[0:3], a[216:219], v[236:239], v[0:3]
    v_fmac_f32 v250, -4.0, v248
    v_fma_f32 v248, v250, s26, v251
    v_mfma_f32_16x16x32_bf16 v[4:7], a[220:223], v[236:239], v[4:7]
    v_fmac_f32 v251, s27, v250
    v_fma_f32 v250, v249, 2.0, v252
    v_fmac_f32 v252, -2.0, v249
    v_mfma_f32_16x16x32_bf16 v[8:11], a[224:227], v[236:239], v[8:11]
    buffer_load_dwordx4 a[244:247], v254, s[8:11], s42 offen offset:1024 sc1
    v_mfma_f32_16x16x32_bf16 v[12:15], a[192:195], v[232:235], v[12:15]
    v_fma_f32 v249, v196, s24, v200
    v_fmac_f32 v200, -4.0, v196
    v_mfma_f32_16x16x32_bf16 v[12:15], a[204:207], v[236:239], v[12:15]
    s_waitcnt lgkmcnt(0)
    v_fma_f32 v196, v194, s24, v198
    v_fmac_f32 v198, -4.0, v194
    v_mfma_f32_16x16x32_bf16 v[12:15], a[216:219], v[228:231], v[12:15]
    v_fma_f32 v194, v198, s26, v200
    v_fmac_f32 v200, s27, v198
    v_mfma_f32_16x16x32_bf16 v[16:19], a[220:223], v[228:231], v[16:19]
    buffer_load_dwordx4 a[248:251], v254, s[8:11], s42 offen offset:2048 sc1
    v_mfma_f32_16x16x32_bf16 v[16:19], a[208:211], v[236:239], v[16:19]
    s_mov_b32 s42, 264192
    v_fma_f32 v198, v196, 2.0, v249
    v_fmac_f32 v249, -2.0, v196
    v_mfma_f32_16x16x32_bf16 v[16:19], a[196:199], v[232:235], v[16:19]
    v_cvt_pk_bf16_f32 v194, v248, v194
    v_cvt_pk_bf16_f32 v200, v251, v200
    v_mfma_f32_16x16x32_bf16 v[20:23], a[200:203], v[232:235], v[20:23]
    ds_read_b128 v[232:235], v253 offset:12480
    v_cvt_pk_bf16_f32 v198, v250, v198
    v_mfma_f32_16x16x32_bf16 v[20:23], a[212:215], v[236:239], v[20:23]
    buffer_load_dwordx4 a[252:255], v254, s[8:11], s42 offen offset:0 sc1
    v_mfma_f32_16x16x32_bf16 v[20:23], a[224:227], v[228:231], v[20:23]
    v_cvt_pk_bf16_f32 v196, v252, v249
    v_lshlrev_b32 v248, 16, v195
    v_mfma_f32_16x16x32_bf16 v[24:27], a[192:195], v[236:239], v[24:27]
    v_lshlrev_b32 v249, 16, v197
    v_lshlrev_b32 v250, 16, v199
    v_mfma_f32_16x16x32_bf16 v[24:27], a[204:207], v[228:231], v[24:27]
    s_waitcnt lgkmcnt(0)
    v_lshlrev_b32 v251, 16, v201
    v_and_b32 v195, s22, v195
    v_mfma_f32_16x16x32_bf16 v[24:27], a[216:219], v[232:235], v[24:27]
    v_and_b32 v197, s22, v197
    v_and_b32 v199, s22, v199
    v_mfma_f32_16x16x32_bf16 v[28:31], a[220:223], v[232:235], v[28:31]
    buffer_load_dwordx4 v[240:243], v254, s[8:11], s42 offen offset:1024 sc1
    v_mfma_f32_16x16x32_bf16 v[28:31], a[208:211], v[228:231], v[28:31]
    v_and_b32 v201, s22, v201
    v_lshlrev_b32 v252, 16, v193
    v_mfma_f32_16x16x32_bf16 v[28:31], a[196:199], v[236:239], v[28:31]
    v_and_b32 v193, s22, v193
    v_fmac_f32 v252, s25, v251
    v_mfma_f32_16x16x32_bf16 v[32:35], a[200:203], v[236:239], v[32:35]
    ds_read_b128 v[236:239], v253 offset:14304
    v_fmac_f32 v193, s25, v201
    v_mfma_f32_16x16x32_bf16 v[32:35], a[212:215], v[228:231], v[32:35]
    buffer_load_dwordx4 v[244:247], v254, s[8:11], s42 offen offset:2048 sc1
    v_mfma_f32_16x16x32_bf16 v[32:35], a[224:227], v[232:235], v[32:35]
    v_fmac_f32 v252, s28, v249
    v_fmac_f32 v193, s28, v197
    v_mfma_f32_16x16x32_bf16 v[36:39], a[192:195], v[228:231], v[36:39]
    v_and_b32 v227, 0x7fff, v255
    v_cvt_pk_bf16_f32 v193, v252, v193
    v_mfma_f32_16x16x32_bf16 v[36:39], a[204:207], v[232:235], v[36:39]
    s_waitcnt lgkmcnt(0)
    v_lshlrev_b32 v252, 16, v203
    v_and_b32 v203, s22, v203
    v_mfma_f32_16x16x32_bf16 v[36:39], a[216:219], v[236:239], v[36:39]
    buffer_load_dwordx2 v[216:217], v227, s[4:7], s16 offen offset:192
    v_mfma_f32_16x16x32_bf16 v[40:43], a[220:223], v[236:239], v[40:43]
    v_fmac_f32 v252, s29, v248
    v_fmac_f32 v203, s29, v195
    v_mfma_f32_16x16x32_bf16 v[40:43], a[208:211], v[232:235], v[40:43]
    v_fmac_f32 v252, s23, v250
    v_fmac_f32 v203, s23, v199
    v_mfma_f32_16x16x32_bf16 v[40:43], a[196:199], v[228:231], v[40:43]
    v_cvt_pk_bf16_f32 v203, v252, v203
    v_fma_f32 v252, v249, s24, v251
    v_mfma_f32_16x16x32_bf16 v[44:47], a[200:203], v[228:231], v[44:47]
    ds_read_b128 v[228:231], v253 offset:14048
    v_fmac_f32 v251, -4.0, v249
    v_mfma_f32_16x16x32_bf16 v[44:47], a[212:215], v[232:235], v[44:47]
    buffer_load_dwordx2 v[218:219], v227, s[4:7], s17 offen offset:192
    v_mfma_f32_16x16x32_bf16 v[44:47], a[224:227], v[236:239], v[44:47]
    v_fma_f32 v249, v248, s24, v250
    v_fmac_f32 v250, -4.0, v248
    v_mfma_f32_16x16x32_bf16 v[48:51], a[192:195], v[232:235], v[48:51]
    v_fma_f32 v248, v250, s26, v251
    v_fmac_f32 v251, s27, v250
    v_mfma_f32_16x16x32_bf16 v[48:51], a[204:207], v[236:239], v[48:51]
    s_waitcnt lgkmcnt(0)
    v_fma_f32 v250, v249, 2.0, v252
    v_fmac_f32 v252, -2.0, v249
    v_mfma_f32_16x16x32_bf16 v[48:51], a[216:219], v[228:231], v[48:51]
    buffer_load_dwordx2 v[220:221], v227, s[4:7], s18 offen offset:192
    v_mfma_f32_16x16x32_bf16 v[52:55], a[220:223], v[228:231], v[52:55]
    v_fma_f32 v249, v197, s24, v201
    v_fmac_f32 v201, -4.0, v197
    v_mfma_f32_16x16x32_bf16 v[52:55], a[208:211], v[236:239], v[52:55]
    v_fma_f32 v197, v195, s24, v199
    v_fmac_f32 v199, -4.0, v195
    v_mfma_f32_16x16x32_bf16 v[52:55], a[196:199], v[232:235], v[52:55]
    v_fma_f32 v195, v199, s26, v201
    v_fmac_f32 v201, s27, v199
    v_mfma_f32_16x16x32_bf16 v[56:59], a[200:203], v[232:235], v[56:59]
    ds_read_b128 v[232:235], v253 offset:13792
    v_fma_f32 v199, v197, 2.0, v249
    v_mfma_f32_16x16x32_bf16 v[56:59], a[212:215], v[236:239], v[56:59]
    buffer_load_dwordx2 v[222:223], v227, s[4:7], s19 offen offset:192
    v_mfma_f32_16x16x32_bf16 v[56:59], a[224:227], v[228:231], v[56:59]
    v_fmac_f32 v249, -2.0, v197
    v_cvt_pk_bf16_f32 v195, v248, v195
    v_mfma_f32_16x16x32_bf16 v[60:63], a[192:195], v[236:239], v[60:63]
    v_cvt_pk_bf16_f32 v201, v251, v201
    v_cvt_pk_bf16_f32 v199, v250, v199
    v_mfma_f32_16x16x32_bf16 v[60:63], a[204:207], v[228:231], v[60:63]
    s_waitcnt lgkmcnt(0)
    v_cvt_pk_bf16_f32 v197, v252, v249
    v_lshrrev_b32 v252, 15, v255
    v_mfma_f32_16x16x32_bf16 v[60:63], a[216:219], v[232:235], v[60:63]
    buffer_load_dwordx2 v[224:225], v227, s[4:7], s20 offen offset:192
    v_mfma_f32_16x16x32_bf16 v[64:67], a[220:223], v[232:235], v[64:67]
    ds_write_b64 v252, v[194:195] offset:256
    v_mfma_f32_16x16x32_bf16 v[64:67], a[208:211], v[228:231], v[64:67]
    s_waitcnt vmcnt(14)
    v_lshrrev_b32 v194, 15, v255
    v_lshlrev_b32 v248, 16, v206
    v_mfma_f32_16x16x32_bf16 v[64:67], a[196:199], v[236:239], v[64:67]
    ds_write_b64 v194, v[200:201] offset:2336
    v_mfma_f32_16x16x32_bf16 v[68:71], a[200:203], v[236:239], v[68:71]
    ds_read_b128 v[236:239], v253 offset:13536
    v_lshlrev_b32 v249, 16, v208
    v_mfma_f32_16x16x32_bf16 v[68:71], a[212:215], v[228:231], v[68:71]
    buffer_load_dwordx2 v[226:227], v227, s[4:7], s21 offen offset:192
    v_mfma_f32_16x16x32_bf16 v[68:71], a[224:227], v[232:235], v[68:71]
    ds_write_b64 v194, v[198:199] offset:4416
    v_mfma_f32_16x16x32_bf16 v[72:75], a[192:195], v[228:231], v[72:75]
    v_lshlrev_b32 v250, 16, v210
    v_lshlrev_b32 v251, 16, v212
    v_mfma_f32_16x16x32_bf16 v[72:75], a[204:207], v[232:235], v[72:75]
    s_waitcnt lgkmcnt(1)
    v_and_b32 v206, s22, v206
    v_and_b32 v208, s22, v208
    v_mfma_f32_16x16x32_bf16 v[72:75], a[216:219], v[236:239], v[72:75]
    ds_write_b64 v194, v[192:193] offset:16896
    v_mfma_f32_16x16x32_bf16 v[76:79], a[220:223], v[236:239], v[76:79]
    v_and_b32 v210, s22, v210
    v_and_b32 v212, s22, v212
    v_mfma_f32_16x16x32_bf16 v[76:79], a[208:211], v[232:235], v[76:79]
    ds_write_b64 v194, v[202:203] offset:25216
    v_mfma_f32_16x16x32_bf16 v[76:79], a[196:199], v[228:231], v[76:79]
    v_lshlrev_b32 v252, 16, v204
    v_and_b32 v204, s22, v204
    v_mfma_f32_16x16x32_bf16 v[80:83], a[200:203], v[228:231], v[80:83]
    ds_read_b128 v[228:231], v253 offset:13264
    v_fmac_f32 v252, s25, v251
    v_mfma_f32_16x16x32_bf16 v[80:83], a[212:215], v[232:235], v[80:83]
    ds_write_b64 v194, v[196:197] offset:6496
    v_mfma_f32_16x16x32_bf16 v[80:83], a[224:227], v[236:239], v[80:83]
    s_mov_b32 s42, 294912
    v_fmac_f32 v204, s25, v212
    v_fmac_f32 v252, s28, v249
    v_mfma_f32_16x16x32_bf16 v[84:87], a[192:195], v[232:235], v[84:87]
    v_fmac_f32 v204, s28, v208
    v_cvt_pk_bf16_f32 v204, v252, v204
    v_mfma_f32_16x16x32_bf16 v[88:91], a[196:199], v[232:235], v[88:91]
    v_lshlrev_b32 v252, 16, v214
    v_and_b32 v214, s22, v214
    v_mfma_f32_16x16x32_bf16 v[92:95], a[200:203], v[232:235], v[92:95]
    ds_read_b128 v[232:235], v253 offset:32240
    v_fmac_f32 v252, s29, v248
    v_mfma_f32_16x16x32_bf16 v[92:95], a[212:215], v[236:239], v[92:95]
    buffer_load_dwordx4 a[192:195], v254, s[8:11], s42 offen offset:0 sc1
    v_mfma_f32_16x16x32_bf16 v[88:91], a[208:211], v[236:239], v[88:91]
    s_waitcnt lgkmcnt(2)
    v_fmac_f32 v214, s29, v206
    v_fmac_f32 v252, s23, v250
    v_mfma_f32_16x16x32_bf16 v[84:87], a[204:207], v[236:239], v[84:87]
    ds_read_b128 v[236:239], v253 offset:31968
    v_fmac_f32 v214, s23, v210
    v_mfma_f32_16x16x32_bf16 v[84:87], a[216:219], v[228:231], v[84:87]
    buffer_load_dwordx4 a[196:199], v254, s[8:11], s42 offen offset:1024 sc1
    v_mfma_f32_16x16x32_bf16 v[88:91], a[220:223], v[228:231], v[88:91]
    s_waitcnt vmcnt(14) lgkmcnt(1)
    v_cvt_pk_bf16_f32 v214, v252, v214
    v_fma_f32 v252, v249, s24, v251
    v_mfma_f32_16x16x32_bf16 v[92:95], a[224:227], v[228:231], v[92:95]
    ds_read_b128 v[228:231], v253 offset:31712
    v_fmac_f32 v251, -4.0, v249
sub7:
    v_mfma_f32_16x16x32_bf16 v[96:99], a[228:231], v[232:235], v[96:99]
    buffer_load_dwordx4 a[200:203], v254, s[8:11], s42 offen offset:2048 sc1
    v_mfma_f32_16x16x32_bf16 v[100:103], a[232:235], v[232:235], v[100:103]
    s_mov_b32 s42, 297984
    v_fma_f32 v249, v248, s24, v250
    v_fmac_f32 v250, -4.0, v248
    v_mfma_f32_16x16x32_bf16 v[104:107], a[236:239], v[232:235], v[104:107]
    ds_read_b128 v[232:235], v253 offset:31456
    s_waitcnt vmcnt(12)
    s_waitcnt lgkmcnt(2)
    v_mfma_f32_16x16x32_bf16 v[104:107], a[248:251], v[236:239], v[104:107]
    v_fma_f32 v248, v250, s26, v251
    v_fmac_f32 v251, s27, v250
    v_mfma_f32_16x16x32_bf16 v[100:103], a[244:247], v[236:239], v[100:103]
    buffer_load_dwordx4 a[204:207], v254, s[8:11], s42 offen offset:0 sc1
    v_mfma_f32_16x16x32_bf16 v[96:99], a[240:243], v[236:239], v[96:99]
    s_waitcnt vmcnt(10) lgkmcnt(1)
    v_fma_f32 v250, v249, 2.0, v252
    v_fmac_f32 v252, -2.0, v249
    v_mfma_f32_16x16x32_bf16 v[96:99], a[252:255], v[228:231], v[96:99]
    v_fma_f32 v249, v208, s24, v212
    v_fmac_f32 v212, -4.0, v208
    v_mfma_f32_16x16x32_bf16 v[100:103], v[240:243], v[228:231], v[100:103]
    v_fma_f32 v208, v206, s24, v210
    v_fmac_f32 v210, -4.0, v206
    v_mfma_f32_16x16x32_bf16 v[104:107], v[244:247], v[228:231], v[104:107]
    buffer_load_dwordx4 a[208:211], v254, s[8:11], s42 offen offset:1024 sc1
    v_mfma_f32_16x16x32_bf16 v[108:111], a[228:231], v[236:239], v[108:111]
    v_fma_f32 v206, v210, s26, v212
    v_fmac_f32 v212, s27, v210
    v_mfma_f32_16x16x32_bf16 v[108:111], a[240:243], v[228:231], v[108:111]
    s_waitcnt lgkmcnt(0)
    v_fma_f32 v210, v208, 2.0, v249
    v_fmac_f32 v249, -2.0, v208
    v_mfma_f32_16x16x32_bf16 v[108:111], a[252:255], v[232:235], v[108:111]
    v_cvt_pk_bf16_f32 v206, v248, v206
    v_cvt_pk_bf16_f32 v212, v251, v212
    v_mfma_f32_16x16x32_bf16 v[112:115], v[240:243], v[232:235], v[112:115]
    buffer_load_dwordx4 a[212:215], v254, s[8:11], s42 offen offset:2048 sc1
    v_mfma_f32_16x16x32_bf16 v[112:115], a[244:247], v[228:231], v[112:115]
    s_mov_b32 s42, 301056
    v_cvt_pk_bf16_f32 v210, v250, v210
    v_cvt_pk_bf16_f32 v208, v252, v249
    v_mfma_f32_16x16x32_bf16 v[112:115], a[232:235], v[236:239], v[112:115]
    v_lshlrev_b32 v248, 16, v207
    v_lshlrev_b32 v249, 16, v209
    v_mfma_f32_16x16x32_bf16 v[116:119], a[236:239], v[236:239], v[116:119]
    ds_read_b128 v[236:239], v253 offset:31200
    v_lshlrev_b32 v250, 16, v211
    v_lshlrev_b32 v251, 16, v213
    v_mfma_f32_16x16x32_bf16 v[116:119], a[248:251], v[228:231], v[116:119]
    buffer_load_dwordx4 a[216:219], v254, s[8:11], s42 offen offset:0 sc1
    v_mfma_f32_16x16x32_bf16 v[116:119], v[244:247], v[232:235], v[116:119]
    v_and_b32 v207, s22, v207
    v_and_b32 v209, s22, v209
    v_mfma_f32_16x16x32_bf16 v[120:123], a[228:231], v[228:231], v[120:123]
    v_and_b32 v211, s22, v211
    v_and_b32 v213, s22, v213
    v_mfma_f32_16x16x32_bf16 v[120:123], a[240:243], v[232:235], v[120:123]
    s_waitcnt lgkmcnt(0)
    v_lshlrev_b32 v252, 16, v205
    v_and_b32 v205, s22, v205
    v_mfma_f32_16x16x32_bf16 v[120:123], a[252:255], v[236:239], v[120:123]
    v_fmac_f32 v252, s25, v251
    v_fmac_f32 v205, s25, v213
    v_mfma_f32_16x16x32_bf16 v[124:127], v[240:243], v[236:239], v[124:127]
    buffer_load_dwordx4 a[220:223], v254, s[8:11], s42 offen offset:1024 sc1
    v_mfma_f32_16x16x32_bf16 v[124:127], a[244:247], v[232:235], v[124:127]
    v_fmac_f32 v252, s28, v249
    v_fmac_f32 v205, s28, v209
    v_mfma_f32_16x16x32_bf16 v[124:127], a[232:235], v[228:231], v[124:127]
    v_cvt_pk_bf16_f32 v205, v252, v205
    v_lshlrev_b32 v252, 16, v215
    v_mfma_f32_16x16x32_bf16 v[128:131], a[236:239], v[228:231], v[128:131]
    ds_read_b128 v[228:231], v253 offset:33024
    v_and_b32 v215, s22, v215
    v_mfma_f32_16x16x32_bf16 v[128:131], a[248:251], v[232:235], v[128:131]
    buffer_load_dwordx4 a[224:227], v254, s[8:11], s42 offen offset:2048 sc1
    v_mfma_f32_16x16x32_bf16 v[128:131], v[244:247], v[236:239], v[128:131]
    v_fmac_f32 v252, s29, v248
    v_fmac_f32 v215, s29, v207
    v_mfma_f32_16x16x32_bf16 v[132:135], a[228:231], v[232:235], v[132:135]
    v_and_b32 v203, 0x7fff, v255
    v_fmac_f32 v252, s23, v250
    v_mfma_f32_16x16x32_bf16 v[132:135], a[240:243], v[236:239], v[132:135]
    s_waitcnt lgkmcnt(0)
    v_fmac_f32 v215, s23, v211
    v_cvt_pk_bf16_f32 v215, v252, v215
    v_mfma_f32_16x16x32_bf16 v[132:135], a[252:255], v[228:231], v[132:135]
    buffer_load_dwordx2 v[192:193], v203, s[4:7], s16 offen offset:576
    v_mfma_f32_16x16x32_bf16 v[136:139], v[240:243], v[228:231], v[136:139]
    v_fma_f32 v252, v249, s24, v251
    v_fmac_f32 v251, -4.0, v249
    v_mfma_f32_16x16x32_bf16 v[136:139], a[244:247], v[236:239], v[136:139]
    v_fma_f32 v249, v248, s24, v250
    v_fmac_f32 v250, -4.0, v248
    v_mfma_f32_16x16x32_bf16 v[136:139], a[232:235], v[232:235], v[136:139]
    v_fma_f32 v248, v250, s26, v251
    v_fmac_f32 v251, s27, v250
    v_mfma_f32_16x16x32_bf16 v[140:143], a[236:239], v[232:235], v[140:143]
    ds_read_b128 v[232:235], v253 offset:32768
    v_fma_f32 v250, v249, 2.0, v252
    v_mfma_f32_16x16x32_bf16 v[140:143], a[248:251], v[236:239], v[140:143]
    buffer_load_dwordx2 v[194:195], v203, s[4:7], s17 offen offset:576
    v_mfma_f32_16x16x32_bf16 v[140:143], v[244:247], v[228:231], v[140:143]
    v_fmac_f32 v252, -2.0, v249
    v_fma_f32 v249, v209, s24, v213
    v_mfma_f32_16x16x32_bf16 v[144:147], a[228:231], v[236:239], v[144:147]
    v_fmac_f32 v213, -4.0, v209
    v_fma_f32 v209, v207, s24, v211
    v_mfma_f32_16x16x32_bf16 v[144:147], a[240:243], v[228:231], v[144:147]
    s_waitcnt lgkmcnt(0)
    v_fmac_f32 v211, -4.0, v207
    v_fma_f32 v207, v211, s26, v213
    v_mfma_f32_16x16x32_bf16 v[144:147], a[252:255], v[232:235], v[144:147]
    buffer_load_dwordx2 v[196:197], v203, s[4:7], s18 offen offset:576
    v_mfma_f32_16x16x32_bf16 v[148:151], v[240:243], v[232:235], v[148:151]
    v_fmac_f32 v213, s27, v211
    v_fma_f32 v211, v209, 2.0, v249
    v_mfma_f32_16x16x32_bf16 v[148:151], a[244:247], v[228:231], v[148:151]
    v_fmac_f32 v249, -2.0, v209
    v_cvt_pk_bf16_f32 v207, v248, v207
    v_mfma_f32_16x16x32_bf16 v[148:151], a[232:235], v[236:239], v[148:151]
    v_cvt_pk_bf16_f32 v213, v251, v213
    v_cvt_pk_bf16_f32 v211, v250, v211
    v_mfma_f32_16x16x32_bf16 v[152:155], a[236:239], v[236:239], v[152:155]
    ds_read_b128 v[236:239], v253 offset:32512
    v_cvt_pk_bf16_f32 v209, v252, v249
    v_mfma_f32_16x16x32_bf16 v[152:155], a[248:251], v[228:231], v[152:155]
    buffer_load_dwordx2 v[198:199], v203, s[4:7], s19 offen offset:576
    v_mfma_f32_16x16x32_bf16 v[152:155], v[244:247], v[232:235], v[152:155]
    v_lshrrev_b32 v252, 15, v255
    v_mfma_f32_16x16x32_bf16 v[156:159], a[228:231], v[228:231], v[156:159]
    ds_write_b64 v252, v[206:207] offset:0
    v_mfma_f32_16x16x32_bf16 v[156:159], a[240:243], v[232:235], v[156:159]
    s_waitcnt lgkmcnt(1)
    v_lshrrev_b32 v206, 15, v255
    s_waitcnt vmcnt(13)
    v_mfma_f32_16x16x32_bf16 v[156:159], a[252:255], v[236:239], v[156:159]
    buffer_load_dwordx2 v[200:201], v203, s[4:7], s20 offen offset:576
    v_mfma_f32_16x16x32_bf16 v[160:163], v[240:243], v[236:239], v[160:163]
    ds_write_b64 v206, v[212:213] offset:2080
    v_mfma_f32_16x16x32_bf16 v[160:163], a[244:247], v[232:235], v[160:163]
    v_lshlrev_b32 v248, 16, v218
    v_lshlrev_b32 v249, 16, v220
    v_mfma_f32_16x16x32_bf16 v[160:163], a[232:235], v[228:231], v[160:163]
    ds_write_b64 v206, v[210:211] offset:4160
    v_mfma_f32_16x16x32_bf16 v[164:167], a[236:239], v[228:231], v[164:167]
    ds_read_b128 v[228:231], v253 offset:32256
    v_lshlrev_b32 v250, 16, v222
    v_mfma_f32_16x16x32_bf16 v[164:167], a[248:251], v[232:235], v[164:167]
    buffer_load_dwordx2 v[202:203], v203, s[4:7], s21 offen offset:576
    v_mfma_f32_16x16x32_bf16 v[164:167], v[244:247], v[236:239], v[164:167]
    ds_write_b64 v206, v[204:205] offset:16640
    v_mfma_f32_16x16x32_bf16 v[168:171], a[228:231], v[232:235], v[168:171]
    v_lshlrev_b32 v251, 16, v224
    v_and_b32 v218, s22, v218
    v_mfma_f32_16x16x32_bf16 v[168:171], a[240:243], v[236:239], v[168:171]
    s_waitcnt lgkmcnt(1)
    v_and_b32 v220, s22, v220
    v_and_b32 v222, s22, v222
    v_and_b32 v224, s22, v224
    v_mfma_f32_16x16x32_bf16 v[168:171], a[252:255], v[228:231], v[168:171]
    ds_write_b64 v206, v[214:215] offset:24960
    v_mfma_f32_16x16x32_bf16 v[172:175], v[240:243], v[228:231], v[172:175]
    v_lshlrev_b32 v252, 16, v216
    v_and_b32 v216, s22, v216
    v_mfma_f32_16x16x32_bf16 v[172:175], a[244:247], v[236:239], v[172:175]
    ds_write_b64 v206, v[208:209] offset:6240
    v_mfma_f32_16x16x32_bf16 v[172:175], a[232:235], v[232:235], v[172:175]
    v_fmac_f32 v252, s25, v251
    v_fmac_f32 v216, s25, v224
    v_mfma_f32_16x16x32_bf16 v[176:179], a[236:239], v[232:235], v[176:179]
    ds_read_b128 v[232:235], v253 offset:31984
    v_fmac_f32 v252, s28, v249
    v_mfma_f32_16x16x32_bf16 v[176:179], a[248:251], v[236:239], v[176:179]
    v_fmac_f32 v216, s28, v220
    v_cvt_pk_bf16_f32 v216, v252, v216
    v_mfma_f32_16x16x32_bf16 v[176:179], v[244:247], v[228:231], v[176:179]
    s_mov_b32 s42, 331776
    v_lshlrev_b32 v252, 16, v226
    v_and_b32 v226, s22, v226
    v_mfma_f32_16x16x32_bf16 v[180:183], a[228:231], v[236:239], v[180:183]
    s_waitcnt lgkmcnt(0)
    v_fmac_f32 v252, s29, v248
    v_fmac_f32 v226, s29, v218
    v_mfma_f32_16x16x32_bf16 v[184:187], a[232:235], v[236:239], v[184:187]
    s_barrier
    v_mfma_f32_16x16x32_bf16 v[188:191], a[236:239], v[236:239], v[188:191]
    ds_read_b128 v[236:239], v253 offset:1040
    v_fmac_f32 v252, s23, v250
    v_mfma_f32_16x16x32_bf16 v[188:191], a[248:251], v[228:231], v[188:191]
    buffer_load_dwordx4 a[228:231], v254, s[8:11], s42 offen offset:0 sc1
    v_mfma_f32_16x16x32_bf16 v[184:187], a[244:247], v[228:231], v[184:187]
    v_fmac_f32 v226, s23, v222
    v_cvt_pk_bf16_f32 v226, v252, v226
    v_mfma_f32_16x16x32_bf16 v[180:183], a[240:243], v[228:231], v[180:183]
    ds_read_b128 v[228:231], v253 offset:768
    v_fma_f32 v252, v249, s24, v251
    v_mfma_f32_16x16x32_bf16 v[180:183], a[252:255], v[232:235], v[180:183]
    buffer_load_dwordx4 a[232:235], v254, s[8:11], s42 offen offset:1024 sc1
    v_mfma_f32_16x16x32_bf16 v[184:187], v[240:243], v[232:235], v[184:187]
    s_waitcnt vmcnt(14) lgkmcnt(1)
    v_fmac_f32 v251, -4.0, v249
    v_fma_f32 v249, v248, s24, v250
    v_mfma_f32_16x16x32_bf16 v[188:191], v[244:247], v[232:235], v[188:191]
    ds_read_b128 v[232:235], v253 offset:512
    v_fmac_f32 v250, -4.0, v248
sub8:
    v_mfma_f32_16x16x32_bf16 a[0:3], a[192:195], v[236:239], a[0:3]
    buffer_load_dwordx4 a[236:239], v254, s[8:11], s42 offen offset:2048 sc1
    v_mfma_f32_16x16x32_bf16 a[4:7], a[196:199], v[236:239], a[4:7]
    s_mov_b32 s42, 334848
    v_fma_f32 v248, v250, s26, v251
    v_fmac_f32 v251, s27, v250
    v_mfma_f32_16x16x32_bf16 a[8:11], a[200:203], v[236:239], a[8:11]
    ds_read_b128 v[236:239], v253 offset:256
    s_waitcnt vmcnt(12)
    s_waitcnt lgkmcnt(2)
    v_mfma_f32_16x16x32_bf16 a[8:11], a[212:215], v[228:231], a[8:11]
    v_fma_f32 v250, v249, 2.0, v252
    v_fmac_f32 v252, -2.0, v249
    v_mfma_f32_16x16x32_bf16 a[4:7], a[208:211], v[228:231], a[4:7]
    buffer_load_dwordx4 a[240:243], v254, s[8:11], s42 offen offset:0 sc1
    v_mfma_f32_16x16x32_bf16 a[0:3], a[204:207], v[228:231], a[0:3]
    s_waitcnt vmcnt(10) lgkmcnt(1)
    v_fma_f32 v249, v220, s24, v224
    v_fmac_f32 v224, -4.0, v220
    v_mfma_f32_16x16x32_bf16 a[0:3], a[216:219], v[232:235], a[0:3]
    v_fma_f32 v220, v218, s24, v222
    v_fmac_f32 v222, -4.0, v218
    v_mfma_f32_16x16x32_bf16 a[4:7], a[220:223], v[232:235], a[4:7]
    v_fma_f32 v218, v222, s26, v224
    v_fmac_f32 v224, s27, v222
    v_mfma_f32_16x16x32_bf16 a[8:11], a[224:227], v[232:235], a[8:11]
    buffer_load_dwordx4 a[244:247], v254, s[8:11], s42 offen offset:1024 sc1
    v_mfma_f32_16x16x32_bf16 a[12:15], a[192:195], v[228:231], a[12:15]
    v_fma_f32 v222, v220, 2.0, v249
    v_fmac_f32 v249, -2.0, v220
    v_mfma_f32_16x16x32_bf16 a[12:15], a[204:207], v[232:235], a[12:15]
    s_waitcnt lgkmcnt(0)
    v_cvt_pk_bf16_f32 v218, v248, v218
    v_cvt_pk_bf16_f32 v224, v251, v224
    v_mfma_f32_16x16x32_bf16 a[12:15], a[216:219], v[236:239], a[12:15]
    v_cvt_pk_bf16_f32 v222, v250, v222
    v_cvt_pk_bf16_f32 v220, v252, v249
    v_mfma_f32_16x16x32_bf16 a[16:19], a[220:223], v[236:239], a[16:19]
    buffer_load_dwordx4 a[248:251], v254, s[8:11], s42 offen offset:2048 sc1
    v_mfma_f32_16x16x32_bf16 a[16:19], a[208:211], v[232:235], a[16:19]
    s_mov_b32 s42, 337920
    v_lshlrev_b32 v248, 16, v219
    v_lshlrev_b32 v249, 16, v221
    v_mfma_f32_16x16x32_bf16 a[16:19], a[196:199], v[228:231], a[16:19]
    v_lshlrev_b32 v250, 16, v223
    v_lshlrev_b32 v251, 16, v225
    v_mfma_f32_16x16x32_bf16 a[20:23], a[200:203], v[228:231], a[20:23]
    ds_read_b128 v[228:231], v253 offset:0
    v_and_b32 v219, s22, v219
    v_mfma_f32_16x16x32_bf16 a[20:23], a[212:215], v[232:235], a[20:23]
    buffer_load_dwordx4 a[252:255], v254, s[8:11], s42 offen offset:0 sc1
    v_mfma_f32_16x16x32_bf16 a[20:23], a[224:227], v[236:239], a[20:23]
    v_and_b32 v221, s22, v221
    v_and_b32 v223, s22, v223
    v_mfma_f32_16x16x32_bf16 a[24:27], a[192:195], v[232:235], a[24:27]
    v_and_b32 v225, s22, v225
    v_lshlrev_b32 v252, 16, v217
    v_mfma_f32_16x16x32_bf16 a[24:27], a[204:207], v[236:239], a[24:27]
    s_waitcnt lgkmcnt(0)
    v_and_b32 v217, s22, v217
    v_fmac_f32 v252, s25, v251
    v_mfma_f32_16x16x32_bf16 a[24:27], a[216:219], v[228:231], a[24:27]
    v_fmac_f32 v217, s25, v225
    v_fmac_f32 v252, s28, v249
    v_mfma_f32_16x16x32_bf16 a[28:31], a[220:223], v[228:231], a[28:31]
    buffer_load_dwordx4 v[240:243], v254, s[8:11], s42 offen offset:1024 sc1
    v_mfma_f32_16x16x32_bf16 a[28:31], a[208:211], v[236:239], a[28:31]
    v_fmac_f32 v217, s28, v221
    v_cvt_pk_bf16_f32 v217, v252, v217
    v_mfma_f32_16x16x32_bf16 a[28:31], a[196:199], v[232:235], a[28:31]
    v_lshlrev_b32 v252, 16, v227
    v_and_b32 v227, s22, v227
    v_fmac_f32 v252, s29, v248
    v_mfma_f32_16x16x32_bf16 a[32:35], a[200:203], v[232:235], a[32:35]
    ds_read_b128 v[232:235], v253 offset:1824
    v_fmac_f32 v227, s29, v219
    v_mfma_f32_16x16x32_bf16 a[32:35], a[212:215], v[236:239], a[32:35]
    buffer_load_dwordx4 v[244:247], v254, s[8:11], s42 offen offset:2048 sc1
    v_mfma_f32_16x16x32_bf16 a[32:35], a[224:227], v[228:231], a[32:35]
    v_fmac_f32 v252, s23, v250
    v_fmac_f32 v227, s23, v223
    v_mfma_f32_16x16x32_bf16 a[36:39], a[192:195], v[236:239], a[36:39]
    v_and_b32 v215, 0x7fff, v255
    v_cvt_pk_bf16_f32 v227, v252, v227
    v_mfma_f32_16x16x32_bf16 a[36:39], a[204:207], v[228:231], a[36:39]
    s_waitcnt lgkmcnt(0)
    v_fma_f32 v252, v249, s24, v251
    v_fmac_f32 v251, -4.0, v249
    v_mfma_f32_16x16x32_bf16 a[36:39], a[216:219], v[232:235], a[36:39]
    buffer_load_dwordx2 v[204:205], v215, s[4:7], s16 offen offset:960
    v_mfma_f32_16x16x32_bf16 a[40:43], a[220:223], v[232:235], a[40:43]
    v_fma_f32 v249, v248, s24, v250
    v_fmac_f32 v250, -4.0, v248
    v_mfma_f32_16x16x32_bf16 a[40:43], a[208:211], v[228:231], a[40:43]
    v_fma_f32 v248, v250, s26, v251
    v_fmac_f32 v251, s27, v250
    v_mfma_f32_16x16x32_bf16 a[40:43], a[196:199], v[236:239], a[40:43]
    v_fma_f32 v250, v249, 2.0, v252
    v_fmac_f32 v252, -2.0, v249
    v_mfma_f32_16x16x32_bf16 a[44:47], a[200:203], v[236:239], a[44:47]
    ds_read_b128 v[236:239], v253 offset:1568
    v_fma_f32 v249, v221, s24, v225
    v_mfma_f32_16x16x32_bf16 a[44:47], a[212:215], v[228:231], a[44:47]
    buffer_load_dwordx2 v[206:207], v215, s[4:7], s17 offen offset:960
    v_mfma_f32_16x16x32_bf16 a[44:47], a[224:227], v[232:235], a[44:47]
    v_fmac_f32 v225, -4.0, v221
    v_fma_f32 v221, v219, s24, v223
    v_mfma_f32_16x16x32_bf16 a[48:51], a[192:195], v[228:231], a[48:51]
    v_fmac_f32 v223, -4.0, v219
    v_fma_f32 v219, v223, s26, v225
    v_mfma_f32_16x16x32_bf16 a[48:51], a[204:207], v[232:235], a[48:51]
    s_waitcnt lgkmcnt(0)
    v_fmac_f32 v225, s27, v223
    v_fma_f32 v223, v221, 2.0, v249
    v_mfma_f32_16x16x32_bf16 a[48:51], a[216:219], v[236:239], a[48:51]
    buffer_load_dwordx2 v[208:209], v215, s[4:7], s18 offen offset:960
    v_mfma_f32_16x16x32_bf16 a[52:55], a[220:223], v[236:239], a[52:55]
    v_fmac_f32 v249, -2.0, v221
    v_cvt_pk_bf16_f32 v219, v248, v219
    v_mfma_f32_16x16x32_bf16 a[52:55], a[208:211], v[232:235], a[52:55]
    v_cvt_pk_bf16_f32 v225, v251, v225
    v_cvt_pk_bf16_f32 v223, v250, v223
    v_mfma_f32_16x16x32_bf16 a[52:55], a[196:199], v[228:231], a[52:55]
    v_cvt_pk_bf16_f32 v221, v252, v249
    v_lshrrev_b32 v252, 15, v255
    v_mfma_f32_16x16x32_bf16 a[56:59], a[200:203], v[228:231], a[56:59]
    ds_read_b128 v[228:231], v253 offset:1312
    v_mfma_f32_16x16x32_bf16 a[56:59], a[212:215], v[232:235], a[56:59]
    buffer_load_dwordx2 v[210:211], v215, s[4:7], s19 offen offset:960
    v_mfma_f32_16x16x32_bf16 a[56:59], a[224:227], v[236:239], a[56:59]
    ds_write_b64 v252, v[218:219] offset:9088
    v_mfma_f32_16x16x32_bf16 a[60:63], a[192:195], v[232:235], a[60:63]
    v_lshrrev_b32 v218, 15, v255
    v_mfma_f32_16x16x32_bf16 a[60:63], a[204:207], v[236:239], a[60:63]
    s_waitcnt lgkmcnt(1)
    s_waitcnt vmcnt(13)
    v_lshlrev_b32 v248, 16, v194
    v_mfma_f32_16x16x32_bf16 a[60:63], a[216:219], v[228:231], a[60:63]
    buffer_load_dwordx2 v[212:213], v215, s[4:7], s20 offen offset:960
    v_mfma_f32_16x16x32_bf16 a[64:67], a[220:223], v[228:231], a[64:67]
    ds_write_b64 v218, v[224:225] offset:11168
    v_mfma_f32_16x16x32_bf16 a[64:67], a[208:211], v[236:239], a[64:67]
    v_lshlrev_b32 v249, 16, v196
    v_lshlrev_b32 v250, 16, v198
    v_mfma_f32_16x16x32_bf16 a[64:67], a[196:199], v[232:235], a[64:67]
    ds_write_b64 v218, v[222:223] offset:13248
    v_mfma_f32_16x16x32_bf16 a[68:71], a[200:203], v[232:235], a[68:71]
    ds_read_b128 v[232:235], v253 offset:1056
    v_lshlrev_b32 v251, 16, v200
    v_mfma_f32_16x16x32_bf16 a[68:71], a[212:215], v[236:239], a[68:71]
    buffer_load_dwordx2 v[214:215], v215, s[4:7], s21 offen offset:960
    v_mfma_f32_16x16x32_bf16 a[68:71], a[224:227], v[228:231], a[68:71]
pad3:
    s_cbranch_vccnz pad7
    ds_write_b64 v218, v[216:217] offset:19488
    v_mfma_f32_16x16x32_bf16 a[72:75], a[192:195], v[236:239], a[72:75]
    v_and_b32 v194, s22, v194
    v_and_b32 v196, s22, v196
    v_mfma_f32_16x16x32_bf16 a[72:75], a[204:207], v[228:231], a[72:75]
    s_waitcnt lgkmcnt(1)
    v_and_b32 v198, s22, v198
    v_and_b32 v200, s22, v200
    v_mfma_f32_16x16x32_bf16 a[72:75], a[216:219], v[232:235], a[72:75]
    ds_write_b64 v218, v[226:227] offset:27808
    v_mfma_f32_16x16x32_bf16 a[76:79], a[220:223], v[232:235], a[76:79]
    v_lshlrev_b32 v252, 16, v192
    v_and_b32 v192, s22, v192
    v_mfma_f32_16x16x32_bf16 a[76:79], a[208:211], v[228:231], a[76:79]
    ds_write_b64 v218, v[220:221] offset:31968
    v_mfma_f32_16x16x32_bf16 a[76:79], a[196:199], v[236:239], a[76:79]
    v_fmac_f32 v252, s25, v251
    v_fmac_f32 v192, s25, v200
    v_mfma_f32_16x16x32_bf16 a[80:83], a[200:203], v[236:239], a[80:83]
    ds_read_b128 v[236:239], v253 offset:784
    v_fmac_f32 v252, s28, v249
    v_mfma_f32_16x16x32_bf16 a[80:83], a[212:215], v[228:231], a[80:83]
    v_fmac_f32 v192, s28, v196
    v_cvt_pk_bf16_f32 v192, v252, v192
    v_mfma_f32_16x16x32_bf16 a[80:83], a[224:227], v[232:235], a[80:83]
    s_mov_b32 s42, 368640
    v_lshlrev_b32 v252, 16, v202
    v_and_b32 v202, s22, v202
    v_mfma_f32_16x16x32_bf16 a[84:87], a[192:195], v[228:231], a[84:87]
    v_fmac_f32 v252, s29, v248
    v_fmac_f32 v202, s29, v194
    v_fmac_f32 v252, s23, v250
    v_mfma_f32_16x16x32_bf16 a[88:91], a[196:199], v[228:231], a[88:91]
    v_fmac_f32 v202, s23, v198
    v_cvt_pk_bf16_f32 v202, v252, v202
    v_mfma_f32_16x16x32_bf16 a[92:95], a[200:203], v[228:231], a[92:95]
    ds_read_b128 v[228:231], v253 offset:3120
    v_fma_f32 v252, v249, s24, v251
    v_mfma_f32_16x16x32_bf16 a[92:95], a[212:215], v[232:235], a[92:95]
    buffer_load_dwordx4 a[192:195], v254, s[8:11], s42 offen offset:0 sc1
    v_mfma_f32_16x16x32_bf16 a[88:91], a[208:211], v[232:235], a[88:91]
    s_waitcnt lgkmcnt(1)
    v_fmac_f32 v251, -4.0, v249
    v_fma_f32 v249, v248, s24, v250
    v_mfma_f32_16x16x32_bf16 a[84:87], a[204:207], v[232:235], a[84:87]
    ds_read_b128 v[232:235], v253 offset:2848
    v_fmac_f32 v250, -4.0, v248
    v_mfma_f32_16x16x32_bf16 a[84:87], a[216:219], v[236:239], a[84:87]
    buffer_load_dwordx4 a[196:199], v254, s[8:11], s42 offen offset:1024 sc1
    v_mfma_f32_16x16x32_bf16 a[88:91], a[220:223], v[236:239], a[88:91]
    s_waitcnt vmcnt(14) lgkmcnt(1)
    v_fma_f32 v248, v250, s26, v251
    v_fmac_f32 v251, s27, v250
    v_mfma_f32_16x16x32_bf16 a[92:95], a[224:227], v[236:239], a[92:95]
    ds_read_b128 v[236:239], v253 offset:2592
    v_fma_f32 v250, v249, 2.0, v252
sub9:
    v_mfma_f32_16x16x32_bf16 a[96:99], a[228:231], v[228:231], a[96:99]
    buffer_load_dwordx4 a[200:203], v254, s[8:11], s42 offen offset:2048 sc1
    v_mfma_f32_16x16x32_bf16 a[100:103], a[232:235], v[228:231], a[100:103]
    s_mov_b32 s42, 371712
    v_fmac_f32 v252, -2.0, v249
    v_fma_f32 v249, v196, s24, v200
    v_mfma_f32_16x16x32_bf16 a[104:107], a[236:239], v[228:231], a[104:107]
    ds_read_b128 v[228:231], v253 offset:2336
    s_waitcnt vmcnt(12)
    s_waitcnt lgkmcnt(2)
    v_mfma_f32_16x16x32_bf16 a[104:107], a[248:251], v[232:235], a[104:107]
    v_fmac_f32 v200, -4.0, v196
    v_fma_f32 v196, v194, s24, v198
    v_mfma_f32_16x16x32_bf16 a[100:103], a[244:247], v[232:235], a[100:103]
    buffer_load_dwordx4 a[204:207], v254, s[8:11], s42 offen offset:0 sc1
    v_mfma_f32_16x16x32_bf16 a[96:99], a[240:243], v[232:235], a[96:99]
    s_waitcnt vmcnt(10) lgkmcnt(1)
    v_fmac_f32 v198, -4.0, v194
    v_fma_f32 v194, v198, s26, v200
    v_mfma_f32_16x16x32_bf16 a[96:99], a[252:255], v[236:239], a[96:99]
    v_fmac_f32 v200, s27, v198
    v_fma_f32 v198, v196, 2.0, v249
    v_mfma_f32_16x16x32_bf16 a[100:103], v[240:243], v[236:239], a[100:103]
    v_fmac_f32 v249, -2.0, v196
    v_cvt_pk_bf16_f32 v194, v248, v194
    v_mfma_f32_16x16x32_bf16 a[104:107], v[244:247], v[236:239], a[104:107]
    buffer_load_dwordx4 a[208:211], v254, s[8:11], s42 offen offset:1024 sc1
    v_mfma_f32_16x16x32_bf16 a[108:111], a[228:231], v[232:235], a[108:111]
    v_cvt_pk_bf16_f32 v200, v251, v200
    v_cvt_pk_bf16_f32 v198, v250, v198
    v_mfma_f32_16x16x32_bf16 a[108:111], a[240:243], v[236:239], a[108:111]
    s_waitcnt lgkmcnt(0)
    v_cvt_pk_bf16_f32 v196, v252, v249
    v_lshlrev_b32 v248, 16, v195
    v_mfma_f32_16x16x32_bf16 a[108:111], a[252:255], v[228:231], a[108:111]
    v_lshlrev_b32 v249, 16, v197
    v_lshlrev_b32 v250, 16, v199
    v_mfma_f32_16x16x32_bf16 a[112:115], v[240:243], v[228:231], a[112:115]
    buffer_load_dwordx4 a[212:215], v254, s[8:11], s42 offen offset:2048 sc1
    v_mfma_f32_16x16x32_bf16 a[112:115], a[244:247], v[236:239], a[112:115]
    s_mov_b32 s42, 374784
    v_lshlrev_b32 v251, 16, v201
    v_and_b32 v195, s22, v195
    v_mfma_f32_16x16x32_bf16 a[112:115], a[232:235], v[232:235], a[112:115]
    v_and_b32 v197, s22, v197
    v_and_b32 v199, s22, v199
    v_mfma_f32_16x16x32_bf16 a[116:119], a[236:239], v[232:235], a[116:119]
    ds_read_b128 v[232:235], v253 offset:2080
    v_and_b32 v201, s22, v201
    v_mfma_f32_16x16x32_bf16 a[116:119], a[248:251], v[236:239], a[116:119]
    buffer_load_dwordx4 a[216:219], v254, s[8:11], s42 offen offset:0 sc1
    v_mfma_f32_16x16x32_bf16 a[116:119], v[244:247], v[228:231], a[116:119]
    v_lshlrev_b32 v252, 16, v193
    v_and_b32 v193, s22, v193
    v_mfma_f32_16x16x32_bf16 a[120:123], a[228:231], v[236:239], a[120:123]
    v_fmac_f32 v252, s25, v251
    v_fmac_f32 v193, s25, v201
    v_mfma_f32_16x16x32_bf16 a[120:123], a[240:243], v[228:231], a[120:123]
    s_waitcnt lgkmcnt(0)
    v_fmac_f32 v252, s28, v249
    v_fmac_f32 v193, s28, v197
    v_mfma_f32_16x16x32_bf16 a[120:123], a[252:255], v[232:235], a[120:123]
    v_cvt_pk_bf16_f32 v193, v252, v193
    v_lshlrev_b32 v252, 16, v203
    v_mfma_f32_16x16x32_bf16 a[124:127], v[240:243], v[232:235], a[124:127]
    buffer_load_dwordx4 a[220:223], v254, s[8:11], s42 offen offset:1024 sc1
    v_mfma_f32_16x16x32_bf16 a[124:127], a[244:247], v[228:231], a[124:127]
    v_and_b32 v203, s22, v203
    v_fmac_f32 v252, s29, v248
    v_mfma_f32_16x16x32_bf16 a[124:127], a[232:235], v[236:239], a[124:127]
    v_fmac_f32 v203, s29, v195
    v_fmac_f32 v252, s23, v250
    v_mfma_f32_16x16x32_bf16 a[128:131], a[236:239], v[236:239], a[128:131]
    ds_read_b128 v[236:239], v253 offset:3904
    v_fmac_f32 v203, s23, v199
    v_mfma_f32_16x16x32_bf16 a[128:131], a[248:251], v[228:231], a[128:131]
    buffer_load_dwordx4 a[224:227], v254, s[8:11], s42 offen offset:2048 sc1
    v_mfma_f32_16x16x32_bf16 a[128:131], v[244:247], v[232:235], a[128:131]
    v_cvt_pk_bf16_f32 v203, v252, v203
    v_fma_f32 v252, v249, s24, v251
    v_mfma_f32_16x16x32_bf16 a[132:135], a[228:231], v[228:231], a[132:135]
    v_and_b32 v227, 0x7fff, v255
    v_fmac_f32 v251, -4.0, v249
    v_mfma_f32_16x16x32_bf16 a[132:135], a[240:243], v[232:235], a[132:135]
    s_waitcnt lgkmcnt(0)
    v_fma_f32 v249, v248, s24, v250
    v_fmac_f32 v250, -4.0, v248
    v_mfma_f32_16x16x32_bf16 a[132:135], a[252:255], v[236:239], a[132:135]
    buffer_load_dwordx2 v[216:217], v227, s[4:7], s16 offen offset:1344
    v_mfma_f32_16x16x32_bf16 a[136:139], v[240:243], v[236:239], a[136:139]
    v_fma_f32 v248, v250, s26, v251
    v_fmac_f32 v251, s27, v250
    v_mfma_f32_16x16x32_bf16 a[136:139], a[244:247], v[232:235], a[136:139]
    v_fma_f32 v250, v249, 2.0, v252
    v_fmac_f32 v252, -2.0, v249
    v_fma_f32 v249, v197, s24, v201
    v_mfma_f32_16x16x32_bf16 a[136:139], a[232:235], v[228:231], a[136:139]
    v_fmac_f32 v201, -4.0, v197
    v_fma_f32 v197, v195, s24, v199
    v_mfma_f32_16x16x32_bf16 a[140:143], a[236:239], v[228:231], a[140:143]
    ds_read_b128 v[228:231], v253 offset:3648
    v_fmac_f32 v199, -4.0, v195
    v_mfma_f32_16x16x32_bf16 a[140:143], a[248:251], v[232:235], a[140:143]
    buffer_load_dwordx2 v[218:219], v227, s[4:7], s17 offen offset:1344
    v_mfma_f32_16x16x32_bf16 a[140:143], v[244:247], v[236:239], a[140:143]
    v_fma_f32 v195, v199, s26, v201
    v_fmac_f32 v201, s27, v199
    v_mfma_f32_16x16x32_bf16 a[144:147], a[228:231], v[232:235], a[144:147]
    v_fma_f32 v199, v197, 2.0, v249
    v_fmac_f32 v249, -2.0, v197
    v_mfma_f32_16x16x32_bf16 a[144:147], a[240:243], v[236:239], a[144:147]
    s_waitcnt lgkmcnt(0)
    v_cvt_pk_bf16_f32 v195, v248, v195
    v_cvt_pk_bf16_f32 v201, v251, v201
    v_mfma_f32_16x16x32_bf16 a[144:147], a[252:255], v[228:231], a[144:147]
    buffer_load_dwordx2 v[220:221], v227, s[4:7], s18 offen offset:1344
    v_mfma_f32_16x16x32_bf16 a[148:151], v[240:243], v[228:231], a[148:151]
    v_cvt_pk_bf16_f32 v199, v250, v199
    v_cvt_pk_bf16_f32 v197, v252, v249
    v_mfma_f32_16x16x32_bf16 a[148:151], a[244:247], v[236:239], a[148:151]
    v_lshrrev_b32 v252, 15, v255
    v_mfma_f32_16x16x32_bf16 a[148:151], a[232:235], v[232:235], a[148:151]
    ds_write_b64 v252, v[194:195] offset:8832
    v_mfma_f32_16x16x32_bf16 a[152:155], a[236:239], v[232:235], a[152:155]
    ds_read_b128 v[232:235], v253 offset:3392
    v_lshrrev_b32 v194, 15, v255
    v_mfma_f32_16x16x32_bf16 a[152:155], a[248:251], v[236:239], a[152:155]
    buffer_load_dwordx2 v[222:223], v227, s[4:7], s19 offen offset:1344
    v_mfma_f32_16x16x32_bf16 a[152:155], v[244:247], v[228:231], a[152:155]
    ds_write_b64 v194, v[200:201] offset:10912
    v_mfma_f32_16x16x32_bf16 a[156:159], a[228:231], v[236:239], a[156:159]
    v_mfma_f32_16x16x32_bf16 a[156:159], a[240:243], v[228:231], a[156:159]
    s_waitcnt lgkmcnt(1)
    s_waitcnt vmcnt(13)
    v_lshlrev_b32 v248, 16, v206
    v_mfma_f32_16x16x32_bf16 a[156:159], a[252:255], v[232:235], a[156:159]
    buffer_load_dwordx2 v[224:225], v227, s[4:7], s20 offen offset:1344
    v_mfma_f32_16x16x32_bf16 a[160:163], v[240:243], v[232:235], a[160:163]
    ds_write_b64 v194, v[198:199] offset:12992
    v_mfma_f32_16x16x32_bf16 a[160:163], a[244:247], v[228:231], a[160:163]
    v_lshlrev_b32 v249, 16, v208
    v_lshlrev_b32 v250, 16, v210
    v_mfma_f32_16x16x32_bf16 a[160:163], a[232:235], v[236:239], a[160:163]
    ds_write_b64 v194, v[192:193] offset:19232
    v_mfma_f32_16x16x32_bf16 a[164:167], a[236:239], v[236:239], a[164:167]
    ds_read_b128 v[236:239], v253 offset:3136
    v_lshlrev_b32 v251, 16, v212
    v_mfma_f32_16x16x32_bf16 a[164:167], a[248:251], v[228:231], a[164:167]
    buffer_load_dwordx2 v[226:227], v227, s[4:7], s21 offen offset:1344
    v_mfma_f32_16x16x32_bf16 a[164:167], v[244:247], v[232:235], a[164:167]
    ds_write_b64 v194, v[202:203] offset:27552
    v_mfma_f32_16x16x32_bf16 a[168:171], a[228:231], v[228:231], a[168:171]
    v_and_b32 v206, s22, v206
    v_and_b32 v208, s22, v208
    v_mfma_f32_16x16x32_bf16 a[168:171], a[240:243], v[232:235], a[168:171]
    s_waitcnt lgkmcnt(1)
    v_and_b32 v210, s22, v210
    v_and_b32 v212, s22, v212
    v_mfma_f32_16x16x32_bf16 a[168:171], a[252:255], v[236:239], a[168:171]
    ds_write_b64 v194, v[196:197] offset:31712
    v_mfma_f32_16x16x32_bf16 a[172:175], v[240:243], v[236:239], a[172:175]
    ds_read_b128 v[192:195], v253 offset:40096
    s_mov_b32 s45, 452138121
    v_mfma_f32_16x16x32_bf16 a[172:175], a[244:247], v[232:235], a[172:175]
    v_bfe_u32 v196, v254, 5, 3
    v_mul_u32_u24 v197, 5, v196
    v_mfma_f32_16x16x32_bf16 a[172:175], a[232:235], v[228:231], a[172:175]
    v_bfe_u32 v197, s45, v197, 5
    v_mul_u32_u24 v197, 65, v197
    v_mfma_f32_16x16x32_bf16 a[176:179], a[236:239], v[228:231], a[176:179]
    ds_read_b128 v[228:231], v253 offset:2864
    v_sub_u32 v197, v197, v196
    v_mfma_f32_16x16x32_bf16 a[176:179], a[248:251], v[232:235], a[176:179]
    v_lshl_add_u32 v196, v197, 5, v253
    s_waitcnt lgkmcnt(1)
    v_mfma_f32_16x16x32_bf16 a[176:179], v[244:247], v[236:239], a[176:179]
    s_mov_b32 s42, 405504
    v_lshlrev_b32 v252, 16, v204
    v_and_b32 v204, s22, v204
    v_mfma_f32_16x16x32_bf16 a[180:183], a[228:231], v[232:235], a[180:183]
    s_mov_b64 exec, s[46:47]
    ds_write_b128 v196, v[192:195] offset:1024
    s_mov_b64 exec, -1
    v_mfma_f32_16x16x32_bf16 a[184:187], a[232:235], v[232:235], a[184:187]
    v_fmac_f32 v252, s25, v251
    v_fmac_f32 v204, s25, v212
    v_mfma_f32_16x16x32_bf16 a[188:191], a[236:239], v[232:235], a[188:191]
    ds_read_b128 v[232:235], v253 offset:5200
    v_fmac_f32 v252, s28, v249
    v_mfma_f32_16x16x32_bf16 a[188:191], a[248:251], v[236:239], a[188:191]
    buffer_load_dwordx4 a[228:231], v254, s[8:11], s42 offen offset:0 sc1
    v_mfma_f32_16x16x32_bf16 a[184:187], a[244:247], v[236:239], a[184:187]
    s_waitcnt lgkmcnt(2)
    v_fmac_f32 v204, s28, v208
    v_cvt_pk_bf16_f32 v204, v252, v204
    v_mfma_f32_16x16x32_bf16 a[180:183], a[240:243], v[236:239], a[180:183]
    ds_read_b128 v[236:239], v253 offset:4928
    v_lshlrev_b32 v252, 16, v214
    v_mfma_f32_16x16x32_bf16 a[180:183], a[252:255], v[228:231], a[180:183]
    buffer_load_dwordx4 a[232:235], v254, s[8:11], s42 offen offset:1024 sc1
    v_mfma_f32_16x16x32_bf16 a[184:187], v[240:243], v[228:231], a[184:187]
    s_waitcnt vmcnt(14) lgkmcnt(1)
    v_and_b32 v214, s22, v214
    v_fmac_f32 v252, s29, v248
    v_mfma_f32_16x16x32_bf16 a[188:191], v[244:247], v[228:231], a[188:191]
    ds_read_b128 v[228:231], v253 offset:4672
    v_fmac_f32 v214, s29, v206
    v_fmac_f32 v252, s23, v250
sub10:
    v_mfma_f32_16x16x32_bf16 v[0:3], a[192:195], v[232:235], v[0:3]
    buffer_load_dwordx4 a[236:239], v254, s[8:11], s42 offen offset:2048 sc1
    v_mfma_f32_16x16x32_bf16 v[4:7], a[196:199], v[232:235], v[4:7]
    s_mov_b32 s42, 408576
    v_fmac_f32 v214, s23, v210
    v_cvt_pk_bf16_f32 v214, v252, v214
    v_mfma_f32_16x16x32_bf16 v[8:11], a[200:203], v[232:235], v[8:11]
    ds_read_b128 v[232:235], v253 offset:4416
    s_waitcnt vmcnt(12)
    s_waitcnt lgkmcnt(2)
    v_mfma_f32_16x16x32_bf16 v[8:11], a[212:215], v[236:239], v[8:11]
    v_fma_f32 v252, v249, s24, v251
    v_fmac_f32 v251, -4.0, v249
    v_mfma_f32_16x16x32_bf16 v[4:7], a[208:211], v[236:239], v[4:7]
    buffer_load_dwordx4 a[240:243], v254, s[8:11], s42 offen offset:0 sc1
    v_mfma_f32_16x16x32_bf16 v[0:3], a[204:207], v[236:239], v[0:3]
    s_waitcnt vmcnt(10) lgkmcnt(1)
    v_fma_f32 v249, v248, s24, v250
    v_fmac_f32 v250, -4.0, v248
    v_mfma_f32_16x16x32_bf16 v[0:3], a[216:219], v[228:231], v[0:3]
    v_fma_f32 v248, v250, s26, v251
    v_fmac_f32 v251, s27, v250
    v_mfma_f32_16x16x32_bf16 v[4:7], a[220:223], v[228:231], v[4:7]
    v_fma_f32 v250, v249, 2.0, v252
    v_fmac_f32 v252, -2.0, v249
    v_mfma_f32_16x16x32_bf16 v[8:11], a[224:227], v[228:231], v[8:11]
    buffer_load_dwordx4 a[244:247], v254, s[8:11], s42 offen offset:1024 sc1
    v_mfma_f32_16x16x32_bf16 v[12:15], a[192:195], v[236:239], v[12:15]
    v_fma_f32 v249, v208, s24, v212
    v_fmac_f32 v212, -4.0, v208
    v_mfma_f32_16x16x32_bf16 v[12:15], a[204:207], v[228:231], v[12:15]
    s_waitcnt lgkmcnt(0)
    v_fma_f32 v208, v206, s24, v210
    v_fmac_f32 v210, -4.0, v206
    v_mfma_f32_16x16x32_bf16 v[12:15], a[216:219], v[232:235], v[12:15]
    v_fma_f32 v206, v210, s26, v212
    v_fmac_f32 v212, s27, v210
    v_mfma_f32_16x16x32_bf16 v[16:19], a[220:223], v[232:235], v[16:19]
    buffer_load_dwordx4 a[248:251], v254, s[8:11], s42 offen offset:2048 sc1
    v_mfma_f32_16x16x32_bf16 v[16:19], a[208:211], v[228:231], v[16:19]
    s_mov_b32 s42, 411648
    v_fma_f32 v210, v208, 2.0, v249
    v_fmac_f32 v249, -2.0, v208
    v_mfma_f32_16x16x32_bf16 v[16:19], a[196:199], v[236:239], v[16:19]
    v_cvt_pk_bf16_f32 v206, v248, v206
    v_cvt_pk_bf16_f32 v212, v251, v212
    v_mfma_f32_16x16x32_bf16 v[20:23], a[200:203], v[236:239], v[20:23]
    ds_read_b128 v[236:239], v253 offset:4160
    v_cvt_pk_bf16_f32 v210, v250, v210
    v_mfma_f32_16x16x32_bf16 v[20:23], a[212:215], v[228:231], v[20:23]
    buffer_load_dwordx4 a[252:255], v254, s[8:11], s42 offen offset:0 sc1
    v_mfma_f32_16x16x32_bf16 v[20:23], a[224:227], v[232:235], v[20:23]
    v_cvt_pk_bf16_f32 v208, v252, v249
    v_lshlrev_b32 v248, 16, v207
    v_mfma_f32_16x16x32_bf16 v[24:27], a[192:195], v[228:231], v[24:27]
    v_lshlrev_b32 v249, 16, v209
    v_lshlrev_b32 v250, 16, v211
    v_mfma_f32_16x16x32_bf16 v[24:27], a[204:207], v[232:235], v[24:27]
    s_waitcnt lgkmcnt(0)
    v_lshlrev_b32 v251, 16, v213
    v_and_b32 v207, s22, v207
    v_mfma_f32_16x16x32_bf16 v[24:27], a[216:219], v[236:239], v[24:27]
    v_and_b32 v209, s22, v209
    v_and_b32 v211, s22, v211
    v_mfma_f32_16x16x32_bf16 v[28:31], a[220:223], v[236:239], v[28:31]
    buffer_load_dwordx4 v[240:243], v254, s[8:11], s42 offen offset:1024 sc1
    v_mfma_f32_16x16x32_bf16 v[28:31], a[208:211], v[232:235], v[28:31]
    v_and_b32 v213, s22, v213
    v_lshlrev_b32 v252, 16, v205
    v_mfma_f32_16x16x32_bf16 v[28:31], a[196:199], v[228:231], v[28:31]
    v_and_b32 v205, s22, v205
    v_fmac_f32 v252, s25, v251
    v_mfma_f32_16x16x32_bf16 v[32:35], a[200:203], v[228:231], v[32:35]
    ds_read_b128 v[228:231], v253 offset:5984
    v_fmac_f32 v205, s25, v213
    v_mfma_f32_16x16x32_bf16 v[32:35], a[212:215], v[232:235], v[32:35]
    buffer_load_dwordx4 v[244:247], v254, s[8:11], s42 offen offset:2048 sc1
    v_mfma_f32_16x16x32_bf16 v[32:35], a[224:227], v[236:239], v[32:35]
    v_fmac_f32 v252, s28, v249
    v_fmac_f32 v205, s28, v209
    v_mfma_f32_16x16x32_bf16 v[36:39], a[192:195], v[232:235], v[36:39]
    v_and_b32 v203, 0x7fff, v255
    v_cvt_pk_bf16_f32 v205, v252, v205
    v_mfma_f32_16x16x32_bf16 v[36:39], a[204:207], v[236:239], v[36:39]
    s_waitcnt lgkmcnt(0)
    v_lshlrev_b32 v252, 16, v215
    v_and_b32 v215, s22, v215
    v_mfma_f32_16x16x32_bf16 v[36:39], a[216:219], v[228:231], v[36:39]
    buffer_load_dwordx2 v[192:193], v203, s[4:7], s16 offen offset:256
    v_mfma_f32_16x16x32_bf16 v[40:43], a[220:223], v[228:231], v[40:43]
    v_fmac_f32 v252, s29, v248
    v_fmac_f32 v215, s29, v207
    v_mfma_f32_16x16x32_bf16 v[40:43], a[208:211], v[236:239], v[40:43]
    v_fmac_f32 v252, s23, v250
    v_fmac_f32 v215, s23, v211
    v_mfma_f32_16x16x32_bf16 v[40:43], a[196:199], v[232:235], v[40:43]
    v_cvt_pk_bf16_f32 v215, v252, v215
    v_fma_f32 v252, v249, s24, v251
    v_mfma_f32_16x16x32_bf16 v[44:47], a[200:203], v[232:235], v[44:47]
    ds_read_b128 v[232:235], v253 offset:5728
    v_fmac_f32 v251, -4.0, v249
    v_mfma_f32_16x16x32_bf16 v[44:47], a[212:215], v[236:239], v[44:47]
    buffer_load_dwordx2 v[194:195], v203, s[4:7], s17 offen offset:256
    v_mfma_f32_16x16x32_bf16 v[44:47], a[224:227], v[228:231], v[44:47]
    v_fma_f32 v249, v248, s24, v250
    v_fmac_f32 v250, -4.0, v248
    v_mfma_f32_16x16x32_bf16 v[48:51], a[192:195], v[236:239], v[48:51]
    v_fma_f32 v248, v250, s26, v251
    v_fmac_f32 v251, s27, v250
    v_mfma_f32_16x16x32_bf16 v[48:51], a[204:207], v[228:231], v[48:51]
    s_waitcnt lgkmcnt(0)
    v_fma_f32 v250, v249, 2.0, v252
    v_fmac_f32 v252, -2.0, v249
    v_mfma_f32_16x16x32_bf16 v[48:51], a[216:219], v[232:235], v[48:51]
    buffer_load_dwordx2 v[196:197], v203, s[4:7], s18 offen offset:256
    v_mfma_f32_16x16x32_bf16 v[52:55], a[220:223], v[232:235], v[52:55]
    v_fma_f32 v249, v209, s24, v213
    v_fmac_f32 v213, -4.0, v209
    v_fma_f32 v209, v207, s24, v211
    v_mfma_f32_16x16x32_bf16 v[52:55], a[208:211], v[228:231], v[52:55]
    v_fmac_f32 v211, -4.0, v207
    v_fma_f32 v207, v211, s26, v213
    v_mfma_f32_16x16x32_bf16 v[52:55], a[196:199], v[236:239], v[52:55]
    v_fmac_f32 v213, s27, v211
    v_fma_f32 v211, v209, 2.0, v249
    v_mfma_f32_16x16x32_bf16 v[56:59], a[200:203], v[236:239], v[56:59]
    ds_read_b128 v[236:239], v253 offset:5472
    v_fmac_f32 v249, -2.0, v209
    v_mfma_f32_16x16x32_bf16 v[56:59], a[212:215], v[228:231], v[56:59]
    buffer_load_dwordx2 v[198:199], v203, s[4:7], s19 offen offset:256
    v_mfma_f32_16x16x32_bf16 v[56:59], a[224:227], v[232:235], v[56:59]
    v_cvt_pk_bf16_f32 v207, v248, v207
    v_cvt_pk_bf16_f32 v213, v251, v213
    v_mfma_f32_16x16x32_bf16 v[60:63], a[192:195], v[228:231], v[60:63]
    v_cvt_pk_bf16_f32 v211, v250, v211
    v_cvt_pk_bf16_f32 v209, v252, v249
    v_mfma_f32_16x16x32_bf16 v[60:63], a[204:207], v[232:235], v[60:63]
    s_waitcnt lgkmcnt(0)
    v_lshrrev_b32 v252, 15, v255
    v_mfma_f32_16x16x32_bf16 v[60:63], a[216:219], v[236:239], v[60:63]
    buffer_load_dwordx2 v[200:201], v203, s[4:7], s20 offen offset:256
    v_mfma_f32_16x16x32_bf16 v[64:67], a[220:223], v[236:239], v[64:67]
    ds_write_b64 v252, v[206:207] offset:8576
    v_mfma_f32_16x16x32_bf16 v[64:67], a[208:211], v[232:235], v[64:67]
    s_waitcnt vmcnt(14)
    v_lshrrev_b32 v206, 15, v255
    v_lshlrev_b32 v248, 16, v218
    v_mfma_f32_16x16x32_bf16 v[64:67], a[196:199], v[228:231], v[64:67]
    ds_write_b64 v206, v[212:213] offset:10656
    v_mfma_f32_16x16x32_bf16 v[68:71], a[200:203], v[228:231], v[68:71]
    ds_read_b128 v[228:231], v253 offset:5216
    v_lshlrev_b32 v249, 16, v220
    v_mfma_f32_16x16x32_bf16 v[68:71], a[212:215], v[232:235], v[68:71]
    buffer_load_dwordx2 v[202:203], v203, s[4:7], s21 offen offset:256
    v_mfma_f32_16x16x32_bf16 v[68:71], a[224:227], v[236:239], v[68:71]
    ds_write_b64 v206, v[210:211] offset:12736
    v_mfma_f32_16x16x32_bf16 v[72:75], a[192:195], v[232:235], v[72:75]
    v_lshlrev_b32 v250, 16, v222
    v_lshlrev_b32 v251, 16, v224
    v_mfma_f32_16x16x32_bf16 v[72:75], a[204:207], v[236:239], v[72:75]
    s_waitcnt lgkmcnt(1)
    v_and_b32 v218, s22, v218
    v_and_b32 v220, s22, v220
    v_mfma_f32_16x16x32_bf16 v[72:75], a[216:219], v[228:231], v[72:75]
    ds_write_b64 v206, v[204:205] offset:18976
    v_mfma_f32_16x16x32_bf16 v[76:79], a[220:223], v[228:231], v[76:79]
    v_and_b32 v222, s22, v222
    v_and_b32 v224, s22, v224
    v_mfma_f32_16x16x32_bf16 v[76:79], a[208:211], v[236:239], v[76:79]
    ds_write_b64 v206, v[214:215] offset:27296
    v_mfma_f32_16x16x32_bf16 v[76:79], a[196:199], v[232:235], v[76:79]
    v_lshlrev_b32 v252, 16, v216
    v_and_b32 v216, s22, v216
    v_mfma_f32_16x16x32_bf16 v[80:83], a[200:203], v[232:235], v[80:83]
    ds_read_b128 v[232:235], v253 offset:4944
    v_fmac_f32 v252, s25, v251
    v_mfma_f32_16x16x32_bf16 v[80:83], a[212:215], v[236:239], v[80:83]
    ds_write_b64 v206, v[208:209] offset:31456
    v_mfma_f32_16x16x32_bf16 v[80:83], a[224:227], v[228:231], v[80:83]
    s_mov_b32 s42, 442368
    v_fmac_f32 v216, s25, v224
    v_fmac_f32 v252, s28, v249
    v_mfma_f32_16x16x32_bf16 v[84:87], a[192:195], v[236:239], v[84:87]
    v_fmac_f32 v216, s28, v220
    v_cvt_pk_bf16_f32 v216, v252, v216
    v_mfma_f32_16x16x32_bf16 v[88:91], a[196:199], v[236:239], v[88:91]
    v_lshlrev_b32 v252, 16, v226
    v_and_b32 v226, s22, v226
    v_mfma_f32_16x16x32_bf16 v[92:95], a[200:203], v[236:239], v[92:95]
    ds_read_b128 v[236:239], v253 offset:7280
    v_fmac_f32 v252, s29, v248
    v_mfma_f32_16x16x32_bf16 v[92:95], a[212:215], v[228:231], v[92:95]
    buffer_load_dwordx4 a[192:195], v254, s[8:11], s42 offen offset:0 sc1
    v_mfma_f32_16x16x32_bf16 v[88:91], a[208:211], v[228:231], v[88:91]
    s_waitcnt lgkmcnt(2)
    v_fmac_f32 v226, s29, v218
    v_fmac_f32 v252, s23, v250
    v_mfma_f32_16x16x32_bf16 v[84:87], a[204:207], v[228:231], v[84:87]
    ds_read_b128 v[228:231], v253 offset:7008
    v_fmac_f32 v226, s23, v222
    v_mfma_f32_16x16x32_bf16 v[84:87], a[216:219], v[232:235], v[84:87]
    buffer_load_dwordx4 a[196:199], v254, s[8:11], s42 offen offset:1024 sc1
    v_mfma_f32_16x16x32_bf16 v[88:91], a[220:223], v[232:235], v[88:91]
    s_waitcnt vmcnt(14) lgkmcnt(1)
    v_cvt_pk_bf16_f32 v226, v252, v226
    v_fma_f32 v252, v249, s24, v251
    v_mfma_f32_16x16x32_bf16 v[92:95], a[224:227], v[232:235], v[92:95]
    ds_read_b128 v[232:235], v253 offset:6752
    v_fmac_f32 v251, -4.0, v249
sub11:
    v_mfma_f32_16x16x32_bf16 v[96:99], a[228:231], v[236:239], v[96:99]
    buffer_load_dwordx4 a[200:203], v254, s[8:11], s42 offen offset:2048 sc1
    v_mfma_f32_16x16x32_bf16 v[100:103], a[232:235], v[236:239], v[100:103]
    s_mov_b32 s42, 445440
    v_fma_f32 v249, v248, s24, v250
    v_fmac_f32 v250, -4.0, v248
    v_mfma_f32_16x16x32_bf16 v[104:107], a[236:239], v[236:239], v[104:107]
    ds_read_b128 v[236:239], v253 offset:6496
    s_waitcnt vmcnt(12)
    s_waitcnt lgkmcnt(2)
    v_mfma_f32_16x16x32_bf16 v[104:107], a[248:251], v[228:231], v[104:107]
    v_fma_f32 v248, v250, s26, v251
    v_fmac_f32 v251, s27, v250
    v_mfma_f32_16x16x32_bf16 v[100:103], a[244:247], v[228:231], v[100:103]
    buffer_load_dwordx4 a[204:207], v254, s[8:11], s42 offen offset:0 sc1
    v_mfma_f32_16x16x32_bf16 v[96:99], a[240:243], v[228:231], v[96:99]
    s_waitcnt vmcnt(10) lgkmcnt(1)
    v_fma_f32 v250, v249, 2.0, v252
    v_fmac_f32 v252, -2.0, v249
    v_mfma_f32_16x16x32_bf16 v[96:99], a[252:255], v[232:235], v[96:99]
    v_fma_f32 v249, v220, s24, v224
    v_fmac_f32 v224, -4.0, v220
    v_mfma_f32_16x16x32_bf16 v[100:103], v[240:243], v[232:235], v[100:103]
    v_fma_f32 v220, v218, s24, v222
    v_fmac_f32 v222, -4.0, v218
    v_fma_f32 v218, v222, s26, v224
    v_mfma_f32_16x16x32_bf16 v[104:107], v[244:247], v[232:235], v[104:107]
    buffer_load_dwordx4 a[208:211], v254, s[8:11], s42 offen offset:1024 sc1
    v_mfma_f32_16x16x32_bf16 v[108:111], a[228:231], v[228:231], v[108:111]
    v_fmac_f32 v224, s27, v222
    v_fma_f32 v222, v220, 2.0, v249
    v_mfma_f32_16x16x32_bf16 v[108:111], a[240:243], v[232:235], v[108:111]
    s_waitcnt lgkmcnt(0)
    v_fmac_f32 v249, -2.0, v220
    v_cvt_pk_bf16_f32 v218, v248, v218
    v_mfma_f32_16x16x32_bf16 v[108:111], a[252:255], v[236:239], v[108:111]
    v_cvt_pk_bf16_f32 v224, v251, v224
    v_cvt_pk_bf16_f32 v222, v250, v222
    v_mfma_f32_16x16x32_bf16 v[112:115], v[240:243], v[236:239], v[112:115]
    buffer_load_dwordx4 a[212:215], v254, s[8:11], s42 offen offset:2048 sc1
    v_mfma_f32_16x16x32_bf16 v[112:115], a[244:247], v[232:235], v[112:115]
    s_mov_b32 s42, 448512
    v_cvt_pk_bf16_f32 v220, v252, v249
    v_lshlrev_b32 v248, 16, v219
    v_mfma_f32_16x16x32_bf16 v[112:115], a[232:235], v[228:231], v[112:115]
    v_lshlrev_b32 v249, 16, v221
    v_lshlrev_b32 v250, 16, v223
    v_mfma_f32_16x16x32_bf16 v[116:119], a[236:239], v[228:231], v[116:119]
    ds_read_b128 v[228:231], v253 offset:6240
    v_lshlrev_b32 v251, 16, v225
    v_mfma_f32_16x16x32_bf16 v[116:119], a[248:251], v[232:235], v[116:119]
    buffer_load_dwordx4 a[216:219], v254, s[8:11], s42 offen offset:0 sc1
    v_mfma_f32_16x16x32_bf16 v[116:119], v[244:247], v[236:239], v[116:119]
    v_and_b32 v219, s22, v219
    v_and_b32 v221, s22, v221
    v_mfma_f32_16x16x32_bf16 v[120:123], a[228:231], v[232:235], v[120:123]
    v_and_b32 v223, s22, v223
    v_and_b32 v225, s22, v225
    v_mfma_f32_16x16x32_bf16 v[120:123], a[240:243], v[236:239], v[120:123]
    s_waitcnt lgkmcnt(0)
    v_lshlrev_b32 v252, 16, v217
    v_and_b32 v217, s22, v217
    v_mfma_f32_16x16x32_bf16 v[120:123], a[252:255], v[228:231], v[120:123]
    v_fmac_f32 v252, s25, v251
    v_fmac_f32 v217, s25, v225
    v_mfma_f32_16x16x32_bf16 v[124:127], v[240:243], v[228:231], v[124:127]
    buffer_load_dwordx4 a[220:223], v254, s[8:11], s42 offen offset:1024 sc1
    v_mfma_f32_16x16x32_bf16 v[124:127], a[244:247], v[236:239], v[124:127]
    v_fmac_f32 v252, s28, v249
    v_fmac_f32 v217, s28, v221
    v_mfma_f32_16x16x32_bf16 v[124:127], a[232:235], v[232:235], v[124:127]
    v_cvt_pk_bf16_f32 v217, v252, v217
    v_lshlrev_b32 v252, 16, v227
    v_mfma_f32_16x16x32_bf16 v[128:131], a[236:239], v[232:235], v[128:131]
    ds_read_b128 v[232:235], v253 offset:8064
    v_and_b32 v227, s22, v227
    v_mfma_f32_16x16x32_bf16 v[128:131], a[248:251], v[236:239], v[128:131]
    buffer_load_dwordx4 a[224:227], v254, s[8:11], s42 offen offset:2048 sc1
    v_mfma_f32_16x16x32_bf16 v[128:131], v[244:247], v[228:231], v[128:131]
    v_fmac_f32 v252, s29, v248
    v_fmac_f32 v227, s29, v219
    v_mfma_f32_16x16x32_bf16 v[132:135], a[228:231], v[236:239], v[132:135]
    v_and_b32 v215, 0x7fff, v255
    v_fmac_f32 v252, s23, v250
    v_mfma_f32_16x16x32_bf16 v[132:135], a[240:243], v[228:231], v[132:135]
    s_waitcnt lgkmcnt(0)
    v_fmac_f32 v227, s23, v223
    v_cvt_pk_bf16_f32 v227, v252, v227
    v_mfma_f32_16x16x32_bf16 v[132:135], a[252:255], v[232:235], v[132:135]
    buffer_load_dwordx2 v[204:205], v215, s[4:7], s16 offen offset:640
    v_mfma_f32_16x16x32_bf16 v[136:139], v[240:243], v[232:235], v[136:139]
    v_fma_f32 v252, v249, s24, v251
    v_fmac_f32 v251, -4.0, v249
    v_mfma_f32_16x16x32_bf16 v[136:139], a[244:247], v[228:231], v[136:139]
    v_fma_f32 v249, v248, s24, v250
    v_fmac_f32 v250, -4.0, v248
    v_mfma_f32_16x16x32_bf16 v[136:139], a[232:235], v[236:239], v[136:139]
    v_fma_f32 v248, v250, s26, v251
    v_fmac_f32 v251, s27, v250
    v_mfma_f32_16x16x32_bf16 v[140:143], a[236:239], v[236:239], v[140:143]
    ds_read_b128 v[236:239], v253 offset:7808
    v_fma_f32 v250, v249, 2.0, v252
    v_mfma_f32_16x16x32_bf16 v[140:143], a[248:251], v[228:231], v[140:143]
    buffer_load_dwordx2 v[206:207], v215, s[4:7], s17 offen offset:640
    v_mfma_f32_16x16x32_bf16 v[140:143], v[244:247], v[232:235], v[140:143]
    v_fmac_f32 v252, -2.0, v249
    v_fma_f32 v249, v221, s24, v225
    v_mfma_f32_16x16x32_bf16 v[144:147], a[228:231], v[228:231], v[144:147]
    v_fmac_f32 v225, -4.0, v221
    v_fma_f32 v221, v219, s24, v223
    v_mfma_f32_16x16x32_bf16 v[144:147], a[240:243], v[232:235], v[144:147]
    s_waitcnt lgkmcnt(0)
    v_fmac_f32 v223, -4.0, v219
    v_fma_f32 v219, v223, s26, v225
    v_mfma_f32_16x16x32_bf16 v[144:147], a[252:255], v[236:239], v[144:147]
    buffer_load_dwordx2 v[208:209], v215, s[4:7], s18 offen offset:640
    v_mfma_f32_16x16x32_bf16 v[148:151], v[240:243], v[236:239], v[148:151]
    v_fmac_f32 v225, s27, v223
    v_fma_f32 v223, v221, 2.0, v249
    v_mfma_f32_16x16x32_bf16 v[148:151], a[244:247], v[232:235], v[148:151]
    v_fmac_f32 v249, -2.0, v221
    v_cvt_pk_bf16_f32 v219, v248, v219
    v_mfma_f32_16x16x32_bf16 v[148:151], a[232:235], v[228:231], v[148:151]
    v_cvt_pk_bf16_f32 v225, v251, v225
    v_cvt_pk_bf16_f32 v223, v250, v223
    v_mfma_f32_16x16x32_bf16 v[152:155], a[236:239], v[228:231], v[152:155]
    ds_read_b128 v[228:231], v253 offset:7552
    v_cvt_pk_bf16_f32 v221, v252, v249
    v_mfma_f32_16x16x32_bf16 v[152:155], a[248:251], v[232:235], v[152:155]
    buffer_load_dwordx2 v[210:211], v215, s[4:7], s19 offen offset:640
    v_mfma_f32_16x16x32_bf16 v[152:155], v[244:247], v[236:239], v[152:155]
    v_lshrrev_b32 v252, 15, v255
    v_mfma_f32_16x16x32_bf16 v[156:159], a[228:231], v[232:235], v[156:159]
    ds_write_b64 v252, v[218:219] offset:8320
    v_mfma_f32_16x16x32_bf16 v[156:159], a[240:243], v[236:239], v[156:159]
    s_waitcnt lgkmcnt(1)
    v_lshrrev_b32 v218, 15, v255
    s_waitcnt vmcnt(13)
    v_mfma_f32_16x16x32_bf16 v[156:159], a[252:255], v[228:231], v[156:159]
    buffer_load_dwordx2 v[212:213], v215, s[4:7], s20 offen offset:640
    v_lshlrev_b32 v248, 16, v194
    v_mfma_f32_16x16x32_bf16 v[160:163], v[240:243], v[228:231], v[160:163]
    ds_write_b64 v218, v[224:225] offset:10400
    v_mfma_f32_16x16x32_bf16 v[160:163], a[244:247], v[236:239], v[160:163]
pad4:
    s_cbranch_vccnz pad8
    v_lshlrev_b32 v249, 16, v196
    v_lshlrev_b32 v250, 16, v198
    v_mfma_f32_16x16x32_bf16 v[160:163], a[232:235], v[232:235], v[160:163]
    ds_write_b64 v218, v[222:223] offset:12480
    v_mfma_f32_16x16x32_bf16 v[164:167], a[236:239], v[232:235], v[164:167]
    ds_read_b128 v[232:235], v253 offset:7296
    v_lshlrev_b32 v251, 16, v200
    v_mfma_f32_16x16x32_bf16 v[164:167], a[248:251], v[236:239], v[164:167]
    buffer_load_dwordx2 v[214:215], v215, s[4:7], s21 offen offset:640
    v_mfma_f32_16x16x32_bf16 v[164:167], v[244:247], v[228:231], v[164:167]
    ds_write_b64 v218, v[216:217] offset:18720
    v_mfma_f32_16x16x32_bf16 v[168:171], a[228:231], v[236:239], v[168:171]
    v_and_b32 v194, s22, v194
    v_and_b32 v196, s22, v196
    v_mfma_f32_16x16x32_bf16 v[168:171], a[240:243], v[228:231], v[168:171]
    s_waitcnt lgkmcnt(1)
    v_and_b32 v198, s22, v198
    v_and_b32 v200, s22, v200
    v_mfma_f32_16x16x32_bf16 v[168:171], a[252:255], v[232:235], v[168:171]
    ds_write_b64 v218, v[226:227] offset:27040
    v_mfma_f32_16x16x32_bf16 v[172:175], v[240:243], v[232:235], v[172:175]
    v_lshlrev_b32 v252, 16, v192
    v_and_b32 v192, s22, v192
    v_mfma_f32_16x16x32_bf16 v[172:175], a[244:247], v[228:231], v[172:175]
    ds_write_b64 v218, v[220:221] offset:31200
    v_mfma_f32_16x16x32_bf16 v[172:175], a[232:235], v[236:239], v[172:175]
    v_fmac_f32 v252, s25, v251
    v_fmac_f32 v192, s25, v200
    v_mfma_f32_16x16x32_bf16 v[176:179], a[236:239], v[236:239], v[176:179]
    ds_read_b128 v[236:239], v253 offset:7024
    v_fmac_f32 v252, s28, v249
    v_mfma_f32_16x16x32_bf16 v[176:179], a[248:251], v[228:231], v[176:179]
    v_fmac_f32 v192, s28, v196
    v_cvt_pk_bf16_f32 v192, v252, v192
    v_mfma_f32_16x16x32_bf16 v[176:179], v[244:247], v[232:235], v[176:179]
    s_mov_b32 s42, 479232
    v_lshlrev_b32 v252, 16, v202
    v_and_b32 v202, s22, v202
    v_mfma_f32_16x16x32_bf16 v[180:183], a[228:231], v[228:231], v[180:183]
    s_waitcnt lgkmcnt(0)
    v_fmac_f32 v252, s29, v248
    v_fmac_f32 v202, s29, v194
    v_mfma_f32_16x16x32_bf16 v[184:187], a[232:235], v[228:231], v[184:187]
    s_barrier
    v_mfma_f32_16x16x32_bf16 v[188:191], a[236:239], v[228:231], v[188:191]
    ds_read_b128 v[228:231], v253 offset:9360
    v_fmac_f32 v252, s23, v250
    v_mfma_f32_16x16x32_bf16 v[188:191], a[248:251], v[232:235], v[188:191]
    buffer_load_dwordx4 a[228:231], v254, s[8:11], s42 offen offset:0 sc1
    v_mfma_f32_16x16x32_bf16 v[184:187], a[244:247], v[232:235], v[184:187]
    v_fmac_f32 v202, s23, v198
    v_cvt_pk_bf16_f32 v202, v252, v202
    v_mfma_f32_16x16x32_bf16 v[180:183], a[240:243], v[232:235], v[180:183]
    ds_read_b128 v[232:235], v253 offset:9088
    v_fma_f32 v252, v249, s24, v251
    v_mfma_f32_16x16x32_bf16 v[180:183], a[252:255], v[236:239], v[180:183]
    buffer_load_dwordx4 a[232:235], v254, s[8:11], s42 offen offset:1024 sc1
    v_mfma_f32_16x16x32_bf16 v[184:187], v[240:243], v[236:239], v[184:187]
    s_waitcnt vmcnt(14) lgkmcnt(1)
    v_fmac_f32 v251, -4.0, v249
    v_fma_f32 v249, v248, s24, v250
    v_mfma_f32_16x16x32_bf16 v[188:191], v[244:247], v[236:239], v[188:191]
    ds_read_b128 v[236:239], v253 offset:8832
    v_fmac_f32 v250, -4.0, v248
sub12:
    v_mfma_f32_16x16x32_bf16 a[0:3], a[192:195], v[228:231], a[0:3]
    buffer_load_dwordx4 a[236:239], v254, s[8:11], s42 offen offset:2048 sc1
    v_mfma_f32_16x16x32_bf16 a[4:7], a[196:199], v[228:231], a[4:7]
    s_mov_b32 s42, 482304
    v_fma_f32 v248, v250, s26, v251
    v_fmac_f32 v251, s27, v250
    v_mfma_f32_16x16x32_bf16 a[8:11], a[200:203], v[228:231], a[8:11]
    ds_read_b128 v[228:231], v253 offset:8576
    s_waitcnt vmcnt(12)
    s_waitcnt lgkmcnt(2)
    v_mfma_f32_16x16x32_bf16 a[8:11], a[212:215], v[232:235], a[8:11]
    v_fma_f32 v250, v249, 2.0, v252
    v_fmac_f32 v252, -2.0, v249
    v_mfma_f32_16x16x32_bf16 a[4:7], a[208:211], v[232:235], a[4:7]
    buffer_load_dwordx4 a[240:243], v254, s[8:11], s42 offen offset:0 sc1
    v_mfma_f32_16x16x32_bf16 a[0:3], a[204:207], v[232:235], a[0:3]
    s_waitcnt vmcnt(10) lgkmcnt(1)
    v_fma_f32 v249, v196, s24, v200
    v_fmac_f32 v200, -4.0, v196
    v_mfma_f32_16x16x32_bf16 a[0:3], a[216:219], v[236:239], a[0:3]
    v_fma_f32 v196, v194, s24, v198
    v_fmac_f32 v198, -4.0, v194
    v_mfma_f32_16x16x32_bf16 a[4:7], a[220:223], v[236:239], a[4:7]
    v_fma_f32 v194, v198, s26, v200
    v_fmac_f32 v200, s27, v198
    v_mfma_f32_16x16x32_bf16 a[8:11], a[224:227], v[236:239], a[8:11]
    buffer_load_dwordx4 a[244:247], v254, s[8:11], s42 offen offset:1024 sc1
    v_mfma_f32_16x16x32_bf16 a[12:15], a[192:195], v[232:235], a[12:15]
    v_fma_f32 v198, v196, 2.0, v249
    v_fmac_f32 v249, -2.0, v196
    v_mfma_f32_16x16x32_bf16 a[12:15], a[204:207], v[236:239], a[12:15]
    s_waitcnt lgkmcnt(0)
    v_cvt_pk_bf16_f32 v194, v248, v194
    v_cvt_pk_bf16_f32 v200, v251, v200
    v_mfma_f32_16x16x32_bf16 a[12:15], a[216:219], v[228:231], a[12:15]
    v_cvt_pk_bf16_f32 v198, v250, v198
    v_cvt_pk_bf16_f32 v196, v252, v249
    v_mfma_f32_16x16x32_bf16 a[16:19], a[220:223], v[228:231], a[16:19]
    buffer_load_dwordx4 a[248:251], v254, s[8:11], s42 offen offset:2048 sc1
    v_mfma_f32_16x16x32_bf16 a[16:19], a[208:211], v[236:239], a[16:19]
    s_mov_b32 s42, 485376
    v_lshlrev_b32 v248, 16, v195
    v_lshlrev_b32 v249, 16, v197
    v_mfma_f32_16x16x32_bf16 a[16:19], a[196:199], v[232:235], a[16:19]
    v_lshlrev_b32 v250, 16, v199
    v_lshlrev_b32 v251, 16, v201
    v_mfma_f32_16x16x32_bf16 a[20:23], a[200:203], v[232:235], a[20:23]
    ds_read_b128 v[232:235], v253 offset:8320
    v_and_b32 v195, s22, v195
    v_and_b32 v197, s22, v197
    v_mfma_f32_16x16x32_bf16 a[20:23], a[212:215], v[236:239], a[20:23]
    buffer_load_dwordx4 a[252:255], v254, s[8:11], s42 offen offset:0 sc1
    v_mfma_f32_16x16x32_bf16 a[20:23], a[224:227], v[228:231], a[20:23]
    v_and_b32 v199, s22, v199
    v_and_b32 v201, s22, v201
    v_mfma_f32_16x16x32_bf16 a[24:27], a[192:195], v[236:239], a[24:27]
    v_lshlrev_b32 v252, 16, v193
    v_and_b32 v193, s22, v193
    v_mfma_f32_16x16x32_bf16 a[24:27], a[204:207], v[228:231], a[24:27]
    s_waitcnt lgkmcnt(0)
    v_fmac_f32 v252, s25, v251
    v_fmac_f32 v193, s25, v201
    v_mfma_f32_16x16x32_bf16 a[24:27], a[216:219], v[232:235], a[24:27]
    v_fmac_f32 v252, s28, v249
    v_fmac_f32 v193, s28, v197
    v_mfma_f32_16x16x32_bf16 a[28:31], a[220:223], v[232:235], a[28:31]
    buffer_load_dwordx4 v[240:243], v254, s[8:11], s42 offen offset:1024 sc1
    v_mfma_f32_16x16x32_bf16 a[28:31], a[208:211], v[228:231], a[28:31]
    v_cvt_pk_bf16_f32 v193, v252, v193
    v_lshlrev_b32 v252, 16, v203
    v_mfma_f32_16x16x32_bf16 a[28:31], a[196:199], v[236:239], a[28:31]
    v_and_b32 v203, s22, v203
    v_fmac_f32 v252, s29, v248
    v_mfma_f32_16x16x32_bf16 a[32:35], a[200:203], v[236:239], a[32:35]
    ds_read_b128 v[236:239], v253 offset:10144
    v_fmac_f32 v203, s29, v195
    v_mfma_f32_16x16x32_bf16 a[32:35], a[212:215], v[228:231], a[32:35]
    buffer_load_dwordx4 v[244:247], v254, s[8:11], s42 offen offset:2048 sc1
    v_mfma_f32_16x16x32_bf16 a[32:35], a[224:227], v[232:235], a[32:35]
    v_fmac_f32 v252, s23, v250
    v_fmac_f32 v203, s23, v199
    v_mfma_f32_16x16x32_bf16 a[36:39], a[192:195], v[228:231], a[36:39]
    v_and_b32 v227, 0x7fff, v255
    v_cvt_pk_bf16_f32 v203, v252, v203
    v_mfma_f32_16x16x32_bf16 a[36:39], a[204:207], v[232:235], a[36:39]
    s_waitcnt lgkmcnt(0)
    v_fma_f32 v252, v249, s24, v251
    v_fmac_f32 v251, -4.0, v249
    v_mfma_f32_16x16x32_bf16 a[36:39], a[216:219], v[236:239], a[36:39]
    buffer_load_dwordx2 v[216:217], v227, s[4:7], s16 offen offset:1024
    v_mfma_f32_16x16x32_bf16 a[40:43], a[220:223], v[236:239], a[40:43]
    v_fma_f32 v249, v248, s24, v250
    v_fmac_f32 v250, -4.0, v248
    v_mfma_f32_16x16x32_bf16 a[40:43], a[208:211], v[232:235], a[40:43]
    v_fma_f32 v248, v250, s26, v251
    v_fmac_f32 v251, s27, v250
    v_mfma_f32_16x16x32_bf16 a[40:43], a[196:199], v[228:231], a[40:43]
    v_fma_f32 v250, v249, 2.0, v252
    v_fmac_f32 v252, -2.0, v249
    v_mfma_f32_16x16x32_bf16 a[44:47], a[200:203], v[228:231], a[44:47]
    ds_read_b128 v[228:231], v253 offset:9888
    v_fma_f32 v249, v197, s24, v201
    v_mfma_f32_16x16x32_bf16 a[44:47], a[212:215], v[232:235], a[44:47]
    buffer_load_dwordx2 v[218:219], v227, s[4:7], s17 offen offset:1024
    v_mfma_f32_16x16x32_bf16 a[44:47], a[224:227], v[236:239], a[44:47]
    v_fmac_f32 v201, -4.0, v197
    v_fma_f32 v197, v195, s24, v199
    v_mfma_f32_16x16x32_bf16 a[48:51], a[192:195], v[232:235], a[48:51]
    v_fmac_f32 v199, -4.0, v195
    v_fma_f32 v195, v199, s26, v201
    v_mfma_f32_16x16x32_bf16 a[48:51], a[204:207], v[236:239], a[48:51]
    s_waitcnt lgkmcnt(0)
    v_fmac_f32 v201, s27, v199
    v_fma_f32 v199, v197, 2.0, v249
    v_mfma_f32_16x16x32_bf16 a[48:51], a[216:219], v[228:231], a[48:51]
    buffer_load_dwordx2 v[220:221], v227, s[4:7], s18 offen offset:1024
    v_mfma_f32_16x16x32_bf16 a[52:55], a[220:223], v[228:231], a[52:55]
    v_fmac_f32 v249, -2.0, v197
    v_cvt_pk_bf16_f32 v195, v248, v195
    v_mfma_f32_16x16x32_bf16 a[52:55], a[208:211], v[236:239], a[52:55]
    v_cvt_pk_bf16_f32 v201, v251, v201
    v_cvt_pk_bf16_f32 v199, v250, v199
    v_mfma_f32_16x16x32_bf16 a[52:55], a[196:199], v[232:235], a[52:55]
    v_cvt_pk_bf16_f32 v197, v252, v249
    v_lshrrev_b32 v252, 15, v255
    v_mfma_f32_16x16x32_bf16 a[56:59], a[200:203], v[232:235], a[56:59]
    ds_read_b128 v[232:235], v253 offset:9632
    v_mfma_f32_16x16x32_bf16 a[56:59], a[212:215], v[236:239], a[56:59]
    buffer_load_dwordx2 v[222:223], v227, s[4:7], s19 offen offset:1024
    v_mfma_f32_16x16x32_bf16 a[56:59], a[224:227], v[228:231], a[56:59]
    ds_write_b64 v252, v[194:195] offset:768
    v_mfma_f32_16x16x32_bf16 a[60:63], a[192:195], v[236:239], a[60:63]
    v_lshrrev_b32 v194, 15, v255
    v_mfma_f32_16x16x32_bf16 a[60:63], a[204:207], v[228:231], a[60:63]
    s_waitcnt lgkmcnt(1)
    s_waitcnt vmcnt(13)
    v_lshlrev_b32 v248, 16, v206
    v_mfma_f32_16x16x32_bf16 a[60:63], a[216:219], v[232:235], a[60:63]
    buffer_load_dwordx2 v[224:225], v227, s[4:7], s20 offen offset:1024
    v_mfma_f32_16x16x32_bf16 a[64:67], a[220:223], v[232:235], a[64:67]
    ds_write_b64 v194, v[200:201] offset:2848
    v_mfma_f32_16x16x32_bf16 a[64:67], a[208:211], v[228:231], a[64:67]
    v_lshlrev_b32 v249, 16, v208
    v_lshlrev_b32 v250, 16, v210
    v_mfma_f32_16x16x32_bf16 a[64:67], a[196:199], v[236:239], a[64:67]
    ds_write_b64 v194, v[198:199] offset:4928
    v_mfma_f32_16x16x32_bf16 a[68:71], a[200:203], v[236:239], a[68:71]
    ds_read_b128 v[236:239], v253 offset:9376
    v_lshlrev_b32 v251, 16, v212
    v_mfma_f32_16x16x32_bf16 a[68:71], a[212:215], v[228:231], a[68:71]
    buffer_load_dwordx2 v[226:227], v227, s[4:7], s21 offen offset:1024
    v_mfma_f32_16x16x32_bf16 a[68:71], a[224:227], v[232:235], a[68:71]
    ds_write_b64 v194, v[192:193] offset:21568
    v_mfma_f32_16x16x32_bf16 a[72:75], a[192:195], v[228:231], a[72:75]
    v_and_b32 v206, s22, v206
    v_and_b32 v208, s22, v208
    v_mfma_f32_16x16x32_bf16 a[72:75], a[204:207], v[232:235], a[72:75]
    s_waitcnt lgkmcnt(1)
    v_and_b32 v210, s22, v210
    v_and_b32 v212, s22, v212
    v_lshlrev_b32 v252, 16, v204
    v_mfma_f32_16x16x32_bf16 a[72:75], a[216:219], v[236:239], a[72:75]
    ds_write_b64 v194, v[202:203] offset:29888
    v_mfma_f32_16x16x32_bf16 a[76:79], a[220:223], v[236:239], a[76:79]
    v_and_b32 v204, s22, v204
    v_fmac_f32 v252, s25, v251
    v_mfma_f32_16x16x32_bf16 a[76:79], a[208:211], v[232:235], a[76:79]
    ds_write_b64 v194, v[196:197] offset:7008
    v_mfma_f32_16x16x32_bf16 a[76:79], a[196:199], v[228:231], a[76:79]
    v_fmac_f32 v204, s25, v212
    v_fmac_f32 v252, s28, v249
    v_mfma_f32_16x16x32_bf16 a[80:83], a[200:203], v[228:231], a[80:83]
    ds_read_b128 v[228:231], v253 offset:9104
    v_fmac_f32 v204, s28, v208
    v_mfma_f32_16x16x32_bf16 a[80:83], a[212:215], v[232:235], a[80:83]
    v_cvt_pk_bf16_f32 v204, v252, v204
    v_lshlrev_b32 v252, 16, v214
    v_mfma_f32_16x16x32_bf16 a[80:83], a[224:227], v[236:239], a[80:83]
    s_mov_b32 s42, 516096
    v_and_b32 v214, s22, v214
    v_fmac_f32 v252, s29, v248
    v_mfma_f32_16x16x32_bf16 a[84:87], a[192:195], v[232:235], a[84:87]
    v_fmac_f32 v214, s29, v206
    v_fmac_f32 v252, s23, v250
    v_mfma_f32_16x16x32_bf16 a[88:91], a[196:199], v[232:235], a[88:91]
    v_fmac_f32 v214, s23, v210
    v_cvt_pk_bf16_f32 v214, v252, v214
    v_mfma_f32_16x16x32_bf16 a[92:95], a[200:203], v[232:235], a[92:95]
    ds_read_b128 v[232:235], v253 offset:11440
    v_fma_f32 v252, v249, s24, v251
    v_mfma_f32_16x16x32_bf16 a[92:95], a[212:215], v[236:239], a[92:95]
    buffer_load_dwordx4 a[192:195], v254, s[8:11], s42 offen offset:0 sc1
    v_mfma_f32_16x16x32_bf16 a[88:91], a[208:211], v[236:239], a[88:91]
    s_waitcnt lgkmcnt(1)
    v_fmac_f32 v251, -4.0, v249
    v_fma_f32 v249, v248, s24, v250
    v_mfma_f32_16x16x32_bf16 a[84:87], a[204:207], v[236:239], a[84:87]
    ds_read_b128 v[236:239], v253 offset:11168
    v_fmac_f32 v250, -4.0, v248
    v_mfma_f32_16x16x32_bf16 a[84:87], a[216:219], v[228:231], a[84:87]
    buffer_load_dwordx4 a[196:199], v254, s[8:11], s42 offen offset:1024 sc1
    v_mfma_f32_16x16x32_bf16 a[88:91], a[220:223], v[228:231], a[88:91]
    s_waitcnt vmcnt(14) lgkmcnt(1)
    v_fma_f32 v248, v250, s26, v251
    v_fmac_f32 v251, s27, v250
    v_mfma_f32_16x16x32_bf16 a[92:95], a[224:227], v[228:231], a[92:95]
    ds_read_b128 v[228:231], v253 offset:10912
    v_fma_f32 v250, v249, 2.0, v252
sub13:
    v_mfma_f32_16x16x32_bf16 a[96:99], a[228:231], v[232:235], a[96:99]
    buffer_load_dwordx4 a[200:203], v254, s[8:11], s42 offen offset:2048 sc1
    v_mfma_f32_16x16x32_bf16 a[100:103], a[232:235], v[232:235], a[100:103]
    s_mov_b32 s42, 519168
    v_fmac_f32 v252, -2.0, v249
    v_fma_f32 v249, v208, s24, v212
    v_mfma_f32_16x16x32_bf16 a[104:107], a[236:239], v[232:235], a[104:107]
    ds_read_b128 v[232:235], v253 offset:10656
    s_waitcnt vmcnt(12)
    s_waitcnt lgkmcnt(2)
    v_mfma_f32_16x16x32_bf16 a[104:107], a[248:251], v[236:239], a[104:107]
    v_fmac_f32 v212, -4.0, v208
    v_fma_f32 v208, v206, s24, v210
    v_mfma_f32_16x16x32_bf16 a[100:103], a[244:247], v[236:239], a[100:103]
    buffer_load_dwordx4 a[204:207], v254, s[8:11], s42 offen offset:0 sc1
    v_mfma_f32_16x16x32_bf16 a[96:99], a[240:243], v[236:239], a[96:99]
    s_waitcnt vmcnt(10) lgkmcnt(1)
    v_fmac_f32 v210, -4.0, v206
    v_fma_f32 v206, v210, s26, v212
    v_mfma_f32_16x16x32_bf16 a[96:99], a[252:255], v[228:231], a[96:99]
    v_fmac_f32 v212, s27, v210
    v_fma_f32 v210, v208, 2.0, v249
    v_mfma_f32_16x16x32_bf16 a[100:103], v[240:243], v[228:231], a[100:103]
    v_fmac_f32 v249, -2.0, v208
    v_cvt_pk_bf16_f32 v206, v248, v206
    v_mfma_f32_16x16x32_bf16 a[104:107], v[244:247], v[228:231], a[104:107]
    buffer_load_dwordx4 a[208:211], v254, s[8:11], s42 offen offset:1024 sc1
    v_mfma_f32_16x16x32_bf16 a[108:111], a[228:231], v[236:239], a[108:111]
    v_cvt_pk_bf16_f32 v212, v251, v212
    v_cvt_pk_bf16_f32 v210, v250, v210
    v_mfma_f32_16x16x32_bf16 a[108:111], a[240:243], v[228:231], a[108:111]
    s_waitcnt lgkmcnt(0)
    v_cvt_pk_bf16_f32 v208, v252, v249
    v_lshlrev_b32 v248, 16, v207
    v_mfma_f32_16x16x32_bf16 a[108:111], a[252:255], v[232:235], a[108:111]
    v_lshlrev_b32 v249, 16, v209
    v_lshlrev_b32 v250, 16, v211
    v_mfma_f32_16x16x32_bf16 a[112:115], v[240:243], v[232:235], a[112:115]
    buffer_load_dwordx4 a[212:215], v254, s[8:11], s42 offen offset:2048 sc1
    v_mfma_f32_16x16x32_bf16 a[112:115], a[244:247], v[228:231], a[112:115]
    s_mov_b32 s42, 522240
    v_lshlrev_b32 v251, 16, v213
    v_and_b32 v207, s22, v207
    v_mfma_f32_16x16x32_bf16 a[112:115], a[232:235], v[236:239], a[112:115]
    v_and_b32 v209, s22, v209
    v_and_b32 v211, s22, v211
    v_mfma_f32_16x16x32_bf16 a[116:119], a[236:239], v[236:239], a[116:119]
    ds_read_b128 v[236:239], v253 offset:10400
    v_and_b32 v213, s22, v213
    v_mfma_f32_16x16x32_bf16 a[116:119], a[248:251], v[228:231], a[116:119]
    buffer_load_dwordx4 a[216:219], v254, s[8:11], s42 offen offset:0 sc1
    v_mfma_f32_16x16x32_bf16 a[116:119], v[244:247], v[232:235], a[116:119]
    v_lshlrev_b32 v252, 16, v205
    v_and_b32 v205, s22, v205
    v_mfma_f32_16x16x32_bf16 a[120:123], a[228:231], v[228:231], a[120:123]
    v_fmac_f32 v252, s25, v251
    v_fmac_f32 v205, s25, v213
    v_mfma_f32_16x16x32_bf16 a[120:123], a[240:243], v[232:235], a[120:123]
    s_waitcnt lgkmcnt(0)
    v_fmac_f32 v252, s28, v249
    v_fmac_f32 v205, s28, v209
    v_mfma_f32_16x16x32_bf16 a[120:123], a[252:255], v[236:239], a[120:123]
    v_cvt_pk_bf16_f32 v205, v252, v205
    v_lshlrev_b32 v252, 16, v215
    v_mfma_f32_16x16x32_bf16 a[124:127], v[240:243], v[236:239], a[124:127]
    buffer_load_dwordx4 a[220:223], v254, s[8:11], s42 offen offset:1024 sc1
    v_mfma_f32_16x16x32_bf16 a[124:127], a[244:247], v[232:235], a[124:127]
    v_and_b32 v215, s22, v215
    v_fmac_f32 v252, s29, v248
    v_mfma_f32_16x16x32_bf16 a[124:127], a[232:235], v[228:231], a[124:127]
    v_fmac_f32 v215, s29, v207
    v_fmac_f32 v252, s23, v250
    v_fmac_f32 v215, s23, v211
    v_mfma_f32_16x16x32_bf16 a[128:131], a[236:239], v[228:231], a[128:131]
    ds_read_b128 v[228:231], v253 offset:12224
    v_cvt_pk_bf16_f32 v215, v252, v215
    v_mfma_f32_16x16x32_bf16 a[128:131], a[248:251], v[232:235], a[128:131]
    buffer_load_dwordx4 a[224:227], v254, s[8:11], s42 offen offset:2048 sc1
    v_mfma_f32_16x16x32_bf16 a[128:131], v[244:247], v[236:239], a[128:131]
    v_fma_f32 v252, v249, s24, v251
    v_fmac_f32 v251, -4.0, v249
    v_mfma_f32_16x16x32_bf16 a[132:135], a[228:231], v[232:235], a[132:135]
    v_and_b32 v203, 0x7fff, v255
    v_fma_f32 v249, v248, s24, v250
    v_mfma_f32_16x16x32_bf16 a[132:135], a[240:243], v[236:239], a[132:135]
    s_waitcnt lgkmcnt(0)
    v_fmac_f32 v250, -4.0, v248
    v_fma_f32 v248, v250, s26, v251
    v_mfma_f32_16x16x32_bf16 a[132:135], a[252:255], v[228:231], a[132:135]
    buffer_load_dwordx2 v[192:193], v203, s[4:7], s16 offen offset:1408
    v_mfma_f32_16x16x32_bf16 a[136:139], v[240:243], v[228:231], a[136:139]
    v_fmac_f32 v251, s27, v250
    v_fma_f32 v250, v249, 2.0, v252
    v_mfma_f32_16x16x32_bf16 a[136:139], a[244:247], v[236:239], a[136:139]
    v_fmac_f32 v252, -2.0, v249
    v_fma_f32 v249, v209, s24, v213
    v_mfma_f32_16x16x32_bf16 a[136:139], a[232:235], v[232:235], a[136:139]
    v_fmac_f32 v213, -4.0, v209
    v_fma_f32 v209, v207, s24, v211
    v_mfma_f32_16x16x32_bf16 a[140:143], a[236:239], v[232:235], a[140:143]
    ds_read_b128 v[232:235], v253 offset:11968
    v_fmac_f32 v211, -4.0, v207
    v_mfma_f32_16x16x32_bf16 a[140:143], a[248:251], v[236:239], a[140:143]
    buffer_load_dwordx2 v[194:195], v203, s[4:7], s17 offen offset:1408
    v_mfma_f32_16x16x32_bf16 a[140:143], v[244:247], v[228:231], a[140:143]
    v_fma_f32 v207, v211, s26, v213
    v_fmac_f32 v213, s27, v211
    v_mfma_f32_16x16x32_bf16 a[144:147], a[228:231], v[236:239], a[144:147]
    v_fma_f32 v211, v209, 2.0, v249
    v_fmac_f32 v249, -2.0, v209
    v_mfma_f32_16x16x32_bf16 a[144:147], a[240:243], v[228:231], a[144:147]
    s_waitcnt lgkmcnt(0)
    v_cvt_pk_bf16_f32 v207, v248, v207
    v_cvt_pk_bf16_f32 v213, v251, v213
    v_mfma_f32_16x16x32_bf16 a[144:147], a[252:255], v[232:235], a[144:147]
    buffer_load_dwordx2 v[196:197], v203, s[4:7], s18 offen offset:1408
    v_mfma_f32_16x16x32_bf16 a[148:151], v[240:243], v[232:235], a[148:151]
    v_cvt_pk_bf16_f32 v211, v250, v211
    v_cvt_pk_bf16_f32 v209, v252, v249
    v_mfma_f32_16x16x32_bf16 a[148:151], a[244:247], v[228:231], a[148:151]
    v_lshrrev_b32 v252, 15, v255
    v_mfma_f32_16x16x32_bf16 a[148:151], a[232:235], v[236:239], a[148:151]
    ds_write_b64 v252, v[206:207] offset:512
    v_mfma_f32_16x16x32_bf16 a[152:155], a[236:239], v[236:239], a[152:155]
    ds_read_b128 v[236:239], v253 offset:11712
    v_lshrrev_b32 v206, 15, v255
    v_mfma_f32_16x16x32_bf16 a[152:155], a[248:251], v[228:231], a[152:155]
    buffer_load_dwordx2 v[198:199], v203, s[4:7], s19 offen offset:1408
    v_mfma_f32_16x16x32_bf16 a[152:155], v[244:247], v[232:235], a[152:155]
    ds_write_b64 v206, v[212:213] offset:2592
    v_mfma_f32_16x16x32_bf16 a[156:159], a[228:231], v[228:231], a[156:159]
    v_mfma_f32_16x16x32_bf16 a[156:159], a[240:243], v[232:235], a[156:159]
    s_waitcnt lgkmcnt(1)
    s_waitcnt vmcnt(13)
    v_lshlrev_b32 v248, 16, v218
    v_mfma_f32_16x16x32_bf16 a[156:159], a[252:255], v[236:239], a[156:159]
    buffer_load_dwordx2 v[200:201], v203, s[4:7], s20 offen offset:1408
    v_mfma_f32_16x16x32_bf16 a[160:163], v[240:243], v[236:239], a[160:163]
    ds_write_b64 v206, v[210:211] offset:4672
    v_mfma_f32_16x16x32_bf16 a[160:163], a[244:247], v[232:235], a[160:163]
    v_lshlrev_b32 v249, 16, v220
    v_lshlrev_b32 v250, 16, v222
    v_mfma_f32_16x16x32_bf16 a[160:163], a[232:235], v[228:231], a[160:163]
    ds_write_b64 v206, v[204:205] offset:21312
    v_mfma_f32_16x16x32_bf16 a[164:167], a[236:239], v[228:231], a[164:167]
    ds_read_b128 v[228:231], v253 offset:11456
    v_lshlrev_b32 v251, 16, v224
    v_mfma_f32_16x16x32_bf16 a[164:167], a[248:251], v[232:235], a[164:167]
    buffer_load_dwordx2 v[202:203], v203, s[4:7], s21 offen offset:1408
    v_mfma_f32_16x16x32_bf16 a[164:167], v[244:247], v[236:239], a[164:167]
    ds_write_b64 v206, v[214:215] offset:29632
    v_mfma_f32_16x16x32_bf16 a[168:171], a[228:231], v[232:235], a[168:171]
    v_and_b32 v218, s22, v218
    v_and_b32 v220, s22, v220
    v_mfma_f32_16x16x32_bf16 a[168:171], a[240:243], v[236:239], a[168:171]
    s_waitcnt lgkmcnt(1)
    v_and_b32 v222, s22, v222
    v_and_b32 v224, s22, v224
    v_mfma_f32_16x16x32_bf16 a[168:171], a[252:255], v[228:231], a[168:171]
    ds_write_b64 v206, v[208:209] offset:6752
    v_mfma_f32_16x16x32_bf16 a[172:175], v[240:243], v[228:231], a[172:175]
    ds_read_b128 v[204:207], v253 offset:40288
    s_mov_b32 s45, 472974346
    v_mfma_f32_16x16x32_bf16 a[172:175], a[244:247], v[236:239], a[172:175]
    v_bfe_u32 v208, v254, 5, 3
    v_mul_u32_u24 v209, 5, v208
    v_mfma_f32_16x16x32_bf16 a[172:175], a[232:235], v[232:235], a[172:175]
    v_bfe_u32 v209, s45, v209, 5
    v_mul_u32_u24 v209, 65, v209
    v_mfma_f32_16x16x32_bf16 a[176:179], a[236:239], v[232:235], a[176:179]
    ds_read_b128 v[232:235], v253 offset:11184
    v_sub_u32 v209, v209, v208
    v_mfma_f32_16x16x32_bf16 a[176:179], a[248:251], v[236:239], a[176:179]
    v_lshl_add_u32 v208, v209, 5, v253
    s_waitcnt lgkmcnt(1)
    v_mfma_f32_16x16x32_bf16 a[176:179], v[244:247], v[228:231], a[176:179]
    s_mov_b32 s42, 552960
    v_lshlrev_b32 v252, 16, v216
    v_and_b32 v216, s22, v216
    v_mfma_f32_16x16x32_bf16 a[180:183], a[228:231], v[236:239], a[180:183]
    s_mov_b64 exec, s[46:47]
    ds_write_b128 v208, v[204:207] offset:1024
    s_mov_b64 exec, -1
    v_fmac_f32 v252, s25, v251
    v_mfma_f32_16x16x32_bf16 a[184:187], a[232:235], v[236:239], a[184:187]
    v_fmac_f32 v216, s25, v224
    v_fmac_f32 v252, s28, v249
    v_mfma_f32_16x16x32_bf16 a[188:191], a[236:239], v[236:239], a[188:191]
    ds_read_b128 v[236:239], v253 offset:13520
    v_fmac_f32 v216, s28, v220
    v_mfma_f32_16x16x32_bf16 a[188:191], a[248:251], v[228:231], a[188:191]
    buffer_load_dwordx4 a[228:231], v254, s[8:11], s42 offen offset:0 sc1
    v_mfma_f32_16x16x32_bf16 a[184:187], a[244:247], v[228:231], a[184:187]
    s_waitcnt lgkmcnt(2)
    v_cvt_pk_bf16_f32 v216, v252, v216
    v_lshlrev_b32 v252, 16, v226
    v_mfma_f32_16x16x32_bf16 a[180:183], a[240:243], v[228:231], a[180:183]
    ds_read_b128 v[228:231], v253 offset:13248
    v_and_b32 v226, s22, v226
    v_mfma_f32_16x16x32_bf16 a[180:183], a[252:255], v[232:235], a[180:183]
    buffer_load_dwordx4 a[232:235], v254, s[8:11], s42 offen offset:1024 sc1
    v_mfma_f32_16x16x32_bf16 a[184:187], v[240:243], v[232:235], a[184:187]
    s_waitcnt vmcnt(14) lgkmcnt(1)
    v_fmac_f32 v252, s29, v248
    v_fmac_f32 v226, s29, v218
    v_mfma_f32_16x16x32_bf16 a[188:191], v[244:247], v[232:235], a[188:191]
    ds_read_b128 v[232:235], v253 offset:12992
    v_fmac_f32 v252, s23, v250
sub14:
    v_mfma_f32_16x16x32_bf16 v[0:3], a[192:195], v[236:239], v[0:3]
    buffer_load_dwordx4 a[236:239], v254, s[8:11], s42 offen offset:2048 sc1
    v_mfma_f32_16x16x32_bf16 v[4:7], a[196:199], v[236:239], v[4:7]
    s_mov_b32 s42, 556032
    v_fmac_f32 v226, s23, v222
    v_cvt_pk_bf16_f32 v226, v252, v226
    v_mfma_f32_16x16x32_bf16 v[8:11], a[200:203], v[236:239], v[8:11]
    ds_read_b128 v[236:239], v253 offset:12736
    s_waitcnt vmcnt(12)
    s_waitcnt lgkmcnt(2)
    v_mfma_f32_16x16x32_bf16 v[8:11], a[212:215], v[228:231], v[8:11]
    v_fma_f32 v252, v249, s24, v251
    v_fmac_f32 v251, -4.0, v249
    v_mfma_f32_16x16x32_bf16 v[4:7], a[208:211], v[228:231], v[4:7]
    buffer_load_dwordx4 a[240:243], v254, s[8:11], s42 offen offset:0 sc1
    v_mfma_f32_16x16x32_bf16 v[0:3], a[204:207], v[228:231], v[0:3]
    s_waitcnt vmcnt(10) lgkmcnt(1)
    v_fma_f32 v249, v248, s24, v250
    v_fmac_f32 v250, -4.0, v248
    v_mfma_f32_16x16x32_bf16 v[0:3], a[216:219], v[232:235], v[0:3]
    v_fma_f32 v248, v250, s26, v251
    v_fmac_f32 v251, s27, v250
    v_mfma_f32_16x16x32_bf16 v[4:7], a[220:223], v[232:235], v[4:7]
    v_fma_f32 v250, v249, 2.0, v252
    v_fmac_f32 v252, -2.0, v249
    v_mfma_f32_16x16x32_bf16 v[8:11], a[224:227], v[232:235], v[8:11]
    buffer_load_dwordx4 a[244:247], v254, s[8:11], s42 offen offset:1024 sc1
    v_mfma_f32_16x16x32_bf16 v[12:15], a[192:195], v[228:231], v[12:15]
    v_fma_f32 v249, v220, s24, v224
    v_fmac_f32 v224, -4.0, v220
    v_mfma_f32_16x16x32_bf16 v[12:15], a[204:207], v[232:235], v[12:15]
    s_waitcnt lgkmcnt(0)
    v_fma_f32 v220, v218, s24, v222
    v_fmac_f32 v222, -4.0, v218
    v_mfma_f32_16x16x32_bf16 v[12:15], a[216:219], v[236:239], v[12:15]
    v_fma_f32 v218, v222, s26, v224
    v_fmac_f32 v224, s27, v222
    v_mfma_f32_16x16x32_bf16 v[16:19], a[220:223], v[236:239], v[16:19]
    buffer_load_dwordx4 a[248:251], v254, s[8:11], s42 offen offset:2048 sc1
    v_mfma_f32_16x16x32_bf16 v[16:19], a[208:211], v[232:235], v[16:19]
    s_mov_b32 s42, 559104
    v_fma_f32 v222, v220, 2.0, v249
    v_fmac_f32 v249, -2.0, v220
    v_mfma_f32_16x16x32_bf16 v[16:19], a[196:199], v[228:231], v[16:19]
    v_cvt_pk_bf16_f32 v218, v248, v218
    v_cvt_pk_bf16_f32 v224, v251, v224
    v_mfma_f32_16x16x32_bf16 v[20:23], a[200:203], v[228:231], v[20:23]
    ds_read_b128 v[228:231], v253 offset:12480
    v_cvt_pk_bf16_f32 v222, v250, v222
    v_mfma_f32_16x16x32_bf16 v[20:23], a[212:215], v[232:235], v[20:23]
    buffer_load_dwordx4 a[252:255], v254, s[8:11], s42 offen offset:0 sc1
    v_mfma_f32_16x16x32_bf16 v[20:23], a[224:227], v[236:239], v[20:23]
    v_cvt_pk_bf16_f32 v220, v252, v249
    v_lshlrev_b32 v248, 16, v219
    v_mfma_f32_16x16x32_bf16 v[24:27], a[192:195], v[232:235], v[24:27]
    v_lshlrev_b32 v249, 16, v221
    v_lshlrev_b32 v250, 16, v223
    v_mfma_f32_16x16x32_bf16 v[24:27], a[204:207], v[236:239], v[24:27]
    s_waitcnt lgkmcnt(0)
    v_lshlrev_b32 v251, 16, v225
    v_and_b32 v219, s22, v219
    v_mfma_f32_16x16x32_bf16 v[24:27], a[216:219], v[228:231], v[24:27]
    v_and_b32 v221, s22, v221
    v_and_b32 v223, s22, v223
    v_mfma_f32_16x16x32_bf16 v[28:31], a[220:223], v[228:231], v[28:31]
    buffer_load_dwordx4 v[240:243], v254, s[8:11], s42 offen offset:1024 sc1
    v_mfma_f32_16x16x32_bf16 v[28:31], a[208:211], v[236:239], v[28:31]
    v_and_b32 v225, s22, v225
    v_lshlrev_b32 v252, 16, v217
    v_mfma_f32_16x16x32_bf16 v[28:31], a[196:199], v[232:235], v[28:31]
    v_and_b32 v217, s22, v217
    v_fmac_f32 v252, s25, v251
    v_mfma_f32_16x16x32_bf16 v[32:35], a[200:203], v[232:235], v[32:35]
    ds_read_b128 v[232:235], v253 offset:14304
    v_fmac_f32 v217, s25, v225
    v_mfma_f32_16x16x32_bf16 v[32:35], a[212:215], v[236:239], v[32:35]
    buffer_load_dwordx4 v[244:247], v254, s[8:11], s42 offen offset:2048 sc1
    v_mfma_f32_16x16x32_bf16 v[32:35], a[224:227], v[228:231], v[32:35]
    v_fmac_f32 v252, s28, v249
    v_fmac_f32 v217, s28, v221
    v_mfma_f32_16x16x32_bf16 v[36:39], a[192:195], v[236:239], v[36:39]
    v_and_b32 v215, 0x7fff, v255
    v_cvt_pk_bf16_f32 v217, v252, v217
    v_mfma_f32_16x16x32_bf16 v[36:39], a[204:207], v[228:231], v[36:39]
    s_waitcnt lgkmcnt(0)
    v_lshlrev_b32 v252, 16, v227
    v_and_b32 v227, s22, v227
    v_mfma_f32_16x16x32_bf16 v[36:39], a[216:219], v[232:235], v[36:39]
    buffer_load_dwordx2 v[204:205], v215, s[4:7], s16 offen offset:320
    v_mfma_f32_16x16x32_bf16 v[40:43], a[220:223], v[232:235], v[40:43]
    v_fmac_f32 v252, s29, v248
    v_fmac_f32 v227, s29, v219
    v_mfma_f32_16x16x32_bf16 v[40:43], a[208:211], v[228:231], v[40:43]
    v_fmac_f32 v252, s23, v250
    v_fmac_f32 v227, s23, v223
    v_cvt_pk_bf16_f32 v227, v252, v227
    v_mfma_f32_16x16x32_bf16 v[40:43], a[196:199], v[236:239], v[40:43]
    v_fma_f32 v252, v249, s24, v251
    v_fmac_f32 v251, -4.0, v249
    v_mfma_f32_16x16x32_bf16 v[44:47], a[200:203], v[236:239], v[44:47]
    ds_read_b128 v[236:239], v253 offset:14048
    v_fma_f32 v249, v248, s24, v250
    v_mfma_f32_16x16x32_bf16 v[44:47], a[212:215], v[228:231], v[44:47]
    buffer_load_dwordx2 v[206:207], v215, s[4:7], s17 offen offset:320
    v_mfma_f32_16x16x32_bf16 v[44:47], a[224:227], v[232:235], v[44:47]
    v_fmac_f32 v250, -4.0, v248
    v_fma_f32 v248, v250, s26, v251
    v_mfma_f32_16x16x32_bf16 v[48:51], a[192:195], v[228:231], v[48:51]
    v_fmac_f32 v251, s27, v250
    v_fma_f32 v250, v249, 2.0, v252
    v_mfma_f32_16x16x32_bf16 v[48:51], a[204:207], v[232:235], v[48:51]
    s_waitcnt lgkmcnt(0)
    v_fmac_f32 v252, -2.0, v249
    v_fma_f32 v249, v221, s24, v225
    v_mfma_f32_16x16x32_bf16 v[48:51], a[216:219], v[236:239], v[48:51]
    buffer_load_dwordx2 v[208:209], v215, s[4:7], s18 offen offset:320
    v_mfma_f32_16x16x32_bf16 v[52:55], a[220:223], v[236:239], v[52:55]
    v_fmac_f32 v225, -4.0, v221
    v_fma_f32 v221, v219, s24, v223
    v_mfma_f32_16x16x32_bf16 v[52:55], a[208:211], v[232:235], v[52:55]
    v_fmac_f32 v223, -4.0, v219
    v_fma_f32 v219, v223, s26, v225
    v_mfma_f32_16x16x32_bf16 v[52:55], a[196:199], v[228:231], v[52:55]
    v_fmac_f32 v225, s27, v223
    v_fma_f32 v223, v221, 2.0, v249
    v_mfma_f32_16x16x32_bf16 v[56:59], a[200:203], v[228:231], v[56:59]
    ds_read_b128 v[228:231], v253 offset:13792
    v_fmac_f32 v249, -2.0, v221
    v_mfma_f32_16x16x32_bf16 v[56:59], a[212:215], v[232:235], v[56:59]
    buffer_load_dwordx2 v[210:211], v215, s[4:7], s19 offen offset:320
    v_mfma_f32_16x16x32_bf16 v[56:59], a[224:227], v[236:239], v[56:59]
    v_cvt_pk_bf16_f32 v219, v248, v219
    v_cvt_pk_bf16_f32 v225, v251, v225
    v_mfma_f32_16x16x32_bf16 v[60:63], a[192:195], v[232:235], v[60:63]
    v_cvt_pk_bf16_f32 v223, v250, v223
    v_cvt_pk_bf16_f32 v221, v252, v249
    v_mfma_f32_16x16x32_bf16 v[60:63], a[204:207], v[236:239], v[60:63]
pad5:
    s_cbranch_vccnz pad9
    s_waitcnt lgkmcnt(0)
    v_lshrrev_b32 v252, 15, v255
    v_mfma_f32_16x16x32_bf16 v[60:63], a[216:219], v[228:231], v[60:63]
    buffer_load_dwordx2 v[212:213], v215, s[4:7], s20 offen offset:320
    v_mfma_f32_16x16x32_bf16 v[64:67], a[220:223], v[228:231], v[64:67]
    ds_write_b64 v252, v[218:219] offset:256
    v_mfma_f32_16x16x32_bf16 v[64:67], a[208:211], v[236:239], v[64:67]
    s_waitcnt vmcnt(14)
    v_lshrrev_b32 v218, 15, v255
    v_lshlrev_b32 v248, 16, v194
    v_mfma_f32_16x16x32_bf16 v[64:67], a[196:199], v[232:235], v[64:67]
    ds_write_b64 v218, v[224:225] offset:2336
    v_mfma_f32_16x16x32_bf16 v[68:71], a[200:203], v[232:235], v[68:71]
    ds_read_b128 v[232:235], v253 offset:13536
    v_lshlrev_b32 v249, 16, v196
    v_mfma_f32_16x16x32_bf16 v[68:71], a[212:215], v[236:239], v[68:71]
    buffer_load_dwordx2 v[214:215], v215, s[4:7], s21 offen offset:320
    v_mfma_f32_16x16x32_bf16 v[68:71], a[224:227], v[228:231], v[68:71]
    ds_write_b64 v218, v[222:223] offset:4416
    v_mfma_f32_16x16x32_bf16 v[72:75], a[192:195], v[236:239], v[72:75]
    v_lshlrev_b32 v250, 16, v198
    v_lshlrev_b32 v251, 16, v200
    v_mfma_f32_16x16x32_bf16 v[72:75], a[204:207], v[228:231], v[72:75]
    s_waitcnt lgkmcnt(1)
    v_and_b32 v194, s22, v194
    v_and_b32 v196, s22, v196
    v_mfma_f32_16x16x32_bf16 v[72:75], a[216:219], v[232:235], v[72:75]
    ds_write_b64 v218, v[216:217] offset:21056
    v_mfma_f32_16x16x32_bf16 v[76:79], a[220:223], v[232:235], v[76:79]
    v_and_b32 v198, s22, v198
    v_and_b32 v200, s22, v200
    v_mfma_f32_16x16x32_bf16 v[76:79], a[208:211], v[228:231], v[76:79]
    ds_write_b64 v218, v[226:227] offset:29376
    v_mfma_f32_16x16x32_bf16 v[76:79], a[196:199], v[236:239], v[76:79]
    v_lshlrev_b32 v252, 16, v192
    v_and_b32 v192, s22, v192
    v_mfma_f32_16x16x32_bf16 v[80:83], a[200:203], v[236:239], v[80:83]
    ds_read_b128 v[236:239], v253 offset:13264
    v_fmac_f32 v252, s25, v251
    v_mfma_f32_16x16x32_bf16 v[80:83], a[212:215], v[228:231], v[80:83]
    ds_write_b64 v218, v[220:221] offset:6496
    v_mfma_f32_16x16x32_bf16 v[80:83], a[224:227], v[232:235], v[80:83]
    s_mov_b32 s42, 589824
    v_fmac_f32 v192, s25, v200
    v_fmac_f32 v252, s28, v249
    v_mfma_f32_16x16x32_bf16 v[84:87], a[192:195], v[228:231], v[84:87]
    v_fmac_f32 v192, s28, v196
    v_cvt_pk_bf16_f32 v192, v252, v192
    v_mfma_f32_16x16x32_bf16 v[88:91], a[196:199], v[228:231], v[88:91]
    v_lshlrev_b32 v252, 16, v202
    v_and_b32 v202, s22, v202
    v_mfma_f32_16x16x32_bf16 v[92:95], a[200:203], v[228:231], v[92:95]
    ds_read_b128 v[228:231], v253 offset:32240
    v_fmac_f32 v252, s29, v248
    v_mfma_f32_16x16x32_bf16 v[92:95], a[212:215], v[232:235], v[92:95]
    buffer_load_dwordx4 a[192:195], v254, s[8:11], s42 offen offset:0 sc1
    v_mfma_f32_16x16x32_bf16 v[88:91], a[208:211], v[232:235], v[88:91]
    s_waitcnt lgkmcnt(2)
    v_fmac_f32 v202, s29, v194
    v_fmac_f32 v252, s23, v250
    v_mfma_f32_16x16x32_bf16 v[84:87], a[204:207], v[232:235], v[84:87]
    ds_read_b128 v[232:235], v253 offset:31968
    v_fmac_f32 v202, s23, v198
    v_mfma_f32_16x16x32_bf16 v[84:87], a[216:219], v[236:239], v[84:87]
    buffer_load_dwordx4 a[196:199], v254, s[8:11], s42 offen offset:1024 sc1
    v_mfma_f32_16x16x32_bf16 v[88:91], a[220:223], v[236:239], v[88:91]
    s_waitcnt vmcnt(14) lgkmcnt(1)
    v_cvt_pk_bf16_f32 v202, v252, v202
    v_fma_f32 v252, v249, s24, v251
    v_mfma_f32_16x16x32_bf16 v[92:95], a[224:227], v[236:239], v[92:95]
    ds_read_b128 v[236:239], v253 offset:31712
    v_fmac_f32 v251, -4.0, v249
    v_fma_f32 v249, v248, s24, v250
sub15:
    v_mfma_f32_16x16x32_bf16 v[96:99], a[228:231], v[228:231], v[96:99]
    buffer_load_dwordx4 a[200:203], v254, s[8:11], s42 offen offset:2048 sc1
    v_mfma_f32_16x16x32_bf16 v[100:103], a[232:235], v[228:231], v[100:103]
    s_mov_b32 s42, 592896
    v_fmac_f32 v250, -4.0, v248
    v_fma_f32 v248, v250, s26, v251
    v_mfma_f32_16x16x32_bf16 v[104:107], a[236:239], v[228:231], v[104:107]
    ds_read_b128 v[228:231], v253 offset:31456
    s_waitcnt vmcnt(12)
    s_waitcnt lgkmcnt(2)
    v_mfma_f32_16x16x32_bf16 v[104:107], a[248:251], v[232:235], v[104:107]
    v_fmac_f32 v251, s27, v250
    v_fma_f32 v250, v249, 2.0, v252
    v_mfma_f32_16x16x32_bf16 v[100:103], a[244:247], v[232:235], v[100:103]
    buffer_load_dwordx4 a[204:207], v254, s[8:11], s42 offen offset:0 sc1
    v_mfma_f32_16x16x32_bf16 v[96:99], a[240:243], v[232:235], v[96:99]
    s_waitcnt vmcnt(10) lgkmcnt(1)
    v_fmac_f32 v252, -2.0, v249
    v_fma_f32 v249, v196, s24, v200
    v_mfma_f32_16x16x32_bf16 v[96:99], a[252:255], v[236:239], v[96:99]
    v_fmac_f32 v200, -4.0, v196
    v_fma_f32 v196, v194, s24, v198
    v_mfma_f32_16x16x32_bf16 v[100:103], v[240:243], v[236:239], v[100:103]
    v_fmac_f32 v198, -4.0, v194
    v_fma_f32 v194, v198, s26, v200
    v_mfma_f32_16x16x32_bf16 v[104:107], v[244:247], v[236:239], v[104:107]
    buffer_load_dwordx4 a[208:211], v254, s[8:11], s42 offen offset:1024 sc1
    v_mfma_f32_16x16x32_bf16 v[108:111], a[228:231], v[232:235], v[108:111]
    v_fmac_f32 v200, s27, v198
    v_fma_f32 v198, v196, 2.0, v249
    v_mfma_f32_16x16x32_bf16 v[108:111], a[240:243], v[236:239], v[108:111]
    s_waitcnt lgkmcnt(0)
    v_fmac_f32 v249, -2.0, v196
    v_cvt_pk_bf16_f32 v194, v248, v194
    v_mfma_f32_16x16x32_bf16 v[108:111], a[252:255], v[228:231], v[108:111]
    v_cvt_pk_bf16_f32 v200, v251, v200
    v_cvt_pk_bf16_f32 v198, v250, v198
    v_mfma_f32_16x16x32_bf16 v[112:115], v[240:243], v[228:231], v[112:115]
    buffer_load_dwordx4 a[212:215], v254, s[8:11], s42 offen offset:2048 sc1
    v_mfma_f32_16x16x32_bf16 v[112:115], a[244:247], v[236:239], v[112:115]
    s_mov_b32 s42, 595968
    v_cvt_pk_bf16_f32 v196, v252, v249
    v_lshlrev_b32 v248, 16, v195
    v_mfma_f32_16x16x32_bf16 v[112:115], a[232:235], v[232:235], v[112:115]
    v_lshlrev_b32 v249, 16, v197
    v_lshlrev_b32 v250, 16, v199
    v_mfma_f32_16x16x32_bf16 v[116:119], a[236:239], v[232:235], v[116:119]
    ds_read_b128 v[232:235], v253 offset:31200
    v_lshlrev_b32 v251, 16, v201
    v_mfma_f32_16x16x32_bf16 v[116:119], a[248:251], v[236:239], v[116:119]
    buffer_load_dwordx4 a[216:219], v254, s[8:11], s42 offen offset:0 sc1
    v_mfma_f32_16x16x32_bf16 v[116:119], v[244:247], v[228:231], v[116:119]
    v_and_b32 v195, s22, v195
    v_and_b32 v197, s22, v197
    v_mfma_f32_16x16x32_bf16 v[120:123], a[228:231], v[236:239], v[120:123]
    v_and_b32 v199, s22, v199
    v_and_b32 v201, s22, v201
    v_mfma_f32_16x16x32_bf16 v[120:123], a[240:243], v[228:231], v[120:123]
    s_waitcnt lgkmcnt(0)
    v_lshlrev_b32 v252, 16, v193
    v_and_b32 v193, s22, v193
    v_mfma_f32_16x16x32_bf16 v[120:123], a[252:255], v[232:235], v[120:123]
    v_fmac_f32 v252, s25, v251
    v_fmac_f32 v193, s25, v201
    v_mfma_f32_16x16x32_bf16 v[124:127], v[240:243], v[232:235], v[124:127]
    buffer_load_dwordx4 a[220:223], v254, s[8:11], s42 offen offset:1024 sc1
    v_mfma_f32_16x16x32_bf16 v[124:127], a[244:247], v[228:231], v[124:127]
    v_fmac_f32 v252, s28, v249
    v_fmac_f32 v193, s28, v197
    v_mfma_f32_16x16x32_bf16 v[124:127], a[232:235], v[236:239], v[124:127]
    v_cvt_pk_bf16_f32 v193, v252, v193
    v_lshlrev_b32 v252, 16, v203
    v_mfma_f32_16x16x32_bf16 v[128:131], a[236:239], v[236:239], v[128:131]
    ds_read_b128 v[236:239], v253 offset:33024
    v_and_b32 v203, s22, v203
    v_mfma_f32_16x16x32_bf16 v[128:131], a[248:251], v[228:231], v[128:131]
    buffer_load_dwordx4 a[224:227], v254, s[8:11], s42 offen offset:2048 sc1
    v_mfma_f32_16x16x32_bf16 v[128:131], v[244:247], v[232:235], v[128:131]
    v_fmac_f32 v252, s29, v248
    v_fmac_f32 v203, s29, v195
    v_mfma_f32_16x16x32_bf16 v[132:135], a[228:231], v[228:231], v[132:135]
    v_and_b32 v227, 0x7fff, v255
    v_fmac_f32 v252, s23, v250
    v_mfma_f32_16x16x32_bf16 v[132:135], a[240:243], v[232:235], v[132:135]
    s_waitcnt lgkmcnt(0)
    v_fmac_f32 v203, s23, v199
    v_cvt_pk_bf16_f32 v203, v252, v203
    v_mfma_f32_16x16x32_bf16 v[132:135], a[252:255], v[236:239], v[132:135]
    buffer_load_dwordx2 v[216:217], v227, s[4:7], s16 offen offset:704
    v_mfma_f32_16x16x32_bf16 v[136:139], v[240:243], v[236:239], v[136:139]
    v_fma_f32 v252, v249, s24, v251
    v_fmac_f32 v251, -4.0, v249
    v_mfma_f32_16x16x32_bf16 v[136:139], a[244:247], v[232:235], v[136:139]
    v_fma_f32 v249, v248, s24, v250
    v_fmac_f32 v250, -4.0, v248
    v_mfma_f32_16x16x32_bf16 v[136:139], a[232:235], v[228:231], v[136:139]
    v_fma_f32 v248, v250, s26, v251
    v_fmac_f32 v251, s27, v250
    v_mfma_f32_16x16x32_bf16 v[140:143], a[236:239], v[228:231], v[140:143]
    ds_read_b128 v[228:231], v253 offset:32768
    v_fma_f32 v250, v249, 2.0, v252
    v_mfma_f32_16x16x32_bf16 v[140:143], a[248:251], v[232:235], v[140:143]
    buffer_load_dwordx2 v[218:219], v227, s[4:7], s17 offen offset:704
    v_mfma_f32_16x16x32_bf16 v[140:143], v[244:247], v[236:239], v[140:143]
    v_fmac_f32 v252, -2.0, v249
    v_fma_f32 v249, v197, s24, v201
    v_mfma_f32_16x16x32_bf16 v[144:147], a[228:231], v[232:235], v[144:147]
    v_fmac_f32 v201, -4.0, v197
    v_fma_f32 v197, v195, s24, v199
    v_mfma_f32_16x16x32_bf16 v[144:147], a[240:243], v[236:239], v[144:147]
    s_waitcnt lgkmcnt(0)
    v_fmac_f32 v199, -4.0, v195
    v_fma_f32 v195, v199, s26, v201
    v_mfma_f32_16x16x32_bf16 v[144:147], a[252:255], v[228:231], v[144:147]
    buffer_load_dwordx2 v[220:221], v227, s[4:7], s18 offen offset:704
    v_mfma_f32_16x16x32_bf16 v[148:151], v[240:243], v[228:231], v[148:151]
    v_fmac_f32 v201, s27, v199
    v_fma_f32 v199, v197, 2.0, v249
    v_fmac_f32 v249, -2.0, v197
    v_mfma_f32_16x16x32_bf16 v[148:151], a[244:247], v[236:239], v[148:151]
    v_cvt_pk_bf16_f32 v195, v248, v195
    v_cvt_pk_bf16_f32 v201, v251, v201
    v_mfma_f32_16x16x32_bf16 v[148:151], a[232:235], v[232:235], v[148:151]
    v_cvt_pk_bf16_f32 v199, v250, v199
    v_cvt_pk_bf16_f32 v197, v252, v249
    v_mfma_f32_16x16x32_bf16 v[152:155], a[236:239], v[232:235], v[152:155]
    ds_read_b128 v[232:235], v253 offset:32512
    v_lshrrev_b32 v252, 15, v255
    v_mfma_f32_16x16x32_bf16 v[152:155], a[248:251], v[236:239], v[152:155]
    buffer_load_dwordx2 v[222:223], v227, s[4:7], s19 offen offset:704
    v_mfma_f32_16x16x32_bf16 v[152:155], v[244:247], v[228:231], v[152:155]
    ds_write_b64 v252, v[194:195] offset:0
    v_mfma_f32_16x16x32_bf16 v[156:159], a[228:231], v[236:239], v[156:159]
    v_lshrrev_b32 v194, 15, v255
    v_mfma_f32_16x16x32_bf16 v[156:159], a[240:243], v[228:231], v[156:159]
    s_waitcnt lgkmcnt(1)
    s_waitcnt vmcnt(13)
    v_lshlrev_b32 v248, 16, v206
    v_mfma_f32_16x16x32_bf16 v[156:159], a[252:255], v[232:235], v[156:159]
    buffer_load_dwordx2 v[224:225], v227, s[4:7], s20 offen offset:704
    v_mfma_f32_16x16x32_bf16 v[160:163], v[240:243], v[232:235], v[160:163]
    ds_write_b64 v194, v[200:201] offset:2080
    v_mfma_f32_16x16x32_bf16 v[160:163], a[244:247], v[228:231], v[160:163]
    v_lshlrev_b32 v249, 16, v208
    v_lshlrev_b32 v250, 16, v210
    v_mfma_f32_16x16x32_bf16 v[160:163], a[232:235], v[236:239], v[160:163]
    ds_write_b64 v194, v[198:199] offset:4160
    v_mfma_f32_16x16x32_bf16 v[164:167], a[236:239], v[236:239], v[164:167]
    ds_read_b128 v[236:239], v253 offset:32256
    v_lshlrev_b32 v251, 16, v212
    v_mfma_f32_16x16x32_bf16 v[164:167], a[248:251], v[228:231], v[164:167]
    buffer_load_dwordx2 v[226:227], v227, s[4:7], s21 offen offset:704
    v_mfma_f32_16x16x32_bf16 v[164:167], v[244:247], v[232:235], v[164:167]
    ds_write_b64 v194, v[192:193] offset:20800
    v_mfma_f32_16x16x32_bf16 v[168:171], a[228:231], v[228:231], v[168:171]
    v_and_b32 v206, s22, v206
    v_and_b32 v208, s22, v208
    v_mfma_f32_16x16x32_bf16 v[168:171], a[240:243], v[232:235], v[168:171]
    s_waitcnt lgkmcnt(1)
    v_and_b32 v210, s22, v210
    v_and_b32 v212, s22, v212
    v_mfma_f32_16x16x32_bf16 v[168:171], a[252:255], v[236:239], v[168:171]
    ds_write_b64 v194, v[202:203] offset:29120
    v_mfma_f32_16x16x32_bf16 v[172:175], v[240:243], v[236:239], v[172:175]
    v_lshlrev_b32 v252, 16, v204
    v_and_b32 v204, s22, v204
    v_mfma_f32_16x16x32_bf16 v[172:175], a[244:247], v[232:235], v[172:175]
    ds_write_b64 v194, v[196:197] offset:6240
    v_mfma_f32_16x16x32_bf16 v[172:175], a[232:235], v[228:231], v[172:175]
    v_fmac_f32 v252, s25, v251
    v_fmac_f32 v204, s25, v212
    v_fmac_f32 v252, s28, v249
    v_mfma_f32_16x16x32_bf16 v[176:179], a[236:239], v[228:231], v[176:179]
    ds_read_b128 v[228:231], v253 offset:31984
    v_fmac_f32 v204, s28, v208
    v_mfma_f32_16x16x32_bf16 v[176:179], a[248:251], v[232:235], v[176:179]
    v_cvt_pk_bf16_f32 v204, v252, v204
    v_lshlrev_b32 v252, 16, v214
    v_mfma_f32_16x16x32_bf16 v[176:179], v[244:247], v[236:239], v[176:179]
    s_mov_b32 s42, 626688
    v_and_b32 v214, s22, v214
    v_fmac_f32 v252, s29, v248
    v_mfma_f32_16x16x32_bf16 v[180:183], a[228:231], v[232:235], v[180:183]
    s_waitcnt lgkmcnt(0)
    v_fmac_f32 v214, s29, v206
    v_fmac_f32 v252, s23, v250
    v_mfma_f32_16x16x32_bf16 v[184:187], a[232:235], v[232:235], v[184:187]
    s_barrier
    v_mfma_f32_16x16x32_bf16 v[188:191], a[236:239], v[232:235], v[188:191]
    ds_read_b128 v[232:235], v253 offset:1040
    v_fmac_f32 v214, s23, v210
    v_mfma_f32_16x16x32_bf16 v[188:191], a[248:251], v[236:239], v[188:191]
    buffer_load_dwordx4 a[228:231], v254, s[8:11], s42 offen offset:0 sc1
    v_mfma_f32_16x16x32_bf16 v[184:187], a[244:247], v[236:239], v[184:187]
    v_cvt_pk_bf16_f32 v214, v252, v214
    v_fma_f32 v252, v249, s24, v251
    v_mfma_f32_16x16x32_bf16 v[180:183], a[240:243], v[236:239], v[180:183]
    ds_read_b128 v[236:239], v253 offset:768
    v_fmac_f32 v251, -4.0, v249
    v_mfma_f32_16x16x32_bf16 v[180:183], a[252:255], v[228:231], v[180:183]
    buffer_load_dwordx4 a[232:235], v254, s[8:11], s42 offen offset:1024 sc1
    v_mfma_f32_16x16x32_bf16 v[184:187], v[240:243], v[228:231], v[184:187]
    s_waitcnt vmcnt(14) lgkmcnt(1)
    v_fma_f32 v249, v248, s24, v250
    v_fmac_f32 v250, -4.0, v248
    v_mfma_f32_16x16x32_bf16 v[188:191], v[244:247], v[228:231], v[188:191]
    ds_read_b128 v[228:231], v253 offset:512
    v_fma_f32 v248, v250, s26, v251
sub16:
    v_mfma_f32_16x16x32_bf16 a[0:3], a[192:195], v[232:235], a[0:3]
    buffer_load_dwordx4 a[236:239], v254, s[8:11], s42 offen offset:2048 sc1
    v_mfma_f32_16x16x32_bf16 a[4:7], a[196:199], v[232:235], a[4:7]
    s_mov_b32 s42, 629760
    v_fmac_f32 v251, s27, v250
    v_fma_f32 v250, v249, 2.0, v252
    v_mfma_f32_16x16x32_bf16 a[8:11], a[200:203], v[232:235], a[8:11]
    ds_read_b128 v[232:235], v253 offset:256
    s_waitcnt vmcnt(12)
    s_waitcnt lgkmcnt(2)
    v_mfma_f32_16x16x32_bf16 a[8:11], a[212:215], v[236:239], a[8:11]
    v_fmac_f32 v252, -2.0, v249
    v_fma_f32 v249, v208, s24, v212
    v_mfma_f32_16x16x32_bf16 a[4:7], a[208:211], v[236:239], a[4:7]
    buffer_load_dwordx4 a[240:243], v254, s[8:11], s42 offen offset:0 sc1
    v_mfma_f32_16x16x32_bf16 a[0:3], a[204:207], v[236:239], a[0:3]
    s_waitcnt vmcnt(10) lgkmcnt(1)
    v_fmac_f32 v212, -4.0, v208
    v_fma_f32 v208, v206, s24, v210
    v_mfma_f32_16x16x32_bf16 a[0:3], a[216:219], v[228:231], a[0:3]
    v_fmac_f32 v210, -4.0, v206
    v_fma_f32 v206, v210, s26, v212
    v_mfma_f32_16x16x32_bf16 a[4:7], a[220:223], v[228:231], a[4:7]
    v_fmac_f32 v212, s27, v210
    v_fma_f32 v210, v208, 2.0, v249
    v_fmac_f32 v249, -2.0, v208
    v_mfma_f32_16x16x32_bf16 a[8:11], a[224:227], v[228:231], a[8:11]
    buffer_load_dwordx4 a[244:247], v254, s[8:11], s42 offen offset:1024 sc1
    v_mfma_f32_16x16x32_bf16 a[12:15], a[192:195], v[236:239], a[12:15]
    v_cvt_pk_bf16_f32 v206, v248, v206
    v_cvt_pk_bf16_f32 v212, v251, v212
    v_mfma_f32_16x16x32_bf16 a[12:15], a[204:207], v[228:231], a[12:15]
    s_waitcnt lgkmcnt(0)
    v_cvt_pk_bf16_f32 v210, v250, v210
    v_cvt_pk_bf16_f32 v208, v252, v249
    v_mfma_f32_16x16x32_bf16 a[12:15], a[216:219], v[232:235], a[12:15]
    v_lshlrev_b32 v248, 16, v207
    v_lshlrev_b32 v249, 16, v209
    v_mfma_f32_16x16x32_bf16 a[16:19], a[220:223], v[232:235], a[16:19]
    buffer_load_dwordx4 a[248:251], v254, s[8:11], s42 offen offset:2048 sc1
    v_mfma_f32_16x16x32_bf16 a[16:19], a[208:211], v[228:231], a[16:19]
    s_mov_b32 s42, 632832
    v_lshlrev_b32 v250, 16, v211
    v_lshlrev_b32 v251, 16, v213
    v_mfma_f32_16x16x32_bf16 a[16:19], a[196:199], v[236:239], a[16:19]
    v_and_b32 v207, s22, v207
    v_and_b32 v209, s22, v209
    v_mfma_f32_16x16x32_bf16 a[20:23], a[200:203], v[236:239], a[20:23]
    ds_read_b128 v[236:239], v253 offset:0
    v_and_b32 v211, s22, v211
    v_mfma_f32_16x16x32_bf16 a[20:23], a[212:215], v[228:231], a[20:23]
    buffer_load_dwordx4 a[252:255], v254, s[8:11], s42 offen offset:0 sc1
    v_mfma_f32_16x16x32_bf16 a[20:23], a[224:227], v[232:235], a[20:23]
    v_and_b32 v213, s22, v213
    v_lshlrev_b32 v252, 16, v205
    v_mfma_f32_16x16x32_bf16 a[24:27], a[192:195], v[228:231], a[24:27]
    v_and_b32 v205, s22, v205
    v_fmac_f32 v252, s25, v251
    v_mfma_f32_16x16x32_bf16 a[24:27], a[204:207], v[232:235], a[24:27]
    s_waitcnt lgkmcnt(0)
    v_fmac_f32 v205, s25, v213
    v_fmac_f32 v252, s28, v249
    v_mfma_f32_16x16x32_bf16 a[24:27], a[216:219], v[236:239], a[24:27]
    v_fmac_f32 v205, s28, v209
    v_cvt_pk_bf16_f32 v205, v252, v205
    v_mfma_f32_16x16x32_bf16 a[28:31], a[220:223], v[236:239], a[28:31]
    buffer_load_dwordx4 v[240:243], v254, s[8:11], s42 offen offset:1024 sc1
    v_mfma_f32_16x16x32_bf16 a[28:31], a[208:211], v[232:235], a[28:31]
    v_lshlrev_b32 v252, 16, v215
    v_and_b32 v215, s22, v215
    v_mfma_f32_16x16x32_bf16 a[28:31], a[196:199], v[228:231], a[28:31]
    v_fmac_f32 v252, s29, v248
    v_fmac_f32 v215, s29, v207
    v_mfma_f32_16x16x32_bf16 a[32:35], a[200:203], v[228:231], a[32:35]
    ds_read_b128 v[228:231], v253 offset:1824
    v_fmac_f32 v252, s23, v250
    v_mfma_f32_16x16x32_bf16 a[32:35], a[212:215], v[232:235], a[32:35]
    buffer_load_dwordx4 v[244:247], v254, s[8:11], s42 offen offset:2048 sc1
    v_mfma_f32_16x16x32_bf16 a[32:35], a[224:227], v[236:239], a[32:35]
    v_fmac_f32 v215, s23, v211
    v_cvt_pk_bf16_f32 v215, v252, v215
    v_mfma_f32_16x16x32_bf16 a[36:39], a[192:195], v[232:235], a[36:39]
    v_and_b32 v203, 0x7fff, v255
    v_fma_f32 v252, v249, s24, v251
    v_fmac_f32 v251, -4.0, v249
    v_mfma_f32_16x16x32_bf16 a[36:39], a[204:207], v[236:239], a[36:39]
    s_waitcnt lgkmcnt(0)
    v_fma_f32 v249, v248, s24, v250
    v_fmac_f32 v250, -4.0, v248
    v_mfma_f32_16x16x32_bf16 a[36:39], a[216:219], v[228:231], a[36:39]
    buffer_load_dwordx2 v[192:193], v203, s[4:7], s16 offen offset:1088
    v_mfma_f32_16x16x32_bf16 a[40:43], a[220:223], v[228:231], a[40:43]
    v_fma_f32 v248, v250, s26, v251
    v_fmac_f32 v251, s27, v250
    v_mfma_f32_16x16x32_bf16 a[40:43], a[208:211], v[236:239], a[40:43]
    v_fma_f32 v250, v249, 2.0, v252
    v_fmac_f32 v252, -2.0, v249
    v_mfma_f32_16x16x32_bf16 a[40:43], a[196:199], v[232:235], a[40:43]
    v_fma_f32 v249, v209, s24, v213
    v_fmac_f32 v213, -4.0, v209
    v_mfma_f32_16x16x32_bf16 a[44:47], a[200:203], v[232:235], a[44:47]
    ds_read_b128 v[232:235], v253 offset:1568
    v_fma_f32 v209, v207, s24, v211
    v_mfma_f32_16x16x32_bf16 a[44:47], a[212:215], v[236:239], a[44:47]
    buffer_load_dwordx2 v[194:195], v203, s[4:7], s17 offen offset:1088
    v_mfma_f32_16x16x32_bf16 a[44:47], a[224:227], v[228:231], a[44:47]
    v_fmac_f32 v211, -4.0, v207
    v_fma_f32 v207, v211, s26, v213
    v_mfma_f32_16x16x32_bf16 a[48:51], a[192:195], v[236:239], a[48:51]
    v_fmac_f32 v213, s27, v211
    v_fma_f32 v211, v209, 2.0, v249
    v_mfma_f32_16x16x32_bf16 a[48:51], a[204:207], v[228:231], a[48:51]
    s_waitcnt lgkmcnt(0)
    v_fmac_f32 v249, -2.0, v209
    v_cvt_pk_bf16_f32 v207, v248, v207
    v_mfma_f32_16x16x32_bf16 a[48:51], a[216:219], v[232:235], a[48:51]
    buffer_load_dwordx2 v[196:197], v203, s[4:7], s18 offen offset:1088
    v_mfma_f32_16x16x32_bf16 a[52:55], a[220:223], v[232:235], a[52:55]
    v_cvt_pk_bf16_f32 v213, v251, v213
    v_cvt_pk_bf16_f32 v211, v250, v211
    v_mfma_f32_16x16x32_bf16 a[52:55], a[208:211], v[228:231], a[52:55]
    v_cvt_pk_bf16_f32 v209, v252, v249
    v_lshrrev_b32 v252, 15, v255
    v_mfma_f32_16x16x32_bf16 a[52:55], a[196:199], v[236:239], a[52:55]
    ds_write_b64 v252, v[206:207] offset:9088
    v_mfma_f32_16x16x32_bf16 a[56:59], a[200:203], v[236:239], a[56:59]
    ds_read_b128 v[236:239], v253 offset:1312
    v_lshrrev_b32 v206, 15, v255
    v_mfma_f32_16x16x32_bf16 a[56:59], a[212:215], v[228:231], a[56:59]
    buffer_load_dwordx2 v[198:199], v203, s[4:7], s19 offen offset:1088
    v_mfma_f32_16x16x32_bf16 a[56:59], a[224:227], v[232:235], a[56:59]
    ds_write_b64 v206, v[212:213] offset:11168
    v_mfma_f32_16x16x32_bf16 a[60:63], a[192:195], v[228:231], a[60:63]
    v_mfma_f32_16x16x32_bf16 a[60:63], a[204:207], v[232:235], a[60:63]
    s_waitcnt lgkmcnt(1)
    s_waitcnt vmcnt(13)
    v_lshlrev_b32 v248, 16, v218
    v_mfma_f32_16x16x32_bf16 a[60:63], a[216:219], v[236:239], a[60:63]
    buffer_load_dwordx2 v[200:201], v203, s[4:7], s20 offen offset:1088
    v_lshlrev_b32 v249, 16, v220
    v_mfma_f32_16x16x32_bf16 a[64:67], a[220:223], v[236:239], a[64:67]
    ds_write_b64 v206, v[210:211] offset:13248
    v_mfma_f32_16x16x32_bf16 a[64:67], a[208:211], v[232:235], a[64:67]
    v_lshlrev_b32 v250, 16, v222
    v_lshlrev_b32 v251, 16, v224
    v_mfma_f32_16x16x32_bf16 a[64:67], a[196:199], v[228:231], a[64:67]
    ds_write_b64 v206, v[204:205] offset:23648
    v_mfma_f32_16x16x32_bf16 a[68:71], a[200:203], v[228:231], a[68:71]
    ds_read_b128 v[228:231], v253 offset:1056
    v_and_b32 v218, s22, v218
    v_mfma_f32_16x16x32_bf16 a[68:71], a[212:215], v[232:235], a[68:71]
    buffer_load_dwordx2 v[202:203], v203, s[4:7], s21 offen offset:1088
    v_mfma_f32_16x16x32_bf16 a[68:71], a[224:227], v[236:239], a[68:71]
    ds_write_b64 v206, v[214:215] offset:31968
    v_mfma_f32_16x16x32_bf16 a[72:75], a[192:195], v[232:235], a[72:75]
    v_and_b32 v220, s22, v220
    v_and_b32 v222, s22, v222
    v_mfma_f32_16x16x32_bf16 a[72:75], a[204:207], v[236:239], a[72:75]
    s_waitcnt lgkmcnt(1)
    v_and_b32 v224, s22, v224
    v_lshlrev_b32 v252, 16, v216
    v_mfma_f32_16x16x32_bf16 a[72:75], a[216:219], v[228:231], a[72:75]
    v_and_b32 v216, s22, v216
    v_fmac_f32 v252, s25, v251
    v_mfma_f32_16x16x32_bf16 a[76:79], a[220:223], v[228:231], a[76:79]
    v_fmac_f32 v216, s25, v224
    v_fmac_f32 v252, s28, v249
    v_mfma_f32_16x16x32_bf16 a[76:79], a[208:211], v[236:239], a[76:79]
    v_fmac_f32 v216, s28, v220
    v_cvt_pk_bf16_f32 v216, v252, v216
    v_mfma_f32_16x16x32_bf16 a[76:79], a[196:199], v[232:235], a[76:79]
    v_lshlrev_b32 v252, 16, v226
    v_and_b32 v226, s22, v226
    v_mfma_f32_16x16x32_bf16 a[80:83], a[200:203], v[232:235], a[80:83]
    ds_read_b128 v[232:235], v253 offset:784
    v_fmac_f32 v252, s29, v248
    v_mfma_f32_16x16x32_bf16 a[80:83], a[212:215], v[236:239], a[80:83]
    v_fmac_f32 v226, s29, v218
    v_fmac_f32 v252, s23, v250
    v_mfma_f32_16x16x32_bf16 a[80:83], a[224:227], v[228:231], a[80:83]
    s_mov_b32 s42, 663552
    v_fmac_f32 v226, s23, v222
    v_cvt_pk_bf16_f32 v226, v252, v226
    v_mfma_f32_16x16x32_bf16 a[84:87], a[192:195], v[236:239], a[84:87]
    s_waitcnt lgkmcnt(0)
    v_fma_f32 v252, v249, s24, v251
    v_fmac_f32 v251, -4.0, v249
    v_mfma_f32_16x16x32_bf16 a[88:91], a[196:199], v[236:239], a[88:91]
    s_barrier
    v_mfma_f32_16x16x32_bf16 a[92:95], a[200:203], v[236:239], a[92:95]
    ds_read_b128 v[236:239], v253 offset:3120
    v_fma_f32 v249, v248, s24, v250
    v_mfma_f32_16x16x32_bf16 a[92:95], a[212:215], v[228:231], a[92:95]
    buffer_load_dwordx4 a[192:195], v254, s[8:11], s42 offen offset:0 sc1
    v_mfma_f32_16x16x32_bf16 a[88:91], a[208:211], v[228:231], a[88:91]
    v_fmac_f32 v250, -4.0, v248
    v_fma_f32 v248, v250, s26, v251
    v_fmac_f32 v251, s27, v250
    v_mfma_f32_16x16x32_bf16 a[84:87], a[204:207], v[228:231], a[84:87]
    ds_read_b128 v[228:231], v253 offset:2848
    v_fma_f32 v250, v249, 2.0, v252
    v_mfma_f32_16x16x32_bf16 a[84:87], a[216:219], v[232:235], a[84:87]
    buffer_load_dwordx4 a[196:199], v254, s[8:11], s42 offen offset:1024 sc1
    v_mfma_f32_16x16x32_bf16 a[88:91], a[220:223], v[232:235], a[88:91]
    s_waitcnt vmcnt(14) lgkmcnt(1)
    v_fmac_f32 v252, -2.0, v249
    v_fma_f32 v249, v220, s24, v224
    v_mfma_f32_16x16x32_bf16 a[92:95], a[224:227], v[232:235], a[92:95]
    ds_read_b128 v[232:235], v253 offset:2592
    v_fmac_f32 v224, -4.0, v220
sub17:
    v_mfma_f32_16x16x32_bf16 a[96:99], a[228:231], v[236:239], a[96:99]
    buffer_load_dwordx4 a[200:203], v254, s[8:11], s42 offen offset:2048 sc1
    v_mfma_f32_16x16x32_bf16 a[100:103], a[232:235], v[236:239], a[100:103]
    s_mov_b32 s42, 666624
    v_fma_f32 v220, v218, s24, v222
    v_fmac_f32 v222, -4.0, v218
    v_mfma_f32_16x16x32_bf16 a[104:107], a[236:239], v[236:239], a[104:107]
    ds_read_b128 v[236:239], v253 offset:2336
    s_waitcnt vmcnt(12)
    s_waitcnt lgkmcnt(2)
    v_mfma_f32_16x16x32_bf16 a[104:107], a[248:251], v[228:231], a[104:107]
    ds_write_b64 v206, v[208:209] offset:768
    v_mfma_f32_16x16x32_bf16 a[100:103], a[244:247], v[228:231], a[100:103]
    buffer_load_dwordx4 a[204:207], v254, s[8:11], s42 offen offset:0 sc1
    v_mfma_f32_16x16x32_bf16 a[96:99], a[240:243], v[228:231], a[96:99]
    s_waitcnt vmcnt(10) lgkmcnt(2)
    v_fma_f32 v218, v222, s26, v224
    v_fmac_f32 v224, s27, v222
    v_mfma_f32_16x16x32_bf16 a[96:99], a[252:255], v[232:235], a[96:99]
    v_fma_f32 v222, v220, 2.0, v249
    v_fmac_f32 v249, -2.0, v220
    v_mfma_f32_16x16x32_bf16 a[100:103], v[240:243], v[232:235], a[100:103]
    v_cvt_pk_bf16_f32 v218, v248, v218
    v_cvt_pk_bf16_f32 v224, v251, v224
    v_mfma_f32_16x16x32_bf16 a[104:107], v[244:247], v[232:235], a[104:107]
    buffer_load_dwordx4 a[208:211], v254, s[8:11], s42 offen offset:1024 sc1
    v_mfma_f32_16x16x32_bf16 a[108:111], a[228:231], v[228:231], a[108:111]
    v_cvt_pk_bf16_f32 v222, v250, v222
    v_cvt_pk_bf16_f32 v220, v252, v249
    v_mfma_f32_16x16x32_bf16 a[108:111], a[240:243], v[232:235], a[108:111]
    s_waitcnt lgkmcnt(1)
    v_lshlrev_b32 v248, 16, v219
    v_lshlrev_b32 v249, 16, v221
    v_mfma_f32_16x16x32_bf16 a[108:111], a[252:255], v[236:239], a[108:111]
    v_lshlrev_b32 v250, 16, v223
    v_lshlrev_b32 v251, 16, v225
    v_mfma_f32_16x16x32_bf16 a[112:115], v[240:243], v[236:239], a[112:115]
    buffer_load_dwordx4 a[212:215], v254, s[8:11], s42 offen offset:2048 sc1
    v_mfma_f32_16x16x32_bf16 a[112:115], a[244:247], v[232:235], a[112:115]
    s_mov_b32 s42, 669696
    v_and_b32 v219, s22, v219
    v_and_b32 v221, s22, v221
    v_mfma_f32_16x16x32_bf16 a[112:115], a[232:235], v[228:231], a[112:115]
    v_and_b32 v223, s22, v223
    v_and_b32 v225, s22, v225
    v_mfma_f32_16x16x32_bf16 a[116:119], a[236:239], v[228:231], a[116:119]
    ds_read_b128 v[228:231], v253 offset:2080
    v_lshlrev_b32 v252, 16, v217
    v_and_b32 v217, s22, v217
    v_mfma_f32_16x16x32_bf16 a[116:119], a[248:251], v[232:235], a[116:119]
    buffer_load_dwordx4 a[216:219], v254, s[8:11], s42 offen offset:0 sc1
    v_mfma_f32_16x16x32_bf16 a[116:119], v[244:247], v[236:239], a[116:119]
    v_fmac_f32 v252, s25, v251
    v_fmac_f32 v217, s25, v225
    v_mfma_f32_16x16x32_bf16 a[120:123], a[228:231], v[232:235], a[120:123]
    v_fmac_f32 v252, s28, v249
    v_fmac_f32 v217, s28, v221
    v_mfma_f32_16x16x32_bf16 a[120:123], a[240:243], v[236:239], a[120:123]
    s_waitcnt lgkmcnt(0)
    v_cvt_pk_bf16_f32 v217, v252, v217
    v_lshlrev_b32 v252, 16, v227
    v_mfma_f32_16x16x32_bf16 a[120:123], a[252:255], v[228:231], a[120:123]
    v_and_b32 v227, s22, v227
    v_fmac_f32 v252, s29, v248
    v_mfma_f32_16x16x32_bf16 a[124:127], v[240:243], v[228:231], a[124:127]
    buffer_load_dwordx4 a[220:223], v254, s[8:11], s42 offen offset:1024 sc1
    v_mfma_f32_16x16x32_bf16 a[124:127], a[244:247], v[236:239], a[124:127]
    v_fmac_f32 v227, s29, v219
    v_fmac_f32 v252, s23, v250
    v_mfma_f32_16x16x32_bf16 a[124:127], a[232:235], v[232:235], a[124:127]
    v_fmac_f32 v227, s23, v223
    v_cvt_pk_bf16_f32 v227, v252, v227
    v_mfma_f32_16x16x32_bf16 a[128:131], a[236:239], v[232:235], a[128:131]
    ds_read_b128 v[232:235], v253 offset:3904
    v_fma_f32 v252, v249, s24, v251
    v_mfma_f32_16x16x32_bf16 a[128:131], a[248:251], v[236:239], a[128:131]
    buffer_load_dwordx4 a[224:227], v254, s[8:11], s42 offen offset:2048 sc1
    v_mfma_f32_16x16x32_bf16 a[128:131], v[244:247], v[228:231], a[128:131]
    v_fmac_f32 v251, -4.0, v249
    v_fma_f32 v249, v248, s24, v250
    v_mfma_f32_16x16x32_bf16 a[132:135], a[228:231], v[236:239], a[132:135]
    v_and_b32 v215, 0x7fff, v255
    v_fmac_f32 v250, -4.0, v248
    v_mfma_f32_16x16x32_bf16 a[132:135], a[240:243], v[228:231], a[132:135]
    s_waitcnt lgkmcnt(0)
    v_fma_f32 v248, v250, s26, v251
    v_fmac_f32 v251, s27, v250
    v_mfma_f32_16x16x32_bf16 a[132:135], a[252:255], v[232:235], a[132:135]
    buffer_load_dwordx2 v[204:205], v215, s[4:7], s16 offen offset:1472
    v_mfma_f32_16x16x32_bf16 a[136:139], v[240:243], v[232:235], a[136:139]
    v_fma_f32 v250, v249, 2.0, v252
    v_fmac_f32 v252, -2.0, v249
    v_mfma_f32_16x16x32_bf16 a[136:139], a[244:247], v[228:231], a[136:139]
    v_fma_f32 v249, v221, s24, v225
    v_fmac_f32 v225, -4.0, v221
    v_mfma_f32_16x16x32_bf16 a[136:139], a[232:235], v[236:239], a[136:139]
    v_fma_f32 v221, v219, s24, v223
    v_fmac_f32 v223, -4.0, v219
    v_mfma_f32_16x16x32_bf16 a[140:143], a[236:239], v[236:239], a[140:143]
    ds_read_b128 v[236:239], v253 offset:3648
    v_fma_f32 v219, v223, s26, v225
    v_mfma_f32_16x16x32_bf16 a[140:143], a[248:251], v[228:231], a[140:143]
    buffer_load_dwordx2 v[206:207], v215, s[4:7], s17 offen offset:1472
    v_mfma_f32_16x16x32_bf16 a[140:143], v[244:247], v[232:235], a[140:143]
    v_fmac_f32 v225, s27, v223
    v_fma_f32 v223, v221, 2.0, v249
    v_fmac_f32 v249, -2.0, v221
    v_mfma_f32_16x16x32_bf16 a[144:147], a[228:231], v[228:231], a[144:147]
    v_cvt_pk_bf16_f32 v219, v248, v219
    v_cvt_pk_bf16_f32 v225, v251, v225
    v_mfma_f32_16x16x32_bf16 a[144:147], a[240:243], v[232:235], a[144:147]
    s_waitcnt lgkmcnt(0)
    v_cvt_pk_bf16_f32 v223, v250, v223
    v_cvt_pk_bf16_f32 v221, v252, v249
    v_mfma_f32_16x16x32_bf16 a[144:147], a[252:255], v[236:239], a[144:147]
    buffer_load_dwordx2 v[208:209], v215, s[4:7], s18 offen offset:1472
    v_mfma_f32_16x16x32_bf16 a[148:151], v[240:243], v[236:239], a[148:151]
    v_lshrrev_b32 v252, 15, v255
    v_mfma_f32_16x16x32_bf16 a[148:151], a[244:247], v[232:235], a[148:151]
    ds_write_b64 v252, v[218:219] offset:8832
    v_mfma_f32_16x16x32_bf16 a[148:151], a[232:235], v[228:231], a[148:151]
    v_lshrrev_b32 v218, 15, v255
    v_mfma_f32_16x16x32_bf16 a[152:155], a[236:239], v[228:231], a[152:155]
    ds_read_b128 v[228:231], v253 offset:3392
    v_mfma_f32_16x16x32_bf16 a[152:155], a[248:251], v[232:235], a[152:155]
    buffer_load_dwordx2 v[210:211], v215, s[4:7], s19 offen offset:1472
    v_mfma_f32_16x16x32_bf16 a[152:155], v[244:247], v[236:239], a[152:155]
pad6:
    s_cbranch_vccnz pad10
    ds_write_b64 v218, v[224:225] offset:10912
    v_mfma_f32_16x16x32_bf16 a[156:159], a[228:231], v[232:235], a[156:159]
    v_mfma_f32_16x16x32_bf16 a[156:159], a[240:243], v[236:239], a[156:159]
    s_waitcnt lgkmcnt(1)
    s_waitcnt vmcnt(13)
    v_lshlrev_b32 v248, 16, v194
    v_mfma_f32_16x16x32_bf16 a[156:159], a[252:255], v[228:231], a[156:159]
    buffer_load_dwordx2 v[212:213], v215, s[4:7], s20 offen offset:1472
    v_mfma_f32_16x16x32_bf16 a[160:163], v[240:243], v[228:231], a[160:163]
    ds_write_b64 v218, v[222:223] offset:12992
    v_mfma_f32_16x16x32_bf16 a[160:163], a[244:247], v[236:239], a[160:163]
    v_lshlrev_b32 v249, 16, v196
    v_lshlrev_b32 v250, 16, v198
    v_mfma_f32_16x16x32_bf16 a[160:163], a[232:235], v[232:235], a[160:163]
    ds_write_b64 v218, v[216:217] offset:23392
    v_mfma_f32_16x16x32_bf16 a[164:167], a[236:239], v[232:235], a[164:167]
    ds_read_b128 v[232:235], v253 offset:3136
    v_lshlrev_b32 v251, 16, v200
    v_mfma_f32_16x16x32_bf16 a[164:167], a[248:251], v[236:239], a[164:167]
    buffer_load_dwordx2 v[214:215], v215, s[4:7], s21 offen offset:1472
    v_mfma_f32_16x16x32_bf16 a[164:167], v[244:247], v[228:231], a[164:167]
    s_add_u32 s49, s49, 8
    v_and_b32 v194, s22, v194
    v_and_b32 v196, s22, v196
    v_mfma_f32_16x16x32_bf16 a[168:171], a[228:231], v[236:239], a[168:171]
    ds_write_b64 v218, v[226:227] offset:31712
    v_mfma_f32_16x16x32_bf16 a[168:171], a[240:243], v[228:231], a[168:171]
    s_waitcnt lgkmcnt(1)
    v_and_b32 v198, s22, v198
    v_and_b32 v200, s22, v200
    v_lshlrev_b32 v252, 16, v192
    v_mfma_f32_16x16x32_bf16 a[168:171], a[252:255], v[232:235], a[168:171]
    s_cmp_eq_u32 s39, 1
    s_cselect_b32 s49, 128, s49
    s_cselect_b32 s36, 2130706432, 0
    v_mfma_f32_16x16x32_bf16 a[172:175], v[240:243], v[232:235], a[172:175]
    ds_write_b64 v218, v[220:221] offset:512
    v_mfma_f32_16x16x32_bf16 a[172:175], a[244:247], v[228:231], a[172:175]
    ds_read_b128 v[216:219], v253 offset:40480
    s_mov_b32 s45, 503518347
    v_mfma_f32_16x16x32_bf16 a[172:175], a[232:235], v[236:239], a[172:175]
    s_mul_i32 s43, s49, 786432
    v_bfe_u32 v220, v254, 5, 3
    v_mul_u32_u24 v221, 5, v220
    v_mfma_f32_16x16x32_bf16 a[176:179], a[236:239], v[236:239], a[176:179]
    ds_read_b128 v[236:239], v253 offset:2864
    v_bfe_u32 v221, s45, v221, 5
    v_mfma_f32_16x16x32_bf16 a[176:179], a[248:251], v[228:231], a[176:179]
    v_mul_u32_u24 v221, 65, v221
    v_sub_u32 v221, v221, v220
    v_mfma_f32_16x16x32_bf16 a[176:179], v[244:247], v[232:235], a[176:179]
    s_mov_b32 s42, 700416
    s_add_u32 s43, s43, s53
    v_lshl_add_u32 v220, v221, 5, v253
    v_mfma_f32_16x16x32_bf16 a[180:183], a[228:231], v[228:231], a[180:183]
    s_waitcnt lgkmcnt(1)
    v_and_b32 v192, s22, v192
    v_fmac_f32 v252, s25, v251
    v_mfma_f32_16x16x32_bf16 a[184:187], a[232:235], v[228:231], a[184:187]
    s_mov_b64 exec, s[46:47]
    ds_write_b128 v220, v[216:219] offset:1024
    s_mov_b64 exec, -1
    v_mfma_f32_16x16x32_bf16 a[188:191], a[236:239], v[228:231], a[188:191]
    ds_read_b128 v[228:231], v253 offset:5200
    v_fmac_f32 v192, s25, v200
    v_mfma_f32_16x16x32_bf16 a[188:191], a[248:251], v[232:235], a[188:191]
    buffer_load_dwordx4 a[228:231], v254, s[8:11], s42 offen offset:0 sc1
    v_mfma_f32_16x16x32_bf16 a[184:187], a[244:247], v[232:235], a[184:187]
    s_waitcnt lgkmcnt(2)
    v_fmac_f32 v252, s28, v249
    v_fmac_f32 v192, s28, v196
    v_mfma_f32_16x16x32_bf16 a[180:183], a[240:243], v[232:235], a[180:183]
    ds_read_b128 v[232:235], v253 offset:4928
    v_cvt_pk_bf16_f32 v192, v252, v192
    v_mfma_f32_16x16x32_bf16 a[180:183], a[252:255], v[236:239], a[180:183]
    buffer_load_dwordx4 a[232:235], v254, s[8:11], s42 offen offset:1024 sc1
    v_mfma_f32_16x16x32_bf16 a[184:187], v[240:243], v[236:239], a[184:187]
    s_waitcnt vmcnt(14) lgkmcnt(1)
    v_lshlrev_b32 v252, 16, v202
    v_and_b32 v202, s22, v202
    v_mfma_f32_16x16x32_bf16 a[188:191], v[244:247], v[236:239], a[188:191]
    ds_read_b128 v[236:239], v253 offset:4672
    v_fmac_f32 v252, s29, v248
sub18:
    v_mfma_f32_16x16x32_bf16 v[0:3], a[192:195], v[228:231], v[0:3]
    buffer_load_dwordx4 a[236:239], v254, s[8:11], s42 offen offset:2048 sc1
    v_mfma_f32_16x16x32_bf16 v[4:7], a[196:199], v[228:231], v[4:7]
    s_mov_b32 s42, 703488
    v_fmac_f32 v202, s29, v194
    v_fmac_f32 v252, s23, v250
    v_mfma_f32_16x16x32_bf16 v[8:11], a[200:203], v[228:231], v[8:11]
    ds_read_b128 v[228:231], v253 offset:4416
    s_waitcnt vmcnt(12)
    s_waitcnt lgkmcnt(2)
    v_mfma_f32_16x16x32_bf16 v[8:11], a[212:215], v[232:235], v[8:11]
    s_cmp_ge_u32 s49, 128
    s_cselect_b32 s43, 2130706432, s43
    s_sub_u32 s16, s43, 196608
    v_fmac_f32 v202, s23, v198
    v_mfma_f32_16x16x32_bf16 v[4:7], a[208:211], v[232:235], v[4:7]
    buffer_load_dwordx4 a[240:243], v254, s[8:11], s42 offen offset:0 sc1
    v_mfma_f32_16x16x32_bf16 v[0:3], a[204:207], v[232:235], v[0:3]
    s_waitcnt vmcnt(10) lgkmcnt(1)
    v_cvt_pk_bf16_f32 v202, v252, v202
    v_fma_f32 v252, v249, s24, v251
    v_mfma_f32_16x16x32_bf16 v[0:3], a[216:219], v[236:239], v[0:3]
    s_cmp_eq_u32 s49, 0
    s_cselect_b32 s16, 2130706432, s16
    s_mov_b32 s17, s43
    v_mfma_f32_16x16x32_bf16 v[4:7], a[220:223], v[236:239], v[4:7]
    s_add_u32 s18, s43, 196608
    v_fmac_f32 v251, -4.0, v249
    v_fma_f32 v249, v248, s24, v250
    v_mfma_f32_16x16x32_bf16 v[8:11], a[224:227], v[236:239], v[8:11]
    buffer_load_dwordx4 a[244:247], v254, s[8:11], s42 offen offset:1024 sc1
    v_mfma_f32_16x16x32_bf16 v[12:15], a[192:195], v[232:235], v[12:15]
    s_add_u32 s19, s43, 393216
    v_fmac_f32 v250, -4.0, v248
    v_fma_f32 v248, v250, s26, v251
    v_mfma_f32_16x16x32_bf16 v[12:15], a[204:207], v[236:239], v[12:15]
    s_waitcnt lgkmcnt(0)
    v_fmac_f32 v251, s27, v250
    v_fma_f32 v250, v249, 2.0, v252
    v_mfma_f32_16x16x32_bf16 v[12:15], a[216:219], v[228:231], v[12:15]
    v_fmac_f32 v252, -2.0, v249
    v_fma_f32 v249, v196, s24, v200
    v_mfma_f32_16x16x32_bf16 v[16:19], a[220:223], v[228:231], v[16:19]
    buffer_load_dwordx4 a[248:251], v254, s[8:11], s42 offen offset:2048 sc1
    v_mfma_f32_16x16x32_bf16 v[16:19], a[208:211], v[236:239], v[16:19]
    s_mov_b32 s42, 706560
    s_add_u32 s20, s43, 589824
    v_fmac_f32 v200, -4.0, v196
    v_mfma_f32_16x16x32_bf16 v[16:19], a[196:199], v[232:235], v[16:19]
    v_fma_f32 v196, v194, s24, v198
    v_fmac_f32 v198, -4.0, v194
    v_mfma_f32_16x16x32_bf16 v[20:23], a[200:203], v[232:235], v[20:23]
    ds_read_b128 v[232:235], v253 offset:4160
    v_fma_f32 v194, v198, s26, v200
    v_mfma_f32_16x16x32_bf16 v[20:23], a[212:215], v[236:239], v[20:23]
    buffer_load_dwordx4 a[252:255], v254, s[8:11], s42 offen offset:0 sc1
    v_mfma_f32_16x16x32_bf16 v[20:23], a[224:227], v[228:231], v[20:23]
    s_add_u32 s21, s43, 786432
    v_fmac_f32 v200, s27, v198
    v_fma_f32 v198, v196, 2.0, v249
    v_mfma_f32_16x16x32_bf16 v[24:27], a[192:195], v[236:239], v[24:27]
    v_fmac_f32 v249, -2.0, v196
    v_cvt_pk_bf16_f32 v194, v248, v194
    v_mfma_f32_16x16x32_bf16 v[24:27], a[204:207], v[228:231], v[24:27]
    s_waitcnt lgkmcnt(0)
    s_add_u32 s100, s43, s101
    v_cvt_pk_bf16_f32 v200, v251, v200
    v_mfma_f32_16x16x32_bf16 v[24:27], a[216:219], v[232:235], v[24:27]
    v_cvt_pk_bf16_f32 v198, v250, v198
    v_cvt_pk_bf16_f32 v196, v252, v249
    v_mfma_f32_16x16x32_bf16 v[28:31], a[220:223], v[232:235], v[28:31]
    buffer_load_dwordx4 v[240:243], v254, s[8:11], s42 offen offset:1024 sc1
    v_mfma_f32_16x16x32_bf16 v[28:31], a[208:211], v[228:231], v[28:31]
    s_add_u32 s37, s43, s33
    v_lshlrev_b32 v248, 16, v195
    v_lshlrev_b32 v249, 16, v197
    v_mfma_f32_16x16x32_bf16 v[28:31], a[196:199], v[236:239], v[28:31]
    v_lshlrev_b32 v250, 16, v199
    v_lshlrev_b32 v251, 16, v201
    v_and_b32 v195, s22, v195
    v_mfma_f32_16x16x32_bf16 v[32:35], a[200:203], v[236:239], v[32:35]
    ds_read_b128 v[236:239], v253 offset:5984
    v_and_b32 v197, s22, v197
    v_mfma_f32_16x16x32_bf16 v[32:35], a[212:215], v[228:231], v[32:35]
    buffer_load_dwordx4 v[244:247], v254, s[8:11], s42 offen offset:2048 sc1
    v_mfma_f32_16x16x32_bf16 v[32:35], a[224:227], v[232:235], v[32:35]
    v_and_b32 v199, s22, v199
    v_and_b32 v201, s22, v201
    v_mfma_f32_16x16x32_bf16 v[36:39], a[192:195], v[228:231], v[36:39]
    v_and_b32 v224, 0x1f0, v254
    v_mul_u32_u24 v224, 96, v224
    v_mfma_f32_16x16x32_bf16 v[36:39], a[204:207], v[232:235], v[36:39]
    s_waitcnt lgkmcnt(0)
    v_lshlrev_b32 v252, 16, v193
    v_and_b32 v193, s22, v193
    v_mfma_f32_16x16x32_bf16 v[36:39], a[216:219], v[236:239], v[36:39]
    buffer_load_dword v224, v224, s[4:7], s100 offen offset:0
    v_mfma_f32_16x16x32_bf16 v[40:43], a[220:223], v[236:239], v[40:43]
    v_and_b32 v227, 0xf0, v254
    v_lshrrev_b32 v227, 1, v227
    v_mfma_f32_16x16x32_bf16 v[40:43], a[208:211], v[232:235], v[40:43]
    v_add_u32 v227, s52, v227
    v_mov_b32 v226, s54
    v_mfma_f32_16x16x32_bf16 v[40:43], a[196:199], v[228:231], v[40:43]
    v_mov_b32 v225, s55
    v_cndmask_b32 v226, v226, v225, s[56:57]
    v_mfma_f32_16x16x32_bf16 v[44:47], a[200:203], v[228:231], v[44:47]
    ds_read_b128 v[228:231], v253 offset:5728
    v_add_u32 v227, v227, v226
    v_mfma_f32_16x16x32_bf16 v[44:47], a[212:215], v[232:235], v[44:47]
    s_sub_u32 s45, s16, s50
    v_fmac_f32 v252, s25, v251
    v_fmac_f32 v193, s25, v201
    v_mfma_f32_16x16x32_bf16 v[44:47], a[224:227], v[236:239], v[44:47]
    buffer_load_dwordx2 v[216:217], v227, s[4:7], s45 offen
    v_mfma_f32_16x16x32_bf16 v[48:51], a[192:195], v[232:235], v[48:51]
    s_sub_u32 s45, s17, s50
    v_fmac_f32 v252, s28, v249
    v_fmac_f32 v193, s28, v197
    v_mfma_f32_16x16x32_bf16 v[48:51], a[204:207], v[236:239], v[48:51]
    s_waitcnt lgkmcnt(0)
    v_cvt_pk_bf16_f32 v193, v252, v193
    v_lshlrev_b32 v252, 16, v203
    v_mfma_f32_16x16x32_bf16 v[48:51], a[216:219], v[228:231], v[48:51]
    v_and_b32 v203, s22, v203
    v_fmac_f32 v252, s29, v248
    v_mfma_f32_16x16x32_bf16 v[52:55], a[220:223], v[228:231], v[52:55]
    buffer_load_dwordx2 v[218:219], v227, s[4:7], s45 offen
    v_mfma_f32_16x16x32_bf16 v[52:55], a[208:211], v[236:239], v[52:55]
    s_sub_u32 s45, s18, s50
    v_fmac_f32 v203, s29, v195
    v_fmac_f32 v252, s23, v250
    v_mfma_f32_16x16x32_bf16 v[52:55], a[196:199], v[232:235], v[52:55]
    v_fmac_f32 v203, s23, v199
    v_cvt_pk_bf16_f32 v203, v252, v203
    v_mfma_f32_16x16x32_bf16 v[56:59], a[200:203], v[232:235], v[56:59]
    ds_read_b128 v[232:235], v253 offset:5472
    v_fma_f32 v252, v249, s24, v251
    v_mfma_f32_16x16x32_bf16 v[56:59], a[212:215], v[236:239], v[56:59]
    buffer_load_dwordx2 v[220:221], v227, s[4:7], s45 offen
    v_fmac_f32 v251, -4.0, v249
    v_mfma_f32_16x16x32_bf16 v[56:59], a[224:227], v[228:231], v[56:59]
    s_sub_u32 s45, s19, s50
    v_fma_f32 v249, v248, s24, v250
    v_fmac_f32 v250, -4.0, v248
    v_mfma_f32_16x16x32_bf16 v[60:63], a[192:195], v[236:239], v[60:63]
    v_fma_f32 v248, v250, s26, v251
    v_fmac_f32 v251, s27, v250
    v_mfma_f32_16x16x32_bf16 v[60:63], a[204:207], v[228:231], v[60:63]
    s_waitcnt lgkmcnt(0)
    v_fma_f32 v250, v249, 2.0, v252
    v_fmac_f32 v252, -2.0, v249
    v_mfma_f32_16x16x32_bf16 v[60:63], a[216:219], v[232:235], v[60:63]
    buffer_load_dwordx2 v[222:223], v227, s[4:7], s45 offen
    v_mfma_f32_16x16x32_bf16 v[64:67], a[220:223], v[232:235], v[64:67]
    s_sub_u32 s45, s20, s50
    v_fma_f32 v249, v197, s24, v201
    v_fmac_f32 v201, -4.0, v197
    v_mfma_f32_16x16x32_bf16 v[64:67], a[208:211], v[228:231], v[64:67]
    v_fma_f32 v197, v195, s24, v199
    v_fmac_f32 v199, -4.0, v195
    v_mfma_f32_16x16x32_bf16 v[64:67], a[196:199], v[236:239], v[64:67]
    v_fma_f32 v195, v199, s26, v201
    v_fmac_f32 v201, s27, v199
    v_mfma_f32_16x16x32_bf16 v[68:71], a[200:203], v[236:239], v[68:71]
    ds_read_b128 v[236:239], v253 offset:5216
    v_fma_f32 v199, v197, 2.0, v249
    v_mfma_f32_16x16x32_bf16 v[68:71], a[212:215], v[228:231], v[68:71]
    buffer_load_dwordx2 v[224:225], v227, s[4:7], s45 offen
    v_mfma_f32_16x16x32_bf16 v[68:71], a[224:227], v[232:235], v[68:71]
    s_sub_u32 s45, s21, s50
    v_fmac_f32 v249, -2.0, v197
    v_cvt_pk_bf16_f32 v195, v248, v195
    v_mfma_f32_16x16x32_bf16 v[72:75], a[192:195], v[228:231], v[72:75]
    v_cvt_pk_bf16_f32 v201, v251, v201
    v_cvt_pk_bf16_f32 v199, v250, v199
    v_mfma_f32_16x16x32_bf16 v[72:75], a[204:207], v[232:235], v[72:75]
    s_waitcnt lgkmcnt(0)
    v_cvt_pk_bf16_f32 v197, v252, v249
    v_lshrrev_b32 v252, 15, v255
    v_mfma_f32_16x16x32_bf16 v[72:75], a[216:219], v[236:239], v[72:75]
    buffer_load_dwordx2 v[226:227], v227, s[4:7], s45 offen
    v_mfma_f32_16x16x32_bf16 v[76:79], a[220:223], v[236:239], v[76:79]
    ds_write_b64 v252, v[194:195] offset:8576
    v_mfma_f32_16x16x32_bf16 v[76:79], a[208:211], v[232:235], v[76:79]
    s_waitcnt vmcnt(16)
    v_lshrrev_b32 v194, 15, v255
    v_lshlrev_b32 v248, 16, v206
    v_mfma_f32_16x16x32_bf16 v[76:79], a[196:199], v[228:231], v[76:79]
    ds_write_b64 v194, v[200:201] offset:10656
    v_mfma_f32_16x16x32_bf16 v[80:83], a[200:203], v[228:231], v[80:83]
    ds_read_b128 v[228:231], v253 offset:4944
    v_lshlrev_b32 v249, 16, v208
    v_mfma_f32_16x16x32_bf16 v[80:83], a[212:215], v[232:235], v[80:83]
    ds_write_b64 v194, v[198:199] offset:12736
    v_mfma_f32_16x16x32_bf16 v[80:83], a[224:227], v[236:239], v[80:83]
    s_mov_b32 s42, 737280
    v_lshlrev_b32 v250, 16, v210
    v_lshlrev_b32 v251, 16, v212
    v_mfma_f32_16x16x32_bf16 v[84:87], a[192:195], v[232:235], v[84:87]
    ds_write_b64 v194, v[192:193] offset:23136
    v_and_b32 v206, s22, v206
    v_mfma_f32_16x16x32_bf16 v[88:91], a[196:199], v[232:235], v[88:91]
    v_and_b32 v208, s22, v208
    v_and_b32 v210, s22, v210
    v_mfma_f32_16x16x32_bf16 v[92:95], a[200:203], v[232:235], v[92:95]
    ds_read_b128 v[232:235], v253 offset:7280
    v_and_b32 v212, s22, v212
    v_mfma_f32_16x16x32_bf16 v[92:95], a[212:215], v[236:239], v[92:95]
    buffer_load_dwordx4 a[192:195], v254, s[8:11], s42 offen offset:0 sc1
    v_mfma_f32_16x16x32_bf16 v[88:91], a[208:211], v[236:239], v[88:91]
    s_waitcnt lgkmcnt(3)
    v_lshlrev_b32 v252, 16, v204
    v_and_b32 v204, s22, v204
    v_mfma_f32_16x16x32_bf16 v[84:87], a[204:207], v[236:239], v[84:87]
    ds_read_b128 v[236:239], v253 offset:7008
    v_fmac_f32 v252, s25, v251
    v_mfma_f32_16x16x32_bf16 v[84:87], a[216:219], v[228:231], v[84:87]
    buffer_load_dwordx4 a[196:199], v254, s[8:11], s42 offen offset:1024 sc1
    v_mfma_f32_16x16x32_bf16 v[88:91], a[220:223], v[228:231], v[88:91]
    s_waitcnt vmcnt(15) lgkmcnt(1)
    v_fmac_f32 v204, s25, v212
    v_fmac_f32 v252, s28, v249
    v_mfma_f32_16x16x32_bf16 v[92:95], a[224:227], v[228:231], v[92:95]
    ds_read_b128 v[228:231], v253 offset:6752
    v_fmac_f32 v204, s28, v208
sub19:
    v_mfma_f32_16x16x32_bf16 v[96:99], a[228:231], v[232:235], v[96:99]
    buffer_load_dwordx4 a[200:203], v254, s[8:11], s42 offen offset:2048 sc1
    v_mfma_f32_16x16x32_bf16 v[100:103], a[232:235], v[232:235], v[100:103]
    s_mov_b32 s42, 740352
    v_cvt_pk_bf16_f32 v204, v252, v204
    v_lshlrev_b32 v252, 16, v214
    v_mfma_f32_16x16x32_bf16 v[104:107], a[236:239], v[232:235], v[104:107]
    ds_read_b128 v[232:235], v253 offset:6496
    s_waitcnt vmcnt(13)
    s_waitcnt lgkmcnt(2)
    v_mfma_f32_16x16x32_bf16 v[104:107], a[248:251], v[236:239], v[104:107]
    ds_write_b64 v194, v[202:203] offset:31456
    v_mfma_f32_16x16x32_bf16 v[100:103], a[244:247], v[236:239], v[100:103]
    buffer_load_dwordx4 a[204:207], v254, s[8:11], s42 offen offset:0 sc1
    v_mfma_f32_16x16x32_bf16 v[96:99], a[240:243], v[236:239], v[96:99]
    s_waitcnt vmcnt(11) lgkmcnt(2)
    v_and_b32 v214, s22, v214
    v_fmac_f32 v252, s29, v248
    v_mfma_f32_16x16x32_bf16 v[96:99], a[252:255], v[228:231], v[96:99]
    ds_write_b64 v194, v[196:197] offset:256
    v_mfma_f32_16x16x32_bf16 v[100:103], v[240:243], v[228:231], v[100:103]
    v_fmac_f32 v214, s29, v206
    v_fmac_f32 v252, s23, v250
    v_mfma_f32_16x16x32_bf16 v[104:107], v[244:247], v[228:231], v[104:107]
    buffer_load_dwordx4 a[208:211], v254, s[8:11], s42 offen offset:1024 sc1
    v_mfma_f32_16x16x32_bf16 v[108:111], a[228:231], v[236:239], v[108:111]
    v_fmac_f32 v214, s23, v210
    v_cvt_pk_bf16_f32 v214, v252, v214
    v_mfma_f32_16x16x32_bf16 v[108:111], a[240:243], v[228:231], v[108:111]
    s_waitcnt lgkmcnt(2)
    v_fma_f32 v252, v249, s24, v251
    v_fmac_f32 v251, -4.0, v249
    v_mfma_f32_16x16x32_bf16 v[108:111], a[252:255], v[232:235], v[108:111]
    v_fma_f32 v249, v248, s24, v250
    v_fmac_f32 v250, -4.0, v248
    v_fma_f32 v248, v250, s26, v251
    v_mfma_f32_16x16x32_bf16 v[112:115], v[240:243], v[232:235], v[112:115]
    buffer_load_dwordx4 a[212:215], v254, s[8:11], s42 offen offset:2048 sc1
    v_mfma_f32_16x16x32_bf16 v[112:115], a[244:247], v[228:231], v[112:115]
    s_mov_b32 s42, 743424
    v_fmac_f32 v251, s27, v250
    v_fma_f32 v250, v249, 2.0, v252
    v_mfma_f32_16x16x32_bf16 v[112:115], a[232:235], v[236:239], v[112:115]
    v_fmac_f32 v252, -2.0, v249
    v_fma_f32 v249, v208, s24, v212
    v_mfma_f32_16x16x32_bf16 v[116:119], a[236:239], v[236:239], v[116:119]
    ds_read_b128 v[236:239], v253 offset:6240
    v_fmac_f32 v212, -4.0, v208
    v_mfma_f32_16x16x32_bf16 v[116:119], a[248:251], v[228:231], v[116:119]
    buffer_load_dwordx4 a[216:219], v254, s[8:11], s42 offen offset:0 sc1
    v_mfma_f32_16x16x32_bf16 v[116:119], v[244:247], v[232:235], v[116:119]
    v_fma_f32 v208, v206, s24, v210
    v_fmac_f32 v210, -4.0, v206
    v_mfma_f32_16x16x32_bf16 v[120:123], a[228:231], v[228:231], v[120:123]
    v_fma_f32 v206, v210, s26, v212
    v_fmac_f32 v212, s27, v210
    v_mfma_f32_16x16x32_bf16 v[120:123], a[240:243], v[232:235], v[120:123]
    s_waitcnt lgkmcnt(0)
    v_fma_f32 v210, v208, 2.0, v249
    v_fmac_f32 v249, -2.0, v208
    v_mfma_f32_16x16x32_bf16 v[120:123], a[252:255], v[236:239], v[120:123]
    v_cvt_pk_bf16_f32 v206, v248, v206
    v_cvt_pk_bf16_f32 v212, v251, v212
    v_mfma_f32_16x16x32_bf16 v[124:127], v[240:243], v[236:239], v[124:127]
    buffer_load_dwordx4 a[220:223], v254, s[8:11], s42 offen offset:1024 sc1
    v_mfma_f32_16x16x32_bf16 v[124:127], a[244:247], v[232:235], v[124:127]
    v_cvt_pk_bf16_f32 v210, v250, v210
    v_cvt_pk_bf16_f32 v208, v252, v249
    v_mfma_f32_16x16x32_bf16 v[124:127], a[232:235], v[228:231], v[124:127]
    v_lshlrev_b32 v248, 16, v207
    v_lshlrev_b32 v249, 16, v209
    v_mfma_f32_16x16x32_bf16 v[128:131], a[236:239], v[228:231], v[128:131]
    ds_read_b128 v[228:231], v253 offset:8064
    v_lshlrev_b32 v250, 16, v211
    v_mfma_f32_16x16x32_bf16 v[128:131], a[248:251], v[232:235], v[128:131]
    buffer_load_dwordx4 a[224:227], v254, s[8:11], s42 offen offset:2048 sc1
    v_mfma_f32_16x16x32_bf16 v[128:131], v[244:247], v[236:239], v[128:131]
    v_lshlrev_b32 v251, 16, v213
    v_and_b32 v207, s22, v207
    v_mfma_f32_16x16x32_bf16 v[132:135], a[228:231], v[232:235], v[132:135]
    v_and_b32 v209, s22, v209
    v_and_b32 v211, s22, v211
    v_mfma_f32_16x16x32_bf16 v[132:135], a[240:243], v[236:239], v[132:135]
    s_waitcnt lgkmcnt(0)
    v_and_b32 v213, s22, v213
    v_lshlrev_b32 v252, 16, v205
    v_mfma_f32_16x16x32_bf16 v[132:135], a[252:255], v[228:231], v[132:135]
    v_and_b32 v205, s22, v205
    v_fmac_f32 v252, s25, v251
    v_mfma_f32_16x16x32_bf16 v[136:139], v[240:243], v[228:231], v[136:139]
    v_fmac_f32 v205, s25, v213
    v_fmac_f32 v252, s28, v249
    v_mfma_f32_16x16x32_bf16 v[136:139], a[244:247], v[236:239], v[136:139]
    v_fmac_f32 v205, s28, v209
    v_cvt_pk_bf16_f32 v205, v252, v205
    v_lshlrev_b32 v252, 16, v215
    v_mfma_f32_16x16x32_bf16 v[136:139], a[232:235], v[232:235], v[136:139]
    v_and_b32 v215, s22, v215
    v_fmac_f32 v252, s29, v248
    v_mfma_f32_16x16x32_bf16 v[140:143], a[236:239], v[232:235], v[140:143]
    ds_read_b128 v[232:235], v253 offset:7808
    v_fmac_f32 v215, s29, v207
    v_mfma_f32_16x16x32_bf16 v[140:143], a[248:251], v[236:239], v[140:143]
    v_fmac_f32 v252, s23, v250
    v_fmac_f32 v215, s23, v211
    v_mfma_f32_16x16x32_bf16 v[140:143], v[244:247], v[228:231], v[140:143]
    v_cvt_pk_bf16_f32 v215, v252, v215
    v_fma_f32 v252, v249, s24, v251
    v_mfma_f32_16x16x32_bf16 v[144:147], a[228:231], v[236:239], v[144:147]
    v_fmac_f32 v251, -4.0, v249
    v_fma_f32 v249, v248, s24, v250
    v_mfma_f32_16x16x32_bf16 v[144:147], a[240:243], v[228:231], v[144:147]
    s_waitcnt lgkmcnt(0)
    v_fmac_f32 v250, -4.0, v248
    v_fma_f32 v248, v250, s26, v251
    v_mfma_f32_16x16x32_bf16 v[144:147], a[252:255], v[232:235], v[144:147]
    v_fmac_f32 v251, s27, v250
    v_fma_f32 v250, v249, 2.0, v252
    v_mfma_f32_16x16x32_bf16 v[148:151], v[240:243], v[232:235], v[148:151]
    v_fmac_f32 v252, -2.0, v249
    v_fma_f32 v249, v209, s24, v213
    v_mfma_f32_16x16x32_bf16 v[148:151], a[244:247], v[228:231], v[148:151]
    v_fmac_f32 v213, -4.0, v209
    v_fma_f32 v209, v207, s24, v211
    v_mfma_f32_16x16x32_bf16 v[148:151], a[232:235], v[236:239], v[148:151]
    v_fmac_f32 v211, -4.0, v207
    v_fma_f32 v207, v211, s26, v213
    v_mfma_f32_16x16x32_bf16 v[152:155], a[236:239], v[236:239], v[152:155]
    ds_read_b128 v[236:239], v253 offset:7552
    v_fmac_f32 v213, s27, v211
    v_mfma_f32_16x16x32_bf16 v[152:155], a[248:251], v[228:231], v[152:155]
    v_fma_f32 v211, v209, 2.0, v249
    v_fmac_f32 v249, -2.0, v209
    v_mfma_f32_16x16x32_bf16 v[152:155], v[244:247], v[232:235], v[152:155]
    v_cvt_pk_bf16_f32 v207, v248, v207
    v_cvt_pk_bf16_f32 v213, v251, v213
    v_mfma_f32_16x16x32_bf16 v[156:159], a[228:231], v[228:231], v[156:159]
    v_cvt_pk_bf16_f32 v211, v250, v211
    v_cvt_pk_bf16_f32 v209, v252, v249
    v_mfma_f32_16x16x32_bf16 v[156:159], a[240:243], v[232:235], v[156:159]
    s_waitcnt lgkmcnt(0)
    v_lshrrev_b32 v252, 15, v255
    v_mfma_f32_16x16x32_bf16 v[156:159], a[252:255], v[236:239], v[156:159]
    ds_write_b64 v252, v[206:207] offset:8320
    v_mfma_f32_16x16x32_bf16 v[160:163], v[240:243], v[236:239], v[160:163]
    v_lshrrev_b32 v206, 15, v255
    v_mfma_f32_16x16x32_bf16 v[160:163], a[244:247], v[232:235], v[160:163]
    ds_write_b64 v206, v[212:213] offset:10400
    v_mfma_f32_16x16x32_bf16 v[160:163], a[232:235], v[228:231], v[160:163]
    s_waitcnt vmcnt(9)
    v_lshlrev_b32 v248, 16, v218
    v_lshlrev_b32 v249, 16, v220
    v_mfma_f32_16x16x32_bf16 v[164:167], a[236:239], v[228:231], v[164:167]
    ds_read_b128 v[228:231], v253 offset:7296
    v_lshlrev_b32 v250, 16, v222
    v_mfma_f32_16x16x32_bf16 v[164:167], a[248:251], v[232:235], v[164:167]
    ds_write_b64 v206, v[210:211] offset:12480
    v_mfma_f32_16x16x32_bf16 v[164:167], v[244:247], v[236:239], v[164:167]
    v_lshlrev_b32 v251, 16, v224
    v_and_b32 v218, s22, v218
    v_mfma_f32_16x16x32_bf16 v[168:171], a[228:231], v[232:235], v[168:171]
    ds_write_b64 v206, v[204:205] offset:22880
    v_mfma_f32_16x16x32_bf16 v[168:171], a[240:243], v[236:239], v[168:171]
    s_waitcnt lgkmcnt(2)
    v_and_b32 v220, s22, v220
    v_and_b32 v222, s22, v222
    v_mfma_f32_16x16x32_bf16 v[168:171], a[252:255], v[228:231], v[168:171]
    ds_write_b64 v206, v[214:215] offset:31200
    v_mfma_f32_16x16x32_bf16 v[172:175], v[240:243], v[228:231], v[172:175]
    v_and_b32 v224, s22, v224
    v_lshlrev_b32 v252, 16, v216
    v_mfma_f32_16x16x32_bf16 v[172:175], a[244:247], v[236:239], v[172:175]
    ds_write_b64 v206, v[208:209] offset:0
    v_mfma_f32_16x16x32_bf16 v[172:175], a[232:235], v[232:235], v[172:175]
    v_and_b32 v216, s22, v216
    v_fmac_f32 v252, s25, v251
    v_mfma_f32_16x16x32_bf16 v[176:179], a[236:239], v[232:235], v[176:179]
    ds_read_b128 v[232:235], v253 offset:7024
    v_fmac_f32 v216, s25, v224
    v_mfma_f32_16x16x32_bf16 v[176:179], a[248:251], v[236:239], v[176:179]
    v_fmac_f32 v252, s28, v249
    v_fmac_f32 v216, s28, v220
    v_mfma_f32_16x16x32_bf16 v[176:179], v[244:247], v[228:231], v[176:179]
    s_mov_b32 s42, 774144
    v_cvt_pk_bf16_f32 v216, v252, v216
    v_lshlrev_b32 v252, 16, v226
    v_mfma_f32_16x16x32_bf16 v[180:183], a[228:231], v[236:239], v[180:183]
    s_waitcnt lgkmcnt(0)
    v_and_b32 v226, s22, v226
    v_fmac_f32 v252, s29, v248
    v_mfma_f32_16x16x32_bf16 v[184:187], a[232:235], v[236:239], v[184:187]
    s_barrier
    v_mfma_f32_16x16x32_bf16 v[188:191], a[236:239], v[236:239], v[188:191]
    ds_read_b128 v[236:239], v253 offset:9360
    v_fmac_f32 v226, s29, v218
    v_mfma_f32_16x16x32_bf16 v[188:191], a[248:251], v[228:231], v[188:191]
    buffer_load_dwordx4 a[228:231], v254, s[8:11], s42 offen offset:0 sc1
    v_mfma_f32_16x16x32_bf16 v[184:187], a[244:247], v[228:231], v[184:187]
    v_fmac_f32 v252, s23, v250
    v_fmac_f32 v226, s23, v222
    v_mfma_f32_16x16x32_bf16 v[180:183], a[240:243], v[228:231], v[180:183]
    ds_read_b128 v[228:231], v253 offset:9088
    v_cvt_pk_bf16_f32 v226, v252, v226
    v_mfma_f32_16x16x32_bf16 v[180:183], a[252:255], v[232:235], v[180:183]
    buffer_load_dwordx4 a[232:235], v254, s[8:11], s42 offen offset:1024 sc1
    v_mfma_f32_16x16x32_bf16 v[184:187], v[240:243], v[232:235], v[184:187]
    s_waitcnt vmcnt(8) lgkmcnt(1)
    v_fma_f32 v252, v249, s24, v251
    v_fmac_f32 v251, -4.0, v249
    v_mfma_f32_16x16x32_bf16 v[188:191], v[244:247], v[232:235], v[188:191]
    ds_read_b128 v[232:235], v253 offset:8832
    v_fma_f32 v249, v248, s24, v250
sub20:
    v_mfma_f32_16x16x32_bf16 a[0:3], a[192:195], v[236:239], a[0:3]
    buffer_load_dwordx4 a[236:239], v254, s[8:11], s42 offen offset:2048 sc1
    v_mfma_f32_16x16x32_bf16 a[4:7], a[196:199], v[236:239], a[4:7]
    s_mov_b32 s42, 777216
    v_fmac_f32 v250, -4.0, v248
    v_fma_f32 v248, v250, s26, v251
    v_mfma_f32_16x16x32_bf16 a[8:11], a[200:203], v[236:239], a[8:11]
    ds_read_b128 v[236:239], v253 offset:8576
    s_waitcnt vmcnt(6)
    s_waitcnt lgkmcnt(2)
    v_mfma_f32_16x16x32_bf16 a[8:11], a[212:215], v[228:231], a[8:11]
    v_fmac_f32 v251, s27, v250
    v_fma_f32 v250, v249, 2.0, v252
    v_mfma_f32_16x16x32_bf16 a[4:7], a[208:211], v[228:231], a[4:7]
    buffer_load_dwordx4 a[240:243], v254, s[8:11], s42 offen offset:0 sc1
    v_mfma_f32_16x16x32_bf16 a[0:3], a[204:207], v[228:231], a[0:3]
    s_waitcnt vmcnt(4) lgkmcnt(1)
    v_fmac_f32 v252, -2.0, v249
    v_fma_f32 v249, v220, s24, v224
    v_mfma_f32_16x16x32_bf16 a[0:3], a[216:219], v[232:235], a[0:3]
    v_fmac_f32 v224, -4.0, v220
    v_fma_f32 v220, v218, s24, v222
    v_mfma_f32_16x16x32_bf16 a[4:7], a[220:223], v[232:235], a[4:7]
    v_fmac_f32 v222, -4.0, v218
    v_fma_f32 v218, v222, s26, v224
    v_mfma_f32_16x16x32_bf16 a[8:11], a[224:227], v[232:235], a[8:11]
    buffer_load_dwordx4 a[244:247], v254, s[8:11], s42 offen offset:1024 sc1
    v_mfma_f32_16x16x32_bf16 a[12:15], a[192:195], v[228:231], a[12:15]
    v_fmac_f32 v224, s27, v222
    v_fma_f32 v222, v220, 2.0, v249
    v_mfma_f32_16x16x32_bf16 a[12:15], a[204:207], v[232:235], a[12:15]
    s_waitcnt lgkmcnt(0)
    v_fmac_f32 v249, -2.0, v220
    v_cvt_pk_bf16_f32 v218, v248, v218
    v_mfma_f32_16x16x32_bf16 a[12:15], a[216:219], v[236:239], a[12:15]
    v_cvt_pk_bf16_f32 v224, v251, v224
    v_cvt_pk_bf16_f32 v222, v250, v222
    v_mfma_f32_16x16x32_bf16 a[16:19], a[220:223], v[236:239], a[16:19]
    buffer_load_dwordx4 a[248:251], v254, s[8:11], s42 offen offset:2048 sc1
    v_mfma_f32_16x16x32_bf16 a[16:19], a[208:211], v[232:235], a[16:19]
    s_mov_b32 s42, 780288
    v_cvt_pk_bf16_f32 v220, v252, v249
    v_lshlrev_b32 v248, 16, v219
    v_mfma_f32_16x16x32_bf16 a[16:19], a[196:199], v[228:231], a[16:19]
    v_lshlrev_b32 v249, 16, v221
    v_lshlrev_b32 v250, 16, v223
    v_mfma_f32_16x16x32_bf16 a[20:23], a[200:203], v[228:231], a[20:23]
    ds_read_b128 v[228:231], v253 offset:8320
    v_lshlrev_b32 v251, 16, v225
    v_mfma_f32_16x16x32_bf16 a[20:23], a[212:215], v[232:235], a[20:23]
    buffer_load_dwordx4 a[252:255], v254, s[8:11], s42 offen offset:0 sc1
    v_mfma_f32_16x16x32_bf16 a[20:23], a[224:227], v[236:239], a[20:23]
    v_and_b32 v219, s22, v219
    v_and_b32 v221, s22, v221
    v_mfma_f32_16x16x32_bf16 a[24:27], a[192:195], v[232:235], a[24:27]
    v_and_b32 v223, s22, v223
    v_and_b32 v225, s22, v225
    v_mfma_f32_16x16x32_bf16 a[24:27], a[204:207], v[236:239], a[24:27]
    s_waitcnt lgkmcnt(0)
    v_lshlrev_b32 v252, 16, v217
    v_and_b32 v217, s22, v217
    v_mfma_f32_16x16x32_bf16 a[24:27], a[216:219], v[228:231], a[24:27]
    v_fmac_f32 v252, s25, v251
    v_fmac_f32 v217, s25, v225
    v_mfma_f32_16x16x32_bf16 a[28:31], a[220:223], v[228:231], a[28:31]
    buffer_load_dwordx4 v[240:243], v254, s[8:11], s42 offen offset:1024 sc1
    v_mfma_f32_16x16x32_bf16 a[28:31], a[208:211], v[236:239], a[28:31]
    v_fmac_f32 v252, s28, v249
    v_fmac_f32 v217, s28, v221
    v_mfma_f32_16x16x32_bf16 a[28:31], a[196:199], v[232:235], a[28:31]
    v_cvt_pk_bf16_f32 v217, v252, v217
    v_lshlrev_b32 v252, 16, v227
    v_mfma_f32_16x16x32_bf16 a[32:35], a[200:203], v[232:235], a[32:35]
    ds_read_b128 v[232:235], v253 offset:10144
    v_and_b32 v227, s22, v227
    v_mfma_f32_16x16x32_bf16 a[32:35], a[212:215], v[236:239], a[32:35]
    buffer_load_dwordx4 v[244:247], v254, s[8:11], s42 offen offset:2048 sc1
    v_mfma_f32_16x16x32_bf16 a[32:35], a[224:227], v[228:231], a[32:35]
    v_fmac_f32 v252, s29, v248
    v_fmac_f32 v227, s29, v219
    v_mfma_f32_16x16x32_bf16 a[36:39], a[192:195], v[236:239], a[36:39]
    v_and_b32 v192, 0x1f0, v254
    v_mul_u32_u24 v192, 96, v192
    v_mfma_f32_16x16x32_bf16 a[36:39], a[204:207], v[228:231], a[36:39]
    s_waitcnt lgkmcnt(0)
    v_fmac_f32 v252, s23, v250
    v_fmac_f32 v227, s23, v223
    v_mfma_f32_16x16x32_bf16 a[36:39], a[216:219], v[232:235], a[36:39]
    buffer_load_dword v192, v192, s[4:7], s100 offen offset:384
    v_mfma_f32_16x16x32_bf16 a[40:43], a[220:223], v[232:235], a[40:43]
    v_cvt_pk_bf16_f32 v227, v252, v227
    v_fma_f32 v252, v249, s24, v251
    v_mfma_f32_16x16x32_bf16 a[40:43], a[208:211], v[228:231], a[40:43]
    v_fmac_f32 v251, -4.0, v249
    v_fma_f32 v249, v248, s24, v250
    v_mfma_f32_16x16x32_bf16 a[40:43], a[196:199], v[236:239], a[40:43]
    v_fmac_f32 v250, -4.0, v248
    v_fma_f32 v248, v250, s26, v251
    v_mfma_f32_16x16x32_bf16 a[44:47], a[200:203], v[236:239], a[44:47]
    ds_read_b128 v[236:239], v253 offset:9888
    v_fmac_f32 v251, s27, v250
    v_mfma_f32_16x16x32_bf16 a[44:47], a[212:215], v[228:231], a[44:47]
    v_fma_f32 v250, v249, 2.0, v252
    v_fmac_f32 v252, -2.0, v249
    v_mfma_f32_16x16x32_bf16 a[44:47], a[224:227], v[232:235], a[44:47]
pad7:
    s_cbranch_vccnz pad11
    v_fma_f32 v249, v221, s24, v225
    v_fmac_f32 v225, -4.0, v221
    v_mfma_f32_16x16x32_bf16 a[48:51], a[192:195], v[228:231], a[48:51]
    v_fma_f32 v221, v219, s24, v223
    v_fmac_f32 v223, -4.0, v219
    v_mfma_f32_16x16x32_bf16 a[48:51], a[204:207], v[232:235], a[48:51]
    s_waitcnt lgkmcnt(0)
    v_fma_f32 v219, v223, s26, v225
    v_fmac_f32 v225, s27, v223
    v_mfma_f32_16x16x32_bf16 a[48:51], a[216:219], v[236:239], a[48:51]
    v_fma_f32 v223, v221, 2.0, v249
    v_fmac_f32 v249, -2.0, v221
    v_mfma_f32_16x16x32_bf16 a[52:55], a[220:223], v[236:239], a[52:55]
    v_cvt_pk_bf16_f32 v219, v248, v219
    v_cvt_pk_bf16_f32 v225, v251, v225
    v_mfma_f32_16x16x32_bf16 a[52:55], a[208:211], v[232:235], a[52:55]
    v_cvt_pk_bf16_f32 v223, v250, v223
    v_cvt_pk_bf16_f32 v221, v252, v249
    v_mfma_f32_16x16x32_bf16 a[52:55], a[196:199], v[228:231], a[52:55]
    v_and_b32 v248, 0xf0, v254
    v_lshrrev_b32 v248, 1, v248
    v_mfma_f32_16x16x32_bf16 a[56:59], a[200:203], v[228:231], a[56:59]
    ds_read_b128 v[228:231], v253 offset:9632
    v_add_u32 v248, s52, v248
    v_mfma_f32_16x16x32_bf16 a[56:59], a[212:215], v[232:235], a[56:59]
    v_and_b32 v252, 8, v248
    v_lshrrev_b32 v249, 6, v248
    v_mfma_f32_16x16x32_bf16 a[56:59], a[224:227], v[236:239], a[56:59]
    v_mul_u32_u24 v249, 192, v249
    v_add_u32 v252, v252, v249
    v_mfma_f32_16x16x32_bf16 a[60:63], a[192:195], v[232:235], a[60:63]
    v_bfe_u32 v249, v248, 4, 2
    v_mul_u32_u24 v249, 40704, v249
    v_mfma_f32_16x16x32_bf16 a[60:63], a[204:207], v[236:239], a[60:63]
    s_waitcnt lgkmcnt(0)
    v_add_u32 v252, v252, v249
    v_and_b32 v249, 32, v248
    v_mfma_f32_16x16x32_bf16 a[60:63], a[216:219], v[228:231], a[60:63]
    v_lshl_add_u32 v252, v249, 1, v252
    v_bfe_u32 v249, v254, 8, 1
    v_mfma_f32_16x16x32_bf16 a[64:67], a[220:223], v[228:231], a[64:67]
    v_lshl_add_u32 v252, v249, 4, v252
    v_mov_b32 v249, 123328
    v_mfma_f32_16x16x32_bf16 a[64:67], a[208:211], v[236:239], a[64:67]
    v_cndmask_b32 v252, v249, v252, s[58:59]
    v_mfma_f32_16x16x32_bf16 a[64:67], a[196:199], v[232:235], a[64:67]
    ds_write_b64 v252, v[216:217] offset:39520
    v_mfma_f32_16x16x32_bf16 a[68:71], a[200:203], v[232:235], a[68:71]
    ds_read_b128 v[232:235], v253 offset:9376
    v_mfma_f32_16x16x32_bf16 a[68:71], a[212:215], v[236:239], a[68:71]
    ds_write_b64 v252, v[218:219] offset:39552
    v_mfma_f32_16x16x32_bf16 a[68:71], a[224:227], v[228:231], a[68:71]
    v_mfma_f32_16x16x32_bf16 a[72:75], a[192:195], v[236:239], a[72:75]
    ds_write_b64 v252, v[224:225] offset:39584
    v_mfma_f32_16x16x32_bf16 a[72:75], a[204:207], v[228:231], a[72:75]
    s_waitcnt lgkmcnt(2)
    v_mfma_f32_16x16x32_bf16 a[72:75], a[216:219], v[232:235], a[72:75]
    ds_write_b64 v252, v[222:223] offset:39616
    v_mfma_f32_16x16x32_bf16 a[76:79], a[220:223], v[232:235], a[76:79]
    v_mfma_f32_16x16x32_bf16 a[76:79], a[208:211], v[228:231], a[76:79]
    ds_write_b64 v252, v[220:221] offset:39648
    v_mfma_f32_16x16x32_bf16 a[76:79], a[196:199], v[236:239], a[76:79]
    v_mfma_f32_16x16x32_bf16 a[80:83], a[200:203], v[236:239], a[80:83]
    ds_read_b128 v[236:239], v253 offset:9104
    v_mfma_f32_16x16x32_bf16 a[80:83], a[212:215], v[228:231], a[80:83]
    ds_write_b64 v252, v[226:227] offset:39680
    v_mfma_f32_16x16x32_bf16 a[80:83], a[224:227], v[232:235], a[80:83]
    s_mov_b32 s42, 811008
    v_mfma_f32_16x16x32_bf16 a[84:87], a[192:195], v[228:231], a[84:87]
    v_mfma_f32_16x16x32_bf16 a[88:91], a[196:199], v[228:231], a[88:91]
    v_mfma_f32_16x16x32_bf16 a[92:95], a[200:203], v[228:231], a[92:95]
    ds_read_b128 v[228:231], v253 offset:11440
    v_mfma_f32_16x16x32_bf16 a[92:95], a[212:215], v[232:235], a[92:95]
    buffer_load_dwordx4 a[192:195], v254, s[8:11], s42 offen offset:0 sc1
    v_mfma_f32_16x16x32_bf16 a[88:91], a[208:211], v[232:235], a[88:91]
    s_waitcnt lgkmcnt(2)
    v_mfma_f32_16x16x32_bf16 a[84:87], a[204:207], v[232:235], a[84:87]
    ds_read_b128 v[232:235], v253 offset:11168
    v_mfma_f32_16x16x32_bf16 a[84:87], a[216:219], v[236:239], a[84:87]
    buffer_load_dwordx4 a[196:199], v254, s[8:11], s42 offen offset:1024 sc1
    v_mfma_f32_16x16x32_bf16 a[88:91], a[220:223], v[236:239], a[88:91]
    s_waitcnt vmcnt(9) lgkmcnt(1)
    v_mfma_f32_16x16x32_bf16 a[92:95], a[224:227], v[236:239], a[92:95]
    ds_read_b128 v[236:239], v253 offset:10912
sub21:
    v_mfma_f32_16x16x32_bf16 a[96:99], a[228:231], v[228:231], a[96:99]
    buffer_load_dwordx4 a[200:203], v254, s[8:11], s42 offen offset:2048 sc1
    v_mfma_f32_16x16x32_bf16 a[100:103], a[232:235], v[228:231], a[100:103]
    s_mov_b32 s42, 814080
    v_mfma_f32_16x16x32_bf16 a[104:107], a[236:239], v[228:231], a[104:107]
    ds_read_b128 v[228:231], v253 offset:10656
    s_waitcnt vmcnt(7)
    s_waitcnt lgkmcnt(2)
    v_mfma_f32_16x16x32_bf16 a[104:107], a[248:251], v[232:235], a[104:107]
    v_bfe_u32 v251, v254, 6, 2
    v_mul_u32_u24 v248, 40704, v251
    v_mfma_f32_16x16x32_bf16 a[100:103], a[244:247], v[232:235], a[100:103]
    buffer_load_dwordx4 a[204:207], v254, s[8:11], s42 offen offset:0 sc1
    v_mfma_f32_16x16x32_bf16 a[96:99], a[240:243], v[232:235], a[96:99]
    s_waitcnt vmcnt(5) lgkmcnt(1)
    v_and_b32 v251, 0x80, v254
    v_lshrrev_b32 v251, 1, v251
    v_mfma_f32_16x16x32_bf16 a[96:99], a[252:255], v[236:239], a[96:99]
    v_add_u32 v248, v248, v251
    v_and_b32 v251, 0x40, v254
    v_mfma_f32_16x16x32_bf16 a[100:103], v[240:243], v[236:239], a[100:103]
    v_lshrrev_b32 v251, 2, v251
    v_add_u32 v248, v248, v251
    v_mfma_f32_16x16x32_bf16 a[104:107], v[244:247], v[236:239], a[104:107]
    buffer_load_dwordx4 a[208:211], v254, s[8:11], s42 offen offset:1024 sc1
    v_mfma_f32_16x16x32_bf16 a[108:111], a[228:231], v[232:235], a[108:111]
    v_bfe_u32 v251, v254, 4, 2
    v_mul_u32_u24 v251, 3104, v251
    v_mfma_f32_16x16x32_bf16 a[108:111], a[240:243], v[236:239], a[108:111]
    s_waitcnt lgkmcnt(0)
    v_add_u32 v248, v248, v251
    v_add_u32 v248, s52, v248
    v_mfma_f32_16x16x32_bf16 a[108:111], a[252:255], v[228:231], a[108:111]
    v_lshrrev_b32 v251, 8, v254
    v_lshl_add_u32 v249, v251, 3, v248
    v_mfma_f32_16x16x32_bf16 a[112:115], v[240:243], v[228:231], a[112:115]
    buffer_load_dwordx4 a[212:215], v254, s[8:11], s42 offen offset:2048 sc1
    v_mfma_f32_16x16x32_bf16 a[112:115], a[244:247], v[236:239], a[112:115]
    s_mov_b32 s42, 817152
    v_lshl_add_u32 v248, v251, 4, v248
    v_add_u32 v250, s51, v254
    v_mfma_f32_16x16x32_bf16 a[112:115], a[232:235], v[232:235], a[112:115]
    v_accvgpr_read_b32 v204, a0
    v_accvgpr_read_b32 v205, a1
    v_mfma_f32_16x16x32_bf16 a[116:119], a[236:239], v[232:235], a[116:119]
    ds_read_b128 v[232:235], v253 offset:10400
    v_accvgpr_read_b32 v206, a2
    v_mfma_f32_16x16x32_bf16 a[116:119], a[248:251], v[236:239], a[116:119]
    buffer_load_dwordx4 a[216:219], v254, s[8:11], s42 offen offset:0 sc1
    v_mfma_f32_16x16x32_bf16 a[116:119], v[244:247], v[228:231], a[116:119]
    v_accvgpr_read_b32 v207, a3
    v_accvgpr_read_b32 v208, a96
    v_mfma_f32_16x16x32_bf16 a[120:123], a[228:231], v[236:239], a[120:123]
    v_accvgpr_read_b32 v209, a97
    v_accvgpr_read_b32 v210, a98
    v_mfma_f32_16x16x32_bf16 a[120:123], a[240:243], v[228:231], a[120:123]
    s_waitcnt lgkmcnt(0)
    v_accvgpr_read_b32 v211, a99
    v_add_f32 v212, v204, v208
    v_mfma_f32_16x16x32_bf16 a[120:123], a[252:255], v[232:235], a[120:123]
    v_add_f32 v213, v205, v209
    v_add_f32 v214, v206, v210
    v_mfma_f32_16x16x32_bf16 a[124:127], v[240:243], v[232:235], a[124:127]
    buffer_load_dwordx4 a[220:223], v254, s[8:11], s42 offen offset:1024 sc1
    v_mfma_f32_16x16x32_bf16 a[124:127], a[244:247], v[228:231], a[124:127]
    v_add_f32 v215, v207, v211
    v_sub_f32 v204, v204, v208
    v_mfma_f32_16x16x32_bf16 a[124:127], a[232:235], v[236:239], a[124:127]
    v_sub_f32 v205, v205, v209
    v_sub_f32 v206, v206, v210
    v_mfma_f32_16x16x32_bf16 a[128:131], a[236:239], v[236:239], a[128:131]
    ds_read_b128 v[236:239], v253 offset:12224
    v_sub_f32 v207, v207, v211
    v_mfma_f32_16x16x32_bf16 a[128:131], a[248:251], v[228:231], a[128:131]
    buffer_load_dwordx4 a[224:227], v254, s[8:11], s42 offen offset:2048 sc1
    v_mfma_f32_16x16x32_bf16 a[128:131], v[244:247], v[232:235], a[128:131]
    v_accvgpr_write_b32 a0, v212
    v_accvgpr_write_b32 a1, v213
    v_mfma_f32_16x16x32_bf16 a[132:135], a[228:231], v[228:231], a[132:135]
    v_and_b32 v193, 0x1f0, v254
    v_mul_u32_u24 v193, 96, v193
    v_mfma_f32_16x16x32_bf16 a[132:135], a[240:243], v[232:235], a[132:135]
    s_waitcnt lgkmcnt(0)
    v_accvgpr_write_b32 a2, v214
    v_accvgpr_write_b32 a3, v215
    v_mfma_f32_16x16x32_bf16 a[132:135], a[252:255], v[236:239], a[132:135]
    buffer_load_dword v193, v193, s[4:7], s100 offen offset:768
    v_mfma_f32_16x16x32_bf16 a[136:139], v[240:243], v[236:239], a[136:139]
    v_accvgpr_write_b32 a96, v204
    v_accvgpr_write_b32 a97, v205
    v_mfma_f32_16x16x32_bf16 a[136:139], a[244:247], v[232:235], a[136:139]
    v_accvgpr_write_b32 a98, v206
    v_accvgpr_write_b32 a99, v207
    v_mfma_f32_16x16x32_bf16 a[136:139], a[232:235], v[228:231], a[136:139]
    v_accvgpr_read_b32 v204, a4
    v_accvgpr_read_b32 v205, a5
    v_mfma_f32_16x16x32_bf16 a[140:143], a[236:239], v[228:231], a[140:143]
    ds_read_b128 v[228:231], v253 offset:11968
    v_accvgpr_read_b32 v206, a6
    v_mfma_f32_16x16x32_bf16 a[140:143], a[248:251], v[232:235], a[140:143]
    v_accvgpr_read_b32 v207, a7
    v_accvgpr_read_b32 v208, a100
    v_mfma_f32_16x16x32_bf16 a[140:143], v[244:247], v[236:239], a[140:143]
    v_accvgpr_read_b32 v209, a101
    v_accvgpr_read_b32 v210, a102
    v_mfma_f32_16x16x32_bf16 a[144:147], a[228:231], v[232:235], a[144:147]
    v_accvgpr_read_b32 v211, a103
    v_add_f32 v212, v204, v208
    v_mfma_f32_16x16x32_bf16 a[144:147], a[240:243], v[236:239], a[144:147]
    s_waitcnt lgkmcnt(0)
    v_add_f32 v213, v205, v209
    v_add_f32 v214, v206, v210
    v_mfma_f32_16x16x32_bf16 a[144:147], a[252:255], v[228:231], a[144:147]
    v_add_f32 v215, v207, v211
    v_sub_f32 v204, v204, v208
    v_mfma_f32_16x16x32_bf16 a[148:151], v[240:243], v[228:231], a[148:151]
    v_sub_f32 v205, v205, v209
    v_sub_f32 v206, v206, v210
    v_mfma_f32_16x16x32_bf16 a[148:151], a[244:247], v[236:239], a[148:151]
    v_sub_f32 v207, v207, v211
    v_accvgpr_write_b32 a4, v212
    v_mfma_f32_16x16x32_bf16 a[148:151], a[232:235], v[232:235], a[148:151]
    v_accvgpr_write_b32 a5, v213
    v_accvgpr_write_b32 a6, v214
    v_mfma_f32_16x16x32_bf16 a[152:155], a[236:239], v[232:235], a[152:155]
    ds_read_b128 v[232:235], v253 offset:11712
    v_accvgpr_write_b32 a7, v215
    v_mfma_f32_16x16x32_bf16 a[152:155], a[248:251], v[236:239], a[152:155]
    v_accvgpr_write_b32 a100, v204
    v_accvgpr_write_b32 a101, v205
    v_mfma_f32_16x16x32_bf16 a[152:155], v[244:247], v[228:231], a[152:155]
    v_accvgpr_write_b32 a102, v206
    v_accvgpr_write_b32 a103, v207
    v_mfma_f32_16x16x32_bf16 a[156:159], a[228:231], v[236:239], a[156:159]
    v_accvgpr_read_b32 v204, a8
    v_accvgpr_read_b32 v205, a9
    v_mfma_f32_16x16x32_bf16 a[156:159], a[240:243], v[228:231], a[156:159]
    s_waitcnt lgkmcnt(0)
    v_accvgpr_read_b32 v206, a10
    v_accvgpr_read_b32 v207, a11
    v_mfma_f32_16x16x32_bf16 a[156:159], a[252:255], v[232:235], a[156:159]
    v_accvgpr_read_b32 v208, a104
    v_accvgpr_read_b32 v209, a105
    v_mfma_f32_16x16x32_bf16 a[160:163], v[240:243], v[232:235], a[160:163]
    v_accvgpr_read_b32 v210, a106
    v_accvgpr_read_b32 v211, a107
    v_mfma_f32_16x16x32_bf16 a[160:163], a[244:247], v[228:231], a[160:163]
    v_add_f32 v212, v204, v208
    v_add_f32 v213, v205, v209
    v_mfma_f32_16x16x32_bf16 a[160:163], a[232:235], v[236:239], a[160:163]
    v_add_f32 v214, v206, v210
    v_add_f32 v215, v207, v211
    v_mfma_f32_16x16x32_bf16 a[164:167], a[236:239], v[236:239], a[164:167]
    ds_read_b128 v[236:239], v253 offset:11456
    v_sub_f32 v204, v204, v208
    v_mfma_f32_16x16x32_bf16 a[164:167], a[248:251], v[228:231], a[164:167]
    v_sub_f32 v205, v205, v209
    v_sub_f32 v206, v206, v210
    v_mfma_f32_16x16x32_bf16 a[164:167], v[244:247], v[232:235], a[164:167]
    v_sub_f32 v207, v207, v211
    v_accvgpr_write_b32 a8, v212
    v_mfma_f32_16x16x32_bf16 a[168:171], a[228:231], v[228:231], a[168:171]
    v_accvgpr_write_b32 a9, v213
    v_accvgpr_write_b32 a10, v214
    v_mfma_f32_16x16x32_bf16 a[168:171], a[240:243], v[232:235], a[168:171]
    s_waitcnt lgkmcnt(0)
    v_accvgpr_write_b32 a11, v215
    v_accvgpr_write_b32 a104, v204
    v_mfma_f32_16x16x32_bf16 a[168:171], a[252:255], v[236:239], a[168:171]
    v_accvgpr_write_b32 a105, v205
    v_accvgpr_write_b32 a106, v206
    v_mfma_f32_16x16x32_bf16 a[172:175], v[240:243], v[236:239], a[172:175]
    v_accvgpr_write_b32 a107, v207
    v_accvgpr_read_b32 v204, a12
    v_mfma_f32_16x16x32_bf16 a[172:175], a[244:247], v[232:235], a[172:175]
    v_accvgpr_read_b32 v205, a13
    v_accvgpr_read_b32 v206, a14
    v_mfma_f32_16x16x32_bf16 a[172:175], a[232:235], v[228:231], a[172:175]
    v_accvgpr_read_b32 v207, a15
    v_accvgpr_read_b32 v208, a108
    v_mfma_f32_16x16x32_bf16 a[176:179], a[236:239], v[228:231], a[176:179]
    ds_read_b128 v[228:231], v253 offset:11184
    v_accvgpr_read_b32 v209, a109
    v_mfma_f32_16x16x32_bf16 a[176:179], a[248:251], v[232:235], a[176:179]
    v_accvgpr_read_b32 v210, a110
    v_accvgpr_read_b32 v211, a111
    v_mfma_f32_16x16x32_bf16 a[176:179], v[244:247], v[236:239], a[176:179]
    s_mov_b32 s42, 847872
    v_add_f32 v212, v204, v208
    v_add_f32 v213, v205, v209
    v_mfma_f32_16x16x32_bf16 a[180:183], a[228:231], v[232:235], a[180:183]
    v_add_f32 v214, v206, v210
    v_add_f32 v215, v207, v211
    v_mfma_f32_16x16x32_bf16 a[184:187], a[232:235], v[232:235], a[184:187]
    v_sub_f32 v204, v204, v208
    v_sub_f32 v205, v205, v209
    v_mfma_f32_16x16x32_bf16 a[188:191], a[236:239], v[232:235], a[188:191]
    ds_read_b128 v[232:235], v253 offset:13520
    v_sub_f32 v206, v206, v210
    v_mfma_f32_16x16x32_bf16 a[188:191], a[248:251], v[236:239], a[188:191]
    buffer_load_dwordx4 a[228:231], v254, s[8:11], s42 offen offset:0 sc1
    v_mfma_f32_16x16x32_bf16 a[184:187], a[244:247], v[236:239], a[184:187]
    s_waitcnt lgkmcnt(1)
    v_sub_f32 v207, v207, v211
    v_accvgpr_write_b32 a12, v212
    v_mfma_f32_16x16x32_bf16 a[180:183], a[240:243], v[236:239], a[180:183]
    ds_read_b128 v[236:239], v253 offset:13248
    v_accvgpr_write_b32 a13, v213
    v_mfma_f32_16x16x32_bf16 a[180:183], a[252:255], v[228:231], a[180:183]
    buffer_load_dwordx4 a[232:235], v254, s[8:11], s42 offen offset:1024 sc1
    v_mfma_f32_16x16x32_bf16 a[184:187], v[240:243], v[228:231], a[184:187]
    s_waitcnt vmcnt(9) lgkmcnt(1)
    v_accvgpr_write_b32 a14, v214
    v_accvgpr_write_b32 a15, v215
    v_mfma_f32_16x16x32_bf16 a[188:191], v[244:247], v[228:231], a[188:191]
    ds_read_b128 v[228:231], v253 offset:12992
    v_accvgpr_write_b32 a108, v204
sub22:
    v_mfma_f32_16x16x32_bf16 v[0:3], a[192:195], v[232:235], v[0:3]
    buffer_load_dwordx4 a[236:239], v254, s[8:11], s42 offen offset:2048 sc1
    v_mfma_f32_16x16x32_bf16 v[4:7], a[196:199], v[232:235], v[4:7]
    s_mov_b32 s42, 850944
    v_accvgpr_write_b32 a109, v205
    v_accvgpr_write_b32 a110, v206
    v_mfma_f32_16x16x32_bf16 v[8:11], a[200:203], v[232:235], v[8:11]
    ds_read_b128 v[232:235], v253 offset:12736
    s_waitcnt vmcnt(7)
    s_waitcnt lgkmcnt(2)
    v_mfma_f32_16x16x32_bf16 v[8:11], a[212:215], v[236:239], v[8:11]
    v_accvgpr_write_b32 a111, v207
    v_accvgpr_read_b32 v204, a16
    v_mfma_f32_16x16x32_bf16 v[4:7], a[208:211], v[236:239], v[4:7]
    buffer_load_dwordx4 a[240:243], v254, s[8:11], s42 offen offset:0 sc1
    v_mfma_f32_16x16x32_bf16 v[0:3], a[204:207], v[236:239], v[0:3]
    s_waitcnt vmcnt(5) lgkmcnt(1)
    v_accvgpr_read_b32 v205, a17
    v_accvgpr_read_b32 v206, a18
    v_mfma_f32_16x16x32_bf16 v[0:3], a[216:219], v[228:231], v[0:3]
    v_accvgpr_read_b32 v207, a19
    v_accvgpr_read_b32 v208, a112
    v_mfma_f32_16x16x32_bf16 v[4:7], a[220:223], v[228:231], v[4:7]
    v_accvgpr_read_b32 v209, a113
    v_accvgpr_read_b32 v210, a114
    v_mfma_f32_16x16x32_bf16 v[8:11], a[224:227], v[228:231], v[8:11]
    buffer_load_dwordx4 a[244:247], v254, s[8:11], s42 offen offset:1024 sc1
    v_mfma_f32_16x16x32_bf16 v[12:15], a[192:195], v[236:239], v[12:15]
    v_accvgpr_read_b32 v211, a115
    v_add_f32 v212, v204, v208
    v_mfma_f32_16x16x32_bf16 v[12:15], a[204:207], v[228:231], v[12:15]
    s_waitcnt lgkmcnt(0)
    v_add_f32 v213, v205, v209
    v_add_f32 v214, v206, v210
    v_mfma_f32_16x16x32_bf16 v[12:15], a[216:219], v[232:235], v[12:15]
    v_add_f32 v215, v207, v211
    v_sub_f32 v204, v204, v208
    v_mfma_f32_16x16x32_bf16 v[16:19], a[220:223], v[232:235], v[16:19]
    buffer_load_dwordx4 a[248:251], v254, s[8:11], s42 offen offset:2048 sc1
    v_mfma_f32_16x16x32_bf16 v[16:19], a[208:211], v[228:231], v[16:19]
    s_mov_b32 s42, 854016
    v_sub_f32 v205, v205, v209
    v_sub_f32 v206, v206, v210
    v_mfma_f32_16x16x32_bf16 v[16:19], a[196:199], v[236:239], v[16:19]
    v_sub_f32 v207, v207, v211
    v_accvgpr_write_b32 a16, v212
    v_mfma_f32_16x16x32_bf16 v[20:23], a[200:203], v[236:239], v[20:23]
    ds_read_b128 v[236:239], v253 offset:12480
    v_accvgpr_write_b32 a17, v213
    v_mfma_f32_16x16x32_bf16 v[20:23], a[212:215], v[228:231], v[20:23]
    buffer_load_dwordx4 a[252:255], v254, s[8:11], s42 offen offset:0 sc1
    v_mfma_f32_16x16x32_bf16 v[20:23], a[224:227], v[232:235], v[20:23]
    v_accvgpr_write_b32 a18, v214
    v_accvgpr_write_b32 a19, v215
    v_mfma_f32_16x16x32_bf16 v[24:27], a[192:195], v[228:231], v[24:27]
    v_accvgpr_write_b32 a112, v204
    v_accvgpr_write_b32 a113, v205
    v_mfma_f32_16x16x32_bf16 v[24:27], a[204:207], v[232:235], v[24:27]
    s_waitcnt lgkmcnt(0)
    v_accvgpr_write_b32 a114, v206
    v_accvgpr_write_b32 a115, v207
    v_mfma_f32_16x16x32_bf16 v[24:27], a[216:219], v[236:239], v[24:27]
    v_accvgpr_read_b32 v204, a20
    v_accvgpr_read_b32 v205, a21
    v_mfma_f32_16x16x32_bf16 v[28:31], a[220:223], v[236:239], v[28:31]
    buffer_load_dwordx4 v[240:243], v254, s[8:11], s42 offen offset:1024 sc1
    v_mfma_f32_16x16x32_bf16 v[28:31], a[208:211], v[232:235], v[28:31]
    v_accvgpr_read_b32 v206, a22
    v_accvgpr_read_b32 v207, a23
    v_mfma_f32_16x16x32_bf16 v[28:31], a[196:199], v[228:231], v[28:31]
    v_accvgpr_read_b32 v208, a116
    v_accvgpr_read_b32 v209, a117
    v_mfma_f32_16x16x32_bf16 v[32:35], a[200:203], v[228:231], v[32:35]
    ds_read_b128 v[228:231], v253 offset:14304
    v_accvgpr_read_b32 v210, a118
    v_mfma_f32_16x16x32_bf16 v[32:35], a[212:215], v[232:235], v[32:35]
    buffer_load_dwordx4 v[244:247], v254, s[8:11], s42 offen offset:2048 sc1
    v_mfma_f32_16x16x32_bf16 v[32:35], a[224:227], v[236:239], v[32:35]
    v_accvgpr_read_b32 v211, a119
    v_add_f32 v212, v204, v208
    v_mfma_f32_16x16x32_bf16 v[36:39], a[192:195], v[232:235], v[36:39]
    v_add_f32 v213, v205, v209
    v_add_f32 v214, v206, v210
    v_mfma_f32_16x16x32_bf16 v[36:39], a[204:207], v[236:239], v[36:39]
    s_waitcnt lgkmcnt(0)
    v_add_f32 v215, v207, v211
    v_sub_f32 v204, v204, v208
    v_mfma_f32_16x16x32_bf16 v[36:39], a[216:219], v[228:231], v[36:39]
    v_sub_f32 v205, v205, v209
    v_sub_f32 v206, v206, v210
    v_mfma_f32_16x16x32_bf16 v[40:43], a[220:223], v[228:231], v[40:43]
    v_sub_f32 v207, v207, v211
    v_accvgpr_write_b32 a20, v212
    v_mfma_f32_16x16x32_bf16 v[40:43], a[208:211], v[236:239], v[40:43]
    v_accvgpr_write_b32 a21, v213
    v_accvgpr_write_b32 a22, v214
    v_mfma_f32_16x16x32_bf16 v[40:43], a[196:199], v[232:235], v[40:43]
    v_accvgpr_write_b32 a23, v215
    v_accvgpr_write_b32 a116, v204
    v_mfma_f32_16x16x32_bf16 v[44:47], a[200:203], v[232:235], v[44:47]
    ds_read_b128 v[232:235], v253 offset:14048
    v_accvgpr_write_b32 a117, v205
    v_mfma_f32_16x16x32_bf16 v[44:47], a[212:215], v[236:239], v[44:47]
    v_accvgpr_write_b32 a118, v206
    v_accvgpr_write_b32 a119, v207
    v_mfma_f32_16x16x32_bf16 v[44:47], a[224:227], v[228:231], v[44:47]
    v_accvgpr_read_b32 v204, a24
    v_accvgpr_read_b32 v205, a25
    v_mfma_f32_16x16x32_bf16 v[48:51], a[192:195], v[236:239], v[48:51]
    v_accvgpr_read_b32 v206, a26
    v_accvgpr_read_b32 v207, a27
    v_mfma_f32_16x16x32_bf16 v[48:51], a[204:207], v[228:231], v[48:51]
    s_waitcnt lgkmcnt(0)
    v_accvgpr_read_b32 v208, a120
    v_accvgpr_read_b32 v209, a121
    v_mfma_f32_16x16x32_bf16 v[48:51], a[216:219], v[232:235], v[48:51]
    v_accvgpr_read_b32 v210, a122
    v_accvgpr_read_b32 v211, a123
    v_mfma_f32_16x16x32_bf16 v[52:55], a[220:223], v[232:235], v[52:55]
    v_add_f32 v212, v204, v208
    v_add_f32 v213, v205, v209
    v_mfma_f32_16x16x32_bf16 v[52:55], a[208:211], v[228:231], v[52:55]
    v_add_f32 v214, v206, v210
    v_add_f32 v215, v207, v211
    v_mfma_f32_16x16x32_bf16 v[52:55], a[196:199], v[236:239], v[52:55]
    v_sub_f32 v204, v204, v208
    v_sub_f32 v205, v205, v209
    v_mfma_f32_16x16x32_bf16 v[56:59], a[200:203], v[236:239], v[56:59]
    ds_read_b128 v[236:239], v253 offset:13792
    v_sub_f32 v206, v206, v210
    v_mfma_f32_16x16x32_bf16 v[56:59], a[212:215], v[228:231], v[56:59]
    v_sub_f32 v207, v207, v211
    v_accvgpr_write_b32 a24, v212
    v_mfma_f32_16x16x32_bf16 v[56:59], a[224:227], v[232:235], v[56:59]
    v_accvgpr_write_b32 a25, v213
    v_accvgpr_write_b32 a26, v214
    v_mfma_f32_16x16x32_bf16 v[60:63], a[192:195], v[228:231], v[60:63]
    v_accvgpr_write_b32 a27, v215
    v_accvgpr_write_b32 a120, v204
    v_mfma_f32_16x16x32_bf16 v[60:63], a[204:207], v[232:235], v[60:63]
    s_waitcnt lgkmcnt(0)
    v_accvgpr_write_b32 a121, v205
    v_accvgpr_write_b32 a122, v206
    v_mfma_f32_16x16x32_bf16 v[60:63], a[216:219], v[236:239], v[60:63]
    v_accvgpr_write_b32 a123, v207
    v_accvgpr_read_b32 v204, a84
    v_mfma_f32_16x16x32_bf16 v[64:67], a[220:223], v[236:239], v[64:67]
    v_accvgpr_read_b32 v205, a85
    v_accvgpr_read_b32 v206, a86
    v_mfma_f32_16x16x32_bf16 v[64:67], a[208:211], v[232:235], v[64:67]
    v_accvgpr_read_b32 v207, a87
    v_accvgpr_read_b32 v208, a180
    v_mfma_f32_16x16x32_bf16 v[64:67], a[196:199], v[228:231], v[64:67]
    v_accvgpr_read_b32 v209, a181
    v_accvgpr_read_b32 v210, a182
    v_mfma_f32_16x16x32_bf16 v[68:71], a[200:203], v[228:231], v[68:71]
    ds_read_b128 v[228:231], v253 offset:13536
    v_accvgpr_read_b32 v211, a183
    v_mfma_f32_16x16x32_bf16 v[68:71], a[212:215], v[232:235], v[68:71]
    v_add_f32 v212, v204, v208
    v_add_f32 v213, v205, v209
    v_mfma_f32_16x16x32_bf16 v[68:71], a[224:227], v[236:239], v[68:71]
    v_add_f32 v214, v206, v210
    v_add_f32 v215, v207, v211
    v_mfma_f32_16x16x32_bf16 v[72:75], a[192:195], v[232:235], v[72:75]
    v_sub_f32 v204, v204, v208
    v_sub_f32 v205, v205, v209
    v_mfma_f32_16x16x32_bf16 v[72:75], a[204:207], v[236:239], v[72:75]
    s_waitcnt lgkmcnt(0)
    v_sub_f32 v206, v206, v210
    v_sub_f32 v207, v207, v211
    v_mfma_f32_16x16x32_bf16 v[72:75], a[216:219], v[228:231], v[72:75]
    v_accvgpr_write_b32 a84, v212
    v_accvgpr_write_b32 a85, v213
    v_mfma_f32_16x16x32_bf16 v[76:79], a[220:223], v[228:231], v[76:79]
    v_accvgpr_write_b32 a86, v214
    v_accvgpr_write_b32 a87, v215
    v_mfma_f32_16x16x32_bf16 v[76:79], a[208:211], v[236:239], v[76:79]
    v_accvgpr_write_b32 a180, v204
    v_accvgpr_write_b32 a181, v205
    v_mfma_f32_16x16x32_bf16 v[76:79], a[196:199], v[232:235], v[76:79]
    v_accvgpr_write_b32 a182, v206
    v_accvgpr_write_b32 a183, v207
    v_mfma_f32_16x16x32_bf16 v[80:83], a[200:203], v[232:235], v[80:83]
    ds_read_b128 v[232:235], v253 offset:13264
    v_accvgpr_read_b32 v204, a88
    v_mfma_f32_16x16x32_bf16 v[80:83], a[212:215], v[236:239], v[80:83]
    v_accvgpr_read_b32 v205, a89
    v_accvgpr_read_b32 v206, a90
    v_mfma_f32_16x16x32_bf16 v[80:83], a[224:227], v[228:231], v[80:83]
    s_mov_b32 s42, 921600
    v_accvgpr_read_b32 v207, a91
    v_accvgpr_read_b32 v208, a184
    v_mfma_f32_16x16x32_bf16 v[84:87], a[192:195], v[236:239], v[84:87]
    v_accvgpr_read_b32 v209, a185
    v_accvgpr_read_b32 v210, a186
    v_mfma_f32_16x16x32_bf16 v[88:91], a[196:199], v[236:239], v[88:91]
    v_accvgpr_read_b32 v211, a187
    v_add_f32 v212, v204, v208
    v_mfma_f32_16x16x32_bf16 v[92:95], a[200:203], v[236:239], v[92:95]
    ds_read_b128 v[236:239], v253 offset:1040
    v_add_f32 v213, v205, v209
    v_mfma_f32_16x16x32_bf16 v[92:95], a[212:215], v[228:231], v[92:95]
    buffer_load_dwordx4 a[192:195], v254, s[8:11], s42 offen offset:0 sc1
    v_mfma_f32_16x16x32_bf16 v[88:91], a[208:211], v[228:231], v[88:91]
    s_waitcnt lgkmcnt(1)
    v_add_f32 v214, v206, v210
    v_add_f32 v215, v207, v211
    v_mfma_f32_16x16x32_bf16 v[84:87], a[204:207], v[228:231], v[84:87]
    ds_read_b128 v[228:231], v253 offset:768
    v_sub_f32 v204, v204, v208
    v_mfma_f32_16x16x32_bf16 v[84:87], a[216:219], v[232:235], v[84:87]
    buffer_load_dwordx4 a[196:199], v254, s[8:11], s42 offen offset:1024 sc1
    v_mfma_f32_16x16x32_bf16 v[88:91], a[220:223], v[232:235], v[88:91]
    s_waitcnt vmcnt(8) lgkmcnt(1)
    v_sub_f32 v205, v205, v209
    v_sub_f32 v206, v206, v210
    v_mfma_f32_16x16x32_bf16 v[92:95], a[224:227], v[232:235], v[92:95]
    ds_read_b128 v[232:235], v253 offset:512
    v_sub_f32 v207, v207, v211
sub23:
    v_mfma_f32_16x16x32_bf16 v[96:99], a[228:231], v[236:239], v[96:99]
    buffer_load_dwordx4 a[200:203], v254, s[8:11], s42 offen offset:2048 sc1
    v_mfma_f32_16x16x32_bf16 v[100:103], a[232:235], v[236:239], v[100:103]
    s_mov_b32 s42, 924672
    v_accvgpr_write_b32 a88, v212
    v_accvgpr_write_b32 a89, v213
    v_mfma_f32_16x16x32_bf16 v[104:107], a[236:239], v[236:239], v[104:107]
    ds_read_b128 v[236:239], v253 offset:256
    s_waitcnt vmcnt(6)
    s_waitcnt lgkmcnt(2)
    v_mfma_f32_16x16x32_bf16 v[104:107], a[248:251], v[228:231], v[104:107]
    v_accvgpr_write_b32 a90, v214
    v_accvgpr_write_b32 a91, v215
    v_mfma_f32_16x16x32_bf16 v[100:103], a[244:247], v[228:231], v[100:103]
    buffer_load_dwordx4 a[204:207], v254, s[8:11], s42 offen offset:0 sc1
    v_mfma_f32_16x16x32_bf16 v[96:99], a[240:243], v[228:231], v[96:99]
    s_waitcnt vmcnt(4) lgkmcnt(1)
    v_accvgpr_write_b32 a184, v204
    v_accvgpr_write_b32 a185, v205
    v_mfma_f32_16x16x32_bf16 v[96:99], a[252:255], v[232:235], v[96:99]
    v_accvgpr_write_b32 a186, v206
    v_accvgpr_write_b32 a187, v207
    v_mfma_f32_16x16x32_bf16 v[100:103], v[240:243], v[232:235], v[100:103]
    v_accvgpr_read_b32 v204, a92
    v_accvgpr_read_b32 v205, a93
    v_mfma_f32_16x16x32_bf16 v[104:107], v[244:247], v[232:235], v[104:107]
    buffer_load_dwordx4 a[208:211], v254, s[8:11], s42 offen offset:1024 sc1
    v_mfma_f32_16x16x32_bf16 v[108:111], a[228:231], v[228:231], v[108:111]
    v_accvgpr_read_b32 v206, a94
    v_accvgpr_read_b32 v207, a95
    v_mfma_f32_16x16x32_bf16 v[108:111], a[240:243], v[232:235], v[108:111]
    s_waitcnt lgkmcnt(0)
    v_accvgpr_read_b32 v208, a188
    v_accvgpr_read_b32 v209, a189
    v_mfma_f32_16x16x32_bf16 v[108:111], a[252:255], v[236:239], v[108:111]
    v_accvgpr_read_b32 v210, a190
    v_accvgpr_read_b32 v211, a191
    v_mfma_f32_16x16x32_bf16 v[112:115], v[240:243], v[236:239], v[112:115]
    buffer_load_dwordx4 a[212:215], v254, s[8:11], s42 offen offset:2048 sc1
    v_mfma_f32_16x16x32_bf16 v[112:115], a[244:247], v[232:235], v[112:115]
    s_mov_b32 s42, 927744
    v_add_f32 v212, v204, v208
    v_add_f32 v213, v205, v209
    v_mfma_f32_16x16x32_bf16 v[112:115], a[232:235], v[228:231], v[112:115]
    v_add_f32 v214, v206, v210
    v_add_f32 v215, v207, v211
    v_mfma_f32_16x16x32_bf16 v[116:119], a[236:239], v[228:231], v[116:119]
    ds_read_b128 v[228:231], v253 offset:0
    v_sub_f32 v204, v204, v208
    v_mfma_f32_16x16x32_bf16 v[116:119], a[248:251], v[232:235], v[116:119]
    buffer_load_dwordx4 a[216:219], v254, s[8:11], s42 offen offset:0 sc1
    v_mfma_f32_16x16x32_bf16 v[116:119], v[244:247], v[236:239], v[116:119]
    v_sub_f32 v205, v205, v209
    v_sub_f32 v206, v206, v210
    v_mfma_f32_16x16x32_bf16 v[120:123], a[228:231], v[232:235], v[120:123]
pad8:
    s_cbranch_vccnz pad12
    v_sub_f32 v207, v207, v211
    v_accvgpr_write_b32 a92, v212
    v_mfma_f32_16x16x32_bf16 v[120:123], a[240:243], v[236:239], v[120:123]
    s_waitcnt lgkmcnt(0)
    v_accvgpr_write_b32 a93, v213
    v_accvgpr_write_b32 a94, v214
    v_mfma_f32_16x16x32_bf16 v[120:123], a[252:255], v[228:231], v[120:123]
    v_accvgpr_write_b32 a95, v215
    v_accvgpr_write_b32 a188, v204
    v_mfma_f32_16x16x32_bf16 v[124:127], v[240:243], v[228:231], v[124:127]
    buffer_load_dwordx4 a[220:223], v254, s[8:11], s42 offen offset:1024 sc1
    v_mfma_f32_16x16x32_bf16 v[124:127], a[244:247], v[236:239], v[124:127]
    v_accvgpr_write_b32 a189, v205
    v_accvgpr_write_b32 a190, v206
    v_mfma_f32_16x16x32_bf16 v[124:127], a[232:235], v[232:235], v[124:127]
    v_accvgpr_write_b32 a191, v207
    v_accvgpr_read_b32 v204, a0
    v_mfma_f32_16x16x32_bf16 v[128:131], a[236:239], v[232:235], v[128:131]
    ds_read_b128 v[232:235], v253 offset:1824
    v_accvgpr_read_b32 v205, a1
    v_mfma_f32_16x16x32_bf16 v[128:131], a[248:251], v[236:239], v[128:131]
    buffer_load_dwordx4 a[224:227], v254, s[8:11], s42 offen offset:2048 sc1
    v_mfma_f32_16x16x32_bf16 v[128:131], v[244:247], v[228:231], v[128:131]
    v_accvgpr_read_b32 v206, a2
    v_accvgpr_read_b32 v207, a3
    v_mfma_f32_16x16x32_bf16 v[132:135], a[228:231], v[236:239], v[132:135]
    v_and_b32 v252, 0x1f0, v254
    v_mul_u32_u24 v252, 96, v252
    v_mfma_f32_16x16x32_bf16 v[132:135], a[240:243], v[228:231], v[132:135]
    s_waitcnt lgkmcnt(0)
    v_add_f32 v208, v0, v96
    v_add_f32 v209, v1, v97
    v_mfma_f32_16x16x32_bf16 v[132:135], a[252:255], v[232:235], v[132:135]
    buffer_load_dword v252, v252, s[4:7], s100 offen offset:1152
    v_mfma_f32_16x16x32_bf16 v[136:139], v[240:243], v[232:235], v[136:139]
    v_add_f32 v210, v2, v98
    v_add_f32 v211, v3, v99
    v_mfma_f32_16x16x32_bf16 v[136:139], a[244:247], v[228:231], v[136:139]
    v_sub_f32 v96, v0, v96
    v_sub_f32 v97, v1, v97
    v_mfma_f32_16x16x32_bf16 v[136:139], a[232:235], v[236:239], v[136:139]
    v_sub_f32 v98, v2, v98
    v_sub_f32 v99, v3, v99
    v_mfma_f32_16x16x32_bf16 v[140:143], a[236:239], v[236:239], v[140:143]
    ds_read_b128 v[236:239], v253 offset:1568
    v_fma_f32 v0, v208, s31, v204
    v_mfma_f32_16x16x32_bf16 v[140:143], a[248:251], v[228:231], v[140:143]
    v_fma_f32 v1, v209, s31, v205
    v_fma_f32 v2, v210, s31, v206
    v_mfma_f32_16x16x32_bf16 v[140:143], v[244:247], v[232:235], v[140:143]
    v_fma_f32 v3, v211, s31, v207
    v_fmac_f32 v208, s30, v204
    v_mfma_f32_16x16x32_bf16 v[144:147], a[228:231], v[228:231], v[144:147]
    v_fmac_f32 v209, s30, v205
    v_fmac_f32 v210, s30, v206
    v_mfma_f32_16x16x32_bf16 v[144:147], a[240:243], v[232:235], v[144:147]
    s_waitcnt lgkmcnt(0)
    v_fmac_f32 v211, s30, v207
    v_cvt_pk_bf16_f32 v194, v208, v209
    v_mfma_f32_16x16x32_bf16 v[144:147], a[252:255], v[236:239], v[144:147]
    v_cvt_pk_bf16_f32 v195, v210, v211
    v_accvgpr_read_b32 v204, a4
    v_mfma_f32_16x16x32_bf16 v[148:151], v[240:243], v[236:239], v[148:151]
    v_accvgpr_read_b32 v205, a5
    v_accvgpr_read_b32 v206, a6
    v_mfma_f32_16x16x32_bf16 v[148:151], a[244:247], v[232:235], v[148:151]
    v_accvgpr_read_b32 v207, a7
    v_add_f32 v208, v4, v100
    v_mfma_f32_16x16x32_bf16 v[148:151], a[232:235], v[228:231], v[148:151]
    v_add_f32 v209, v5, v101
    v_add_f32 v210, v6, v102
    v_mfma_f32_16x16x32_bf16 v[152:155], a[236:239], v[228:231], v[152:155]
    ds_read_b128 v[228:231], v253 offset:1312
    v_add_f32 v211, v7, v103
    v_mfma_f32_16x16x32_bf16 v[152:155], a[248:251], v[232:235], v[152:155]
    v_sub_f32 v100, v4, v100
    v_sub_f32 v101, v5, v101
    v_mfma_f32_16x16x32_bf16 v[152:155], v[244:247], v[236:239], v[152:155]
    v_sub_f32 v102, v6, v102
    v_sub_f32 v103, v7, v103
    v_mfma_f32_16x16x32_bf16 v[156:159], a[228:231], v[232:235], v[156:159]
    v_fma_f32 v4, v208, s31, v204
    v_fma_f32 v5, v209, s31, v205
    v_mfma_f32_16x16x32_bf16 v[156:159], a[240:243], v[236:239], v[156:159]
    s_waitcnt lgkmcnt(0)
    v_fma_f32 v6, v210, s31, v206
    v_fma_f32 v7, v211, s31, v207
    v_mfma_f32_16x16x32_bf16 v[156:159], a[252:255], v[228:231], v[156:159]
    v_fmac_f32 v208, s30, v204
    v_fmac_f32 v209, s30, v205
    v_mfma_f32_16x16x32_bf16 v[160:163], v[240:243], v[228:231], v[160:163]
    v_fmac_f32 v210, s30, v206
    v_fmac_f32 v211, s30, v207
    v_mfma_f32_16x16x32_bf16 v[160:163], a[244:247], v[236:239], v[160:163]
    v_cvt_pk_bf16_f32 v196, v208, v209
    v_cvt_pk_bf16_f32 v197, v210, v211
    v_mfma_f32_16x16x32_bf16 v[160:163], a[232:235], v[232:235], v[160:163]
    v_accvgpr_read_b32 v204, a8
    v_accvgpr_read_b32 v205, a9
    v_mfma_f32_16x16x32_bf16 v[164:167], a[236:239], v[232:235], v[164:167]
    ds_read_b128 v[232:235], v253 offset:1056
    v_accvgpr_read_b32 v206, a10
    v_mfma_f32_16x16x32_bf16 v[164:167], a[248:251], v[236:239], v[164:167]
    v_accvgpr_read_b32 v207, a11
    v_add_f32 v208, v8, v104
    v_mfma_f32_16x16x32_bf16 v[164:167], v[244:247], v[228:231], v[164:167]
    v_add_f32 v209, v9, v105
    v_add_f32 v210, v10, v106
    v_mfma_f32_16x16x32_bf16 v[168:171], a[228:231], v[236:239], v[168:171]
    v_add_f32 v211, v11, v107
    v_sub_f32 v104, v8, v104
    v_mfma_f32_16x16x32_bf16 v[168:171], a[240:243], v[228:231], v[168:171]
    s_waitcnt lgkmcnt(0)
    v_sub_f32 v105, v9, v105
    v_sub_f32 v106, v10, v106
    v_mfma_f32_16x16x32_bf16 v[168:171], a[252:255], v[232:235], v[168:171]
    v_sub_f32 v107, v11, v107
    v_fma_f32 v8, v208, s31, v204
    v_mfma_f32_16x16x32_bf16 v[172:175], v[240:243], v[232:235], v[172:175]
    v_fma_f32 v9, v209, s31, v205
    v_fma_f32 v10, v210, s31, v206
    v_mfma_f32_16x16x32_bf16 v[172:175], a[244:247], v[228:231], v[172:175]
    v_fma_f32 v11, v211, s31, v207
    v_fmac_f32 v208, s30, v204
    v_mfma_f32_16x16x32_bf16 v[172:175], a[232:235], v[236:239], v[172:175]
    v_fmac_f32 v209, s30, v205
    v_fmac_f32 v210, s30, v206
    v_mfma_f32_16x16x32_bf16 v[176:179], a[236:239], v[236:239], v[176:179]
    ds_read_b128 v[236:239], v253 offset:784
    v_fmac_f32 v211, s30, v207
    v_mfma_f32_16x16x32_bf16 v[176:179], a[248:251], v[228:231], v[176:179]
    v_cvt_pk_bf16_f32 v198, v208, v209
    v_cvt_pk_bf16_f32 v199, v210, v211
    v_mfma_f32_16x16x32_bf16 v[176:179], v[244:247], v[232:235], v[176:179]
    s_mov_b32 s42, 958464
    v_mfma_f32_16x16x32_bf16 v[180:183], a[228:231], v[228:231], v[180:183]
    s_waitcnt lgkmcnt(0)
    v_mfma_f32_16x16x32_bf16 v[184:187], a[232:235], v[228:231], v[184:187]
    s_barrier
    v_mfma_f32_16x16x32_bf16 v[188:191], a[236:239], v[228:231], v[188:191]
    ds_read_b128 v[228:231], v253 offset:15600
    v_mfma_f32_16x16x32_bf16 v[188:191], a[248:251], v[232:235], v[188:191]
    buffer_load_dwordx4 a[228:231], v254, s[8:11], s42 offen offset:0 sc1
    v_mfma_f32_16x16x32_bf16 v[184:187], a[244:247], v[232:235], v[184:187]
    v_mfma_f32_16x16x32_bf16 v[180:183], a[240:243], v[232:235], v[180:183]
    ds_read_b128 v[232:235], v253 offset:15328
    v_mfma_f32_16x16x32_bf16 v[180:183], a[252:255], v[236:239], v[180:183]
    buffer_load_dwordx4 a[232:235], v254, s[8:11], s42 offen offset:1024 sc1
    v_mfma_f32_16x16x32_bf16 v[184:187], v[240:243], v[236:239], v[184:187]
    s_waitcnt vmcnt(9) lgkmcnt(1)
    v_mfma_f32_16x16x32_bf16 v[188:191], v[244:247], v[236:239], v[188:191]
    ds_read_b128 v[236:239], v253 offset:15072
    s_nop 0
    ds_write_b128 v248, v[194:197] offset:0
    v_accvgpr_read_b32 v204, a12
    v_accvgpr_read_b32 v205, a13
    v_accvgpr_read_b32 v206, a14
    v_accvgpr_read_b32 v207, a15
    v_pk_add_f32 v[208:209], v[12:13], v[108:109]
    v_pk_add_f32 v[210:211], v[14:15], v[110:111]
    v_pk_add_f32 v[108:109], v[12:13], v[108:109] neg_lo:[0,1] neg_hi:[0,1]
    v_pk_add_f32 v[110:111], v[14:15], v[110:111] neg_lo:[0,1] neg_hi:[0,1]
    v_pk_fma_f32 v[12:13], v[208:209], s[30:31], v[204:205] op_sel:[0,1,0]
    v_pk_fma_f32 v[14:15], v[210:211], s[30:31], v[206:207] op_sel:[0,1,0]
    v_pk_fma_f32 v[204:205], v[204:205], s[30:31], v[208:209] op_sel_hi:[1,0,1]
    v_pk_fma_f32 v[206:207], v[206:207], s[30:31], v[210:211] op_sel_hi:[1,0,1]
    v_cvt_pk_bf16_f32 v220, v204, v205
    v_cvt_pk_bf16_f32 v221, v206, v207
    ds_write_b64 v249, v[198:199] offset:64
    v_accvgpr_read_b32 v212, a16
    v_accvgpr_read_b32 v213, a17
    v_accvgpr_read_b32 v214, a18
    v_accvgpr_read_b32 v215, a19
    v_pk_add_f32 v[216:217], v[16:17], v[112:113]
    v_pk_add_f32 v[218:219], v[18:19], v[114:115]
    v_pk_add_f32 v[112:113], v[16:17], v[112:113] neg_lo:[0,1] neg_hi:[0,1]
    v_pk_add_f32 v[114:115], v[18:19], v[114:115] neg_lo:[0,1] neg_hi:[0,1]
    v_pk_fma_f32 v[16:17], v[216:217], s[30:31], v[212:213] op_sel:[0,1,0]
    v_pk_fma_f32 v[18:19], v[218:219], s[30:31], v[214:215] op_sel:[0,1,0]
    v_pk_fma_f32 v[212:213], v[212:213], s[30:31], v[216:217] op_sel_hi:[1,0,1]
    v_pk_fma_f32 v[214:215], v[214:215], s[30:31], v[218:219] op_sel_hi:[1,0,1]
    v_cvt_pk_bf16_f32 v222, v212, v213
    v_cvt_pk_bf16_f32 v223, v214, v215
    ds_write_b128 v248, v[220:223] offset:384
    v_accvgpr_read_b32 v204, a20
    v_accvgpr_read_b32 v205, a21
    v_accvgpr_read_b32 v206, a22
    v_accvgpr_read_b32 v207, a23
    v_pk_add_f32 v[208:209], v[20:21], v[116:117]
    v_pk_add_f32 v[210:211], v[22:23], v[118:119]
    v_pk_add_f32 v[116:117], v[20:21], v[116:117] neg_lo:[0,1] neg_hi:[0,1]
    v_pk_add_f32 v[118:119], v[22:23], v[118:119] neg_lo:[0,1] neg_hi:[0,1]
    v_pk_fma_f32 v[20:21], v[208:209], s[30:31], v[204:205] op_sel:[0,1,0]
    v_pk_fma_f32 v[22:23], v[210:211], s[30:31], v[206:207] op_sel:[0,1,0]
    v_pk_fma_f32 v[204:205], v[204:205], s[30:31], v[208:209] op_sel_hi:[1,0,1]
    v_pk_fma_f32 v[206:207], v[206:207], s[30:31], v[210:211] op_sel_hi:[1,0,1]
    v_cvt_pk_bf16_f32 v224, v204, v205
    v_cvt_pk_bf16_f32 v225, v206, v207
    v_accvgpr_read_b32 v204, a24
    v_accvgpr_read_b32 v205, a25
    v_accvgpr_read_b32 v206, a26
    v_accvgpr_read_b32 v207, a27
    v_pk_add_f32 v[208:209], v[24:25], v[120:121]
    v_pk_add_f32 v[210:211], v[26:27], v[122:123]
    v_pk_add_f32 v[120:121], v[24:25], v[120:121] neg_lo:[0,1] neg_hi:[0,1]
    v_pk_add_f32 v[122:123], v[26:27], v[122:123] neg_lo:[0,1] neg_hi:[0,1]
    v_pk_fma_f32 v[24:25], v[208:209], s[30:31], v[204:205] op_sel:[0,1,0]
    v_pk_fma_f32 v[26:27], v[210:211], s[30:31], v[206:207] op_sel:[0,1,0]
    v_pk_fma_f32 v[204:205], v[204:205], s[30:31], v[208:209] op_sel_hi:[1,0,1]
    v_pk_fma_f32 v[206:207], v[206:207], s[30:31], v[210:211] op_sel_hi:[1,0,1]
    v_cvt_pk_bf16_f32 v194, v204, v205
    v_cvt_pk_bf16_f32 v195, v206, v207
    ds_write_b64 v249, v[224:225] offset:448
    v_accvgpr_read_b32 v212, a28
    v_accvgpr_read_b32 v213, a29
    v_accvgpr_read_b32 v214, a30
    v_accvgpr_read_b32 v215, a31
    v_accvgpr_read_b32 v216, a124
    v_accvgpr_read_b32 v217, a125
    v_accvgpr_read_b32 v218, a126
    v_accvgpr_read_b32 v219, a127
    v_pk_add_f32 v[212:213], v[212:213], v[216:217]
    v_pk_add_f32 v[214:215], v[214:215], v[218:219]
    v_pk_add_f32 v[216:217], v[28:29], v[124:125]
    v_pk_add_f32 v[218:219], v[30:31], v[126:127]
    v_pk_add_f32 v[124:125], v[28:29], v[124:125] neg_lo:[0,1] neg_hi:[0,1]
    v_pk_add_f32 v[126:127], v[30:31], v[126:127] neg_lo:[0,1] neg_hi:[0,1]
    v_pk_fma_f32 v[28:29], v[216:217], s[30:31], v[212:213] op_sel:[0,1,0]
    v_pk_fma_f32 v[30:31], v[218:219], s[30:31], v[214:215] op_sel:[0,1,0]
    v_pk_fma_f32 v[212:213], v[212:213], s[30:31], v[216:217] op_sel_hi:[1,0,1]
    v_pk_fma_f32 v[214:215], v[214:215], s[30:31], v[218:219] op_sel_hi:[1,0,1]
    v_cvt_pk_bf16_f32 v196, v212, v213
    v_cvt_pk_bf16_f32 v197, v214, v215
    ds_write_b128 v248, v[194:197] offset:768
    v_accvgpr_read_b32 v204, a32
    v_accvgpr_read_b32 v205, a33
    v_accvgpr_read_b32 v206, a34
    v_accvgpr_read_b32 v207, a35
    v_accvgpr_read_b32 v208, a128
    v_accvgpr_read_b32 v209, a129
    v_accvgpr_read_b32 v210, a130
    v_accvgpr_read_b32 v211, a131
    v_pk_add_f32 v[204:205], v[204:205], v[208:209]
    v_pk_add_f32 v[206:207], v[206:207], v[210:211]
    v_pk_add_f32 v[208:209], v[32:33], v[128:129]
    v_pk_add_f32 v[210:211], v[34:35], v[130:131]
    v_pk_add_f32 v[128:129], v[32:33], v[128:129] neg_lo:[0,1] neg_hi:[0,1]
    v_pk_add_f32 v[130:131], v[34:35], v[130:131] neg_lo:[0,1] neg_hi:[0,1]
    v_pk_fma_f32 v[32:33], v[208:209], s[30:31], v[204:205] op_sel:[0,1,0]
    v_pk_fma_f32 v[34:35], v[210:211], s[30:31], v[206:207] op_sel:[0,1,0]
    v_pk_fma_f32 v[204:205], v[204:205], s[30:31], v[208:209] op_sel_hi:[1,0,1]
    v_pk_fma_f32 v[206:207], v[206:207], s[30:31], v[210:211] op_sel_hi:[1,0,1]
    v_cvt_pk_bf16_f32 v198, v204, v205
    v_cvt_pk_bf16_f32 v199, v206, v207
    v_accvgpr_read_b32 v204, a36
    v_accvgpr_read_b32 v205, a37
    v_accvgpr_read_b32 v206, a38
    v_accvgpr_read_b32 v207, a39
    v_accvgpr_read_b32 v208, a132
    v_accvgpr_read_b32 v209, a133
    v_accvgpr_read_b32 v210, a134
    v_accvgpr_read_b32 v211, a135
    v_pk_add_f32 v[204:205], v[204:205], v[208:209]
    v_pk_add_f32 v[206:207], v[206:207], v[210:211]
    v_pk_add_f32 v[208:209], v[36:37], v[132:133]
    v_pk_add_f32 v[210:211], v[38:39], v[134:135]
    v_pk_add_f32 v[132:133], v[36:37], v[132:133] neg_lo:[0,1] neg_hi:[0,1]
    v_pk_add_f32 v[134:135], v[38:39], v[134:135] neg_lo:[0,1] neg_hi:[0,1]
    v_pk_fma_f32 v[36:37], v[208:209], s[30:31], v[204:205] op_sel:[0,1,0]
    v_pk_fma_f32 v[38:39], v[210:211], s[30:31], v[206:207] op_sel:[0,1,0]
    v_pk_fma_f32 v[204:205], v[204:205], s[30:31], v[208:209] op_sel_hi:[1,0,1]
    v_pk_fma_f32 v[206:207], v[206:207], s[30:31], v[210:211] op_sel_hi:[1,0,1]
    v_cvt_pk_bf16_f32 v220, v204, v205
    v_cvt_pk_bf16_f32 v221, v206, v207
    ds_write_b64 v249, v[198:199] offset:832
    v_accvgpr_read_b32 v212, a40
    v_accvgpr_read_b32 v213, a41
    v_accvgpr_read_b32 v214, a42
    v_accvgpr_read_b32 v215, a43
    v_accvgpr_read_b32 v216, a136
    v_accvgpr_read_b32 v217, a137
    v_accvgpr_read_b32 v218, a138
    v_accvgpr_read_b32 v219, a139
    v_pk_add_f32 v[212:213], v[212:213], v[216:217]
    v_pk_add_f32 v[214:215], v[214:215], v[218:219]
    v_pk_add_f32 v[216:217], v[40:41], v[136:137]
    v_pk_add_f32 v[218:219], v[42:43], v[138:139]
    v_pk_add_f32 v[136:137], v[40:41], v[136:137] neg_lo:[0,1] neg_hi:[0,1]
    v_pk_add_f32 v[138:139], v[42:43], v[138:139] neg_lo:[0,1] neg_hi:[0,1]
    v_pk_fma_f32 v[40:41], v[216:217], s[30:31], v[212:213] op_sel:[0,1,0]
    v_pk_fma_f32 v[42:43], v[218:219], s[30:31], v[214:215] op_sel:[0,1,0]
    v_pk_fma_f32 v[212:213], v[212:213], s[30:31], v[216:217] op_sel_hi:[1,0,1]
    v_pk_fma_f32 v[214:215], v[214:215], s[30:31], v[218:219] op_sel_hi:[1,0,1]
    v_cvt_pk_bf16_f32 v222, v212, v213
    v_cvt_pk_bf16_f32 v223, v214, v215
    ds_write_b128 v248, v[220:223] offset:1152
    v_accvgpr_read_b32 v204, a44
    v_accvgpr_read_b32 v205, a45
    v_accvgpr_read_b32 v206, a46
    v_accvgpr_read_b32 v207, a47
    v_accvgpr_read_b32 v208, a140
    v_accvgpr_read_b32 v209, a141
    v_accvgpr_read_b32 v210, a142
    v_accvgpr_read_b32 v211, a143
    v_pk_add_f32 v[204:205], v[204:205], v[208:209]
    v_pk_add_f32 v[206:207], v[206:207], v[210:211]
    v_pk_add_f32 v[208:209], v[44:45], v[140:141]
    v_pk_add_f32 v[210:211], v[46:47], v[142:143]
    v_pk_add_f32 v[140:141], v[44:45], v[140:141] neg_lo:[0,1] neg_hi:[0,1]
    v_pk_add_f32 v[142:143], v[46:47], v[142:143] neg_lo:[0,1] neg_hi:[0,1]
    v_pk_fma_f32 v[44:45], v[208:209], s[30:31], v[204:205] op_sel:[0,1,0]
    v_pk_fma_f32 v[46:47], v[210:211], s[30:31], v[206:207] op_sel:[0,1,0]
    v_pk_fma_f32 v[204:205], v[204:205], s[30:31], v[208:209] op_sel_hi:[1,0,1]
    v_pk_fma_f32 v[206:207], v[206:207], s[30:31], v[210:211] op_sel_hi:[1,0,1]
    v_cvt_pk_bf16_f32 v224, v204, v205
    v_cvt_pk_bf16_f32 v225, v206, v207
    v_accvgpr_read_b32 v204, a48
    v_accvgpr_read_b32 v205, a49
    v_accvgpr_read_b32 v206, a50
    v_accvgpr_read_b32 v207, a51
    v_accvgpr_read_b32 v208, a144
    v_accvgpr_read_b32 v209, a145
    v_accvgpr_read_b32 v210, a146
    v_accvgpr_read_b32 v211, a147
    v_pk_add_f32 v[204:205], v[204:205], v[208:209]
    v_pk_add_f32 v[206:207], v[206:207], v[210:211]
    v_pk_add_f32 v[208:209], v[48:49], v[144:145]
    v_pk_add_f32 v[210:211], v[50:51], v[146:147]
    v_pk_add_f32 v[144:145], v[48:49], v[144:145] neg_lo:[0,1] neg_hi:[0,1]
    v_pk_add_f32 v[146:147], v[50:51], v[146:147] neg_lo:[0,1] neg_hi:[0,1]
    v_pk_fma_f32 v[48:49], v[208:209], s[30:31], v[204:205] op_sel:[0,1,0]
    v_pk_fma_f32 v[50:51], v[210:211], s[30:31], v[206:207] op_sel:[0,1,0]
    v_pk_fma_f32 v[204:205], v[204:205], s[30:31], v[208:209] op_sel_hi:[1,0,1]
    v_pk_fma_f32 v[206:207], v[206:207], s[30:31], v[210:211] op_sel_hi:[1,0,1]
    v_cvt_pk_bf16_f32 v194, v204, v205
    v_cvt_pk_bf16_f32 v195, v206, v207
    ds_write_b64 v249, v[224:225] offset:1216
    v_accvgpr_read_b32 v212, a52
    v_accvgpr_read_b32 v213, a53
    v_accvgpr_read_b32 v214, a54
    v_accvgpr_read_b32 v215, a55
    v_accvgpr_read_b32 v216, a148
    v_accvgpr_read_b32 v217, a149
    v_accvgpr_read_b32 v218, a150
    v_accvgpr_read_b32 v219, a151
    v_pk_add_f32 v[212:213], v[212:213], v[216:217]
    v_pk_add_f32 v[214:215], v[214:215], v[218:219]
    v_pk_add_f32 v[216:217], v[52:53], v[148:149]
    v_pk_add_f32 v[218:219], v[54:55], v[150:151]
    v_pk_add_f32 v[148:149], v[52:53], v[148:149] neg_lo:[0,1] neg_hi:[0,1]
    v_pk_add_f32 v[150:151], v[54:55], v[150:151] neg_lo:[0,1] neg_hi:[0,1]
    v_pk_fma_f32 v[52:53], v[216:217], s[30:31], v[212:213] op_sel:[0,1,0]
    v_pk_fma_f32 v[54:55], v[218:219], s[30:31], v[214:215] op_sel:[0,1,0]
    v_pk_fma_f32 v[212:213], v[212:213], s[30:31], v[216:217] op_sel_hi:[1,0,1]
    v_pk_fma_f32 v[214:215], v[214:215], s[30:31], v[218:219] op_sel_hi:[1,0,1]
    v_cvt_pk_bf16_f32 v196, v212, v213
    v_cvt_pk_bf16_f32 v197, v214, v215
    ds_write_b128 v248, v[194:197] offset:1536
    v_accvgpr_read_b32 v204, a56
    v_accvgpr_read_b32 v205, a57
    v_accvgpr_read_b32 v206, a58
    v_accvgpr_read_b32 v207, a59
    v_accvgpr_read_b32 v208, a152
    v_accvgpr_read_b32 v209, a153
    v_accvgpr_read_b32 v210, a154
    v_accvgpr_read_b32 v211, a155
    v_pk_add_f32 v[204:205], v[204:205], v[208:209]
    v_pk_add_f32 v[206:207], v[206:207], v[210:211]
    v_pk_add_f32 v[208:209], v[56:57], v[152:153]
    v_pk_add_f32 v[210:211], v[58:59], v[154:155]
    v_pk_add_f32 v[152:153], v[56:57], v[152:153] neg_lo:[0,1] neg_hi:[0,1]
    v_pk_add_f32 v[154:155], v[58:59], v[154:155] neg_lo:[0,1] neg_hi:[0,1]
    v_pk_fma_f32 v[56:57], v[208:209], s[30:31], v[204:205] op_sel:[0,1,0]
    v_pk_fma_f32 v[58:59], v[210:211], s[30:31], v[206:207] op_sel:[0,1,0]
    v_pk_fma_f32 v[204:205], v[204:205], s[30:31], v[208:209] op_sel_hi:[1,0,1]
    v_pk_fma_f32 v[206:207], v[206:207], s[30:31], v[210:211] op_sel_hi:[1,0,1]
    v_cvt_pk_bf16_f32 v198, v204, v205
    v_cvt_pk_bf16_f32 v199, v206, v207
    v_accvgpr_read_b32 v204, a60
    v_accvgpr_read_b32 v205, a61
    v_accvgpr_read_b32 v206, a62
    v_accvgpr_read_b32 v207, a63
    v_accvgpr_read_b32 v208, a156
    v_accvgpr_read_b32 v209, a157
    v_accvgpr_read_b32 v210, a158
    v_accvgpr_read_b32 v211, a159
    v_pk_add_f32 v[204:205], v[204:205], v[208:209]
    v_pk_add_f32 v[206:207], v[206:207], v[210:211]
    v_pk_add_f32 v[208:209], v[60:61], v[156:157]
    v_pk_add_f32 v[210:211], v[62:63], v[158:159]
    v_pk_add_f32 v[156:157], v[60:61], v[156:157] neg_lo:[0,1] neg_hi:[0,1]
    v_pk_add_f32 v[158:159], v[62:63], v[158:159] neg_lo:[0,1] neg_hi:[0,1]
    v_pk_fma_f32 v[60:61], v[208:209], s[30:31], v[204:205] op_sel:[0,1,0]
    v_pk_fma_f32 v[62:63], v[210:211], s[30:31], v[206:207] op_sel:[0,1,0]
    v_pk_fma_f32 v[204:205], v[204:205], s[30:31], v[208:209] op_sel_hi:[1,0,1]
    v_pk_fma_f32 v[206:207], v[206:207], s[30:31], v[210:211] op_sel_hi:[1,0,1]
    v_cvt_pk_bf16_f32 v220, v204, v205
    v_cvt_pk_bf16_f32 v221, v206, v207
    ds_write_b64 v249, v[198:199] offset:1600
    v_accvgpr_read_b32 v212, a64
    v_accvgpr_read_b32 v213, a65
    v_accvgpr_read_b32 v214, a66
    v_accvgpr_read_b32 v215, a67
    v_accvgpr_read_b32 v216, a160
    v_accvgpr_read_b32 v217, a161
    v_accvgpr_read_b32 v218, a162
    v_accvgpr_read_b32 v219, a163
    v_pk_add_f32 v[212:213], v[212:213], v[216:217]
    v_pk_add_f32 v[214:215], v[214:215], v[218:219]
    v_pk_add_f32 v[216:217], v[64:65], v[160:161]
    v_pk_add_f32 v[218:219], v[66:67], v[162:163]
    v_pk_add_f32 v[160:161], v[64:65], v[160:161] neg_lo:[0,1] neg_hi:[0,1]
    v_pk_add_f32 v[162:163], v[66:67], v[162:163] neg_lo:[0,1] neg_hi:[0,1]
    v_pk_fma_f32 v[64:65], v[216:217], s[30:31], v[212:213] op_sel:[0,1,0]
    v_pk_fma_f32 v[66:67], v[218:219], s[30:31], v[214:215] op_sel:[0,1,0]
    v_pk_fma_f32 v[212:213], v[212:213], s[30:31], v[216:217] op_sel_hi:[1,0,1]
    v_pk_fma_f32 v[214:215], v[214:215], s[30:31], v[218:219] op_sel_hi:[1,0,1]
    v_cvt_pk_bf16_f32 v222, v212, v213
    v_cvt_pk_bf16_f32 v223, v214, v215
    ds_write_b128 v248, v[220:223] offset:1920
    v_accvgpr_read_b32 v204, a68
    v_accvgpr_read_b32 v205, a69
    v_accvgpr_read_b32 v206, a70
    v_accvgpr_read_b32 v207, a71
    v_accvgpr_read_b32 v208, a164
    v_accvgpr_read_b32 v209, a165
    v_accvgpr_read_b32 v210, a166
    v_accvgpr_read_b32 v211, a167
    v_pk_add_f32 v[204:205], v[204:205], v[208:209]
    v_pk_add_f32 v[206:207], v[206:207], v[210:211]
    v_pk_add_f32 v[208:209], v[68:69], v[164:165]
    v_pk_add_f32 v[210:211], v[70:71], v[166:167]
    v_pk_add_f32 v[164:165], v[68:69], v[164:165] neg_lo:[0,1] neg_hi:[0,1]
    v_pk_add_f32 v[166:167], v[70:71], v[166:167] neg_lo:[0,1] neg_hi:[0,1]
    v_pk_fma_f32 v[68:69], v[208:209], s[30:31], v[204:205] op_sel:[0,1,0]
    v_pk_fma_f32 v[70:71], v[210:211], s[30:31], v[206:207] op_sel:[0,1,0]
    v_pk_fma_f32 v[204:205], v[204:205], s[30:31], v[208:209] op_sel_hi:[1,0,1]
    v_pk_fma_f32 v[206:207], v[206:207], s[30:31], v[210:211] op_sel_hi:[1,0,1]
    v_cvt_pk_bf16_f32 v224, v204, v205
    v_cvt_pk_bf16_f32 v225, v206, v207
    v_accvgpr_read_b32 v204, a72
    v_accvgpr_read_b32 v205, a73
    v_accvgpr_read_b32 v206, a74
    v_accvgpr_read_b32 v207, a75
    v_accvgpr_read_b32 v208, a168
    v_accvgpr_read_b32 v209, a169
    v_accvgpr_read_b32 v210, a170
    v_accvgpr_read_b32 v211, a171
    v_pk_add_f32 v[204:205], v[204:205], v[208:209]
    v_pk_add_f32 v[206:207], v[206:207], v[210:211]
    v_pk_add_f32 v[208:209], v[72:73], v[168:169]
    v_pk_add_f32 v[210:211], v[74:75], v[170:171]
    v_pk_add_f32 v[168:169], v[72:73], v[168:169] neg_lo:[0,1] neg_hi:[0,1]
    v_pk_add_f32 v[170:171], v[74:75], v[170:171] neg_lo:[0,1] neg_hi:[0,1]
    v_pk_fma_f32 v[72:73], v[208:209], s[30:31], v[204:205] op_sel:[0,1,0]
    v_pk_fma_f32 v[74:75], v[210:211], s[30:31], v[206:207] op_sel:[0,1,0]
    v_pk_fma_f32 v[204:205], v[204:205], s[30:31], v[208:209] op_sel_hi:[1,0,1]
    v_pk_fma_f32 v[206:207], v[206:207], s[30:31], v[210:211] op_sel_hi:[1,0,1]
    v_cvt_pk_bf16_f32 v194, v204, v205
    v_cvt_pk_bf16_f32 v195, v206, v207
    ds_write_b64 v249, v[224:225] offset:1984
    v_accvgpr_read_b32 v212, a76
    v_accvgpr_read_b32 v213, a77
    v_accvgpr_read_b32 v214, a78
    v_accvgpr_read_b32 v215, a79
    v_accvgpr_read_b32 v216, a172
    v_accvgpr_read_b32 v217, a173
    v_accvgpr_read_b32 v218, a174
    v_accvgpr_read_b32 v219, a175
    v_pk_add_f32 v[212:213], v[212:213], v[216:217]
    v_pk_add_f32 v[214:215], v[214:215], v[218:219]
    v_pk_add_f32 v[216:217], v[76:77], v[172:173]
    v_pk_add_f32 v[218:219], v[78:79], v[174:175]
    v_pk_add_f32 v[172:173], v[76:77], v[172:173] neg_lo:[0,1] neg_hi:[0,1]
    v_pk_add_f32 v[174:175], v[78:79], v[174:175] neg_lo:[0,1] neg_hi:[0,1]
    v_pk_fma_f32 v[76:77], v[216:217], s[30:31], v[212:213] op_sel:[0,1,0]
    v_pk_fma_f32 v[78:79], v[218:219], s[30:31], v[214:215] op_sel:[0,1,0]
    v_pk_fma_f32 v[212:213], v[212:213], s[30:31], v[216:217] op_sel_hi:[1,0,1]
    v_pk_fma_f32 v[214:215], v[214:215], s[30:31], v[218:219] op_sel_hi:[1,0,1]
    v_cvt_pk_bf16_f32 v196, v212, v213
    v_cvt_pk_bf16_f32 v197, v214, v215
    ds_write_b128 v248, v[194:197] offset:2304
    v_accvgpr_read_b32 v204, a80
    v_accvgpr_read_b32 v205, a81
    v_accvgpr_read_b32 v206, a82
    v_accvgpr_read_b32 v207, a83
    v_accvgpr_read_b32 v208, a176
    v_accvgpr_read_b32 v209, a177
    v_accvgpr_read_b32 v210, a178
    v_accvgpr_read_b32 v211, a179
    v_pk_add_f32 v[204:205], v[204:205], v[208:209]
    v_pk_add_f32 v[206:207], v[206:207], v[210:211]
    v_pk_add_f32 v[208:209], v[80:81], v[176:177]
    v_pk_add_f32 v[210:211], v[82:83], v[178:179]
    v_pk_add_f32 v[176:177], v[80:81], v[176:177] neg_lo:[0,1] neg_hi:[0,1]
    v_pk_add_f32 v[178:179], v[82:83], v[178:179] neg_lo:[0,1] neg_hi:[0,1]
    v_pk_fma_f32 v[80:81], v[208:209], s[30:31], v[204:205] op_sel:[0,1,0]
    v_pk_fma_f32 v[82:83], v[210:211], s[30:31], v[206:207] op_sel:[0,1,0]
    v_pk_fma_f32 v[204:205], v[204:205], s[30:31], v[208:209] op_sel_hi:[1,0,1]
    v_pk_fma_f32 v[206:207], v[206:207], s[30:31], v[210:211] op_sel_hi:[1,0,1]
    v_cvt_pk_bf16_f32 v198, v204, v205
    v_cvt_pk_bf16_f32 v199, v206, v207
    ds_write_b64 v249, v[198:199] offset:2368
    s_waitcnt lgkmcnt(0)
    s_barrier
sub24:
    v_mfma_f32_16x16x32_bf16 v[0:3], a[192:195], v[228:231], v[0:3]
    buffer_load_dwordx4 a[236:239], v254, s[8:11], s42 offen offset:2048 sc1
    v_mfma_f32_16x16x32_bf16 v[4:7], a[196:199], v[228:231], v[4:7]
    s_mov_b32 s42, 961536
    v_accvgpr_read_b32 v204, a84
    v_accvgpr_read_b32 v205, a85
    v_mfma_f32_16x16x32_bf16 v[8:11], a[200:203], v[228:231], v[8:11]
    ds_read_b128 v[228:231], v253 offset:14816
    s_waitcnt vmcnt(7)
    v_mfma_f32_16x16x32_bf16 v[8:11], a[212:215], v[232:235], v[8:11]
    ds_read_b128 v[212:215], v250 offset:0
    v_accvgpr_read_b32 v206, a86
    v_mfma_f32_16x16x32_bf16 v[4:7], a[208:211], v[232:235], v[4:7]
    buffer_load_dwordx4 a[240:243], v254, s[8:11], s42 offen offset:0 sc1
    v_mfma_f32_16x16x32_bf16 v[0:3], a[204:207], v[232:235], v[0:3]
    s_waitcnt vmcnt(5)
    v_accvgpr_read_b32 v207, a87
    v_add_f32 v208, v84, v180
    v_mfma_f32_16x16x32_bf16 v[0:3], a[216:219], v[236:239], v[0:3]
    ds_read_b128 v[216:219], v250 offset:3104
    v_add_f32 v209, v85, v181
    v_mfma_f32_16x16x32_bf16 v[4:7], a[220:223], v[236:239], v[4:7]
    ds_read_b128 v[220:223], v250 offset:6208
    s_add_u32 s44, s40, 393216
    v_mfma_f32_16x16x32_bf16 v[8:11], a[224:227], v[236:239], v[8:11]
    buffer_load_dwordx4 a[244:247], v254, s[8:11], s42 offen offset:1024 sc1
    v_mfma_f32_16x16x32_bf16 v[12:15], a[192:195], v[232:235], v[12:15]
    ds_read_b128 v[224:227], v250 offset:9312
    v_add_f32 v210, v86, v182
    v_mfma_f32_16x16x32_bf16 v[12:15], a[204:207], v[236:239], v[12:15]
    s_waitcnt lgkmcnt(4)
    v_add_f32 v211, v87, v183
    v_sub_f32 v180, v84, v180
    v_mfma_f32_16x16x32_bf16 v[12:15], a[216:219], v[228:231], v[12:15]
pad9:
    s_cbranch_vccnz pad13
    s_waitcnt lgkmcnt(3)
    v_sub_f32 v181, v85, v181
    v_sub_f32 v182, v86, v182
    v_mfma_f32_16x16x32_bf16 v[16:19], a[220:223], v[228:231], v[16:19]
    buffer_load_dwordx4 a[248:251], v254, s[8:11], s42 offen offset:2048 sc1
    v_mfma_f32_16x16x32_bf16 v[16:19], a[208:211], v[236:239], v[16:19]
    s_mov_b32 s42, 964608
    v_sub_f32 v183, v87, v183
    v_fma_f32 v84, v208, s31, v204
    v_mfma_f32_16x16x32_bf16 v[16:19], a[196:199], v[232:235], v[16:19]
    v_fma_f32 v85, v209, s31, v205
    v_fma_f32 v86, v210, s31, v206
    v_mfma_f32_16x16x32_bf16 v[20:23], a[200:203], v[232:235], v[20:23]
    ds_read_b128 v[232:235], v253 offset:14560
    v_fma_f32 v87, v211, s31, v207
    v_mfma_f32_16x16x32_bf16 v[20:23], a[212:215], v[236:239], v[20:23]
    buffer_load_dwordx4 a[252:255], v254, s[8:11], s42 offen offset:0 sc1
    v_mfma_f32_16x16x32_bf16 v[20:23], a[224:227], v[228:231], v[20:23]
    v_fmac_f32 v208, s30, v204
    v_fmac_f32 v209, s30, v205
    v_mfma_f32_16x16x32_bf16 v[24:27], a[192:195], v[236:239], v[24:27]
    v_fmac_f32 v210, s30, v206
    v_fmac_f32 v211, s30, v207
    v_mfma_f32_16x16x32_bf16 v[24:27], a[204:207], v[228:231], v[24:27]
    s_waitcnt lgkmcnt(0)
    v_cvt_pk_bf16_f32 v192, v208, v209
    v_cvt_pk_bf16_f32 v193, v210, v211
    v_mfma_f32_16x16x32_bf16 v[24:27], a[216:219], v[232:235], v[24:27]
    v_accvgpr_read_b32 v204, a88
    v_accvgpr_read_b32 v205, a89
    v_mfma_f32_16x16x32_bf16 v[28:31], a[220:223], v[232:235], v[28:31]
    buffer_load_dwordx4 v[240:243], v254, s[8:11], s42 offen offset:1024 sc1
    v_mfma_f32_16x16x32_bf16 v[28:31], a[208:211], v[228:231], v[28:31]
    v_accvgpr_read_b32 v206, a90
    v_accvgpr_read_b32 v207, a91
    v_mfma_f32_16x16x32_bf16 v[28:31], a[196:199], v[236:239], v[28:31]
    v_add_f32 v208, v88, v184
    v_add_f32 v209, v89, v185
    v_mfma_f32_16x16x32_bf16 v[32:35], a[200:203], v[236:239], v[32:35]
    ds_read_b128 v[236:239], v253 offset:16384
    v_add_f32 v210, v90, v186
    v_mfma_f32_16x16x32_bf16 v[32:35], a[212:215], v[228:231], v[32:35]
    buffer_load_dwordx4 v[244:247], v254, s[8:11], s42 offen offset:2048 sc1
    v_mfma_f32_16x16x32_bf16 v[32:35], a[224:227], v[232:235], v[32:35]
    v_add_f32 v211, v91, v187
    v_sub_f32 v184, v88, v184
    v_mfma_f32_16x16x32_bf16 v[36:39], a[192:195], v[228:231], v[36:39]
    v_sub_f32 v185, v89, v185
    v_sub_f32 v186, v90, v186
    v_mfma_f32_16x16x32_bf16 v[36:39], a[204:207], v[232:235], v[36:39]
    s_waitcnt lgkmcnt(0)
    v_sub_f32 v187, v91, v187
    v_fma_f32 v88, v208, s31, v204
    v_mfma_f32_16x16x32_bf16 v[36:39], a[216:219], v[236:239], v[36:39]
    buffer_store_dwordx4 v[212:215], v254, s[12:15], s44 offen nt
    s_add_u32 s44, s40, 396288
    v_mfma_f32_16x16x32_bf16 v[40:43], a[220:223], v[236:239], v[40:43]
    v_fma_f32 v89, v209, s31, v205
    v_fma_f32 v90, v210, s31, v206
    v_mfma_f32_16x16x32_bf16 v[40:43], a[208:211], v[232:235], v[40:43]
    v_fma_f32 v91, v211, s31, v207
    v_fmac_f32 v208, s30, v204
    v_mfma_f32_16x16x32_bf16 v[40:43], a[196:199], v[228:231], v[40:43]
    buffer_store_dwordx4 v[216:219], v254, s[12:15], s44 offen nt
    v_fmac_f32 v209, s30, v205
    v_fmac_f32 v210, s30, v206
    v_mfma_f32_16x16x32_bf16 v[44:47], a[200:203], v[228:231], v[44:47]
    ds_read_b128 v[228:231], v253 offset:16128
    v_fmac_f32 v211, s30, v207
    v_mfma_f32_16x16x32_bf16 v[44:47], a[212:215], v[232:235], v[44:47]
    ds_read_b128 v[212:215], v250 offset:1024
    v_cvt_pk_bf16_f32 v194, v208, v209
    v_mfma_f32_16x16x32_bf16 v[44:47], a[224:227], v[236:239], v[44:47]
    s_add_u32 s44, s40, 399360
    v_cvt_pk_bf16_f32 v195, v210, v211
    v_accvgpr_read_b32 v204, a92
    v_mfma_f32_16x16x32_bf16 v[48:51], a[192:195], v[232:235], v[48:51]
    ds_read_b128 v[216:219], v250 offset:4128
    v_accvgpr_read_b32 v205, a93
    v_mfma_f32_16x16x32_bf16 v[48:51], a[204:207], v[236:239], v[48:51]
    s_waitcnt lgkmcnt(2)
    v_accvgpr_read_b32 v206, a94
    v_accvgpr_read_b32 v207, a95
    v_mfma_f32_16x16x32_bf16 v[48:51], a[216:219], v[228:231], v[48:51]
    v_add_f32 v208, v92, v188
    v_add_f32 v209, v93, v189
    v_mfma_f32_16x16x32_bf16 v[52:55], a[220:223], v[228:231], v[52:55]
    v_add_f32 v210, v94, v190
    v_add_f32 v211, v95, v191
    v_mfma_f32_16x16x32_bf16 v[52:55], a[208:211], v[236:239], v[52:55]
    v_sub_f32 v188, v92, v188
    v_sub_f32 v189, v93, v189
    v_mfma_f32_16x16x32_bf16 v[52:55], a[196:199], v[232:235], v[52:55]
    v_sub_f32 v190, v94, v190
    v_sub_f32 v191, v95, v191
    v_mfma_f32_16x16x32_bf16 v[56:59], a[200:203], v[232:235], v[56:59]
    ds_read_b128 v[232:235], v253 offset:15872
    v_fma_f32 v92, v208, s31, v204
    v_mfma_f32_16x16x32_bf16 v[56:59], a[212:215], v[236:239], v[56:59]
    v_fma_f32 v93, v209, s31, v205
    v_fma_f32 v94, v210, s31, v206
    v_mfma_f32_16x16x32_bf16 v[56:59], a[224:227], v[228:231], v[56:59]
    buffer_store_dwordx4 v[220:223], v254, s[12:15], s44 offen nt
    v_fma_f32 v95, v211, s31, v207
    v_fmac_f32 v208, s30, v204
    v_mfma_f32_16x16x32_bf16 v[60:63], a[192:195], v[236:239], v[60:63]
    v_fmac_f32 v209, s30, v205
    v_fmac_f32 v210, s30, v206
    v_mfma_f32_16x16x32_bf16 v[60:63], a[204:207], v[228:231], v[60:63]
    s_waitcnt lgkmcnt(0)
    v_fmac_f32 v211, s30, v207
    v_cvt_pk_bf16_f32 v196, v208, v209
    v_mfma_f32_16x16x32_bf16 v[60:63], a[216:219], v[232:235], v[60:63]
    v_cvt_pk_bf16_f32 v197, v210, v211
    v_accvgpr_read_b32 v204, a96
    v_mfma_f32_16x16x32_bf16 v[64:67], a[220:223], v[232:235], v[64:67]
    ds_write_b64 v249, v[196:197] offset:2752
    v_mfma_f32_16x16x32_bf16 v[64:67], a[208:211], v[228:231], v[64:67]
    s_add_u32 s44, s40, 402432
    v_accvgpr_read_b32 v205, a97
    v_accvgpr_read_b32 v206, a98
    v_mfma_f32_16x16x32_bf16 v[64:67], a[196:199], v[236:239], v[64:67]
    ds_write_b128 v248, v[192:195] offset:2688
    v_mfma_f32_16x16x32_bf16 v[68:71], a[200:203], v[236:239], v[68:71]
    ds_read_b128 v[236:239], v253 offset:15616
    v_accvgpr_read_b32 v207, a99
    v_fma_f32 v208, v204, s34, v96 div:2
    v_mfma_f32_16x16x32_bf16 v[68:71], a[212:215], v[228:231], v[68:71]
    v_fma_f32 v209, v205, s34, v97 div:2
    v_fma_f32 v210, v206, s34, v98 div:2
    v_mfma_f32_16x16x32_bf16 v[68:71], a[224:227], v[232:235], v[68:71]
    v_fma_f32 v211, v207, s34, v99 div:2
    v_fma_f32 v96, v204, s35, v96 mul:2
    v_mfma_f32_16x16x32_bf16 v[72:75], a[192:195], v[228:231], v[72:75]
    v_fma_f32 v97, v205, s35, v97 mul:2
    v_fma_f32 v98, v206, s35, v98 mul:2
    v_mfma_f32_16x16x32_bf16 v[72:75], a[204:207], v[232:235], v[72:75]
    s_waitcnt lgkmcnt(0)
    v_fma_f32 v99, v207, s35, v99 mul:2
    v_cvt_pk_bf16_f32 v198, v208, v209
    v_mfma_f32_16x16x32_bf16 v[72:75], a[216:219], v[236:239], v[72:75]
    v_cvt_pk_bf16_f32 v199, v210, v211
    v_accvgpr_write_b32 a0, v198
    v_mfma_f32_16x16x32_bf16 v[76:79], a[220:223], v[236:239], v[76:79]
    v_accvgpr_write_b32 a1, v199
    v_accvgpr_read_b32 v204, a100
    v_mfma_f32_16x16x32_bf16 v[76:79], a[208:211], v[232:235], v[76:79]
    buffer_store_dwordx4 v[224:227], v254, s[12:15], s44 offen nt
    v_accvgpr_read_b32 v205, a101
    v_accvgpr_read_b32 v206, a102
    v_mfma_f32_16x16x32_bf16 v[76:79], a[196:199], v[228:231], v[76:79]
    v_accvgpr_read_b32 v207, a103
    v_fma_f32 v208, v204, s34, v100 div:2
    v_mfma_f32_16x16x32_bf16 v[80:83], a[200:203], v[228:231], v[80:83]
    ds_read_b128 v[228:231], v253 offset:15344
    v_fma_f32 v209, v205, s34, v101 div:2
    v_mfma_f32_16x16x32_bf16 v[80:83], a[212:215], v[232:235], v[80:83]
    v_fma_f32 v210, v206, s34, v102 div:2
    v_fma_f32 v211, v207, s34, v103 div:2
    v_fma_f32 v100, v204, s35, v100 mul:2
    v_mfma_f32_16x16x32_bf16 v[80:83], a[224:227], v[236:239], v[80:83]
    s_mov_b32 s42, 995328
    v_fma_f32 v101, v205, s35, v101 mul:2
    v_fma_f32 v102, v206, s35, v102 mul:2
    v_mfma_f32_16x16x32_bf16 v[84:87], a[192:195], v[232:235], v[84:87]
    s_waitcnt lgkmcnt(0)
    v_fma_f32 v103, v207, s35, v103 mul:2
    v_cvt_pk_bf16_f32 v200, v208, v209
    v_mfma_f32_16x16x32_bf16 v[88:91], a[196:199], v[232:235], v[88:91]
    s_barrier
    v_mfma_f32_16x16x32_bf16 v[92:95], a[200:203], v[232:235], v[92:95]
    ds_read_b128 v[232:235], v253 offset:17680
    v_cvt_pk_bf16_f32 v201, v210, v211
    v_mfma_f32_16x16x32_bf16 v[92:95], a[212:215], v[236:239], v[92:95]
    buffer_load_dwordx4 a[192:195], v254, s[8:11], s42 offen offset:0 sc1
    v_mfma_f32_16x16x32_bf16 v[88:91], a[208:211], v[236:239], v[88:91]
    v_accvgpr_write_b32 a2, v200
    v_accvgpr_write_b32 a3, v201
    v_mfma_f32_16x16x32_bf16 v[84:87], a[204:207], v[236:239], v[84:87]
    ds_read_b128 v[236:239], v253 offset:17408
    v_accvgpr_read_b32 v204, a104
    v_mfma_f32_16x16x32_bf16 v[84:87], a[216:219], v[228:231], v[84:87]
    buffer_load_dwordx4 a[196:199], v254, s[8:11], s42 offen offset:1024 sc1
    v_mfma_f32_16x16x32_bf16 v[88:91], a[220:223], v[228:231], v[88:91]
    s_waitcnt vmcnt(12) lgkmcnt(1)
    v_accvgpr_read_b32 v205, a105
    v_accvgpr_read_b32 v206, a106
    v_mfma_f32_16x16x32_bf16 v[92:95], a[224:227], v[228:231], v[92:95]
    ds_read_b128 v[228:231], v253 offset:17152
    v_accvgpr_read_b32 v207, a107
    v_fma_f32 v208, v204, s34, v104 div:2
sub25:
    v_mfma_f32_16x16x32_bf16 v[0:3], a[228:231], v[232:235], v[0:3]
    buffer_load_dwordx4 a[200:203], v254, s[8:11], s42 offen offset:2048 sc1
    v_mfma_f32_16x16x32_bf16 v[4:7], a[232:235], v[232:235], v[4:7]
    s_mov_b32 s42, 998400
    v_fma_f32 v209, v205, s34, v105 div:2
    v_fma_f32 v210, v206, s34, v106 div:2
    v_mfma_f32_16x16x32_bf16 v[8:11], a[236:239], v[232:235], v[8:11]
    ds_read_b128 v[232:235], v253 offset:16896
    s_waitcnt vmcnt(10)
    s_waitcnt lgkmcnt(2)
    v_mfma_f32_16x16x32_bf16 v[8:11], a[248:251], v[236:239], v[8:11]
    v_fma_f32 v211, v207, s34, v107 div:2
    v_fma_f32 v104, v204, s35, v104 mul:2
    v_mfma_f32_16x16x32_bf16 v[4:7], a[244:247], v[236:239], v[4:7]
    buffer_load_dwordx4 a[204:207], v254, s[8:11], s42 offen offset:0 sc1
    v_mfma_f32_16x16x32_bf16 v[0:3], a[240:243], v[236:239], v[0:3]
    s_waitcnt vmcnt(8) lgkmcnt(1)
    v_fma_f32 v105, v205, s35, v105 mul:2
    v_fma_f32 v106, v206, s35, v106 mul:2
    v_mfma_f32_16x16x32_bf16 v[0:3], a[252:255], v[228:231], v[0:3]
    s_add_u32 s44, s40, 394240
    v_fma_f32 v107, v207, s35, v107 mul:2
    v_cvt_pk_bf16_f32 v202, v208, v209
    v_mfma_f32_16x16x32_bf16 v[4:7], v[240:243], v[228:231], v[4:7]
    v_cvt_pk_bf16_f32 v203, v210, v211
    v_accvgpr_write_b32 a4, v202
    v_mfma_f32_16x16x32_bf16 v[8:11], v[244:247], v[228:231], v[8:11]
    buffer_load_dwordx4 a[208:211], v254, s[8:11], s42 offen offset:1024 sc1
    v_mfma_f32_16x16x32_bf16 v[12:15], a[228:231], v[236:239], v[12:15]
    v_accvgpr_write_b32 a5, v203
    v_accvgpr_read_b32 v204, a108
    v_accvgpr_read_b32 v205, a109
    v_mfma_f32_16x16x32_bf16 v[12:15], a[240:243], v[228:231], v[12:15]
    s_waitcnt lgkmcnt(0)
    v_accvgpr_read_b32 v206, a110
    v_accvgpr_read_b32 v207, a111
    v_mfma_f32_16x16x32_bf16 v[12:15], a[252:255], v[232:235], v[12:15]
    v_fma_f32 v208, v204, s34, v108 div:2
    v_fma_f32 v209, v205, s34, v109 div:2
    v_mfma_f32_16x16x32_bf16 v[16:19], v[240:243], v[232:235], v[16:19]
    buffer_load_dwordx4 a[212:215], v254, s[8:11], s42 offen offset:2048 sc1
    v_mfma_f32_16x16x32_bf16 v[16:19], a[244:247], v[228:231], v[16:19]
    s_mov_b32 s42, 1001472
    v_fma_f32 v210, v206, s34, v110 div:2
    v_fma_f32 v211, v207, s34, v111 div:2
    v_mfma_f32_16x16x32_bf16 v[16:19], a[232:235], v[236:239], v[16:19]
    v_fma_f32 v108, v204, s35, v108 mul:2
    v_fma_f32 v109, v205, s35, v109 mul:2
    v_mfma_f32_16x16x32_bf16 v[20:23], a[236:239], v[236:239], v[20:23]
    ds_read_b128 v[236:239], v253 offset:16640
    v_fma_f32 v110, v206, s35, v110 mul:2
    v_mfma_f32_16x16x32_bf16 v[20:23], a[248:251], v[228:231], v[20:23]
    buffer_load_dwordx4 a[216:219], v254, s[8:11], s42 offen offset:0 sc1
    v_mfma_f32_16x16x32_bf16 v[20:23], v[244:247], v[232:235], v[20:23]
    v_fma_f32 v111, v207, s35, v111 mul:2
    v_cvt_pk_bf16_f32 v192, v208, v209
    v_mfma_f32_16x16x32_bf16 v[24:27], a[228:231], v[228:231], v[24:27]
    v_cvt_pk_bf16_f32 v193, v210, v211
    v_accvgpr_write_b32 a12, v192
    v_mfma_f32_16x16x32_bf16 v[24:27], a[240:243], v[232:235], v[24:27]
    s_waitcnt lgkmcnt(0)
    v_accvgpr_write_b32 a13, v193
    v_accvgpr_read_b32 v204, a112
    v_accvgpr_read_b32 v205, a113
    v_mfma_f32_16x16x32_bf16 v[24:27], a[252:255], v[236:239], v[24:27]
    ds_read_b128 a[84:87], v250 offset:7232
    v_accvgpr_read_b32 v206, a114
    v_mfma_f32_16x16x32_bf16 v[28:31], v[240:243], v[236:239], v[28:31]
    buffer_load_dwordx4 a[220:223], v254, s[8:11], s42 offen offset:1024 sc1
    v_mfma_f32_16x16x32_bf16 v[28:31], a[244:247], v[232:235], v[28:31]
    v_accvgpr_read_b32 v207, a115
    v_fma_f32 v208, v204, s34, v112 div:2
    v_mfma_f32_16x16x32_bf16 v[28:31], a[232:235], v[228:231], v[28:31]
    v_fma_f32 v209, v205, s34, v113 div:2
    v_fma_f32 v210, v206, s34, v114 div:2
    v_mfma_f32_16x16x32_bf16 v[32:35], a[236:239], v[228:231], v[32:35]
    ds_read_b128 v[228:231], v253 offset:18464
    v_fma_f32 v211, v207, s34, v115 div:2
    v_mfma_f32_16x16x32_bf16 v[32:35], a[248:251], v[232:235], v[32:35]
    buffer_load_dwordx4 a[224:227], v254, s[8:11], s42 offen offset:2048 sc1
    v_mfma_f32_16x16x32_bf16 v[32:35], v[244:247], v[236:239], v[32:35]
    ds_read_b128 a[88:91], v250 offset:10336
    v_fma_f32 v112, v204, s35, v112 mul:2
    v_mfma_f32_16x16x32_bf16 v[36:39], a[228:231], v[232:235], v[36:39]
    v_fma_f32 v113, v205, s35, v113 mul:2
    v_fma_f32 v114, v206, s35, v114 mul:2
    v_mfma_f32_16x16x32_bf16 v[36:39], a[240:243], v[236:239], v[36:39]
    s_waitcnt lgkmcnt(1)
    v_fma_f32 v115, v207, s35, v115 mul:2
    v_cvt_pk_bf16_f32 v194, v208, v209
    v_mfma_f32_16x16x32_bf16 v[36:39], a[252:255], v[228:231], v[36:39]
    buffer_store_dwordx4 v[212:215], v254, s[12:15], s44 offen nt
    s_add_u32 s44, s40, 397312
    v_cvt_pk_bf16_f32 v195, v210, v211
    v_mfma_f32_16x16x32_bf16 v[40:43], v[240:243], v[228:231], v[40:43]
    v_accvgpr_write_b32 a14, v194
    v_accvgpr_write_b32 a15, v195
    v_mfma_f32_16x16x32_bf16 v[40:43], a[244:247], v[236:239], v[40:43]
    v_accvgpr_read_b32 v204, a116
    v_accvgpr_read_b32 v205, a117
    v_mfma_f32_16x16x32_bf16 v[40:43], a[232:235], v[232:235], v[40:43]
    buffer_store_dwordx4 v[216:219], v254, s[12:15], s44 offen nt
    v_accvgpr_read_b32 v206, a118
    v_accvgpr_read_b32 v207, a119
    v_mfma_f32_16x16x32_bf16 v[44:47], a[236:239], v[232:235], v[44:47]
    ds_read_b128 v[232:235], v253 offset:18208
    v_fma_f32 v208, v204, s34, v116 div:2
    v_mfma_f32_16x16x32_bf16 v[44:47], a[248:251], v[236:239], v[44:47]
    ds_read_b128 a[92:95], v250 offset:2048
    v_fma_f32 v209, v205, s34, v117 div:2
    v_mfma_f32_16x16x32_bf16 v[44:47], v[244:247], v[228:231], v[44:47]
    v_fma_f32 v210, v206, s34, v118 div:2
    v_fma_f32 v211, v207, s34, v119 div:2
    v_mfma_f32_16x16x32_bf16 v[48:51], a[228:231], v[236:239], v[48:51]
    v_fma_f32 v116, v204, s35, v116 mul:2
    v_fma_f32 v117, v205, s35, v117 mul:2
    v_mfma_f32_16x16x32_bf16 v[48:51], a[240:243], v[228:231], v[48:51]
    s_waitcnt lgkmcnt(1)
    s_add_u32 s44, s40, 400384
    v_fma_f32 v118, v206, s35, v118 mul:2
    v_mfma_f32_16x16x32_bf16 v[48:51], a[252:255], v[232:235], v[48:51]
    v_fma_f32 v119, v207, s35, v119 mul:2
    v_cvt_pk_bf16_f32 v196, v208, v209
    v_mfma_f32_16x16x32_bf16 v[52:55], v[240:243], v[232:235], v[52:55]
    ds_read_b128 a[96:99], v250 offset:5152
    v_cvt_pk_bf16_f32 v197, v210, v211
    v_accvgpr_write_b32 a16, v196
    v_mfma_f32_16x16x32_bf16 v[52:55], a[244:247], v[228:231], v[52:55]
    v_accvgpr_write_b32 a17, v197
    v_accvgpr_read_b32 v204, a120
    v_mfma_f32_16x16x32_bf16 v[52:55], a[232:235], v[236:239], v[52:55]
    v_accvgpr_read_b32 v205, a121
    v_accvgpr_read_b32 v206, a122
    v_mfma_f32_16x16x32_bf16 v[56:59], a[236:239], v[236:239], v[56:59]
    ds_read_b128 v[236:239], v253 offset:17952
    v_mfma_f32_16x16x32_bf16 v[56:59], a[248:251], v[228:231], v[56:59]
    v_accvgpr_read_b32 v207, a123
    v_fma_f32 v208, v204, s34, v120 div:2
    v_mfma_f32_16x16x32_bf16 v[56:59], v[244:247], v[232:235], v[56:59]
    v_fma_f32 v209, v205, s34, v121 div:2
    v_fma_f32 v210, v206, s34, v122 div:2
    v_mfma_f32_16x16x32_bf16 v[60:63], a[228:231], v[228:231], v[60:63]
    v_fma_f32 v211, v207, s34, v123 div:2
    v_fma_f32 v120, v204, s35, v120 mul:2
    v_mfma_f32_16x16x32_bf16 v[60:63], a[240:243], v[232:235], v[60:63]
    s_waitcnt lgkmcnt(0)
    v_fma_f32 v121, v205, s35, v121 mul:2
    v_fma_f32 v122, v206, s35, v122 mul:2
    v_mfma_f32_16x16x32_bf16 v[60:63], a[252:255], v[236:239], v[60:63]
    ds_read_b128 a[100:103], v250 offset:8256
    v_fma_f32 v123, v207, s35, v123 mul:2
    v_mfma_f32_16x16x32_bf16 v[64:67], v[240:243], v[236:239], v[64:67]
    buffer_store_dwordx4 a[84:87], v254, s[12:15], s44 offen nt
    v_cvt_pk_bf16_f32 v198, v208, v209
    v_cvt_pk_bf16_f32 v199, v210, v211
    v_mfma_f32_16x16x32_bf16 v[64:67], a[244:247], v[232:235], v[64:67]
    v_accvgpr_read_b32 v204, a28
    v_accvgpr_read_b32 v205, a29
    v_accvgpr_read_b32 v206, a30
    v_mfma_f32_16x16x32_bf16 v[64:67], a[232:235], v[228:231], v[64:67]
    v_accvgpr_read_b32 v207, a31
    v_accvgpr_read_b32 v208, a124
    v_mfma_f32_16x16x32_bf16 v[68:71], a[236:239], v[228:231], v[68:71]
    ds_read_b128 v[228:231], v253 offset:17696
    v_accvgpr_read_b32 v209, a125
    v_mfma_f32_16x16x32_bf16 v[68:71], a[248:251], v[232:235], v[68:71]
    ds_read_b128 a[104:107], v250 offset:11360
    s_add_u32 s44, s40, 403456
    v_mfma_f32_16x16x32_bf16 v[68:71], v[244:247], v[236:239], v[68:71]
    v_accvgpr_read_b32 v210, a126
    v_accvgpr_read_b32 v211, a127
    v_mfma_f32_16x16x32_bf16 v[72:75], a[228:231], v[232:235], v[72:75]
    v_sub_f32 v204, v204, v208
    v_sub_f32 v205, v205, v209
    v_mfma_f32_16x16x32_bf16 v[72:75], a[240:243], v[236:239], v[72:75]
    s_waitcnt lgkmcnt(1)
    v_sub_f32 v206, v206, v210
    v_sub_f32 v207, v207, v211
    v_mfma_f32_16x16x32_bf16 v[72:75], a[252:255], v[228:231], v[72:75]
    v_fma_f32 v208, v204, s34, v124 div:2
    v_fma_f32 v209, v205, s34, v125 div:2
    v_mfma_f32_16x16x32_bf16 v[76:79], v[240:243], v[228:231], v[76:79]
    v_fma_f32 v210, v206, s34, v126 div:2
    v_fma_f32 v211, v207, s34, v127 div:2
    v_mfma_f32_16x16x32_bf16 v[76:79], a[244:247], v[236:239], v[76:79]
    v_fma_f32 v124, v204, s35, v124 mul:2
    v_fma_f32 v125, v205, s35, v125 mul:2
    v_mfma_f32_16x16x32_bf16 v[76:79], a[232:235], v[232:235], v[76:79]
    v_fma_f32 v126, v206, s35, v126 mul:2
    v_fma_f32 v127, v207, s35, v127 mul:2
    v_cvt_pk_bf16_f32 v200, v208, v209
    v_mfma_f32_16x16x32_bf16 v[80:83], a[236:239], v[232:235], v[80:83]
    ds_read_b128 v[232:235], v253 offset:17424
    v_cvt_pk_bf16_f32 v201, v210, v211
    v_mfma_f32_16x16x32_bf16 v[80:83], a[248:251], v[236:239], v[80:83]
    v_accvgpr_read_b32 v204, a32
    v_accvgpr_read_b32 v205, a33
    v_mfma_f32_16x16x32_bf16 v[80:83], v[244:247], v[228:231], v[80:83]
    s_mov_b32 s42, 1032192
    v_accvgpr_read_b32 v206, a34
    v_accvgpr_read_b32 v207, a35
    v_mfma_f32_16x16x32_bf16 v[84:87], a[228:231], v[236:239], v[84:87]
    s_waitcnt lgkmcnt(0)
    v_accvgpr_read_b32 v208, a128
    v_accvgpr_read_b32 v209, a129
    v_mfma_f32_16x16x32_bf16 v[88:91], a[232:235], v[236:239], v[88:91]
    s_barrier
    v_mfma_f32_16x16x32_bf16 v[92:95], a[236:239], v[236:239], v[92:95]
    ds_read_b128 v[236:239], v253 offset:19760
    v_accvgpr_read_b32 v210, a130
    v_mfma_f32_16x16x32_bf16 v[92:95], a[248:251], v[228:231], v[92:95]
    buffer_load_dwordx4 a[228:231], v254, s[8:11], s42 offen offset:0 sc1
    v_mfma_f32_16x16x32_bf16 v[88:91], a[244:247], v[228:231], v[88:91]
    v_accvgpr_read_b32 v211, a131
    v_sub_f32 v204, v204, v208
    v_mfma_f32_16x16x32_bf16 v[84:87], a[240:243], v[228:231], v[84:87]
    ds_read_b128 v[228:231], v253 offset:19488
    v_sub_f32 v205, v205, v209
    v_mfma_f32_16x16x32_bf16 v[84:87], a[252:255], v[232:235], v[84:87]
    buffer_load_dwordx4 a[232:235], v254, s[8:11], s42 offen offset:1024 sc1
    v_sub_f32 v206, v206, v210
    v_mfma_f32_16x16x32_bf16 v[88:91], v[240:243], v[232:235], v[88:91]
    s_waitcnt vmcnt(11) lgkmcnt(1)
    v_sub_f32 v207, v207, v211
    v_fma_f32 v208, v204, s34, v128 div:2
    v_mfma_f32_16x16x32_bf16 v[92:95], v[244:247], v[232:235], v[92:95]
    ds_read_b128 v[232:235], v253 offset:19232
    v_fma_f32 v209, v205, s34, v129 div:2
sub26:
    v_mfma_f32_16x16x32_bf16 v[0:3], a[192:195], v[236:239], v[0:3]
    buffer_load_dwordx4 a[236:239], v254, s[8:11], s42 offen offset:2048 sc1
    v_mfma_f32_16x16x32_bf16 v[4:7], a[196:199], v[236:239], v[4:7]
    s_mov_b32 s42, 1035264
    v_fma_f32 v210, v206, s34, v130 div:2
    v_fma_f32 v211, v207, s34, v131 div:2
    v_mfma_f32_16x16x32_bf16 v[8:11], a[200:203], v[236:239], v[8:11]
    ds_read_b128 v[236:239], v253 offset:18976
    s_waitcnt vmcnt(9)
    s_waitcnt lgkmcnt(2)
    v_mfma_f32_16x16x32_bf16 v[8:11], a[212:215], v[228:231], v[8:11]
    ds_write_b128 v248, a[0:3] offset:0
    v_mfma_f32_16x16x32_bf16 v[4:7], a[208:211], v[228:231], v[4:7]
    buffer_load_dwordx4 a[240:243], v254, s[8:11], s42 offen offset:0 sc1
    v_mfma_f32_16x16x32_bf16 v[0:3], a[204:207], v[228:231], v[0:3]
    s_waitcnt vmcnt(7) lgkmcnt(2)
    v_fma_f32 v128, v204, s35, v128 mul:2
    v_fma_f32 v129, v205, s35, v129 mul:2
    v_mfma_f32_16x16x32_bf16 v[0:3], a[216:219], v[232:235], v[0:3]
    v_fma_f32 v130, v206, s35, v130 mul:2
    v_fma_f32 v131, v207, s35, v131 mul:2
    v_mfma_f32_16x16x32_bf16 v[4:7], a[220:223], v[232:235], v[4:7]
    ds_write_b64 v249, a[4:5] offset:64
    v_cvt_pk_bf16_f32 v202, v208, v209
    v_mfma_f32_16x16x32_bf16 v[8:11], a[224:227], v[232:235], v[8:11]
    buffer_load_dwordx4 a[244:247], v254, s[8:11], s42 offen offset:1024 sc1
    v_mfma_f32_16x16x32_bf16 v[12:15], a[192:195], v[228:231], v[12:15]
    ds_write_b128 v248, v[198:201] offset:768
    v_mfma_f32_16x16x32_bf16 v[12:15], a[204:207], v[232:235], v[12:15]
    s_waitcnt lgkmcnt(3)
    v_cvt_pk_bf16_f32 v203, v210, v211
    v_accvgpr_read_b32 v204, a36
    v_mfma_f32_16x16x32_bf16 v[12:15], a[216:219], v[236:239], v[12:15]
    v_accvgpr_read_b32 v205, a37
    v_accvgpr_read_b32 v206, a38
    v_mfma_f32_16x16x32_bf16 v[16:19], a[220:223], v[236:239], v[16:19]
    buffer_load_dwordx4 a[248:251], v254, s[8:11], s42 offen offset:2048 sc1
    v_mfma_f32_16x16x32_bf16 v[16:19], a[208:211], v[232:235], v[16:19]
    s_mov_b32 s42, 1038336
    v_accvgpr_read_b32 v207, a39
    v_accvgpr_read_b32 v208, a132
    v_mfma_f32_16x16x32_bf16 v[16:19], a[196:199], v[228:231], v[16:19]
    ds_write_b128 v248, a[12:15] offset:384
    v_mfma_f32_16x16x32_bf16 v[20:23], a[200:203], v[228:231], v[20:23]
    ds_read_b128 v[228:231], v253 offset:18720
    v_accvgpr_read_b32 v209, a133
    v_mfma_f32_16x16x32_bf16 v[20:23], a[212:215], v[232:235], v[20:23]
    buffer_load_dwordx4 a[252:255], v254, s[8:11], s42 offen offset:0 sc1
    v_mfma_f32_16x16x32_bf16 v[20:23], a[224:227], v[236:239], v[20:23]
    v_accvgpr_read_b32 v210, a134
    v_accvgpr_read_b32 v211, a135
    v_sub_f32 v204, v204, v208
    v_mfma_f32_16x16x32_bf16 v[24:27], a[192:195], v[232:235], v[24:27]
    ds_write_b64 v249, v[202:203] offset:832
    v_mfma_f32_16x16x32_bf16 v[24:27], a[204:207], v[236:239], v[24:27]
    s_waitcnt lgkmcnt(1)
    v_sub_f32 v205, v205, v209
    v_sub_f32 v206, v206, v210
    v_mfma_f32_16x16x32_bf16 v[24:27], a[216:219], v[228:231], v[24:27]
    v_sub_f32 v207, v207, v211
    v_fma_f32 v208, v204, s34, v132 div:2
    v_mfma_f32_16x16x32_bf16 v[28:31], a[220:223], v[228:231], v[28:31]
    buffer_load_dwordx4 v[240:243], v254, s[8:11], s42 offen offset:1024 sc1
    v_mfma_f32_16x16x32_bf16 v[28:31], a[208:211], v[236:239], v[28:31]
    ds_write_b64 v249, a[16:17] offset:448
    v_mfma_f32_16x16x32_bf16 v[28:31], a[196:199], v[232:235], v[28:31]
    v_fma_f32 v209, v205, s34, v133 div:2
    v_fma_f32 v210, v206, s34, v134 div:2
    v_mfma_f32_16x16x32_bf16 v[32:35], a[200:203], v[232:235], v[32:35]
    ds_read_b128 v[232:235], v253 offset:20544
    v_fma_f32 v211, v207, s34, v135 div:2
    v_mfma_f32_16x16x32_bf16 v[32:35], a[212:215], v[236:239], v[32:35]
    buffer_load_dwordx4 v[244:247], v254, s[8:11], s42 offen offset:2048 sc1
    v_mfma_f32_16x16x32_bf16 v[32:35], a[224:227], v[228:231], v[32:35]
    v_fma_f32 v132, v204, s35, v132 mul:2
    v_fma_f32 v133, v205, s35, v133 mul:2
    v_mfma_f32_16x16x32_bf16 v[36:39], a[192:195], v[236:239], v[36:39]
    v_fma_f32 v134, v206, s35, v134 mul:2
    v_fma_f32 v135, v207, s35, v135 mul:2
    v_cvt_pk_bf16_f32 v192, v208, v209
    v_mfma_f32_16x16x32_bf16 v[36:39], a[204:207], v[228:231], v[36:39]
    s_waitcnt lgkmcnt(0)
    v_cvt_pk_bf16_f32 v193, v210, v211
    v_accvgpr_read_b32 v204, a40
    v_mfma_f32_16x16x32_bf16 v[36:39], a[216:219], v[232:235], v[36:39]
    buffer_store_dwordx4 a[88:91], v254, s[12:15], s44 offen nt
    s_add_u32 s44, s40, 395264
    v_mfma_f32_16x16x32_bf16 v[40:43], a[220:223], v[232:235], v[40:43]
    v_accvgpr_read_b32 v205, a41
    v_accvgpr_read_b32 v206, a42
    v_mfma_f32_16x16x32_bf16 v[40:43], a[208:211], v[228:231], v[40:43]
    v_accvgpr_read_b32 v207, a43
    v_accvgpr_read_b32 v208, a136
    v_mfma_f32_16x16x32_bf16 v[40:43], a[196:199], v[236:239], v[40:43]
    buffer_store_dwordx4 a[92:95], v254, s[12:15], s44 offen nt
    s_add_u32 s44, s40, 398336
    v_mfma_f32_16x16x32_bf16 v[44:47], a[200:203], v[236:239], v[44:47]
    ds_read_b128 v[236:239], v253 offset:20288
    v_accvgpr_read_b32 v209, a137
    v_mfma_f32_16x16x32_bf16 v[44:47], a[212:215], v[228:231], v[44:47]
    v_accvgpr_read_b32 v210, a138
    v_accvgpr_read_b32 v211, a139
    v_mfma_f32_16x16x32_bf16 v[44:47], a[224:227], v[232:235], v[44:47]
    buffer_store_dwordx4 a[96:99], v254, s[12:15], s44 offen nt
    s_add_u32 s44, s40, 401408
    v_mfma_f32_16x16x32_bf16 v[48:51], a[192:195], v[228:231], v[48:51]
    v_sub_f32 v204, v204, v208
    v_sub_f32 v205, v205, v209
    v_mfma_f32_16x16x32_bf16 v[48:51], a[204:207], v[232:235], v[48:51]
    s_waitcnt lgkmcnt(0)
    v_sub_f32 v206, v206, v210
    v_sub_f32 v207, v207, v211
    v_fma_f32 v208, v204, s34, v136 div:2
    v_mfma_f32_16x16x32_bf16 v[48:51], a[216:219], v[236:239], v[48:51]
    buffer_store_dwordx4 a[100:103], v254, s[12:15], s44 offen nt
    v_fma_f32 v209, v205, s34, v137 div:2
    v_fma_f32 v210, v206, s34, v138 div:2
    v_mfma_f32_16x16x32_bf16 v[52:55], a[220:223], v[236:239], v[52:55]
    v_fma_f32 v211, v207, s34, v139 div:2
    v_fma_f32 v136, v204, s35, v136 mul:2
    v_mfma_f32_16x16x32_bf16 v[52:55], a[208:211], v[232:235], v[52:55]
    v_fma_f32 v137, v205, s35, v137 mul:2
    v_fma_f32 v138, v206, s35, v138 mul:2
    v_mfma_f32_16x16x32_bf16 v[52:55], a[196:199], v[228:231], v[52:55]
    v_fma_f32 v139, v207, s35, v139 mul:2
    v_cvt_pk_bf16_f32 v194, v208, v209
    v_mfma_f32_16x16x32_bf16 v[56:59], a[200:203], v[228:231], v[56:59]
    ds_read_b128 v[228:231], v253 offset:20032
    s_add_u32 s44, s40, 404480
    v_mfma_f32_16x16x32_bf16 v[56:59], a[212:215], v[232:235], v[56:59]
pad10:
    s_cbranch_vccnz warm_ret
    v_cvt_pk_bf16_f32 v195, v210, v211
    v_accvgpr_read_b32 v204, a44
    v_mfma_f32_16x16x32_bf16 v[56:59], a[224:227], v[236:239], v[56:59]
    ds_write_b128 v248, v[192:195] offset:1152
    v_mfma_f32_16x16x32_bf16 v[60:63], a[192:195], v[232:235], v[60:63]
    v_accvgpr_read_b32 v205, a45
    v_accvgpr_read_b32 v206, a46
    v_mfma_f32_16x16x32_bf16 v[60:63], a[204:207], v[236:239], v[60:63]
    s_waitcnt lgkmcnt(1)
    v_accvgpr_read_b32 v207, a47
    v_accvgpr_read_b32 v208, a140
    v_mfma_f32_16x16x32_bf16 v[60:63], a[216:219], v[228:231], v[60:63]
    v_accvgpr_read_b32 v209, a141
    v_accvgpr_read_b32 v210, a142
    v_accvgpr_read_b32 v211, a143
    v_mfma_f32_16x16x32_bf16 v[64:67], a[220:223], v[228:231], v[64:67]
    v_sub_f32 v204, v204, v208
    v_sub_f32 v205, v205, v209
    v_mfma_f32_16x16x32_bf16 v[64:67], a[208:211], v[236:239], v[64:67]
    v_sub_f32 v206, v206, v210
    v_sub_f32 v207, v207, v211
    v_mfma_f32_16x16x32_bf16 v[64:67], a[196:199], v[232:235], v[64:67]
    v_fma_f32 v208, v204, s34, v140 div:2
    v_fma_f32 v209, v205, s34, v141 div:2
    v_mfma_f32_16x16x32_bf16 v[68:71], a[200:203], v[232:235], v[68:71]
    ds_read_b128 v[232:235], v253 offset:19776
    v_fma_f32 v210, v206, s34, v142 div:2
    v_mfma_f32_16x16x32_bf16 v[68:71], a[212:215], v[236:239], v[68:71]
    v_fma_f32 v211, v207, s34, v143 div:2
    v_fma_f32 v140, v204, s35, v140 mul:2
    v_mfma_f32_16x16x32_bf16 v[68:71], a[224:227], v[228:231], v[68:71]
    buffer_store_dwordx4 a[104:107], v254, s[12:15], s44 offen nt
    v_fma_f32 v141, v205, s35, v141 mul:2
    v_fma_f32 v142, v206, s35, v142 mul:2
    v_mfma_f32_16x16x32_bf16 v[72:75], a[192:195], v[236:239], v[72:75]
    v_fma_f32 v143, v207, s35, v143 mul:2
    v_cvt_pk_bf16_f32 v196, v208, v209
    v_mfma_f32_16x16x32_bf16 v[72:75], a[204:207], v[228:231], v[72:75]
    s_waitcnt lgkmcnt(0)
    v_cvt_pk_bf16_f32 v197, v210, v211
    v_accvgpr_read_b32 v204, a48
    v_mfma_f32_16x16x32_bf16 v[72:75], a[216:219], v[232:235], v[72:75]
    ds_write_b64 v249, v[196:197] offset:1216
    v_mfma_f32_16x16x32_bf16 v[76:79], a[220:223], v[232:235], v[76:79]
    v_accvgpr_read_b32 v205, a49
    v_accvgpr_read_b32 v206, a50
    v_accvgpr_read_b32 v207, a51
    v_mfma_f32_16x16x32_bf16 v[76:79], a[208:211], v[228:231], v[76:79]
    v_accvgpr_read_b32 v208, a144
    v_accvgpr_read_b32 v209, a145
    v_mfma_f32_16x16x32_bf16 v[76:79], a[196:199], v[236:239], v[76:79]
    v_accvgpr_read_b32 v210, a146
    v_accvgpr_read_b32 v211, a147
    v_mfma_f32_16x16x32_bf16 v[80:83], a[200:203], v[236:239], v[80:83]
    ds_read_b128 v[236:239], v253 offset:19504
    v_sub_f32 v204, v204, v208
    v_mfma_f32_16x16x32_bf16 v[80:83], a[212:215], v[228:231], v[80:83]
    v_sub_f32 v205, v205, v209
    v_sub_f32 v206, v206, v210
    v_mfma_f32_16x16x32_bf16 v[80:83], a[224:227], v[232:235], v[80:83]
    s_mov_b32 s42, 1069056
    v_sub_f32 v207, v207, v211
    v_fma_f32 v208, v204, s34, v144 div:2
    v_mfma_f32_16x16x32_bf16 v[84:87], a[192:195], v[228:231], v[84:87]
    s_waitcnt lgkmcnt(0)
    v_fma_f32 v209, v205, s34, v145 div:2
    v_fma_f32 v210, v206, s34, v146 div:2
    v_mfma_f32_16x16x32_bf16 v[88:91], a[196:199], v[228:231], v[88:91]
    s_barrier
    v_mfma_f32_16x16x32_bf16 v[92:95], a[200:203], v[228:231], v[92:95]
    ds_read_b128 v[228:231], v253 offset:21840
    v_fma_f32 v211, v207, s34, v147 div:2
    v_mfma_f32_16x16x32_bf16 v[92:95], a[212:215], v[232:235], v[92:95]
    buffer_load_dwordx4 a[192:195], v254, s[8:11], s42 offen offset:0 sc1
    v_mfma_f32_16x16x32_bf16 v[88:91], a[208:211], v[232:235], v[88:91]
    v_fma_f32 v144, v204, s35, v144 mul:2
    v_fma_f32 v145, v205, s35, v145 mul:2
    v_fma_f32 v146, v206, s35, v146 mul:2
    v_mfma_f32_16x16x32_bf16 v[84:87], a[204:207], v[232:235], v[84:87]
    ds_read_b128 v[232:235], v253 offset:21568
    v_fma_f32 v147, v207, s35, v147 mul:2
    v_mfma_f32_16x16x32_bf16 v[84:87], a[216:219], v[236:239], v[84:87]
    buffer_load_dwordx4 a[196:199], v254, s[8:11], s42 offen offset:1024 sc1
    v_mfma_f32_16x16x32_bf16 v[88:91], a[220:223], v[236:239], v[88:91]
    s_waitcnt vmcnt(13) lgkmcnt(1)
    v_cvt_pk_bf16_f32 v198, v208, v209
    v_cvt_pk_bf16_f32 v199, v210, v211
    v_mfma_f32_16x16x32_bf16 v[92:95], a[224:227], v[236:239], v[92:95]
    ds_read_b128 v[236:239], v253 offset:21312
    v_accvgpr_read_b32 v204, a52
sub27:
    v_mfma_f32_16x16x32_bf16 v[0:3], a[228:231], v[228:231], v[0:3]
    buffer_load_dwordx4 a[200:203], v254, s[8:11], s42 offen offset:2048 sc1
    v_mfma_f32_16x16x32_bf16 v[4:7], a[232:235], v[228:231], v[4:7]
    s_mov_b32 s42, 1072128
    s_add_u32 s44, s40, 196608
    v_accvgpr_read_b32 v205, a53
    v_mfma_f32_16x16x32_bf16 v[8:11], a[236:239], v[228:231], v[8:11]
    ds_read_b128 v[228:231], v253 offset:21056
    s_waitcnt vmcnt(11)
    s_waitcnt lgkmcnt(2)
    v_mfma_f32_16x16x32_bf16 v[8:11], a[248:251], v[232:235], v[8:11]
    ds_read_b128 a[108:111], v250 offset:0
    v_accvgpr_read_b32 v206, a54
    v_mfma_f32_16x16x32_bf16 v[4:7], a[244:247], v[232:235], v[4:7]
    buffer_load_dwordx4 a[204:207], v254, s[8:11], s42 offen offset:0 sc1
    v_mfma_f32_16x16x32_bf16 v[0:3], a[240:243], v[232:235], v[0:3]
    s_waitcnt vmcnt(9) lgkmcnt(2)
    v_accvgpr_read_b32 v207, a55
    v_accvgpr_read_b32 v208, a148
    v_accvgpr_read_b32 v209, a149
    v_mfma_f32_16x16x32_bf16 v[0:3], a[252:255], v[236:239], v[0:3]
    ds_read_b128 a[112:115], v250 offset:3104
    v_accvgpr_read_b32 v210, a150
    v_mfma_f32_16x16x32_bf16 v[4:7], v[240:243], v[236:239], v[4:7]
    v_accvgpr_read_b32 v211, a151
    v_sub_f32 v204, v204, v208
    v_mfma_f32_16x16x32_bf16 v[8:11], v[244:247], v[236:239], v[8:11]
    buffer_load_dwordx4 a[208:211], v254, s[8:11], s42 offen offset:1024 sc1
    v_mfma_f32_16x16x32_bf16 v[12:15], a[228:231], v[232:235], v[12:15]
    s_waitcnt lgkmcnt(1)
    v_sub_f32 v205, v205, v209
    v_sub_f32 v206, v206, v210
    v_mfma_f32_16x16x32_bf16 v[12:15], a[240:243], v[236:239], v[12:15]
    v_sub_f32 v207, v207, v211
    v_fma_f32 v208, v204, s34, v148 div:2
    v_mfma_f32_16x16x32_bf16 v[12:15], a[252:255], v[228:231], v[12:15]
    v_fma_f32 v209, v205, s34, v149 div:2
    v_fma_f32 v210, v206, s34, v150 div:2
    v_mfma_f32_16x16x32_bf16 v[16:19], v[240:243], v[228:231], v[16:19]
    buffer_load_dwordx4 a[212:215], v254, s[8:11], s42 offen offset:2048 sc1
    v_mfma_f32_16x16x32_bf16 v[16:19], a[244:247], v[236:239], v[16:19]
    s_mov_b32 s42, 1075200
    v_fma_f32 v211, v207, s34, v151 div:2
    v_fma_f32 v148, v204, s35, v148 mul:2
    v_mfma_f32_16x16x32_bf16 v[16:19], a[232:235], v[232:235], v[16:19]
    ds_read_b128 a[116:119], v250 offset:6208
    v_fma_f32 v149, v205, s35, v149 mul:2
    v_mfma_f32_16x16x32_bf16 v[20:23], a[236:239], v[232:235], v[20:23]
    ds_read_b128 v[232:235], v253 offset:20800
    v_fma_f32 v150, v206, s35, v150 mul:2
    v_fma_f32 v151, v207, s35, v151 mul:2
    v_mfma_f32_16x16x32_bf16 v[20:23], a[248:251], v[236:239], v[20:23]
    buffer_load_dwordx4 a[216:219], v254, s[8:11], s42 offen offset:0 sc1
    v_mfma_f32_16x16x32_bf16 v[20:23], v[244:247], v[228:231], v[20:23]
    v_cvt_pk_bf16_f32 v200, v208, v209
    v_cvt_pk_bf16_f32 v201, v210, v211
    v_mfma_f32_16x16x32_bf16 v[24:27], a[228:231], v[236:239], v[24:27]
    ds_write_b128 v248, v[198:201] offset:1536
    v_mfma_f32_16x16x32_bf16 v[24:27], a[240:243], v[228:231], v[24:27]
    s_waitcnt lgkmcnt(1)
    v_accvgpr_read_b32 v204, a56
    v_accvgpr_read_b32 v205, a57
    v_mfma_f32_16x16x32_bf16 v[24:27], a[252:255], v[232:235], v[24:27]
    v_accvgpr_read_b32 v206, a58
    v_accvgpr_read_b32 v207, a59
    v_mfma_f32_16x16x32_bf16 v[28:31], v[240:243], v[232:235], v[28:31]
    buffer_load_dwordx4 a[220:223], v254, s[8:11], s42 offen offset:1024 sc1
    v_mfma_f32_16x16x32_bf16 v[28:31], a[244:247], v[228:231], v[28:31]
    ds_read_b128 a[120:123], v250 offset:9312
    v_accvgpr_read_b32 v208, a152
    v_mfma_f32_16x16x32_bf16 v[28:31], a[232:235], v[236:239], v[28:31]
    v_accvgpr_read_b32 v209, a153
    v_accvgpr_read_b32 v210, a154
    v_mfma_f32_16x16x32_bf16 v[32:35], a[236:239], v[236:239], v[32:35]
    ds_read_b128 v[236:239], v253 offset:22624
    v_accvgpr_read_b32 v211, a155
    v_mfma_f32_16x16x32_bf16 v[32:35], a[248:251], v[228:231], v[32:35]
    buffer_load_dwordx4 a[224:227], v254, s[8:11], s42 offen offset:2048 sc1
    v_sub_f32 v204, v204, v208
    v_mfma_f32_16x16x32_bf16 v[32:35], v[244:247], v[232:235], v[32:35]
    v_sub_f32 v205, v205, v209
    v_sub_f32 v206, v206, v210
    v_mfma_f32_16x16x32_bf16 v[36:39], a[228:231], v[228:231], v[36:39]
    v_sub_f32 v207, v207, v211
    v_fma_f32 v208, v204, s34, v152 div:2
    v_mfma_f32_16x16x32_bf16 v[36:39], a[240:243], v[232:235], v[36:39]
    s_waitcnt lgkmcnt(0)
    v_fma_f32 v209, v205, s34, v153 div:2
    v_fma_f32 v210, v206, s34, v154 div:2
    v_mfma_f32_16x16x32_bf16 v[36:39], a[252:255], v[236:239], v[36:39]
    buffer_store_dwordx4 a[108:111], v254, s[12:15], s44 offen nt
    s_add_u32 s44, s40, 199680
    v_fma_f32 v211, v207, s34, v155 div:2
    v_mfma_f32_16x16x32_bf16 v[40:43], v[240:243], v[236:239], v[40:43]
    v_fma_f32 v152, v204, s35, v152 mul:2
    v_fma_f32 v153, v205, s35, v153 mul:2
    v_mfma_f32_16x16x32_bf16 v[40:43], a[244:247], v[232:235], v[40:43]
    v_fma_f32 v154, v206, s35, v154 mul:2
    v_fma_f32 v155, v207, s35, v155 mul:2
    v_mfma_f32_16x16x32_bf16 v[40:43], a[232:235], v[228:231], v[40:43]
    v_cvt_pk_bf16_f32 v202, v208, v209
    v_cvt_pk_bf16_f32 v203, v210, v211
    v_mfma_f32_16x16x32_bf16 v[44:47], a[236:239], v[228:231], v[44:47]
    ds_read_b128 v[228:231], v253 offset:22368
    v_mfma_f32_16x16x32_bf16 v[44:47], a[248:251], v[232:235], v[44:47]
    ds_write_b64 v249, v[202:203] offset:1600
    v_mfma_f32_16x16x32_bf16 v[44:47], v[244:247], v[236:239], v[44:47]
    v_accvgpr_read_b32 v204, a60
    v_accvgpr_read_b32 v205, a61
    v_accvgpr_read_b32 v206, a62
    v_mfma_f32_16x16x32_bf16 v[48:51], a[228:231], v[232:235], v[48:51]
    v_accvgpr_read_b32 v207, a63
    v_accvgpr_read_b32 v208, a156
    v_mfma_f32_16x16x32_bf16 v[48:51], a[240:243], v[236:239], v[48:51]
    s_waitcnt lgkmcnt(1)
    v_accvgpr_read_b32 v209, a157
    v_accvgpr_read_b32 v210, a158
    v_mfma_f32_16x16x32_bf16 v[48:51], a[252:255], v[228:231], v[48:51]
    v_accvgpr_read_b32 v211, a159
    v_sub_f32 v204, v204, v208
    v_mfma_f32_16x16x32_bf16 v[52:55], v[240:243], v[228:231], v[52:55]
    v_sub_f32 v205, v205, v209
    v_sub_f32 v206, v206, v210
    v_mfma_f32_16x16x32_bf16 v[52:55], a[244:247], v[236:239], v[52:55]
    v_sub_f32 v207, v207, v211
    v_fma_f32 v208, v204, s34, v156 div:2
    v_mfma_f32_16x16x32_bf16 v[52:55], a[232:235], v[232:235], v[52:55]
    buffer_store_dwordx4 a[112:115], v254, s[12:15], s44 offen nt
    v_fma_f32 v209, v205, s34, v157 div:2
    v_fma_f32 v210, v206, s34, v158 div:2
    v_mfma_f32_16x16x32_bf16 v[56:59], a[236:239], v[232:235], v[56:59]
    ds_read_b128 v[232:235], v253 offset:22112
    v_fma_f32 v211, v207, s34, v159 div:2
    v_mfma_f32_16x16x32_bf16 v[56:59], a[248:251], v[236:239], v[56:59]
    v_fma_f32 v156, v204, s35, v156 mul:2
    v_fma_f32 v157, v205, s35, v157 mul:2
    v_mfma_f32_16x16x32_bf16 v[56:59], v[244:247], v[228:231], v[56:59]
    v_fma_f32 v158, v206, s35, v158 mul:2
    v_fma_f32 v159, v207, s35, v159 mul:2
    v_mfma_f32_16x16x32_bf16 v[60:63], a[228:231], v[236:239], v[60:63]
    v_cvt_pk_bf16_f32 v192, v208, v209
    v_cvt_pk_bf16_f32 v193, v210, v211
    v_accvgpr_read_b32 v204, a64
    v_mfma_f32_16x16x32_bf16 v[60:63], a[240:243], v[228:231], v[60:63]
    s_waitcnt lgkmcnt(0)
    v_accvgpr_read_b32 v205, a65
    v_accvgpr_read_b32 v206, a66
    v_mfma_f32_16x16x32_bf16 v[60:63], a[252:255], v[232:235], v[60:63]
    v_accvgpr_read_b32 v207, a67
    v_accvgpr_read_b32 v208, a160
    v_mfma_f32_16x16x32_bf16 v[64:67], v[240:243], v[232:235], v[64:67]
    v_accvgpr_read_b32 v209, a161
    v_accvgpr_read_b32 v210, a162
    v_mfma_f32_16x16x32_bf16 v[64:67], a[244:247], v[228:231], v[64:67]
    v_accvgpr_read_b32 v211, a163
    v_sub_f32 v204, v204, v208
    v_mfma_f32_16x16x32_bf16 v[64:67], a[232:235], v[236:239], v[64:67]
    s_add_u32 s44, s40, 202752
    v_sub_f32 v205, v205, v209
    v_sub_f32 v206, v206, v210
    v_mfma_f32_16x16x32_bf16 v[68:71], a[236:239], v[236:239], v[68:71]
    ds_read_b128 v[236:239], v253 offset:21856
    v_sub_f32 v207, v207, v211
    v_mfma_f32_16x16x32_bf16 v[68:71], a[248:251], v[228:231], v[68:71]
    v_fma_f32 v208, v204, s34, v160 div:2
    v_fma_f32 v209, v205, s34, v161 div:2
    v_mfma_f32_16x16x32_bf16 v[68:71], v[244:247], v[232:235], v[68:71]
    v_fma_f32 v210, v206, s34, v162 div:2
    v_fma_f32 v211, v207, s34, v163 div:2
    v_mfma_f32_16x16x32_bf16 v[72:75], a[228:231], v[228:231], v[72:75]
    v_fma_f32 v160, v204, s35, v160 mul:2
    v_fma_f32 v161, v205, s35, v161 mul:2
    v_mfma_f32_16x16x32_bf16 v[72:75], a[240:243], v[232:235], v[72:75]
    s_waitcnt lgkmcnt(0)
    v_fma_f32 v162, v206, s35, v162 mul:2
    v_fma_f32 v163, v207, s35, v163 mul:2
    v_cvt_pk_bf16_f32 v194, v208, v209
    v_mfma_f32_16x16x32_bf16 v[72:75], a[252:255], v[236:239], v[72:75]
    v_cvt_pk_bf16_f32 v195, v210, v211
    v_accvgpr_read_b32 v204, a68
    v_mfma_f32_16x16x32_bf16 v[76:79], v[240:243], v[236:239], v[76:79]
    ds_write_b128 v248, v[192:195] offset:1920
    v_mfma_f32_16x16x32_bf16 v[76:79], a[244:247], v[232:235], v[76:79]
    v_accvgpr_read_b32 v205, a69
    v_accvgpr_read_b32 v206, a70
    v_mfma_f32_16x16x32_bf16 v[76:79], a[232:235], v[228:231], v[76:79]
    v_accvgpr_read_b32 v207, a71
    v_accvgpr_read_b32 v208, a164
    v_mfma_f32_16x16x32_bf16 v[80:83], a[236:239], v[228:231], v[80:83]
    ds_read_b128 v[228:231], v253 offset:21584
    v_accvgpr_read_b32 v209, a165
    v_mfma_f32_16x16x32_bf16 v[80:83], a[248:251], v[232:235], v[80:83]
    v_accvgpr_read_b32 v210, a166
    v_accvgpr_read_b32 v211, a167
    v_mfma_f32_16x16x32_bf16 v[80:83], v[244:247], v[236:239], v[80:83]
    s_mov_b32 s42, 884736
    v_sub_f32 v204, v204, v208
    v_sub_f32 v205, v205, v209
    v_mfma_f32_16x16x32_bf16 v[84:87], a[228:231], v[232:235], v[84:87]
    v_sub_f32 v206, v206, v210
    v_sub_f32 v207, v207, v211
    v_mfma_f32_16x16x32_bf16 v[88:91], a[232:235], v[232:235], v[88:91]
    v_fma_f32 v208, v204, s34, v164 div:2
    v_fma_f32 v209, v205, s34, v165 div:2
    v_mfma_f32_16x16x32_bf16 v[92:95], a[236:239], v[232:235], v[92:95]
    ds_read_b128 v[232:235], v253 offset:23920
    v_fma_f32 v210, v206, s34, v166 div:2
    v_fma_f32 v211, v207, s34, v167 div:2
    v_mfma_f32_16x16x32_bf16 v[92:95], a[248:251], v[236:239], v[92:95]
    buffer_load_dwordx4 a[228:231], v254, s[8:11], s42 offen offset:0 sc1
    v_mfma_f32_16x16x32_bf16 v[88:91], a[244:247], v[236:239], v[88:91]
    s_waitcnt lgkmcnt(1)
    v_fma_f32 v164, v204, s35, v164 mul:2
    v_fma_f32 v165, v205, s35, v165 mul:2
    v_mfma_f32_16x16x32_bf16 v[84:87], a[240:243], v[236:239], v[84:87]
    ds_read_b128 v[236:239], v253 offset:23648
    v_fma_f32 v166, v206, s35, v166 mul:2
    v_mfma_f32_16x16x32_bf16 v[84:87], a[252:255], v[228:231], v[84:87]
    buffer_load_dwordx4 a[232:235], v254, s[8:11], s42 offen offset:1024 sc1
    v_mfma_f32_16x16x32_bf16 v[88:91], v[240:243], v[228:231], v[88:91]
    s_waitcnt vmcnt(10) lgkmcnt(1)
    v_fma_f32 v167, v207, s35, v167 mul:2
    v_cvt_pk_bf16_f32 v196, v208, v209
    v_mfma_f32_16x16x32_bf16 v[92:95], v[244:247], v[228:231], v[92:95]
    ds_read_b128 v[228:231], v253 offset:23392
    v_cvt_pk_bf16_f32 v197, v210, v211
sub28:
    v_mfma_f32_16x16x32_bf16 v[0:3], a[192:195], v[232:235], v[0:3]
    buffer_load_dwordx4 a[236:239], v254, s[8:11], s42 offen offset:2048 sc1
    v_mfma_f32_16x16x32_bf16 v[4:7], a[196:199], v[232:235], v[4:7]
    s_mov_b32 s42, 887808
    v_accvgpr_read_b32 v204, a72
    v_accvgpr_read_b32 v205, a73
    v_mfma_f32_16x16x32_bf16 v[8:11], a[200:203], v[232:235], v[8:11]
    ds_read_b128 v[232:235], v253 offset:23136
    s_waitcnt vmcnt(8)
    s_waitcnt lgkmcnt(2)
    v_mfma_f32_16x16x32_bf16 v[8:11], a[212:215], v[236:239], v[8:11]
    ds_write_b64 v249, v[196:197] offset:1984
    v_accvgpr_read_b32 v206, a74
    v_mfma_f32_16x16x32_bf16 v[4:7], a[208:211], v[236:239], v[4:7]
    buffer_load_dwordx4 a[240:243], v254, s[8:11], s42 offen offset:0 sc1
    v_mfma_f32_16x16x32_bf16 v[0:3], a[204:207], v[236:239], v[0:3]
    s_waitcnt vmcnt(6) lgkmcnt(2)
    v_accvgpr_read_b32 v207, a75
    v_accvgpr_read_b32 v208, a168
    v_mfma_f32_16x16x32_bf16 v[0:3], a[216:219], v[228:231], v[0:3]
    v_accvgpr_read_b32 v209, a169
    v_accvgpr_read_b32 v210, a170
    v_mfma_f32_16x16x32_bf16 v[4:7], a[220:223], v[228:231], v[4:7]
    v_accvgpr_read_b32 v211, a171
    v_sub_f32 v204, v204, v208
    v_mfma_f32_16x16x32_bf16 v[8:11], a[224:227], v[228:231], v[8:11]
    buffer_load_dwordx4 a[244:247], v254, s[8:11], s42 offen offset:1024 sc1
    v_mfma_f32_16x16x32_bf16 v[12:15], a[192:195], v[236:239], v[12:15]
    v_sub_f32 v205, v205, v209
    v_sub_f32 v206, v206, v210
    v_mfma_f32_16x16x32_bf16 v[12:15], a[204:207], v[228:231], v[12:15]
    s_waitcnt lgkmcnt(1)
    v_sub_f32 v207, v207, v211
    v_fma_f32 v208, v204, s34, v168 div:2
    v_mfma_f32_16x16x32_bf16 v[12:15], a[216:219], v[232:235], v[12:15]
    v_fma_f32 v209, v205, s34, v169 div:2
    v_fma_f32 v210, v206, s34, v170 div:2
    v_mfma_f32_16x16x32_bf16 v[16:19], a[220:223], v[232:235], v[16:19]
    buffer_load_dwordx4 a[248:251], v254, s[8:11], s42 offen offset:2048 sc1
    v_mfma_f32_16x16x32_bf16 v[16:19], a[208:211], v[228:231], v[16:19]
    s_mov_b32 s42, 890880
    v_fma_f32 v211, v207, s34, v171 div:2
    v_fma_f32 v168, v204, s35, v168 mul:2
    v_fma_f32 v169, v205, s35, v169 mul:2
    v_mfma_f32_16x16x32_bf16 v[16:19], a[196:199], v[236:239], v[16:19]
    v_fma_f32 v170, v206, s35, v170 mul:2
    v_fma_f32 v171, v207, s35, v171 mul:2
    v_mfma_f32_16x16x32_bf16 v[20:23], a[200:203], v[236:239], v[20:23]
    ds_read_b128 v[236:239], v253 offset:22880
    v_cvt_pk_bf16_f32 v198, v208, v209
    v_mfma_f32_16x16x32_bf16 v[20:23], a[212:215], v[228:231], v[20:23]
    buffer_load_dwordx4 a[252:255], v254, s[8:11], s42 offen offset:0 sc1
    v_mfma_f32_16x16x32_bf16 v[20:23], a[224:227], v[232:235], v[20:23]
    v_cvt_pk_bf16_f32 v199, v210, v211
    v_accvgpr_read_b32 v204, a76
    v_mfma_f32_16x16x32_bf16 v[24:27], a[192:195], v[228:231], v[24:27]
    v_accvgpr_read_b32 v205, a77
    v_accvgpr_read_b32 v206, a78
    v_mfma_f32_16x16x32_bf16 v[24:27], a[204:207], v[232:235], v[24:27]
    s_waitcnt lgkmcnt(0)
    v_accvgpr_read_b32 v207, a79
    v_accvgpr_read_b32 v208, a172
    v_mfma_f32_16x16x32_bf16 v[24:27], a[216:219], v[236:239], v[24:27]
    v_accvgpr_read_b32 v209, a173
    v_accvgpr_read_b32 v210, a174
    v_mfma_f32_16x16x32_bf16 v[28:31], a[220:223], v[236:239], v[28:31]
    buffer_load_dwordx4 v[240:243], v254, s[8:11], s42 offen offset:1024 sc1
    v_mfma_f32_16x16x32_bf16 v[28:31], a[208:211], v[232:235], v[28:31]
    v_accvgpr_read_b32 v211, a175
    v_sub_f32 v204, v204, v208
    v_mfma_f32_16x16x32_bf16 v[28:31], a[196:199], v[228:231], v[28:31]
    v_sub_f32 v205, v205, v209
    v_sub_f32 v206, v206, v210
    v_sub_f32 v207, v207, v211
    v_mfma_f32_16x16x32_bf16 v[32:35], a[200:203], v[228:231], v[32:35]
    ds_read_b128 v[228:231], v253 offset:24704
    v_fma_f32 v208, v204, s34, v172 div:2
    v_mfma_f32_16x16x32_bf16 v[32:35], a[212:215], v[232:235], v[32:35]
    buffer_load_dwordx4 v[244:247], v254, s[8:11], s42 offen offset:2048 sc1
    v_mfma_f32_16x16x32_bf16 v[32:35], a[224:227], v[236:239], v[32:35]
    v_fma_f32 v209, v205, s34, v173 div:2
    v_fma_f32 v210, v206, s34, v174 div:2
    v_mfma_f32_16x16x32_bf16 v[36:39], a[192:195], v[232:235], v[36:39]
    v_fma_f32 v211, v207, s34, v175 div:2
    v_fma_f32 v172, v204, s35, v172 mul:2
    v_mfma_f32_16x16x32_bf16 v[36:39], a[204:207], v[236:239], v[36:39]
    s_waitcnt lgkmcnt(0)
    v_fma_f32 v173, v205, s35, v173 mul:2
    v_fma_f32 v174, v206, s35, v174 mul:2
    v_mfma_f32_16x16x32_bf16 v[36:39], a[216:219], v[228:231], v[36:39]
    buffer_store_dwordx4 a[116:119], v254, s[12:15], s44 offen nt
    s_add_u32 s44, s40, 205824
    v_mfma_f32_16x16x32_bf16 v[40:43], a[220:223], v[228:231], v[40:43]
    v_fma_f32 v175, v207, s35, v175 mul:2
    v_cvt_pk_bf16_f32 v200, v208, v209
    v_mfma_f32_16x16x32_bf16 v[40:43], a[208:211], v[236:239], v[40:43]
    v_cvt_pk_bf16_f32 v201, v210, v211
    v_accvgpr_read_b32 v204, a80
    v_mfma_f32_16x16x32_bf16 v[40:43], a[196:199], v[232:235], v[40:43]
    buffer_store_dwordx4 a[120:123], v254, s[12:15], s44 offen nt
    s_add_u32 s44, s40, 197632
    v_accvgpr_read_b32 v205, a81
    v_mfma_f32_16x16x32_bf16 v[44:47], a[200:203], v[232:235], v[44:47]
    ds_read_b128 v[232:235], v253 offset:24448
    v_accvgpr_read_b32 v206, a82
    v_accvgpr_read_b32 v207, a83
    v_mfma_f32_16x16x32_bf16 v[44:47], a[212:215], v[236:239], v[44:47]
    ds_write_b128 v248, v[198:201] offset:2304
    v_mfma_f32_16x16x32_bf16 v[44:47], a[224:227], v[228:231], v[44:47]
    v_accvgpr_read_b32 v208, a176
    v_accvgpr_read_b32 v209, a177
    v_mfma_f32_16x16x32_bf16 v[48:51], a[192:195], v[236:239], v[48:51]
    v_accvgpr_read_b32 v210, a178
    v_accvgpr_read_b32 v211, a179
    v_mfma_f32_16x16x32_bf16 v[48:51], a[204:207], v[228:231], v[48:51]
    s_waitcnt lgkmcnt(1)
    v_sub_f32 v204, v204, v208
    v_sub_f32 v205, v205, v209
    v_mfma_f32_16x16x32_bf16 v[48:51], a[216:219], v[232:235], v[48:51]
    v_sub_f32 v206, v206, v210
    v_sub_f32 v207, v207, v211
    v_mfma_f32_16x16x32_bf16 v[52:55], a[220:223], v[232:235], v[52:55]
    v_fma_f32 v208, v204, s34, v176 div:2
    v_fma_f32 v209, v205, s34, v177 div:2
    v_mfma_f32_16x16x32_bf16 v[52:55], a[208:211], v[228:231], v[52:55]
    v_fma_f32 v210, v206, s34, v178 div:2
    v_fma_f32 v211, v207, s34, v179 div:2
    v_mfma_f32_16x16x32_bf16 v[52:55], a[196:199], v[236:239], v[52:55]
    v_fma_f32 v176, v204, s35, v176 mul:2
    v_fma_f32 v177, v205, s35, v177 mul:2
    v_mfma_f32_16x16x32_bf16 v[56:59], a[200:203], v[236:239], v[56:59]
    ds_read_b128 v[236:239], v253 offset:24192
    v_fma_f32 v178, v206, s35, v178 mul:2
    v_mfma_f32_16x16x32_bf16 v[56:59], a[212:215], v[228:231], v[56:59]
    v_fma_f32 v179, v207, s35, v179 mul:2
    v_cvt_pk_bf16_f32 v202, v208, v209
    v_cvt_pk_bf16_f32 v203, v210, v211
    v_mfma_f32_16x16x32_bf16 v[56:59], a[224:227], v[232:235], v[56:59]
    ds_write_b64 v249, v[202:203] offset:2368
    v_mfma_f32_16x16x32_bf16 v[60:63], a[192:195], v[228:231], v[60:63]
    v_accvgpr_read_b32 v204, a180
    v_accvgpr_read_b32 v205, a181
    v_mfma_f32_16x16x32_bf16 v[60:63], a[204:207], v[232:235], v[60:63]
    s_waitcnt lgkmcnt(1)
    v_accvgpr_read_b32 v206, a182
    v_accvgpr_read_b32 v207, a183
    v_mfma_f32_16x16x32_bf16 v[60:63], a[216:219], v[236:239], v[60:63]
    v_fma_f32 v208, v204, s34, v180 div:2
    v_fma_f32 v209, v205, s34, v181 div:2
    v_mfma_f32_16x16x32_bf16 v[64:67], a[220:223], v[236:239], v[64:67]
    v_fma_f32 v210, v206, s34, v182 div:2
    v_fma_f32 v211, v207, s34, v183 div:2
    v_mfma_f32_16x16x32_bf16 v[64:67], a[208:211], v[232:235], v[64:67]
    v_fma_f32 v180, v204, s35, v180 mul:2
    v_fma_f32 v181, v205, s35, v181 mul:2
    v_mfma_f32_16x16x32_bf16 v[64:67], a[196:199], v[228:231], v[64:67]
    v_fma_f32 v182, v206, s35, v182 mul:2
    v_fma_f32 v183, v207, s35, v183 mul:2
    v_mfma_f32_16x16x32_bf16 v[68:71], a[200:203], v[228:231], v[68:71]
    ds_read_b128 v[228:231], v253 offset:23936
    v_cvt_pk_bf16_f32 v192, v208, v209
    v_mfma_f32_16x16x32_bf16 v[68:71], a[212:215], v[232:235], v[68:71]
    v_cvt_pk_bf16_f32 v193, v210, v211
    v_accvgpr_read_b32 v204, a184
    v_mfma_f32_16x16x32_bf16 v[68:71], a[224:227], v[236:239], v[68:71]
    v_accvgpr_read_b32 v205, a185
    v_accvgpr_read_b32 v206, a186
    v_accvgpr_read_b32 v207, a187
    v_mfma_f32_16x16x32_bf16 v[72:75], a[192:195], v[232:235], v[72:75]
    v_fma_f32 v208, v204, s34, v184 div:2
    v_fma_f32 v209, v205, s34, v185 div:2
    v_mfma_f32_16x16x32_bf16 v[72:75], a[204:207], v[236:239], v[72:75]
    s_waitcnt lgkmcnt(0)
    v_fma_f32 v210, v206, s34, v186 div:2
    v_fma_f32 v211, v207, s34, v187 div:2
    v_mfma_f32_16x16x32_bf16 v[72:75], a[216:219], v[228:231], v[72:75]
    v_fma_f32 v184, v204, s35, v184 mul:2
    v_fma_f32 v185, v205, s35, v185 mul:2
    v_mfma_f32_16x16x32_bf16 v[76:79], a[220:223], v[228:231], v[76:79]
    v_fma_f32 v186, v206, s35, v186 mul:2
    v_fma_f32 v187, v207, s35, v187 mul:2
    v_mfma_f32_16x16x32_bf16 v[76:79], a[208:211], v[236:239], v[76:79]
    v_cvt_pk_bf16_f32 v194, v208, v209
    v_cvt_pk_bf16_f32 v195, v210, v211
    v_mfma_f32_16x16x32_bf16 v[76:79], a[196:199], v[232:235], v[76:79]
    ds_write_b128 v248, v[192:195] offset:2688
    v_mfma_f32_16x16x32_bf16 v[80:83], a[200:203], v[232:235], v[80:83]
    ds_read_b128 v[232:235], v253 offset:23664
    v_accvgpr_read_b32 v204, a188
    v_mfma_f32_16x16x32_bf16 v[80:83], a[212:215], v[236:239], v[80:83]
    v_accvgpr_read_b32 v205, a189
    v_accvgpr_read_b32 v206, a190
    v_mfma_f32_16x16x32_bf16 v[80:83], a[224:227], v[228:231], v[80:83]
    s_mov_b32 s42, 1105920
    v_accvgpr_read_b32 v207, a191
    v_fma_f32 v208, v204, s34, v188 div:2
    v_mfma_f32_16x16x32_bf16 v[84:87], a[192:195], v[236:239], v[84:87]
    s_waitcnt lgkmcnt(0)
    v_fma_f32 v209, v205, s34, v189 div:2
    v_fma_f32 v210, v206, s34, v190 div:2
    v_fma_f32 v211, v207, s34, v191 div:2
    v_mfma_f32_16x16x32_bf16 v[88:91], a[196:199], v[236:239], v[88:91]
    s_barrier
    v_mfma_f32_16x16x32_bf16 v[92:95], a[200:203], v[236:239], v[92:95]
    ds_read_b128 v[236:239], v253 offset:34320
    v_fma_f32 v188, v204, s35, v188 mul:2
    v_mfma_f32_16x16x32_bf16 v[92:95], a[212:215], v[228:231], v[92:95]
    buffer_load_dwordx4 a[192:195], v254, s[8:11], s42 offen offset:0 sc1
    v_mfma_f32_16x16x32_bf16 v[88:91], a[208:211], v[228:231], v[88:91]
    v_fma_f32 v189, v205, s35, v189 mul:2
    v_fma_f32 v190, v206, s35, v190 mul:2
    v_mfma_f32_16x16x32_bf16 v[84:87], a[204:207], v[228:231], v[84:87]
    ds_read_b128 v[228:231], v253 offset:34048
    v_fma_f32 v191, v207, s35, v191 mul:2
    v_mfma_f32_16x16x32_bf16 v[84:87], a[216:219], v[232:235], v[84:87]
    buffer_load_dwordx4 a[196:199], v254, s[8:11], s42 offen offset:1024 sc1
    v_mfma_f32_16x16x32_bf16 v[88:91], a[220:223], v[232:235], v[88:91]
    s_waitcnt vmcnt(10) lgkmcnt(1)
    v_cvt_pk_bf16_f32 v196, v208, v209
    v_cvt_pk_bf16_f32 v197, v210, v211
    v_mfma_f32_16x16x32_bf16 v[92:95], a[224:227], v[232:235], v[92:95]
    ds_read_b128 v[232:235], v253 offset:33792
sub29:
    v_mfma_f32_16x16x32_bf16 v[0:3], a[228:231], v[236:239], v[0:3]
    buffer_load_dwordx4 a[200:203], v254, s[8:11], s42 offen offset:2048 sc1
    v_mfma_f32_16x16x32_bf16 v[4:7], a[232:235], v[236:239], v[4:7]
    s_mov_b32 s42, 1108992
    v_mfma_f32_16x16x32_bf16 v[8:11], a[236:239], v[236:239], v[8:11]
    ds_read_b128 v[236:239], v253 offset:33536
    s_waitcnt vmcnt(8)
    s_waitcnt lgkmcnt(2)
    v_mfma_f32_16x16x32_bf16 v[8:11], a[248:251], v[228:231], v[8:11]
pad11:
    s_cbranch_vccnz warm_ret
    ds_read_b128 a[124:127], v250 offset:1024
    v_mfma_f32_16x16x32_bf16 v[4:7], a[244:247], v[228:231], v[4:7]
    buffer_load_dwordx4 a[204:207], v254, s[8:11], s42 offen offset:0 sc1
    v_mfma_f32_16x16x32_bf16 v[0:3], a[240:243], v[228:231], v[0:3]
    s_waitcnt vmcnt(6) lgkmcnt(2)
    v_mfma_f32_16x16x32_bf16 v[0:3], a[252:255], v[232:235], v[0:3]
    ds_write_b64 v249, v[196:197] offset:2752
    v_mfma_f32_16x16x32_bf16 v[4:7], v[240:243], v[232:235], v[4:7]
    ds_read_b128 a[128:131], v250 offset:4128
    v_mfma_f32_16x16x32_bf16 v[8:11], v[244:247], v[232:235], v[8:11]
    buffer_load_dwordx4 a[208:211], v254, s[8:11], s42 offen offset:1024 sc1
    v_mfma_f32_16x16x32_bf16 v[12:15], a[228:231], v[228:231], v[12:15]
    ds_read_b128 a[132:135], v250 offset:7232
    s_waitcnt lgkmcnt(3)
    v_mfma_f32_16x16x32_bf16 v[12:15], a[240:243], v[232:235], v[12:15]
    v_mfma_f32_16x16x32_bf16 v[12:15], a[252:255], v[236:239], v[12:15]
    v_mfma_f32_16x16x32_bf16 v[16:19], v[240:243], v[236:239], v[16:19]
    buffer_load_dwordx4 a[212:215], v254, s[8:11], s42 offen offset:2048 sc1
    v_mfma_f32_16x16x32_bf16 v[16:19], a[244:247], v[232:235], v[16:19]
    s_mov_b32 s42, 1112064
    v_mfma_f32_16x16x32_bf16 v[16:19], a[232:235], v[228:231], v[16:19]
    buffer_store_dwordx4 a[124:127], v254, s[12:15], s44 offen nt
    s_add_u32 s44, s40, 200704
    s_waitcnt lgkmcnt(1)
    v_mfma_f32_16x16x32_bf16 v[20:23], a[236:239], v[228:231], v[20:23]
    ds_read_b128 v[228:231], v253 offset:33280
    v_mfma_f32_16x16x32_bf16 v[20:23], a[248:251], v[232:235], v[20:23]
    buffer_load_dwordx4 a[216:219], v254, s[8:11], s42 offen offset:0 sc1
    v_mfma_f32_16x16x32_bf16 v[20:23], v[244:247], v[236:239], v[20:23]
    ds_read_b128 a[136:139], v250 offset:10336
    v_mfma_f32_16x16x32_bf16 v[24:27], a[228:231], v[232:235], v[24:27]
    buffer_store_dwordx4 a[128:131], v254, s[12:15], s44 offen nt
    s_add_u32 s44, s40, 203776
    s_waitcnt lgkmcnt(2)
    v_mfma_f32_16x16x32_bf16 v[24:27], a[240:243], v[236:239], v[24:27]
    s_waitcnt lgkmcnt(1)
    v_mfma_f32_16x16x32_bf16 v[24:27], a[252:255], v[228:231], v[24:27]
    v_cvt_pk_bf16_f32 v8, v8, v9
    v_cvt_pk_bf16_f32 v9, v10, v11
    v_mfma_f32_16x16x32_bf16 v[28:31], v[240:243], v[228:231], v[28:31]
    buffer_load_dwordx4 a[220:223], v254, s[8:11], s42 offen offset:1024 sc1
    v_mfma_f32_16x16x32_bf16 v[28:31], a[244:247], v[236:239], v[28:31]
    ds_write_b64 v249, v[8:9] offset:12544
    v_mfma_f32_16x16x32_bf16 v[28:31], a[232:235], v[232:235], v[28:31]
    v_cvt_pk_bf16_f32 v0, v0, v1
    v_cvt_pk_bf16_f32 v1, v2, v3
    v_mfma_f32_16x16x32_bf16 v[32:35], a[236:239], v[232:235], v[32:35]
    ds_read_b128 v[232:235], v253 offset:35104
    v_cvt_pk_bf16_f32 v2, v4, v5
    v_mfma_f32_16x16x32_bf16 v[32:35], a[248:251], v[236:239], v[32:35]
    buffer_load_dwordx4 a[224:227], v254, s[8:11], s42 offen offset:2048 sc1
    v_mfma_f32_16x16x32_bf16 v[32:35], v[244:247], v[228:231], v[32:35]
    v_cvt_pk_bf16_f32 v3, v6, v7
    v_mov_b32 v4, v248
    v_mfma_f32_16x16x32_bf16 v[36:39], a[228:231], v[236:239], v[36:39]
    buffer_store_dwordx4 a[132:135], v254, s[12:15], s44 offen nt
    v_and_b32 v227, 0x7fff, v255
    v_mov_b32 v5, v249
    v_mfma_f32_16x16x32_bf16 v[36:39], a[240:243], v[228:231], v[36:39]
    s_waitcnt lgkmcnt(0)
    s_add_u32 s44, s40, 206848
    v_mov_b32 v6, v250
    v_mfma_f32_16x16x32_bf16 v[36:39], a[252:255], v[232:235], v[36:39]
    buffer_load_dwordx2 v[216:217], v227, s[4:7], s16 offen offset:0
    v_mfma_f32_16x16x32_bf16 v[40:43], v[240:243], v[232:235], v[40:43]
    ds_write_b128 v248, v[0:3] offset:12480
    v_mfma_f32_16x16x32_bf16 v[40:43], a[244:247], v[228:231], v[40:43]
    v_cvt_pk_bf16_f32 v20, v20, v21
    v_cvt_pk_bf16_f32 v21, v22, v23
    v_mfma_f32_16x16x32_bf16 v[40:43], a[232:235], v[236:239], v[40:43]
    v_cvt_pk_bf16_f32 v12, v12, v13
    v_cvt_pk_bf16_f32 v13, v14, v15
    v_mfma_f32_16x16x32_bf16 v[44:47], a[236:239], v[236:239], v[44:47]
    ds_read_b128 v[236:239], v253 offset:34848
    v_cvt_pk_bf16_f32 v14, v16, v17
    v_mfma_f32_16x16x32_bf16 v[44:47], a[248:251], v[228:231], v[44:47]
    buffer_load_dwordx2 v[218:219], v227, s[4:7], s17 offen offset:0
    v_mfma_f32_16x16x32_bf16 v[44:47], v[244:247], v[232:235], v[44:47]
    ds_write_b64 v5, v[20:21] offset:12928
    v_mfma_f32_16x16x32_bf16 v[48:51], a[228:231], v[228:231], v[48:51]
    v_cvt_pk_bf16_f32 v15, v18, v19
    v_cvt_pk_bf16_f32 v32, v32, v33
    v_mfma_f32_16x16x32_bf16 v[48:51], a[240:243], v[232:235], v[48:51]
    s_waitcnt lgkmcnt(1)
    v_cvt_pk_bf16_f32 v33, v34, v35
    v_cvt_pk_bf16_f32 v24, v24, v25
    v_mfma_f32_16x16x32_bf16 v[48:51], a[252:255], v[236:239], v[48:51]
    buffer_load_dwordx2 v[220:221], v227, s[4:7], s18 offen offset:0
    v_mfma_f32_16x16x32_bf16 v[52:55], v[240:243], v[236:239], v[52:55]
    ds_write_b128 v4, v[12:15] offset:12864
    v_mfma_f32_16x16x32_bf16 v[52:55], a[244:247], v[232:235], v[52:55]
    v_cvt_pk_bf16_f32 v25, v26, v27
    v_cvt_pk_bf16_f32 v26, v28, v29
    v_mfma_f32_16x16x32_bf16 v[52:55], a[232:235], v[228:231], v[52:55]
    v_cvt_pk_bf16_f32 v27, v30, v31
    v_cvt_pk_bf16_f32 v44, v44, v45
    v_mfma_f32_16x16x32_bf16 v[56:59], a[236:239], v[228:231], v[56:59]
    ds_read_b128 v[228:231], v253 offset:34592
    v_cvt_pk_bf16_f32 v45, v46, v47
    v_mfma_f32_16x16x32_bf16 v[56:59], a[248:251], v[232:235], v[56:59]
    buffer_load_dwordx2 v[222:223], v227, s[4:7], s19 offen offset:0
    v_mfma_f32_16x16x32_bf16 v[56:59], v[244:247], v[236:239], v[56:59]
    ds_write_b64 v5, v[32:33] offset:13312
    v_mfma_f32_16x16x32_bf16 v[60:63], a[228:231], v[232:235], v[60:63]
    v_cvt_pk_bf16_f32 v36, v36, v37
    v_cvt_pk_bf16_f32 v37, v38, v39
    v_mfma_f32_16x16x32_bf16 v[60:63], a[240:243], v[236:239], v[60:63]
    s_waitcnt lgkmcnt(1)
    v_cvt_pk_bf16_f32 v38, v40, v41
    v_cvt_pk_bf16_f32 v39, v42, v43
    v_mfma_f32_16x16x32_bf16 v[60:63], a[252:255], v[228:231], v[60:63]
    buffer_load_dwordx2 v[224:225], v227, s[4:7], s20 offen offset:0
    v_mfma_f32_16x16x32_bf16 v[64:67], v[240:243], v[228:231], v[64:67]
    ds_write_b128 v4, v[24:27] offset:13248
    v_mfma_f32_16x16x32_bf16 v[64:67], a[244:247], v[236:239], v[64:67]
    v_mfma_f32_16x16x32_bf16 v[64:67], a[232:235], v[232:235], v[64:67]
    v_cvt_pk_bf16_f32 v56, v56, v57
    v_cvt_pk_bf16_f32 v57, v58, v59
    v_mfma_f32_16x16x32_bf16 v[68:71], a[236:239], v[232:235], v[68:71]
    ds_read_b128 v[232:235], v253 offset:34336
    v_cvt_pk_bf16_f32 v48, v48, v49
    v_mfma_f32_16x16x32_bf16 v[68:71], a[248:251], v[236:239], v[68:71]
    buffer_load_dwordx2 v[226:227], v227, s[4:7], s21 offen offset:0
    v_mfma_f32_16x16x32_bf16 v[68:71], v[244:247], v[228:231], v[68:71]
    ds_write_b64 v5, v[44:45] offset:13696
    v_mfma_f32_16x16x32_bf16 v[72:75], a[228:231], v[236:239], v[72:75]
    buffer_store_dwordx4 a[136:139], v254, s[12:15], s44 offen nt
    s_add_u32 s44, s40, 198656
    v_cvt_pk_bf16_f32 v49, v50, v51
    v_mfma_f32_16x16x32_bf16 v[72:75], a[240:243], v[228:231], v[72:75]
    s_waitcnt lgkmcnt(1)
    v_cvt_pk_bf16_f32 v50, v52, v53
    v_cvt_pk_bf16_f32 v51, v54, v55
    v_mfma_f32_16x16x32_bf16 v[72:75], a[252:255], v[232:235], v[72:75]
    ds_write_b128 v4, v[36:39] offset:13632
    v_mfma_f32_16x16x32_bf16 v[76:79], v[240:243], v[232:235], v[76:79]
    v_mfma_f32_16x16x32_bf16 v[76:79], a[244:247], v[228:231], v[76:79]
    v_mfma_f32_16x16x32_bf16 v[76:79], a[232:235], v[236:239], v[76:79]
    v_cvt_pk_bf16_f32 v68, v68, v69
    v_cvt_pk_bf16_f32 v69, v70, v71
    v_mfma_f32_16x16x32_bf16 v[80:83], a[236:239], v[236:239], v[80:83]
    ds_read_b128 v[236:239], v253 offset:34064
    v_cvt_pk_bf16_f32 v60, v60, v61
    v_mfma_f32_16x16x32_bf16 v[80:83], a[248:251], v[228:231], v[80:83]
    v_cvt_pk_bf16_f32 v61, v62, v63
    v_cvt_pk_bf16_f32 v62, v64, v65
    v_mfma_f32_16x16x32_bf16 v[80:83], v[244:247], v[232:235], v[80:83]
    s_mov_b32 s42, 1142784
    v_cvt_pk_bf16_f32 v63, v66, v67
    v_mfma_f32_16x16x32_bf16 v[84:87], a[228:231], v[228:231], v[84:87]
    s_waitcnt lgkmcnt(0)
    v_mfma_f32_16x16x32_bf16 v[88:91], a[232:235], v[228:231], v[88:91]
    s_barrier
    v_mfma_f32_16x16x32_bf16 v[92:95], a[236:239], v[228:231], v[92:95]
    ds_read_b128 v[228:231], v253 offset:36400
    v_mfma_f32_16x16x32_bf16 v[92:95], a[248:251], v[232:235], v[92:95]
    buffer_load_dwordx4 a[228:231], v254, s[8:11], s42 offen offset:0 sc1
    v_mfma_f32_16x16x32_bf16 v[88:91], a[244:247], v[232:235], v[88:91]
    v_mfma_f32_16x16x32_bf16 v[84:87], a[240:243], v[232:235], v[84:87]
    ds_read_b128 v[232:235], v253 offset:36128
    v_cvt_pk_bf16_f32 v80, v80, v81
    v_mfma_f32_16x16x32_bf16 v[84:87], a[252:255], v[236:239], v[84:87]
    buffer_load_dwordx4 a[232:235], v254, s[8:11], s42 offen offset:1024 sc1
    v_mfma_f32_16x16x32_bf16 v[88:91], v[240:243], v[236:239], v[88:91]
    s_waitcnt vmcnt(18) lgkmcnt(1)
    v_cvt_pk_bf16_f32 v81, v82, v83
    v_cvt_pk_bf16_f32 v72, v72, v73
    v_mfma_f32_16x16x32_bf16 v[92:95], v[244:247], v[236:239], v[92:95]
    ds_read_b128 v[236:239], v253 offset:35872
    v_cvt_pk_bf16_f32 v73, v74, v75
sub30:
    v_mfma_f32_16x16x32_bf16 v[96:99], a[192:195], v[228:231], v[96:99]
    buffer_load_dwordx4 a[236:239], v254, s[8:11], s42 offen offset:2048 sc1
    v_mfma_f32_16x16x32_bf16 v[100:103], a[196:199], v[228:231], v[100:103]
    s_mov_b32 s42, 1145856
    v_cvt_pk_bf16_f32 v74, v76, v77
    v_cvt_pk_bf16_f32 v75, v78, v79
    v_mfma_f32_16x16x32_bf16 v[104:107], a[200:203], v[228:231], v[104:107]
    ds_read_b128 v[228:231], v253 offset:35616
    s_waitcnt vmcnt(16)
    s_waitcnt lgkmcnt(2)
    v_mfma_f32_16x16x32_bf16 v[104:107], a[212:215], v[232:235], v[104:107]
    ds_read_b128 a[140:143], v6 offset:2048
    v_mfma_f32_16x16x32_bf16 v[100:103], a[208:211], v[232:235], v[100:103]
    buffer_load_dwordx4 a[240:243], v254, s[8:11], s42 offen offset:0 sc1
    v_mfma_f32_16x16x32_bf16 v[96:99], a[204:207], v[232:235], v[96:99]
    s_waitcnt vmcnt(12) lgkmcnt(2)
    v_cvt_pk_bf16_f32 v92, v92, v93
    v_cvt_pk_bf16_f32 v93, v94, v95
    v_mfma_f32_16x16x32_bf16 v[96:99], a[216:219], v[236:239], v[96:99]
    v_cvt_pk_bf16_f32 v84, v84, v85
    v_cvt_pk_bf16_f32 v85, v86, v87
    v_mfma_f32_16x16x32_bf16 v[100:103], a[220:223], v[236:239], v[100:103]
    ds_read_b128 a[144:147], v6 offset:5152
    v_cvt_pk_bf16_f32 v86, v88, v89
    v_mfma_f32_16x16x32_bf16 v[104:107], a[224:227], v[236:239], v[104:107]
    buffer_load_dwordx4 a[244:247], v254, s[8:11], s42 offen offset:1024 sc1
    v_mfma_f32_16x16x32_bf16 v[108:111], a[192:195], v[232:235], v[108:111]
    s_waitcnt lgkmcnt(1)
    v_cvt_pk_bf16_f32 v87, v90, v91
    v_mfma_f32_16x16x32_bf16 v[108:111], a[204:207], v[236:239], v[108:111]
    v_mfma_f32_16x16x32_bf16 v[108:111], a[216:219], v[228:231], v[108:111]
    ds_write_b64 v5, v[56:57] offset:14080
    v_mfma_f32_16x16x32_bf16 v[112:115], a[220:223], v[228:231], v[112:115]
    buffer_load_dwordx4 a[248:251], v254, s[8:11], s42 offen offset:2048 sc1
    v_mfma_f32_16x16x32_bf16 v[112:115], a[208:211], v[236:239], v[112:115]
    s_mov_b32 s42, 1148928
    v_mfma_f32_16x16x32_bf16 v[112:115], a[196:199], v[232:235], v[112:115]
    buffer_store_dwordx4 a[140:143], v254, s[12:15], s44 offen nt
    s_add_u32 s44, s40, 201728
    s_waitcnt lgkmcnt(1)
    v_mfma_f32_16x16x32_bf16 v[116:119], a[200:203], v[232:235], v[116:119]
    ds_read_b128 v[232:235], v253 offset:35360
    v_mfma_f32_16x16x32_bf16 v[116:119], a[212:215], v[236:239], v[116:119]
    buffer_load_dwordx4 a[252:255], v254, s[8:11], s42 offen offset:0 sc1
    v_mfma_f32_16x16x32_bf16 v[116:119], a[224:227], v[228:231], v[116:119]
    ds_read_b128 a[148:151], v6 offset:8256
    v_mfma_f32_16x16x32_bf16 v[120:123], a[192:195], v[236:239], v[120:123]
    v_mfma_f32_16x16x32_bf16 v[120:123], a[204:207], v[228:231], v[120:123]
    s_waitcnt lgkmcnt(1)
    v_mfma_f32_16x16x32_bf16 v[120:123], a[216:219], v[232:235], v[120:123]
    ds_write_b128 v4, v[48:51] offset:14016
    v_mfma_f32_16x16x32_bf16 v[124:127], a[220:223], v[232:235], v[124:127]
    buffer_load_dwordx4 v[240:243], v254, s[8:11], s42 offen offset:1024 sc1
    v_mfma_f32_16x16x32_bf16 v[124:127], a[208:211], v[228:231], v[124:127]
    ds_read_b128 a[152:155], v6 offset:11360
    v_mfma_f32_16x16x32_bf16 v[124:127], a[196:199], v[236:239], v[124:127]
    v_mfma_f32_16x16x32_bf16 v[128:131], a[200:203], v[236:239], v[128:131]
    ds_read_b128 v[236:239], v253 offset:37184
    v_mfma_f32_16x16x32_bf16 v[128:131], a[212:215], v[228:231], v[128:131]
    buffer_load_dwordx4 v[244:247], v254, s[8:11], s42 offen offset:2048 sc1
    v_mfma_f32_16x16x32_bf16 v[128:131], a[224:227], v[232:235], v[128:131]
    ds_write_b64 v5, v[68:69] offset:14464
    v_mfma_f32_16x16x32_bf16 v[132:135], a[192:195], v[228:231], v[132:135]
    buffer_store_dwordx4 a[144:147], v254, s[12:15], s44 offen nt
    v_and_b32 v203, 0x7fff, v255
    s_waitcnt vmcnt(12)
    v_mfma_f32_16x16x32_bf16 v[132:135], a[204:207], v[232:235], v[132:135]
    s_waitcnt lgkmcnt(1)
    v_lshlrev_b32 v248, 16, v218
    v_lshlrev_b32 v249, 16, v220
    v_mfma_f32_16x16x32_bf16 v[132:135], a[216:219], v[236:239], v[132:135]
    buffer_load_dwordx2 v[192:193], v203, s[4:7], s16 offen offset:384
    v_mfma_f32_16x16x32_bf16 v[136:139], a[220:223], v[236:239], v[136:139]
    s_add_u32 s44, s40, 204800
    v_lshlrev_b32 v250, 16, v222
    v_lshlrev_b32 v251, 16, v224
    v_mfma_f32_16x16x32_bf16 v[136:139], a[208:211], v[232:235], v[136:139]
    ds_write_b128 v4, v[60:63] offset:14400
    v_mfma_f32_16x16x32_bf16 v[136:139], a[196:199], v[228:231], v[136:139]
    v_and_b32 v218, s22, v218
    v_and_b32 v220, s22, v220
    v_mfma_f32_16x16x32_bf16 v[140:143], a[200:203], v[228:231], v[140:143]
    ds_read_b128 v[228:231], v253 offset:36928
    v_and_b32 v222, s22, v222
    v_mfma_f32_16x16x32_bf16 v[140:143], a[212:215], v[232:235], v[140:143]
    buffer_load_dwordx2 v[194:195], v203, s[4:7], s17 offen offset:384
    v_mfma_f32_16x16x32_bf16 v[140:143], a[224:227], v[236:239], v[140:143]
    ds_write_b64 v5, v[80:81] offset:14848
    v_mfma_f32_16x16x32_bf16 v[144:147], a[192:195], v[232:235], v[144:147]
    v_and_b32 v224, s22, v224
    v_lshlrev_b32 v252, 16, v216
    v_mfma_f32_16x16x32_bf16 v[144:147], a[204:207], v[236:239], v[144:147]
    s_waitcnt lgkmcnt(1)
    v_and_b32 v216, s22, v216
    v_fmac_f32 v252, s25, v251
    v_mfma_f32_16x16x32_bf16 v[144:147], a[216:219], v[228:231], v[144:147]
    buffer_load_dwordx2 v[196:197], v203, s[4:7], s18 offen offset:384
    v_mfma_f32_16x16x32_bf16 v[148:151], a[220:223], v[228:231], v[148:151]
    v_fmac_f32 v216, s25, v224
    v_fmac_f32 v252, s28, v249
    v_mfma_f32_16x16x32_bf16 v[148:151], a[208:211], v[236:239], v[148:151]
    ds_write_b128 v4, v[72:75] offset:14784
    v_mfma_f32_16x16x32_bf16 v[148:151], a[196:199], v[232:235], v[148:151]
    v_fmac_f32 v216, s28, v220
    v_cvt_pk_bf16_f32 v216, v252, v216
    v_mfma_f32_16x16x32_bf16 v[152:155], a[200:203], v[232:235], v[152:155]
    ds_read_b128 v[232:235], v253 offset:36672
    v_lshlrev_b32 v252, 16, v226
    v_mfma_f32_16x16x32_bf16 v[152:155], a[212:215], v[236:239], v[152:155]
    buffer_load_dwordx2 v[198:199], v203, s[4:7], s19 offen offset:384
    v_mfma_f32_16x16x32_bf16 v[152:155], a[224:227], v[228:231], v[152:155]
    ds_write_b64 v5, v[92:93] offset:15232
    v_mfma_f32_16x16x32_bf16 v[156:159], a[192:195], v[236:239], v[156:159]
    v_and_b32 v226, s22, v226
    v_fmac_f32 v252, s29, v248
    v_mfma_f32_16x16x32_bf16 v[156:159], a[204:207], v[228:231], v[156:159]
    s_waitcnt lgkmcnt(1)
    v_fmac_f32 v226, s29, v218
    v_fmac_f32 v252, s23, v250
    v_mfma_f32_16x16x32_bf16 v[156:159], a[216:219], v[232:235], v[156:159]
    buffer_load_dwordx2 v[200:201], v203, s[4:7], s20 offen offset:384
    v_mfma_f32_16x16x32_bf16 v[160:163], a[220:223], v[232:235], v[160:163]
    ds_write_b128 v4, v[84:87] offset:15168
    v_mfma_f32_16x16x32_bf16 v[160:163], a[208:211], v[228:231], v[160:163]
    v_fmac_f32 v226, s23, v222
    v_cvt_pk_bf16_f32 v226, v252, v226
    v_mfma_f32_16x16x32_bf16 v[160:163], a[196:199], v[236:239], v[160:163]
    v_fma_f32 v252, v249, s24, v251
    v_fmac_f32 v251, -4.0, v249
    v_mfma_f32_16x16x32_bf16 v[164:167], a[200:203], v[236:239], v[164:167]
    ds_read_b128 v[236:239], v253 offset:36416
    v_fma_f32 v249, v248, s24, v250
    v_mfma_f32_16x16x32_bf16 v[164:167], a[212:215], v[228:231], v[164:167]
    buffer_load_dwordx2 v[202:203], v203, s[4:7], s21 offen offset:384
    v_mfma_f32_16x16x32_bf16 v[164:167], a[224:227], v[232:235], v[164:167]
    v_fmac_f32 v250, -4.0, v248
    v_fma_f32 v248, v250, s26, v251
    v_mfma_f32_16x16x32_bf16 v[168:171], a[192:195], v[228:231], v[168:171]
    buffer_store_dwordx4 a[148:151], v254, s[12:15], s44 offen nt
    s_add_u32 s44, s40, 207872
    v_fmac_f32 v251, s27, v250
    v_mfma_f32_16x16x32_bf16 v[168:171], a[204:207], v[232:235], v[168:171]
    s_waitcnt lgkmcnt(0)
    v_fma_f32 v250, v249, 2.0, v252
    v_fmac_f32 v252, -2.0, v249
    v_mfma_f32_16x16x32_bf16 v[168:171], a[216:219], v[236:239], v[168:171]
    v_fma_f32 v249, v220, s24, v224
    v_fmac_f32 v224, -4.0, v220
    v_mfma_f32_16x16x32_bf16 v[172:175], a[220:223], v[236:239], v[172:175]
    v_fma_f32 v220, v218, s24, v222
    v_fmac_f32 v222, -4.0, v218
    v_mfma_f32_16x16x32_bf16 v[172:175], a[208:211], v[232:235], v[172:175]
    v_fma_f32 v218, v222, s26, v224
    v_fmac_f32 v224, s27, v222
    v_mfma_f32_16x16x32_bf16 v[172:175], a[196:199], v[228:231], v[172:175]
    v_fma_f32 v222, v220, 2.0, v249
    v_fmac_f32 v249, -2.0, v220
    v_mfma_f32_16x16x32_bf16 v[176:179], a[200:203], v[228:231], v[176:179]
    ds_read_b128 v[228:231], v253 offset:36144
    v_cvt_pk_bf16_f32 v218, v248, v218
    v_mfma_f32_16x16x32_bf16 v[176:179], a[212:215], v[232:235], v[176:179]
    v_cvt_pk_bf16_f32 v224, v251, v224
    v_cvt_pk_bf16_f32 v222, v250, v222
    v_mfma_f32_16x16x32_bf16 v[176:179], a[224:227], v[236:239], v[176:179]
    s_mov_b32 s42, 1179648
    v_cvt_pk_bf16_f32 v220, v252, v249
    v_mfma_f32_16x16x32_bf16 v[180:183], a[192:195], v[232:235], v[180:183]
    s_waitcnt lgkmcnt(0)
    v_lshlrev_b32 v248, 16, v219
    v_lshlrev_b32 v249, 16, v221
    v_mfma_f32_16x16x32_bf16 v[184:187], a[196:199], v[232:235], v[184:187]
    s_barrier
    v_mfma_f32_16x16x32_bf16 v[188:191], a[200:203], v[232:235], v[188:191]
    ds_read_b128 v[232:235], v253 offset:38480
    v_lshlrev_b32 v250, 16, v223
    v_mfma_f32_16x16x32_bf16 v[188:191], a[212:215], v[236:239], v[188:191]
    buffer_load_dwordx4 a[192:195], v254, s[8:11], s42 offen offset:0 sc1
    v_mfma_f32_16x16x32_bf16 v[184:187], a[208:211], v[236:239], v[184:187]
    v_lshlrev_b32 v251, 16, v225
    v_and_b32 v219, s22, v219
    v_mfma_f32_16x16x32_bf16 v[180:183], a[204:207], v[236:239], v[180:183]
    ds_read_b128 v[236:239], v253 offset:38208
    v_and_b32 v221, s22, v221
    v_mfma_f32_16x16x32_bf16 v[180:183], a[216:219], v[228:231], v[180:183]
    buffer_load_dwordx4 a[196:199], v254, s[8:11], s42 offen offset:1024 sc1
    v_mfma_f32_16x16x32_bf16 v[184:187], a[220:223], v[228:231], v[184:187]
    s_waitcnt vmcnt(17) lgkmcnt(1)
    v_and_b32 v223, s22, v223
    v_and_b32 v225, s22, v225
    v_mfma_f32_16x16x32_bf16 v[188:191], a[224:227], v[228:231], v[188:191]
    ds_read_b128 v[228:231], v253 offset:37952
    v_lshlrev_b32 v252, 16, v217
sub31:
    v_mfma_f32_16x16x32_bf16 v[96:99], a[228:231], v[232:235], v[96:99]
    buffer_load_dwordx4 a[200:203], v254, s[8:11], s42 offen offset:2048 sc1
    v_mfma_f32_16x16x32_bf16 v[100:103], a[232:235], v[232:235], v[100:103]
    s_mov_b32 s42, 1182720
    v_and_b32 v217, s22, v217
    v_fmac_f32 v252, s25, v251
    v_mfma_f32_16x16x32_bf16 v[104:107], a[236:239], v[232:235], v[104:107]
    ds_read_b128 v[232:235], v253 offset:37696
    s_waitcnt vmcnt(15)
    s_waitcnt lgkmcnt(2)
    v_mfma_f32_16x16x32_bf16 v[104:107], a[248:251], v[236:239], v[104:107]
    ds_read_b128 a[0:3], v6 offset:12480
    v_fmac_f32 v217, s25, v225
    v_mfma_f32_16x16x32_bf16 v[100:103], a[244:247], v[236:239], v[100:103]
    buffer_load_dwordx4 a[204:207], v254, s[8:11], s42 offen offset:0 sc1
    v_mfma_f32_16x16x32_bf16 v[96:99], a[240:243], v[236:239], v[96:99]
    s_waitcnt vmcnt(12) lgkmcnt(2)
    v_fmac_f32 v252, s28, v249
    v_fmac_f32 v217, s28, v221
    v_mfma_f32_16x16x32_bf16 v[96:99], a[252:255], v[228:231], v[96:99]
    buffer_store_dwordx4 a[152:155], v254, s[12:15], s44 offen nt
    v_cvt_pk_bf16_f32 v217, v252, v217
    v_lshlrev_b32 v252, 16, v227
    v_mfma_f32_16x16x32_bf16 v[100:103], v[240:243], v[228:231], v[100:103]
    v_and_b32 v227, s22, v227
    v_fmac_f32 v252, s29, v248
    v_mfma_f32_16x16x32_bf16 v[104:107], v[244:247], v[228:231], v[104:107]
    buffer_load_dwordx4 a[208:211], v254, s[8:11], s42 offen offset:1024 sc1
    v_mfma_f32_16x16x32_bf16 v[108:111], a[228:231], v[236:239], v[108:111]
    ds_read_b128 a[4:7], v6 offset:13504
    s_add_u32 s44, s40, 0
    v_mfma_f32_16x16x32_bf16 v[108:111], a[240:243], v[228:231], v[108:111]
    s_waitcnt lgkmcnt(2)
    v_fmac_f32 v227, s29, v219
    v_fmac_f32 v252, s23, v250
    v_mfma_f32_16x16x32_bf16 v[108:111], a[252:255], v[232:235], v[108:111]
    v_fmac_f32 v227, s23, v223
    v_cvt_pk_bf16_f32 v227, v252, v227
    v_mfma_f32_16x16x32_bf16 v[112:115], v[240:243], v[232:235], v[112:115]
    buffer_load_dwordx4 a[212:215], v254, s[8:11], s42 offen offset:2048 sc1
    v_mfma_f32_16x16x32_bf16 v[112:115], a[244:247], v[228:231], v[112:115]
    s_mov_b32 s42, 1185792
    v_fma_f32 v252, v249, s24, v251
    v_fmac_f32 v251, -4.0, v249
    v_mfma_f32_16x16x32_bf16 v[112:115], a[232:235], v[236:239], v[112:115]
    s_waitcnt lgkmcnt(1)
    v_fma_f32 v249, v248, s24, v250
    v_mfma_f32_16x16x32_bf16 v[116:119], a[236:239], v[236:239], v[116:119]
    ds_read_b128 v[236:239], v253 offset:37440
    v_fmac_f32 v250, -4.0, v248
    v_mfma_f32_16x16x32_bf16 v[116:119], a[248:251], v[228:231], v[116:119]
    buffer_load_dwordx4 a[216:219], v254, s[8:11], s42 offen offset:0 sc1
    v_mfma_f32_16x16x32_bf16 v[116:119], v[244:247], v[232:235], v[116:119]
    v_fma_f32 v248, v250, s26, v251
    v_fmac_f32 v251, s27, v250
    v_mfma_f32_16x16x32_bf16 v[120:123], a[228:231], v[228:231], v[120:123]
    v_fma_f32 v250, v249, 2.0, v252
    v_fmac_f32 v252, -2.0, v249
    v_mfma_f32_16x16x32_bf16 v[120:123], a[240:243], v[232:235], v[120:123]
    s_waitcnt lgkmcnt(0)
    v_fma_f32 v249, v221, s24, v225
    v_fmac_f32 v225, -4.0, v221
    v_mfma_f32_16x16x32_bf16 v[120:123], a[252:255], v[236:239], v[120:123]
    v_fma_f32 v221, v219, s24, v223
    v_fmac_f32 v223, -4.0, v219
    v_mfma_f32_16x16x32_bf16 v[124:127], v[240:243], v[236:239], v[124:127]
    buffer_load_dwordx4 a[220:223], v254, s[8:11], s42 offen offset:1024 sc1
    v_mfma_f32_16x16x32_bf16 v[124:127], a[244:247], v[232:235], v[124:127]
    ds_read_b128 a[8:11], v6 offset:14528
    v_fma_f32 v219, v223, s26, v225
    v_mfma_f32_16x16x32_bf16 v[124:127], a[232:235], v[228:231], v[124:127]
    v_fmac_f32 v225, s27, v223
    v_fma_f32 v223, v221, 2.0, v249
    v_mfma_f32_16x16x32_bf16 v[128:131], a[236:239], v[228:231], v[128:131]
    ds_read_b128 v[228:231], v253 offset:39264
    v_fmac_f32 v249, -2.0, v221
    v_mfma_f32_16x16x32_bf16 v[128:131], a[248:251], v[232:235], v[128:131]
    buffer_load_dwordx4 a[224:227], v254, s[8:11], s42 offen offset:2048 sc1
    v_mfma_f32_16x16x32_bf16 v[128:131], v[244:247], v[236:239], v[128:131]
    v_cvt_pk_bf16_f32 v219, v248, v219
    v_cvt_pk_bf16_f32 v225, v251, v225
    v_mfma_f32_16x16x32_bf16 v[132:135], a[228:231], v[232:235], v[132:135]
    buffer_store_dwordx4 a[0:3], v254, s[12:15], s44 offen nt
    v_and_b32 v215, 0x7fff, v255
    v_cvt_pk_bf16_f32 v223, v250, v223
    v_mfma_f32_16x16x32_bf16 v[132:135], a[240:243], v[236:239], v[132:135]
    s_waitcnt lgkmcnt(0)
    s_add_u32 s44, s40, 1024
    v_cvt_pk_bf16_f32 v221, v252, v249
    v_mfma_f32_16x16x32_bf16 v[132:135], a[252:255], v[228:231], v[132:135]
    buffer_load_dwordx2 v[204:205], v215, s[4:7], s16 offen offset:768
    v_mfma_f32_16x16x32_bf16 v[136:139], v[240:243], v[228:231], v[136:139]
    v_lshrrev_b32 v252, 15, v255
    v_mfma_f32_16x16x32_bf16 v[136:139], a[244:247], v[236:239], v[136:139]
    ds_write_b64 v252, v[218:219] offset:768
    v_mfma_f32_16x16x32_bf16 v[136:139], a[232:235], v[232:235], v[136:139]
    s_waitcnt vmcnt(13)
    v_lshrrev_b32 v218, 15, v255
    v_lshlrev_b32 v248, 16, v194
    v_mfma_f32_16x16x32_bf16 v[140:143], a[236:239], v[232:235], v[140:143]
    ds_read_b128 v[232:235], v253 offset:39008
    v_lshlrev_b32 v249, 16, v196
    v_mfma_f32_16x16x32_bf16 v[140:143], a[248:251], v[236:239], v[140:143]
    buffer_load_dwordx2 v[206:207], v215, s[4:7], s17 offen offset:768
    v_mfma_f32_16x16x32_bf16 v[140:143], v[244:247], v[228:231], v[140:143]
    v_lshlrev_b32 v250, 16, v198
    v_lshlrev_b32 v251, 16, v200
    v_mfma_f32_16x16x32_bf16 v[144:147], a[228:231], v[236:239], v[144:147]
    ds_read_b128 a[12:15], v6 offset:15584
    v_and_b32 v194, s22, v194
    v_mfma_f32_16x16x32_bf16 v[144:147], a[240:243], v[228:231], v[144:147]
    s_waitcnt lgkmcnt(1)
    v_and_b32 v196, s22, v196
    v_and_b32 v198, s22, v198
    v_mfma_f32_16x16x32_bf16 v[144:147], a[252:255], v[232:235], v[144:147]
    buffer_load_dwordx2 v[208:209], v215, s[4:7], s18 offen offset:768
    v_mfma_f32_16x16x32_bf16 v[148:151], v[240:243], v[232:235], v[148:151]
    ds_write_b64 v218, v[224:225] offset:2848
    v_mfma_f32_16x16x32_bf16 v[148:151], a[244:247], v[228:231], v[148:151]
    v_and_b32 v200, s22, v200
    v_lshlrev_b32 v252, 16, v192
    v_mfma_f32_16x16x32_bf16 v[148:151], a[232:235], v[236:239], v[148:151]
    ds_write_b64 v218, v[222:223] offset:4928
    v_mfma_f32_16x16x32_bf16 v[152:155], a[236:239], v[236:239], v[152:155]
    ds_read_b128 v[236:239], v253 offset:38752
    v_and_b32 v192, s22, v192
    v_mfma_f32_16x16x32_bf16 v[152:155], a[248:251], v[228:231], v[152:155]
    buffer_load_dwordx2 v[210:211], v215, s[4:7], s19 offen offset:768
    v_mfma_f32_16x16x32_bf16 v[152:155], v[244:247], v[232:235], v[152:155]
    ds_write_b64 v218, v[216:217] offset:34048
    v_mfma_f32_16x16x32_bf16 v[156:159], a[228:231], v[228:231], v[156:159]
    v_fmac_f32 v252, s25, v251
    v_fmac_f32 v192, s25, v200
    v_mfma_f32_16x16x32_bf16 v[156:159], a[240:243], v[232:235], v[156:159]
    s_waitcnt lgkmcnt(1)
    v_fmac_f32 v252, s28, v249
    v_fmac_f32 v192, s28, v196
    v_mfma_f32_16x16x32_bf16 v[156:159], a[252:255], v[236:239], v[156:159]
    buffer_load_dwordx2 v[212:213], v215, s[4:7], s20 offen offset:768
    v_mfma_f32_16x16x32_bf16 v[160:163], v[240:243], v[236:239], v[160:163]
    ds_write_b64 v218, v[226:227] offset:36128
    v_mfma_f32_16x16x32_bf16 v[160:163], a[244:247], v[232:235], v[160:163]
    v_cvt_pk_bf16_f32 v192, v252, v192
    v_lshlrev_b32 v252, 16, v202
    v_mfma_f32_16x16x32_bf16 v[160:163], a[232:235], v[228:231], v[160:163]
    ds_read_b128 a[16:19], v6 offset:16608
    v_and_b32 v202, s22, v202
    v_mfma_f32_16x16x32_bf16 v[164:167], a[236:239], v[228:231], v[164:167]
    ds_read_b128 v[228:231], v253 offset:38496
    v_fmac_f32 v252, s29, v248
    v_mfma_f32_16x16x32_bf16 v[164:167], a[248:251], v[232:235], v[164:167]
    buffer_load_dwordx2 v[214:215], v215, s[4:7], s21 offen offset:768
    v_mfma_f32_16x16x32_bf16 v[164:167], v[244:247], v[236:239], v[164:167]
    ds_write_b64 v218, v[220:221] offset:7008
    v_mfma_f32_16x16x32_bf16 v[168:171], a[228:231], v[232:235], v[168:171]
    buffer_store_dwordx4 a[4:7], v254, s[12:15], s44 offen nt
    s_add_u32 s44, s40, 2048
    v_fmac_f32 v202, s29, v194
    v_mfma_f32_16x16x32_bf16 v[168:171], a[240:243], v[236:239], v[168:171]
    s_waitcnt lgkmcnt(1)
    v_fmac_f32 v252, s23, v250
    v_fmac_f32 v202, s23, v198
    v_mfma_f32_16x16x32_bf16 v[168:171], a[252:255], v[228:231], v[168:171]
    v_cvt_pk_bf16_f32 v202, v252, v202
    v_fma_f32 v252, v249, s24, v251
    v_mfma_f32_16x16x32_bf16 v[172:175], v[240:243], v[228:231], v[172:175]
    v_fmac_f32 v251, -4.0, v249
    v_fma_f32 v249, v248, s24, v250
    v_mfma_f32_16x16x32_bf16 v[172:175], a[244:247], v[236:239], v[172:175]
    v_fmac_f32 v250, -4.0, v248
    v_fma_f32 v248, v250, s26, v251
    v_mfma_f32_16x16x32_bf16 v[172:175], a[232:235], v[232:235], v[172:175]
    v_fmac_f32 v251, s27, v250
    v_fma_f32 v250, v249, 2.0, v252
    v_mfma_f32_16x16x32_bf16 v[176:179], a[236:239], v[232:235], v[176:179]
    ds_read_b128 v[232:235], v253 offset:38224
    v_fmac_f32 v252, -2.0, v249
    v_mfma_f32_16x16x32_bf16 v[176:179], a[248:251], v[236:239], v[176:179]
    v_fma_f32 v249, v196, s24, v200
    v_fmac_f32 v200, -4.0, v196
    v_mfma_f32_16x16x32_bf16 v[176:179], v[244:247], v[228:231], v[176:179]
    s_mov_b32 s42, 1216512
    v_fma_f32 v196, v194, s24, v198
    v_fmac_f32 v198, -4.0, v194
    v_mfma_f32_16x16x32_bf16 v[180:183], a[228:231], v[236:239], v[180:183]
    v_fma_f32 v194, v198, s26, v200
    v_fmac_f32 v200, s27, v198
    v_mfma_f32_16x16x32_bf16 v[184:187], a[232:235], v[236:239], v[184:187]
    ds_read_b128 a[20:23], v6 offset:17632
    v_fma_f32 v198, v196, 2.0, v249
    v_mfma_f32_16x16x32_bf16 v[188:191], a[236:239], v[236:239], v[188:191]
    ds_read_b128 v[236:239], v253 offset:26000
    v_fmac_f32 v249, -2.0, v196
    v_mfma_f32_16x16x32_bf16 v[188:191], a[248:251], v[228:231], v[188:191]
    buffer_load_dwordx4 a[228:231], v254, s[8:11], s42 offen offset:0 sc1
    v_mfma_f32_16x16x32_bf16 v[184:187], a[244:247], v[228:231], v[184:187]
    s_waitcnt lgkmcnt(2)
    v_cvt_pk_bf16_f32 v194, v248, v194
    v_cvt_pk_bf16_f32 v200, v251, v200
    v_mfma_f32_16x16x32_bf16 v[180:183], a[240:243], v[228:231], v[180:183]
    ds_read_b128 v[228:231], v253 offset:25728
    v_cvt_pk_bf16_f32 v198, v250, v198
    v_mfma_f32_16x16x32_bf16 v[180:183], a[252:255], v[232:235], v[180:183]
    buffer_load_dwordx4 a[232:235], v254, s[8:11], s42 offen offset:1024 sc1
    v_mfma_f32_16x16x32_bf16 v[184:187], v[240:243], v[232:235], v[184:187]
    s_waitcnt vmcnt(17) lgkmcnt(1)
    v_cvt_pk_bf16_f32 v196, v252, v249
    v_lshlrev_b32 v248, 16, v195
    v_mfma_f32_16x16x32_bf16 v[188:191], v[244:247], v[232:235], v[188:191]
    ds_read_b128 v[232:235], v253 offset:25472
    v_lshlrev_b32 v249, 16, v197
sub32:
    v_mfma_f32_16x16x32_bf16 v[96:99], a[192:195], v[236:239], v[96:99]
    buffer_load_dwordx4 a[236:239], v254, s[8:11], s42 offen offset:2048 sc1
    v_mfma_f32_16x16x32_bf16 v[100:103], a[196:199], v[236:239], v[100:103]
    s_mov_b32 s42, 1219584
    v_lshlrev_b32 v250, 16, v199
    v_lshlrev_b32 v251, 16, v201
    v_mfma_f32_16x16x32_bf16 v[104:107], a[200:203], v[236:239], v[104:107]
pad12:
    s_cbranch_vccnz warm_ret
    ds_read_b128 v[236:239], v253 offset:25216
    s_waitcnt vmcnt(14)
    s_waitcnt lgkmcnt(2)
    v_mfma_f32_16x16x32_bf16 v[104:107], a[212:215], v[228:231], v[104:107]
    v_and_b32 v195, s22, v195
    v_and_b32 v197, s22, v197
    v_mfma_f32_16x16x32_bf16 v[100:103], a[208:211], v[228:231], v[100:103]
    buffer_load_dwordx4 a[240:243], v254, s[8:11], s42 offen offset:0 sc1
    v_mfma_f32_16x16x32_bf16 v[96:99], a[204:207], v[228:231], v[96:99]
    s_waitcnt vmcnt(12) lgkmcnt(1)
    v_and_b32 v199, s22, v199
    v_and_b32 v201, s22, v201
    v_mfma_f32_16x16x32_bf16 v[96:99], a[216:219], v[232:235], v[96:99]
    buffer_store_dwordx4 a[8:11], v254, s[12:15], s44 offen nt
    s_add_u32 s44, s40, 3072
    v_mfma_f32_16x16x32_bf16 v[100:103], a[220:223], v[232:235], v[100:103]
    ds_read_b128 a[24:27], v6 offset:18688
    v_lshlrev_b32 v252, 16, v193
    v_mfma_f32_16x16x32_bf16 v[104:107], a[224:227], v[232:235], v[104:107]
    buffer_load_dwordx4 a[244:247], v254, s[8:11], s42 offen offset:1024 sc1
    v_mfma_f32_16x16x32_bf16 v[108:111], a[192:195], v[228:231], v[108:111]
    v_and_b32 v193, s22, v193
    v_fmac_f32 v252, s25, v251
    v_mfma_f32_16x16x32_bf16 v[108:111], a[204:207], v[232:235], v[108:111]
    s_waitcnt lgkmcnt(1)
    v_fmac_f32 v193, s25, v201
    v_fmac_f32 v252, s28, v249
    v_mfma_f32_16x16x32_bf16 v[108:111], a[216:219], v[236:239], v[108:111]
    v_fmac_f32 v193, s28, v197
    v_cvt_pk_bf16_f32 v193, v252, v193
    v_mfma_f32_16x16x32_bf16 v[112:115], a[220:223], v[236:239], v[112:115]
    buffer_load_dwordx4 a[248:251], v254, s[8:11], s42 offen offset:2048 sc1
    v_mfma_f32_16x16x32_bf16 v[112:115], a[208:211], v[232:235], v[112:115]
    s_mov_b32 s42, 1222656
    v_lshlrev_b32 v252, 16, v203
    v_and_b32 v203, s22, v203
    v_mfma_f32_16x16x32_bf16 v[112:115], a[196:199], v[228:231], v[112:115]
    buffer_store_dwordx4 a[12:15], v254, s[12:15], s44 offen nt
    v_fmac_f32 v252, s29, v248
    v_fmac_f32 v203, s29, v195
    v_mfma_f32_16x16x32_bf16 v[116:119], a[200:203], v[228:231], v[116:119]
    ds_read_b128 v[228:231], v253 offset:24960
    v_fmac_f32 v252, s23, v250
    v_mfma_f32_16x16x32_bf16 v[116:119], a[212:215], v[232:235], v[116:119]
    buffer_load_dwordx4 a[252:255], v254, s[8:11], s42 offen offset:0 sc1
    v_mfma_f32_16x16x32_bf16 v[116:119], a[224:227], v[236:239], v[116:119]
    v_fmac_f32 v203, s23, v199
    v_cvt_pk_bf16_f32 v203, v252, v203
    v_mfma_f32_16x16x32_bf16 v[120:123], a[192:195], v[232:235], v[120:123]
    v_fma_f32 v252, v249, s24, v251
    v_fmac_f32 v251, -4.0, v249
    v_mfma_f32_16x16x32_bf16 v[120:123], a[204:207], v[236:239], v[120:123]
    s_waitcnt lgkmcnt(0)
    s_add_u32 s44, s40, 4096
    v_fma_f32 v249, v248, s24, v250
    v_mfma_f32_16x16x32_bf16 v[120:123], a[216:219], v[228:231], v[120:123]
    ds_read_b128 a[28:31], v6 offset:19712
    v_fmac_f32 v250, -4.0, v248
    v_mfma_f32_16x16x32_bf16 v[124:127], a[220:223], v[228:231], v[124:127]
    buffer_load_dwordx4 v[240:243], v254, s[8:11], s42 offen offset:1024 sc1
    v_mfma_f32_16x16x32_bf16 v[124:127], a[208:211], v[236:239], v[124:127]
    v_fma_f32 v248, v250, s26, v251
    v_fmac_f32 v251, s27, v250
    v_mfma_f32_16x16x32_bf16 v[124:127], a[196:199], v[232:235], v[124:127]
    v_fma_f32 v250, v249, 2.0, v252
    v_fmac_f32 v252, -2.0, v249
    v_mfma_f32_16x16x32_bf16 v[128:131], a[200:203], v[232:235], v[128:131]
    ds_read_b128 v[232:235], v253 offset:26784
    v_fma_f32 v249, v197, s24, v201
    v_mfma_f32_16x16x32_bf16 v[128:131], a[212:215], v[236:239], v[128:131]
    buffer_load_dwordx4 v[244:247], v254, s[8:11], s42 offen offset:2048 sc1
    v_mfma_f32_16x16x32_bf16 v[128:131], a[224:227], v[228:231], v[128:131]
    v_fmac_f32 v201, -4.0, v197
    v_fma_f32 v197, v195, s24, v199
    v_mfma_f32_16x16x32_bf16 v[132:135], a[192:195], v[236:239], v[132:135]
    v_and_b32 v227, 0x7fff, v255
    v_fmac_f32 v199, -4.0, v195
    v_mfma_f32_16x16x32_bf16 v[132:135], a[204:207], v[228:231], v[132:135]
    s_waitcnt lgkmcnt(0)
    v_fma_f32 v195, v199, s26, v201
    v_fmac_f32 v201, s27, v199
    v_mfma_f32_16x16x32_bf16 v[132:135], a[216:219], v[232:235], v[132:135]
    buffer_load_dwordx2 v[216:217], v227, s[4:7], s16 offen offset:1152
    v_mfma_f32_16x16x32_bf16 v[136:139], a[220:223], v[232:235], v[136:139]
    v_fma_f32 v199, v197, 2.0, v249
    v_fmac_f32 v249, -2.0, v197
    v_mfma_f32_16x16x32_bf16 v[136:139], a[208:211], v[228:231], v[136:139]
    v_cvt_pk_bf16_f32 v195, v248, v195
    v_cvt_pk_bf16_f32 v201, v251, v201
    v_mfma_f32_16x16x32_bf16 v[136:139], a[196:199], v[236:239], v[136:139]
    v_cvt_pk_bf16_f32 v199, v250, v199
    v_cvt_pk_bf16_f32 v197, v252, v249
    v_mfma_f32_16x16x32_bf16 v[140:143], a[200:203], v[236:239], v[140:143]
    ds_read_b128 v[236:239], v253 offset:26528
    v_lshrrev_b32 v252, 15, v255
    v_mfma_f32_16x16x32_bf16 v[140:143], a[212:215], v[228:231], v[140:143]
    buffer_load_dwordx2 v[218:219], v227, s[4:7], s17 offen offset:1152
    v_mfma_f32_16x16x32_bf16 v[140:143], a[224:227], v[232:235], v[140:143]
    ds_read_b128 a[32:35], v6 offset:20736
    v_mfma_f32_16x16x32_bf16 v[144:147], a[192:195], v[228:231], v[144:147]
    ds_write_b64 v252, v[194:195] offset:512
    v_mfma_f32_16x16x32_bf16 v[144:147], a[204:207], v[232:235], v[144:147]
    s_waitcnt lgkmcnt(2)
    v_lshrrev_b32 v194, 15, v255
    s_waitcnt vmcnt(14)
    v_mfma_f32_16x16x32_bf16 v[144:147], a[216:219], v[236:239], v[144:147]
    buffer_load_dwordx2 v[220:221], v227, s[4:7], s18 offen offset:1152
    v_mfma_f32_16x16x32_bf16 v[148:151], a[220:223], v[236:239], v[148:151]
    ds_write_b64 v194, v[200:201] offset:2592
    v_mfma_f32_16x16x32_bf16 v[148:151], a[208:211], v[232:235], v[148:151]
    v_lshlrev_b32 v248, 16, v206
    v_lshlrev_b32 v249, 16, v208
    v_mfma_f32_16x16x32_bf16 v[148:151], a[196:199], v[228:231], v[148:151]
    ds_write_b64 v194, v[198:199] offset:4672
    v_mfma_f32_16x16x32_bf16 v[152:155], a[200:203], v[228:231], v[152:155]
    ds_read_b128 v[228:231], v253 offset:26272
    v_lshlrev_b32 v250, 16, v210
    v_mfma_f32_16x16x32_bf16 v[152:155], a[212:215], v[232:235], v[152:155]
    buffer_load_dwordx2 v[222:223], v227, s[4:7], s19 offen offset:1152
    v_mfma_f32_16x16x32_bf16 v[152:155], a[224:227], v[236:239], v[152:155]
    ds_write_b64 v194, v[192:193] offset:33792
    v_mfma_f32_16x16x32_bf16 v[156:159], a[192:195], v[232:235], v[156:159]
    v_lshlrev_b32 v251, 16, v212
    v_and_b32 v206, s22, v206
    v_mfma_f32_16x16x32_bf16 v[156:159], a[204:207], v[236:239], v[156:159]
    s_waitcnt lgkmcnt(1)
    v_and_b32 v208, s22, v208
    v_and_b32 v210, s22, v210
    v_mfma_f32_16x16x32_bf16 v[156:159], a[216:219], v[228:231], v[156:159]
    buffer_load_dwordx2 v[224:225], v227, s[4:7], s20 offen offset:1152
    v_mfma_f32_16x16x32_bf16 v[160:163], a[220:223], v[228:231], v[160:163]
    ds_read_b128 a[36:39], v6 offset:21792
    v_and_b32 v212, s22, v212
    v_mfma_f32_16x16x32_bf16 v[160:163], a[208:211], v[236:239], v[160:163]
    ds_write_b64 v194, v[202:203] offset:35872
    v_mfma_f32_16x16x32_bf16 v[160:163], a[196:199], v[232:235], v[160:163]
    v_lshlrev_b32 v252, 16, v204
    v_and_b32 v204, s22, v204
    v_mfma_f32_16x16x32_bf16 v[164:167], a[200:203], v[232:235], v[164:167]
    ds_read_b128 v[232:235], v253 offset:26016
    v_fmac_f32 v252, s25, v251
    v_mfma_f32_16x16x32_bf16 v[164:167], a[212:215], v[236:239], v[164:167]
    buffer_load_dwordx2 v[226:227], v227, s[4:7], s21 offen offset:1152
    v_mfma_f32_16x16x32_bf16 v[164:167], a[224:227], v[228:231], v[164:167]
    ds_write_b64 v194, v[196:197] offset:6752
    v_mfma_f32_16x16x32_bf16 v[168:171], a[192:195], v[236:239], v[168:171]
    buffer_store_dwordx4 a[16:19], v254, s[12:15], s44 offen nt
    s_add_u32 s44, s40, 5120
    v_mfma_f32_16x16x32_bf16 v[168:171], a[204:207], v[228:231], v[168:171]
    s_waitcnt lgkmcnt(1)
    v_fmac_f32 v204, s25, v212
    v_fmac_f32 v252, s28, v249
    v_mfma_f32_16x16x32_bf16 v[168:171], a[216:219], v[232:235], v[168:171]
    ds_read_b128 v[192:195], v253 offset:39520
    s_mov_b32 s45, 573637648
    v_mfma_f32_16x16x32_bf16 v[172:175], a[220:223], v[232:235], v[172:175]
    buffer_store_dwordx4 a[20:23], v254, s[12:15], s44 offen nt
    v_bfe_u32 v196, v254, 5, 3
    v_mul_u32_u24 v197, 5, v196
    v_mfma_f32_16x16x32_bf16 v[172:175], a[208:211], v[228:231], v[172:175]
    v_bfe_u32 v197, s45, v197, 5
    v_mul_u32_u24 v197, 65, v197
    v_mfma_f32_16x16x32_bf16 v[172:175], a[196:199], v[236:239], v[172:175]
    v_sub_u32 v197, v197, v196
    v_lshl_add_u32 v196, v197, 5, v253
    v_mfma_f32_16x16x32_bf16 v[176:179], a[200:203], v[236:239], v[176:179]
    ds_read_b128 v[236:239], v253 offset:25744
    s_waitcnt lgkmcnt(1)
    v_mfma_f32_16x16x32_bf16 v[176:179], a[212:215], v[228:231], v[176:179]
    s_add_u32 s44, s40, 6144
    v_fmac_f32 v204, s28, v208
    v_mfma_f32_16x16x32_bf16 v[176:179], a[224:227], v[232:235], v[176:179]
    s_mov_b32 s42, 1253376
    v_cvt_pk_bf16_f32 v204, v252, v204
    v_lshlrev_b32 v252, 16, v214
    v_mfma_f32_16x16x32_bf16 v[180:183], a[192:195], v[228:231], v[180:183]
    ds_read_b128 a[40:43], v6 offset:22816
    v_and_b32 v214, s22, v214
    v_mfma_f32_16x16x32_bf16 v[184:187], a[196:199], v[228:231], v[184:187]
    s_mov_b64 exec, s[46:47]
    ds_write_b128 v196, v[192:195] offset:1024
    s_mov_b64 exec, -1
    v_mfma_f32_16x16x32_bf16 v[188:191], a[200:203], v[228:231], v[188:191]
    ds_read_b128 v[228:231], v253 offset:28080
    v_fmac_f32 v252, s29, v248
    v_mfma_f32_16x16x32_bf16 v[188:191], a[212:215], v[232:235], v[188:191]
    buffer_load_dwordx4 a[96:99], v254, s[8:11], s42 offen offset:0 sc1
    v_mfma_f32_16x16x32_bf16 v[184:187], a[208:211], v[232:235], v[184:187]
    s_waitcnt lgkmcnt(3)
    v_fmac_f32 v214, s29, v206
    v_fmac_f32 v252, s23, v250
    v_mfma_f32_16x16x32_bf16 v[180:183], a[204:207], v[232:235], v[180:183]
    ds_read_b128 v[232:235], v253 offset:27808
    v_mfma_f32_16x16x32_bf16 v[180:183], a[216:219], v[236:239], v[180:183]
    buffer_load_dwordx4 a[100:103], v254, s[8:11], s42 offen offset:1024 sc1
    v_mfma_f32_16x16x32_bf16 v[184:187], a[220:223], v[236:239], v[184:187]
    s_waitcnt vmcnt(18) lgkmcnt(1)
    v_fmac_f32 v214, s23, v210
    v_cvt_pk_bf16_f32 v214, v252, v214
    v_mfma_f32_16x16x32_bf16 v[188:191], a[224:227], v[236:239], v[188:191]
    ds_read_b128 v[236:239], v253 offset:27552
    v_fma_f32 v252, v249, s24, v251
sub33:
    v_mfma_f32_16x16x32_bf16 v[96:99], a[228:231], v[228:231], v[96:99]
    buffer_load_dwordx4 a[104:107], v254, s[8:11], s42 offen offset:2048 sc1
    v_mfma_f32_16x16x32_bf16 v[100:103], a[232:235], v[228:231], v[100:103]
    s_mov_b32 s42, 1256448
    v_fmac_f32 v251, -4.0, v249
    v_fma_f32 v249, v248, s24, v250
    v_mfma_f32_16x16x32_bf16 v[104:107], a[236:239], v[228:231], v[104:107]
    ds_read_b128 v[228:231], v253 offset:27296
    s_waitcnt vmcnt(15)
    s_waitcnt lgkmcnt(2)
    v_mfma_f32_16x16x32_bf16 v[104:107], a[248:251], v[232:235], v[104:107]
    v_fmac_f32 v250, -4.0, v248
    v_fma_f32 v248, v250, s26, v251
    v_mfma_f32_16x16x32_bf16 v[100:103], a[244:247], v[232:235], v[100:103]
    buffer_load_dwordx4 a[108:111], v254, s[8:11], s42 offen offset:0 sc1
    v_mfma_f32_16x16x32_bf16 v[96:99], a[240:243], v[232:235], v[96:99]
    s_waitcnt vmcnt(12) lgkmcnt(1)
    v_fmac_f32 v251, s27, v250
    v_fma_f32 v250, v249, 2.0, v252
    v_mfma_f32_16x16x32_bf16 v[96:99], a[252:255], v[236:239], v[96:99]
    buffer_store_dwordx4 a[24:27], v254, s[12:15], s44 offen nt
    v_fmac_f32 v252, -2.0, v249
    v_fma_f32 v249, v208, s24, v212
    v_mfma_f32_16x16x32_bf16 v[100:103], v[240:243], v[236:239], v[100:103]
    ds_read_b128 a[44:47], v6 offset:23840
    v_fmac_f32 v212, -4.0, v208
    v_mfma_f32_16x16x32_bf16 v[104:107], v[244:247], v[236:239], v[104:107]
    buffer_load_dwordx4 a[112:115], v254, s[8:11], s42 offen offset:1024 sc1
    v_mfma_f32_16x16x32_bf16 v[108:111], a[228:231], v[232:235], v[108:111]
    s_add_u32 s44, s40, 7168
    v_fma_f32 v208, v206, s24, v210
    v_fmac_f32 v210, -4.0, v206
    v_mfma_f32_16x16x32_bf16 v[108:111], a[240:243], v[236:239], v[108:111]
    s_waitcnt lgkmcnt(1)
    v_fma_f32 v206, v210, s26, v212
    v_fmac_f32 v212, s27, v210
    v_mfma_f32_16x16x32_bf16 v[108:111], a[252:255], v[228:231], v[108:111]
    v_fma_f32 v210, v208, 2.0, v249
    v_fmac_f32 v249, -2.0, v208
    v_mfma_f32_16x16x32_bf16 v[112:115], v[240:243], v[228:231], v[112:115]
    buffer_load_dwordx4 a[116:119], v254, s[8:11], s42 offen offset:2048 sc1
    v_mfma_f32_16x16x32_bf16 v[112:115], a[244:247], v[236:239], v[112:115]
    s_mov_b32 s42, 1259520
    v_cvt_pk_bf16_f32 v206, v248, v206
    v_cvt_pk_bf16_f32 v212, v251, v212
    v_mfma_f32_16x16x32_bf16 v[112:115], a[232:235], v[232:235], v[112:115]
    v_cvt_pk_bf16_f32 v210, v250, v210
    v_cvt_pk_bf16_f32 v208, v252, v249
    v_mfma_f32_16x16x32_bf16 v[116:119], a[236:239], v[232:235], v[116:119]
    ds_read_b128 v[232:235], v253 offset:27040
    v_lshlrev_b32 v248, 16, v207
    v_mfma_f32_16x16x32_bf16 v[116:119], a[248:251], v[236:239], v[116:119]
    buffer_load_dwordx4 a[120:123], v254, s[8:11], s42 offen offset:0 sc1
    v_mfma_f32_16x16x32_bf16 v[116:119], v[244:247], v[228:231], v[116:119]
    v_lshlrev_b32 v249, 16, v209
    v_lshlrev_b32 v250, 16, v211
    v_mfma_f32_16x16x32_bf16 v[120:123], a[228:231], v[236:239], v[120:123]
    v_lshlrev_b32 v251, 16, v213
    v_and_b32 v207, s22, v207
    v_mfma_f32_16x16x32_bf16 v[120:123], a[240:243], v[228:231], v[120:123]
    s_waitcnt lgkmcnt(0)
    v_and_b32 v209, s22, v209
    v_and_b32 v211, s22, v211
    v_mfma_f32_16x16x32_bf16 v[120:123], a[252:255], v[232:235], v[120:123]
    v_and_b32 v213, s22, v213
    v_lshlrev_b32 v252, 16, v205
    v_mfma_f32_16x16x32_bf16 v[124:127], v[240:243], v[232:235], v[124:127]
    buffer_load_dwordx4 a[124:127], v254, s[8:11], s42 offen offset:1024 sc1
    v_mfma_f32_16x16x32_bf16 v[124:127], a[244:247], v[228:231], v[124:127]
    v_and_b32 v205, s22, v205
    v_fmac_f32 v252, s25, v251
    v_mfma_f32_16x16x32_bf16 v[124:127], a[232:235], v[236:239], v[124:127]
    v_fmac_f32 v205, s25, v213
    v_fmac_f32 v252, s28, v249
    v_mfma_f32_16x16x32_bf16 v[128:131], a[236:239], v[236:239], v[128:131]
    ds_read_b128 v[236:239], v253 offset:28864
    v_fmac_f32 v205, s28, v209
    v_mfma_f32_16x16x32_bf16 v[128:131], a[248:251], v[228:231], v[128:131]
    buffer_load_dwordx4 a[128:131], v254, s[8:11], s42 offen offset:2048 sc1
    v_mfma_f32_16x16x32_bf16 v[128:131], v[244:247], v[232:235], v[128:131]
    s_mov_b32 s42, 1290240
    v_cvt_pk_bf16_f32 v205, v252, v205
    v_lshlrev_b32 v252, 16, v215
    v_mfma_f32_16x16x32_bf16 v[132:135], a[228:231], v[228:231], v[132:135]
    ds_read_b128 a[48:51], v253 offset:30160
    v_and_b32 v215, s22, v215
    v_mfma_f32_16x16x32_bf16 v[132:135], a[240:243], v[232:235], v[132:135]
    s_waitcnt lgkmcnt(1)
    v_fmac_f32 v252, s29, v248
    v_fmac_f32 v215, s29, v207
    v_mfma_f32_16x16x32_bf16 v[132:135], a[252:255], v[236:239], v[132:135]
    buffer_load_dwordx4 a[132:135], v254, s[8:11], s42 offen offset:0 sc1
    v_mfma_f32_16x16x32_bf16 v[136:139], v[240:243], v[236:239], v[136:139]
    v_fmac_f32 v252, s23, v250
    v_fmac_f32 v215, s23, v211
    v_mfma_f32_16x16x32_bf16 v[136:139], a[244:247], v[232:235], v[136:139]
    ds_read_b128 a[64:67], v253 offset:32240
    v_cvt_pk_bf16_f32 v215, v252, v215
    v_mfma_f32_16x16x32_bf16 v[136:139], a[232:235], v[228:231], v[136:139]
    buffer_load_dwordx4 a[136:139], v254, s[8:11], s42 offen offset:1024 sc1
    v_mfma_f32_16x16x32_bf16 v[140:143], a[236:239], v[228:231], v[140:143]
    ds_read_b128 v[228:231], v253 offset:28608
    v_fma_f32 v252, v249, s24, v251
    v_mfma_f32_16x16x32_bf16 v[140:143], a[248:251], v[232:235], v[140:143]
    v_fmac_f32 v251, -4.0, v249
    v_fma_f32 v249, v248, s24, v250
    v_mfma_f32_16x16x32_bf16 v[140:143], v[244:247], v[236:239], v[140:143]
    ds_read_b128 a[52:55], v253 offset:29888
    v_fmac_f32 v250, -4.0, v248
    v_mfma_f32_16x16x32_bf16 v[144:147], a[228:231], v[232:235], v[144:147]
    buffer_load_dwordx4 a[140:143], v254, s[8:11], s42 offen offset:2048 sc1
    v_mfma_f32_16x16x32_bf16 v[144:147], a[240:243], v[236:239], v[144:147]
    s_mov_b32 s42, 1293312
    s_waitcnt lgkmcnt(1)
    v_fma_f32 v248, v250, s26, v251
    v_mfma_f32_16x16x32_bf16 v[144:147], a[252:255], v[228:231], v[144:147]
    v_fmac_f32 v251, s27, v250
    v_fma_f32 v250, v249, 2.0, v252
    v_mfma_f32_16x16x32_bf16 v[148:151], v[240:243], v[228:231], v[148:151]
    ds_read_b128 a[68:71], v253 offset:31968
    v_fmac_f32 v252, -2.0, v249
    v_mfma_f32_16x16x32_bf16 v[148:151], a[244:247], v[236:239], v[148:151]
    buffer_load_dwordx4 a[144:147], v254, s[8:11], s42 offen offset:0 sc1
    v_mfma_f32_16x16x32_bf16 v[148:151], a[232:235], v[232:235], v[148:151]
    v_fma_f32 v249, v209, s24, v213
    v_fmac_f32 v213, -4.0, v209
    v_mfma_f32_16x16x32_bf16 v[152:155], a[236:239], v[232:235], v[152:155]
    ds_read_b128 v[232:235], v253 offset:28352
    v_fma_f32 v209, v207, s24, v211
    v_mfma_f32_16x16x32_bf16 v[152:155], a[248:251], v[236:239], v[152:155]
    ds_read_b128 a[56:59], v253 offset:29632
    v_fmac_f32 v211, -4.0, v207
    v_mfma_f32_16x16x32_bf16 v[152:155], v[244:247], v[228:231], v[152:155]
    buffer_load_dwordx4 a[148:151], v254, s[8:11], s42 offen offset:1024 sc1
    v_mfma_f32_16x16x32_bf16 v[156:159], a[228:231], v[236:239], v[156:159]
    v_fma_f32 v207, v211, s26, v213
    v_fmac_f32 v213, s27, v211
    v_mfma_f32_16x16x32_bf16 v[156:159], a[240:243], v[228:231], v[156:159]
    s_waitcnt lgkmcnt(1)
    v_fma_f32 v211, v209, 2.0, v249
    v_fmac_f32 v249, -2.0, v209
    v_mfma_f32_16x16x32_bf16 v[156:159], a[252:255], v[232:235], v[156:159]
    ds_read_b128 a[72:75], v253 offset:31712
    v_cvt_pk_bf16_f32 v207, v248, v207
    v_mfma_f32_16x16x32_bf16 v[160:163], v[240:243], v[232:235], v[160:163]
    buffer_load_dwordx4 a[152:155], v254, s[8:11], s42 offen offset:2048 sc1
    v_mfma_f32_16x16x32_bf16 v[160:163], a[244:247], v[228:231], v[160:163]
    s_mov_b32 s42, 1296384
    v_cvt_pk_bf16_f32 v213, v251, v213
    v_cvt_pk_bf16_f32 v211, v250, v211
    v_mfma_f32_16x16x32_bf16 v[160:163], a[232:235], v[236:239], v[160:163]
    v_cvt_pk_bf16_f32 v209, v252, v249
    v_lshrrev_b32 v252, 15, v255
    v_mfma_f32_16x16x32_bf16 v[164:167], a[236:239], v[236:239], v[164:167]
    ds_read_b128 v[236:239], v253 offset:28096
    v_mfma_f32_16x16x32_bf16 v[164:167], a[248:251], v[228:231], v[164:167]
    buffer_load_dwordx4 a[156:159], v254, s[8:11], s42 offen offset:0 sc1
    v_mfma_f32_16x16x32_bf16 v[164:167], v[244:247], v[232:235], v[164:167]
    ds_read_b128 a[60:63], v253 offset:29376
    v_mfma_f32_16x16x32_bf16 v[168:171], a[228:231], v[228:231], v[168:171]
    buffer_store_dwordx4 a[28:31], v254, s[12:15], s44 offen nt
    s_add_u32 s44, s40, 8192
    v_mfma_f32_16x16x32_bf16 v[168:171], a[240:243], v[232:235], v[168:171]
    buffer_load_dwordx4 a[160:163], v254, s[8:11], s42 offen offset:1024 sc1
    s_waitcnt lgkmcnt(1)
    v_mfma_f32_16x16x32_bf16 v[168:171], a[252:255], v[236:239], v[168:171]
    ds_write_b64 v252, v[206:207] offset:256
    v_mfma_f32_16x16x32_bf16 v[172:175], v[240:243], v[236:239], v[172:175]
    ds_read_b128 a[76:79], v253 offset:31456
    v_lshrrev_b32 v206, 15, v255
    v_mfma_f32_16x16x32_bf16 v[172:175], a[244:247], v[232:235], v[172:175]
    ds_write_b64 v206, v[212:213] offset:2336
    s_waitcnt vmcnt(21)
    v_mfma_f32_16x16x32_bf16 v[172:175], a[232:235], v[228:231], v[172:175]
    buffer_load_dwordx4 a[164:167], v254, s[8:11], s42 offen offset:2048 sc1
    v_mfma_f32_16x16x32_bf16 v[176:179], a[236:239], v[228:231], v[176:179]
    ds_read_b128 v[228:231], v253 offset:27824
    v_lshlrev_b32 v248, 16, v218
    v_mfma_f32_16x16x32_bf16 v[176:179], a[248:251], v[232:235], v[176:179]
    buffer_store_dwordx4 a[32:35], v254, s[12:15], s44 offen nt
    s_add_u32 s44, s40, 9216
    v_mfma_f32_16x16x32_bf16 v[176:179], v[244:247], v[236:239], v[176:179]
    s_add_u32 s42, s36, 0
    v_lshlrev_b32 v249, 16, v220
    v_lshlrev_b32 v250, 16, v222
    v_mfma_f32_16x16x32_bf16 v[180:183], a[228:231], v[232:235], v[180:183]
    s_waitcnt lgkmcnt(0)
    v_lshlrev_b32 v251, 16, v224
    v_and_b32 v218, s22, v218
    v_and_b32 v220, s22, v220
    v_mfma_f32_16x16x32_bf16 v[184:187], a[232:235], v[232:235], v[184:187]
    s_barrier
    v_mfma_f32_16x16x32_bf16 v[188:191], a[236:239], v[232:235], v[188:191]
    ds_write_b64 v206, v[210:211] offset:4416
    v_mfma_f32_16x16x32_bf16 v[188:191], a[248:251], v[236:239], v[188:191]
    buffer_load_dwordx4 a[192:195], v254, s[8:11], s42 offen offset:0 sc1
    v_mfma_f32_16x16x32_bf16 v[184:187], a[244:247], v[236:239], v[184:187]
    ds_write_b64 v206, v[204:205] offset:33536
    v_mfma_f32_16x16x32_bf16 v[180:183], a[240:243], v[236:239], v[180:183]
    v_and_b32 v222, s22, v222
    v_and_b32 v224, s22, v224
    v_lshlrev_b32 v252, 16, v216
    v_mfma_f32_16x16x32_bf16 v[180:183], a[252:255], v[228:231], v[180:183]
    buffer_load_dwordx4 a[196:199], v254, s[8:11], s42 offen offset:1024 sc1
    v_mfma_f32_16x16x32_bf16 v[184:187], v[240:243], v[228:231], v[184:187]
    ds_write_b64 v206, v[214:215] offset:35616
    v_mfma_f32_16x16x32_bf16 v[188:191], v[244:247], v[228:231], v[188:191]
    s_waitcnt vmcnt(13)
    v_and_b32 v216, s22, v216
    v_fmac_f32 v252, s25, v251
sub34:
    v_mfma_f32_16x16x32_bf16 v[96:99], a[96:99], a[48:51], v[96:99]
    buffer_load_dwordx4 a[200:203], v254, s[8:11], s42 offen offset:2048 sc1
    v_mfma_f32_16x16x32_bf16 v[96:99], a[108:111], a[52:55], v[96:99]
    s_add_u32 s42, s36, 3072
    v_fmac_f32 v216, s25, v224
    v_fmac_f32 v252, s28, v249
    v_fmac_f32 v216, s28, v220
    v_mfma_f32_16x16x32_bf16 v[96:99], a[120:123], a[56:59], v[96:99]
    ds_write_b64 v206, v[208:209] offset:6496
    v_mfma_f32_16x16x32_bf16 v[100:103], a[124:127], a[56:59], v[100:103]
    v_cvt_pk_bf16_f32 v216, v252, v216
    v_lshlrev_b32 v252, 16, v226
    v_mfma_f32_16x16x32_bf16 v[100:103], a[112:115], a[52:55], v[100:103]
    buffer_load_dwordx4 a[204:207], v254, s[8:11], s42 offen offset:0 sc1
    v_mfma_f32_16x16x32_bf16 v[100:103], a[100:103], a[48:51], v[100:103]
    v_and_b32 v226, s22, v226
    v_fmac_f32 v252, s29, v248
    v_mfma_f32_16x16x32_bf16 v[104:107], a[104:107], a[48:51], v[104:107]
    ds_read_b128 a[48:51], v253 offset:29120
    v_fmac_f32 v226, s29, v218
    v_fmac_f32 v252, s23, v250
    v_mfma_f32_16x16x32_bf16 v[104:107], a[116:119], a[52:55], v[104:107]
    v_fmac_f32 v226, s23, v222
    v_cvt_pk_bf16_f32 v226, v252, v226
    v_mfma_f32_16x16x32_bf16 v[104:107], a[128:131], a[56:59], v[104:107]
    buffer_load_dwordx4 a[208:211], v254, s[8:11], s42 offen offset:1024 sc1
    v_mfma_f32_16x16x32_bf16 v[108:111], a[96:99], a[52:55], v[108:111]
    v_fma_f32 v252, v249, s24, v251
    v_fmac_f32 v251, -4.0, v249
    v_mfma_f32_16x16x32_bf16 v[108:111], a[108:111], a[56:59], v[108:111]
    v_fma_f32 v249, v248, s24, v250
    v_fmac_f32 v250, -4.0, v248
    v_mfma_f32_16x16x32_bf16 v[108:111], a[120:123], a[60:63], v[108:111]
    v_fma_f32 v248, v250, s26, v251
    v_fmac_f32 v251, s27, v250
    v_fma_f32 v250, v249, 2.0, v252
    v_mfma_f32_16x16x32_bf16 v[112:115], a[124:127], a[60:63], v[112:115]
    buffer_load_dwordx4 a[212:215], v254, s[8:11], s42 offen offset:2048 sc1
    v_mfma_f32_16x16x32_bf16 v[112:115], a[112:115], a[56:59], v[112:115]
    s_add_u32 s42, s36, 6144
    v_fmac_f32 v252, -2.0, v249
    v_fma_f32 v249, v220, s24, v224
    v_mfma_f32_16x16x32_bf16 v[112:115], a[100:103], a[52:55], v[112:115]
    buffer_store_dwordx4 a[36:39], v254, s[12:15], s44 offen nt
    s_add_u32 s44, s40, 10240
    v_mfma_f32_16x16x32_bf16 v[116:119], a[104:107], a[52:55], v[116:119]
    ds_read_b128 a[52:55], v253 offset:30944
    v_fmac_f32 v224, -4.0, v220
    v_mfma_f32_16x16x32_bf16 v[116:119], a[116:119], a[56:59], v[116:119]
    buffer_load_dwordx4 a[216:219], v254, s[8:11], s42 offen offset:0 sc1
    v_fma_f32 v220, v218, s24, v222
    v_mfma_f32_16x16x32_bf16 v[116:119], a[128:131], a[60:63], v[116:119]
    s_waitcnt vmcnt(16)
    v_fmac_f32 v222, -4.0, v218
    v_fma_f32 v218, v222, s26, v224
    v_mfma_f32_16x16x32_bf16 v[96:99], a[132:135], a[64:67], v[96:99]
    s_waitcnt vmcnt(13)
    v_fmac_f32 v224, s27, v222
    v_fma_f32 v222, v220, 2.0, v249
    v_mfma_f32_16x16x32_bf16 v[96:99], a[144:147], a[68:71], v[96:99]
    s_waitcnt vmcnt(9)
    v_fmac_f32 v249, -2.0, v220
    v_cvt_pk_bf16_f32 v218, v248, v218
    v_mfma_f32_16x16x32_bf16 v[96:99], a[156:159], a[72:75], v[96:99]
    v_cvt_pk_bf16_f32 v224, v251, v224
    v_cvt_pk_bf16_f32 v222, v250, v222
    v_mfma_f32_16x16x32_bf16 v[100:103], a[160:163], a[72:75], v[100:103]
    buffer_load_dwordx4 a[220:223], v254, s[8:11], s42 offen offset:1024 sc1
    v_cvt_pk_bf16_f32 v220, v252, v249
    v_mfma_f32_16x16x32_bf16 v[100:103], a[148:151], a[68:71], v[100:103]
    v_lshlrev_b32 v248, 16, v219
    v_lshlrev_b32 v249, 16, v221
    v_mfma_f32_16x16x32_bf16 v[100:103], a[136:139], a[64:67], v[100:103]
    v_lshlrev_b32 v250, 16, v223
    v_lshlrev_b32 v251, 16, v225
    v_mfma_f32_16x16x32_bf16 v[104:107], a[140:143], a[64:67], v[104:107]
    ds_read_b128 a[64:67], v253 offset:31200
    v_and_b32 v219, s22, v219
    v_mfma_f32_16x16x32_bf16 v[104:107], a[152:155], a[68:71], v[104:107]
    buffer_load_dwordx4 a[224:227], v254, s[8:11], s42 offen offset:2048 sc1
    v_mfma_f32_16x16x32_bf16 v[104:107], a[164:167], a[72:75], v[104:107]
    v_and_b32 v221, s22, v221
    v_and_b32 v223, s22, v223
    v_and_b32 v225, s22, v225
    v_mfma_f32_16x16x32_bf16 v[108:111], a[132:135], a[68:71], v[108:111]
    buffer_store_dwordx4 a[40:43], v254, s[12:15], s44 offen nt
    v_and_b32 v203, 0x7fff, v255
    s_add_u32 s44, s40, 11264
    v_mfma_f32_16x16x32_bf16 v[108:111], a[144:147], a[72:75], v[108:111]
    v_lshlrev_b32 v252, 16, v217
    v_mfma_f32_16x16x32_bf16 v[108:111], a[156:159], a[76:79], v[108:111]
    buffer_load_dwordx2 v[192:193], v203, s[4:7], s16 offen offset:64
    v_mfma_f32_16x16x32_bf16 v[112:115], a[160:163], a[76:79], v[112:115]
    v_and_b32 v217, s22, v217
    v_fmac_f32 v252, s25, v251
    v_mfma_f32_16x16x32_bf16 v[112:115], a[148:151], a[72:75], v[112:115]
    v_cvt_pk_bf16_f32 v96, v96, v97
    v_cvt_pk_bf16_f32 v97, v98, v99
    v_fmac_f32 v217, s25, v225
    v_mfma_f32_16x16x32_bf16 v[112:115], a[136:139], a[68:71], v[112:115]
    v_cvt_pk_bf16_f32 v98, v100, v101
    v_cvt_pk_bf16_f32 v99, v102, v103
    v_mfma_f32_16x16x32_bf16 v[116:119], a[140:143], a[68:71], v[116:119]
    ds_read_b128 a[68:71], v253 offset:33024
    v_fmac_f32 v252, s28, v249
    v_mfma_f32_16x16x32_bf16 v[116:119], a[152:155], a[72:75], v[116:119]
    buffer_load_dwordx2 v[194:195], v203, s[4:7], s17 offen offset:64
    v_mfma_f32_16x16x32_bf16 v[116:119], a[164:167], a[76:79], v[116:119]
    ds_write_b128 v4, v[96:99] offset:16640
    v_mfma_f32_16x16x32_bf16 v[120:123], a[96:99], a[56:59], v[120:123]
    v_fmac_f32 v217, s28, v221
    v_cvt_pk_bf16_f32 v217, v252, v217
    v_lshlrev_b32 v252, 16, v227
    v_mfma_f32_16x16x32_bf16 v[120:123], a[108:111], a[60:63], v[120:123]
    s_waitcnt lgkmcnt(4)
    v_cvt_pk_bf16_f32 v104, v104, v105
    v_cvt_pk_bf16_f32 v105, v106, v107
    v_mfma_f32_16x16x32_bf16 v[120:123], a[120:123], a[48:51], v[120:123]
    buffer_load_dwordx2 v[196:197], v203, s[4:7], s18 offen offset:64
    v_mfma_f32_16x16x32_bf16 v[120:123], a[132:135], a[72:75], v[120:123]
    ds_write_b64 v5, v[104:105] offset:16704
    v_mfma_f32_16x16x32_bf16 v[120:123], a[144:147], a[76:79], v[120:123]
    s_waitcnt lgkmcnt(3)
    v_cvt_pk_bf16_f32 v108, v108, v109
    v_cvt_pk_bf16_f32 v109, v110, v111
    v_mfma_f32_16x16x32_bf16 v[120:123], a[156:159], a[64:67], v[120:123]
    v_cvt_pk_bf16_f32 v110, v112, v113
    v_cvt_pk_bf16_f32 v111, v114, v115
    v_and_b32 v227, s22, v227
    v_mfma_f32_16x16x32_bf16 v[124:127], a[160:163], a[64:67], v[124:127]
    buffer_load_dwordx2 v[198:199], v203, s[4:7], s19 offen offset:64
    v_mfma_f32_16x16x32_bf16 v[124:127], a[148:151], a[76:79], v[124:127]
    ds_write_b128 v4, v[108:111] offset:17024
    v_mfma_f32_16x16x32_bf16 v[124:127], a[136:139], a[72:75], v[124:127]
    v_fmac_f32 v252, s29, v248
    v_fmac_f32 v227, s29, v219
    v_mfma_f32_16x16x32_bf16 v[124:127], a[124:127], a[48:51], v[124:127]
    v_fmac_f32 v252, s23, v250
    v_fmac_f32 v227, s23, v223
    v_mfma_f32_16x16x32_bf16 v[124:127], a[112:115], a[60:63], v[124:127]
    buffer_load_dwordx2 v[200:201], v203, s[4:7], s20 offen offset:64
    v_cvt_pk_bf16_f32 v227, v252, v227
    v_mfma_f32_16x16x32_bf16 v[124:127], a[100:103], a[56:59], v[124:127]
    v_cvt_pk_bf16_f32 v116, v116, v117
    v_cvt_pk_bf16_f32 v117, v118, v119
    v_mfma_f32_16x16x32_bf16 v[128:131], a[104:107], a[56:59], v[128:131]
    ds_read_b128 a[56:59], v253 offset:30688
    v_fma_f32 v252, v249, s24, v251
    v_mfma_f32_16x16x32_bf16 v[128:131], a[116:119], a[60:63], v[128:131]
    ds_write_b64 v5, v[116:117] offset:17088
    v_mfma_f32_16x16x32_bf16 v[128:131], a[128:131], a[48:51], v[128:131]
    buffer_load_dwordx2 v[202:203], v203, s[4:7], s21 offen offset:64
    v_mfma_f32_16x16x32_bf16 v[128:131], a[140:143], a[72:75], v[128:131]
    ds_read_b128 a[72:75], v253 offset:32768
    v_fmac_f32 v251, -4.0, v249
    v_fma_f32 v249, v248, s24, v250
    v_mfma_f32_16x16x32_bf16 v[128:131], a[152:155], a[76:79], v[128:131]
    v_fmac_f32 v250, -4.0, v248
    v_fma_f32 v248, v250, s26, v251
    v_mfma_f32_16x16x32_bf16 v[128:131], a[164:167], a[64:67], v[128:131]
    v_fmac_f32 v251, s27, v250
    v_fma_f32 v250, v249, 2.0, v252
    v_mfma_f32_16x16x32_bf16 v[132:135], a[96:99], a[60:63], v[132:135]
    buffer_store_dwordx4 a[44:47], v254, s[12:15], s44 offen nt
    v_fmac_f32 v252, -2.0, v249
    v_fma_f32 v249, v221, s24, v225
    v_mfma_f32_16x16x32_bf16 v[132:135], a[108:111], a[48:51], v[132:135]
    v_cvt_pk_bf16_f32 v120, v120, v121
    v_cvt_pk_bf16_f32 v121, v122, v123
    v_mfma_f32_16x16x32_bf16 v[132:135], a[120:123], a[52:55], v[132:135]
    v_cvt_pk_bf16_f32 v122, v124, v125
    v_cvt_pk_bf16_f32 v123, v126, v127
    v_fmac_f32 v225, -4.0, v221
    v_mfma_f32_16x16x32_bf16 v[132:135], a[132:135], a[76:79], v[132:135]
    v_fma_f32 v221, v219, s24, v223
    v_fmac_f32 v223, -4.0, v219
    v_mfma_f32_16x16x32_bf16 v[132:135], a[144:147], a[64:67], v[132:135]
    s_waitcnt lgkmcnt(6)
    v_fma_f32 v219, v223, s26, v225
    v_fmac_f32 v225, s27, v223
    v_mfma_f32_16x16x32_bf16 v[132:135], a[156:159], a[68:71], v[132:135]
    ds_write_b128 v4, v[120:123] offset:17408
    v_mfma_f32_16x16x32_bf16 v[136:139], a[160:163], a[68:71], v[136:139]
    v_fma_f32 v223, v221, 2.0, v249
    v_fmac_f32 v249, -2.0, v221
    v_mfma_f32_16x16x32_bf16 v[136:139], a[148:151], a[64:67], v[136:139]
pad13:
    s_cbranch_vccnz warm_ret
    v_cvt_pk_bf16_f32 v128, v128, v129
    v_cvt_pk_bf16_f32 v129, v130, v131
    v_cvt_pk_bf16_f32 v219, v248, v219
    v_mfma_f32_16x16x32_bf16 v[136:139], a[136:139], a[76:79], v[136:139]
    s_add_u32 s42, s36, 36864
    v_cvt_pk_bf16_f32 v225, v251, v225
    v_cvt_pk_bf16_f32 v223, v250, v223
    v_mfma_f32_16x16x32_bf16 v[136:139], a[124:127], a[52:55], v[136:139]
    ds_write_b64 v5, v[128:129] offset:17472
    v_mfma_f32_16x16x32_bf16 v[136:139], a[112:115], a[48:51], v[136:139]
    v_cvt_pk_bf16_f32 v221, v252, v249
    v_lshrrev_b32 v252, 15, v255
    v_mfma_f32_16x16x32_bf16 v[136:139], a[100:103], a[60:63], v[136:139]
    ds_write_b64 v252, v[218:219] offset:0
    v_mfma_f32_16x16x32_bf16 v[140:143], a[104:107], a[60:63], v[140:143]
    buffer_load_dwordx4 a[228:231], v254, s[8:11], s42 offen offset:0 sc1
    v_mfma_f32_16x16x32_bf16 v[140:143], a[116:119], a[48:51], v[140:143]
    ds_read_b128 a[60:63], v253 offset:30432
    v_lshrrev_b32 v218, 15, v255
    v_mfma_f32_16x16x32_bf16 v[140:143], a[128:131], a[52:55], v[140:143]
    ds_write_b64 v218, v[224:225] offset:2080
    v_mfma_f32_16x16x32_bf16 v[140:143], a[140:143], a[76:79], v[140:143]
    buffer_load_dwordx4 a[232:235], v254, s[8:11], s42 offen offset:1024 sc1
    v_mfma_f32_16x16x32_bf16 v[140:143], a[152:155], a[64:67], v[140:143]
    ds_read_b128 a[76:79], v253 offset:32512
    v_mfma_f32_16x16x32_bf16 v[140:143], a[164:167], a[68:71], v[140:143]
    s_waitcnt lgkmcnt(6)
    s_add_u32 s44, s40, 589824
sub35:
    v_mfma_f32_16x16x32_bf16 v[144:147], a[96:99], a[48:51], v[144:147]
    buffer_load_dwordx4 a[236:239], v254, s[8:11], s42 offen offset:2048 sc1
    v_mfma_f32_16x16x32_bf16 v[144:147], a[108:111], a[52:55], v[144:147]
    s_add_u32 s42, s36, 39936
    v_mfma_f32_16x16x32_bf16 v[144:147], a[120:123], a[56:59], v[144:147]
    s_waitcnt lgkmcnt(0)
    v_mfma_f32_16x16x32_bf16 v[144:147], a[132:135], a[64:67], v[144:147]
    s_barrier
    v_mfma_f32_16x16x32_bf16 v[144:147], a[144:147], a[68:71], v[144:147]
    buffer_load_dwordx4 a[240:243], v254, s[8:11], s42 offen offset:0 sc1
    v_mfma_f32_16x16x32_bf16 v[144:147], a[156:159], a[72:75], v[144:147]
    v_cvt_pk_bf16_f32 v132, v132, v133
    v_cvt_pk_bf16_f32 v133, v134, v135
    v_mfma_f32_16x16x32_bf16 v[148:151], a[160:163], a[72:75], v[148:151]
    v_cvt_pk_bf16_f32 v134, v136, v137
    v_cvt_pk_bf16_f32 v135, v138, v139
    v_mfma_f32_16x16x32_bf16 v[148:151], a[148:151], a[68:71], v[148:151]
    ds_write_b128 v4, v[132:135] offset:17792
    v_mfma_f32_16x16x32_bf16 v[148:151], a[136:139], a[64:67], v[148:151]
    buffer_load_dwordx4 a[244:247], v254, s[8:11], s42 offen offset:1024 sc1
    v_mfma_f32_16x16x32_bf16 v[148:151], a[124:127], a[56:59], v[148:151]
    ds_read_b128 v[96:99], v6 offset:16640
    v_cvt_pk_bf16_f32 v140, v140, v141
    v_cvt_pk_bf16_f32 v141, v142, v143
    v_mfma_f32_16x16x32_bf16 v[148:151], a[112:115], a[52:55], v[148:151]
    ds_read_b128 v[100:103], v6 offset:19744
    v_mfma_f32_16x16x32_bf16 v[148:151], a[100:103], a[48:51], v[148:151]
    ds_write_b64 v5, v[140:141] offset:17856
    v_mfma_f32_16x16x32_bf16 v[152:155], a[104:107], a[48:51], v[152:155]
    buffer_load_dwordx4 a[248:251], v254, s[8:11], s42 offen offset:2048 sc1
    v_mfma_f32_16x16x32_bf16 v[152:155], a[116:119], a[52:55], v[152:155]
    s_add_u32 s42, s36, 43008
    v_mfma_f32_16x16x32_bf16 v[152:155], a[128:131], a[56:59], v[152:155]
    ds_read_b128 a[48:51], v253 offset:30176
    s_waitcnt lgkmcnt(3)
    v_mfma_f32_16x16x32_bf16 v[152:155], a[140:143], a[64:67], v[152:155]
    ds_read_b128 a[64:67], v253 offset:32256
    v_mfma_f32_16x16x32_bf16 v[152:155], a[152:155], a[68:71], v[152:155]
    buffer_load_dwordx4 a[252:255], v254, s[8:11], s42 offen offset:0 sc1
    v_mfma_f32_16x16x32_bf16 v[152:155], a[164:167], a[72:75], v[152:155]
    ds_read_b128 v[104:107], v6 offset:22848
    v_mfma_f32_16x16x32_bf16 v[156:159], a[96:99], a[52:55], v[156:159]
    buffer_store_dwordx4 v[96:99], v254, s[12:15], s44 offen nt
    s_add_u32 s44, s40, 592896
    s_waitcnt lgkmcnt(4)
    v_mfma_f32_16x16x32_bf16 v[156:159], a[108:111], a[56:59], v[156:159]
    v_cvt_pk_bf16_f32 v144, v144, v145
    v_cvt_pk_bf16_f32 v145, v146, v147
    v_mfma_f32_16x16x32_bf16 v[156:159], a[120:123], a[60:63], v[156:159]
    v_cvt_pk_bf16_f32 v146, v148, v149
    v_cvt_pk_bf16_f32 v147, v150, v151
    v_mfma_f32_16x16x32_bf16 v[156:159], a[132:135], a[68:71], v[156:159]
    buffer_load_dwordx4 v[240:243], v254, s[8:11], s42 offen offset:1024 sc1
    v_mfma_f32_16x16x32_bf16 v[156:159], a[144:147], a[72:75], v[156:159]
    v_mfma_f32_16x16x32_bf16 v[156:159], a[156:159], a[76:79], v[156:159]
    ds_write_b128 v4, v[144:147] offset:18176
    v_mfma_f32_16x16x32_bf16 v[160:163], a[160:163], a[76:79], v[160:163]
    ds_read_b128 v[108:111], v6 offset:25952
    v_mfma_f32_16x16x32_bf16 v[160:163], a[148:151], a[72:75], v[160:163]
    buffer_load_dwordx4 v[244:247], v254, s[8:11], s42 offen offset:2048 sc1
    v_mfma_f32_16x16x32_bf16 v[160:163], a[136:139], a[68:71], v[160:163]
    v_cvt_pk_bf16_f32 v152, v152, v153
    v_cvt_pk_bf16_f32 v153, v154, v155
    v_mfma_f32_16x16x32_bf16 v[160:163], a[124:127], a[60:63], v[160:163]
    buffer_store_dwordx4 v[100:103], v254, s[12:15], s44 offen nt
    v_and_b32 v215, 0x7fff, v255
    s_add_u32 s44, s40, 595968
    v_mfma_f32_16x16x32_bf16 v[160:163], a[112:115], a[56:59], v[160:163]
    buffer_load_dwordx2 v[204:205], v215, s[4:7], s16 offen offset:448
    v_mfma_f32_16x16x32_bf16 v[160:163], a[100:103], a[52:55], v[160:163]
    ds_write_b64 v5, v[152:153] offset:18240
    v_mfma_f32_16x16x32_bf16 v[164:167], a[104:107], a[52:55], v[164:167]
    ds_read_b128 a[52:55], v253 offset:29904
    s_waitcnt lgkmcnt(4)
    v_mfma_f32_16x16x32_bf16 v[164:167], a[116:119], a[56:59], v[164:167]
    ds_write_b64 v218, v[222:223] offset:4160
    v_mfma_f32_16x16x32_bf16 v[164:167], a[128:131], a[60:63], v[164:167]
    buffer_load_dwordx2 v[206:207], v215, s[4:7], s17 offen offset:448
    v_mfma_f32_16x16x32_bf16 v[164:167], a[140:143], a[68:71], v[164:167]
    ds_read_b128 a[68:71], v253 offset:31984
    v_mfma_f32_16x16x32_bf16 v[164:167], a[152:155], a[72:75], v[164:167]
    ds_write_b64 v218, v[216:217] offset:33280
    v_mfma_f32_16x16x32_bf16 v[164:167], a[164:167], a[76:79], v[164:167]
    v_mfma_f32_16x16x32_bf16 v[168:171], a[96:99], a[56:59], v[168:171]
    buffer_load_dwordx2 v[208:209], v215, s[4:7], s18 offen offset:448
    v_mfma_f32_16x16x32_bf16 v[168:171], a[108:111], a[60:63], v[168:171]
    v_cvt_pk_bf16_f32 v156, v156, v157
    v_cvt_pk_bf16_f32 v157, v158, v159
    v_mfma_f32_16x16x32_bf16 v[168:171], a[120:123], a[48:51], v[168:171]
    v_cvt_pk_bf16_f32 v158, v160, v161
    v_cvt_pk_bf16_f32 v159, v162, v163
    v_mfma_f32_16x16x32_bf16 v[168:171], a[132:135], a[72:75], v[168:171]
    ds_write_b128 v4, v[156:159] offset:18560
    v_mfma_f32_16x16x32_bf16 v[168:171], a[144:147], a[76:79], v[168:171]
    v_mfma_f32_16x16x32_bf16 v[168:171], a[156:159], a[64:67], v[168:171]
    buffer_load_dwordx2 v[210:211], v215, s[4:7], s19 offen offset:448
    v_mfma_f32_16x16x32_bf16 v[172:175], a[160:163], a[64:67], v[172:175]
    v_mfma_f32_16x16x32_bf16 v[172:175], a[148:151], a[76:79], v[172:175]
    v_cvt_pk_bf16_f32 v164, v164, v165
    v_cvt_pk_bf16_f32 v165, v166, v167
    v_mfma_f32_16x16x32_bf16 v[172:175], a[136:139], a[72:75], v[172:175]
    ds_write_b64 v5, v[164:165] offset:18624
    v_mfma_f32_16x16x32_bf16 v[172:175], a[124:127], a[48:51], v[172:175]
    buffer_load_dwordx2 v[212:213], v215, s[4:7], s20 offen offset:448
    v_mfma_f32_16x16x32_bf16 v[172:175], a[112:115], a[60:63], v[172:175]
    ds_write_b64 v218, v[226:227] offset:35360
    v_mfma_f32_16x16x32_bf16 v[172:175], a[100:103], a[56:59], v[172:175]
    v_mfma_f32_16x16x32_bf16 v[176:179], a[104:107], a[56:59], v[176:179]
    ds_write_b64 v218, v[220:221] offset:6240
    v_mfma_f32_16x16x32_bf16 v[176:179], a[116:119], a[60:63], v[176:179]
    buffer_load_dwordx2 v[214:215], v215, s[4:7], s21 offen offset:448
    v_mfma_f32_16x16x32_bf16 v[176:179], a[128:131], a[48:51], v[176:179]
    s_waitcnt lgkmcnt(0)
    v_mfma_f32_16x16x32_bf16 v[176:179], a[140:143], a[72:75], v[176:179]
    s_barrier
    v_mfma_f32_16x16x32_bf16 v[176:179], a[152:155], a[76:79], v[176:179]
    ds_read_b128 v[228:231], v253 offset:1040
    v_mfma_f32_16x16x32_bf16 v[176:179], a[164:167], a[64:67], v[176:179]
    ds_read_b128 v[232:235], v253 offset:768
    v_mfma_f32_16x16x32_bf16 v[180:183], a[96:99], a[60:63], v[180:183]
    ds_read_b128 v[236:239], v253 offset:512
    v_mfma_f32_16x16x32_bf16 v[180:183], a[108:111], a[48:51], v[180:183]
    v_cvt_pk_bf16_f32 v168, v168, v169
    v_cvt_pk_bf16_f32 v169, v170, v171
    v_mfma_f32_16x16x32_bf16 v[180:183], a[120:123], a[52:55], v[180:183]
    buffer_store_dwordx4 v[104:107], v254, s[12:15], s44 offen nt
    v_cvt_pk_bf16_f32 v170, v172, v173
    v_cvt_pk_bf16_f32 v171, v174, v175
    v_mfma_f32_16x16x32_bf16 v[180:183], a[132:135], a[76:79], v[180:183]
    ds_write_b128 v4, v[168:171] offset:18944
    v_mfma_f32_16x16x32_bf16 v[180:183], a[144:147], a[64:67], v[180:183]
    s_add_u32 s44, s40, 599040
    v_mfma_f32_16x16x32_bf16 v[180:183], a[156:159], a[68:71], v[180:183]
    ds_read_b128 v[112:115], v6 offset:17664
    v_mfma_f32_16x16x32_bf16 v[184:187], a[160:163], a[68:71], v[184:187]
    ds_read_b128 v[116:119], v6 offset:20768
    v_mfma_f32_16x16x32_bf16 v[184:187], a[148:151], a[64:67], v[184:187]
    buffer_store_dwordx4 v[108:111], v254, s[12:15], s44 offen nt
    v_cvt_pk_bf16_f32 v176, v176, v177
    v_cvt_pk_bf16_f32 v177, v178, v179
    v_mfma_f32_16x16x32_bf16 v[184:187], a[136:139], a[76:79], v[184:187]
    ds_write_b64 v5, v[176:177] offset:19008
    v_mfma_f32_16x16x32_bf16 v[184:187], a[124:127], a[52:55], v[184:187]
    ds_read_b128 v[120:123], v6 offset:23872
    s_add_u32 s44, s40, 590848
    v_mfma_f32_16x16x32_bf16 v[184:187], a[112:115], a[48:51], v[184:187]
    ds_read_b128 v[124:127], v6 offset:26976
    s_waitcnt lgkmcnt(4)
    v_mfma_f32_16x16x32_bf16 v[184:187], a[100:103], a[60:63], v[184:187]
    buffer_store_dwordx4 v[112:115], v254, s[12:15], s44 offen nt
    s_add_u32 s44, s40, 593920
    s_waitcnt lgkmcnt(3)
    v_mfma_f32_16x16x32_bf16 v[188:191], a[104:107], a[60:63], v[188:191]
    v_mfma_f32_16x16x32_bf16 v[188:191], a[116:119], a[48:51], v[188:191]
    buffer_store_dwordx4 v[116:119], v254, s[12:15], s44 offen nt
    s_add_u32 s44, s40, 596992
    v_mfma_f32_16x16x32_bf16 v[188:191], a[128:131], a[52:55], v[188:191]
    s_waitcnt lgkmcnt(1)
    v_mfma_f32_16x16x32_bf16 v[188:191], a[140:143], a[76:79], v[188:191]
    buffer_store_dwordx4 v[120:123], v254, s[12:15], s44 offen nt
    v_mfma_f32_16x16x32_bf16 v[188:191], a[152:155], a[64:67], v[188:191]
    v_mfma_f32_16x16x32_bf16 v[188:191], a[164:167], a[68:71], v[188:191]
    s_waitcnt vmcnt(37)
    s_add_u32 s41, s40, 589824
    s_add_u32 s40, s40, 6291456
    s_add_u32 s39, s39, 1
    s_cmp_lt_u32 s39, 2
    s_cbranch_scc1 blk_loop
    s_add_u32 s44, s41, 10240
    s_waitcnt lgkmcnt(0)
    buffer_store_dwordx4 v[124:127], v254, s[12:15], s44 offen nt
    v_cvt_pk_bf16_f32 v180, v180, v181
    v_cvt_pk_bf16_f32 v181, v182, v183
    v_cvt_pk_bf16_f32 v182, v184, v185
    v_cvt_pk_bf16_f32 v183, v186, v187
    ds_write_b128 v4, v[180:183] offset:19328
    v_cvt_pk_bf16_f32 v188, v188, v189
    v_cvt_pk_bf16_f32 v189, v190, v191
    ds_write_b64 v5, v[188:189] offset:19392
    s_waitcnt lgkmcnt(0)
    s_barrier
    ds_read_b128 v[32:35], v6 offset:18688
    ds_read_b128 v[36:39], v6 offset:21792
    ds_read_b128 v[40:43], v6 offset:24896
    ds_read_b128 v[44:47], v6 offset:28000
    s_add_u32 s44, s41, 2048
    s_waitcnt lgkmcnt(3)
    buffer_store_dwordx4 v[32:35], v254, s[12:15], s44 offen nt
    s_add_u32 s44, s41, 5120
    s_waitcnt lgkmcnt(2)
    buffer_store_dwordx4 v[36:39], v254, s[12:15], s44 offen nt
    s_add_u32 s44, s41, 8192
    s_waitcnt lgkmcnt(1)
    buffer_store_dwordx4 v[40:43], v254, s[12:15], s44 offen nt
    s_add_u32 s44, s41, 11264
    s_waitcnt lgkmcnt(0)
    buffer_store_dwordx4 v[44:47], v254, s[12:15], s44 offen nt
main_done:
    s_endpgm
code_end:
wt_loop:
    s_mul_i32 s73, s70, 43691
    s_lshr_b32 s73, s73, 17
    s_mul_i32 s74, s73, 3
    s_sub_u32 s74, s70, s74
    s_mul_i32 s75, s73, 43691
    s_lshr_b32 s75, s75, 17
    s_mul_i32 s76, s75, 3
    s_sub_u32 s76, s73, s76
    v_and_b32 v101, 14, v2
    v_lshrrev_b32 v102, 4, v2
    v_and_b32 v103, 12, v101
    v_and_b32 v105, 1, v2
    s_lshl_b32 s78, s74, 2
    s_cmp_lt_u32 s74, 2
    s_cselect_b32 s77, 1, 0
    s_cselect_b32 s78, s78, 32
    v_mul_u32_u24 v103, s77, v103
    v_add_u32 v103, v103, v101
    v_add_u32 v103, s78, v103
    v_lshl_add_u32 v103, v103, 1, s52
    v_lshl_add_u32 v102, v102, 1, v105
    v_mul_u32_u24 v104, 1536, v102
    v_add_u32 v103, v103, v104
    s_mul_i32 s79, s76, 73728
    s_mul_i32 s80, s75, 12288
    s_add_u32 s79, s79, s80
    s_add_u32 s80, s79, 221184
    s_add_u32 s81, s79, 442368
    buffer_load_dword v136, v103, s[60:63], s79 offen offset:0
    buffer_load_dword v137, v103, s[60:63], s79 offen offset:384
    buffer_load_dword v138, v103, s[60:63], s79 offen offset:768
    buffer_load_dword v139, v103, s[60:63], s79 offen offset:1152
    buffer_load_dword v140, v103, s[60:63], s80 offen offset:0
    buffer_load_dword v141, v103, s[60:63], s80 offen offset:384
    buffer_load_dword v142, v103, s[60:63], s80 offen offset:768
    buffer_load_dword v143, v103, s[60:63], s80 offen offset:1152
    buffer_load_dword v144, v103, s[60:63], s81 offen offset:0
    buffer_load_dword v145, v103, s[60:63], s81 offen offset:384
    buffer_load_dword v146, v103, s[60:63], s81 offen offset:768
    buffer_load_dword v147, v103, s[60:63], s81 offen offset:1152
    v_mul_u32_u24 v106, 0x0202, v105
    v_sub_u32 v106, 0x0504, v106
    v_mul_u32_u24 v107, 0x0606, v105
    v_add_u32 v107, 0x0100, v107
    v_mov_b32 v108, 0x0c0c
    v_lshl_or_b32 v106, v106, 16, v108
    v_lshl_or_b32 v107, v107, 16, v108
    s_mul_i32 s82, s76, 3072
    s_lshl_b32 s83, s74, 10
    s_add_u32 s82, s82, s83
    s_mul_i32 s83, s75, 36864
    s_lshl_b32 s84, s83, 2
    s_add_u32 s83, s83, s82
    s_add_u32 s84, s84, s82
    s_waitcnt vmcnt(0)
    v_mov_b32_dpp v152, v136 quad_perm:[1,0,3,2] row_mask:0xf bank_mask:0xf
    v_mov_b32_dpp v153, v137 quad_perm:[1,0,3,2] row_mask:0xf bank_mask:0xf
    v_mov_b32_dpp v154, v138 quad_perm:[1,0,3,2] row_mask:0xf bank_mask:0xf
    v_mov_b32_dpp v155, v139 quad_perm:[1,0,3,2] row_mask:0xf bank_mask:0xf
    v_mov_b32_dpp v156, v140 quad_perm:[1,0,3,2] row_mask:0xf bank_mask:0xf
    v_mov_b32_dpp v157, v141 quad_perm:[1,0,3,2] row_mask:0xf bank_mask:0xf
    v_mov_b32_dpp v158, v142 quad_perm:[1,0,3,2] row_mask:0xf bank_mask:0xf
    v_mov_b32_dpp v159, v143 quad_perm:[1,0,3,2] row_mask:0xf bank_mask:0xf
    v_mov_b32_dpp v160, v144 quad_perm:[1,0,3,2] row_mask:0xf bank_mask:0xf
    v_mov_b32_dpp v161, v145 quad_perm:[1,0,3,2] row_mask:0xf bank_mask:0xf
    v_mov_b32_dpp v162, v146 quad_perm:[1,0,3,2] row_mask:0xf bank_mask:0xf
    v_mov_b32_dpp v163, v147 quad_perm:[1,0,3,2] row_mask:0xf bank_mask:0xf
    v_perm_b32 v110, v136, v152, v106
    v_perm_b32 v114, v136, v152, v107
    v_perm_b32 v111, v137, v153, v106
    v_perm_b32 v115, v137, v153, v107
    v_perm_b32 v112, v138, v154, v106
    v_perm_b32 v116, v138, v154, v107
    v_perm_b32 v113, v139, v155, v106
    v_perm_b32 v117, v139, v155, v107
    v_perm_b32 v118, v140, v156, v106
    v_perm_b32 v122, v140, v156, v107
    v_perm_b32 v119, v141, v157, v106
    v_perm_b32 v123, v141, v157, v107
    v_perm_b32 v120, v142, v158, v106
    v_perm_b32 v124, v142, v158, v107
    v_perm_b32 v121, v143, v159, v106
    v_perm_b32 v125, v143, v159, v107
    v_perm_b32 v126, v144, v160, v106
    v_perm_b32 v130, v144, v160, v107
    v_perm_b32 v127, v145, v161, v106
    v_perm_b32 v131, v145, v161, v107
    v_perm_b32 v128, v146, v162, v106
    v_perm_b32 v132, v146, v162, v107
    v_perm_b32 v129, v147, v163, v106
    v_perm_b32 v133, v147, v163, v107
    v_mul_f32 v136, 0xbedba55c, v110
    v_fmac_f32 v136, 0xbe0afea5, v126
    v_fmamk_f32 v144, v118, 0xbe771a08, v136
    v_fmac_f32 v136, 0x3e771a08, v118
    v_mul_f32 v137, 0xbedba55c, v111
    v_fmac_f32 v137, 0xbe0afea5, v127
    v_fmamk_f32 v145, v119, 0xbe771a08, v137
    v_fmac_f32 v137, 0x3e771a08, v119
    v_mul_f32 v138, 0xbedba55c, v112
    v_fmac_f32 v138, 0xbe0afea5, v128
    v_fmamk_f32 v146, v120, 0xbe771a08, v138
    v_fmac_f32 v138, 0x3e771a08, v120
    v_mul_f32 v139, 0xbedba55c, v113
    v_fmac_f32 v139, 0xbe0afea5, v129
    v_fmamk_f32 v147, v121, 0xbe771a08, v139
    v_fmac_f32 v139, 0x3e771a08, v121
    v_mul_f32 v140, 0xbedba55c, v114
    v_fmac_f32 v140, 0xbe0afea5, v130
    v_fmamk_f32 v148, v122, 0xbe771a08, v140
    v_fmac_f32 v140, 0x3e771a08, v122
    v_mul_f32 v141, 0xbedba55c, v115
    v_fmac_f32 v141, 0xbe0afea5, v131
    v_fmamk_f32 v149, v123, 0xbe771a08, v141
    v_fmac_f32 v141, 0x3e771a08, v123
    v_mul_f32 v142, 0xbedba55c, v116
    v_fmac_f32 v142, 0xbe0afea5, v132
    v_fmamk_f32 v150, v124, 0xbe771a08, v142
    v_fmac_f32 v142, 0x3e771a08, v124
    v_mul_f32 v143, 0xbedba55c, v117
    v_fmac_f32 v143, 0xbe0afea5, v133
    v_fmamk_f32 v151, v125, 0xbe771a08, v143
    v_fmac_f32 v143, 0x3e771a08, v125
    v_cvt_pk_bf16_f32 v156, v144, v145
    v_cvt_pk_bf16_f32 v157, v146, v147
    v_cvt_pk_bf16_f32 v158, v148, v149
    v_cvt_pk_bf16_f32 v159, v150, v151
    s_add_u32 s85, s84, 0
    buffer_store_dwordx4 v[156:159], v254, s[8:11], s85 offen sc1
    v_cvt_pk_bf16_f32 v160, v136, v137
    v_cvt_pk_bf16_f32 v161, v138, v139
    v_cvt_pk_bf16_f32 v162, v140, v141
    v_cvt_pk_bf16_f32 v163, v142, v143
    s_add_u32 s85, s84, 36864
    buffer_store_dwordx4 v[160:163], v254, s[8:11], s85 offen sc1
    v_mul_f32 v136, 0x3e0afea5, v110
    v_fmac_f32 v136, 0x3f0afea5, v126
    v_fmamk_f32 v144, v118, 0x3e8afea5, v136
    v_fmac_f32 v136, 0xbe8afea5, v118
    v_mul_f32 v137, 0x3e0afea5, v111
    v_fmac_f32 v137, 0x3f0afea5, v127
    v_fmamk_f32 v145, v119, 0x3e8afea5, v137
    v_fmac_f32 v137, 0xbe8afea5, v119
    v_mul_f32 v138, 0x3e0afea5, v112
    v_fmac_f32 v138, 0x3f0afea5, v128
    v_fmamk_f32 v146, v120, 0x3e8afea5, v138
    v_fmac_f32 v138, 0xbe8afea5, v120
    v_mul_f32 v139, 0x3e0afea5, v113
    v_fmac_f32 v139, 0x3f0afea5, v129
    v_fmamk_f32 v147, v121, 0x3e8afea5, v139
    v_fmac_f32 v139, 0xbe8afea5, v121
    v_mul_f32 v140, 0x3e0afea5, v114
    v_fmac_f32 v140, 0x3f0afea5, v130
    v_fmamk_f32 v148, v122, 0x3e8afea5, v140
    v_fmac_f32 v140, 0xbe8afea5, v122
    v_mul_f32 v141, 0x3e0afea5, v115
    v_fmac_f32 v141, 0x3f0afea5, v131
    v_fmamk_f32 v149, v123, 0x3e8afea5, v141
    v_fmac_f32 v141, 0xbe8afea5, v123
    v_mul_f32 v142, 0x3e0afea5, v116
    v_fmac_f32 v142, 0x3f0afea5, v132
    v_fmamk_f32 v150, v124, 0x3e8afea5, v142
    v_fmac_f32 v142, 0xbe8afea5, v124
    v_mul_f32 v143, 0x3e0afea5, v117
    v_fmac_f32 v143, 0x3f0afea5, v133
    v_fmamk_f32 v151, v125, 0x3e8afea5, v143
    v_fmac_f32 v143, 0xbe8afea5, v125
    v_cvt_pk_bf16_f32 v164, v144, v145
    v_cvt_pk_bf16_f32 v165, v146, v147
    v_cvt_pk_bf16_f32 v166, v148, v149
    v_cvt_pk_bf16_f32 v167, v150, v151
    s_add_u32 s85, s84, 73728
    buffer_store_dwordx4 v[164:167], v254, s[8:11], s85 offen sc1
    v_cvt_pk_bf16_f32 v168, v136, v137
    v_cvt_pk_bf16_f32 v169, v138, v139
    v_cvt_pk_bf16_f32 v170, v140, v141
    v_cvt_pk_bf16_f32 v171, v142, v143
    s_add_u32 s85, s84, 110592
    buffer_store_dwordx4 v[168:171], v254, s[8:11], s85 offen sc1
    v_cvt_pk_bf16_f32 v152, v110, v111
    v_cvt_pk_bf16_f32 v153, v112, v113
    v_cvt_pk_bf16_f32 v154, v114, v115
    v_cvt_pk_bf16_f32 v155, v116, v117
    s_add_u32 s85, s83, 884736
    buffer_store_dwordx4 v[152:155], v254, s[8:11], s85 offen sc1
    v_cvt_pk_bf16_f32 v172, v126, v127
    v_cvt_pk_bf16_f32 v173, v128, v129
    v_cvt_pk_bf16_f32 v174, v130, v131
    v_cvt_pk_bf16_f32 v175, v132, v133
    s_add_u32 s85, s83, 1105920
    buffer_store_dwordx4 v[172:175], v254, s[8:11], s85 offen sc1
    s_add_u32 s70, s70, 1
    s_cmp_lt_u32 s70, 54
    s_cbranch_scc1 wt_loop
    s_waitcnt vmcnt(0)
    s_branch u_ready
.section .rodata,"a"
.p2align 6
.amdhsa_kernel standalone__winograd__vision_kernel
  .amdhsa_next_free_vgpr 512
  .amdhsa_next_free_sgpr 102
  .amdhsa_accum_offset 256
  .amdhsa_group_segment_fixed_size 0
  .amdhsa_kernarg_size 40
  .amdhsa_user_sgpr_count 2
  .amdhsa_user_sgpr_kernarg_segment_ptr 1
  .amdhsa_system_sgpr_workgroup_id_x 1
  .amdhsa_ieee_mode 0
.end_amdhsa_kernel
```

```asm
; @launch grid=(256,1,1) block=(256,1,1) lds=163840
.amdgcn_target "amdgcn-amd-amdhsa--gfx950"
.text
.globl standalone__winograd__vision_kernel
.p2align 8
.type standalone__winograd__vision_kernel,@function
standalone__winograd__vision_kernel:
    s_cmp_ge_u32 s2, 256
    s_cbranch_scc1 main_done
    s_load_dwordx2 s[60:61], s[0:1], 8
    s_load_dwordx2 s[4:5], s[0:1], 0
    s_load_dwordx4 s[12:15], s[0:1], 16
    s_load_dwordx2 s[8:9], s[0:1], 32
    s_getpc_b64 s[92:93]
pcref:
    v_and_b32 v70, 3, v0
    v_lshrrev_b32 v71, 6, v0
    v_lshl_add_u32 v70, v70, 7, v71
    s_lshr_b32 s94, s2, 3
    s_lshl_b32 s94, s94, 2
    v_add_lshl_u32 v70, v70, s94, 7
    v_min_u32 v70, code_end-pcref-4, v70
    v_add_co_u32 v72, vcc, s92, v70
    v_mov_b32 v73, s93
    s_nop 0
    v_addc_co_u32 v73, vcc, 0, v73, vcc
    global_load_dword v76, v[72:73], off
    v_lshrrev_b32 v1, 6, v0
    v_and_b32 v2, 63, v0
    v_readfirstlane_b32 s38, v1
    s_mov_b32 s62, 663552
    s_mov_b32 s63, 0x20000
    s_mov_b32 s70, s2
    s_mul_i32 s52, s38, 96
    s_cmp_lt_u32 s2, 54
    s_cbranch_scc1 wl_far
wl_skip:
    v_lshlrev_b32 v254, 4, v2
    v_mov_b32 v98, 0
    v_bfe_u32 v3, v2, 2, 2
    v_lshrrev_b32 v4, 5, v2
    v_lshl_add_u32 v3, v4, 2, v3
    v_bfe_u32 v4, v2, 4, 1
    v_and_b32 v5, 3, v2
    v_lshl_add_u32 v4, v4, 2, v5
    v_mul_u32_u24 v5, 3072, v3
    v_lshl_add_u32 v255, v4, 3, v5
    s_lshr_b32 s44, s2, 3
    s_and_b32 s48, s44, 3
    s_lshr_b32 s44, s44, 2
    s_and_b32 s49, s2, 7
    s_lshl_b32 s49, s49, 4
    s_add_u32 s49, s49, s44
    s_and_b32 s90, s38, 1
    s_lshr_b32 s91, s38, 1
    s_mul_i32 s50, s90, 24576
    s_mul_i32 s45, s91, 1536
    s_add_u32 s50, s50, s45
    s_mul_i32 s101, s38, 196608
    s_sub_u32 s101, s101, s50
    s_mul_i32 s53, s48, 49152
    s_add_u32 s53, s53, s50
    s_mul_i32 s43, s49, 786432
    s_add_u32 s43, s43, s53
    s_cmp_ge_u32 s49, 128
    s_cselect_b32 s43, 2130706432, s43
    s_sub_u32 s16, s43, 196608
    s_cmp_eq_u32 s49, 0
    s_cselect_b32 s16, 2130706432, s16
    s_mov_b32 s17, s43
    s_add_u32 s18, s43, 196608
    s_add_u32 s19, s43, 393216
    s_add_u32 s20, s43, 589824
    s_add_u32 s21, s43, 786432
    s_add_u32 s100, s43, s101
    v_mov_b32 v80, v255
    s_mov_b32 s6, 100663296
    s_mov_b32 s7, 0x20000
    s_waitcnt lgkmcnt(0)
    s_and_b32 s5, s5, 0xffff
    s_cmp_lt_u32 s2, 54
    s_cbranch_scc1 wt_path
    buffer_load_dwordx2 v[8:9], v80, s[4:7], s16 offen offset:0
    buffer_load_dwordx2 v[10:11], v80, s[4:7], s17 offen offset:0
    buffer_load_dwordx2 v[12:13], v80, s[4:7], s18 offen offset:0
    buffer_load_dwordx2 v[14:15], v80, s[4:7], s19 offen offset:0
    buffer_load_dwordx2 v[16:17], v80, s[4:7], s20 offen offset:0
    buffer_load_dwordx2 v[18:19], v80, s[4:7], s21 offen offset:0
    buffer_load_dwordx2 v[20:21], v80, s[4:7], s16 offen offset:384
    buffer_load_dwordx2 v[22:23], v80, s[4:7], s17 offen offset:384
    buffer_load_dwordx2 v[24:25], v80, s[4:7], s18 offen offset:384
    buffer_load_dwordx2 v[26:27], v80, s[4:7], s19 offen offset:384
    buffer_load_dwordx2 v[28:29], v80, s[4:7], s20 offen offset:384
    buffer_load_dwordx2 v[30:31], v80, s[4:7], s21 offen offset:384
    s_and_b32 s61, s61, 0xffff
    s_mul_i32 s44, s38, 9216
    s_add_u32 s8, s8, s44
    s_addc_u32 s9, s9, 0
    s_and_b32 s9, s9, 0xffff
    s_mov_b32 s10, 1299456
    s_mov_b32 s11, 0x20000
    s_mov_b32 s64, s14
    s_and_b32 s65, s15, 0xffff
    s_mov_b32 s66, 256
    s_mov_b32 s67, 0x20000
    s_mov_b64 s[68:69], s[14:15]
    s_branch wt_join
wl_far:
    s_mul_i32 s73, s70, 43691
    s_lshr_b32 s73, s73, 17
    s_mul_i32 s74, s73, 3
    s_sub_u32 s74, s70, s74
    s_mul_i32 s75, s73, 43691
    s_lshr_b32 s75, s75, 17
    s_mul_i32 s76, s75, 3
    s_sub_u32 s76, s73, s76
    v_and_b32 v101, 14, v2
    v_lshrrev_b32 v102, 5, v2
    v_lshrrev_b32 v104, 3, v2
    v_and_or_b32 v102, v104, 2, v102
    v_and_b32 v103, 12, v101
    v_and_b32 v105, 1, v2
    s_lshl_b32 s78, s74, 2
    s_cmp_lt_u32 s74, 2
    s_cselect_b32 s77, 1, 0
    s_cselect_b32 s78, s78, 32
    v_mul_u32_u24 v103, s77, v103
    v_add_u32 v103, v103, v101
    v_add_u32 v103, s78, v103
    v_lshl_add_u32 v103, v103, 1, s52
    v_lshl_add_u32 v102, v102, 1, v105
    v_mul_u32_u24 v104, 1536, v102
    v_add_u32 v103, v103, v104
    s_mul_i32 s79, s76, 73728
    s_mul_i32 s80, s75, 12288
    s_add_u32 s79, s79, s80
    s_add_u32 s80, s79, 221184
    s_add_u32 s81, s79, 442368
    s_waitcnt lgkmcnt(0)
    s_and_b32 s61, s61, 0xffff
    buffer_load_dword v136, v103, s[60:63], s79 offen offset:0
    buffer_load_dword v137, v103, s[60:63], s79 offen offset:384
    buffer_load_dword v138, v103, s[60:63], s79 offen offset:768
    buffer_load_dword v139, v103, s[60:63], s79 offen offset:1152
    buffer_load_dword v140, v103, s[60:63], s80 offen offset:0
    buffer_load_dword v141, v103, s[60:63], s80 offen offset:384
    buffer_load_dword v142, v103, s[60:63], s80 offen offset:768
    buffer_load_dword v143, v103, s[60:63], s80 offen offset:1152
    buffer_load_dword v144, v103, s[60:63], s81 offen offset:0
    buffer_load_dword v145, v103, s[60:63], s81 offen offset:384
    buffer_load_dword v146, v103, s[60:63], s81 offen offset:768
    buffer_load_dword v147, v103, s[60:63], s81 offen offset:1152
    v_mul_u32_u24 v106, 0x0202, v105
    v_sub_u32 v106, 0x0504, v106
    v_mul_u32_u24 v107, 0x0606, v105
    v_add_u32 v107, 0x0100, v107
    v_mov_b32 v108, 0x0c0c
    v_lshl_or_b32 v106, v106, 16, v108
    v_lshl_or_b32 v107, v107, 16, v108
    s_mul_i32 s82, s76, 3072
    s_lshl_b32 s83, s74, 10
    s_add_u32 s82, s82, s83
    s_mul_i32 s83, s75, 36864
    s_lshl_b32 s84, s83, 2
    s_add_u32 s83, s83, s82
    s_add_u32 s84, s84, s82
    s_branch wl_skip
wt_path:
    s_and_b32 s61, s61, 0xffff
    s_mul_i32 s44, s38, 9216
    s_add_u32 s8, s8, s44
    s_addc_u32 s9, s9, 0
    s_and_b32 s9, s9, 0xffff
    s_mov_b32 s10, 1299456
    s_mov_b32 s11, 0x20000
    s_mov_b32 s64, s14
    s_and_b32 s65, s15, 0xffff
    s_mov_b32 s66, 256
    s_mov_b32 s67, 0x20000
    s_mov_b64 s[68:69], s[14:15]
    s_waitcnt vmcnt(0)
    v_mov_b32_dpp v152, v136 quad_perm:[1,0,3,2] row_mask:0xf bank_mask:0xf
    v_mov_b32_dpp v153, v137 quad_perm:[1,0,3,2] row_mask:0xf bank_mask:0xf
    v_mov_b32_dpp v154, v138 quad_perm:[1,0,3,2] row_mask:0xf bank_mask:0xf
    v_mov_b32_dpp v155, v139 quad_perm:[1,0,3,2] row_mask:0xf bank_mask:0xf
    v_mov_b32_dpp v156, v140 quad_perm:[1,0,3,2] row_mask:0xf bank_mask:0xf
    v_mov_b32_dpp v157, v141 quad_perm:[1,0,3,2] row_mask:0xf bank_mask:0xf
    v_mov_b32_dpp v158, v142 quad_perm:[1,0,3,2] row_mask:0xf bank_mask:0xf
    v_mov_b32_dpp v159, v143 quad_perm:[1,0,3,2] row_mask:0xf bank_mask:0xf
    v_mov_b32_dpp v160, v144 quad_perm:[1,0,3,2] row_mask:0xf bank_mask:0xf
    v_mov_b32_dpp v161, v145 quad_perm:[1,0,3,2] row_mask:0xf bank_mask:0xf
    v_mov_b32_dpp v162, v146 quad_perm:[1,0,3,2] row_mask:0xf bank_mask:0xf
    v_mov_b32_dpp v163, v147 quad_perm:[1,0,3,2] row_mask:0xf bank_mask:0xf
    v_perm_b32 v110, v136, v152, v106
    v_perm_b32 v114, v136, v152, v107
    v_perm_b32 v111, v137, v153, v106
    v_perm_b32 v115, v137, v153, v107
    v_perm_b32 v112, v138, v154, v106
    v_perm_b32 v116, v138, v154, v107
    v_perm_b32 v113, v139, v155, v106
    v_perm_b32 v117, v139, v155, v107
    v_perm_b32 v118, v140, v156, v106
    v_perm_b32 v122, v140, v156, v107
    v_perm_b32 v119, v141, v157, v106
    v_perm_b32 v123, v141, v157, v107
    v_perm_b32 v120, v142, v158, v106
    v_perm_b32 v124, v142, v158, v107
    v_perm_b32 v121, v143, v159, v106
    v_perm_b32 v125, v143, v159, v107
    v_perm_b32 v126, v144, v160, v106
    v_perm_b32 v130, v144, v160, v107
    v_perm_b32 v127, v145, v161, v106
    v_perm_b32 v131, v145, v161, v107
    v_perm_b32 v128, v146, v162, v106
    v_perm_b32 v132, v146, v162, v107
    v_perm_b32 v129, v147, v163, v106
    v_perm_b32 v133, v147, v163, v107
    v_mul_f32 v136, 0xbedba55c, v110
    v_fmac_f32 v136, 0xbe0afea5, v126
    v_fmamk_f32 v144, v118, 0xbe771a08, v136
    v_fmac_f32 v136, 0x3e771a08, v118
    v_mul_f32 v137, 0xbedba55c, v111
    v_fmac_f32 v137, 0xbe0afea5, v127
    v_fmamk_f32 v145, v119, 0xbe771a08, v137
    v_fmac_f32 v137, 0x3e771a08, v119
    v_mul_f32 v138, 0xbedba55c, v112
    v_fmac_f32 v138, 0xbe0afea5, v128
    v_fmamk_f32 v146, v120, 0xbe771a08, v138
    v_fmac_f32 v138, 0x3e771a08, v120
    v_mul_f32 v139, 0xbedba55c, v113
    v_fmac_f32 v139, 0xbe0afea5, v129
    v_fmamk_f32 v147, v121, 0xbe771a08, v139
    v_fmac_f32 v139, 0x3e771a08, v121
    v_mul_f32 v140, 0xbedba55c, v114
    v_fmac_f32 v140, 0xbe0afea5, v130
    v_fmamk_f32 v148, v122, 0xbe771a08, v140
    v_fmac_f32 v140, 0x3e771a08, v122
    v_mul_f32 v141, 0xbedba55c, v115
    v_fmac_f32 v141, 0xbe0afea5, v131
    v_fmamk_f32 v149, v123, 0xbe771a08, v141
    v_fmac_f32 v141, 0x3e771a08, v123
    v_mul_f32 v142, 0xbedba55c, v116
    v_fmac_f32 v142, 0xbe0afea5, v132
    v_fmamk_f32 v150, v124, 0xbe771a08, v142
    v_fmac_f32 v142, 0x3e771a08, v124
    v_mul_f32 v143, 0xbedba55c, v117
    v_fmac_f32 v143, 0xbe0afea5, v133
    v_fmamk_f32 v151, v125, 0xbe771a08, v143
    v_fmac_f32 v143, 0x3e771a08, v125
    v_cvt_pk_bf16_f32 v156, v144, v145
    v_cvt_pk_bf16_f32 v157, v146, v147
    v_cvt_pk_bf16_f32 v158, v148, v149
    v_cvt_pk_bf16_f32 v159, v150, v151
    s_add_u32 s85, s84, 0
    buffer_store_dwordx4 v[156:159], v254, s[8:11], s85 offen sc1
    v_cvt_pk_bf16_f32 v160, v136, v137
    v_cvt_pk_bf16_f32 v161, v138, v139
    v_cvt_pk_bf16_f32 v162, v140, v141
    v_cvt_pk_bf16_f32 v163, v142, v143
    s_add_u32 s85, s84, 36864
    buffer_store_dwordx4 v[160:163], v254, s[8:11], s85 offen sc1
    v_mul_f32 v136, 0x3e0afea5, v110
    v_fmac_f32 v136, 0x3f0afea5, v126
    v_fmamk_f32 v144, v118, 0x3e8afea5, v136
    v_fmac_f32 v136, 0xbe8afea5, v118
    v_mul_f32 v137, 0x3e0afea5, v111
    v_fmac_f32 v137, 0x3f0afea5, v127
    v_fmamk_f32 v145, v119, 0x3e8afea5, v137
    v_fmac_f32 v137, 0xbe8afea5, v119
    v_mul_f32 v138, 0x3e0afea5, v112
    v_fmac_f32 v138, 0x3f0afea5, v128
    v_fmamk_f32 v146, v120, 0x3e8afea5, v138
    v_fmac_f32 v138, 0xbe8afea5, v120
    v_mul_f32 v139, 0x3e0afea5, v113
    v_fmac_f32 v139, 0x3f0afea5, v129
    v_fmamk_f32 v147, v121, 0x3e8afea5, v139
    v_fmac_f32 v139, 0xbe8afea5, v121
    v_mul_f32 v140, 0x3e0afea5, v114
    v_fmac_f32 v140, 0x3f0afea5, v130
    v_fmamk_f32 v148, v122, 0x3e8afea5, v140
    v_fmac_f32 v140, 0xbe8afea5, v122
    v_mul_f32 v141, 0x3e0afea5, v115
    v_fmac_f32 v141, 0x3f0afea5, v131
    v_fmamk_f32 v149, v123, 0x3e8afea5, v141
    v_fmac_f32 v141, 0xbe8afea5, v123
    v_mul_f32 v142, 0x3e0afea5, v116
    v_fmac_f32 v142, 0x3f0afea5, v132
    v_fmamk_f32 v150, v124, 0x3e8afea5, v142
    v_fmac_f32 v142, 0xbe8afea5, v124
    v_mul_f32 v143, 0x3e0afea5, v117
    v_fmac_f32 v143, 0x3f0afea5, v133
    v_fmamk_f32 v151, v125, 0x3e8afea5, v143
    v_fmac_f32 v143, 0xbe8afea5, v125
    v_cvt_pk_bf16_f32 v164, v144, v145
    v_cvt_pk_bf16_f32 v165, v146, v147
    v_cvt_pk_bf16_f32 v166, v148, v149
    v_cvt_pk_bf16_f32 v167, v150, v151
    s_add_u32 s85, s84, 73728
    buffer_store_dwordx4 v[164:167], v254, s[8:11], s85 offen sc1
    v_cvt_pk_bf16_f32 v168, v136, v137
    v_cvt_pk_bf16_f32 v169, v138, v139
    v_cvt_pk_bf16_f32 v170, v140, v141
    v_cvt_pk_bf16_f32 v171, v142, v143
    s_add_u32 s85, s84, 110592
    buffer_store_dwordx4 v[168:171], v254, s[8:11], s85 offen sc1
    v_cvt_pk_bf16_f32 v152, v110, v111
    v_cvt_pk_bf16_f32 v153, v112, v113
    v_cvt_pk_bf16_f32 v154, v114, v115
    v_cvt_pk_bf16_f32 v155, v116, v117
    s_add_u32 s85, s83, 884736
    buffer_store_dwordx4 v[152:155], v254, s[8:11], s85 offen sc1
    v_cvt_pk_bf16_f32 v172, v126, v127
    v_cvt_pk_bf16_f32 v173, v128, v129
    v_cvt_pk_bf16_f32 v174, v130, v131
    v_cvt_pk_bf16_f32 v175, v132, v133
    s_add_u32 s85, s83, 1105920
    buffer_store_dwordx4 v[172:175], v254, s[8:11], s85 offen sc1
wt_join:
    s_and_b32 s13, s13, 0xffff
    s_mov_b32 s14, 100663296
    s_mov_b32 s15, 0x20000
    v_lshrrev_b32 v5, 4, v2
    v_mul_u32_u24 v6, 40704, v5
    v_lshrrev_b32 v5, 1, v5
    v_lshl_add_u32 v6, v5, 6, v6
    v_and_b32 v5, 0xf0, v254
    v_add_u32 v253, v6, v5
    v_lshrrev_b32 v6, 2, v4
    v_and_or_b32 v6, v4, 2, v6
    v_mul_u32_u24 v7, 40704, v6
    v_lshrrev_b32 v6, 1, v6
    v_lshl_add_u32 v7, v6, 6, v7
    v_and_b32 v6, 1, v2
    v_lshl_add_u32 v7, v6, 3, v7
    v_lshl_add_u32 v7, v3, 4, v7
    s_lshl_b32 s44, s90, 7
    s_mul_i32 s45, s91, 1056
    s_add_u32 s44, s44, s45
    v_add_u32 v7, s44, v7
    v_lshl_or_b32 v255, v7, 15, v255
    s_mul_i32 s51, s38, 40704
    s_lshl_b32 s45, s91, 6
    s_add_u32 s51, s51, s45
    s_lshl_b32 s45, s90, 4
    s_add_u32 s51, s51, s45
    s_mul_i32 s40, s49, 786432
    s_mul_i32 s45, s48, 49152
    s_add_u32 s40, s40, s45
    s_mul_i32 s45, s38, 12288
    s_add_u32 s40, s40, s45
    s_mov_b32 s41, 2130706432
    s_mov_b32 s39, 0
    s_mov_b32 s36, 0
    s_lshl_b32 s45, s38, 4
    s_mov_b32 s46, 0xfff
    s_mov_b32 s47, 0
    s_lshl_b64 s[46:47], s[46:47], s45
    s_mov_b32 s58, 0x0fff0fff
    s_mov_b32 s59, 0
    s_mov_b32 s23, 0xc08a2000
    s_mov_b32 s24, 0xbea20000
    s_mov_b32 s25, 0x3f4a4588
    s_mov_b32 s26, 0x3f100000
    s_mov_b32 s27, 0xbf100000
    s_mov_b32 s28, 0xc05a4588
    s_mov_b32 s29, 0x3fa20000
    s_mov_b32 s30, 0x3ea20000
    s_mov_b32 s31, 0x3e800000
    s_mov_b32 s34, 0x3f900000
    s_mov_b32 s35, 0x3db64000
    s_mov_b32 s22, 0xffff0000
    s_and_b32 s45, s49, 7
    s_cmp_eq_u32 s45, 0
    s_cselect_b32 s33, 4294770688, 0x40000000
    s_cmp_eq_u32 s45, 7
    s_cselect_b32 s33, 786432, s33
    s_mul_i32 s45, s38, 196224
    s_sub_u32 s45, s101, s45
    s_add_u32 s33, s33, s45
    s_mov_b32 s37, 2130706432
    v_bfe_u32 v6, v254, 6, 2
    v_mul_u32_u24 v4, 40704, v6
    v_and_b32 v6, 0x80, v254
    v_lshrrev_b32 v6, 1, v6
    v_add_u32 v4, v4, v6
    v_and_b32 v6, 0x40, v254
    v_lshrrev_b32 v6, 2, v6
    v_add_u32 v4, v4, v6
    v_bfe_u32 v6, v254, 4, 2
    v_mul_u32_u24 v6, 3104, v6
    v_add_u32 v4, v4, v6
    v_add_u32 v4, s52, v4
    v_lshrrev_b32 v6, 8, v254
    v_lshl_add_u32 v5, v6, 3, v4
    v_lshl_add_u32 v4, v6, 4, v4
    v_add_u32 v6, s51, v254
    v_mov_b32 v192, 0
    v_mov_b32 v193, 0
    v_mov_b32 v203, 0
    v_mov_b32 v215, 0
    v_mov_b32 v224, 0
    v_mov_b32 v227, 0
    v_mov_b32 v252, 0
    s_mov_b32 s42, 0
    s_cmp_gt_u32 s48, 0
    s_cselect_b32 s45, 384, 0
    s_cselect_b32 s55, 0, 2130706432
    s_add_u32 s50, s50, s45
    s_add_u32 s54, s45, 49152
    s_cmp_eq_u32 s48, 3
    s_cselect_b32 s54, 2130706432, s54
    s_mov_b32 s56, 0xffff0000
    s_mov_b32 s57, 0
    s_cmp_ge_u32 s2, 54
    s_cbranch_scc1 pub_skip
    s_branch do_warm
wt_ret:
    s_mov_b32 s87, 1
    s_cmp_lg_u32 s38, 0
    s_waitcnt vmcnt(0)
    s_barrier
    s_cbranch_scc1 wt_pub
    s_atomic_add s87, s[68:69], 0 glc
    s_waitcnt lgkmcnt(0)
    s_cmp_lg_u32 s87, 53
    s_cbranch_scc1 wt_pub
    s_atomic_add s87, s[68:69], 128
wt_pub:
    buffer_load_dwordx2 v[8:9], v80, s[4:7], s16 offen offset:0
    buffer_load_dwordx2 v[10:11], v80, s[4:7], s17 offen offset:0
    buffer_load_dwordx2 v[12:13], v80, s[4:7], s18 offen offset:0
    buffer_load_dwordx2 v[14:15], v80, s[4:7], s19 offen offset:0
    buffer_load_dwordx2 v[16:17], v80, s[4:7], s20 offen offset:0
    buffer_load_dwordx2 v[18:19], v80, s[4:7], s21 offen offset:0
    buffer_load_dwordx2 v[20:21], v80, s[4:7], s16 offen offset:384
    buffer_load_dwordx2 v[22:23], v80, s[4:7], s17 offen offset:384
    buffer_load_dwordx2 v[24:25], v80, s[4:7], s18 offen offset:384
    buffer_load_dwordx2 v[26:27], v80, s[4:7], s19 offen offset:384
    buffer_load_dwordx2 v[28:29], v80, s[4:7], s20 offen offset:384
    buffer_load_dwordx2 v[30:31], v80, s[4:7], s21 offen offset:384
pub_skip:
    v_and_b32 v67, 0xf0, v254
    v_lshrrev_b32 v67, 1, v67
    v_add_u32 v67, s52, v67
    v_mov_b32 v66, s54
    v_mov_b32 v65, s55
    v_cndmask_b32 v66, v66, v65, s[56:57]
    v_add_u32 v67, v67, v66
    s_sub_u32 s45, s16, s50
    buffer_load_dwordx2 v[56:57], v67, s[4:7], s45 offen
    s_sub_u32 s45, s17, s50
    buffer_load_dwordx2 v[58:59], v67, s[4:7], s45 offen
    s_sub_u32 s45, s18, s50
    buffer_load_dwordx2 v[60:61], v67, s[4:7], s45 offen
    s_sub_u32 s45, s19, s50
    buffer_load_dwordx2 v[62:63], v67, s[4:7], s45 offen
    s_sub_u32 s45, s20, s50
    buffer_load_dwordx2 v[64:65], v67, s[4:7], s45 offen
    s_sub_u32 s45, s21, s50
    buffer_load_dwordx2 v[66:67], v67, s[4:7], s45 offen
    buffer_load_dwordx2 v[32:33], v80, s[4:7], s16 offen offset:768
    buffer_load_dwordx2 v[34:35], v80, s[4:7], s17 offen offset:768
    buffer_load_dwordx2 v[36:37], v80, s[4:7], s18 offen offset:768
    buffer_load_dwordx2 v[38:39], v80, s[4:7], s19 offen offset:768
    buffer_load_dwordx2 v[40:41], v80, s[4:7], s20 offen offset:768
    buffer_load_dwordx2 v[42:43], v80, s[4:7], s21 offen offset:768
    buffer_load_dwordx2 v[44:45], v80, s[4:7], s16 offen offset:1152
    buffer_load_dwordx2 v[46:47], v80, s[4:7], s17 offen offset:1152
    buffer_load_dwordx2 v[48:49], v80, s[4:7], s18 offen offset:1152
    buffer_load_dwordx2 v[50:51], v80, s[4:7], s19 offen offset:1152
    buffer_load_dwordx2 v[52:53], v80, s[4:7], s20 offen offset:1152
    buffer_load_dwordx2 v[54:55], v80, s[4:7], s21 offen offset:1152
    s_waitcnt vmcnt(24)
    v_lshlrev_b32 v176, 16, v8
    v_and_b32 v177, s22, v8
    v_lshlrev_b32 v178, 16, v10
    v_and_b32 v179, s22, v10
    v_lshlrev_b32 v180, 16, v12
    v_and_b32 v181, s22, v12
    v_lshlrev_b32 v182, 16, v14
    v_and_b32 v183, s22, v14
    v_lshlrev_b32 v184, 16, v16
    v_and_b32 v185, s22, v16
    v_lshlrev_b32 v186, 16, v18
    v_and_b32 v187, s22, v18
    v_pk_fma_f32 v[176:177], v[184:185], s[24:25], v[176:177] op_sel:[0,1,0]
    v_pk_fma_f32 v[186:187], v[178:179], s[28:29], v[186:187] op_sel:[0,1,0]
    v_pk_fma_f32 v[176:177], v[180:181], s[28:29], v[176:177] op_sel_hi:[1,0,1]
    v_pk_fma_f32 v[186:187], v[182:183], s[22:23], v[186:187] op_sel:[0,1,0]
    v_pk_fma_f32 v[188:189], v[180:181], s[24:25], v[184:185] op_sel_hi:[1,0,1]
    v_pk_fma_f32 v[184:185], v[180:181], -4.0, v[184:185] op_sel_hi:[1,0,1]
    v_pk_fma_f32 v[180:181], v[178:179], s[24:25], v[182:183] op_sel_hi:[1,0,1]
    v_pk_fma_f32 v[182:183], v[178:179], -4.0, v[182:183] op_sel_hi:[1,0,1]
    v_pk_fma_f32 v[178:179], v[182:183], s[26:27], v[184:185] op_sel_hi:[1,0,1]
    v_pk_fma_f32 v[184:185], v[182:183], s[26:27], v[184:185] op_sel:[0,1,0]
    v_pk_fma_f32 v[182:183], v[180:181], 2.0, v[188:189] op_sel_hi:[1,0,1]
    v_pk_fma_f32 v[180:181], v[180:181], -2.0, v[188:189] op_sel_hi:[1,0,1]
    v_cvt_pk_bf16_f32 v8, v176, v177
    v_cvt_pk_bf16_f32 v10, v178, v179
    v_cvt_pk_bf16_f32 v12, v180, v181
    v_cvt_pk_bf16_f32 v14, v182, v183
    v_cvt_pk_bf16_f32 v16, v184, v185
    v_cvt_pk_bf16_f32 v18, v186, v187
    v_lshlrev_b32 v176, 16, v9
    v_and_b32 v177, s22, v9
    v_lshlrev_b32 v178, 16, v11
    v_and_b32 v179, s22, v11
    v_lshlrev_b32 v180, 16, v13
    v_and_b32 v181, s22, v13
    v_lshlrev_b32 v182, 16, v15
    v_and_b32 v183, s22, v15
    v_lshlrev_b32 v184, 16, v17
    v_and_b32 v185, s22, v17
    v_lshlrev_b32 v186, 16, v19
    v_and_b32 v187, s22, v19
    v_pk_fma_f32 v[176:177], v[184:185], s[24:25], v[176:177] op_sel:[0,1,0]
    v_pk_fma_f32 v[186:187], v[178:179], s[28:29], v[186:187] op_sel:[0,1,0]
    v_pk_fma_f32 v[176:177], v[180:181], s[28:29], v[176:177] op_sel_hi:[1,0,1]
    v_pk_fma_f32 v[186:187], v[182:183], s[22:23], v[186:187] op_sel:[0,1,0]
    v_pk_fma_f32 v[188:189], v[180:181], s[24:25], v[184:185] op_sel_hi:[1,0,1]
    v_pk_fma_f32 v[184:185], v[180:181], -4.0, v[184:185] op_sel_hi:[1,0,1]
    v_pk_fma_f32 v[180:181], v[178:179], s[24:25], v[182:183] op_sel_hi:[1,0,1]
    v_pk_fma_f32 v[182:183], v[178:179], -4.0, v[182:183] op_sel_hi:[1,0,1]
    v_pk_fma_f32 v[178:179], v[182:183], s[26:27], v[184:185] op_sel_hi:[1,0,1]
    v_pk_fma_f32 v[184:185], v[182:183], s[26:27], v[184:185] op_sel:[0,1,0]
    v_pk_fma_f32 v[182:183], v[180:181], 2.0, v[188:189] op_sel_hi:[1,0,1]
    v_pk_fma_f32 v[180:181], v[180:181], -2.0, v[188:189] op_sel_hi:[1,0,1]
    v_cvt_pk_bf16_f32 v9, v176, v177
    v_cvt_pk_bf16_f32 v11, v178, v179
    v_cvt_pk_bf16_f32 v13, v180, v181
    v_cvt_pk_bf16_f32 v15, v182, v183
    v_cvt_pk_bf16_f32 v17, v184, v185
    v_cvt_pk_bf16_f32 v19, v186, v187
    v_lshrrev_b32 v252, 15, v255
    ds_write_b64 v252, v[8:9] offset:34048
    ds_write_b64 v252, v[10:11] offset:768
    ds_write_b64 v252, v[16:17] offset:2848
    ds_write_b64 v252, v[14:15] offset:4928
    ds_write_b64 v252, v[12:13] offset:7008
    ds_write_b64 v252, v[18:19] offset:36128
    s_waitcnt vmcnt(18)
    v_lshlrev_b32 v176, 16, v20
    v_and_b32 v177, s22, v20
    v_lshlrev_b32 v178, 16, v22
    v_and_b32 v179, s22, v22
    v_lshlrev_b32 v180, 16, v24
    v_and_b32 v181, s22, v24
    v_lshlrev_b32 v182, 16, v26
    v_and_b32 v183, s22, v26
    v_lshlrev_b32 v184, 16, v28
    v_and_b32 v185, s22, v28
    v_lshlrev_b32 v186, 16, v30
    v_and_b32 v187, s22, v30
    v_pk_fma_f32 v[176:177], v[184:185], s[24:25], v[176:177] op_sel:[0,1,0]
    v_pk_fma_f32 v[186:187], v[178:179], s[28:29], v[186:187] op_sel:[0,1,0]
    v_pk_fma_f32 v[176:177], v[180:181], s[28:29], v[176:177] op_sel_hi:[1,0,1]
    v_pk_fma_f32 v[186:187], v[182:183], s[22:23], v[186:187] op_sel:[0,1,0]
    v_pk_fma_f32 v[188:189], v[180:181], s[24:25], v[184:185] op_sel_hi:[1,0,1]
    v_pk_fma_f32 v[184:185], v[180:181], -4.0, v[184:185] op_sel_hi:[1,0,1]
    v_pk_fma_f32 v[180:181], v[178:179], s[24:25], v[182:183] op_sel_hi:[1,0,1]
    v_pk_fma_f32 v[182:183], v[178:179], -4.0, v[182:183] op_sel_hi:[1,0,1]
    v_pk_fma_f32 v[178:179], v[182:183], s[26:27], v[184:185] op_sel_hi:[1,0,1]
    v_pk_fma_f32 v[184:185], v[182:183], s[26:27], v[184:185] op_sel:[0,1,0]
    v_pk_fma_f32 v[182:183], v[180:181], 2.0, v[188:189] op_sel_hi:[1,0,1]
    v_pk_fma_f32 v[180:181], v[180:181], -2.0, v[188:189] op_sel_hi:[1,0,1]
    v_cvt_pk_bf16_f32 v20, v176, v177
    v_cvt_pk_bf16_f32 v22, v178, v179
    v_cvt_pk_bf16_f32 v24, v180, v181
    v_cvt_pk_bf16_f32 v26, v182, v183
    v_cvt_pk_bf16_f32 v28, v184, v185
    v_cvt_pk_bf16_f32 v30, v186, v187
    v_lshlrev_b32 v176, 16, v21
    v_and_b32 v177, s22, v21
    v_lshlrev_b32 v178, 16, v23
    v_and_b32 v179, s22, v23
    v_lshlrev_b32 v180, 16, v25
    v_and_b32 v181, s22, v25
    v_lshlrev_b32 v182, 16, v27
    v_and_b32 v183, s22, v27
    v_lshlrev_b32 v184, 16, v29
    v_and_b32 v185, s22, v29
    v_lshlrev_b32 v186, 16, v31
    v_and_b32 v187, s22, v31
    v_pk_fma_f32 v[176:177], v[184:185], s[24:25], v[176:177] op_sel:[0,1,0]
    v_pk_fma_f32 v[186:187], v[178:179], s[28:29], v[186:187] op_sel:[0,1,0]
    v_pk_fma_f32 v[176:177], v[180:181], s[28:29], v[176:177] op_sel_hi:[1,0,1]
    v_pk_fma_f32 v[186:187], v[182:183], s[22:23], v[186:187] op_sel:[0,1,0]
    v_pk_fma_f32 v[188:189], v[180:181], s[24:25], v[184:185] op_sel_hi:[1,0,1]
    v_pk_fma_f32 v[184:185], v[180:181], -4.0, v[184:185] op_sel_hi:[1,0,1]
    v_pk_fma_f32 v[180:181], v[178:179], s[24:25], v[182:183] op_sel_hi:[1,0,1]
    v_pk_fma_f32 v[182:183], v[178:179], -4.0, v[182:183] op_sel_hi:[1,0,1]
    v_pk_fma_f32 v[178:179], v[182:183], s[26:27], v[184:185] op_sel_hi:[1,0,1]
    v_pk_fma_f32 v[184:185], v[182:183], s[26:27], v[184:185] op_sel:[0,1,0]
    v_pk_fma_f32 v[182:183], v[180:181], 2.0, v[188:189] op_sel_hi:[1,0,1]
    v_pk_fma_f32 v[180:181], v[180:181], -2.0, v[188:189] op_sel_hi:[1,0,1]
    v_cvt_pk_bf16_f32 v21, v176, v177
    v_cvt_pk_bf16_f32 v23, v178, v179
    v_cvt_pk_bf16_f32 v25, v180, v181
    v_cvt_pk_bf16_f32 v27, v182, v183
    v_cvt_pk_bf16_f32 v29, v184, v185
    v_cvt_pk_bf16_f32 v31, v186, v187
    v_lshrrev_b32 v252, 15, v255
    ds_write_b64 v252, v[20:21] offset:33792
    ds_write_b64 v252, v[22:23] offset:512
    ds_write_b64 v252, v[28:29] offset:2592
    ds_write_b64 v252, v[26:27] offset:4672
    ds_write_b64 v252, v[24:25] offset:6752
    ds_write_b64 v252, v[30:31] offset:35872
    s_waitcnt vmcnt(12)
    v_lshlrev_b32 v176, 16, v56
    v_and_b32 v177, s22, v56
    v_lshlrev_b32 v178, 16, v58
    v_and_b32 v179, s22, v58
    v_lshlrev_b32 v180, 16, v60
    v_and_b32 v181, s22, v60
    v_lshlrev_b32 v182, 16, v62
    v_and_b32 v183, s22, v62
    v_lshlrev_b32 v184, 16, v64
    v_and_b32 v185, s22, v64
    v_lshlrev_b32 v186, 16, v66
    v_and_b32 v187, s22, v66
    v_pk_fma_f32 v[176:177], v[184:185], s[24:25], v[176:177] op_sel:[0,1,0]
    v_pk_fma_f32 v[186:187], v[178:179], s[28:29], v[186:187] op_sel:[0,1,0]
    v_pk_fma_f32 v[176:177], v[180:181], s[28:29], v[176:177] op_sel_hi:[1,0,1]
    v_pk_fma_f32 v[186:187], v[182:183], s[22:23], v[186:187] op_sel:[0,1,0]
    v_pk_fma_f32 v[188:189], v[180:181], s[24:25], v[184:185] op_sel_hi:[1,0,1]
    v_pk_fma_f32 v[184:185], v[180:181], -4.0, v[184:185] op_sel_hi:[1,0,1]
    v_pk_fma_f32 v[180:181], v[178:179], s[24:25], v[182:183] op_sel_hi:[1,0,1]
    v_pk_fma_f32 v[182:183], v[178:179], -4.0, v[182:183] op_sel_hi:[1,0,1]
    v_pk_fma_f32 v[178:179], v[182:183], s[26:27], v[184:185] op_sel_hi:[1,0,1]
    v_pk_fma_f32 v[184:185], v[182:183], s[26:27], v[184:185] op_sel:[0,1,0]
    v_pk_fma_f32 v[182:183], v[180:181], 2.0, v[188:189] op_sel_hi:[1,0,1]
    v_pk_fma_f32 v[180:181], v[180:181], -2.0, v[188:189] op_sel_hi:[1,0,1]
    v_cvt_pk_bf16_f32 v56, v176, v177
    v_cvt_pk_bf16_f32 v58, v178, v179
    v_cvt_pk_bf16_f32 v60, v180, v181
    v_cvt_pk_bf16_f32 v62, v182, v183
    v_cvt_pk_bf16_f32 v64, v184, v185
    v_cvt_pk_bf16_f32 v66, v186, v187
    v_lshlrev_b32 v176, 16, v57
    v_and_b32 v177, s22, v57
    v_lshlrev_b32 v178, 16, v59
    v_and_b32 v179, s22, v59
    v_lshlrev_b32 v180, 16, v61
    v_and_b32 v181, s22, v61
    v_lshlrev_b32 v182, 16, v63
    v_and_b32 v183, s22, v63
    v_lshlrev_b32 v184, 16, v65
    v_and_b32 v185, s22, v65
    v_lshlrev_b32 v186, 16, v67
    v_and_b32 v187, s22, v67
    v_pk_fma_f32 v[176:177], v[184:185], s[24:25], v[176:177] op_sel:[0,1,0]
    v_pk_fma_f32 v[186:187], v[178:179], s[28:29], v[186:187] op_sel:[0,1,0]
    v_pk_fma_f32 v[176:177], v[180:181], s[28:29], v[176:177] op_sel_hi:[1,0,1]
    v_pk_fma_f32 v[186:187], v[182:183], s[22:23], v[186:187] op_sel:[0,1,0]
    v_pk_fma_f32 v[188:189], v[180:181], s[24:25], v[184:185] op_sel_hi:[1,0,1]
    v_pk_fma_f32 v[184:185], v[180:181], -4.0, v[184:185] op_sel_hi:[1,0,1]
    v_pk_fma_f32 v[180:181], v[178:179], s[24:25], v[182:183] op_sel_hi:[1,0,1]
    v_pk_fma_f32 v[182:183], v[178:179], -4.0, v[182:183] op_sel_hi:[1,0,1]
    v_pk_fma_f32 v[178:179], v[182:183], s[26:27], v[184:185] op_sel_hi:[1,0,1]
    v_pk_fma_f32 v[184:185], v[182:183], s[26:27], v[184:185] op_sel:[0,1,0]
    v_pk_fma_f32 v[182:183], v[180:181], 2.0, v[188:189] op_sel_hi:[1,0,1]
    v_pk_fma_f32 v[180:181], v[180:181], -2.0, v[188:189] op_sel_hi:[1,0,1]
    v_cvt_pk_bf16_f32 v57, v176, v177
    v_cvt_pk_bf16_f32 v59, v178, v179
    v_cvt_pk_bf16_f32 v61, v180, v181
    v_cvt_pk_bf16_f32 v63, v182, v183
    v_cvt_pk_bf16_f32 v65, v184, v185
    v_cvt_pk_bf16_f32 v67, v186, v187
    v_and_b32 v248, 0xf0, v254
    v_lshrrev_b32 v248, 1, v248
    v_add_u32 v248, s52, v248
    v_and_b32 v252, 8, v248
    v_lshrrev_b32 v249, 6, v248
    v_mul_u32_u24 v249, 192, v249
    v_cmp_eq_u32 s[92:93], 0, v249
    v_add_u32 v252, v252, v249
    v_bfe_u32 v249, v248, 5, 1
    v_mul_u32_u24 v249, 40704, v249
    v_add_u32 v252, v252, v249
    v_bfe_u32 v249, v248, 4, 1
    v_mul_u32_u24 v249, 81472, v249
    v_add_u32 v252, v252, v249
    v_bfe_u32 v249, v254, 8, 1
    v_lshl_add_u32 v252, v249, 4, v252
    v_mov_b32 v249, 123328
    v_cndmask_b32 v252, v249, v252, s[58:59]
    ds_write_b64 v252, v[56:57] offset:39520
    ds_write_b64 v252, v[58:59] offset:39552
    ds_write_b64 v252, v[64:65] offset:39584
    ds_write_b64 v252, v[62:63] offset:39616
    ds_write_b64 v252, v[60:61] offset:39648
    ds_write_b64 v252, v[66:67] offset:39680
    s_and_b64 exec, s[92:93], s[58:59]
    ds_write_b64 v252, v[56:57] offset:34304
    ds_write_b64 v252, v[58:59] offset:1024
    ds_write_b64 v252, v[64:65] offset:3104
    ds_write_b64 v252, v[62:63] offset:5184
    ds_write_b64 v252, v[60:61] offset:7264
    ds_write_b64 v252, v[66:67] offset:36384
    s_mov_b64 exec, -1
    v_and_b32 v203, 0x7fff, v255
    buffer_load_dwordx2 v[192:193], v203, s[4:7], s16 offen offset:64
    buffer_load_dwordx2 v[194:195], v203, s[4:7], s17 offen offset:64
    buffer_load_dwordx2 v[196:197], v203, s[4:7], s18 offen offset:64
    buffer_load_dwordx2 v[198:199], v203, s[4:7], s19 offen offset:64
    buffer_load_dwordx2 v[200:201], v203, s[4:7], s20 offen offset:64
    buffer_load_dwordx2 v[202:203], v203, s[4:7], s21 offen offset:64
    v_and_b32 v215, 0x7fff, v255
    buffer_load_dwordx2 v[204:205], v215, s[4:7], s16 offen offset:448
    buffer_load_dwordx2 v[206:207], v215, s[4:7], s17 offen offset:448
    buffer_load_dwordx2 v[208:209], v215, s[4:7], s18 offen offset:448
    buffer_load_dwordx2 v[210:211], v215, s[4:7], s19 offen offset:448
    buffer_load_dwordx2 v[212:213], v215, s[4:7], s20 offen offset:448
    buffer_load_dwordx2 v[214:215], v215, s[4:7], s21 offen offset:448
    s_waitcnt vmcnt(18)
    v_lshlrev_b32 v176, 16, v32
    v_and_b32 v177, s22, v32
    v_lshlrev_b32 v178, 16, v34
    v_and_b32 v179, s22, v34
    v_lshlrev_b32 v180, 16, v36
    v_and_b32 v181, s22, v36
    v_lshlrev_b32 v182, 16, v38
    v_and_b32 v183, s22, v38
    v_lshlrev_b32 v184, 16, v40
    v_and_b32 v185, s22, v40
    v_lshlrev_b32 v186, 16, v42
    v_and_b32 v187, s22, v42
    v_pk_fma_f32 v[176:177], v[184:185], s[24:25], v[176:177] op_sel:[0,1,0]
    v_pk_fma_f32 v[186:187], v[178:179], s[28:29], v[186:187] op_sel:[0,1,0]
    v_pk_fma_f32 v[176:177], v[180:181], s[28:29], v[176:177] op_sel_hi:[1,0,1]
    v_pk_fma_f32 v[186:187], v[182:183], s[22:23], v[186:187] op_sel:[0,1,0]
    v_pk_fma_f32 v[188:189], v[180:181], s[24:25], v[184:185] op_sel_hi:[1,0,1]
    v_pk_fma_f32 v[184:185], v[180:181], -4.0, v[184:185] op_sel_hi:[1,0,1]
    v_pk_fma_f32 v[180:181], v[178:179], s[24:25], v[182:183] op_sel_hi:[1,0,1]
    v_pk_fma_f32 v[182:183], v[178:179], -4.0, v[182:183] op_sel_hi:[1,0,1]
    v_pk_fma_f32 v[178:179], v[182:183], s[26:27], v[184:185] op_sel_hi:[1,0,1]
    v_pk_fma_f32 v[184:185], v[182:183], s[26:27], v[184:185] op_sel:[0,1,0]
    v_pk_fma_f32 v[182:183], v[180:181], 2.0, v[188:189] op_sel_hi:[1,0,1]
    v_pk_fma_f32 v[180:181], v[180:181], -2.0, v[188:189] op_sel_hi:[1,0,1]
    v_cvt_pk_bf16_f32 v32, v176, v177
    v_cvt_pk_bf16_f32 v34, v178, v179
    v_cvt_pk_bf16_f32 v36, v180, v181
    v_cvt_pk_bf16_f32 v38, v182, v183
    v_cvt_pk_bf16_f32 v40, v184, v185
    v_cvt_pk_bf16_f32 v42, v186, v187
    v_lshlrev_b32 v176, 16, v33
    v_and_b32 v177, s22, v33
    v_lshlrev_b32 v178, 16, v35
    v_and_b32 v179, s22, v35
    v_lshlrev_b32 v180, 16, v37
    v_and_b32 v181, s22, v37
    v_lshlrev_b32 v182, 16, v39
    v_and_b32 v183, s22, v39
    v_lshlrev_b32 v184, 16, v41
    v_and_b32 v185, s22, v41
    v_lshlrev_b32 v186, 16, v43
    v_and_b32 v187, s22, v43
    v_pk_fma_f32 v[176:177], v[184:185], s[24:25], v[176:177] op_sel:[0,1,0]
    v_pk_fma_f32 v[186:187], v[178:179], s[28:29], v[186:187] op_sel:[0,1,0]
    v_pk_fma_f32 v[176:177], v[180:181], s[28:29], v[176:177] op_sel_hi:[1,0,1]
    v_pk_fma_f32 v[186:187], v[182:183], s[22:23], v[186:187] op_sel:[0,1,0]
    v_pk_fma_f32 v[188:189], v[180:181], s[24:25], v[184:185] op_sel_hi:[1,0,1]
    v_pk_fma_f32 v[184:185], v[180:181], -4.0, v[184:185] op_sel_hi:[1,0,1]
    v_pk_fma_f32 v[180:181], v[178:179], s[24:25], v[182:183] op_sel_hi:[1,0,1]
    v_pk_fma_f32 v[182:183], v[178:179], -4.0, v[182:183] op_sel_hi:[1,0,1]
    v_pk_fma_f32 v[178:179], v[182:183], s[26:27], v[184:185] op_sel_hi:[1,0,1]
    v_pk_fma_f32 v[184:185], v[182:183], s[26:27], v[184:185] op_sel:[0,1,0]
    v_pk_fma_f32 v[182:183], v[180:181], 2.0, v[188:189] op_sel_hi:[1,0,1]
    v_pk_fma_f32 v[180:181], v[180:181], -2.0, v[188:189] op_sel_hi:[1,0,1]
    v_cvt_pk_bf16_f32 v33, v176, v177
    v_cvt_pk_bf16_f32 v35, v178, v179
    v_cvt_pk_bf16_f32 v37, v180, v181
    v_cvt_pk_bf16_f32 v39, v182, v183
    v_cvt_pk_bf16_f32 v41, v184, v185
    v_cvt_pk_bf16_f32 v43, v186, v187
    v_lshrrev_b32 v252, 15, v255
    ds_write_b64 v252, v[32:33] offset:33536
    ds_write_b64 v252, v[34:35] offset:256
    ds_write_b64 v252, v[40:41] offset:2336
    ds_write_b64 v252, v[38:39] offset:4416
    ds_write_b64 v252, v[36:37] offset:6496
    ds_write_b64 v252, v[42:43] offset:35616
    s_waitcnt vmcnt(12)
    v_lshlrev_b32 v176, 16, v44
    v_and_b32 v177, s22, v44
    v_lshlrev_b32 v178, 16, v46
    v_and_b32 v179, s22, v46
    v_lshlrev_b32 v180, 16, v48
    v_and_b32 v181, s22, v48
    v_lshlrev_b32 v182, 16, v50
    v_and_b32 v183, s22, v50
    v_lshlrev_b32 v184, 16, v52
    v_and_b32 v185, s22, v52
    v_lshlrev_b32 v186, 16, v54
    v_and_b32 v187, s22, v54
    v_pk_fma_f32 v[176:177], v[184:185], s[24:25], v[176:177] op_sel:[0,1,0]
    v_pk_fma_f32 v[186:187], v[178:179], s[28:29], v[186:187] op_sel:[0,1,0]
    v_pk_fma_f32 v[176:177], v[180:181], s[28:29], v[176:177] op_sel_hi:[1,0,1]
    v_pk_fma_f32 v[186:187], v[182:183], s[22:23], v[186:187] op_sel:[0,1,0]
    v_pk_fma_f32 v[188:189], v[180:181], s[24:25], v[184:185] op_sel_hi:[1,0,1]
    v_pk_fma_f32 v[184:185], v[180:181], -4.0, v[184:185] op_sel_hi:[1,0,1]
    v_pk_fma_f32 v[180:181], v[178:179], s[24:25], v[182:183] op_sel_hi:[1,0,1]
    v_pk_fma_f32 v[182:183], v[178:179], -4.0, v[182:183] op_sel_hi:[1,0,1]
    v_pk_fma_f32 v[178:179], v[182:183], s[26:27], v[184:185] op_sel_hi:[1,0,1]
    v_pk_fma_f32 v[184:185], v[182:183], s[26:27], v[184:185] op_sel:[0,1,0]
    v_pk_fma_f32 v[182:183], v[180:181], 2.0, v[188:189] op_sel_hi:[1,0,1]
    v_pk_fma_f32 v[180:181], v[180:181], -2.0, v[188:189] op_sel_hi:[1,0,1]
    v_cvt_pk_bf16_f32 v44, v176, v177
    v_cvt_pk_bf16_f32 v46, v178, v179
    v_cvt_pk_bf16_f32 v48, v180, v181
    v_cvt_pk_bf16_f32 v50, v182, v183
    v_cvt_pk_bf16_f32 v52, v184, v185
    v_cvt_pk_bf16_f32 v54, v186, v187
    v_lshlrev_b32 v176, 16, v45
    v_and_b32 v177, s22, v45
    v_lshlrev_b32 v178, 16, v47
    v_and_b32 v179, s22, v47
    v_lshlrev_b32 v180, 16, v49
    v_and_b32 v181, s22, v49
    v_lshlrev_b32 v182, 16, v51
    v_and_b32 v183, s22, v51
    v_lshlrev_b32 v184, 16, v53
    v_and_b32 v185, s22, v53
    v_lshlrev_b32 v186, 16, v55
    v_and_b32 v187, s22, v55
    v_pk_fma_f32 v[176:177], v[184:185], s[24:25], v[176:177] op_sel:[0,1,0]
    v_pk_fma_f32 v[186:187], v[178:179], s[28:29], v[186:187] op_sel:[0,1,0]
    v_pk_fma_f32 v[176:177], v[180:181], s[28:29], v[176:177] op_sel_hi:[1,0,1]
    v_pk_fma_f32 v[186:187], v[182:183], s[22:23], v[186:187] op_sel:[0,1,0]
    v_pk_fma_f32 v[188:189], v[180:181], s[24:25], v[184:185] op_sel_hi:[1,0,1]
    v_pk_fma_f32 v[184:185], v[180:181], -4.0, v[184:185] op_sel_hi:[1,0,1]
    v_pk_fma_f32 v[180:181], v[178:179], s[24:25], v[182:183] op_sel_hi:[1,0,1]
    v_pk_fma_f32 v[182:183], v[178:179], -4.0, v[182:183] op_sel_hi:[1,0,1]
    v_pk_fma_f32 v[178:179], v[182:183], s[26:27], v[184:185] op_sel_hi:[1,0,1]
    v_pk_fma_f32 v[184:185], v[182:183], s[26:27], v[184:185] op_sel:[0,1,0]
    v_pk_fma_f32 v[182:183], v[180:181], 2.0, v[188:189] op_sel_hi:[1,0,1]
    v_pk_fma_f32 v[180:181], v[180:181], -2.0, v[188:189] op_sel_hi:[1,0,1]
    v_cvt_pk_bf16_f32 v45, v176, v177
    v_cvt_pk_bf16_f32 v47, v178, v179
    v_cvt_pk_bf16_f32 v49, v180, v181
    v_cvt_pk_bf16_f32 v51, v182, v183
    v_cvt_pk_bf16_f32 v53, v184, v185
    v_cvt_pk_bf16_f32 v55, v186, v187
    v_lshrrev_b32 v252, 15, v255
    ds_write_b64 v252, v[44:45] offset:33280
    ds_write_b64 v252, v[46:47] offset:0
    ds_write_b64 v252, v[52:53] offset:2080
    ds_write_b64 v252, v[50:51] offset:4160
    ds_write_b64 v252, v[48:49] offset:6240
    ds_write_b64 v252, v[54:55] offset:35360
    buffer_load_dword v97, v98, s[64:67], 0 offen offset:128 sc1
    s_cmp_lt_u32 s2, 54
    s_cbranch_scc1 warm_done
do_warm:
    s_mov_b64 vcc, -1
    s_cmp_eq_u32 s38, 0
    s_cbranch_scc1 pad0
    s_cmp_eq_u32 s38, 1
    s_cbranch_scc1 pad1
    s_cmp_eq_u32 s38, 2
    s_cbranch_scc1 pad2
    s_branch pad3
warm_ret:
    s_mov_b64 vcc, 0
    s_cmp_lt_u32 s2, 54
    s_cbranch_scc1 wt_ret
warm_done:
    s_mov_b32 s86, 0
    s_waitcnt vmcnt(0)
poll_loop:
    v_readfirstlane_b32 s87, v97
    s_add_u32 s86, s86, 1
    s_cmp_lg_u32 s87, 0
    s_cbranch_scc1 u_ready
    buffer_load_dword v97, v98, s[64:67], 0 offen offset:128 sc1
    s_cmp_lt_u32 s86, 512
    s_waitcnt vmcnt(0)
    s_cbranch_scc1 poll_loop
    s_mov_b32 s70, 0
    s_branch wt_loop
u_ready:
    s_mov_b32 s42, 0
    buffer_load_dwordx4 a[192:195], v254, s[8:11], s42 offen offset:0 sc1
    buffer_load_dwordx4 a[196:199], v254, s[8:11], s42 offen offset:1024 sc1
    buffer_load_dwordx4 a[200:203], v254, s[8:11], s42 offen offset:2048 sc1
    s_mov_b32 s42, 3072
    buffer_load_dwordx4 a[204:207], v254, s[8:11], s42 offen offset:0 sc1
    buffer_load_dwordx4 a[208:211], v254, s[8:11], s42 offen offset:1024 sc1
    buffer_load_dwordx4 a[212:215], v254, s[8:11], s42 offen offset:2048 sc1
    s_mov_b32 s42, 6144
    buffer_load_dwordx4 a[216:219], v254, s[8:11], s42 offen offset:0 sc1
    buffer_load_dwordx4 a[220:223], v254, s[8:11], s42 offen offset:1024 sc1
    buffer_load_dwordx4 a[224:227], v254, s[8:11], s42 offen offset:2048 sc1
u_done:
    s_mov_b32 s42, 36864
    buffer_load_dwordx4 a[228:231], v254, s[8:11], s42 offen offset:0 sc1
    buffer_load_dwordx4 a[232:235], v254, s[8:11], s42 offen offset:1024 sc1
    buffer_load_dwordx4 a[236:239], v254, s[8:11], s42 offen offset:2048 sc1
    s_mov_b32 s42, 39936
    buffer_load_dwordx4 a[240:243], v254, s[8:11], s42 offen offset:0 sc1
    buffer_load_dwordx4 a[244:247], v254, s[8:11], s42 offen offset:1024 sc1
    buffer_load_dwordx4 a[248:251], v254, s[8:11], s42 offen offset:2048 sc1
    s_mov_b32 s42, 43008
    buffer_load_dwordx4 a[252:255], v254, s[8:11], s42 offen offset:0 sc1
    buffer_load_dwordx4 v[240:243], v254, s[8:11], s42 offen offset:1024 sc1
    buffer_load_dwordx4 v[244:247], v254, s[8:11], s42 offen offset:2048 sc1
    s_waitcnt lgkmcnt(0)
    s_barrier
    ds_read_b128 v[228:231], v253 offset:1040
    ds_read_b128 v[232:235], v253 offset:768
    ds_read_b128 v[236:239], v253 offset:512
    s_waitcnt vmcnt(9) lgkmcnt(0)
    s_branch blk_loop
.p2align 12
blk_loop:
sub0:
    v_mfma_f32_16x16x32_bf16 a[0:3], a[192:195], v[228:231], 0
pad0:
    s_cbranch_vccnz pad4
    s_add_u32 s44, s41, 10240
    s_waitcnt vmcnt(23)
    v_lshlrev_b32 v248, 16, v194
    v_mfma_f32_16x16x32_bf16 a[4:7], a[196:199], v[228:231], 0
    v_cvt_pk_bf16_f32 v180, v180, v181
    v_cvt_pk_bf16_f32 v181, v182, v183
    v_mfma_f32_16x16x32_bf16 a[8:11], a[200:203], v[228:231], 0
    ds_read_b128 v[228:231], v253 offset:256
    v_cvt_pk_bf16_f32 v182, v184, v185
    v_mfma_f32_16x16x32_bf16 a[8:11], a[212:215], v[232:235], a[8:11]
    s_waitcnt lgkmcnt(1)
    buffer_store_dwordx4 v[124:127], v254, s[12:15], s44 offen nt
    v_cvt_pk_bf16_f32 v183, v186, v187
    v_lshlrev_b32 v249, 16, v196
    v_mfma_f32_16x16x32_bf16 a[4:7], a[208:211], v[232:235], a[4:7]
    ds_write_b128 v4, v[180:183] offset:19328
    v_mfma_f32_16x16x32_bf16 a[0:3], a[204:207], v[232:235], a[0:3]
    v_lshlrev_b32 v250, 16, v198
    v_lshlrev_b32 v251, 16, v200
    v_mfma_f32_16x16x32_bf16 a[0:3], a[216:219], v[236:239], a[0:3]
    v_and_b32 v194, s22, v194
    v_and_b32 v196, s22, v196
    v_and_b32 v198, s22, v198
    v_mfma_f32_16x16x32_bf16 a[4:7], a[220:223], v[236:239], a[4:7]
    v_cvt_pk_bf16_f32 v188, v188, v189
    v_cvt_pk_bf16_f32 v189, v190, v191
    v_mfma_f32_16x16x32_bf16 a[8:11], a[224:227], v[236:239], a[8:11]
    ds_write_b64 v5, v[188:189] offset:19392
    v_mfma_f32_16x16x32_bf16 a[12:15], a[192:195], v[232:235], 0
    v_and_b32 v200, s22, v200
    v_lshlrev_b32 v252, 16, v192
    v_mfma_f32_16x16x32_bf16 a[12:15], a[204:207], v[236:239], a[12:15]
    s_waitcnt lgkmcnt(2)
    v_and_b32 v192, s22, v192
    v_fmac_f32 v252, s25, v251
    v_mfma_f32_16x16x32_bf16 a[12:15], a[216:219], v[228:231], a[12:15]
    v_fmac_f32 v192, s25, v200
    v_fmac_f32 v252, s28, v249
    v_mfma_f32_16x16x32_bf16 a[16:19], a[220:223], v[228:231], 0
    v_fmac_f32 v192, s28, v196
    v_cvt_pk_bf16_f32 v192, v252, v192
    v_mfma_f32_16x16x32_bf16 a[16:19], a[208:211], v[236:239], a[16:19]
    v_lshlrev_b32 v252, 16, v202
    v_and_b32 v202, s22, v202
    v_fmac_f32 v252, s29, v248
    v_mfma_f32_16x16x32_bf16 a[16:19], a[196:199], v[232:235], a[16:19]
    v_fmac_f32 v202, s29, v194
    v_fmac_f32 v252, s23, v250
    v_mfma_f32_16x16x32_bf16 a[20:23], a[200:203], v[232:235], 0
    ds_read_b128 v[232:235], v253 offset:0
    v_fmac_f32 v202, s23, v198
    v_mfma_f32_16x16x32_bf16 a[20:23], a[212:215], v[236:239], a[20:23]
    s_waitcnt lgkmcnt(0)
    v_cvt_pk_bf16_f32 v202, v252, v202
    v_fma_f32 v252, v249, s24, v251
    v_mfma_f32_16x16x32_bf16 a[20:23], a[224:227], v[228:231], a[20:23]
    s_barrier
    v_mfma_f32_16x16x32_bf16 a[24:27], a[192:195], v[236:239], 0
    ds_read_b128 v[128:131], v6 offset:18688
    v_fmac_f32 v251, -4.0, v249
    v_mfma_f32_16x16x32_bf16 a[24:27], a[204:207], v[228:231], a[24:27]
    v_fma_f32 v249, v248, s24, v250
    v_fmac_f32 v250, -4.0, v248
    v_fma_f32 v248, v250, s26, v251
    v_mfma_f32_16x16x32_bf16 a[24:27], a[216:219], v[232:235], a[24:27]
    v_fmac_f32 v251, s27, v250
    v_fma_f32 v250, v249, 2.0, v252
    v_mfma_f32_16x16x32_bf16 a[28:31], a[220:223], v[232:235], 0
    v_fmac_f32 v252, -2.0, v249
    v_fma_f32 v249, v196, s24, v200
    v_mfma_f32_16x16x32_bf16 a[28:31], a[208:211], v[228:231], a[28:31]
    v_fmac_f32 v200, -4.0, v196
    v_fma_f32 v196, v194, s24, v198
    v_mfma_f32_16x16x32_bf16 a[28:31], a[196:199], v[236:239], a[28:31]
    s_add_u32 s44, s41, 2048
    v_fmac_f32 v198, -4.0, v194
    v_fma_f32 v194, v198, s26, v200
    v_mfma_f32_16x16x32_bf16 a[32:35], a[200:203], v[236:239], 0
    ds_read_b128 v[236:239], v253 offset:1824
    v_fmac_f32 v200, s27, v198
    v_mfma_f32_16x16x32_bf16 a[32:35], a[212:215], v[228:231], a[32:35]
    v_fma_f32 v198, v196, 2.0, v249
    v_fmac_f32 v249, -2.0, v196
    v_mfma_f32_16x16x32_bf16 a[32:35], a[224:227], v[232:235], a[32:35]
    v_cvt_pk_bf16_f32 v194, v248, v194
    v_cvt_pk_bf16_f32 v200, v251, v200
    v_cvt_pk_bf16_f32 v198, v250, v198
    v_mfma_f32_16x16x32_bf16 a[36:39], a[192:195], v[228:231], 0
    v_and_b32 v227, 0x7fff, v255
    v_cvt_pk_bf16_f32 v196, v252, v249
    v_mfma_f32_16x16x32_bf16 a[36:39], a[204:207], v[232:235], a[36:39]
    s_waitcnt lgkmcnt(0)
    v_lshlrev_b32 v248, 16, v195
    v_lshlrev_b32 v249, 16, v197
    v_mfma_f32_16x16x32_bf16 a[36:39], a[216:219], v[236:239], a[36:39]
    buffer_load_dwordx2 v[216:217], v227, s[4:7], s16 offen offset:832
    v_mfma_f32_16x16x32_bf16 a[40:43], a[220:223], v[236:239], 0
    ds_read_b128 v[132:135], v6 offset:21792
    v_mfma_f32_16x16x32_bf16 a[40:43], a[208:211], v[232:235], a[40:43]
    v_lshlrev_b32 v250, 16, v199
    v_lshlrev_b32 v251, 16, v201
    v_mfma_f32_16x16x32_bf16 a[40:43], a[196:199], v[228:231], a[40:43]
    v_and_b32 v195, s22, v195
    v_and_b32 v197, s22, v197
    v_mfma_f32_16x16x32_bf16 a[44:47], a[200:203], v[228:231], 0
    ds_read_b128 v[228:231], v253 offset:1568
    v_and_b32 v199, s22, v199
    v_and_b32 v201, s22, v201
    v_mfma_f32_16x16x32_bf16 a[44:47], a[212:215], v[232:235], a[44:47]
    buffer_load_dwordx2 v[218:219], v227, s[4:7], s17 offen offset:832
    v_mfma_f32_16x16x32_bf16 a[44:47], a[224:227], v[236:239], a[44:47]
    v_lshlrev_b32 v252, 16, v193
    v_and_b32 v193, s22, v193
    v_mfma_f32_16x16x32_bf16 a[48:51], a[192:195], v[232:235], 0
    v_fmac_f32 v252, s25, v251
    v_fmac_f32 v193, s25, v201
    v_mfma_f32_16x16x32_bf16 a[48:51], a[204:207], v[236:239], a[48:51]
    s_waitcnt lgkmcnt(0)
    v_fmac_f32 v252, s28, v249
    v_fmac_f32 v193, s28, v197
    v_mfma_f32_16x16x32_bf16 a[48:51], a[216:219], v[228:231], a[48:51]
    buffer_load_dwordx2 v[220:221], v227, s[4:7], s18 offen offset:832
    v_mfma_f32_16x16x32_bf16 a[52:55], a[220:223], v[228:231], 0
    ds_read_b128 v[136:139], v6 offset:24896
    v_cvt_pk_bf16_f32 v193, v252, v193
    v_lshlrev_b32 v252, 16, v203
    v_mfma_f32_16x16x32_bf16 a[52:55], a[208:211], v[236:239], a[52:55]
    v_and_b32 v203, s22, v203
    v_fmac_f32 v252, s29, v248
    v_mfma_f32_16x16x32_bf16 a[52:55], a[196:199], v[232:235], a[52:55]
    v_fmac_f32 v203, s29, v195
    v_fmac_f32 v252, s23, v250
    v_mfma_f32_16x16x32_bf16 a[56:59], a[200:203], v[232:235], 0
    ds_read_b128 v[232:235], v253 offset:1312
    v_fmac_f32 v203, s23, v199
    v_mfma_f32_16x16x32_bf16 a[56:59], a[212:215], v[236:239], a[56:59]
    buffer_load_dwordx2 v[222:223], v227, s[4:7], s19 offen offset:832
    v_mfma_f32_16x16x32_bf16 a[56:59], a[224:227], v[228:231], a[56:59]
    v_cvt_pk_bf16_f32 v203, v252, v203
    v_fma_f32 v252, v249, s24, v251
    v_mfma_f32_16x16x32_bf16 a[60:63], a[192:195], v[236:239], 0
    v_fmac_f32 v251, -4.0, v249
    v_fma_f32 v249, v248, s24, v250
    v_mfma_f32_16x16x32_bf16 a[60:63], a[204:207], v[228:231], a[60:63]
    s_waitcnt lgkmcnt(0)
    v_fmac_f32 v250, -4.0, v248
    v_fma_f32 v248, v250, s26, v251
    v_fmac_f32 v251, s27, v250
    v_mfma_f32_16x16x32_bf16 a[60:63], a[216:219], v[232:235], a[60:63]
    buffer_load_dwordx2 v[224:225], v227, s[4:7], s20 offen offset:832
    v_mfma_f32_16x16x32_bf16 a[64:67], a[220:223], v[232:235], 0
    v_fma_f32 v250, v249, 2.0, v252
    v_fmac_f32 v252, -2.0, v249
    v_mfma_f32_16x16x32_bf16 a[64:67], a[208:211], v[228:231], a[64:67]
    ds_read_b128 v[140:143], v6 offset:28000
    v_fma_f32 v249, v197, s24, v201
    v_mfma_f32_16x16x32_bf16 a[64:67], a[196:199], v[236:239], a[64:67]
    v_fmac_f32 v201, -4.0, v197
    v_fma_f32 v197, v195, s24, v199
    v_mfma_f32_16x16x32_bf16 a[68:71], a[200:203], v[236:239], 0
    ds_read_b128 v[236:239], v253 offset:1056
    v_fmac_f32 v199, -4.0, v195
    v_mfma_f32_16x16x32_bf16 a[68:71], a[212:215], v[228:231], a[68:71]
    buffer_load_dwordx2 v[226:227], v227, s[4:7], s21 offen offset:832
    v_mfma_f32_16x16x32_bf16 a[68:71], a[224:227], v[232:235], a[68:71]
    v_fma_f32 v195, v199, s26, v201
    v_fmac_f32 v201, s27, v199
    v_fma_f32 v199, v197, 2.0, v249
    v_mfma_f32_16x16x32_bf16 a[72:75], a[192:195], v[228:231], 0
    buffer_store_dwordx4 v[128:131], v254, s[12:15], s44 offen nt
    s_add_u32 s44, s41, 5120
    v_mfma_f32_16x16x32_bf16 a[72:75], a[204:207], v[232:235], a[72:75]
    s_waitcnt lgkmcnt(0)
    v_fmac_f32 v249, -2.0, v197
    v_cvt_pk_bf16_f32 v195, v248, v195
    v_mfma_f32_16x16x32_bf16 a[72:75], a[216:219], v[236:239], a[72:75]
    v_cvt_pk_bf16_f32 v201, v251, v201
    v_cvt_pk_bf16_f32 v199, v250, v199
    v_mfma_f32_16x16x32_bf16 a[76:79], a[220:223], v[236:239], 0
    buffer_store_dwordx4 v[132:135], v254, s[12:15], s44 offen nt
    v_cvt_pk_bf16_f32 v197, v252, v249
    v_lshrrev_b32 v252, 15, v255
    v_mfma_f32_16x16x32_bf16 a[76:79], a[208:211], v[232:235], a[76:79]
    ds_write_b64 v252, v[194:195] offset:9088
    v_mfma_f32_16x16x32_bf16 a[76:79], a[196:199], v[228:231], a[76:79]
    s_waitcnt vmcnt(9)
    v_lshrrev_b32 v194, 15, v255
    v_lshlrev_b32 v248, 16, v206
    v_lshlrev_b32 v249, 16, v208
    v_mfma_f32_16x16x32_bf16 a[80:83], a[200:203], v[228:231], 0
    ds_read_b128 v[228:231], v253 offset:784
    v_lshlrev_b32 v250, 16, v210
    v_mfma_f32_16x16x32_bf16 a[80:83], a[212:215], v[232:235], a[80:83]
    ds_write_b64 v194, v[200:201] offset:11168
    v_mfma_f32_16x16x32_bf16 a[80:83], a[224:227], v[236:239], a[80:83]
    s_mov_b32 s42, 73728
    s_add_u32 s44, s41, 8192
    v_lshlrev_b32 v251, 16, v212
    v_mfma_f32_16x16x32_bf16 a[84:87], a[192:195], v[232:235], 0
    ds_write_b64 v194, v[198:199] offset:13248
    v_mfma_f32_16x16x32_bf16 a[88:91], a[196:199], v[232:235], 0
    v_and_b32 v206, s22, v206
    v_and_b32 v208, s22, v208
    v_mfma_f32_16x16x32_bf16 a[92:95], a[200:203], v[232:235], 0
    ds_read_b128 v[232:235], v253 offset:3120
    v_and_b32 v210, s22, v210
    v_mfma_f32_16x16x32_bf16 a[92:95], a[212:215], v[236:239], a[92:95]
    buffer_load_dwordx4 a[192:195], v254, s[8:11], s42 offen offset:0 sc1
    v_and_b32 v212, s22, v212
    v_mfma_f32_16x16x32_bf16 a[88:91], a[208:211], v[236:239], a[88:91]
    s_waitcnt lgkmcnt(3)
    v_lshlrev_b32 v252, 16, v204
    v_and_b32 v204, s22, v204
    v_mfma_f32_16x16x32_bf16 a[84:87], a[204:207], v[236:239], a[84:87]
    ds_read_b128 v[236:239], v253 offset:2848
    v_mfma_f32_16x16x32_bf16 a[84:87], a[216:219], v[228:231], a[84:87]
    buffer_load_dwordx4 a[196:199], v254, s[8:11], s42 offen offset:1024 sc1
    v_mfma_f32_16x16x32_bf16 a[88:91], a[220:223], v[228:231], a[88:91]
    s_waitcnt vmcnt(11) lgkmcnt(1)
    v_fmac_f32 v252, s25, v251
    v_fmac_f32 v204, s25, v212
    v_mfma_f32_16x16x32_bf16 a[92:95], a[224:227], v[228:231], a[92:95]
    ds_read_b128 v[228:231], v253 offset:2592
    v_fmac_f32 v252, s28, v249
sub1:
    v_mfma_f32_16x16x32_bf16 a[96:99], a[228:231], v[232:235], 0
    buffer_load_dwordx4 a[200:203], v254, s[8:11], s42 offen offset:2048 sc1
    v_mfma_f32_16x16x32_bf16 a[100:103], a[232:235], v[232:235], 0
    s_mov_b32 s42, 76800
    v_fmac_f32 v204, s28, v208
    v_cvt_pk_bf16_f32 v204, v252, v204
    v_lshlrev_b32 v252, 16, v214
    v_mfma_f32_16x16x32_bf16 a[104:107], a[236:239], v[232:235], 0
    ds_read_b128 v[232:235], v253 offset:2336
    s_waitcnt vmcnt(12)
    s_waitcnt lgkmcnt(2)
    v_mfma_f32_16x16x32_bf16 a[104:107], a[248:251], v[236:239], a[104:107]
    ds_write_b64 v194, v[192:193] offset:15328
    v_mfma_f32_16x16x32_bf16 a[100:103], a[244:247], v[236:239], a[100:103]
    buffer_load_dwordx4 a[204:207], v254, s[8:11], s42 offen offset:0 sc1
    v_mfma_f32_16x16x32_bf16 a[96:99], a[240:243], v[236:239], a[96:99]
    s_waitcnt vmcnt(13) lgkmcnt(2)
    v_and_b32 v214, s22, v214
    v_fmac_f32 v252, s29, v248
    v_mfma_f32_16x16x32_bf16 a[96:99], a[252:255], v[228:231], a[96:99]
    buffer_store_dwordx4 v[136:139], v254, s[12:15], s44 offen nt
    v_fmac_f32 v214, s29, v206
    v_fmac_f32 v252, s23, v250
    v_mfma_f32_16x16x32_bf16 a[100:103], v[240:243], v[228:231], a[100:103]
    ds_write_b64 v194, v[202:203] offset:38208
    v_fmac_f32 v214, s23, v210
    v_mfma_f32_16x16x32_bf16 a[104:107], v[244:247], v[228:231], a[104:107]
    buffer_load_dwordx4 a[208:211], v254, s[8:11], s42 offen offset:1024 sc1
    v_mfma_f32_16x16x32_bf16 a[108:111], a[228:231], v[236:239], 0
    s_add_u32 s44, s41, 11264
    v_cvt_pk_bf16_f32 v214, v252, v214
    v_fma_f32 v252, v249, s24, v251
    v_mfma_f32_16x16x32_bf16 a[108:111], a[240:243], v[228:231], a[108:111]
    s_waitcnt lgkmcnt(2)
    v_fmac_f32 v251, -4.0, v249
    v_fma_f32 v249, v248, s24, v250
    v_mfma_f32_16x16x32_bf16 a[108:111], a[252:255], v[232:235], a[108:111]
    ds_write_b64 v194, v[196:197] offset:31968
    v_mfma_f32_16x16x32_bf16 a[112:115], v[240:243], v[232:235], 0
    buffer_load_dwordx4 a[212:215], v254, s[8:11], s42 offen offset:2048 sc1
    v_mfma_f32_16x16x32_bf16 a[112:115], a[244:247], v[228:231], a[112:115]
    s_mov_b32 s42, 79872
    v_fmac_f32 v250, -4.0, v248
    v_fma_f32 v248, v250, s26, v251
    v_mfma_f32_16x16x32_bf16 a[112:115], a[232:235], v[236:239], a[112:115]
    v_fmac_f32 v251, s27, v250
    v_fma_f32 v250, v249, 2.0, v252
    v_fmac_f32 v252, -2.0, v249
    v_mfma_f32_16x16x32_bf16 a[116:119], a[236:239], v[236:239], 0
    ds_read_b128 v[236:239], v253 offset:2080
    v_fma_f32 v249, v208, s24, v212
    v_mfma_f32_16x16x32_bf16 a[116:119], a[248:251], v[228:231], a[116:119]
    buffer_load_dwordx4 a[216:219], v254, s[8:11], s42 offen offset:0 sc1
    v_mfma_f32_16x16x32_bf16 a[116:119], v[244:247], v[232:235], a[116:119]
    v_fmac_f32 v212, -4.0, v208
    v_fma_f32 v208, v206, s24, v210
    v_mfma_f32_16x16x32_bf16 a[120:123], a[228:231], v[228:231], 0
    v_fmac_f32 v210, -4.0, v206
    v_fma_f32 v206, v210, s26, v212
    v_mfma_f32_16x16x32_bf16 a[120:123], a[240:243], v[232:235], a[120:123]
    s_waitcnt lgkmcnt(0)
    v_fmac_f32 v212, s27, v210
    v_fma_f32 v210, v208, 2.0, v249
    v_mfma_f32_16x16x32_bf16 a[120:123], a[252:255], v[236:239], a[120:123]
    v_fmac_f32 v249, -2.0, v208
    v_cvt_pk_bf16_f32 v206, v248, v206
    v_mfma_f32_16x16x32_bf16 a[124:127], v[240:243], v[236:239], 0
    buffer_load_dwordx4 a[220:223], v254, s[8:11], s42 offen offset:1024 sc1
    v_cvt_pk_bf16_f32 v212, v251, v212
    v_mfma_f32_16x16x32_bf16 a[124:127], a[244:247], v[232:235], a[124:127]
    v_cvt_pk_bf16_f32 v210, v250, v210
    v_cvt_pk_bf16_f32 v208, v252, v249
    v_mfma_f32_16x16x32_bf16 a[124:127], a[232:235], v[228:231], a[124:127]
    v_lshlrev_b32 v248, 16, v207
    v_lshlrev_b32 v249, 16, v209
    v_mfma_f32_16x16x32_bf16 a[128:131], a[236:239], v[228:231], 0
    ds_read_b128 v[228:231], v253 offset:3904
    v_lshlrev_b32 v250, 16, v211
    v_mfma_f32_16x16x32_bf16 a[128:131], a[248:251], v[232:235], a[128:131]
    buffer_load_dwordx4 a[224:227], v254, s[8:11], s42 offen offset:2048 sc1
    v_mfma_f32_16x16x32_bf16 a[128:131], v[244:247], v[236:239], a[128:131]
    v_lshlrev_b32 v251, 16, v213
    v_and_b32 v207, s22, v207
    v_mfma_f32_16x16x32_bf16 a[132:135], a[228:231], v[232:235], 0
    buffer_store_dwordx4 v[140:143], v254, s[12:15], s44 offen nt
    v_and_b32 v203, 0x7fff, v255
    v_and_b32 v209, s22, v209
    v_and_b32 v211, s22, v211
    v_mfma_f32_16x16x32_bf16 a[132:135], a[240:243], v[236:239], a[132:135]
    s_waitcnt lgkmcnt(0)
    v_and_b32 v213, s22, v213
    v_lshlrev_b32 v252, 16, v205
    v_mfma_f32_16x16x32_bf16 a[132:135], a[252:255], v[228:231], a[132:135]
    buffer_load_dwordx2 v[192:193], v203, s[4:7], s16 offen offset:1216
    v_mfma_f32_16x16x32_bf16 a[136:139], v[240:243], v[228:231], 0
    v_and_b32 v205, s22, v205
    v_fmac_f32 v252, s25, v251
    v_mfma_f32_16x16x32_bf16 a[136:139], a[244:247], v[236:239], a[136:139]
    v_fmac_f32 v205, s25, v213
    v_fmac_f32 v252, s28, v249
    v_mfma_f32_16x16x32_bf16 a[136:139], a[232:235], v[232:235], a[136:139]
    v_fmac_f32 v205, s28, v209
    v_cvt_pk_bf16_f32 v205, v252, v205
    v_mfma_f32_16x16x32_bf16 a[140:143], a[236:239], v[232:235], 0
    ds_read_b128 v[232:235], v253 offset:3648
    v_lshlrev_b32 v252, 16, v215
    v_mfma_f32_16x16x32_bf16 a[140:143], a[248:251], v[236:239], a[140:143]
    buffer_load_dwordx2 v[194:195], v203, s[4:7], s17 offen offset:1216
    v_and_b32 v215, s22, v215
    v_mfma_f32_16x16x32_bf16 a[140:143], v[244:247], v[228:231], a[140:143]
    v_fmac_f32 v252, s29, v248
    v_fmac_f32 v215, s29, v207
    v_mfma_f32_16x16x32_bf16 a[144:147], a[228:231], v[236:239], 0
    v_fmac_f32 v252, s23, v250
    v_fmac_f32 v215, s23, v211
    v_mfma_f32_16x16x32_bf16 a[144:147], a[240:243], v[228:231], a[144:147]
    s_waitcnt lgkmcnt(0)
    v_cvt_pk_bf16_f32 v215, v252, v215
    v_fma_f32 v252, v249, s24, v251
    v_mfma_f32_16x16x32_bf16 a[144:147], a[252:255], v[232:235], a[144:147]
    buffer_load_dwordx2 v[196:197], v203, s[4:7], s18 offen offset:1216
    v_mfma_f32_16x16x32_bf16 a[148:151], v[240:243], v[232:235], 0
    v_fmac_f32 v251, -4.0, v249
    v_fma_f32 v249, v248, s24, v250
    v_mfma_f32_16x16x32_bf16 a[148:151], a[244:247], v[228:231], a[148:151]
    v_fmac_f32 v250, -4.0, v248
    v_fma_f32 v248, v250, s26, v251
    v_mfma_f32_16x16x32_bf16 a[148:151], a[232:235], v[236:239], a[148:151]
    v_fmac_f32 v251, s27, v250
    v_fma_f32 v250, v249, 2.0, v252
    v_fmac_f32 v252, -2.0, v249
    v_mfma_f32_16x16x32_bf16 a[152:155], a[236:239], v[236:239], 0
    ds_read_b128 v[236:239], v253 offset:3392
    v_fma_f32 v249, v209, s24, v213
    v_mfma_f32_16x16x32_bf16 a[152:155], a[248:251], v[228:231], a[152:155]
    buffer_load_dwordx2 v[198:199], v203, s[4:7], s19 offen offset:1216
    v_mfma_f32_16x16x32_bf16 a[152:155], v[244:247], v[232:235], a[152:155]
    v_fmac_f32 v213, -4.0, v209
    v_fma_f32 v209, v207, s24, v211
    v_mfma_f32_16x16x32_bf16 a[156:159], a[228:231], v[228:231], 0
    v_fmac_f32 v211, -4.0, v207
    v_fma_f32 v207, v211, s26, v213
    v_mfma_f32_16x16x32_bf16 a[156:159], a[240:243], v[232:235], a[156:159]
    s_waitcnt lgkmcnt(0)
    v_fmac_f32 v213, s27, v211
    v_fma_f32 v211, v209, 2.0, v249
    v_mfma_f32_16x16x32_bf16 a[156:159], a[252:255], v[236:239], a[156:159]
    buffer_load_dwordx2 v[200:201], v203, s[4:7], s20 offen offset:1216
    v_fmac_f32 v249, -2.0, v209
    v_mfma_f32_16x16x32_bf16 a[160:163], v[240:243], v[236:239], 0
    v_cvt_pk_bf16_f32 v207, v248, v207
    v_cvt_pk_bf16_f32 v213, v251, v213
    v_mfma_f32_16x16x32_bf16 a[160:163], a[244:247], v[232:235], a[160:163]
    v_cvt_pk_bf16_f32 v211, v250, v211
    v_cvt_pk_bf16_f32 v209, v252, v249
    v_mfma_f32_16x16x32_bf16 a[160:163], a[232:235], v[228:231], a[160:163]
    v_lshrrev_b32 v252, 15, v255
    v_mfma_f32_16x16x32_bf16 a[164:167], a[236:239], v[228:231], 0
    ds_read_b128 v[228:231], v253 offset:3136
    v_mfma_f32_16x16x32_bf16 a[164:167], a[248:251], v[232:235], a[164:167]
    buffer_load_dwordx2 v[202:203], v203, s[4:7], s21 offen offset:1216
    v_mfma_f32_16x16x32_bf16 a[164:167], v[244:247], v[236:239], a[164:167]
    ds_write_b64 v252, v[206:207] offset:8832
    v_mfma_f32_16x16x32_bf16 a[168:171], a[228:231], v[232:235], 0
    s_waitcnt vmcnt(19)
    v_lshrrev_b32 v206, 15, v255
    v_lshlrev_b32 v248, 16, v218
    v_lshlrev_b32 v249, 16, v220
    v_mfma_f32_16x16x32_bf16 a[168:171], a[240:243], v[236:239], a[168:171]
    s_waitcnt lgkmcnt(1)
    v_lshlrev_b32 v250, 16, v222
    v_lshlrev_b32 v251, 16, v224
    v_mfma_f32_16x16x32_bf16 a[168:171], a[252:255], v[228:231], a[168:171]
    ds_write_b64 v206, v[212:213] offset:10912
    v_mfma_f32_16x16x32_bf16 a[172:175], v[240:243], v[228:231], 0
    v_and_b32 v218, s22, v218
    v_and_b32 v220, s22, v220
    v_mfma_f32_16x16x32_bf16 a[172:175], a[244:247], v[236:239], a[172:175]
    ds_write_b64 v206, v[210:211] offset:12992
    v_mfma_f32_16x16x32_bf16 a[172:175], a[232:235], v[232:235], a[172:175]
    v_and_b32 v222, s22, v222
    v_and_b32 v224, s22, v224
    v_mfma_f32_16x16x32_bf16 a[176:179], a[236:239], v[232:235], 0
    ds_read_b128 v[232:235], v253 offset:2864
    v_lshlrev_b32 v252, 16, v216
    v_mfma_f32_16x16x32_bf16 a[176:179], a[248:251], v[236:239], a[176:179]
    ds_write_b64 v206, v[204:205] offset:15072
    v_and_b32 v216, s22, v216
    v_mfma_f32_16x16x32_bf16 a[176:179], v[244:247], v[228:231], a[176:179]
    s_mov_b32 s42, 110592
    v_fmac_f32 v252, s25, v251
    v_fmac_f32 v216, s25, v224
    v_mfma_f32_16x16x32_bf16 a[180:183], a[228:231], v[236:239], 0
    ds_write_b64 v206, v[214:215] offset:37952
    v_mfma_f32_16x16x32_bf16 a[184:187], a[232:235], v[236:239], 0
    v_fmac_f32 v252, s28, v249
    v_fmac_f32 v216, s28, v220
    v_mfma_f32_16x16x32_bf16 a[188:191], a[236:239], v[236:239], 0
    ds_read_b128 v[236:239], v253 offset:5200
    v_cvt_pk_bf16_f32 v216, v252, v216
    v_mfma_f32_16x16x32_bf16 a[188:191], a[248:251], v[228:231], a[188:191]
    buffer_load_dwordx4 a[228:231], v254, s[8:11], s42 offen offset:0 sc1
    v_mfma_f32_16x16x32_bf16 a[184:187], a[244:247], v[228:231], a[184:187]
    s_waitcnt lgkmcnt(3)
    v_lshlrev_b32 v252, 16, v226
    v_and_b32 v226, s22, v226
    v_fmac_f32 v252, s29, v248
    v_mfma_f32_16x16x32_bf16 a[180:183], a[240:243], v[228:231], a[180:183]
    ds_read_b128 v[228:231], v253 offset:4928
    v_fmac_f32 v226, s29, v218
    v_mfma_f32_16x16x32_bf16 a[180:183], a[252:255], v[232:235], a[180:183]
    buffer_load_dwordx4 a[232:235], v254, s[8:11], s42 offen offset:1024 sc1
    v_mfma_f32_16x16x32_bf16 a[184:187], v[240:243], v[232:235], a[184:187]
    s_waitcnt vmcnt(16) lgkmcnt(1)
    v_fmac_f32 v252, s23, v250
    v_fmac_f32 v226, s23, v222
    v_mfma_f32_16x16x32_bf16 a[188:191], v[244:247], v[232:235], a[188:191]
    ds_read_b128 v[232:235], v253 offset:4672
    v_cvt_pk_bf16_f32 v226, v252, v226
sub2:
    v_mfma_f32_16x16x32_bf16 v[0:3], a[192:195], v[236:239], 0
    buffer_load_dwordx4 a[236:239], v254, s[8:11], s42 offen offset:2048 sc1
    v_mfma_f32_16x16x32_bf16 v[4:7], a[196:199], v[236:239], 0
    s_mov_b32 s42, 113664
    v_fma_f32 v252, v249, s24, v251
    v_fmac_f32 v251, -4.0, v249
    v_mfma_f32_16x16x32_bf16 v[8:11], a[200:203], v[236:239], 0
    ds_read_b128 v[236:239], v253 offset:4416
    s_waitcnt vmcnt(13)
    s_waitcnt lgkmcnt(2)
    v_mfma_f32_16x16x32_bf16 v[8:11], a[212:215], v[228:231], v[8:11]
    ds_write_b64 v206, v[208:209] offset:31712
    v_mfma_f32_16x16x32_bf16 v[4:7], a[208:211], v[228:231], v[4:7]
    buffer_load_dwordx4 a[240:243], v254, s[8:11], s42 offen offset:0 sc1
    v_mfma_f32_16x16x32_bf16 v[0:3], a[204:207], v[228:231], v[0:3]
    s_waitcnt vmcnt(11) lgkmcnt(2)
    v_fma_f32 v249, v248, s24, v250
    v_fmac_f32 v250, -4.0, v248
    v_mfma_f32_16x16x32_bf16 v[0:3], a[216:219], v[232:235], v[0:3]
    ds_read_b128 v[204:207], v253 offset:39712
    s_mov_b32 s45, 619910279
    v_mfma_f32_16x16x32_bf16 v[4:7], a[220:223], v[232:235], v[4:7]
    v_bfe_u32 v208, v254, 5, 3
    v_mul_u32_u24 v209, 5, v208
    v_mfma_f32_16x16x32_bf16 v[8:11], a[224:227], v[232:235], v[8:11]
    buffer_load_dwordx4 a[244:247], v254, s[8:11], s42 offen offset:1024 sc1
    v_mfma_f32_16x16x32_bf16 v[12:15], a[192:195], v[228:231], 0
    v_bfe_u32 v209, s45, v209, 5
    v_mul_u32_u24 v209, 65, v209
    v_fma_f32 v248, v250, s26, v251
    v_mfma_f32_16x16x32_bf16 v[12:15], a[204:207], v[232:235], v[12:15]
    s_waitcnt lgkmcnt(2)
    v_sub_u32 v209, v209, v208
    v_lshl_add_u32 v208, v209, 5, v253
    v_mfma_f32_16x16x32_bf16 v[12:15], a[216:219], v[236:239], v[12:15]
    s_waitcnt lgkmcnt(0)
    v_fmac_f32 v251, s27, v250
    v_fma_f32 v250, v249, 2.0, v252
    v_mfma_f32_16x16x32_bf16 v[16:19], a[220:223], v[236:239], 0
    buffer_load_dwordx4 a[248:251], v254, s[8:11], s42 offen offset:2048 sc1
    v_mfma_f32_16x16x32_bf16 v[16:19], a[208:211], v[232:235], v[16:19]
    s_mov_b32 s42, 116736
    v_fmac_f32 v252, -2.0, v249
    v_fma_f32 v249, v220, s24, v224
    v_mfma_f32_16x16x32_bf16 v[16:19], a[196:199], v[228:231], v[16:19]
    s_mov_b64 exec, s[46:47]
    ds_write_b128 v208, v[204:207] offset:1024
    s_mov_b64 exec, -1
    v_mfma_f32_16x16x32_bf16 v[20:23], a[200:203], v[228:231], 0
    ds_read_b128 v[228:231], v253 offset:4160
    v_fmac_f32 v224, -4.0, v220
    v_fma_f32 v220, v218, s24, v222
    v_mfma_f32_16x16x32_bf16 v[20:23], a[212:215], v[232:235], v[20:23]
    buffer_load_dwordx4 a[252:255], v254, s[8:11], s42 offen offset:0 sc1
    v_mfma_f32_16x16x32_bf16 v[20:23], a[224:227], v[236:239], v[20:23]
    v_fmac_f32 v222, -4.0, v218
    v_fma_f32 v218, v222, s26, v224
    v_mfma_f32_16x16x32_bf16 v[24:27], a[192:195], v[232:235], 0
    v_fmac_f32 v224, s27, v222
    v_fma_f32 v222, v220, 2.0, v249
    v_mfma_f32_16x16x32_bf16 v[24:27], a[204:207], v[236:239], v[24:27]
    s_waitcnt lgkmcnt(0)
    v_fmac_f32 v249, -2.0, v220
    v_cvt_pk_bf16_f32 v218, v248, v218
    v_mfma_f32_16x16x32_bf16 v[24:27], a[216:219], v[228:231], v[24:27]
    v_cvt_pk_bf16_f32 v224, v251, v224
    v_cvt_pk_bf16_f32 v222, v250, v222
    v_mfma_f32_16x16x32_bf16 v[28:31], a[220:223], v[228:231], 0
    buffer_load_dwordx4 v[240:243], v254, s[8:11], s42 offen offset:1024 sc1
    v_mfma_f32_16x16x32_bf16 v[28:31], a[208:211], v[236:239], v[28:31]
    v_cvt_pk_bf16_f32 v220, v252, v249
    v_lshlrev_b32 v248, 16, v219
    v_lshlrev_b32 v249, 16, v221
    v_mfma_f32_16x16x32_bf16 v[28:31], a[196:199], v[232:235], v[28:31]
    v_lshlrev_b32 v250, 16, v223
    v_lshlrev_b32 v251, 16, v225
    v_mfma_f32_16x16x32_bf16 v[32:35], a[200:203], v[232:235], 0
    ds_read_b128 v[232:235], v253 offset:5984
    v_and_b32 v219, s22, v219
    v_mfma_f32_16x16x32_bf16 v[32:35], a[212:215], v[236:239], v[32:35]
    buffer_load_dwordx4 v[244:247], v254, s[8:11], s42 offen offset:2048 sc1
    v_mfma_f32_16x16x32_bf16 v[32:35], a[224:227], v[228:231], v[32:35]
    v_and_b32 v221, s22, v221
    v_and_b32 v223, s22, v223
    v_mfma_f32_16x16x32_bf16 v[36:39], a[192:195], v[236:239], 0
    v_and_b32 v215, 0x7fff, v255
    v_and_b32 v225, s22, v225
    v_mfma_f32_16x16x32_bf16 v[36:39], a[204:207], v[228:231], v[36:39]
    s_waitcnt lgkmcnt(0)
    v_lshlrev_b32 v252, 16, v217
    v_and_b32 v217, s22, v217
    v_mfma_f32_16x16x32_bf16 v[36:39], a[216:219], v[232:235], v[36:39]
    buffer_load_dwordx2 v[204:205], v215, s[4:7], s16 offen offset:128
    v_fmac_f32 v252, s25, v251
    v_mfma_f32_16x16x32_bf16 v[40:43], a[220:223], v[232:235], 0
    v_fmac_f32 v217, s25, v225
    v_fmac_f32 v252, s28, v249
    v_mfma_f32_16x16x32_bf16 v[40:43], a[208:211], v[228:231], v[40:43]
    v_fmac_f32 v217, s28, v221
    v_cvt_pk_bf16_f32 v217, v252, v217
    v_mfma_f32_16x16x32_bf16 v[40:43], a[196:199], v[236:239], v[40:43]
    v_lshlrev_b32 v252, 16, v227
    v_and_b32 v227, s22, v227
    v_mfma_f32_16x16x32_bf16 v[44:47], a[200:203], v[236:239], 0
    ds_read_b128 v[236:239], v253 offset:5728
    v_fmac_f32 v252, s29, v248
    v_mfma_f32_16x16x32_bf16 v[44:47], a[212:215], v[228:231], v[44:47]
    buffer_load_dwordx2 v[206:207], v215, s[4:7], s17 offen offset:128
    v_mfma_f32_16x16x32_bf16 v[44:47], a[224:227], v[232:235], v[44:47]
    v_fmac_f32 v227, s29, v219
    v_fmac_f32 v252, s23, v250
    v_fmac_f32 v227, s23, v223
    v_mfma_f32_16x16x32_bf16 v[48:51], a[192:195], v[228:231], 0
    v_cvt_pk_bf16_f32 v227, v252, v227
    v_fma_f32 v252, v249, s24, v251
    v_mfma_f32_16x16x32_bf16 v[48:51], a[204:207], v[232:235], v[48:51]
    s_waitcnt lgkmcnt(0)
    v_fmac_f32 v251, -4.0, v249
    v_fma_f32 v249, v248, s24, v250
    v_mfma_f32_16x16x32_bf16 v[48:51], a[216:219], v[236:239], v[48:51]
    buffer_load_dwordx2 v[208:209], v215, s[4:7], s18 offen offset:128
    v_mfma_f32_16x16x32_bf16 v[52:55], a[220:223], v[236:239], 0
    v_fmac_f32 v250, -4.0, v248
    v_fma_f32 v248, v250, s26, v251
    v_mfma_f32_16x16x32_bf16 v[52:55], a[208:211], v[232:235], v[52:55]
    v_fmac_f32 v251, s27, v250
    v_fma_f32 v250, v249, 2.0, v252
    v_mfma_f32_16x16x32_bf16 v[52:55], a[196:199], v[228:231], v[52:55]
    v_fmac_f32 v252, -2.0, v249
    v_fma_f32 v249, v221, s24, v225
    v_mfma_f32_16x16x32_bf16 v[56:59], a[200:203], v[228:231], 0
    ds_read_b128 v[228:231], v253 offset:5472
    v_fmac_f32 v225, -4.0, v221
    v_fma_f32 v221, v219, s24, v223
    v_mfma_f32_16x16x32_bf16 v[56:59], a[212:215], v[232:235], v[56:59]
    buffer_load_dwordx2 v[210:211], v215, s[4:7], s19 offen offset:128
    v_mfma_f32_16x16x32_bf16 v[56:59], a[224:227], v[236:239], v[56:59]
    v_fmac_f32 v223, -4.0, v219
    v_fma_f32 v219, v223, s26, v225
    v_mfma_f32_16x16x32_bf16 v[60:63], a[192:195], v[232:235], 0
    v_fmac_f32 v225, s27, v223
    v_fma_f32 v223, v221, 2.0, v249
    v_mfma_f32_16x16x32_bf16 v[60:63], a[204:207], v[236:239], v[60:63]
    s_waitcnt lgkmcnt(0)
    v_fmac_f32 v249, -2.0, v221
    v_cvt_pk_bf16_f32 v219, v248, v219
    v_mfma_f32_16x16x32_bf16 v[60:63], a[216:219], v[228:231], v[60:63]
    buffer_load_dwordx2 v[212:213], v215, s[4:7], s20 offen offset:128
    v_mfma_f32_16x16x32_bf16 v[64:67], a[220:223], v[228:231], 0
    v_cvt_pk_bf16_f32 v225, v251, v225
    v_cvt_pk_bf16_f32 v223, v250, v223
    v_mfma_f32_16x16x32_bf16 v[64:67], a[208:211], v[236:239], v[64:67]
    v_cvt_pk_bf16_f32 v221, v252, v249
    v_lshrrev_b32 v252, 15, v255
    v_mfma_f32_16x16x32_bf16 v[64:67], a[196:199], v[232:235], v[64:67]
    ds_write_b64 v252, v[218:219] offset:8576
    v_mfma_f32_16x16x32_bf16 v[68:71], a[200:203], v[232:235], 0
    ds_read_b128 v[232:235], v253 offset:5216
    v_lshrrev_b32 v218, 15, v255
    v_mfma_f32_16x16x32_bf16 v[68:71], a[212:215], v[236:239], v[68:71]
    buffer_load_dwordx2 v[214:215], v215, s[4:7], s21 offen offset:128
    v_mfma_f32_16x16x32_bf16 v[68:71], a[224:227], v[228:231], v[68:71]
    ds_write_b64 v218, v[224:225] offset:10656
    v_mfma_f32_16x16x32_bf16 v[72:75], a[192:195], v[236:239], 0
    s_waitcnt vmcnt(15)
    v_lshlrev_b32 v248, 16, v194
    v_lshlrev_b32 v249, 16, v196
    v_mfma_f32_16x16x32_bf16 v[72:75], a[204:207], v[228:231], v[72:75]
    s_waitcnt lgkmcnt(1)
    v_lshlrev_b32 v250, 16, v198
    v_lshlrev_b32 v251, 16, v200
    v_and_b32 v194, s22, v194
    v_mfma_f32_16x16x32_bf16 v[72:75], a[216:219], v[232:235], v[72:75]
    ds_write_b64 v218, v[222:223] offset:12736
    v_mfma_f32_16x16x32_bf16 v[76:79], a[220:223], v[232:235], 0
    v_and_b32 v196, s22, v196
    v_and_b32 v198, s22, v198
    v_mfma_f32_16x16x32_bf16 v[76:79], a[208:211], v[228:231], v[76:79]
pad1:
    s_cbranch_vccnz pad5
    ds_write_b64 v218, v[216:217] offset:14816
    v_mfma_f32_16x16x32_bf16 v[76:79], a[196:199], v[236:239], v[76:79]
    v_and_b32 v200, s22, v200
    v_lshlrev_b32 v252, 16, v192
    v_mfma_f32_16x16x32_bf16 v[80:83], a[200:203], v[236:239], 0
    ds_read_b128 v[236:239], v253 offset:4944
    v_and_b32 v192, s22, v192
    v_mfma_f32_16x16x32_bf16 v[80:83], a[212:215], v[228:231], v[80:83]
    ds_write_b64 v218, v[226:227] offset:37696
    v_mfma_f32_16x16x32_bf16 v[80:83], a[224:227], v[232:235], v[80:83]
    s_mov_b32 s42, 147456
    v_fmac_f32 v252, s25, v251
    v_fmac_f32 v192, s25, v200
    v_fmac_f32 v252, s28, v249
    v_mfma_f32_16x16x32_bf16 v[84:87], a[192:195], v[228:231], 0
    ds_write_b64 v218, v[220:221] offset:31456
    v_mfma_f32_16x16x32_bf16 v[88:91], a[196:199], v[228:231], 0
    v_fmac_f32 v192, s28, v196
    v_cvt_pk_bf16_f32 v192, v252, v192
    v_mfma_f32_16x16x32_bf16 v[92:95], a[200:203], v[228:231], 0
    ds_read_b128 v[228:231], v253 offset:7280
    v_lshlrev_b32 v252, 16, v202
    v_mfma_f32_16x16x32_bf16 v[92:95], a[212:215], v[232:235], v[92:95]
    buffer_load_dwordx4 a[192:195], v254, s[8:11], s42 offen offset:0 sc1
    v_mfma_f32_16x16x32_bf16 v[88:91], a[208:211], v[232:235], v[88:91]
    s_waitcnt lgkmcnt(3)
    v_and_b32 v202, s22, v202
    v_fmac_f32 v252, s29, v248
    v_mfma_f32_16x16x32_bf16 v[84:87], a[204:207], v[232:235], v[84:87]
    ds_read_b128 v[232:235], v253 offset:7008
    v_fmac_f32 v202, s29, v194
    v_mfma_f32_16x16x32_bf16 v[84:87], a[216:219], v[236:239], v[84:87]
    buffer_load_dwordx4 a[196:199], v254, s[8:11], s42 offen offset:1024 sc1
    v_fmac_f32 v252, s23, v250
    v_mfma_f32_16x16x32_bf16 v[88:91], a[220:223], v[236:239], v[88:91]
    s_waitcnt vmcnt(14) lgkmcnt(1)
    v_fmac_f32 v202, s23, v198
    v_cvt_pk_bf16_f32 v202, v252, v202
    v_mfma_f32_16x16x32_bf16 v[92:95], a[224:227], v[236:239], v[92:95]
    ds_read_b128 v[236:239], v253 offset:6752
    v_fma_f32 v252, v249, s24, v251
sub3:
    v_mfma_f32_16x16x32_bf16 v[96:99], a[228:231], v[228:231], 0
    buffer_load_dwordx4 a[200:203], v254, s[8:11], s42 offen offset:2048 sc1
    v_mfma_f32_16x16x32_bf16 v[100:103], a[232:235], v[228:231], 0
    s_mov_b32 s42, 150528
    v_fmac_f32 v251, -4.0, v249
    v_fma_f32 v249, v248, s24, v250
    v_mfma_f32_16x16x32_bf16 v[104:107], a[236:239], v[228:231], 0
    ds_read_b128 v[228:231], v253 offset:6496
    s_waitcnt vmcnt(12)
    s_waitcnt lgkmcnt(2)
    v_mfma_f32_16x16x32_bf16 v[104:107], a[248:251], v[232:235], v[104:107]
    v_fmac_f32 v250, -4.0, v248
    v_fma_f32 v248, v250, s26, v251
    v_fmac_f32 v251, s27, v250
    v_mfma_f32_16x16x32_bf16 v[100:103], a[244:247], v[232:235], v[100:103]
    buffer_load_dwordx4 a[204:207], v254, s[8:11], s42 offen offset:0 sc1
    v_mfma_f32_16x16x32_bf16 v[96:99], a[240:243], v[232:235], v[96:99]
    s_waitcnt vmcnt(10) lgkmcnt(1)
    v_fma_f32 v250, v249, 2.0, v252
    v_fmac_f32 v252, -2.0, v249
    v_mfma_f32_16x16x32_bf16 v[96:99], a[252:255], v[236:239], v[96:99]
    v_fma_f32 v249, v196, s24, v200
    v_fmac_f32 v200, -4.0, v196
    v_mfma_f32_16x16x32_bf16 v[100:103], v[240:243], v[236:239], v[100:103]
    v_fma_f32 v196, v194, s24, v198
    v_fmac_f32 v198, -4.0, v194
    v_mfma_f32_16x16x32_bf16 v[104:107], v[244:247], v[236:239], v[104:107]
    buffer_load_dwordx4 a[208:211], v254, s[8:11], s42 offen offset:1024 sc1
    v_mfma_f32_16x16x32_bf16 v[108:111], a[228:231], v[232:235], 0
    v_fma_f32 v194, v198, s26, v200
    v_fmac_f32 v200, s27, v198
    v_mfma_f32_16x16x32_bf16 v[108:111], a[240:243], v[236:239], v[108:111]
    s_waitcnt lgkmcnt(0)
    v_fma_f32 v198, v196, 2.0, v249
    v_fmac_f32 v249, -2.0, v196
    v_cvt_pk_bf16_f32 v194, v248, v194
    v_mfma_f32_16x16x32_bf16 v[108:111], a[252:255], v[228:231], v[108:111]
    v_cvt_pk_bf16_f32 v200, v251, v200
    v_cvt_pk_bf16_f32 v198, v250, v198
    v_mfma_f32_16x16x32_bf16 v[112:115], v[240:243], v[228:231], 0
    buffer_load_dwordx4 a[212:215], v254, s[8:11], s42 offen offset:2048 sc1
    v_mfma_f32_16x16x32_bf16 v[112:115], a[244:247], v[236:239], v[112:115]
    s_mov_b32 s42, 153600
    v_cvt_pk_bf16_f32 v196, v252, v249
    v_lshlrev_b32 v248, 16, v195
    v_mfma_f32_16x16x32_bf16 v[112:115], a[232:235], v[232:235], v[112:115]
    v_lshlrev_b32 v249, 16, v197
    v_lshlrev_b32 v250, 16, v199
    v_mfma_f32_16x16x32_bf16 v[116:119], a[236:239], v[232:235], 0
    ds_read_b128 v[232:235], v253 offset:6240
    v_lshlrev_b32 v251, 16, v201
    v_mfma_f32_16x16x32_bf16 v[116:119], a[248:251], v[236:239], v[116:119]
    buffer_load_dwordx4 a[216:219], v254, s[8:11], s42 offen offset:0 sc1
    v_mfma_f32_16x16x32_bf16 v[116:119], v[244:247], v[228:231], v[116:119]
    v_and_b32 v195, s22, v195
    v_and_b32 v197, s22, v197
    v_and_b32 v199, s22, v199
    v_mfma_f32_16x16x32_bf16 v[120:123], a[228:231], v[236:239], 0
    v_and_b32 v201, s22, v201
    v_lshlrev_b32 v252, 16, v193
    v_mfma_f32_16x16x32_bf16 v[120:123], a[240:243], v[228:231], v[120:123]
    s_waitcnt lgkmcnt(0)
    v_and_b32 v193, s22, v193
    v_fmac_f32 v252, s25, v251
    v_mfma_f32_16x16x32_bf16 v[120:123], a[252:255], v[232:235], v[120:123]
    v_fmac_f32 v193, s25, v201
    v_fmac_f32 v252, s28, v249
    v_mfma_f32_16x16x32_bf16 v[124:127], v[240:243], v[232:235], 0
    buffer_load_dwordx4 a[220:223], v254, s[8:11], s42 offen offset:1024 sc1
    v_mfma_f32_16x16x32_bf16 v[124:127], a[244:247], v[228:231], v[124:127]
    v_fmac_f32 v193, s28, v197
    v_cvt_pk_bf16_f32 v193, v252, v193
    v_mfma_f32_16x16x32_bf16 v[124:127], a[232:235], v[236:239], v[124:127]
    v_lshlrev_b32 v252, 16, v203
    v_and_b32 v203, s22, v203
    v_fmac_f32 v252, s29, v248
    v_mfma_f32_16x16x32_bf16 v[128:131], a[236:239], v[236:239], 0
    ds_read_b128 v[236:239], v253 offset:8064
    v_fmac_f32 v203, s29, v195
    v_mfma_f32_16x16x32_bf16 v[128:131], a[248:251], v[228:231], v[128:131]
    buffer_load_dwordx4 a[224:227], v254, s[8:11], s42 offen offset:2048 sc1
    v_mfma_f32_16x16x32_bf16 v[128:131], v[244:247], v[232:235], v[128:131]
    v_fmac_f32 v252, s23, v250
    v_fmac_f32 v203, s23, v199
    v_mfma_f32_16x16x32_bf16 v[132:135], a[228:231], v[228:231], 0
    v_and_b32 v227, 0x7fff, v255
    v_cvt_pk_bf16_f32 v203, v252, v203
    v_mfma_f32_16x16x32_bf16 v[132:135], a[240:243], v[232:235], v[132:135]
    s_waitcnt lgkmcnt(0)
    v_fma_f32 v252, v249, s24, v251
    v_fmac_f32 v251, -4.0, v249
    v_mfma_f32_16x16x32_bf16 v[132:135], a[252:255], v[236:239], v[132:135]
    buffer_load_dwordx2 v[216:217], v227, s[4:7], s16 offen offset:512
    v_mfma_f32_16x16x32_bf16 v[136:139], v[240:243], v[236:239], 0
    v_fma_f32 v249, v248, s24, v250
    v_fmac_f32 v250, -4.0, v248
    v_fma_f32 v248, v250, s26, v251
    v_mfma_f32_16x16x32_bf16 v[136:139], a[244:247], v[232:235], v[136:139]
    v_fmac_f32 v251, s27, v250
    v_fma_f32 v250, v249, 2.0, v252
    v_mfma_f32_16x16x32_bf16 v[136:139], a[232:235], v[228:231], v[136:139]
    v_fmac_f32 v252, -2.0, v249
    v_fma_f32 v249, v197, s24, v201
    v_mfma_f32_16x16x32_bf16 v[140:143], a[236:239], v[228:231], 0
    ds_read_b128 v[228:231], v253 offset:7808
    v_fmac_f32 v201, -4.0, v197
    v_mfma_f32_16x16x32_bf16 v[140:143], a[248:251], v[232:235], v[140:143]
    buffer_load_dwordx2 v[218:219], v227, s[4:7], s17 offen offset:512
    v_mfma_f32_16x16x32_bf16 v[140:143], v[244:247], v[236:239], v[140:143]
    v_fma_f32 v197, v195, s24, v199
    v_fmac_f32 v199, -4.0, v195
    v_mfma_f32_16x16x32_bf16 v[144:147], a[228:231], v[232:235], 0
    v_fma_f32 v195, v199, s26, v201
    v_fmac_f32 v201, s27, v199
    v_mfma_f32_16x16x32_bf16 v[144:147], a[240:243], v[236:239], v[144:147]
    s_waitcnt lgkmcnt(0)
    v_fma_f32 v199, v197, 2.0, v249
    v_fmac_f32 v249, -2.0, v197
    v_cvt_pk_bf16_f32 v195, v248, v195
    v_mfma_f32_16x16x32_bf16 v[144:147], a[252:255], v[228:231], v[144:147]
    buffer_load_dwordx2 v[220:221], v227, s[4:7], s18 offen offset:512
    v_mfma_f32_16x16x32_bf16 v[148:151], v[240:243], v[228:231], 0
    v_cvt_pk_bf16_f32 v201, v251, v201
    v_cvt_pk_bf16_f32 v199, v250, v199
    v_mfma_f32_16x16x32_bf16 v[148:151], a[244:247], v[236:239], v[148:151]
    v_cvt_pk_bf16_f32 v197, v252, v249
    v_lshrrev_b32 v252, 15, v255
    v_mfma_f32_16x16x32_bf16 v[148:151], a[232:235], v[232:235], v[148:151]
    ds_write_b64 v252, v[194:195] offset:8320
    v_mfma_f32_16x16x32_bf16 v[152:155], a[236:239], v[232:235], 0
    ds_read_b128 v[232:235], v253 offset:7552
    v_lshrrev_b32 v194, 15, v255
    v_mfma_f32_16x16x32_bf16 v[152:155], a[248:251], v[236:239], v[152:155]
    buffer_load_dwordx2 v[222:223], v227, s[4:7], s19 offen offset:512
    v_mfma_f32_16x16x32_bf16 v[152:155], v[244:247], v[228:231], v[152:155]
    ds_write_b64 v194, v[200:201] offset:10400
    v_mfma_f32_16x16x32_bf16 v[156:159], a[228:231], v[236:239], 0
    v_mfma_f32_16x16x32_bf16 v[156:159], a[240:243], v[228:231], v[156:159]
    s_waitcnt lgkmcnt(1)
    s_waitcnt vmcnt(13)
    v_lshlrev_b32 v248, 16, v206
    v_mfma_f32_16x16x32_bf16 v[156:159], a[252:255], v[232:235], v[156:159]
    buffer_load_dwordx2 v[224:225], v227, s[4:7], s20 offen offset:512
    v_mfma_f32_16x16x32_bf16 v[160:163], v[240:243], v[232:235], 0
    ds_write_b64 v194, v[198:199] offset:12480
    v_mfma_f32_16x16x32_bf16 v[160:163], a[244:247], v[228:231], v[160:163]
    v_lshlrev_b32 v249, 16, v208
    v_lshlrev_b32 v250, 16, v210
    v_mfma_f32_16x16x32_bf16 v[160:163], a[232:235], v[236:239], v[160:163]
    ds_write_b64 v194, v[192:193] offset:14560
    v_mfma_f32_16x16x32_bf16 v[164:167], a[236:239], v[236:239], 0
    ds_read_b128 v[236:239], v253 offset:7296
    v_lshlrev_b32 v251, 16, v212
    v_mfma_f32_16x16x32_bf16 v[164:167], a[248:251], v[228:231], v[164:167]
    buffer_load_dwordx2 v[226:227], v227, s[4:7], s21 offen offset:512
    v_mfma_f32_16x16x32_bf16 v[164:167], v[244:247], v[232:235], v[164:167]
    ds_write_b64 v194, v[202:203] offset:37440
    v_mfma_f32_16x16x32_bf16 v[168:171], a[228:231], v[228:231], 0
    v_and_b32 v206, s22, v206
    v_and_b32 v208, s22, v208
    v_mfma_f32_16x16x32_bf16 v[168:171], a[240:243], v[232:235], v[168:171]
    s_waitcnt lgkmcnt(1)
    v_and_b32 v210, s22, v210
    v_and_b32 v212, s22, v212
    v_mfma_f32_16x16x32_bf16 v[168:171], a[252:255], v[236:239], v[168:171]
    ds_write_b64 v194, v[196:197] offset:31200
    v_mfma_f32_16x16x32_bf16 v[172:175], v[240:243], v[236:239], 0
    v_lshlrev_b32 v252, 16, v204
    v_and_b32 v204, s22, v204
    v_mfma_f32_16x16x32_bf16 v[172:175], a[244:247], v[232:235], v[172:175]
    v_fmac_f32 v252, s25, v251
    v_fmac_f32 v204, s25, v212
    v_mfma_f32_16x16x32_bf16 v[172:175], a[232:235], v[228:231], v[172:175]
    v_fmac_f32 v252, s28, v249
    v_fmac_f32 v204, s28, v208
    v_mfma_f32_16x16x32_bf16 v[176:179], a[236:239], v[228:231], 0
    ds_read_b128 v[228:231], v253 offset:7024
    v_cvt_pk_bf16_f32 v204, v252, v204
    v_mfma_f32_16x16x32_bf16 v[176:179], a[248:251], v[232:235], v[176:179]
    v_lshlrev_b32 v252, 16, v214
    v_and_b32 v214, s22, v214
    v_mfma_f32_16x16x32_bf16 v[176:179], v[244:247], v[236:239], v[176:179]
    s_mov_b32 s42, 184320
    v_fmac_f32 v252, s29, v248
    v_fmac_f32 v214, s29, v206
    v_mfma_f32_16x16x32_bf16 v[180:183], a[228:231], v[232:235], 0
    s_waitcnt lgkmcnt(0)
    v_fmac_f32 v252, s23, v250
    v_fmac_f32 v214, s23, v210
    v_cvt_pk_bf16_f32 v214, v252, v214
    v_mfma_f32_16x16x32_bf16 v[184:187], a[232:235], v[232:235], 0
    s_barrier
    v_mfma_f32_16x16x32_bf16 v[188:191], a[236:239], v[232:235], 0
    ds_read_b128 v[232:235], v253 offset:9360
    v_fma_f32 v252, v249, s24, v251
    v_mfma_f32_16x16x32_bf16 v[188:191], a[248:251], v[236:239], v[188:191]
    buffer_load_dwordx4 a[228:231], v254, s[8:11], s42 offen offset:0 sc1
    v_mfma_f32_16x16x32_bf16 v[184:187], a[244:247], v[236:239], v[184:187]
    v_fmac_f32 v251, -4.0, v249
    v_fma_f32 v249, v248, s24, v250
    v_mfma_f32_16x16x32_bf16 v[180:183], a[240:243], v[236:239], v[180:183]
    ds_read_b128 v[236:239], v253 offset:9088
    v_fmac_f32 v250, -4.0, v248
    v_mfma_f32_16x16x32_bf16 v[180:183], a[252:255], v[228:231], v[180:183]
    buffer_load_dwordx4 a[232:235], v254, s[8:11], s42 offen offset:1024 sc1
    v_mfma_f32_16x16x32_bf16 v[184:187], v[240:243], v[228:231], v[184:187]
    s_waitcnt vmcnt(14) lgkmcnt(1)
    v_fma_f32 v248, v250, s26, v251
    v_fmac_f32 v251, s27, v250
    v_mfma_f32_16x16x32_bf16 v[188:191], v[244:247], v[228:231], v[188:191]
    ds_read_b128 v[228:231], v253 offset:8832
    v_fma_f32 v250, v249, 2.0, v252
sub4:
    v_mfma_f32_16x16x32_bf16 a[0:3], a[192:195], v[232:235], a[0:3]
    buffer_load_dwordx4 a[236:239], v254, s[8:11], s42 offen offset:2048 sc1
    v_mfma_f32_16x16x32_bf16 a[4:7], a[196:199], v[232:235], a[4:7]
    s_mov_b32 s42, 187392
    v_fmac_f32 v252, -2.0, v249
    v_fma_f32 v249, v208, s24, v212
    v_mfma_f32_16x16x32_bf16 a[8:11], a[200:203], v[232:235], a[8:11]
    ds_read_b128 v[232:235], v253 offset:8576
    s_waitcnt vmcnt(12)
    s_waitcnt lgkmcnt(2)
    v_mfma_f32_16x16x32_bf16 a[8:11], a[212:215], v[236:239], a[8:11]
    v_fmac_f32 v212, -4.0, v208
    v_fma_f32 v208, v206, s24, v210
    v_mfma_f32_16x16x32_bf16 a[4:7], a[208:211], v[236:239], a[4:7]
    buffer_load_dwordx4 a[240:243], v254, s[8:11], s42 offen offset:0 sc1
    v_mfma_f32_16x16x32_bf16 a[0:3], a[204:207], v[236:239], a[0:3]
    s_waitcnt vmcnt(10) lgkmcnt(1)
    v_fmac_f32 v210, -4.0, v206
    v_fma_f32 v206, v210, s26, v212
    v_mfma_f32_16x16x32_bf16 a[0:3], a[216:219], v[228:231], a[0:3]
    v_fmac_f32 v212, s27, v210
    v_fma_f32 v210, v208, 2.0, v249
    v_mfma_f32_16x16x32_bf16 a[4:7], a[220:223], v[228:231], a[4:7]
    v_fmac_f32 v249, -2.0, v208
    v_cvt_pk_bf16_f32 v206, v248, v206
    v_mfma_f32_16x16x32_bf16 a[8:11], a[224:227], v[228:231], a[8:11]
    buffer_load_dwordx4 a[244:247], v254, s[8:11], s42 offen offset:1024 sc1
    v_mfma_f32_16x16x32_bf16 a[12:15], a[192:195], v[236:239], a[12:15]
    v_cvt_pk_bf16_f32 v212, v251, v212
    v_cvt_pk_bf16_f32 v210, v250, v210
    v_mfma_f32_16x16x32_bf16 a[12:15], a[204:207], v[228:231], a[12:15]
    s_waitcnt lgkmcnt(0)
    v_cvt_pk_bf16_f32 v208, v252, v249
    v_lshlrev_b32 v248, 16, v207
    v_mfma_f32_16x16x32_bf16 a[12:15], a[216:219], v[232:235], a[12:15]
    v_lshlrev_b32 v249, 16, v209
    v_lshlrev_b32 v250, 16, v211
    v_mfma_f32_16x16x32_bf16 a[16:19], a[220:223], v[232:235], a[16:19]
    buffer_load_dwordx4 a[248:251], v254, s[8:11], s42 offen offset:2048 sc1
    v_mfma_f32_16x16x32_bf16 a[16:19], a[208:211], v[228:231], a[16:19]
    s_mov_b32 s42, 190464
    v_lshlrev_b32 v251, 16, v213
    v_and_b32 v207, s22, v207
    v_mfma_f32_16x16x32_bf16 a[16:19], a[196:199], v[236:239], a[16:19]
    v_and_b32 v209, s22, v209
    v_and_b32 v211, s22, v211
    v_mfma_f32_16x16x32_bf16 a[20:23], a[200:203], v[236:239], a[20:23]
    ds_read_b128 v[236:239], v253 offset:8320
    v_and_b32 v213, s22, v213
    v_mfma_f32_16x16x32_bf16 a[20:23], a[212:215], v[228:231], a[20:23]
    buffer_load_dwordx4 a[252:255], v254, s[8:11], s42 offen offset:0 sc1
    v_mfma_f32_16x16x32_bf16 a[20:23], a[224:227], v[232:235], a[20:23]
    v_lshlrev_b32 v252, 16, v205
    v_and_b32 v205, s22, v205
    v_mfma_f32_16x16x32_bf16 a[24:27], a[192:195], v[228:231], a[24:27]
    v_fmac_f32 v252, s25, v251
    v_fmac_f32 v205, s25, v213
    v_mfma_f32_16x16x32_bf16 a[24:27], a[204:207], v[232:235], a[24:27]
    s_waitcnt lgkmcnt(0)
    v_fmac_f32 v252, s28, v249
    v_fmac_f32 v205, s28, v209
    v_mfma_f32_16x16x32_bf16 a[24:27], a[216:219], v[236:239], a[24:27]
    v_cvt_pk_bf16_f32 v205, v252, v205
    v_lshlrev_b32 v252, 16, v215
    v_mfma_f32_16x16x32_bf16 a[28:31], a[220:223], v[236:239], a[28:31]
    buffer_load_dwordx4 v[240:243], v254, s[8:11], s42 offen offset:1024 sc1
    v_mfma_f32_16x16x32_bf16 a[28:31], a[208:211], v[232:235], a[28:31]
    v_and_b32 v215, s22, v215
    v_fmac_f32 v252, s29, v248
    v_mfma_f32_16x16x32_bf16 a[28:31], a[196:199], v[228:231], a[28:31]
    v_fmac_f32 v215, s29, v207
    v_fmac_f32 v252, s23, v250
    v_mfma_f32_16x16x32_bf16 a[32:35], a[200:203], v[228:231], a[32:35]
    ds_read_b128 v[228:231], v253 offset:10144
    v_fmac_f32 v215, s23, v211
    v_mfma_f32_16x16x32_bf16 a[32:35], a[212:215], v[232:235], a[32:35]
    buffer_load_dwordx4 v[244:247], v254, s[8:11], s42 offen offset:2048 sc1
    v_mfma_f32_16x16x32_bf16 a[32:35], a[224:227], v[236:239], a[32:35]
    v_cvt_pk_bf16_f32 v215, v252, v215
    v_fma_f32 v252, v249, s24, v251
    v_mfma_f32_16x16x32_bf16 a[36:39], a[192:195], v[232:235], a[36:39]
    v_and_b32 v203, 0x7fff, v255
    v_fmac_f32 v251, -4.0, v249
    v_mfma_f32_16x16x32_bf16 a[36:39], a[204:207], v[236:239], a[36:39]
    s_waitcnt lgkmcnt(0)
    v_fma_f32 v249, v248, s24, v250
    v_fmac_f32 v250, -4.0, v248
    v_mfma_f32_16x16x32_bf16 a[36:39], a[216:219], v[228:231], a[36:39]
    buffer_load_dwordx2 v[192:193], v203, s[4:7], s16 offen offset:896
    v_mfma_f32_16x16x32_bf16 a[40:43], a[220:223], v[228:231], a[40:43]
    v_fma_f32 v248, v250, s26, v251
    v_fmac_f32 v251, s27, v250
    v_mfma_f32_16x16x32_bf16 a[40:43], a[208:211], v[236:239], a[40:43]
    v_fma_f32 v250, v249, 2.0, v252
    v_fmac_f32 v252, -2.0, v249
    v_fma_f32 v249, v209, s24, v213
    v_mfma_f32_16x16x32_bf16 a[40:43], a[196:199], v[232:235], a[40:43]
    v_fmac_f32 v213, -4.0, v209
    v_fma_f32 v209, v207, s24, v211
    v_mfma_f32_16x16x32_bf16 a[44:47], a[200:203], v[232:235], a[44:47]
    ds_read_b128 v[232:235], v253 offset:9888
    v_fmac_f32 v211, -4.0, v207
    v_mfma_f32_16x16x32_bf16 a[44:47], a[212:215], v[236:239], a[44:47]
    buffer_load_dwordx2 v[194:195], v203, s[4:7], s17 offen offset:896
    v_mfma_f32_16x16x32_bf16 a[44:47], a[224:227], v[228:231], a[44:47]
    v_fma_f32 v207, v211, s26, v213
    v_fmac_f32 v213, s27, v211
    v_mfma_f32_16x16x32_bf16 a[48:51], a[192:195], v[236:239], a[48:51]
    v_fma_f32 v211, v209, 2.0, v249
    v_fmac_f32 v249, -2.0, v209
    v_mfma_f32_16x16x32_bf16 a[48:51], a[204:207], v[228:231], a[48:51]
    s_waitcnt lgkmcnt(0)
    v_cvt_pk_bf16_f32 v207, v248, v207
    v_cvt_pk_bf16_f32 v213, v251, v213
    v_mfma_f32_16x16x32_bf16 a[48:51], a[216:219], v[232:235], a[48:51]
    buffer_load_dwordx2 v[196:197], v203, s[4:7], s18 offen offset:896
    v_mfma_f32_16x16x32_bf16 a[52:55], a[220:223], v[232:235], a[52:55]
    v_cvt_pk_bf16_f32 v211, v250, v211
    v_cvt_pk_bf16_f32 v209, v252, v249
    v_mfma_f32_16x16x32_bf16 a[52:55], a[208:211], v[228:231], a[52:55]
    v_lshrrev_b32 v252, 15, v255
    v_mfma_f32_16x16x32_bf16 a[52:55], a[196:199], v[236:239], a[52:55]
    ds_write_b64 v252, v[206:207] offset:768
    v_mfma_f32_16x16x32_bf16 a[56:59], a[200:203], v[236:239], a[56:59]
    ds_read_b128 v[236:239], v253 offset:9632
    v_lshrrev_b32 v206, 15, v255
    v_mfma_f32_16x16x32_bf16 a[56:59], a[212:215], v[228:231], a[56:59]
    buffer_load_dwordx2 v[198:199], v203, s[4:7], s19 offen offset:896
    v_mfma_f32_16x16x32_bf16 a[56:59], a[224:227], v[232:235], a[56:59]
    ds_write_b64 v206, v[212:213] offset:2848
    v_mfma_f32_16x16x32_bf16 a[60:63], a[192:195], v[228:231], a[60:63]
    v_mfma_f32_16x16x32_bf16 a[60:63], a[204:207], v[232:235], a[60:63]
    s_waitcnt lgkmcnt(1)
    s_waitcnt vmcnt(13)
    v_lshlrev_b32 v248, 16, v218
    v_mfma_f32_16x16x32_bf16 a[60:63], a[216:219], v[236:239], a[60:63]
    buffer_load_dwordx2 v[200:201], v203, s[4:7], s20 offen offset:896
    v_mfma_f32_16x16x32_bf16 a[64:67], a[220:223], v[236:239], a[64:67]
    ds_write_b64 v206, v[210:211] offset:4928
    v_mfma_f32_16x16x32_bf16 a[64:67], a[208:211], v[232:235], a[64:67]
    v_lshlrev_b32 v249, 16, v220
    v_lshlrev_b32 v250, 16, v222
    v_mfma_f32_16x16x32_bf16 a[64:67], a[196:199], v[228:231], a[64:67]
    ds_write_b64 v206, v[204:205] offset:17408
    v_mfma_f32_16x16x32_bf16 a[68:71], a[200:203], v[228:231], a[68:71]
    ds_read_b128 v[228:231], v253 offset:9376
    v_lshlrev_b32 v251, 16, v224
    v_mfma_f32_16x16x32_bf16 a[68:71], a[212:215], v[232:235], a[68:71]
    buffer_load_dwordx2 v[202:203], v203, s[4:7], s21 offen offset:896
    v_mfma_f32_16x16x32_bf16 a[68:71], a[224:227], v[236:239], a[68:71]
    ds_write_b64 v206, v[214:215] offset:25728
    v_mfma_f32_16x16x32_bf16 a[72:75], a[192:195], v[232:235], a[72:75]
    v_and_b32 v218, s22, v218
    v_and_b32 v220, s22, v220
    v_mfma_f32_16x16x32_bf16 a[72:75], a[204:207], v[236:239], a[72:75]
    s_waitcnt lgkmcnt(1)
    v_and_b32 v222, s22, v222
    v_and_b32 v224, s22, v224
    v_mfma_f32_16x16x32_bf16 a[72:75], a[216:219], v[228:231], a[72:75]
    ds_write_b64 v206, v[208:209] offset:7008
    v_mfma_f32_16x16x32_bf16 a[76:79], a[220:223], v[228:231], a[76:79]
    v_lshlrev_b32 v252, 16, v216
    v_and_b32 v216, s22, v216
    v_mfma_f32_16x16x32_bf16 a[76:79], a[208:211], v[236:239], a[76:79]
    v_fmac_f32 v252, s25, v251
    v_fmac_f32 v216, s25, v224
    v_mfma_f32_16x16x32_bf16 a[76:79], a[196:199], v[232:235], a[76:79]
    v_fmac_f32 v252, s28, v249
    v_fmac_f32 v216, s28, v220
    v_mfma_f32_16x16x32_bf16 a[80:83], a[200:203], v[232:235], a[80:83]
    ds_read_b128 v[232:235], v253 offset:9104
    v_cvt_pk_bf16_f32 v216, v252, v216
    v_mfma_f32_16x16x32_bf16 a[80:83], a[212:215], v[236:239], a[80:83]
    v_lshlrev_b32 v252, 16, v226
    v_and_b32 v226, s22, v226
    v_mfma_f32_16x16x32_bf16 a[80:83], a[224:227], v[228:231], a[80:83]
    s_mov_b32 s42, 221184
    v_fmac_f32 v252, s29, v248
    v_fmac_f32 v226, s29, v218
    v_mfma_f32_16x16x32_bf16 a[84:87], a[192:195], v[236:239], a[84:87]
    v_fmac_f32 v252, s23, v250
    v_fmac_f32 v226, s23, v222
    v_mfma_f32_16x16x32_bf16 a[88:91], a[196:199], v[236:239], a[88:91]
    v_cvt_pk_bf16_f32 v226, v252, v226
    v_fma_f32 v252, v249, s24, v251
    v_mfma_f32_16x16x32_bf16 a[92:95], a[200:203], v[236:239], a[92:95]
    ds_read_b128 v[236:239], v253 offset:11440
    v_fmac_f32 v251, -4.0, v249
    v_mfma_f32_16x16x32_bf16 a[92:95], a[212:215], v[228:231], a[92:95]
    buffer_load_dwordx4 a[192:195], v254, s[8:11], s42 offen offset:0 sc1
    v_mfma_f32_16x16x32_bf16 a[88:91], a[208:211], v[228:231], a[88:91]
    s_waitcnt lgkmcnt(1)
    v_fma_f32 v249, v248, s24, v250
    v_fmac_f32 v250, -4.0, v248
    v_mfma_f32_16x16x32_bf16 a[84:87], a[204:207], v[228:231], a[84:87]
    ds_read_b128 v[228:231], v253 offset:11168
    v_fma_f32 v248, v250, s26, v251
    v_mfma_f32_16x16x32_bf16 a[84:87], a[216:219], v[232:235], a[84:87]
    buffer_load_dwordx4 a[196:199], v254, s[8:11], s42 offen offset:1024 sc1
    v_mfma_f32_16x16x32_bf16 a[88:91], a[220:223], v[232:235], a[88:91]
    s_waitcnt vmcnt(14) lgkmcnt(1)
    v_fmac_f32 v251, s27, v250
    v_fma_f32 v250, v249, 2.0, v252
    v_mfma_f32_16x16x32_bf16 a[92:95], a[224:227], v[232:235], a[92:95]
    ds_read_b128 v[232:235], v253 offset:10912
    v_fmac_f32 v252, -2.0, v249
    v_fma_f32 v249, v220, s24, v224
sub5:
    v_mfma_f32_16x16x32_bf16 a[96:99], a[228:231], v[236:239], a[96:99]
    buffer_load_dwordx4 a[200:203], v254, s[8:11], s42 offen offset:2048 sc1
    v_mfma_f32_16x16x32_bf16 a[100:103], a[232:235], v[236:239], a[100:103]
    s_mov_b32 s42, 224256
    v_fmac_f32 v224, -4.0, v220
    v_fma_f32 v220, v218, s24, v222
    v_mfma_f32_16x16x32_bf16 a[104:107], a[236:239], v[236:239], a[104:107]
    ds_read_b128 v[236:239], v253 offset:10656
    s_waitcnt vmcnt(12)
    s_waitcnt lgkmcnt(2)
    v_mfma_f32_16x16x32_bf16 a[104:107], a[248:251], v[228:231], a[104:107]
    v_fmac_f32 v222, -4.0, v218
    v_fma_f32 v218, v222, s26, v224
    v_mfma_f32_16x16x32_bf16 a[100:103], a[244:247], v[228:231], a[100:103]
    buffer_load_dwordx4 a[204:207], v254, s[8:11], s42 offen offset:0 sc1
    v_mfma_f32_16x16x32_bf16 a[96:99], a[240:243], v[228:231], a[96:99]
    s_waitcnt vmcnt(10) lgkmcnt(1)
    v_fmac_f32 v224, s27, v222
    v_fma_f32 v222, v220, 2.0, v249
    v_mfma_f32_16x16x32_bf16 a[96:99], a[252:255], v[232:235], a[96:99]
    v_fmac_f32 v249, -2.0, v220
    v_cvt_pk_bf16_f32 v218, v248, v218
    v_mfma_f32_16x16x32_bf16 a[100:103], v[240:243], v[232:235], a[100:103]
    v_cvt_pk_bf16_f32 v224, v251, v224
    v_cvt_pk_bf16_f32 v222, v250, v222
    v_mfma_f32_16x16x32_bf16 a[104:107], v[244:247], v[232:235], a[104:107]
    buffer_load_dwordx4 a[208:211], v254, s[8:11], s42 offen offset:1024 sc1
    v_mfma_f32_16x16x32_bf16 a[108:111], a[228:231], v[228:231], a[108:111]
    v_cvt_pk_bf16_f32 v220, v252, v249
    v_lshlrev_b32 v248, 16, v219
    v_mfma_f32_16x16x32_bf16 a[108:111], a[240:243], v[232:235], a[108:111]
    s_waitcnt lgkmcnt(0)
    v_lshlrev_b32 v249, 16, v221
    v_lshlrev_b32 v250, 16, v223
    v_mfma_f32_16x16x32_bf16 a[108:111], a[252:255], v[236:239], a[108:111]
    v_lshlrev_b32 v251, 16, v225
    v_and_b32 v219, s22, v219
    v_mfma_f32_16x16x32_bf16 a[112:115], v[240:243], v[236:239], a[112:115]
    buffer_load_dwordx4 a[212:215], v254, s[8:11], s42 offen offset:2048 sc1
    v_mfma_f32_16x16x32_bf16 a[112:115], a[244:247], v[232:235], a[112:115]
    s_mov_b32 s42, 227328
    v_and_b32 v221, s22, v221
    v_and_b32 v223, s22, v223
    v_mfma_f32_16x16x32_bf16 a[112:115], a[232:235], v[228:231], a[112:115]
    v_and_b32 v225, s22, v225
    v_lshlrev_b32 v252, 16, v217
    v_mfma_f32_16x16x32_bf16 a[116:119], a[236:239], v[228:231], a[116:119]
    ds_read_b128 v[228:231], v253 offset:10400
    v_and_b32 v217, s22, v217
    v_mfma_f32_16x16x32_bf16 a[116:119], a[248:251], v[232:235], a[116:119]
    buffer_load_dwordx4 a[216:219], v254, s[8:11], s42 offen offset:0 sc1
    v_mfma_f32_16x16x32_bf16 a[116:119], v[244:247], v[236:239], a[116:119]
    v_fmac_f32 v252, s25, v251
    v_fmac_f32 v217, s25, v225
    v_mfma_f32_16x16x32_bf16 a[120:123], a[228:231], v[232:235], a[120:123]
    v_fmac_f32 v252, s28, v249
    v_fmac_f32 v217, s28, v221
    v_mfma_f32_16x16x32_bf16 a[120:123], a[240:243], v[236:239], a[120:123]
    s_waitcnt lgkmcnt(0)
    v_cvt_pk_bf16_f32 v217, v252, v217
    v_lshlrev_b32 v252, 16, v227
    v_mfma_f32_16x16x32_bf16 a[120:123], a[252:255], v[228:231], a[120:123]
    v_and_b32 v227, s22, v227
    v_fmac_f32 v252, s29, v248
    v_mfma_f32_16x16x32_bf16 a[124:127], v[240:243], v[228:231], a[124:127]
    buffer_load_dwordx4 a[220:223], v254, s[8:11], s42 offen offset:1024 sc1
    v_mfma_f32_16x16x32_bf16 a[124:127], a[244:247], v[236:239], a[124:127]
    v_fmac_f32 v227, s29, v219
    v_fmac_f32 v252, s23, v250
    v_mfma_f32_16x16x32_bf16 a[124:127], a[232:235], v[232:235], a[124:127]
    v_fmac_f32 v227, s23, v223
    v_cvt_pk_bf16_f32 v227, v252, v227
    v_mfma_f32_16x16x32_bf16 a[128:131], a[236:239], v[232:235], a[128:131]
    ds_read_b128 v[232:235], v253 offset:12224
    v_fma_f32 v252, v249, s24, v251
    v_mfma_f32_16x16x32_bf16 a[128:131], a[248:251], v[236:239], a[128:131]
    buffer_load_dwordx4 a[224:227], v254, s[8:11], s42 offen offset:2048 sc1
    v_mfma_f32_16x16x32_bf16 a[128:131], v[244:247], v[228:231], a[128:131]
    v_fmac_f32 v251, -4.0, v249
    v_fma_f32 v249, v248, s24, v250
    v_mfma_f32_16x16x32_bf16 a[132:135], a[228:231], v[236:239], a[132:135]
    v_and_b32 v215, 0x7fff, v255
    v_fmac_f32 v250, -4.0, v248
    v_mfma_f32_16x16x32_bf16 a[132:135], a[240:243], v[228:231], a[132:135]
    s_waitcnt lgkmcnt(0)
    v_fma_f32 v248, v250, s26, v251
    v_fmac_f32 v251, s27, v250
    v_mfma_f32_16x16x32_bf16 a[132:135], a[252:255], v[232:235], a[132:135]
    buffer_load_dwordx2 v[204:205], v215, s[4:7], s16 offen offset:1280
    v_mfma_f32_16x16x32_bf16 a[136:139], v[240:243], v[232:235], a[136:139]
    v_fma_f32 v250, v249, 2.0, v252
    v_fmac_f32 v252, -2.0, v249
    v_mfma_f32_16x16x32_bf16 a[136:139], a[244:247], v[228:231], a[136:139]
    v_fma_f32 v249, v221, s24, v225
    v_fmac_f32 v225, -4.0, v221
    v_mfma_f32_16x16x32_bf16 a[136:139], a[232:235], v[236:239], a[136:139]
    v_fma_f32 v221, v219, s24, v223
    v_fmac_f32 v223, -4.0, v219
    v_mfma_f32_16x16x32_bf16 a[140:143], a[236:239], v[236:239], a[140:143]
    ds_read_b128 v[236:239], v253 offset:11968
    v_fma_f32 v219, v223, s26, v225
    v_mfma_f32_16x16x32_bf16 a[140:143], a[248:251], v[228:231], a[140:143]
    buffer_load_dwordx2 v[206:207], v215, s[4:7], s17 offen offset:1280
    v_mfma_f32_16x16x32_bf16 a[140:143], v[244:247], v[232:235], a[140:143]
    v_fmac_f32 v225, s27, v223
    v_fma_f32 v223, v221, 2.0, v249
    v_mfma_f32_16x16x32_bf16 a[144:147], a[228:231], v[228:231], a[144:147]
    v_fmac_f32 v249, -2.0, v221
    v_cvt_pk_bf16_f32 v219, v248, v219
    v_mfma_f32_16x16x32_bf16 a[144:147], a[240:243], v[232:235], a[144:147]
    s_waitcnt lgkmcnt(0)
    v_cvt_pk_bf16_f32 v225, v251, v225
    v_cvt_pk_bf16_f32 v223, v250, v223
    v_mfma_f32_16x16x32_bf16 a[144:147], a[252:255], v[236:239], a[144:147]
    buffer_load_dwordx2 v[208:209], v215, s[4:7], s18 offen offset:1280
    v_mfma_f32_16x16x32_bf16 a[148:151], v[240:243], v[236:239], a[148:151]
    v_cvt_pk_bf16_f32 v221, v252, v249
    v_lshrrev_b32 v252, 15, v255
    v_mfma_f32_16x16x32_bf16 a[148:151], a[244:247], v[232:235], a[148:151]
    ds_write_b64 v252, v[218:219] offset:512
    v_mfma_f32_16x16x32_bf16 a[148:151], a[232:235], v[228:231], a[148:151]
    v_lshrrev_b32 v218, 15, v255
    v_mfma_f32_16x16x32_bf16 a[152:155], a[236:239], v[228:231], a[152:155]
    ds_read_b128 v[228:231], v253 offset:11712
    v_mfma_f32_16x16x32_bf16 a[152:155], a[248:251], v[232:235], a[152:155]
    buffer_load_dwordx2 v[210:211], v215, s[4:7], s19 offen offset:1280
    v_mfma_f32_16x16x32_bf16 a[152:155], v[244:247], v[236:239], a[152:155]
    ds_write_b64 v218, v[224:225] offset:2592
    v_mfma_f32_16x16x32_bf16 a[156:159], a[228:231], v[232:235], a[156:159]
    v_mfma_f32_16x16x32_bf16 a[156:159], a[240:243], v[236:239], a[156:159]
    s_waitcnt lgkmcnt(1)
    s_waitcnt vmcnt(13)
    v_lshlrev_b32 v248, 16, v194
    v_mfma_f32_16x16x32_bf16 a[156:159], a[252:255], v[228:231], a[156:159]
    buffer_load_dwordx2 v[212:213], v215, s[4:7], s20 offen offset:1280
    v_mfma_f32_16x16x32_bf16 a[160:163], v[240:243], v[228:231], a[160:163]
    ds_write_b64 v218, v[222:223] offset:4672
    v_mfma_f32_16x16x32_bf16 a[160:163], a[244:247], v[236:239], a[160:163]
    v_lshlrev_b32 v249, 16, v196
    v_lshlrev_b32 v250, 16, v198
    v_mfma_f32_16x16x32_bf16 a[160:163], a[232:235], v[232:235], a[160:163]
    ds_write_b64 v218, v[216:217] offset:17152
    v_mfma_f32_16x16x32_bf16 a[164:167], a[236:239], v[232:235], a[164:167]
    ds_read_b128 v[232:235], v253 offset:11456
    v_lshlrev_b32 v251, 16, v200
    v_mfma_f32_16x16x32_bf16 a[164:167], a[248:251], v[236:239], a[164:167]
    buffer_load_dwordx2 v[214:215], v215, s[4:7], s21 offen offset:1280
    v_mfma_f32_16x16x32_bf16 a[164:167], v[244:247], v[228:231], a[164:167]
    ds_write_b64 v218, v[226:227] offset:25472
    v_mfma_f32_16x16x32_bf16 a[168:171], a[228:231], v[236:239], a[168:171]
    v_and_b32 v194, s22, v194
    v_and_b32 v196, s22, v196
    v_mfma_f32_16x16x32_bf16 a[168:171], a[240:243], v[228:231], a[168:171]
    s_waitcnt lgkmcnt(1)
    v_and_b32 v198, s22, v198
    v_and_b32 v200, s22, v200
    v_mfma_f32_16x16x32_bf16 a[168:171], a[252:255], v[232:235], a[168:171]
pad2:
    s_cbranch_vccnz pad6
    ds_write_b64 v218, v[220:221] offset:6752
    v_mfma_f32_16x16x32_bf16 a[172:175], v[240:243], v[232:235], a[172:175]
    ds_read_b128 v[216:219], v253 offset:39904
    s_mov_b32 s45, 405865480
    v_mfma_f32_16x16x32_bf16 a[172:175], a[244:247], v[228:231], a[172:175]
    v_bfe_u32 v220, v254, 5, 3
    v_mul_u32_u24 v221, 5, v220
    v_mfma_f32_16x16x32_bf16 a[172:175], a[232:235], v[236:239], a[172:175]
    v_bfe_u32 v221, s45, v221, 5
    v_mul_u32_u24 v221, 65, v221
    v_mfma_f32_16x16x32_bf16 a[176:179], a[236:239], v[236:239], a[176:179]
    ds_read_b128 v[236:239], v253 offset:11184
    v_sub_u32 v221, v221, v220
    v_mfma_f32_16x16x32_bf16 a[176:179], a[248:251], v[228:231], a[176:179]
    v_lshl_add_u32 v220, v221, 5, v253
    s_waitcnt lgkmcnt(1)
    v_mfma_f32_16x16x32_bf16 a[176:179], v[244:247], v[232:235], a[176:179]
    s_mov_b32 s42, 258048
    v_lshlrev_b32 v252, 16, v192
    v_and_b32 v192, s22, v192
    v_mfma_f32_16x16x32_bf16 a[180:183], a[228:231], v[228:231], a[180:183]
    s_mov_b64 exec, s[46:47]
    ds_write_b128 v220, v[216:219] offset:1024
    s_mov_b64 exec, -1
    v_mfma_f32_16x16x32_bf16 a[184:187], a[232:235], v[228:231], a[184:187]
    v_fmac_f32 v252, s25, v251
    v_fmac_f32 v192, s25, v200
    v_mfma_f32_16x16x32_bf16 a[188:191], a[236:239], v[228:231], a[188:191]
    ds_read_b128 v[228:231], v253 offset:13520
    v_fmac_f32 v252, s28, v249
    v_mfma_f32_16x16x32_bf16 a[188:191], a[248:251], v[232:235], a[188:191]
    buffer_load_dwordx4 a[228:231], v254, s[8:11], s42 offen offset:0 sc1
    v_mfma_f32_16x16x32_bf16 a[184:187], a[244:247], v[232:235], a[184:187]
    s_waitcnt lgkmcnt(2)
    v_fmac_f32 v192, s28, v196
    v_cvt_pk_bf16_f32 v192, v252, v192
    v_mfma_f32_16x16x32_bf16 a[180:183], a[240:243], v[232:235], a[180:183]
    ds_read_b128 v[232:235], v253 offset:13248
    v_lshlrev_b32 v252, 16, v202
    v_mfma_f32_16x16x32_bf16 a[180:183], a[252:255], v[236:239], a[180:183]
    buffer_load_dwordx4 a[232:235], v254, s[8:11], s42 offen offset:1024 sc1
    v_mfma_f32_16x16x32_bf16 a[184:187], v[240:243], v[236:239], a[184:187]
    s_waitcnt vmcnt(14) lgkmcnt(1)
    v_and_b32 v202, s22, v202
    v_fmac_f32 v252, s29, v248
    v_mfma_f32_16x16x32_bf16 a[188:191], v[244:247], v[236:239], a[188:191]
    ds_read_b128 v[236:239], v253 offset:12992
    v_fmac_f32 v202, s29, v194
sub6:
    v_mfma_f32_16x16x32_bf16 v[0:3], a[192:195], v[228:231], v[0:3]
    buffer_load_dwordx4 a[236:239], v254, s[8:11], s42 offen offset:2048 sc1
    v_mfma_f32_16x16x32_bf16 v[4:7], a[196:199], v[228:231], v[4:7]
    s_mov_b32 s42, 261120
    v_fmac_f32 v252, s23, v250
    v_fmac_f32 v202, s23, v198
    v_mfma_f32_16x16x32_bf16 v[8:11], a[200:203], v[228:231], v[8:11]
    ds_read_b128 v[228:231], v253 offset:12736
    s_waitcnt vmcnt(12)
    s_waitcnt lgkmcnt(2)
    v_mfma_f32_16x16x32_bf16 v[8:11], a[212:215], v[232:235], v[8:11]
    v_cvt_pk_bf16_f32 v202, v252, v202
    v_fma_f32 v252, v249, s24, v251
    v_mfma_f32_16x16x32_bf16 v[4:7], a[208:211], v[232:235], v[4:7]
    buffer_load_dwordx4 a[240:243], v254, s[8:11], s42 offen offset:0 sc1
    v_mfma_f32_16x16x32_bf16 v[0:3], a[204:207], v[232:235], v[0:3]
    s_waitcnt vmcnt(10) lgkmcnt(1)
    v_fmac_f32 v251, -4.0, v249
    v_fma_f32 v249, v248, s24, v250
    v_mfma_f32_16x16x32_bf16 v[0:3], a[216:219], v[236:239], v[0:3]
    v_fmac_f32 v250, -4.0, v248
    v_fma_f32 v248, v250, s26, v251
    v_mfma_f32_16x16x32_bf16 v[4:7], a[220:223], v[236:239], v[4:7]
    v_fmac_f32 v251, s27, v250
    v_fma_f32 v250, v249, 2.0, v252
    v_fmac_f32 v252, -2.0, v249
    v_mfma_f32_16x16x32_bf16 v[8:11], a[224:227], v[236:239], v[8:11]
    buffer_load_dwordx4 a[244:247], v254, s[8:11], s42 offen offset:1024 sc1
    v_mfma_f32_16x16x32_bf16 v[12:15], a[192:195], v[232:235], v[12:15]
    v_fma_f32 v249, v196, s24, v200
    v_fmac_f32 v200, -4.0, v196
    v_mfma_f32_16x16x32_bf16 v[12:15], a[204:207], v[236:239], v[12:15]
    s_waitcnt lgkmcnt(0)
    v_fma_f32 v196, v194, s24, v198
    v_fmac_f32 v198, -4.0, v194
    v_mfma_f32_16x16x32_bf16 v[12:15], a[216:219], v[228:231], v[12:15]
    v_fma_f32 v194, v198, s26, v200
    v_fmac_f32 v200, s27, v198
    v_mfma_f32_16x16x32_bf16 v[16:19], a[220:223], v[228:231], v[16:19]
    buffer_load_dwordx4 a[248:251], v254, s[8:11], s42 offen offset:2048 sc1
    v_mfma_f32_16x16x32_bf16 v[16:19], a[208:211], v[236:239], v[16:19]
    s_mov_b32 s42, 264192
    v_fma_f32 v198, v196, 2.0, v249
    v_fmac_f32 v249, -2.0, v196
    v_mfma_f32_16x16x32_bf16 v[16:19], a[196:199], v[232:235], v[16:19]
    v_cvt_pk_bf16_f32 v194, v248, v194
    v_cvt_pk_bf16_f32 v200, v251, v200
    v_mfma_f32_16x16x32_bf16 v[20:23], a[200:203], v[232:235], v[20:23]
    ds_read_b128 v[232:235], v253 offset:12480
    v_cvt_pk_bf16_f32 v198, v250, v198
    v_mfma_f32_16x16x32_bf16 v[20:23], a[212:215], v[236:239], v[20:23]
    buffer_load_dwordx4 a[252:255], v254, s[8:11], s42 offen offset:0 sc1
    v_mfma_f32_16x16x32_bf16 v[20:23], a[224:227], v[228:231], v[20:23]
    v_cvt_pk_bf16_f32 v196, v252, v249
    v_lshlrev_b32 v248, 16, v195
    v_mfma_f32_16x16x32_bf16 v[24:27], a[192:195], v[236:239], v[24:27]
    v_lshlrev_b32 v249, 16, v197
    v_lshlrev_b32 v250, 16, v199
    v_mfma_f32_16x16x32_bf16 v[24:27], a[204:207], v[228:231], v[24:27]
    s_waitcnt lgkmcnt(0)
    v_lshlrev_b32 v251, 16, v201
    v_and_b32 v195, s22, v195
    v_mfma_f32_16x16x32_bf16 v[24:27], a[216:219], v[232:235], v[24:27]
    v_and_b32 v197, s22, v197
    v_and_b32 v199, s22, v199
    v_mfma_f32_16x16x32_bf16 v[28:31], a[220:223], v[232:235], v[28:31]
    buffer_load_dwordx4 v[240:243], v254, s[8:11], s42 offen offset:1024 sc1
    v_mfma_f32_16x16x32_bf16 v[28:31], a[208:211], v[228:231], v[28:31]
    v_and_b32 v201, s22, v201
    v_lshlrev_b32 v252, 16, v193
    v_mfma_f32_16x16x32_bf16 v[28:31], a[196:199], v[236:239], v[28:31]
    v_and_b32 v193, s22, v193
    v_fmac_f32 v252, s25, v251
    v_mfma_f32_16x16x32_bf16 v[32:35], a[200:203], v[236:239], v[32:35]
    ds_read_b128 v[236:239], v253 offset:14304
    v_fmac_f32 v193, s25, v201
    v_mfma_f32_16x16x32_bf16 v[32:35], a[212:215], v[228:231], v[32:35]
    buffer_load_dwordx4 v[244:247], v254, s[8:11], s42 offen offset:2048 sc1
    v_mfma_f32_16x16x32_bf16 v[32:35], a[224:227], v[232:235], v[32:35]
    v_fmac_f32 v252, s28, v249
    v_fmac_f32 v193, s28, v197
    v_mfma_f32_16x16x32_bf16 v[36:39], a[192:195], v[228:231], v[36:39]
    v_and_b32 v227, 0x7fff, v255
    v_cvt_pk_bf16_f32 v193, v252, v193
    v_mfma_f32_16x16x32_bf16 v[36:39], a[204:207], v[232:235], v[36:39]
    s_waitcnt lgkmcnt(0)
    v_lshlrev_b32 v252, 16, v203
    v_and_b32 v203, s22, v203
    v_mfma_f32_16x16x32_bf16 v[36:39], a[216:219], v[236:239], v[36:39]
    buffer_load_dwordx2 v[216:217], v227, s[4:7], s16 offen offset:192
    v_mfma_f32_16x16x32_bf16 v[40:43], a[220:223], v[236:239], v[40:43]
    v_fmac_f32 v252, s29, v248
    v_fmac_f32 v203, s29, v195
    v_mfma_f32_16x16x32_bf16 v[40:43], a[208:211], v[232:235], v[40:43]
    v_fmac_f32 v252, s23, v250
    v_fmac_f32 v203, s23, v199
    v_mfma_f32_16x16x32_bf16 v[40:43], a[196:199], v[228:231], v[40:43]
    v_cvt_pk_bf16_f32 v203, v252, v203
    v_fma_f32 v252, v249, s24, v251
    v_mfma_f32_16x16x32_bf16 v[44:47], a[200:203], v[228:231], v[44:47]
    ds_read_b128 v[228:231], v253 offset:14048
    v_fmac_f32 v251, -4.0, v249
    v_mfma_f32_16x16x32_bf16 v[44:47], a[212:215], v[232:235], v[44:47]
    buffer_load_dwordx2 v[218:219], v227, s[4:7], s17 offen offset:192
    v_mfma_f32_16x16x32_bf16 v[44:47], a[224:227], v[236:239], v[44:47]
    v_fma_f32 v249, v248, s24, v250
    v_fmac_f32 v250, -4.0, v248
    v_mfma_f32_16x16x32_bf16 v[48:51], a[192:195], v[232:235], v[48:51]
    v_fma_f32 v248, v250, s26, v251
    v_fmac_f32 v251, s27, v250
    v_mfma_f32_16x16x32_bf16 v[48:51], a[204:207], v[236:239], v[48:51]
    s_waitcnt lgkmcnt(0)
    v_fma_f32 v250, v249, 2.0, v252
    v_fmac_f32 v252, -2.0, v249
    v_mfma_f32_16x16x32_bf16 v[48:51], a[216:219], v[228:231], v[48:51]
    buffer_load_dwordx2 v[220:221], v227, s[4:7], s18 offen offset:192
    v_mfma_f32_16x16x32_bf16 v[52:55], a[220:223], v[228:231], v[52:55]
    v_fma_f32 v249, v197, s24, v201
    v_fmac_f32 v201, -4.0, v197
    v_mfma_f32_16x16x32_bf16 v[52:55], a[208:211], v[236:239], v[52:55]
    v_fma_f32 v197, v195, s24, v199
    v_fmac_f32 v199, -4.0, v195
    v_mfma_f32_16x16x32_bf16 v[52:55], a[196:199], v[232:235], v[52:55]
    v_fma_f32 v195, v199, s26, v201
    v_fmac_f32 v201, s27, v199
    v_mfma_f32_16x16x32_bf16 v[56:59], a[200:203], v[232:235], v[56:59]
    ds_read_b128 v[232:235], v253 offset:13792
    v_fma_f32 v199, v197, 2.0, v249
    v_mfma_f32_16x16x32_bf16 v[56:59], a[212:215], v[236:239], v[56:59]
    buffer_load_dwordx2 v[222:223], v227, s[4:7], s19 offen offset:192
    v_mfma_f32_16x16x32_bf16 v[56:59], a[224:227], v[228:231], v[56:59]
    v_fmac_f32 v249, -2.0, v197
    v_cvt_pk_bf16_f32 v195, v248, v195
    v_mfma_f32_16x16x32_bf16 v[60:63], a[192:195], v[236:239], v[60:63]
    v_cvt_pk_bf16_f32 v201, v251, v201
    v_cvt_pk_bf16_f32 v199, v250, v199
    v_mfma_f32_16x16x32_bf16 v[60:63], a[204:207], v[228:231], v[60:63]
    s_waitcnt lgkmcnt(0)
    v_cvt_pk_bf16_f32 v197, v252, v249
    v_lshrrev_b32 v252, 15, v255
    v_mfma_f32_16x16x32_bf16 v[60:63], a[216:219], v[232:235], v[60:63]
    buffer_load_dwordx2 v[224:225], v227, s[4:7], s20 offen offset:192
    v_mfma_f32_16x16x32_bf16 v[64:67], a[220:223], v[232:235], v[64:67]
    ds_write_b64 v252, v[194:195] offset:256
    v_mfma_f32_16x16x32_bf16 v[64:67], a[208:211], v[228:231], v[64:67]
    s_waitcnt vmcnt(14)
    v_lshrrev_b32 v194, 15, v255
    v_lshlrev_b32 v248, 16, v206
    v_mfma_f32_16x16x32_bf16 v[64:67], a[196:199], v[236:239], v[64:67]
    ds_write_b64 v194, v[200:201] offset:2336
    v_mfma_f32_16x16x32_bf16 v[68:71], a[200:203], v[236:239], v[68:71]
    ds_read_b128 v[236:239], v253 offset:13536
    v_lshlrev_b32 v249, 16, v208
    v_mfma_f32_16x16x32_bf16 v[68:71], a[212:215], v[228:231], v[68:71]
    buffer_load_dwordx2 v[226:227], v227, s[4:7], s21 offen offset:192
    v_mfma_f32_16x16x32_bf16 v[68:71], a[224:227], v[232:235], v[68:71]
    ds_write_b64 v194, v[198:199] offset:4416
    v_mfma_f32_16x16x32_bf16 v[72:75], a[192:195], v[228:231], v[72:75]
    v_lshlrev_b32 v250, 16, v210
    v_lshlrev_b32 v251, 16, v212
    v_mfma_f32_16x16x32_bf16 v[72:75], a[204:207], v[232:235], v[72:75]
    s_waitcnt lgkmcnt(1)
    v_and_b32 v206, s22, v206
    v_and_b32 v208, s22, v208
    v_mfma_f32_16x16x32_bf16 v[72:75], a[216:219], v[236:239], v[72:75]
    ds_write_b64 v194, v[192:193] offset:16896
    v_mfma_f32_16x16x32_bf16 v[76:79], a[220:223], v[236:239], v[76:79]
    v_and_b32 v210, s22, v210
    v_and_b32 v212, s22, v212
    v_mfma_f32_16x16x32_bf16 v[76:79], a[208:211], v[232:235], v[76:79]
    ds_write_b64 v194, v[202:203] offset:25216
    v_mfma_f32_16x16x32_bf16 v[76:79], a[196:199], v[228:231], v[76:79]
    v_lshlrev_b32 v252, 16, v204
    v_and_b32 v204, s22, v204
    v_mfma_f32_16x16x32_bf16 v[80:83], a[200:203], v[228:231], v[80:83]
    ds_read_b128 v[228:231], v253 offset:13264
    v_fmac_f32 v252, s25, v251
    v_mfma_f32_16x16x32_bf16 v[80:83], a[212:215], v[232:235], v[80:83]
    ds_write_b64 v194, v[196:197] offset:6496
    v_mfma_f32_16x16x32_bf16 v[80:83], a[224:227], v[236:239], v[80:83]
    s_mov_b32 s42, 294912
    v_fmac_f32 v204, s25, v212
    v_fmac_f32 v252, s28, v249
    v_mfma_f32_16x16x32_bf16 v[84:87], a[192:195], v[232:235], v[84:87]
    v_fmac_f32 v204, s28, v208
    v_cvt_pk_bf16_f32 v204, v252, v204
    v_mfma_f32_16x16x32_bf16 v[88:91], a[196:199], v[232:235], v[88:91]
    v_lshlrev_b32 v252, 16, v214
    v_and_b32 v214, s22, v214
    v_mfma_f32_16x16x32_bf16 v[92:95], a[200:203], v[232:235], v[92:95]
    ds_read_b128 v[232:235], v253 offset:32240
    v_fmac_f32 v252, s29, v248
    v_mfma_f32_16x16x32_bf16 v[92:95], a[212:215], v[236:239], v[92:95]
    buffer_load_dwordx4 a[192:195], v254, s[8:11], s42 offen offset:0 sc1
    v_mfma_f32_16x16x32_bf16 v[88:91], a[208:211], v[236:239], v[88:91]
    s_waitcnt lgkmcnt(2)
    v_fmac_f32 v214, s29, v206
    v_fmac_f32 v252, s23, v250
    v_mfma_f32_16x16x32_bf16 v[84:87], a[204:207], v[236:239], v[84:87]
    ds_read_b128 v[236:239], v253 offset:31968
    v_fmac_f32 v214, s23, v210
    v_mfma_f32_16x16x32_bf16 v[84:87], a[216:219], v[228:231], v[84:87]
    buffer_load_dwordx4 a[196:199], v254, s[8:11], s42 offen offset:1024 sc1
    v_mfma_f32_16x16x32_bf16 v[88:91], a[220:223], v[228:231], v[88:91]
    s_waitcnt vmcnt(14) lgkmcnt(1)
    v_cvt_pk_bf16_f32 v214, v252, v214
    v_fma_f32 v252, v249, s24, v251
    v_mfma_f32_16x16x32_bf16 v[92:95], a[224:227], v[228:231], v[92:95]
    ds_read_b128 v[228:231], v253 offset:31712
    v_fmac_f32 v251, -4.0, v249
sub7:
    v_mfma_f32_16x16x32_bf16 v[96:99], a[228:231], v[232:235], v[96:99]
    buffer_load_dwordx4 a[200:203], v254, s[8:11], s42 offen offset:2048 sc1
    v_mfma_f32_16x16x32_bf16 v[100:103], a[232:235], v[232:235], v[100:103]
    s_mov_b32 s42, 297984
    v_fma_f32 v249, v248, s24, v250
    v_fmac_f32 v250, -4.0, v248
    v_mfma_f32_16x16x32_bf16 v[104:107], a[236:239], v[232:235], v[104:107]
    ds_read_b128 v[232:235], v253 offset:31456
    s_waitcnt vmcnt(12)
    s_waitcnt lgkmcnt(2)
    v_mfma_f32_16x16x32_bf16 v[104:107], a[248:251], v[236:239], v[104:107]
    v_fma_f32 v248, v250, s26, v251
    v_fmac_f32 v251, s27, v250
    v_mfma_f32_16x16x32_bf16 v[100:103], a[244:247], v[236:239], v[100:103]
    buffer_load_dwordx4 a[204:207], v254, s[8:11], s42 offen offset:0 sc1
    v_mfma_f32_16x16x32_bf16 v[96:99], a[240:243], v[236:239], v[96:99]
    s_waitcnt vmcnt(10) lgkmcnt(1)
    v_fma_f32 v250, v249, 2.0, v252
    v_fmac_f32 v252, -2.0, v249
    v_mfma_f32_16x16x32_bf16 v[96:99], a[252:255], v[228:231], v[96:99]
    v_fma_f32 v249, v208, s24, v212
    v_fmac_f32 v212, -4.0, v208
    v_mfma_f32_16x16x32_bf16 v[100:103], v[240:243], v[228:231], v[100:103]
    v_fma_f32 v208, v206, s24, v210
    v_fmac_f32 v210, -4.0, v206
    v_mfma_f32_16x16x32_bf16 v[104:107], v[244:247], v[228:231], v[104:107]
    buffer_load_dwordx4 a[208:211], v254, s[8:11], s42 offen offset:1024 sc1
    v_mfma_f32_16x16x32_bf16 v[108:111], a[228:231], v[236:239], v[108:111]
    v_fma_f32 v206, v210, s26, v212
    v_fmac_f32 v212, s27, v210
    v_mfma_f32_16x16x32_bf16 v[108:111], a[240:243], v[228:231], v[108:111]
    s_waitcnt lgkmcnt(0)
    v_fma_f32 v210, v208, 2.0, v249
    v_fmac_f32 v249, -2.0, v208
    v_mfma_f32_16x16x32_bf16 v[108:111], a[252:255], v[232:235], v[108:111]
    v_cvt_pk_bf16_f32 v206, v248, v206
    v_cvt_pk_bf16_f32 v212, v251, v212
    v_mfma_f32_16x16x32_bf16 v[112:115], v[240:243], v[232:235], v[112:115]
    buffer_load_dwordx4 a[212:215], v254, s[8:11], s42 offen offset:2048 sc1
    v_mfma_f32_16x16x32_bf16 v[112:115], a[244:247], v[228:231], v[112:115]
    s_mov_b32 s42, 301056
    v_cvt_pk_bf16_f32 v210, v250, v210
    v_cvt_pk_bf16_f32 v208, v252, v249
    v_mfma_f32_16x16x32_bf16 v[112:115], a[232:235], v[236:239], v[112:115]
    v_lshlrev_b32 v248, 16, v207
    v_lshlrev_b32 v249, 16, v209
    v_mfma_f32_16x16x32_bf16 v[116:119], a[236:239], v[236:239], v[116:119]
    ds_read_b128 v[236:239], v253 offset:31200
    v_lshlrev_b32 v250, 16, v211
    v_lshlrev_b32 v251, 16, v213
    v_mfma_f32_16x16x32_bf16 v[116:119], a[248:251], v[228:231], v[116:119]
    buffer_load_dwordx4 a[216:219], v254, s[8:11], s42 offen offset:0 sc1
    v_mfma_f32_16x16x32_bf16 v[116:119], v[244:247], v[232:235], v[116:119]
    v_and_b32 v207, s22, v207
    v_and_b32 v209, s22, v209
    v_mfma_f32_16x16x32_bf16 v[120:123], a[228:231], v[228:231], v[120:123]
    v_and_b32 v211, s22, v211
    v_and_b32 v213, s22, v213
    v_mfma_f32_16x16x32_bf16 v[120:123], a[240:243], v[232:235], v[120:123]
    s_waitcnt lgkmcnt(0)
    v_lshlrev_b32 v252, 16, v205
    v_and_b32 v205, s22, v205
    v_mfma_f32_16x16x32_bf16 v[120:123], a[252:255], v[236:239], v[120:123]
    v_fmac_f32 v252, s25, v251
    v_fmac_f32 v205, s25, v213
    v_mfma_f32_16x16x32_bf16 v[124:127], v[240:243], v[236:239], v[124:127]
    buffer_load_dwordx4 a[220:223], v254, s[8:11], s42 offen offset:1024 sc1
    v_mfma_f32_16x16x32_bf16 v[124:127], a[244:247], v[232:235], v[124:127]
    v_fmac_f32 v252, s28, v249
    v_fmac_f32 v205, s28, v209
    v_mfma_f32_16x16x32_bf16 v[124:127], a[232:235], v[228:231], v[124:127]
    v_cvt_pk_bf16_f32 v205, v252, v205
    v_lshlrev_b32 v252, 16, v215
    v_mfma_f32_16x16x32_bf16 v[128:131], a[236:239], v[228:231], v[128:131]
    ds_read_b128 v[228:231], v253 offset:33024
    v_and_b32 v215, s22, v215
    v_mfma_f32_16x16x32_bf16 v[128:131], a[248:251], v[232:235], v[128:131]
    buffer_load_dwordx4 a[224:227], v254, s[8:11], s42 offen offset:2048 sc1
    v_mfma_f32_16x16x32_bf16 v[128:131], v[244:247], v[236:239], v[128:131]
    v_fmac_f32 v252, s29, v248
    v_fmac_f32 v215, s29, v207
    v_mfma_f32_16x16x32_bf16 v[132:135], a[228:231], v[232:235], v[132:135]
    v_and_b32 v203, 0x7fff, v255
    v_fmac_f32 v252, s23, v250
    v_mfma_f32_16x16x32_bf16 v[132:135], a[240:243], v[236:239], v[132:135]
    s_waitcnt lgkmcnt(0)
    v_fmac_f32 v215, s23, v211
    v_cvt_pk_bf16_f32 v215, v252, v215
    v_mfma_f32_16x16x32_bf16 v[132:135], a[252:255], v[228:231], v[132:135]
    buffer_load_dwordx2 v[192:193], v203, s[4:7], s16 offen offset:576
    v_mfma_f32_16x16x32_bf16 v[136:139], v[240:243], v[228:231], v[136:139]
    v_fma_f32 v252, v249, s24, v251
    v_fmac_f32 v251, -4.0, v249
    v_mfma_f32_16x16x32_bf16 v[136:139], a[244:247], v[236:239], v[136:139]
    v_fma_f32 v249, v248, s24, v250
    v_fmac_f32 v250, -4.0, v248
    v_mfma_f32_16x16x32_bf16 v[136:139], a[232:235], v[232:235], v[136:139]
    v_fma_f32 v248, v250, s26, v251
    v_fmac_f32 v251, s27, v250
    v_mfma_f32_16x16x32_bf16 v[140:143], a[236:239], v[232:235], v[140:143]
    ds_read_b128 v[232:235], v253 offset:32768
    v_fma_f32 v250, v249, 2.0, v252
    v_mfma_f32_16x16x32_bf16 v[140:143], a[248:251], v[236:239], v[140:143]
    buffer_load_dwordx2 v[194:195], v203, s[4:7], s17 offen offset:576
    v_mfma_f32_16x16x32_bf16 v[140:143], v[244:247], v[228:231], v[140:143]
    v_fmac_f32 v252, -2.0, v249
    v_fma_f32 v249, v209, s24, v213
    v_mfma_f32_16x16x32_bf16 v[144:147], a[228:231], v[236:239], v[144:147]
    v_fmac_f32 v213, -4.0, v209
    v_fma_f32 v209, v207, s24, v211
    v_mfma_f32_16x16x32_bf16 v[144:147], a[240:243], v[228:231], v[144:147]
    s_waitcnt lgkmcnt(0)
    v_fmac_f32 v211, -4.0, v207
    v_fma_f32 v207, v211, s26, v213
    v_mfma_f32_16x16x32_bf16 v[144:147], a[252:255], v[232:235], v[144:147]
    buffer_load_dwordx2 v[196:197], v203, s[4:7], s18 offen offset:576
    v_mfma_f32_16x16x32_bf16 v[148:151], v[240:243], v[232:235], v[148:151]
    v_fmac_f32 v213, s27, v211
    v_fma_f32 v211, v209, 2.0, v249
    v_mfma_f32_16x16x32_bf16 v[148:151], a[244:247], v[228:231], v[148:151]
    v_fmac_f32 v249, -2.0, v209
    v_cvt_pk_bf16_f32 v207, v248, v207
    v_mfma_f32_16x16x32_bf16 v[148:151], a[232:235], v[236:239], v[148:151]
    v_cvt_pk_bf16_f32 v213, v251, v213
    v_cvt_pk_bf16_f32 v211, v250, v211
    v_mfma_f32_16x16x32_bf16 v[152:155], a[236:239], v[236:239], v[152:155]
    ds_read_b128 v[236:239], v253 offset:32512
    v_cvt_pk_bf16_f32 v209, v252, v249
    v_mfma_f32_16x16x32_bf16 v[152:155], a[248:251], v[228:231], v[152:155]
    buffer_load_dwordx2 v[198:199], v203, s[4:7], s19 offen offset:576
    v_mfma_f32_16x16x32_bf16 v[152:155], v[244:247], v[232:235], v[152:155]
    v_lshrrev_b32 v252, 15, v255
    v_mfma_f32_16x16x32_bf16 v[156:159], a[228:231], v[228:231], v[156:159]
    ds_write_b64 v252, v[206:207] offset:0
    v_mfma_f32_16x16x32_bf16 v[156:159], a[240:243], v[232:235], v[156:159]
    s_waitcnt lgkmcnt(1)
    v_lshrrev_b32 v206, 15, v255
    s_waitcnt vmcnt(13)
    v_mfma_f32_16x16x32_bf16 v[156:159], a[252:255], v[236:239], v[156:159]
    buffer_load_dwordx2 v[200:201], v203, s[4:7], s20 offen offset:576
    v_mfma_f32_16x16x32_bf16 v[160:163], v[240:243], v[236:239], v[160:163]
    ds_write_b64 v206, v[212:213] offset:2080
    v_mfma_f32_16x16x32_bf16 v[160:163], a[244:247], v[232:235], v[160:163]
    v_lshlrev_b32 v248, 16, v218
    v_lshlrev_b32 v249, 16, v220
    v_mfma_f32_16x16x32_bf16 v[160:163], a[232:235], v[228:231], v[160:163]
    ds_write_b64 v206, v[210:211] offset:4160
    v_mfma_f32_16x16x32_bf16 v[164:167], a[236:239], v[228:231], v[164:167]
    ds_read_b128 v[228:231], v253 offset:32256
    v_lshlrev_b32 v250, 16, v222
    v_mfma_f32_16x16x32_bf16 v[164:167], a[248:251], v[232:235], v[164:167]
    buffer_load_dwordx2 v[202:203], v203, s[4:7], s21 offen offset:576
    v_mfma_f32_16x16x32_bf16 v[164:167], v[244:247], v[236:239], v[164:167]
    ds_write_b64 v206, v[204:205] offset:16640
    v_mfma_f32_16x16x32_bf16 v[168:171], a[228:231], v[232:235], v[168:171]
    v_lshlrev_b32 v251, 16, v224
    v_and_b32 v218, s22, v218
    v_mfma_f32_16x16x32_bf16 v[168:171], a[240:243], v[236:239], v[168:171]
    s_waitcnt lgkmcnt(1)
    v_and_b32 v220, s22, v220
    v_and_b32 v222, s22, v222
    v_and_b32 v224, s22, v224
    v_mfma_f32_16x16x32_bf16 v[168:171], a[252:255], v[228:231], v[168:171]
    ds_write_b64 v206, v[214:215] offset:24960
    v_mfma_f32_16x16x32_bf16 v[172:175], v[240:243], v[228:231], v[172:175]
    v_lshlrev_b32 v252, 16, v216
    v_and_b32 v216, s22, v216
    v_mfma_f32_16x16x32_bf16 v[172:175], a[244:247], v[236:239], v[172:175]
    ds_write_b64 v206, v[208:209] offset:6240
    v_mfma_f32_16x16x32_bf16 v[172:175], a[232:235], v[232:235], v[172:175]
    v_fmac_f32 v252, s25, v251
    v_fmac_f32 v216, s25, v224
    v_mfma_f32_16x16x32_bf16 v[176:179], a[236:239], v[232:235], v[176:179]
    ds_read_b128 v[232:235], v253 offset:31984
    v_fmac_f32 v252, s28, v249
    v_mfma_f32_16x16x32_bf16 v[176:179], a[248:251], v[236:239], v[176:179]
    v_fmac_f32 v216, s28, v220
    v_cvt_pk_bf16_f32 v216, v252, v216
    v_mfma_f32_16x16x32_bf16 v[176:179], v[244:247], v[228:231], v[176:179]
    s_mov_b32 s42, 331776
    v_lshlrev_b32 v252, 16, v226
    v_and_b32 v226, s22, v226
    v_mfma_f32_16x16x32_bf16 v[180:183], a[228:231], v[236:239], v[180:183]
    s_waitcnt lgkmcnt(0)
    v_fmac_f32 v252, s29, v248
    v_fmac_f32 v226, s29, v218
    v_mfma_f32_16x16x32_bf16 v[184:187], a[232:235], v[236:239], v[184:187]
    s_barrier
    v_mfma_f32_16x16x32_bf16 v[188:191], a[236:239], v[236:239], v[188:191]
    ds_read_b128 v[236:239], v253 offset:1040
    v_fmac_f32 v252, s23, v250
    v_mfma_f32_16x16x32_bf16 v[188:191], a[248:251], v[228:231], v[188:191]
    buffer_load_dwordx4 a[228:231], v254, s[8:11], s42 offen offset:0 sc1
    v_mfma_f32_16x16x32_bf16 v[184:187], a[244:247], v[228:231], v[184:187]
    v_fmac_f32 v226, s23, v222
    v_cvt_pk_bf16_f32 v226, v252, v226
    v_mfma_f32_16x16x32_bf16 v[180:183], a[240:243], v[228:231], v[180:183]
    ds_read_b128 v[228:231], v253 offset:768
    v_fma_f32 v252, v249, s24, v251
    v_mfma_f32_16x16x32_bf16 v[180:183], a[252:255], v[232:235], v[180:183]
    buffer_load_dwordx4 a[232:235], v254, s[8:11], s42 offen offset:1024 sc1
    v_mfma_f32_16x16x32_bf16 v[184:187], v[240:243], v[232:235], v[184:187]
    s_waitcnt vmcnt(14) lgkmcnt(1)
    v_fmac_f32 v251, -4.0, v249
    v_fma_f32 v249, v248, s24, v250
    v_mfma_f32_16x16x32_bf16 v[188:191], v[244:247], v[232:235], v[188:191]
    ds_read_b128 v[232:235], v253 offset:512
    v_fmac_f32 v250, -4.0, v248
sub8:
    v_mfma_f32_16x16x32_bf16 a[0:3], a[192:195], v[236:239], a[0:3]
    buffer_load_dwordx4 a[236:239], v254, s[8:11], s42 offen offset:2048 sc1
    v_mfma_f32_16x16x32_bf16 a[4:7], a[196:199], v[236:239], a[4:7]
    s_mov_b32 s42, 334848
    v_fma_f32 v248, v250, s26, v251
    v_fmac_f32 v251, s27, v250
    v_mfma_f32_16x16x32_bf16 a[8:11], a[200:203], v[236:239], a[8:11]
    ds_read_b128 v[236:239], v253 offset:256
    s_waitcnt vmcnt(12)
    s_waitcnt lgkmcnt(2)
    v_mfma_f32_16x16x32_bf16 a[8:11], a[212:215], v[228:231], a[8:11]
    v_fma_f32 v250, v249, 2.0, v252
    v_fmac_f32 v252, -2.0, v249
    v_mfma_f32_16x16x32_bf16 a[4:7], a[208:211], v[228:231], a[4:7]
    buffer_load_dwordx4 a[240:243], v254, s[8:11], s42 offen offset:0 sc1
    v_mfma_f32_16x16x32_bf16 a[0:3], a[204:207], v[228:231], a[0:3]
    s_waitcnt vmcnt(10) lgkmcnt(1)
    v_fma_f32 v249, v220, s24, v224
    v_fmac_f32 v224, -4.0, v220
    v_mfma_f32_16x16x32_bf16 a[0:3], a[216:219], v[232:235], a[0:3]
    v_fma_f32 v220, v218, s24, v222
    v_fmac_f32 v222, -4.0, v218
    v_mfma_f32_16x16x32_bf16 a[4:7], a[220:223], v[232:235], a[4:7]
    v_fma_f32 v218, v222, s26, v224
    v_fmac_f32 v224, s27, v222
    v_mfma_f32_16x16x32_bf16 a[8:11], a[224:227], v[232:235], a[8:11]
    buffer_load_dwordx4 a[244:247], v254, s[8:11], s42 offen offset:1024 sc1
    v_mfma_f32_16x16x32_bf16 a[12:15], a[192:195], v[228:231], a[12:15]
    v_fma_f32 v222, v220, 2.0, v249
    v_fmac_f32 v249, -2.0, v220
    v_mfma_f32_16x16x32_bf16 a[12:15], a[204:207], v[232:235], a[12:15]
    s_waitcnt lgkmcnt(0)
    v_cvt_pk_bf16_f32 v218, v248, v218
    v_cvt_pk_bf16_f32 v224, v251, v224
    v_mfma_f32_16x16x32_bf16 a[12:15], a[216:219], v[236:239], a[12:15]
    v_cvt_pk_bf16_f32 v222, v250, v222
    v_cvt_pk_bf16_f32 v220, v252, v249
    v_mfma_f32_16x16x32_bf16 a[16:19], a[220:223], v[236:239], a[16:19]
    buffer_load_dwordx4 a[248:251], v254, s[8:11], s42 offen offset:2048 sc1
    v_mfma_f32_16x16x32_bf16 a[16:19], a[208:211], v[232:235], a[16:19]
    s_mov_b32 s42, 337920
    v_lshlrev_b32 v248, 16, v219
    v_lshlrev_b32 v249, 16, v221
    v_mfma_f32_16x16x32_bf16 a[16:19], a[196:199], v[228:231], a[16:19]
    v_lshlrev_b32 v250, 16, v223
    v_lshlrev_b32 v251, 16, v225
    v_mfma_f32_16x16x32_bf16 a[20:23], a[200:203], v[228:231], a[20:23]
    ds_read_b128 v[228:231], v253 offset:0
    v_and_b32 v219, s22, v219
    v_mfma_f32_16x16x32_bf16 a[20:23], a[212:215], v[232:235], a[20:23]
    buffer_load_dwordx4 a[252:255], v254, s[8:11], s42 offen offset:0 sc1
    v_mfma_f32_16x16x32_bf16 a[20:23], a[224:227], v[236:239], a[20:23]
    v_and_b32 v221, s22, v221
    v_and_b32 v223, s22, v223
    v_mfma_f32_16x16x32_bf16 a[24:27], a[192:195], v[232:235], a[24:27]
    v_and_b32 v225, s22, v225
    v_lshlrev_b32 v252, 16, v217
    v_mfma_f32_16x16x32_bf16 a[24:27], a[204:207], v[236:239], a[24:27]
    s_waitcnt lgkmcnt(0)
    v_and_b32 v217, s22, v217
    v_fmac_f32 v252, s25, v251
    v_mfma_f32_16x16x32_bf16 a[24:27], a[216:219], v[228:231], a[24:27]
    v_fmac_f32 v217, s25, v225
    v_fmac_f32 v252, s28, v249
    v_mfma_f32_16x16x32_bf16 a[28:31], a[220:223], v[228:231], a[28:31]
    buffer_load_dwordx4 v[240:243], v254, s[8:11], s42 offen offset:1024 sc1
    v_mfma_f32_16x16x32_bf16 a[28:31], a[208:211], v[236:239], a[28:31]
    v_fmac_f32 v217, s28, v221
    v_cvt_pk_bf16_f32 v217, v252, v217
    v_mfma_f32_16x16x32_bf16 a[28:31], a[196:199], v[232:235], a[28:31]
    v_lshlrev_b32 v252, 16, v227
    v_and_b32 v227, s22, v227
    v_fmac_f32 v252, s29, v248
    v_mfma_f32_16x16x32_bf16 a[32:35], a[200:203], v[232:235], a[32:35]
    ds_read_b128 v[232:235], v253 offset:1824
    v_fmac_f32 v227, s29, v219
    v_mfma_f32_16x16x32_bf16 a[32:35], a[212:215], v[236:239], a[32:35]
    buffer_load_dwordx4 v[244:247], v254, s[8:11], s42 offen offset:2048 sc1
    v_mfma_f32_16x16x32_bf16 a[32:35], a[224:227], v[228:231], a[32:35]
    v_fmac_f32 v252, s23, v250
    v_fmac_f32 v227, s23, v223
    v_mfma_f32_16x16x32_bf16 a[36:39], a[192:195], v[236:239], a[36:39]
    v_and_b32 v215, 0x7fff, v255
    v_cvt_pk_bf16_f32 v227, v252, v227
    v_mfma_f32_16x16x32_bf16 a[36:39], a[204:207], v[228:231], a[36:39]
    s_waitcnt lgkmcnt(0)
    v_fma_f32 v252, v249, s24, v251
    v_fmac_f32 v251, -4.0, v249
    v_mfma_f32_16x16x32_bf16 a[36:39], a[216:219], v[232:235], a[36:39]
    buffer_load_dwordx2 v[204:205], v215, s[4:7], s16 offen offset:960
    v_mfma_f32_16x16x32_bf16 a[40:43], a[220:223], v[232:235], a[40:43]
    v_fma_f32 v249, v248, s24, v250
    v_fmac_f32 v250, -4.0, v248
    v_mfma_f32_16x16x32_bf16 a[40:43], a[208:211], v[228:231], a[40:43]
    v_fma_f32 v248, v250, s26, v251
    v_fmac_f32 v251, s27, v250
    v_mfma_f32_16x16x32_bf16 a[40:43], a[196:199], v[236:239], a[40:43]
    v_fma_f32 v250, v249, 2.0, v252
    v_fmac_f32 v252, -2.0, v249
    v_mfma_f32_16x16x32_bf16 a[44:47], a[200:203], v[236:239], a[44:47]
    ds_read_b128 v[236:239], v253 offset:1568
    v_fma_f32 v249, v221, s24, v225
    v_mfma_f32_16x16x32_bf16 a[44:47], a[212:215], v[228:231], a[44:47]
    buffer_load_dwordx2 v[206:207], v215, s[4:7], s17 offen offset:960
    v_mfma_f32_16x16x32_bf16 a[44:47], a[224:227], v[232:235], a[44:47]
    v_fmac_f32 v225, -4.0, v221
    v_fma_f32 v221, v219, s24, v223
    v_mfma_f32_16x16x32_bf16 a[48:51], a[192:195], v[228:231], a[48:51]
    v_fmac_f32 v223, -4.0, v219
    v_fma_f32 v219, v223, s26, v225
    v_mfma_f32_16x16x32_bf16 a[48:51], a[204:207], v[232:235], a[48:51]
    s_waitcnt lgkmcnt(0)
    v_fmac_f32 v225, s27, v223
    v_fma_f32 v223, v221, 2.0, v249
    v_mfma_f32_16x16x32_bf16 a[48:51], a[216:219], v[236:239], a[48:51]
    buffer_load_dwordx2 v[208:209], v215, s[4:7], s18 offen offset:960
    v_mfma_f32_16x16x32_bf16 a[52:55], a[220:223], v[236:239], a[52:55]
    v_fmac_f32 v249, -2.0, v221
    v_cvt_pk_bf16_f32 v219, v248, v219
    v_mfma_f32_16x16x32_bf16 a[52:55], a[208:211], v[232:235], a[52:55]
    v_cvt_pk_bf16_f32 v225, v251, v225
    v_cvt_pk_bf16_f32 v223, v250, v223
    v_mfma_f32_16x16x32_bf16 a[52:55], a[196:199], v[228:231], a[52:55]
    v_cvt_pk_bf16_f32 v221, v252, v249
    v_lshrrev_b32 v252, 15, v255
    v_mfma_f32_16x16x32_bf16 a[56:59], a[200:203], v[228:231], a[56:59]
    ds_read_b128 v[228:231], v253 offset:1312
    v_mfma_f32_16x16x32_bf16 a[56:59], a[212:215], v[232:235], a[56:59]
    buffer_load_dwordx2 v[210:211], v215, s[4:7], s19 offen offset:960
    v_mfma_f32_16x16x32_bf16 a[56:59], a[224:227], v[236:239], a[56:59]
    ds_write_b64 v252, v[218:219] offset:9088
    v_mfma_f32_16x16x32_bf16 a[60:63], a[192:195], v[232:235], a[60:63]
    v_lshrrev_b32 v218, 15, v255
    v_mfma_f32_16x16x32_bf16 a[60:63], a[204:207], v[236:239], a[60:63]
    s_waitcnt lgkmcnt(1)
    s_waitcnt vmcnt(13)
    v_lshlrev_b32 v248, 16, v194
    v_mfma_f32_16x16x32_bf16 a[60:63], a[216:219], v[228:231], a[60:63]
    buffer_load_dwordx2 v[212:213], v215, s[4:7], s20 offen offset:960
    v_mfma_f32_16x16x32_bf16 a[64:67], a[220:223], v[228:231], a[64:67]
    ds_write_b64 v218, v[224:225] offset:11168
    v_mfma_f32_16x16x32_bf16 a[64:67], a[208:211], v[236:239], a[64:67]
    v_lshlrev_b32 v249, 16, v196
    v_lshlrev_b32 v250, 16, v198
    v_mfma_f32_16x16x32_bf16 a[64:67], a[196:199], v[232:235], a[64:67]
    ds_write_b64 v218, v[222:223] offset:13248
    v_mfma_f32_16x16x32_bf16 a[68:71], a[200:203], v[232:235], a[68:71]
    ds_read_b128 v[232:235], v253 offset:1056
    v_lshlrev_b32 v251, 16, v200
    v_mfma_f32_16x16x32_bf16 a[68:71], a[212:215], v[236:239], a[68:71]
    buffer_load_dwordx2 v[214:215], v215, s[4:7], s21 offen offset:960
    v_mfma_f32_16x16x32_bf16 a[68:71], a[224:227], v[228:231], a[68:71]
pad3:
    s_cbranch_vccnz pad7
    ds_write_b64 v218, v[216:217] offset:19488
    v_mfma_f32_16x16x32_bf16 a[72:75], a[192:195], v[236:239], a[72:75]
    v_and_b32 v194, s22, v194
    v_and_b32 v196, s22, v196
    v_mfma_f32_16x16x32_bf16 a[72:75], a[204:207], v[228:231], a[72:75]
    s_waitcnt lgkmcnt(1)
    v_and_b32 v198, s22, v198
    v_and_b32 v200, s22, v200
    v_mfma_f32_16x16x32_bf16 a[72:75], a[216:219], v[232:235], a[72:75]
    ds_write_b64 v218, v[226:227] offset:27808
    v_mfma_f32_16x16x32_bf16 a[76:79], a[220:223], v[232:235], a[76:79]
    v_lshlrev_b32 v252, 16, v192
    v_and_b32 v192, s22, v192
    v_mfma_f32_16x16x32_bf16 a[76:79], a[208:211], v[228:231], a[76:79]
    ds_write_b64 v218, v[220:221] offset:31968
    v_mfma_f32_16x16x32_bf16 a[76:79], a[196:199], v[236:239], a[76:79]
    v_fmac_f32 v252, s25, v251
    v_fmac_f32 v192, s25, v200
    v_mfma_f32_16x16x32_bf16 a[80:83], a[200:203], v[236:239], a[80:83]
    ds_read_b128 v[236:239], v253 offset:784
    v_fmac_f32 v252, s28, v249
    v_mfma_f32_16x16x32_bf16 a[80:83], a[212:215], v[228:231], a[80:83]
    v_fmac_f32 v192, s28, v196
    v_cvt_pk_bf16_f32 v192, v252, v192
    v_mfma_f32_16x16x32_bf16 a[80:83], a[224:227], v[232:235], a[80:83]
    s_mov_b32 s42, 368640
    v_lshlrev_b32 v252, 16, v202
    v_and_b32 v202, s22, v202
    v_mfma_f32_16x16x32_bf16 a[84:87], a[192:195], v[228:231], a[84:87]
    v_fmac_f32 v252, s29, v248
    v_fmac_f32 v202, s29, v194
    v_fmac_f32 v252, s23, v250
    v_mfma_f32_16x16x32_bf16 a[88:91], a[196:199], v[228:231], a[88:91]
    v_fmac_f32 v202, s23, v198
    v_cvt_pk_bf16_f32 v202, v252, v202
    v_mfma_f32_16x16x32_bf16 a[92:95], a[200:203], v[228:231], a[92:95]
    ds_read_b128 v[228:231], v253 offset:3120
    v_fma_f32 v252, v249, s24, v251
    v_mfma_f32_16x16x32_bf16 a[92:95], a[212:215], v[232:235], a[92:95]
    buffer_load_dwordx4 a[192:195], v254, s[8:11], s42 offen offset:0 sc1
    v_mfma_f32_16x16x32_bf16 a[88:91], a[208:211], v[232:235], a[88:91]
    s_waitcnt lgkmcnt(1)
    v_fmac_f32 v251, -4.0, v249
    v_fma_f32 v249, v248, s24, v250
    v_mfma_f32_16x16x32_bf16 a[84:87], a[204:207], v[232:235], a[84:87]
    ds_read_b128 v[232:235], v253 offset:2848
    v_fmac_f32 v250, -4.0, v248
    v_mfma_f32_16x16x32_bf16 a[84:87], a[216:219], v[236:239], a[84:87]
    buffer_load_dwordx4 a[196:199], v254, s[8:11], s42 offen offset:1024 sc1
    v_mfma_f32_16x16x32_bf16 a[88:91], a[220:223], v[236:239], a[88:91]
    s_waitcnt vmcnt(14) lgkmcnt(1)
    v_fma_f32 v248, v250, s26, v251
    v_fmac_f32 v251, s27, v250
    v_mfma_f32_16x16x32_bf16 a[92:95], a[224:227], v[236:239], a[92:95]
    ds_read_b128 v[236:239], v253 offset:2592
    v_fma_f32 v250, v249, 2.0, v252
sub9:
    v_mfma_f32_16x16x32_bf16 a[96:99], a[228:231], v[228:231], a[96:99]
    buffer_load_dwordx4 a[200:203], v254, s[8:11], s42 offen offset:2048 sc1
    v_mfma_f32_16x16x32_bf16 a[100:103], a[232:235], v[228:231], a[100:103]
    s_mov_b32 s42, 371712
    v_fmac_f32 v252, -2.0, v249
    v_fma_f32 v249, v196, s24, v200
    v_mfma_f32_16x16x32_bf16 a[104:107], a[236:239], v[228:231], a[104:107]
    ds_read_b128 v[228:231], v253 offset:2336
    s_waitcnt vmcnt(12)
    s_waitcnt lgkmcnt(2)
    v_mfma_f32_16x16x32_bf16 a[104:107], a[248:251], v[232:235], a[104:107]
    v_fmac_f32 v200, -4.0, v196
    v_fma_f32 v196, v194, s24, v198
    v_mfma_f32_16x16x32_bf16 a[100:103], a[244:247], v[232:235], a[100:103]
    buffer_load_dwordx4 a[204:207], v254, s[8:11], s42 offen offset:0 sc1
    v_mfma_f32_16x16x32_bf16 a[96:99], a[240:243], v[232:235], a[96:99]
    s_waitcnt vmcnt(10) lgkmcnt(1)
    v_fmac_f32 v198, -4.0, v194
    v_fma_f32 v194, v198, s26, v200
    v_mfma_f32_16x16x32_bf16 a[96:99], a[252:255], v[236:239], a[96:99]
    v_fmac_f32 v200, s27, v198
    v_fma_f32 v198, v196, 2.0, v249
    v_mfma_f32_16x16x32_bf16 a[100:103], v[240:243], v[236:239], a[100:103]
    v_fmac_f32 v249, -2.0, v196
    v_cvt_pk_bf16_f32 v194, v248, v194
    v_mfma_f32_16x16x32_bf16 a[104:107], v[244:247], v[236:239], a[104:107]
    buffer_load_dwordx4 a[208:211], v254, s[8:11], s42 offen offset:1024 sc1
    v_mfma_f32_16x16x32_bf16 a[108:111], a[228:231], v[232:235], a[108:111]
    v_cvt_pk_bf16_f32 v200, v251, v200
    v_cvt_pk_bf16_f32 v198, v250, v198
    v_mfma_f32_16x16x32_bf16 a[108:111], a[240:243], v[236:239], a[108:111]
    s_waitcnt lgkmcnt(0)
    v_cvt_pk_bf16_f32 v196, v252, v249
    v_lshlrev_b32 v248, 16, v195
    v_mfma_f32_16x16x32_bf16 a[108:111], a[252:255], v[228:231], a[108:111]
    v_lshlrev_b32 v249, 16, v197
    v_lshlrev_b32 v250, 16, v199
    v_mfma_f32_16x16x32_bf16 a[112:115], v[240:243], v[228:231], a[112:115]
    buffer_load_dwordx4 a[212:215], v254, s[8:11], s42 offen offset:2048 sc1
    v_mfma_f32_16x16x32_bf16 a[112:115], a[244:247], v[236:239], a[112:115]
    s_mov_b32 s42, 374784
    v_lshlrev_b32 v251, 16, v201
    v_and_b32 v195, s22, v195
    v_mfma_f32_16x16x32_bf16 a[112:115], a[232:235], v[232:235], a[112:115]
    v_and_b32 v197, s22, v197
    v_and_b32 v199, s22, v199
    v_mfma_f32_16x16x32_bf16 a[116:119], a[236:239], v[232:235], a[116:119]
    ds_read_b128 v[232:235], v253 offset:2080
    v_and_b32 v201, s22, v201
    v_mfma_f32_16x16x32_bf16 a[116:119], a[248:251], v[236:239], a[116:119]
    buffer_load_dwordx4 a[216:219], v254, s[8:11], s42 offen offset:0 sc1
    v_mfma_f32_16x16x32_bf16 a[116:119], v[244:247], v[228:231], a[116:119]
    v_lshlrev_b32 v252, 16, v193
    v_and_b32 v193, s22, v193
    v_mfma_f32_16x16x32_bf16 a[120:123], a[228:231], v[236:239], a[120:123]
    v_fmac_f32 v252, s25, v251
    v_fmac_f32 v193, s25, v201
    v_mfma_f32_16x16x32_bf16 a[120:123], a[240:243], v[228:231], a[120:123]
    s_waitcnt lgkmcnt(0)
    v_fmac_f32 v252, s28, v249
    v_fmac_f32 v193, s28, v197
    v_mfma_f32_16x16x32_bf16 a[120:123], a[252:255], v[232:235], a[120:123]
    v_cvt_pk_bf16_f32 v193, v252, v193
    v_lshlrev_b32 v252, 16, v203
    v_mfma_f32_16x16x32_bf16 a[124:127], v[240:243], v[232:235], a[124:127]
    buffer_load_dwordx4 a[220:223], v254, s[8:11], s42 offen offset:1024 sc1
    v_mfma_f32_16x16x32_bf16 a[124:127], a[244:247], v[228:231], a[124:127]
    v_and_b32 v203, s22, v203
    v_fmac_f32 v252, s29, v248
    v_mfma_f32_16x16x32_bf16 a[124:127], a[232:235], v[236:239], a[124:127]
    v_fmac_f32 v203, s29, v195
    v_fmac_f32 v252, s23, v250
    v_mfma_f32_16x16x32_bf16 a[128:131], a[236:239], v[236:239], a[128:131]
    ds_read_b128 v[236:239], v253 offset:3904
    v_fmac_f32 v203, s23, v199
    v_mfma_f32_16x16x32_bf16 a[128:131], a[248:251], v[228:231], a[128:131]
    buffer_load_dwordx4 a[224:227], v254, s[8:11], s42 offen offset:2048 sc1
    v_mfma_f32_16x16x32_bf16 a[128:131], v[244:247], v[232:235], a[128:131]
    v_cvt_pk_bf16_f32 v203, v252, v203
    v_fma_f32 v252, v249, s24, v251
    v_mfma_f32_16x16x32_bf16 a[132:135], a[228:231], v[228:231], a[132:135]
    v_and_b32 v227, 0x7fff, v255
    v_fmac_f32 v251, -4.0, v249
    v_mfma_f32_16x16x32_bf16 a[132:135], a[240:243], v[232:235], a[132:135]
    s_waitcnt lgkmcnt(0)
    v_fma_f32 v249, v248, s24, v250
    v_fmac_f32 v250, -4.0, v248
    v_mfma_f32_16x16x32_bf16 a[132:135], a[252:255], v[236:239], a[132:135]
    buffer_load_dwordx2 v[216:217], v227, s[4:7], s16 offen offset:1344
    v_mfma_f32_16x16x32_bf16 a[136:139], v[240:243], v[236:239], a[136:139]
    v_fma_f32 v248, v250, s26, v251
    v_fmac_f32 v251, s27, v250
    v_mfma_f32_16x16x32_bf16 a[136:139], a[244:247], v[232:235], a[136:139]
    v_fma_f32 v250, v249, 2.0, v252
    v_fmac_f32 v252, -2.0, v249
    v_fma_f32 v249, v197, s24, v201
    v_mfma_f32_16x16x32_bf16 a[136:139], a[232:235], v[228:231], a[136:139]
    v_fmac_f32 v201, -4.0, v197
    v_fma_f32 v197, v195, s24, v199
    v_mfma_f32_16x16x32_bf16 a[140:143], a[236:239], v[228:231], a[140:143]
    ds_read_b128 v[228:231], v253 offset:3648
    v_fmac_f32 v199, -4.0, v195
    v_mfma_f32_16x16x32_bf16 a[140:143], a[248:251], v[232:235], a[140:143]
    buffer_load_dwordx2 v[218:219], v227, s[4:7], s17 offen offset:1344
    v_mfma_f32_16x16x32_bf16 a[140:143], v[244:247], v[236:239], a[140:143]
    v_fma_f32 v195, v199, s26, v201
    v_fmac_f32 v201, s27, v199
    v_mfma_f32_16x16x32_bf16 a[144:147], a[228:231], v[232:235], a[144:147]
    v_fma_f32 v199, v197, 2.0, v249
    v_fmac_f32 v249, -2.0, v197
    v_mfma_f32_16x16x32_bf16 a[144:147], a[240:243], v[236:239], a[144:147]
    s_waitcnt lgkmcnt(0)
    v_cvt_pk_bf16_f32 v195, v248, v195
    v_cvt_pk_bf16_f32 v201, v251, v201
    v_mfma_f32_16x16x32_bf16 a[144:147], a[252:255], v[228:231], a[144:147]
    buffer_load_dwordx2 v[220:221], v227, s[4:7], s18 offen offset:1344
    v_mfma_f32_16x16x32_bf16 a[148:151], v[240:243], v[228:231], a[148:151]
    v_cvt_pk_bf16_f32 v199, v250, v199
    v_cvt_pk_bf16_f32 v197, v252, v249
    v_mfma_f32_16x16x32_bf16 a[148:151], a[244:247], v[236:239], a[148:151]
    v_lshrrev_b32 v252, 15, v255
    v_mfma_f32_16x16x32_bf16 a[148:151], a[232:235], v[232:235], a[148:151]
    ds_write_b64 v252, v[194:195] offset:8832
    v_mfma_f32_16x16x32_bf16 a[152:155], a[236:239], v[232:235], a[152:155]
    ds_read_b128 v[232:235], v253 offset:3392
    v_lshrrev_b32 v194, 15, v255
    v_mfma_f32_16x16x32_bf16 a[152:155], a[248:251], v[236:239], a[152:155]
    buffer_load_dwordx2 v[222:223], v227, s[4:7], s19 offen offset:1344
    v_mfma_f32_16x16x32_bf16 a[152:155], v[244:247], v[228:231], a[152:155]
    ds_write_b64 v194, v[200:201] offset:10912
    v_mfma_f32_16x16x32_bf16 a[156:159], a[228:231], v[236:239], a[156:159]
    v_mfma_f32_16x16x32_bf16 a[156:159], a[240:243], v[228:231], a[156:159]
    s_waitcnt lgkmcnt(1)
    s_waitcnt vmcnt(13)
    v_lshlrev_b32 v248, 16, v206
    v_mfma_f32_16x16x32_bf16 a[156:159], a[252:255], v[232:235], a[156:159]
    buffer_load_dwordx2 v[224:225], v227, s[4:7], s20 offen offset:1344
    v_mfma_f32_16x16x32_bf16 a[160:163], v[240:243], v[232:235], a[160:163]
    ds_write_b64 v194, v[198:199] offset:12992
    v_mfma_f32_16x16x32_bf16 a[160:163], a[244:247], v[228:231], a[160:163]
    v_lshlrev_b32 v249, 16, v208
    v_lshlrev_b32 v250, 16, v210
    v_mfma_f32_16x16x32_bf16 a[160:163], a[232:235], v[236:239], a[160:163]
    ds_write_b64 v194, v[192:193] offset:19232
    v_mfma_f32_16x16x32_bf16 a[164:167], a[236:239], v[236:239], a[164:167]
    ds_read_b128 v[236:239], v253 offset:3136
    v_lshlrev_b32 v251, 16, v212
    v_mfma_f32_16x16x32_bf16 a[164:167], a[248:251], v[228:231], a[164:167]
    buffer_load_dwordx2 v[226:227], v227, s[4:7], s21 offen offset:1344
    v_mfma_f32_16x16x32_bf16 a[164:167], v[244:247], v[232:235], a[164:167]
    ds_write_b64 v194, v[202:203] offset:27552
    v_mfma_f32_16x16x32_bf16 a[168:171], a[228:231], v[228:231], a[168:171]
    v_and_b32 v206, s22, v206
    v_and_b32 v208, s22, v208
    v_mfma_f32_16x16x32_bf16 a[168:171], a[240:243], v[232:235], a[168:171]
    s_waitcnt lgkmcnt(1)
    v_and_b32 v210, s22, v210
    v_and_b32 v212, s22, v212
    v_mfma_f32_16x16x32_bf16 a[168:171], a[252:255], v[236:239], a[168:171]
    ds_write_b64 v194, v[196:197] offset:31712
    v_mfma_f32_16x16x32_bf16 a[172:175], v[240:243], v[236:239], a[172:175]
    ds_read_b128 v[192:195], v253 offset:40096
    s_mov_b32 s45, 452138121
    v_mfma_f32_16x16x32_bf16 a[172:175], a[244:247], v[232:235], a[172:175]
    v_bfe_u32 v196, v254, 5, 3
    v_mul_u32_u24 v197, 5, v196
    v_mfma_f32_16x16x32_bf16 a[172:175], a[232:235], v[228:231], a[172:175]
    v_bfe_u32 v197, s45, v197, 5
    v_mul_u32_u24 v197, 65, v197
    v_mfma_f32_16x16x32_bf16 a[176:179], a[236:239], v[228:231], a[176:179]
    ds_read_b128 v[228:231], v253 offset:2864
    v_sub_u32 v197, v197, v196
    v_mfma_f32_16x16x32_bf16 a[176:179], a[248:251], v[232:235], a[176:179]
    v_lshl_add_u32 v196, v197, 5, v253
    s_waitcnt lgkmcnt(1)
    v_mfma_f32_16x16x32_bf16 a[176:179], v[244:247], v[236:239], a[176:179]
    s_mov_b32 s42, 405504
    v_lshlrev_b32 v252, 16, v204
    v_and_b32 v204, s22, v204
    v_mfma_f32_16x16x32_bf16 a[180:183], a[228:231], v[232:235], a[180:183]
    s_mov_b64 exec, s[46:47]
    ds_write_b128 v196, v[192:195] offset:1024
    s_mov_b64 exec, -1
    v_mfma_f32_16x16x32_bf16 a[184:187], a[232:235], v[232:235], a[184:187]
    v_fmac_f32 v252, s25, v251
    v_fmac_f32 v204, s25, v212
    v_mfma_f32_16x16x32_bf16 a[188:191], a[236:239], v[232:235], a[188:191]
    ds_read_b128 v[232:235], v253 offset:5200
    v_fmac_f32 v252, s28, v249
    v_mfma_f32_16x16x32_bf16 a[188:191], a[248:251], v[236:239], a[188:191]
    buffer_load_dwordx4 a[228:231], v254, s[8:11], s42 offen offset:0 sc1
    v_mfma_f32_16x16x32_bf16 a[184:187], a[244:247], v[236:239], a[184:187]
    s_waitcnt lgkmcnt(2)
    v_fmac_f32 v204, s28, v208
    v_cvt_pk_bf16_f32 v204, v252, v204
    v_mfma_f32_16x16x32_bf16 a[180:183], a[240:243], v[236:239], a[180:183]
    ds_read_b128 v[236:239], v253 offset:4928
    v_lshlrev_b32 v252, 16, v214
    v_mfma_f32_16x16x32_bf16 a[180:183], a[252:255], v[228:231], a[180:183]
    buffer_load_dwordx4 a[232:235], v254, s[8:11], s42 offen offset:1024 sc1
    v_mfma_f32_16x16x32_bf16 a[184:187], v[240:243], v[228:231], a[184:187]
    s_waitcnt vmcnt(14) lgkmcnt(1)
    v_and_b32 v214, s22, v214
    v_fmac_f32 v252, s29, v248
    v_mfma_f32_16x16x32_bf16 a[188:191], v[244:247], v[228:231], a[188:191]
    ds_read_b128 v[228:231], v253 offset:4672
    v_fmac_f32 v214, s29, v206
    v_fmac_f32 v252, s23, v250
sub10:
    v_mfma_f32_16x16x32_bf16 v[0:3], a[192:195], v[232:235], v[0:3]
    buffer_load_dwordx4 a[236:239], v254, s[8:11], s42 offen offset:2048 sc1
    v_mfma_f32_16x16x32_bf16 v[4:7], a[196:199], v[232:235], v[4:7]
    s_mov_b32 s42, 408576
    v_fmac_f32 v214, s23, v210
    v_cvt_pk_bf16_f32 v214, v252, v214
    v_mfma_f32_16x16x32_bf16 v[8:11], a[200:203], v[232:235], v[8:11]
    ds_read_b128 v[232:235], v253 offset:4416
    s_waitcnt vmcnt(12)
    s_waitcnt lgkmcnt(2)
    v_mfma_f32_16x16x32_bf16 v[8:11], a[212:215], v[236:239], v[8:11]
    v_fma_f32 v252, v249, s24, v251
    v_fmac_f32 v251, -4.0, v249
    v_mfma_f32_16x16x32_bf16 v[4:7], a[208:211], v[236:239], v[4:7]
    buffer_load_dwordx4 a[240:243], v254, s[8:11], s42 offen offset:0 sc1
    v_mfma_f32_16x16x32_bf16 v[0:3], a[204:207], v[236:239], v[0:3]
    s_waitcnt vmcnt(10) lgkmcnt(1)
    v_fma_f32 v249, v248, s24, v250
    v_fmac_f32 v250, -4.0, v248
    v_mfma_f32_16x16x32_bf16 v[0:3], a[216:219], v[228:231], v[0:3]
    v_fma_f32 v248, v250, s26, v251
    v_fmac_f32 v251, s27, v250
    v_mfma_f32_16x16x32_bf16 v[4:7], a[220:223], v[228:231], v[4:7]
    v_fma_f32 v250, v249, 2.0, v252
    v_fmac_f32 v252, -2.0, v249
    v_mfma_f32_16x16x32_bf16 v[8:11], a[224:227], v[228:231], v[8:11]
    buffer_load_dwordx4 a[244:247], v254, s[8:11], s42 offen offset:1024 sc1
    v_mfma_f32_16x16x32_bf16 v[12:15], a[192:195], v[236:239], v[12:15]
    v_fma_f32 v249, v208, s24, v212
    v_fmac_f32 v212, -4.0, v208
    v_mfma_f32_16x16x32_bf16 v[12:15], a[204:207], v[228:231], v[12:15]
    s_waitcnt lgkmcnt(0)
    v_fma_f32 v208, v206, s24, v210
    v_fmac_f32 v210, -4.0, v206
    v_mfma_f32_16x16x32_bf16 v[12:15], a[216:219], v[232:235], v[12:15]
    v_fma_f32 v206, v210, s26, v212
    v_fmac_f32 v212, s27, v210
    v_mfma_f32_16x16x32_bf16 v[16:19], a[220:223], v[232:235], v[16:19]
    buffer_load_dwordx4 a[248:251], v254, s[8:11], s42 offen offset:2048 sc1
    v_mfma_f32_16x16x32_bf16 v[16:19], a[208:211], v[228:231], v[16:19]
    s_mov_b32 s42, 411648
    v_fma_f32 v210, v208, 2.0, v249
    v_fmac_f32 v249, -2.0, v208
    v_mfma_f32_16x16x32_bf16 v[16:19], a[196:199], v[236:239], v[16:19]
    v_cvt_pk_bf16_f32 v206, v248, v206
    v_cvt_pk_bf16_f32 v212, v251, v212
    v_mfma_f32_16x16x32_bf16 v[20:23], a[200:203], v[236:239], v[20:23]
    ds_read_b128 v[236:239], v253 offset:4160
    v_cvt_pk_bf16_f32 v210, v250, v210
    v_mfma_f32_16x16x32_bf16 v[20:23], a[212:215], v[228:231], v[20:23]
    buffer_load_dwordx4 a[252:255], v254, s[8:11], s42 offen offset:0 sc1
    v_mfma_f32_16x16x32_bf16 v[20:23], a[224:227], v[232:235], v[20:23]
    v_cvt_pk_bf16_f32 v208, v252, v249
    v_lshlrev_b32 v248, 16, v207
    v_mfma_f32_16x16x32_bf16 v[24:27], a[192:195], v[228:231], v[24:27]
    v_lshlrev_b32 v249, 16, v209
    v_lshlrev_b32 v250, 16, v211
    v_mfma_f32_16x16x32_bf16 v[24:27], a[204:207], v[232:235], v[24:27]
    s_waitcnt lgkmcnt(0)
    v_lshlrev_b32 v251, 16, v213
    v_and_b32 v207, s22, v207
    v_mfma_f32_16x16x32_bf16 v[24:27], a[216:219], v[236:239], v[24:27]
    v_and_b32 v209, s22, v209
    v_and_b32 v211, s22, v211
    v_mfma_f32_16x16x32_bf16 v[28:31], a[220:223], v[236:239], v[28:31]
    buffer_load_dwordx4 v[240:243], v254, s[8:11], s42 offen offset:1024 sc1
    v_mfma_f32_16x16x32_bf16 v[28:31], a[208:211], v[232:235], v[28:31]
    v_and_b32 v213, s22, v213
    v_lshlrev_b32 v252, 16, v205
    v_mfma_f32_16x16x32_bf16 v[28:31], a[196:199], v[228:231], v[28:31]
    v_and_b32 v205, s22, v205
    v_fmac_f32 v252, s25, v251
    v_mfma_f32_16x16x32_bf16 v[32:35], a[200:203], v[228:231], v[32:35]
    ds_read_b128 v[228:231], v253 offset:5984
    v_fmac_f32 v205, s25, v213
    v_mfma_f32_16x16x32_bf16 v[32:35], a[212:215], v[232:235], v[32:35]
    buffer_load_dwordx4 v[244:247], v254, s[8:11], s42 offen offset:2048 sc1
    v_mfma_f32_16x16x32_bf16 v[32:35], a[224:227], v[236:239], v[32:35]
    v_fmac_f32 v252, s28, v249
    v_fmac_f32 v205, s28, v209
    v_mfma_f32_16x16x32_bf16 v[36:39], a[192:195], v[232:235], v[36:39]
    v_and_b32 v203, 0x7fff, v255
    v_cvt_pk_bf16_f32 v205, v252, v205
    v_mfma_f32_16x16x32_bf16 v[36:39], a[204:207], v[236:239], v[36:39]
    s_waitcnt lgkmcnt(0)
    v_lshlrev_b32 v252, 16, v215
    v_and_b32 v215, s22, v215
    v_mfma_f32_16x16x32_bf16 v[36:39], a[216:219], v[228:231], v[36:39]
    buffer_load_dwordx2 v[192:193], v203, s[4:7], s16 offen offset:256
    v_mfma_f32_16x16x32_bf16 v[40:43], a[220:223], v[228:231], v[40:43]
    v_fmac_f32 v252, s29, v248
    v_fmac_f32 v215, s29, v207
    v_mfma_f32_16x16x32_bf16 v[40:43], a[208:211], v[236:239], v[40:43]
    v_fmac_f32 v252, s23, v250
    v_fmac_f32 v215, s23, v211
    v_mfma_f32_16x16x32_bf16 v[40:43], a[196:199], v[232:235], v[40:43]
    v_cvt_pk_bf16_f32 v215, v252, v215
    v_fma_f32 v252, v249, s24, v251
    v_mfma_f32_16x16x32_bf16 v[44:47], a[200:203], v[232:235], v[44:47]
    ds_read_b128 v[232:235], v253 offset:5728
    v_fmac_f32 v251, -4.0, v249
    v_mfma_f32_16x16x32_bf16 v[44:47], a[212:215], v[236:239], v[44:47]
    buffer_load_dwordx2 v[194:195], v203, s[4:7], s17 offen offset:256
    v_mfma_f32_16x16x32_bf16 v[44:47], a[224:227], v[228:231], v[44:47]
    v_fma_f32 v249, v248, s24, v250
    v_fmac_f32 v250, -4.0, v248
    v_mfma_f32_16x16x32_bf16 v[48:51], a[192:195], v[236:239], v[48:51]
    v_fma_f32 v248, v250, s26, v251
    v_fmac_f32 v251, s27, v250
    v_mfma_f32_16x16x32_bf16 v[48:51], a[204:207], v[228:231], v[48:51]
    s_waitcnt lgkmcnt(0)
    v_fma_f32 v250, v249, 2.0, v252
    v_fmac_f32 v252, -2.0, v249
    v_mfma_f32_16x16x32_bf16 v[48:51], a[216:219], v[232:235], v[48:51]
    buffer_load_dwordx2 v[196:197], v203, s[4:7], s18 offen offset:256
    v_mfma_f32_16x16x32_bf16 v[52:55], a[220:223], v[232:235], v[52:55]
    v_fma_f32 v249, v209, s24, v213
    v_fmac_f32 v213, -4.0, v209
    v_fma_f32 v209, v207, s24, v211
    v_mfma_f32_16x16x32_bf16 v[52:55], a[208:211], v[228:231], v[52:55]
    v_fmac_f32 v211, -4.0, v207
    v_fma_f32 v207, v211, s26, v213
    v_mfma_f32_16x16x32_bf16 v[52:55], a[196:199], v[236:239], v[52:55]
    v_fmac_f32 v213, s27, v211
    v_fma_f32 v211, v209, 2.0, v249
    v_mfma_f32_16x16x32_bf16 v[56:59], a[200:203], v[236:239], v[56:59]
    ds_read_b128 v[236:239], v253 offset:5472
    v_fmac_f32 v249, -2.0, v209
    v_mfma_f32_16x16x32_bf16 v[56:59], a[212:215], v[228:231], v[56:59]
    buffer_load_dwordx2 v[198:199], v203, s[4:7], s19 offen offset:256
    v_mfma_f32_16x16x32_bf16 v[56:59], a[224:227], v[232:235], v[56:59]
    v_cvt_pk_bf16_f32 v207, v248, v207
    v_cvt_pk_bf16_f32 v213, v251, v213
    v_mfma_f32_16x16x32_bf16 v[60:63], a[192:195], v[228:231], v[60:63]
    v_cvt_pk_bf16_f32 v211, v250, v211
    v_cvt_pk_bf16_f32 v209, v252, v249
    v_mfma_f32_16x16x32_bf16 v[60:63], a[204:207], v[232:235], v[60:63]
    s_waitcnt lgkmcnt(0)
    v_lshrrev_b32 v252, 15, v255
    v_mfma_f32_16x16x32_bf16 v[60:63], a[216:219], v[236:239], v[60:63]
    buffer_load_dwordx2 v[200:201], v203, s[4:7], s20 offen offset:256
    v_mfma_f32_16x16x32_bf16 v[64:67], a[220:223], v[236:239], v[64:67]
    ds_write_b64 v252, v[206:207] offset:8576
    v_mfma_f32_16x16x32_bf16 v[64:67], a[208:211], v[232:235], v[64:67]
    s_waitcnt vmcnt(14)
    v_lshrrev_b32 v206, 15, v255
    v_lshlrev_b32 v248, 16, v218
    v_mfma_f32_16x16x32_bf16 v[64:67], a[196:199], v[228:231], v[64:67]
    ds_write_b64 v206, v[212:213] offset:10656
    v_mfma_f32_16x16x32_bf16 v[68:71], a[200:203], v[228:231], v[68:71]
    ds_read_b128 v[228:231], v253 offset:5216
    v_lshlrev_b32 v249, 16, v220
    v_mfma_f32_16x16x32_bf16 v[68:71], a[212:215], v[232:235], v[68:71]
    buffer_load_dwordx2 v[202:203], v203, s[4:7], s21 offen offset:256
    v_mfma_f32_16x16x32_bf16 v[68:71], a[224:227], v[236:239], v[68:71]
    ds_write_b64 v206, v[210:211] offset:12736
    v_mfma_f32_16x16x32_bf16 v[72:75], a[192:195], v[232:235], v[72:75]
    v_lshlrev_b32 v250, 16, v222
    v_lshlrev_b32 v251, 16, v224
    v_mfma_f32_16x16x32_bf16 v[72:75], a[204:207], v[236:239], v[72:75]
    s_waitcnt lgkmcnt(1)
    v_and_b32 v218, s22, v218
    v_and_b32 v220, s22, v220
    v_mfma_f32_16x16x32_bf16 v[72:75], a[216:219], v[228:231], v[72:75]
    ds_write_b64 v206, v[204:205] offset:18976
    v_mfma_f32_16x16x32_bf16 v[76:79], a[220:223], v[228:231], v[76:79]
    v_and_b32 v222, s22, v222
    v_and_b32 v224, s22, v224
    v_mfma_f32_16x16x32_bf16 v[76:79], a[208:211], v[236:239], v[76:79]
    ds_write_b64 v206, v[214:215] offset:27296
    v_mfma_f32_16x16x32_bf16 v[76:79], a[196:199], v[232:235], v[76:79]
    v_lshlrev_b32 v252, 16, v216
    v_and_b32 v216, s22, v216
    v_mfma_f32_16x16x32_bf16 v[80:83], a[200:203], v[232:235], v[80:83]
    ds_read_b128 v[232:235], v253 offset:4944
    v_fmac_f32 v252, s25, v251
    v_mfma_f32_16x16x32_bf16 v[80:83], a[212:215], v[236:239], v[80:83]
    ds_write_b64 v206, v[208:209] offset:31456
    v_mfma_f32_16x16x32_bf16 v[80:83], a[224:227], v[228:231], v[80:83]
    s_mov_b32 s42, 442368
    v_fmac_f32 v216, s25, v224
    v_fmac_f32 v252, s28, v249
    v_mfma_f32_16x16x32_bf16 v[84:87], a[192:195], v[236:239], v[84:87]
    v_fmac_f32 v216, s28, v220
    v_cvt_pk_bf16_f32 v216, v252, v216
    v_mfma_f32_16x16x32_bf16 v[88:91], a[196:199], v[236:239], v[88:91]
    v_lshlrev_b32 v252, 16, v226
    v_and_b32 v226, s22, v226
    v_mfma_f32_16x16x32_bf16 v[92:95], a[200:203], v[236:239], v[92:95]
    ds_read_b128 v[236:239], v253 offset:7280
    v_fmac_f32 v252, s29, v248
    v_mfma_f32_16x16x32_bf16 v[92:95], a[212:215], v[228:231], v[92:95]
    buffer_load_dwordx4 a[192:195], v254, s[8:11], s42 offen offset:0 sc1
    v_mfma_f32_16x16x32_bf16 v[88:91], a[208:211], v[228:231], v[88:91]
    s_waitcnt lgkmcnt(2)
    v_fmac_f32 v226, s29, v218
    v_fmac_f32 v252, s23, v250
    v_mfma_f32_16x16x32_bf16 v[84:87], a[204:207], v[228:231], v[84:87]
    ds_read_b128 v[228:231], v253 offset:7008
    v_fmac_f32 v226, s23, v222
    v_mfma_f32_16x16x32_bf16 v[84:87], a[216:219], v[232:235], v[84:87]
    buffer_load_dwordx4 a[196:199], v254, s[8:11], s42 offen offset:1024 sc1
    v_mfma_f32_16x16x32_bf16 v[88:91], a[220:223], v[232:235], v[88:91]
    s_waitcnt vmcnt(14) lgkmcnt(1)
    v_cvt_pk_bf16_f32 v226, v252, v226
    v_fma_f32 v252, v249, s24, v251
    v_mfma_f32_16x16x32_bf16 v[92:95], a[224:227], v[232:235], v[92:95]
    ds_read_b128 v[232:235], v253 offset:6752
    v_fmac_f32 v251, -4.0, v249
sub11:
    v_mfma_f32_16x16x32_bf16 v[96:99], a[228:231], v[236:239], v[96:99]
    buffer_load_dwordx4 a[200:203], v254, s[8:11], s42 offen offset:2048 sc1
    v_mfma_f32_16x16x32_bf16 v[100:103], a[232:235], v[236:239], v[100:103]
    s_mov_b32 s42, 445440
    v_fma_f32 v249, v248, s24, v250
    v_fmac_f32 v250, -4.0, v248
    v_mfma_f32_16x16x32_bf16 v[104:107], a[236:239], v[236:239], v[104:107]
    ds_read_b128 v[236:239], v253 offset:6496
    s_waitcnt vmcnt(12)
    s_waitcnt lgkmcnt(2)
    v_mfma_f32_16x16x32_bf16 v[104:107], a[248:251], v[228:231], v[104:107]
    v_fma_f32 v248, v250, s26, v251
    v_fmac_f32 v251, s27, v250
    v_mfma_f32_16x16x32_bf16 v[100:103], a[244:247], v[228:231], v[100:103]
    buffer_load_dwordx4 a[204:207], v254, s[8:11], s42 offen offset:0 sc1
    v_mfma_f32_16x16x32_bf16 v[96:99], a[240:243], v[228:231], v[96:99]
    s_waitcnt vmcnt(10) lgkmcnt(1)
    v_fma_f32 v250, v249, 2.0, v252
    v_fmac_f32 v252, -2.0, v249
    v_mfma_f32_16x16x32_bf16 v[96:99], a[252:255], v[232:235], v[96:99]
    v_fma_f32 v249, v220, s24, v224
    v_fmac_f32 v224, -4.0, v220
    v_mfma_f32_16x16x32_bf16 v[100:103], v[240:243], v[232:235], v[100:103]
    v_fma_f32 v220, v218, s24, v222
    v_fmac_f32 v222, -4.0, v218
    v_fma_f32 v218, v222, s26, v224
    v_mfma_f32_16x16x32_bf16 v[104:107], v[244:247], v[232:235], v[104:107]
    buffer_load_dwordx4 a[208:211], v254, s[8:11], s42 offen offset:1024 sc1
    v_mfma_f32_16x16x32_bf16 v[108:111], a[228:231], v[228:231], v[108:111]
    v_fmac_f32 v224, s27, v222
    v_fma_f32 v222, v220, 2.0, v249
    v_mfma_f32_16x16x32_bf16 v[108:111], a[240:243], v[232:235], v[108:111]
    s_waitcnt lgkmcnt(0)
    v_fmac_f32 v249, -2.0, v220
    v_cvt_pk_bf16_f32 v218, v248, v218
    v_mfma_f32_16x16x32_bf16 v[108:111], a[252:255], v[236:239], v[108:111]
    v_cvt_pk_bf16_f32 v224, v251, v224
    v_cvt_pk_bf16_f32 v222, v250, v222
    v_mfma_f32_16x16x32_bf16 v[112:115], v[240:243], v[236:239], v[112:115]
    buffer_load_dwordx4 a[212:215], v254, s[8:11], s42 offen offset:2048 sc1
    v_mfma_f32_16x16x32_bf16 v[112:115], a[244:247], v[232:235], v[112:115]
    s_mov_b32 s42, 448512
    v_cvt_pk_bf16_f32 v220, v252, v249
    v_lshlrev_b32 v248, 16, v219
    v_mfma_f32_16x16x32_bf16 v[112:115], a[232:235], v[228:231], v[112:115]
    v_lshlrev_b32 v249, 16, v221
    v_lshlrev_b32 v250, 16, v223
    v_mfma_f32_16x16x32_bf16 v[116:119], a[236:239], v[228:231], v[116:119]
    ds_read_b128 v[228:231], v253 offset:6240
    v_lshlrev_b32 v251, 16, v225
    v_mfma_f32_16x16x32_bf16 v[116:119], a[248:251], v[232:235], v[116:119]
    buffer_load_dwordx4 a[216:219], v254, s[8:11], s42 offen offset:0 sc1
    v_mfma_f32_16x16x32_bf16 v[116:119], v[244:247], v[236:239], v[116:119]
    v_and_b32 v219, s22, v219
    v_and_b32 v221, s22, v221
    v_mfma_f32_16x16x32_bf16 v[120:123], a[228:231], v[232:235], v[120:123]
    v_and_b32 v223, s22, v223
    v_and_b32 v225, s22, v225
    v_mfma_f32_16x16x32_bf16 v[120:123], a[240:243], v[236:239], v[120:123]
    s_waitcnt lgkmcnt(0)
    v_lshlrev_b32 v252, 16, v217
    v_and_b32 v217, s22, v217
    v_mfma_f32_16x16x32_bf16 v[120:123], a[252:255], v[228:231], v[120:123]
    v_fmac_f32 v252, s25, v251
    v_fmac_f32 v217, s25, v225
    v_mfma_f32_16x16x32_bf16 v[124:127], v[240:243], v[228:231], v[124:127]
    buffer_load_dwordx4 a[220:223], v254, s[8:11], s42 offen offset:1024 sc1
    v_mfma_f32_16x16x32_bf16 v[124:127], a[244:247], v[236:239], v[124:127]
    v_fmac_f32 v252, s28, v249
    v_fmac_f32 v217, s28, v221
    v_mfma_f32_16x16x32_bf16 v[124:127], a[232:235], v[232:235], v[124:127]
    v_cvt_pk_bf16_f32 v217, v252, v217
    v_lshlrev_b32 v252, 16, v227
    v_mfma_f32_16x16x32_bf16 v[128:131], a[236:239], v[232:235], v[128:131]
    ds_read_b128 v[232:235], v253 offset:8064
    v_and_b32 v227, s22, v227
    v_mfma_f32_16x16x32_bf16 v[128:131], a[248:251], v[236:239], v[128:131]
    buffer_load_dwordx4 a[224:227], v254, s[8:11], s42 offen offset:2048 sc1
    v_mfma_f32_16x16x32_bf16 v[128:131], v[244:247], v[228:231], v[128:131]
    v_fmac_f32 v252, s29, v248
    v_fmac_f32 v227, s29, v219
    v_mfma_f32_16x16x32_bf16 v[132:135], a[228:231], v[236:239], v[132:135]
    v_and_b32 v215, 0x7fff, v255
    v_fmac_f32 v252, s23, v250
    v_mfma_f32_16x16x32_bf16 v[132:135], a[240:243], v[228:231], v[132:135]
    s_waitcnt lgkmcnt(0)
    v_fmac_f32 v227, s23, v223
    v_cvt_pk_bf16_f32 v227, v252, v227
    v_mfma_f32_16x16x32_bf16 v[132:135], a[252:255], v[232:235], v[132:135]
    buffer_load_dwordx2 v[204:205], v215, s[4:7], s16 offen offset:640
    v_mfma_f32_16x16x32_bf16 v[136:139], v[240:243], v[232:235], v[136:139]
    v_fma_f32 v252, v249, s24, v251
    v_fmac_f32 v251, -4.0, v249
    v_mfma_f32_16x16x32_bf16 v[136:139], a[244:247], v[228:231], v[136:139]
    v_fma_f32 v249, v248, s24, v250
    v_fmac_f32 v250, -4.0, v248
    v_mfma_f32_16x16x32_bf16 v[136:139], a[232:235], v[236:239], v[136:139]
    v_fma_f32 v248, v250, s26, v251
    v_fmac_f32 v251, s27, v250
    v_mfma_f32_16x16x32_bf16 v[140:143], a[236:239], v[236:239], v[140:143]
    ds_read_b128 v[236:239], v253 offset:7808
    v_fma_f32 v250, v249, 2.0, v252
    v_mfma_f32_16x16x32_bf16 v[140:143], a[248:251], v[228:231], v[140:143]
    buffer_load_dwordx2 v[206:207], v215, s[4:7], s17 offen offset:640
    v_mfma_f32_16x16x32_bf16 v[140:143], v[244:247], v[232:235], v[140:143]
    v_fmac_f32 v252, -2.0, v249
    v_fma_f32 v249, v221, s24, v225
    v_mfma_f32_16x16x32_bf16 v[144:147], a[228:231], v[228:231], v[144:147]
    v_fmac_f32 v225, -4.0, v221
    v_fma_f32 v221, v219, s24, v223
    v_mfma_f32_16x16x32_bf16 v[144:147], a[240:243], v[232:235], v[144:147]
    s_waitcnt lgkmcnt(0)
    v_fmac_f32 v223, -4.0, v219
    v_fma_f32 v219, v223, s26, v225
    v_mfma_f32_16x16x32_bf16 v[144:147], a[252:255], v[236:239], v[144:147]
    buffer_load_dwordx2 v[208:209], v215, s[4:7], s18 offen offset:640
    v_mfma_f32_16x16x32_bf16 v[148:151], v[240:243], v[236:239], v[148:151]
    v_fmac_f32 v225, s27, v223
    v_fma_f32 v223, v221, 2.0, v249
    v_mfma_f32_16x16x32_bf16 v[148:151], a[244:247], v[232:235], v[148:151]
    v_fmac_f32 v249, -2.0, v221
    v_cvt_pk_bf16_f32 v219, v248, v219
    v_mfma_f32_16x16x32_bf16 v[148:151], a[232:235], v[228:231], v[148:151]
    v_cvt_pk_bf16_f32 v225, v251, v225
    v_cvt_pk_bf16_f32 v223, v250, v223
    v_mfma_f32_16x16x32_bf16 v[152:155], a[236:239], v[228:231], v[152:155]
    ds_read_b128 v[228:231], v253 offset:7552
    v_cvt_pk_bf16_f32 v221, v252, v249
    v_mfma_f32_16x16x32_bf16 v[152:155], a[248:251], v[232:235], v[152:155]
    buffer_load_dwordx2 v[210:211], v215, s[4:7], s19 offen offset:640
    v_mfma_f32_16x16x32_bf16 v[152:155], v[244:247], v[236:239], v[152:155]
    v_lshrrev_b32 v252, 15, v255
    v_mfma_f32_16x16x32_bf16 v[156:159], a[228:231], v[232:235], v[156:159]
    ds_write_b64 v252, v[218:219] offset:8320
    v_mfma_f32_16x16x32_bf16 v[156:159], a[240:243], v[236:239], v[156:159]
    s_waitcnt lgkmcnt(1)
    v_lshrrev_b32 v218, 15, v255
    s_waitcnt vmcnt(13)
    v_mfma_f32_16x16x32_bf16 v[156:159], a[252:255], v[228:231], v[156:159]
    buffer_load_dwordx2 v[212:213], v215, s[4:7], s20 offen offset:640
    v_lshlrev_b32 v248, 16, v194
    v_mfma_f32_16x16x32_bf16 v[160:163], v[240:243], v[228:231], v[160:163]
    ds_write_b64 v218, v[224:225] offset:10400
    v_mfma_f32_16x16x32_bf16 v[160:163], a[244:247], v[236:239], v[160:163]
pad4:
    s_cbranch_vccnz pad8
    v_lshlrev_b32 v249, 16, v196
    v_lshlrev_b32 v250, 16, v198
    v_mfma_f32_16x16x32_bf16 v[160:163], a[232:235], v[232:235], v[160:163]
    ds_write_b64 v218, v[222:223] offset:12480
    v_mfma_f32_16x16x32_bf16 v[164:167], a[236:239], v[232:235], v[164:167]
    ds_read_b128 v[232:235], v253 offset:7296
    v_lshlrev_b32 v251, 16, v200
    v_mfma_f32_16x16x32_bf16 v[164:167], a[248:251], v[236:239], v[164:167]
    buffer_load_dwordx2 v[214:215], v215, s[4:7], s21 offen offset:640
    v_mfma_f32_16x16x32_bf16 v[164:167], v[244:247], v[228:231], v[164:167]
    ds_write_b64 v218, v[216:217] offset:18720
    v_mfma_f32_16x16x32_bf16 v[168:171], a[228:231], v[236:239], v[168:171]
    v_and_b32 v194, s22, v194
    v_and_b32 v196, s22, v196
    v_mfma_f32_16x16x32_bf16 v[168:171], a[240:243], v[228:231], v[168:171]
    s_waitcnt lgkmcnt(1)
    v_and_b32 v198, s22, v198
    v_and_b32 v200, s22, v200
    v_mfma_f32_16x16x32_bf16 v[168:171], a[252:255], v[232:235], v[168:171]
    ds_write_b64 v218, v[226:227] offset:27040
    v_mfma_f32_16x16x32_bf16 v[172:175], v[240:243], v[232:235], v[172:175]
    v_lshlrev_b32 v252, 16, v192
    v_and_b32 v192, s22, v192
    v_mfma_f32_16x16x32_bf16 v[172:175], a[244:247], v[228:231], v[172:175]
    ds_write_b64 v218, v[220:221] offset:31200
    v_mfma_f32_16x16x32_bf16 v[172:175], a[232:235], v[236:239], v[172:175]
    v_fmac_f32 v252, s25, v251
    v_fmac_f32 v192, s25, v200
    v_mfma_f32_16x16x32_bf16 v[176:179], a[236:239], v[236:239], v[176:179]
    ds_read_b128 v[236:239], v253 offset:7024
    v_fmac_f32 v252, s28, v249
    v_mfma_f32_16x16x32_bf16 v[176:179], a[248:251], v[228:231], v[176:179]
    v_fmac_f32 v192, s28, v196
    v_cvt_pk_bf16_f32 v192, v252, v192
    v_mfma_f32_16x16x32_bf16 v[176:179], v[244:247], v[232:235], v[176:179]
    s_mov_b32 s42, 479232
    v_lshlrev_b32 v252, 16, v202
    v_and_b32 v202, s22, v202
    v_mfma_f32_16x16x32_bf16 v[180:183], a[228:231], v[228:231], v[180:183]
    s_waitcnt lgkmcnt(0)
    v_fmac_f32 v252, s29, v248
    v_fmac_f32 v202, s29, v194
    v_mfma_f32_16x16x32_bf16 v[184:187], a[232:235], v[228:231], v[184:187]
    s_barrier
    v_mfma_f32_16x16x32_bf16 v[188:191], a[236:239], v[228:231], v[188:191]
    ds_read_b128 v[228:231], v253 offset:9360
    v_fmac_f32 v252, s23, v250
    v_mfma_f32_16x16x32_bf16 v[188:191], a[248:251], v[232:235], v[188:191]
    buffer_load_dwordx4 a[228:231], v254, s[8:11], s42 offen offset:0 sc1
    v_mfma_f32_16x16x32_bf16 v[184:187], a[244:247], v[232:235], v[184:187]
    v_fmac_f32 v202, s23, v198
    v_cvt_pk_bf16_f32 v202, v252, v202
    v_mfma_f32_16x16x32_bf16 v[180:183], a[240:243], v[232:235], v[180:183]
    ds_read_b128 v[232:235], v253 offset:9088
    v_fma_f32 v252, v249, s24, v251
    v_mfma_f32_16x16x32_bf16 v[180:183], a[252:255], v[236:239], v[180:183]
    buffer_load_dwordx4 a[232:235], v254, s[8:11], s42 offen offset:1024 sc1
    v_mfma_f32_16x16x32_bf16 v[184:187], v[240:243], v[236:239], v[184:187]
    s_waitcnt vmcnt(14) lgkmcnt(1)
    v_fmac_f32 v251, -4.0, v249
    v_fma_f32 v249, v248, s24, v250
    v_mfma_f32_16x16x32_bf16 v[188:191], v[244:247], v[236:239], v[188:191]
    ds_read_b128 v[236:239], v253 offset:8832
    v_fmac_f32 v250, -4.0, v248
sub12:
    v_mfma_f32_16x16x32_bf16 a[0:3], a[192:195], v[228:231], a[0:3]
    buffer_load_dwordx4 a[236:239], v254, s[8:11], s42 offen offset:2048 sc1
    v_mfma_f32_16x16x32_bf16 a[4:7], a[196:199], v[228:231], a[4:7]
    s_mov_b32 s42, 482304
    v_fma_f32 v248, v250, s26, v251
    v_fmac_f32 v251, s27, v250
    v_mfma_f32_16x16x32_bf16 a[8:11], a[200:203], v[228:231], a[8:11]
    ds_read_b128 v[228:231], v253 offset:8576
    s_waitcnt vmcnt(12)
    s_waitcnt lgkmcnt(2)
    v_mfma_f32_16x16x32_bf16 a[8:11], a[212:215], v[232:235], a[8:11]
    v_fma_f32 v250, v249, 2.0, v252
    v_fmac_f32 v252, -2.0, v249
    v_mfma_f32_16x16x32_bf16 a[4:7], a[208:211], v[232:235], a[4:7]
    buffer_load_dwordx4 a[240:243], v254, s[8:11], s42 offen offset:0 sc1
    v_mfma_f32_16x16x32_bf16 a[0:3], a[204:207], v[232:235], a[0:3]
    s_waitcnt vmcnt(10) lgkmcnt(1)
    v_fma_f32 v249, v196, s24, v200
    v_fmac_f32 v200, -4.0, v196
    v_mfma_f32_16x16x32_bf16 a[0:3], a[216:219], v[236:239], a[0:3]
    v_fma_f32 v196, v194, s24, v198
    v_fmac_f32 v198, -4.0, v194
    v_mfma_f32_16x16x32_bf16 a[4:7], a[220:223], v[236:239], a[4:7]
    v_fma_f32 v194, v198, s26, v200
    v_fmac_f32 v200, s27, v198
    v_mfma_f32_16x16x32_bf16 a[8:11], a[224:227], v[236:239], a[8:11]
    buffer_load_dwordx4 a[244:247], v254, s[8:11], s42 offen offset:1024 sc1
    v_mfma_f32_16x16x32_bf16 a[12:15], a[192:195], v[232:235], a[12:15]
    v_fma_f32 v198, v196, 2.0, v249
    v_fmac_f32 v249, -2.0, v196
    v_mfma_f32_16x16x32_bf16 a[12:15], a[204:207], v[236:239], a[12:15]
    s_waitcnt lgkmcnt(0)
    v_cvt_pk_bf16_f32 v194, v248, v194
    v_cvt_pk_bf16_f32 v200, v251, v200
    v_mfma_f32_16x16x32_bf16 a[12:15], a[216:219], v[228:231], a[12:15]
    v_cvt_pk_bf16_f32 v198, v250, v198
    v_cvt_pk_bf16_f32 v196, v252, v249
    v_mfma_f32_16x16x32_bf16 a[16:19], a[220:223], v[228:231], a[16:19]
    buffer_load_dwordx4 a[248:251], v254, s[8:11], s42 offen offset:2048 sc1
    v_mfma_f32_16x16x32_bf16 a[16:19], a[208:211], v[236:239], a[16:19]
    s_mov_b32 s42, 485376
    v_lshlrev_b32 v248, 16, v195
    v_lshlrev_b32 v249, 16, v197
    v_mfma_f32_16x16x32_bf16 a[16:19], a[196:199], v[232:235], a[16:19]
    v_lshlrev_b32 v250, 16, v199
    v_lshlrev_b32 v251, 16, v201
    v_mfma_f32_16x16x32_bf16 a[20:23], a[200:203], v[232:235], a[20:23]
    ds_read_b128 v[232:235], v253 offset:8320
    v_and_b32 v195, s22, v195
    v_and_b32 v197, s22, v197
    v_mfma_f32_16x16x32_bf16 a[20:23], a[212:215], v[236:239], a[20:23]
    buffer_load_dwordx4 a[252:255], v254, s[8:11], s42 offen offset:0 sc1
    v_mfma_f32_16x16x32_bf16 a[20:23], a[224:227], v[228:231], a[20:23]
    v_and_b32 v199, s22, v199
    v_and_b32 v201, s22, v201
    v_mfma_f32_16x16x32_bf16 a[24:27], a[192:195], v[236:239], a[24:27]
    v_lshlrev_b32 v252, 16, v193
    v_and_b32 v193, s22, v193
    v_mfma_f32_16x16x32_bf16 a[24:27], a[204:207], v[228:231], a[24:27]
    s_waitcnt lgkmcnt(0)
    v_fmac_f32 v252, s25, v251
    v_fmac_f32 v193, s25, v201
    v_mfma_f32_16x16x32_bf16 a[24:27], a[216:219], v[232:235], a[24:27]
    v_fmac_f32 v252, s28, v249
    v_fmac_f32 v193, s28, v197
    v_mfma_f32_16x16x32_bf16 a[28:31], a[220:223], v[232:235], a[28:31]
    buffer_load_dwordx4 v[240:243], v254, s[8:11], s42 offen offset:1024 sc1
    v_mfma_f32_16x16x32_bf16 a[28:31], a[208:211], v[228:231], a[28:31]
    v_cvt_pk_bf16_f32 v193, v252, v193
    v_lshlrev_b32 v252, 16, v203
    v_mfma_f32_16x16x32_bf16 a[28:31], a[196:199], v[236:239], a[28:31]
    v_and_b32 v203, s22, v203
    v_fmac_f32 v252, s29, v248
    v_mfma_f32_16x16x32_bf16 a[32:35], a[200:203], v[236:239], a[32:35]
    ds_read_b128 v[236:239], v253 offset:10144
    v_fmac_f32 v203, s29, v195
    v_mfma_f32_16x16x32_bf16 a[32:35], a[212:215], v[228:231], a[32:35]
    buffer_load_dwordx4 v[244:247], v254, s[8:11], s42 offen offset:2048 sc1
    v_mfma_f32_16x16x32_bf16 a[32:35], a[224:227], v[232:235], a[32:35]
    v_fmac_f32 v252, s23, v250
    v_fmac_f32 v203, s23, v199
    v_mfma_f32_16x16x32_bf16 a[36:39], a[192:195], v[228:231], a[36:39]
    v_and_b32 v227, 0x7fff, v255
    v_cvt_pk_bf16_f32 v203, v252, v203
    v_mfma_f32_16x16x32_bf16 a[36:39], a[204:207], v[232:235], a[36:39]
    s_waitcnt lgkmcnt(0)
    v_fma_f32 v252, v249, s24, v251
    v_fmac_f32 v251, -4.0, v249
    v_mfma_f32_16x16x32_bf16 a[36:39], a[216:219], v[236:239], a[36:39]
    buffer_load_dwordx2 v[216:217], v227, s[4:7], s16 offen offset:1024
    v_mfma_f32_16x16x32_bf16 a[40:43], a[220:223], v[236:239], a[40:43]
    v_fma_f32 v249, v248, s24, v250
    v_fmac_f32 v250, -4.0, v248
    v_mfma_f32_16x16x32_bf16 a[40:43], a[208:211], v[232:235], a[40:43]
    v_fma_f32 v248, v250, s26, v251
    v_fmac_f32 v251, s27, v250
    v_mfma_f32_16x16x32_bf16 a[40:43], a[196:199], v[228:231], a[40:43]
    v_fma_f32 v250, v249, 2.0, v252
    v_fmac_f32 v252, -2.0, v249
    v_mfma_f32_16x16x32_bf16 a[44:47], a[200:203], v[228:231], a[44:47]
    ds_read_b128 v[228:231], v253 offset:9888
    v_fma_f32 v249, v197, s24, v201
    v_mfma_f32_16x16x32_bf16 a[44:47], a[212:215], v[232:235], a[44:47]
    buffer_load_dwordx2 v[218:219], v227, s[4:7], s17 offen offset:1024
    v_mfma_f32_16x16x32_bf16 a[44:47], a[224:227], v[236:239], a[44:47]
    v_fmac_f32 v201, -4.0, v197
    v_fma_f32 v197, v195, s24, v199
    v_mfma_f32_16x16x32_bf16 a[48:51], a[192:195], v[232:235], a[48:51]
    v_fmac_f32 v199, -4.0, v195
    v_fma_f32 v195, v199, s26, v201
    v_mfma_f32_16x16x32_bf16 a[48:51], a[204:207], v[236:239], a[48:51]
    s_waitcnt lgkmcnt(0)
    v_fmac_f32 v201, s27, v199
    v_fma_f32 v199, v197, 2.0, v249
    v_mfma_f32_16x16x32_bf16 a[48:51], a[216:219], v[228:231], a[48:51]
    buffer_load_dwordx2 v[220:221], v227, s[4:7], s18 offen offset:1024
    v_mfma_f32_16x16x32_bf16 a[52:55], a[220:223], v[228:231], a[52:55]
    v_fmac_f32 v249, -2.0, v197
    v_cvt_pk_bf16_f32 v195, v248, v195
    v_mfma_f32_16x16x32_bf16 a[52:55], a[208:211], v[236:239], a[52:55]
    v_cvt_pk_bf16_f32 v201, v251, v201
    v_cvt_pk_bf16_f32 v199, v250, v199
    v_mfma_f32_16x16x32_bf16 a[52:55], a[196:199], v[232:235], a[52:55]
    v_cvt_pk_bf16_f32 v197, v252, v249
    v_lshrrev_b32 v252, 15, v255
    v_mfma_f32_16x16x32_bf16 a[56:59], a[200:203], v[232:235], a[56:59]
    ds_read_b128 v[232:235], v253 offset:9632
    v_mfma_f32_16x16x32_bf16 a[56:59], a[212:215], v[236:239], a[56:59]
    buffer_load_dwordx2 v[222:223], v227, s[4:7], s19 offen offset:1024
    v_mfma_f32_16x16x32_bf16 a[56:59], a[224:227], v[228:231], a[56:59]
    ds_write_b64 v252, v[194:195] offset:768
    v_mfma_f32_16x16x32_bf16 a[60:63], a[192:195], v[236:239], a[60:63]
    v_lshrrev_b32 v194, 15, v255
    v_mfma_f32_16x16x32_bf16 a[60:63], a[204:207], v[228:231], a[60:63]
    s_waitcnt lgkmcnt(1)
    s_waitcnt vmcnt(13)
    v_lshlrev_b32 v248, 16, v206
    v_mfma_f32_16x16x32_bf16 a[60:63], a[216:219], v[232:235], a[60:63]
    buffer_load_dwordx2 v[224:225], v227, s[4:7], s20 offen offset:1024
    v_mfma_f32_16x16x32_bf16 a[64:67], a[220:223], v[232:235], a[64:67]
    ds_write_b64 v194, v[200:201] offset:2848
    v_mfma_f32_16x16x32_bf16 a[64:67], a[208:211], v[228:231], a[64:67]
    v_lshlrev_b32 v249, 16, v208
    v_lshlrev_b32 v250, 16, v210
    v_mfma_f32_16x16x32_bf16 a[64:67], a[196:199], v[236:239], a[64:67]
    ds_write_b64 v194, v[198:199] offset:4928
    v_mfma_f32_16x16x32_bf16 a[68:71], a[200:203], v[236:239], a[68:71]
    ds_read_b128 v[236:239], v253 offset:9376
    v_lshlrev_b32 v251, 16, v212
    v_mfma_f32_16x16x32_bf16 a[68:71], a[212:215], v[228:231], a[68:71]
    buffer_load_dwordx2 v[226:227], v227, s[4:7], s21 offen offset:1024
    v_mfma_f32_16x16x32_bf16 a[68:71], a[224:227], v[232:235], a[68:71]
    ds_write_b64 v194, v[192:193] offset:21568
    v_mfma_f32_16x16x32_bf16 a[72:75], a[192:195], v[228:231], a[72:75]
    v_and_b32 v206, s22, v206
    v_and_b32 v208, s22, v208
    v_mfma_f32_16x16x32_bf16 a[72:75], a[204:207], v[232:235], a[72:75]
    s_waitcnt lgkmcnt(1)
    v_and_b32 v210, s22, v210
    v_and_b32 v212, s22, v212
    v_lshlrev_b32 v252, 16, v204
    v_mfma_f32_16x16x32_bf16 a[72:75], a[216:219], v[236:239], a[72:75]
    ds_write_b64 v194, v[202:203] offset:29888
    v_mfma_f32_16x16x32_bf16 a[76:79], a[220:223], v[236:239], a[76:79]
    v_and_b32 v204, s22, v204
    v_fmac_f32 v252, s25, v251
    v_mfma_f32_16x16x32_bf16 a[76:79], a[208:211], v[232:235], a[76:79]
    ds_write_b64 v194, v[196:197] offset:7008
    v_mfma_f32_16x16x32_bf16 a[76:79], a[196:199], v[228:231], a[76:79]
    v_fmac_f32 v204, s25, v212
    v_fmac_f32 v252, s28, v249
    v_mfma_f32_16x16x32_bf16 a[80:83], a[200:203], v[228:231], a[80:83]
    ds_read_b128 v[228:231], v253 offset:9104
    v_fmac_f32 v204, s28, v208
    v_mfma_f32_16x16x32_bf16 a[80:83], a[212:215], v[232:235], a[80:83]
    v_cvt_pk_bf16_f32 v204, v252, v204
    v_lshlrev_b32 v252, 16, v214
    v_mfma_f32_16x16x32_bf16 a[80:83], a[224:227], v[236:239], a[80:83]
    s_mov_b32 s42, 516096
    v_and_b32 v214, s22, v214
    v_fmac_f32 v252, s29, v248
    v_mfma_f32_16x16x32_bf16 a[84:87], a[192:195], v[232:235], a[84:87]
    v_fmac_f32 v214, s29, v206
    v_fmac_f32 v252, s23, v250
    v_mfma_f32_16x16x32_bf16 a[88:91], a[196:199], v[232:235], a[88:91]
    v_fmac_f32 v214, s23, v210
    v_cvt_pk_bf16_f32 v214, v252, v214
    v_mfma_f32_16x16x32_bf16 a[92:95], a[200:203], v[232:235], a[92:95]
    ds_read_b128 v[232:235], v253 offset:11440
    v_fma_f32 v252, v249, s24, v251
    v_mfma_f32_16x16x32_bf16 a[92:95], a[212:215], v[236:239], a[92:95]
    buffer_load_dwordx4 a[192:195], v254, s[8:11], s42 offen offset:0 sc1
    v_mfma_f32_16x16x32_bf16 a[88:91], a[208:211], v[236:239], a[88:91]
    s_waitcnt lgkmcnt(1)
    v_fmac_f32 v251, -4.0, v249
    v_fma_f32 v249, v248, s24, v250
    v_mfma_f32_16x16x32_bf16 a[84:87], a[204:207], v[236:239], a[84:87]
    ds_read_b128 v[236:239], v253 offset:11168
    v_fmac_f32 v250, -4.0, v248
    v_mfma_f32_16x16x32_bf16 a[84:87], a[216:219], v[228:231], a[84:87]
    buffer_load_dwordx4 a[196:199], v254, s[8:11], s42 offen offset:1024 sc1
    v_mfma_f32_16x16x32_bf16 a[88:91], a[220:223], v[228:231], a[88:91]
    s_waitcnt vmcnt(14) lgkmcnt(1)
    v_fma_f32 v248, v250, s26, v251
    v_fmac_f32 v251, s27, v250
    v_mfma_f32_16x16x32_bf16 a[92:95], a[224:227], v[228:231], a[92:95]
    ds_read_b128 v[228:231], v253 offset:10912
    v_fma_f32 v250, v249, 2.0, v252
sub13:
    v_mfma_f32_16x16x32_bf16 a[96:99], a[228:231], v[232:235], a[96:99]
    buffer_load_dwordx4 a[200:203], v254, s[8:11], s42 offen offset:2048 sc1
    v_mfma_f32_16x16x32_bf16 a[100:103], a[232:235], v[232:235], a[100:103]
    s_mov_b32 s42, 519168
    v_fmac_f32 v252, -2.0, v249
    v_fma_f32 v249, v208, s24, v212
    v_mfma_f32_16x16x32_bf16 a[104:107], a[236:239], v[232:235], a[104:107]
    ds_read_b128 v[232:235], v253 offset:10656
    s_waitcnt vmcnt(12)
    s_waitcnt lgkmcnt(2)
    v_mfma_f32_16x16x32_bf16 a[104:107], a[248:251], v[236:239], a[104:107]
    v_fmac_f32 v212, -4.0, v208
    v_fma_f32 v208, v206, s24, v210
    v_mfma_f32_16x16x32_bf16 a[100:103], a[244:247], v[236:239], a[100:103]
    buffer_load_dwordx4 a[204:207], v254, s[8:11], s42 offen offset:0 sc1
    v_mfma_f32_16x16x32_bf16 a[96:99], a[240:243], v[236:239], a[96:99]
    s_waitcnt vmcnt(10) lgkmcnt(1)
    v_fmac_f32 v210, -4.0, v206
    v_fma_f32 v206, v210, s26, v212
    v_mfma_f32_16x16x32_bf16 a[96:99], a[252:255], v[228:231], a[96:99]
    v_fmac_f32 v212, s27, v210
    v_fma_f32 v210, v208, 2.0, v249
    v_mfma_f32_16x16x32_bf16 a[100:103], v[240:243], v[228:231], a[100:103]
    v_fmac_f32 v249, -2.0, v208
    v_cvt_pk_bf16_f32 v206, v248, v206
    v_mfma_f32_16x16x32_bf16 a[104:107], v[244:247], v[228:231], a[104:107]
    buffer_load_dwordx4 a[208:211], v254, s[8:11], s42 offen offset:1024 sc1
    v_mfma_f32_16x16x32_bf16 a[108:111], a[228:231], v[236:239], a[108:111]
    v_cvt_pk_bf16_f32 v212, v251, v212
    v_cvt_pk_bf16_f32 v210, v250, v210
    v_mfma_f32_16x16x32_bf16 a[108:111], a[240:243], v[228:231], a[108:111]
    s_waitcnt lgkmcnt(0)
    v_cvt_pk_bf16_f32 v208, v252, v249
    v_lshlrev_b32 v248, 16, v207
    v_mfma_f32_16x16x32_bf16 a[108:111], a[252:255], v[232:235], a[108:111]
    v_lshlrev_b32 v249, 16, v209
    v_lshlrev_b32 v250, 16, v211
    v_mfma_f32_16x16x32_bf16 a[112:115], v[240:243], v[232:235], a[112:115]
    buffer_load_dwordx4 a[212:215], v254, s[8:11], s42 offen offset:2048 sc1
    v_mfma_f32_16x16x32_bf16 a[112:115], a[244:247], v[228:231], a[112:115]
    s_mov_b32 s42, 522240
    v_lshlrev_b32 v251, 16, v213
    v_and_b32 v207, s22, v207
    v_mfma_f32_16x16x32_bf16 a[112:115], a[232:235], v[236:239], a[112:115]
    v_and_b32 v209, s22, v209
    v_and_b32 v211, s22, v211
    v_mfma_f32_16x16x32_bf16 a[116:119], a[236:239], v[236:239], a[116:119]
    ds_read_b128 v[236:239], v253 offset:10400
    v_and_b32 v213, s22, v213
    v_mfma_f32_16x16x32_bf16 a[116:119], a[248:251], v[228:231], a[116:119]
    buffer_load_dwordx4 a[216:219], v254, s[8:11], s42 offen offset:0 sc1
    v_mfma_f32_16x16x32_bf16 a[116:119], v[244:247], v[232:235], a[116:119]
    v_lshlrev_b32 v252, 16, v205
    v_and_b32 v205, s22, v205
    v_mfma_f32_16x16x32_bf16 a[120:123], a[228:231], v[228:231], a[120:123]
    v_fmac_f32 v252, s25, v251
    v_fmac_f32 v205, s25, v213
    v_mfma_f32_16x16x32_bf16 a[120:123], a[240:243], v[232:235], a[120:123]
    s_waitcnt lgkmcnt(0)
    v_fmac_f32 v252, s28, v249
    v_fmac_f32 v205, s28, v209
    v_mfma_f32_16x16x32_bf16 a[120:123], a[252:255], v[236:239], a[120:123]
    v_cvt_pk_bf16_f32 v205, v252, v205
    v_lshlrev_b32 v252, 16, v215
    v_mfma_f32_16x16x32_bf16 a[124:127], v[240:243], v[236:239], a[124:127]
    buffer_load_dwordx4 a[220:223], v254, s[8:11], s42 offen offset:1024 sc1
    v_mfma_f32_16x16x32_bf16 a[124:127], a[244:247], v[232:235], a[124:127]
    v_and_b32 v215, s22, v215
    v_fmac_f32 v252, s29, v248
    v_mfma_f32_16x16x32_bf16 a[124:127], a[232:235], v[228:231], a[124:127]
    v_fmac_f32 v215, s29, v207
    v_fmac_f32 v252, s23, v250
    v_fmac_f32 v215, s23, v211
    v_mfma_f32_16x16x32_bf16 a[128:131], a[236:239], v[228:231], a[128:131]
    ds_read_b128 v[228:231], v253 offset:12224
    v_cvt_pk_bf16_f32 v215, v252, v215
    v_mfma_f32_16x16x32_bf16 a[128:131], a[248:251], v[232:235], a[128:131]
    buffer_load_dwordx4 a[224:227], v254, s[8:11], s42 offen offset:2048 sc1
    v_mfma_f32_16x16x32_bf16 a[128:131], v[244:247], v[236:239], a[128:131]
    v_fma_f32 v252, v249, s24, v251
    v_fmac_f32 v251, -4.0, v249
    v_mfma_f32_16x16x32_bf16 a[132:135], a[228:231], v[232:235], a[132:135]
    v_and_b32 v203, 0x7fff, v255
    v_fma_f32 v249, v248, s24, v250
    v_mfma_f32_16x16x32_bf16 a[132:135], a[240:243], v[236:239], a[132:135]
    s_waitcnt lgkmcnt(0)
    v_fmac_f32 v250, -4.0, v248
    v_fma_f32 v248, v250, s26, v251
    v_mfma_f32_16x16x32_bf16 a[132:135], a[252:255], v[228:231], a[132:135]
    buffer_load_dwordx2 v[192:193], v203, s[4:7], s16 offen offset:1408
    v_mfma_f32_16x16x32_bf16 a[136:139], v[240:243], v[228:231], a[136:139]
    v_fmac_f32 v251, s27, v250
    v_fma_f32 v250, v249, 2.0, v252
    v_mfma_f32_16x16x32_bf16 a[136:139], a[244:247], v[236:239], a[136:139]
    v_fmac_f32 v252, -2.0, v249
    v_fma_f32 v249, v209, s24, v213
    v_mfma_f32_16x16x32_bf16 a[136:139], a[232:235], v[232:235], a[136:139]
    v_fmac_f32 v213, -4.0, v209
    v_fma_f32 v209, v207, s24, v211
    v_mfma_f32_16x16x32_bf16 a[140:143], a[236:239], v[232:235], a[140:143]
    ds_read_b128 v[232:235], v253 offset:11968
    v_fmac_f32 v211, -4.0, v207
    v_mfma_f32_16x16x32_bf16 a[140:143], a[248:251], v[236:239], a[140:143]
    buffer_load_dwordx2 v[194:195], v203, s[4:7], s17 offen offset:1408
    v_mfma_f32_16x16x32_bf16 a[140:143], v[244:247], v[228:231], a[140:143]
    v_fma_f32 v207, v211, s26, v213
    v_fmac_f32 v213, s27, v211
    v_mfma_f32_16x16x32_bf16 a[144:147], a[228:231], v[236:239], a[144:147]
    v_fma_f32 v211, v209, 2.0, v249
    v_fmac_f32 v249, -2.0, v209
    v_mfma_f32_16x16x32_bf16 a[144:147], a[240:243], v[228:231], a[144:147]
    s_waitcnt lgkmcnt(0)
    v_cvt_pk_bf16_f32 v207, v248, v207
    v_cvt_pk_bf16_f32 v213, v251, v213
    v_mfma_f32_16x16x32_bf16 a[144:147], a[252:255], v[232:235], a[144:147]
    buffer_load_dwordx2 v[196:197], v203, s[4:7], s18 offen offset:1408
    v_mfma_f32_16x16x32_bf16 a[148:151], v[240:243], v[232:235], a[148:151]
    v_cvt_pk_bf16_f32 v211, v250, v211
    v_cvt_pk_bf16_f32 v209, v252, v249
    v_mfma_f32_16x16x32_bf16 a[148:151], a[244:247], v[228:231], a[148:151]
    v_lshrrev_b32 v252, 15, v255
    v_mfma_f32_16x16x32_bf16 a[148:151], a[232:235], v[236:239], a[148:151]
    ds_write_b64 v252, v[206:207] offset:512
    v_mfma_f32_16x16x32_bf16 a[152:155], a[236:239], v[236:239], a[152:155]
    ds_read_b128 v[236:239], v253 offset:11712
    v_lshrrev_b32 v206, 15, v255
    v_mfma_f32_16x16x32_bf16 a[152:155], a[248:251], v[228:231], a[152:155]
    buffer_load_dwordx2 v[198:199], v203, s[4:7], s19 offen offset:1408
    v_mfma_f32_16x16x32_bf16 a[152:155], v[244:247], v[232:235], a[152:155]
    ds_write_b64 v206, v[212:213] offset:2592
    v_mfma_f32_16x16x32_bf16 a[156:159], a[228:231], v[228:231], a[156:159]
    v_mfma_f32_16x16x32_bf16 a[156:159], a[240:243], v[232:235], a[156:159]
    s_waitcnt lgkmcnt(1)
    s_waitcnt vmcnt(13)
    v_lshlrev_b32 v248, 16, v218
    v_mfma_f32_16x16x32_bf16 a[156:159], a[252:255], v[236:239], a[156:159]
    buffer_load_dwordx2 v[200:201], v203, s[4:7], s20 offen offset:1408
    v_mfma_f32_16x16x32_bf16 a[160:163], v[240:243], v[236:239], a[160:163]
    ds_write_b64 v206, v[210:211] offset:4672
    v_mfma_f32_16x16x32_bf16 a[160:163], a[244:247], v[232:235], a[160:163]
    v_lshlrev_b32 v249, 16, v220
    v_lshlrev_b32 v250, 16, v222
    v_mfma_f32_16x16x32_bf16 a[160:163], a[232:235], v[228:231], a[160:163]
    ds_write_b64 v206, v[204:205] offset:21312
    v_mfma_f32_16x16x32_bf16 a[164:167], a[236:239], v[228:231], a[164:167]
    ds_read_b128 v[228:231], v253 offset:11456
    v_lshlrev_b32 v251, 16, v224
    v_mfma_f32_16x16x32_bf16 a[164:167], a[248:251], v[232:235], a[164:167]
    buffer_load_dwordx2 v[202:203], v203, s[4:7], s21 offen offset:1408
    v_mfma_f32_16x16x32_bf16 a[164:167], v[244:247], v[236:239], a[164:167]
    ds_write_b64 v206, v[214:215] offset:29632
    v_mfma_f32_16x16x32_bf16 a[168:171], a[228:231], v[232:235], a[168:171]
    v_and_b32 v218, s22, v218
    v_and_b32 v220, s22, v220
    v_mfma_f32_16x16x32_bf16 a[168:171], a[240:243], v[236:239], a[168:171]
    s_waitcnt lgkmcnt(1)
    v_and_b32 v222, s22, v222
    v_and_b32 v224, s22, v224
    v_mfma_f32_16x16x32_bf16 a[168:171], a[252:255], v[228:231], a[168:171]
    ds_write_b64 v206, v[208:209] offset:6752
    v_mfma_f32_16x16x32_bf16 a[172:175], v[240:243], v[228:231], a[172:175]
    ds_read_b128 v[204:207], v253 offset:40288
    s_mov_b32 s45, 472974346
    v_mfma_f32_16x16x32_bf16 a[172:175], a[244:247], v[236:239], a[172:175]
    v_bfe_u32 v208, v254, 5, 3
    v_mul_u32_u24 v209, 5, v208
    v_mfma_f32_16x16x32_bf16 a[172:175], a[232:235], v[232:235], a[172:175]
    v_bfe_u32 v209, s45, v209, 5
    v_mul_u32_u24 v209, 65, v209
    v_mfma_f32_16x16x32_bf16 a[176:179], a[236:239], v[232:235], a[176:179]
    ds_read_b128 v[232:235], v253 offset:11184
    v_sub_u32 v209, v209, v208
    v_mfma_f32_16x16x32_bf16 a[176:179], a[248:251], v[236:239], a[176:179]
    v_lshl_add_u32 v208, v209, 5, v253
    s_waitcnt lgkmcnt(1)
    v_mfma_f32_16x16x32_bf16 a[176:179], v[244:247], v[228:231], a[176:179]
    s_mov_b32 s42, 552960
    v_lshlrev_b32 v252, 16, v216
    v_and_b32 v216, s22, v216
    v_mfma_f32_16x16x32_bf16 a[180:183], a[228:231], v[236:239], a[180:183]
    s_mov_b64 exec, s[46:47]
    ds_write_b128 v208, v[204:207] offset:1024
    s_mov_b64 exec, -1
    v_fmac_f32 v252, s25, v251
    v_mfma_f32_16x16x32_bf16 a[184:187], a[232:235], v[236:239], a[184:187]
    v_fmac_f32 v216, s25, v224
    v_fmac_f32 v252, s28, v249
    v_mfma_f32_16x16x32_bf16 a[188:191], a[236:239], v[236:239], a[188:191]
    ds_read_b128 v[236:239], v253 offset:13520
    v_fmac_f32 v216, s28, v220
    v_mfma_f32_16x16x32_bf16 a[188:191], a[248:251], v[228:231], a[188:191]
    buffer_load_dwordx4 a[228:231], v254, s[8:11], s42 offen offset:0 sc1
    v_mfma_f32_16x16x32_bf16 a[184:187], a[244:247], v[228:231], a[184:187]
    s_waitcnt lgkmcnt(2)
    v_cvt_pk_bf16_f32 v216, v252, v216
    v_lshlrev_b32 v252, 16, v226
    v_mfma_f32_16x16x32_bf16 a[180:183], a[240:243], v[228:231], a[180:183]
    ds_read_b128 v[228:231], v253 offset:13248
    v_and_b32 v226, s22, v226
    v_mfma_f32_16x16x32_bf16 a[180:183], a[252:255], v[232:235], a[180:183]
    buffer_load_dwordx4 a[232:235], v254, s[8:11], s42 offen offset:1024 sc1
    v_mfma_f32_16x16x32_bf16 a[184:187], v[240:243], v[232:235], a[184:187]
    s_waitcnt vmcnt(14) lgkmcnt(1)
    v_fmac_f32 v252, s29, v248
    v_fmac_f32 v226, s29, v218
    v_mfma_f32_16x16x32_bf16 a[188:191], v[244:247], v[232:235], a[188:191]
    ds_read_b128 v[232:235], v253 offset:12992
    v_fmac_f32 v252, s23, v250
sub14:
    v_mfma_f32_16x16x32_bf16 v[0:3], a[192:195], v[236:239], v[0:3]
    buffer_load_dwordx4 a[236:239], v254, s[8:11], s42 offen offset:2048 sc1
    v_mfma_f32_16x16x32_bf16 v[4:7], a[196:199], v[236:239], v[4:7]
    s_mov_b32 s42, 556032
    v_fmac_f32 v226, s23, v222
    v_cvt_pk_bf16_f32 v226, v252, v226
    v_mfma_f32_16x16x32_bf16 v[8:11], a[200:203], v[236:239], v[8:11]
    ds_read_b128 v[236:239], v253 offset:12736
    s_waitcnt vmcnt(12)
    s_waitcnt lgkmcnt(2)
    v_mfma_f32_16x16x32_bf16 v[8:11], a[212:215], v[228:231], v[8:11]
    v_fma_f32 v252, v249, s24, v251
    v_fmac_f32 v251, -4.0, v249
    v_mfma_f32_16x16x32_bf16 v[4:7], a[208:211], v[228:231], v[4:7]
    buffer_load_dwordx4 a[240:243], v254, s[8:11], s42 offen offset:0 sc1
    v_mfma_f32_16x16x32_bf16 v[0:3], a[204:207], v[228:231], v[0:3]
    s_waitcnt vmcnt(10) lgkmcnt(1)
    v_fma_f32 v249, v248, s24, v250
    v_fmac_f32 v250, -4.0, v248
    v_mfma_f32_16x16x32_bf16 v[0:3], a[216:219], v[232:235], v[0:3]
    v_fma_f32 v248, v250, s26, v251
    v_fmac_f32 v251, s27, v250
    v_mfma_f32_16x16x32_bf16 v[4:7], a[220:223], v[232:235], v[4:7]
    v_fma_f32 v250, v249, 2.0, v252
    v_fmac_f32 v252, -2.0, v249
    v_mfma_f32_16x16x32_bf16 v[8:11], a[224:227], v[232:235], v[8:11]
    buffer_load_dwordx4 a[244:247], v254, s[8:11], s42 offen offset:1024 sc1
    v_mfma_f32_16x16x32_bf16 v[12:15], a[192:195], v[228:231], v[12:15]
    v_fma_f32 v249, v220, s24, v224
    v_fmac_f32 v224, -4.0, v220
    v_mfma_f32_16x16x32_bf16 v[12:15], a[204:207], v[232:235], v[12:15]
    s_waitcnt lgkmcnt(0)
    v_fma_f32 v220, v218, s24, v222
    v_fmac_f32 v222, -4.0, v218
    v_mfma_f32_16x16x32_bf16 v[12:15], a[216:219], v[236:239], v[12:15]
    v_fma_f32 v218, v222, s26, v224
    v_fmac_f32 v224, s27, v222
    v_mfma_f32_16x16x32_bf16 v[16:19], a[220:223], v[236:239], v[16:19]
    buffer_load_dwordx4 a[248:251], v254, s[8:11], s42 offen offset:2048 sc1
    v_mfma_f32_16x16x32_bf16 v[16:19], a[208:211], v[232:235], v[16:19]
    s_mov_b32 s42, 559104
    v_fma_f32 v222, v220, 2.0, v249
    v_fmac_f32 v249, -2.0, v220
    v_mfma_f32_16x16x32_bf16 v[16:19], a[196:199], v[228:231], v[16:19]
    v_cvt_pk_bf16_f32 v218, v248, v218
    v_cvt_pk_bf16_f32 v224, v251, v224
    v_mfma_f32_16x16x32_bf16 v[20:23], a[200:203], v[228:231], v[20:23]
    ds_read_b128 v[228:231], v253 offset:12480
    v_cvt_pk_bf16_f32 v222, v250, v222
    v_mfma_f32_16x16x32_bf16 v[20:23], a[212:215], v[232:235], v[20:23]
    buffer_load_dwordx4 a[252:255], v254, s[8:11], s42 offen offset:0 sc1
    v_mfma_f32_16x16x32_bf16 v[20:23], a[224:227], v[236:239], v[20:23]
    v_cvt_pk_bf16_f32 v220, v252, v249
    v_lshlrev_b32 v248, 16, v219
    v_mfma_f32_16x16x32_bf16 v[24:27], a[192:195], v[232:235], v[24:27]
    v_lshlrev_b32 v249, 16, v221
    v_lshlrev_b32 v250, 16, v223
    v_mfma_f32_16x16x32_bf16 v[24:27], a[204:207], v[236:239], v[24:27]
    s_waitcnt lgkmcnt(0)
    v_lshlrev_b32 v251, 16, v225
    v_and_b32 v219, s22, v219
    v_mfma_f32_16x16x32_bf16 v[24:27], a[216:219], v[228:231], v[24:27]
    v_and_b32 v221, s22, v221
    v_and_b32 v223, s22, v223
    v_mfma_f32_16x16x32_bf16 v[28:31], a[220:223], v[228:231], v[28:31]
    buffer_load_dwordx4 v[240:243], v254, s[8:11], s42 offen offset:1024 sc1
    v_mfma_f32_16x16x32_bf16 v[28:31], a[208:211], v[236:239], v[28:31]
    v_and_b32 v225, s22, v225
    v_lshlrev_b32 v252, 16, v217
    v_mfma_f32_16x16x32_bf16 v[28:31], a[196:199], v[232:235], v[28:31]
    v_and_b32 v217, s22, v217
    v_fmac_f32 v252, s25, v251
    v_mfma_f32_16x16x32_bf16 v[32:35], a[200:203], v[232:235], v[32:35]
    ds_read_b128 v[232:235], v253 offset:14304
    v_fmac_f32 v217, s25, v225
    v_mfma_f32_16x16x32_bf16 v[32:35], a[212:215], v[236:239], v[32:35]
    buffer_load_dwordx4 v[244:247], v254, s[8:11], s42 offen offset:2048 sc1
    v_mfma_f32_16x16x32_bf16 v[32:35], a[224:227], v[228:231], v[32:35]
    v_fmac_f32 v252, s28, v249
    v_fmac_f32 v217, s28, v221
    v_mfma_f32_16x16x32_bf16 v[36:39], a[192:195], v[236:239], v[36:39]
    v_and_b32 v215, 0x7fff, v255
    v_cvt_pk_bf16_f32 v217, v252, v217
    v_mfma_f32_16x16x32_bf16 v[36:39], a[204:207], v[228:231], v[36:39]
    s_waitcnt lgkmcnt(0)
    v_lshlrev_b32 v252, 16, v227
    v_and_b32 v227, s22, v227
    v_mfma_f32_16x16x32_bf16 v[36:39], a[216:219], v[232:235], v[36:39]
    buffer_load_dwordx2 v[204:205], v215, s[4:7], s16 offen offset:320
    v_mfma_f32_16x16x32_bf16 v[40:43], a[220:223], v[232:235], v[40:43]
    v_fmac_f32 v252, s29, v248
    v_fmac_f32 v227, s29, v219
    v_mfma_f32_16x16x32_bf16 v[40:43], a[208:211], v[228:231], v[40:43]
    v_fmac_f32 v252, s23, v250
    v_fmac_f32 v227, s23, v223
    v_cvt_pk_bf16_f32 v227, v252, v227
    v_mfma_f32_16x16x32_bf16 v[40:43], a[196:199], v[236:239], v[40:43]
    v_fma_f32 v252, v249, s24, v251
    v_fmac_f32 v251, -4.0, v249
    v_mfma_f32_16x16x32_bf16 v[44:47], a[200:203], v[236:239], v[44:47]
    ds_read_b128 v[236:239], v253 offset:14048
    v_fma_f32 v249, v248, s24, v250
    v_mfma_f32_16x16x32_bf16 v[44:47], a[212:215], v[228:231], v[44:47]
    buffer_load_dwordx2 v[206:207], v215, s[4:7], s17 offen offset:320
    v_mfma_f32_16x16x32_bf16 v[44:47], a[224:227], v[232:235], v[44:47]
    v_fmac_f32 v250, -4.0, v248
    v_fma_f32 v248, v250, s26, v251
    v_mfma_f32_16x16x32_bf16 v[48:51], a[192:195], v[228:231], v[48:51]
    v_fmac_f32 v251, s27, v250
    v_fma_f32 v250, v249, 2.0, v252
    v_mfma_f32_16x16x32_bf16 v[48:51], a[204:207], v[232:235], v[48:51]
    s_waitcnt lgkmcnt(0)
    v_fmac_f32 v252, -2.0, v249
    v_fma_f32 v249, v221, s24, v225
    v_mfma_f32_16x16x32_bf16 v[48:51], a[216:219], v[236:239], v[48:51]
    buffer_load_dwordx2 v[208:209], v215, s[4:7], s18 offen offset:320
    v_mfma_f32_16x16x32_bf16 v[52:55], a[220:223], v[236:239], v[52:55]
    v_fmac_f32 v225, -4.0, v221
    v_fma_f32 v221, v219, s24, v223
    v_mfma_f32_16x16x32_bf16 v[52:55], a[208:211], v[232:235], v[52:55]
    v_fmac_f32 v223, -4.0, v219
    v_fma_f32 v219, v223, s26, v225
    v_mfma_f32_16x16x32_bf16 v[52:55], a[196:199], v[228:231], v[52:55]
    v_fmac_f32 v225, s27, v223
    v_fma_f32 v223, v221, 2.0, v249
    v_mfma_f32_16x16x32_bf16 v[56:59], a[200:203], v[228:231], v[56:59]
    ds_read_b128 v[228:231], v253 offset:13792
    v_fmac_f32 v249, -2.0, v221
    v_mfma_f32_16x16x32_bf16 v[56:59], a[212:215], v[232:235], v[56:59]
    buffer_load_dwordx2 v[210:211], v215, s[4:7], s19 offen offset:320
    v_mfma_f32_16x16x32_bf16 v[56:59], a[224:227], v[236:239], v[56:59]
    v_cvt_pk_bf16_f32 v219, v248, v219
    v_cvt_pk_bf16_f32 v225, v251, v225
    v_mfma_f32_16x16x32_bf16 v[60:63], a[192:195], v[232:235], v[60:63]
    v_cvt_pk_bf16_f32 v223, v250, v223
    v_cvt_pk_bf16_f32 v221, v252, v249
    v_mfma_f32_16x16x32_bf16 v[60:63], a[204:207], v[236:239], v[60:63]
pad5:
    s_cbranch_vccnz pad9
    s_waitcnt lgkmcnt(0)
    v_lshrrev_b32 v252, 15, v255
    v_mfma_f32_16x16x32_bf16 v[60:63], a[216:219], v[228:231], v[60:63]
    buffer_load_dwordx2 v[212:213], v215, s[4:7], s20 offen offset:320
    v_mfma_f32_16x16x32_bf16 v[64:67], a[220:223], v[228:231], v[64:67]
    ds_write_b64 v252, v[218:219] offset:256
    v_mfma_f32_16x16x32_bf16 v[64:67], a[208:211], v[236:239], v[64:67]
    s_waitcnt vmcnt(14)
    v_lshrrev_b32 v218, 15, v255
    v_lshlrev_b32 v248, 16, v194
    v_mfma_f32_16x16x32_bf16 v[64:67], a[196:199], v[232:235], v[64:67]
    ds_write_b64 v218, v[224:225] offset:2336
    v_mfma_f32_16x16x32_bf16 v[68:71], a[200:203], v[232:235], v[68:71]
    ds_read_b128 v[232:235], v253 offset:13536
    v_lshlrev_b32 v249, 16, v196
    v_mfma_f32_16x16x32_bf16 v[68:71], a[212:215], v[236:239], v[68:71]
    buffer_load_dwordx2 v[214:215], v215, s[4:7], s21 offen offset:320
    v_mfma_f32_16x16x32_bf16 v[68:71], a[224:227], v[228:231], v[68:71]
    ds_write_b64 v218, v[222:223] offset:4416
    v_mfma_f32_16x16x32_bf16 v[72:75], a[192:195], v[236:239], v[72:75]
    v_lshlrev_b32 v250, 16, v198
    v_lshlrev_b32 v251, 16, v200
    v_mfma_f32_16x16x32_bf16 v[72:75], a[204:207], v[228:231], v[72:75]
    s_waitcnt lgkmcnt(1)
    v_and_b32 v194, s22, v194
    v_and_b32 v196, s22, v196
    v_mfma_f32_16x16x32_bf16 v[72:75], a[216:219], v[232:235], v[72:75]
    ds_write_b64 v218, v[216:217] offset:21056
    v_mfma_f32_16x16x32_bf16 v[76:79], a[220:223], v[232:235], v[76:79]
    v_and_b32 v198, s22, v198
    v_and_b32 v200, s22, v200
    v_mfma_f32_16x16x32_bf16 v[76:79], a[208:211], v[228:231], v[76:79]
    ds_write_b64 v218, v[226:227] offset:29376
    v_mfma_f32_16x16x32_bf16 v[76:79], a[196:199], v[236:239], v[76:79]
    v_lshlrev_b32 v252, 16, v192
    v_and_b32 v192, s22, v192
    v_mfma_f32_16x16x32_bf16 v[80:83], a[200:203], v[236:239], v[80:83]
    ds_read_b128 v[236:239], v253 offset:13264
    v_fmac_f32 v252, s25, v251
    v_mfma_f32_16x16x32_bf16 v[80:83], a[212:215], v[228:231], v[80:83]
    ds_write_b64 v218, v[220:221] offset:6496
    v_mfma_f32_16x16x32_bf16 v[80:83], a[224:227], v[232:235], v[80:83]
    s_mov_b32 s42, 589824
    v_fmac_f32 v192, s25, v200
    v_fmac_f32 v252, s28, v249
    v_mfma_f32_16x16x32_bf16 v[84:87], a[192:195], v[228:231], v[84:87]
    v_fmac_f32 v192, s28, v196
    v_cvt_pk_bf16_f32 v192, v252, v192
    v_mfma_f32_16x16x32_bf16 v[88:91], a[196:199], v[228:231], v[88:91]
    v_lshlrev_b32 v252, 16, v202
    v_and_b32 v202, s22, v202
    v_mfma_f32_16x16x32_bf16 v[92:95], a[200:203], v[228:231], v[92:95]
    ds_read_b128 v[228:231], v253 offset:32240
    v_fmac_f32 v252, s29, v248
    v_mfma_f32_16x16x32_bf16 v[92:95], a[212:215], v[232:235], v[92:95]
    buffer_load_dwordx4 a[192:195], v254, s[8:11], s42 offen offset:0 sc1
    v_mfma_f32_16x16x32_bf16 v[88:91], a[208:211], v[232:235], v[88:91]
    s_waitcnt lgkmcnt(2)
    v_fmac_f32 v202, s29, v194
    v_fmac_f32 v252, s23, v250
    v_mfma_f32_16x16x32_bf16 v[84:87], a[204:207], v[232:235], v[84:87]
    ds_read_b128 v[232:235], v253 offset:31968
    v_fmac_f32 v202, s23, v198
    v_mfma_f32_16x16x32_bf16 v[84:87], a[216:219], v[236:239], v[84:87]
    buffer_load_dwordx4 a[196:199], v254, s[8:11], s42 offen offset:1024 sc1
    v_mfma_f32_16x16x32_bf16 v[88:91], a[220:223], v[236:239], v[88:91]
    s_waitcnt vmcnt(14) lgkmcnt(1)
    v_cvt_pk_bf16_f32 v202, v252, v202
    v_fma_f32 v252, v249, s24, v251
    v_mfma_f32_16x16x32_bf16 v[92:95], a[224:227], v[236:239], v[92:95]
    ds_read_b128 v[236:239], v253 offset:31712
    v_fmac_f32 v251, -4.0, v249
    v_fma_f32 v249, v248, s24, v250
sub15:
    v_mfma_f32_16x16x32_bf16 v[96:99], a[228:231], v[228:231], v[96:99]
    buffer_load_dwordx4 a[200:203], v254, s[8:11], s42 offen offset:2048 sc1
    v_mfma_f32_16x16x32_bf16 v[100:103], a[232:235], v[228:231], v[100:103]
    s_mov_b32 s42, 592896
    v_fmac_f32 v250, -4.0, v248
    v_fma_f32 v248, v250, s26, v251
    v_mfma_f32_16x16x32_bf16 v[104:107], a[236:239], v[228:231], v[104:107]
    ds_read_b128 v[228:231], v253 offset:31456
    s_waitcnt vmcnt(12)
    s_waitcnt lgkmcnt(2)
    v_mfma_f32_16x16x32_bf16 v[104:107], a[248:251], v[232:235], v[104:107]
    v_fmac_f32 v251, s27, v250
    v_fma_f32 v250, v249, 2.0, v252
    v_mfma_f32_16x16x32_bf16 v[100:103], a[244:247], v[232:235], v[100:103]
    buffer_load_dwordx4 a[204:207], v254, s[8:11], s42 offen offset:0 sc1
    v_mfma_f32_16x16x32_bf16 v[96:99], a[240:243], v[232:235], v[96:99]
    s_waitcnt vmcnt(10) lgkmcnt(1)
    v_fmac_f32 v252, -2.0, v249
    v_fma_f32 v249, v196, s24, v200
    v_mfma_f32_16x16x32_bf16 v[96:99], a[252:255], v[236:239], v[96:99]
    v_fmac_f32 v200, -4.0, v196
    v_fma_f32 v196, v194, s24, v198
    v_mfma_f32_16x16x32_bf16 v[100:103], v[240:243], v[236:239], v[100:103]
    v_fmac_f32 v198, -4.0, v194
    v_fma_f32 v194, v198, s26, v200
    v_mfma_f32_16x16x32_bf16 v[104:107], v[244:247], v[236:239], v[104:107]
    buffer_load_dwordx4 a[208:211], v254, s[8:11], s42 offen offset:1024 sc1
    v_mfma_f32_16x16x32_bf16 v[108:111], a[228:231], v[232:235], v[108:111]
    v_fmac_f32 v200, s27, v198
    v_fma_f32 v198, v196, 2.0, v249
    v_mfma_f32_16x16x32_bf16 v[108:111], a[240:243], v[236:239], v[108:111]
    s_waitcnt lgkmcnt(0)
    v_fmac_f32 v249, -2.0, v196
    v_cvt_pk_bf16_f32 v194, v248, v194
    v_mfma_f32_16x16x32_bf16 v[108:111], a[252:255], v[228:231], v[108:111]
    v_cvt_pk_bf16_f32 v200, v251, v200
    v_cvt_pk_bf16_f32 v198, v250, v198
    v_mfma_f32_16x16x32_bf16 v[112:115], v[240:243], v[228:231], v[112:115]
    buffer_load_dwordx4 a[212:215], v254, s[8:11], s42 offen offset:2048 sc1
    v_mfma_f32_16x16x32_bf16 v[112:115], a[244:247], v[236:239], v[112:115]
    s_mov_b32 s42, 595968
    v_cvt_pk_bf16_f32 v196, v252, v249
    v_lshlrev_b32 v248, 16, v195
    v_mfma_f32_16x16x32_bf16 v[112:115], a[232:235], v[232:235], v[112:115]
    v_lshlrev_b32 v249, 16, v197
    v_lshlrev_b32 v250, 16, v199
    v_mfma_f32_16x16x32_bf16 v[116:119], a[236:239], v[232:235], v[116:119]
    ds_read_b128 v[232:235], v253 offset:31200
    v_lshlrev_b32 v251, 16, v201
    v_mfma_f32_16x16x32_bf16 v[116:119], a[248:251], v[236:239], v[116:119]
    buffer_load_dwordx4 a[216:219], v254, s[8:11], s42 offen offset:0 sc1
    v_mfma_f32_16x16x32_bf16 v[116:119], v[244:247], v[228:231], v[116:119]
    v_and_b32 v195, s22, v195
    v_and_b32 v197, s22, v197
    v_mfma_f32_16x16x32_bf16 v[120:123], a[228:231], v[236:239], v[120:123]
    v_and_b32 v199, s22, v199
    v_and_b32 v201, s22, v201
    v_mfma_f32_16x16x32_bf16 v[120:123], a[240:243], v[228:231], v[120:123]
    s_waitcnt lgkmcnt(0)
    v_lshlrev_b32 v252, 16, v193
    v_and_b32 v193, s22, v193
    v_mfma_f32_16x16x32_bf16 v[120:123], a[252:255], v[232:235], v[120:123]
    v_fmac_f32 v252, s25, v251
    v_fmac_f32 v193, s25, v201
    v_mfma_f32_16x16x32_bf16 v[124:127], v[240:243], v[232:235], v[124:127]
    buffer_load_dwordx4 a[220:223], v254, s[8:11], s42 offen offset:1024 sc1
    v_mfma_f32_16x16x32_bf16 v[124:127], a[244:247], v[228:231], v[124:127]
    v_fmac_f32 v252, s28, v249
    v_fmac_f32 v193, s28, v197
    v_mfma_f32_16x16x32_bf16 v[124:127], a[232:235], v[236:239], v[124:127]
    v_cvt_pk_bf16_f32 v193, v252, v193
    v_lshlrev_b32 v252, 16, v203
    v_mfma_f32_16x16x32_bf16 v[128:131], a[236:239], v[236:239], v[128:131]
    ds_read_b128 v[236:239], v253 offset:33024
    v_and_b32 v203, s22, v203
    v_mfma_f32_16x16x32_bf16 v[128:131], a[248:251], v[228:231], v[128:131]
    buffer_load_dwordx4 a[224:227], v254, s[8:11], s42 offen offset:2048 sc1
    v_mfma_f32_16x16x32_bf16 v[128:131], v[244:247], v[232:235], v[128:131]
    v_fmac_f32 v252, s29, v248
    v_fmac_f32 v203, s29, v195
    v_mfma_f32_16x16x32_bf16 v[132:135], a[228:231], v[228:231], v[132:135]
    v_and_b32 v227, 0x7fff, v255
    v_fmac_f32 v252, s23, v250
    v_mfma_f32_16x16x32_bf16 v[132:135], a[240:243], v[232:235], v[132:135]
    s_waitcnt lgkmcnt(0)
    v_fmac_f32 v203, s23, v199
    v_cvt_pk_bf16_f32 v203, v252, v203
    v_mfma_f32_16x16x32_bf16 v[132:135], a[252:255], v[236:239], v[132:135]
    buffer_load_dwordx2 v[216:217], v227, s[4:7], s16 offen offset:704
    v_mfma_f32_16x16x32_bf16 v[136:139], v[240:243], v[236:239], v[136:139]
    v_fma_f32 v252, v249, s24, v251
    v_fmac_f32 v251, -4.0, v249
    v_mfma_f32_16x16x32_bf16 v[136:139], a[244:247], v[232:235], v[136:139]
    v_fma_f32 v249, v248, s24, v250
    v_fmac_f32 v250, -4.0, v248
    v_mfma_f32_16x16x32_bf16 v[136:139], a[232:235], v[228:231], v[136:139]
    v_fma_f32 v248, v250, s26, v251
    v_fmac_f32 v251, s27, v250
    v_mfma_f32_16x16x32_bf16 v[140:143], a[236:239], v[228:231], v[140:143]
    ds_read_b128 v[228:231], v253 offset:32768
    v_fma_f32 v250, v249, 2.0, v252
    v_mfma_f32_16x16x32_bf16 v[140:143], a[248:251], v[232:235], v[140:143]
    buffer_load_dwordx2 v[218:219], v227, s[4:7], s17 offen offset:704
    v_mfma_f32_16x16x32_bf16 v[140:143], v[244:247], v[236:239], v[140:143]
    v_fmac_f32 v252, -2.0, v249
    v_fma_f32 v249, v197, s24, v201
    v_mfma_f32_16x16x32_bf16 v[144:147], a[228:231], v[232:235], v[144:147]
    v_fmac_f32 v201, -4.0, v197
    v_fma_f32 v197, v195, s24, v199
    v_mfma_f32_16x16x32_bf16 v[144:147], a[240:243], v[236:239], v[144:147]
    s_waitcnt lgkmcnt(0)
    v_fmac_f32 v199, -4.0, v195
    v_fma_f32 v195, v199, s26, v201
    v_mfma_f32_16x16x32_bf16 v[144:147], a[252:255], v[228:231], v[144:147]
    buffer_load_dwordx2 v[220:221], v227, s[4:7], s18 offen offset:704
    v_mfma_f32_16x16x32_bf16 v[148:151], v[240:243], v[228:231], v[148:151]
    v_fmac_f32 v201, s27, v199
    v_fma_f32 v199, v197, 2.0, v249
    v_fmac_f32 v249, -2.0, v197
    v_mfma_f32_16x16x32_bf16 v[148:151], a[244:247], v[236:239], v[148:151]
    v_cvt_pk_bf16_f32 v195, v248, v195
    v_cvt_pk_bf16_f32 v201, v251, v201
    v_mfma_f32_16x16x32_bf16 v[148:151], a[232:235], v[232:235], v[148:151]
    v_cvt_pk_bf16_f32 v199, v250, v199
    v_cvt_pk_bf16_f32 v197, v252, v249
    v_mfma_f32_16x16x32_bf16 v[152:155], a[236:239], v[232:235], v[152:155]
    ds_read_b128 v[232:235], v253 offset:32512
    v_lshrrev_b32 v252, 15, v255
    v_mfma_f32_16x16x32_bf16 v[152:155], a[248:251], v[236:239], v[152:155]
    buffer_load_dwordx2 v[222:223], v227, s[4:7], s19 offen offset:704
    v_mfma_f32_16x16x32_bf16 v[152:155], v[244:247], v[228:231], v[152:155]
    ds_write_b64 v252, v[194:195] offset:0
    v_mfma_f32_16x16x32_bf16 v[156:159], a[228:231], v[236:239], v[156:159]
    v_lshrrev_b32 v194, 15, v255
    v_mfma_f32_16x16x32_bf16 v[156:159], a[240:243], v[228:231], v[156:159]
    s_waitcnt lgkmcnt(1)
    s_waitcnt vmcnt(13)
    v_lshlrev_b32 v248, 16, v206
    v_mfma_f32_16x16x32_bf16 v[156:159], a[252:255], v[232:235], v[156:159]
    buffer_load_dwordx2 v[224:225], v227, s[4:7], s20 offen offset:704
    v_mfma_f32_16x16x32_bf16 v[160:163], v[240:243], v[232:235], v[160:163]
    ds_write_b64 v194, v[200:201] offset:2080
    v_mfma_f32_16x16x32_bf16 v[160:163], a[244:247], v[228:231], v[160:163]
    v_lshlrev_b32 v249, 16, v208
    v_lshlrev_b32 v250, 16, v210
    v_mfma_f32_16x16x32_bf16 v[160:163], a[232:235], v[236:239], v[160:163]
    ds_write_b64 v194, v[198:199] offset:4160
    v_mfma_f32_16x16x32_bf16 v[164:167], a[236:239], v[236:239], v[164:167]
    ds_read_b128 v[236:239], v253 offset:32256
    v_lshlrev_b32 v251, 16, v212
    v_mfma_f32_16x16x32_bf16 v[164:167], a[248:251], v[228:231], v[164:167]
    buffer_load_dwordx2 v[226:227], v227, s[4:7], s21 offen offset:704
    v_mfma_f32_16x16x32_bf16 v[164:167], v[244:247], v[232:235], v[164:167]
    ds_write_b64 v194, v[192:193] offset:20800
    v_mfma_f32_16x16x32_bf16 v[168:171], a[228:231], v[228:231], v[168:171]
    v_and_b32 v206, s22, v206
    v_and_b32 v208, s22, v208
    v_mfma_f32_16x16x32_bf16 v[168:171], a[240:243], v[232:235], v[168:171]
    s_waitcnt lgkmcnt(1)
    v_and_b32 v210, s22, v210
    v_and_b32 v212, s22, v212
    v_mfma_f32_16x16x32_bf16 v[168:171], a[252:255], v[236:239], v[168:171]
    ds_write_b64 v194, v[202:203] offset:29120
    v_mfma_f32_16x16x32_bf16 v[172:175], v[240:243], v[236:239], v[172:175]
    v_lshlrev_b32 v252, 16, v204
    v_and_b32 v204, s22, v204
    v_mfma_f32_16x16x32_bf16 v[172:175], a[244:247], v[232:235], v[172:175]
    ds_write_b64 v194, v[196:197] offset:6240
    v_mfma_f32_16x16x32_bf16 v[172:175], a[232:235], v[228:231], v[172:175]
    v_fmac_f32 v252, s25, v251
    v_fmac_f32 v204, s25, v212
    v_fmac_f32 v252, s28, v249
    v_mfma_f32_16x16x32_bf16 v[176:179], a[236:239], v[228:231], v[176:179]
    ds_read_b128 v[228:231], v253 offset:31984
    v_fmac_f32 v204, s28, v208
    v_mfma_f32_16x16x32_bf16 v[176:179], a[248:251], v[232:235], v[176:179]
    v_cvt_pk_bf16_f32 v204, v252, v204
    v_lshlrev_b32 v252, 16, v214
    v_mfma_f32_16x16x32_bf16 v[176:179], v[244:247], v[236:239], v[176:179]
    s_mov_b32 s42, 626688
    v_and_b32 v214, s22, v214
    v_fmac_f32 v252, s29, v248
    v_mfma_f32_16x16x32_bf16 v[180:183], a[228:231], v[232:235], v[180:183]
    s_waitcnt lgkmcnt(0)
    v_fmac_f32 v214, s29, v206
    v_fmac_f32 v252, s23, v250
    v_mfma_f32_16x16x32_bf16 v[184:187], a[232:235], v[232:235], v[184:187]
    s_barrier
    v_mfma_f32_16x16x32_bf16 v[188:191], a[236:239], v[232:235], v[188:191]
    ds_read_b128 v[232:235], v253 offset:1040
    v_fmac_f32 v214, s23, v210
    v_mfma_f32_16x16x32_bf16 v[188:191], a[248:251], v[236:239], v[188:191]
    buffer_load_dwordx4 a[228:231], v254, s[8:11], s42 offen offset:0 sc1
    v_mfma_f32_16x16x32_bf16 v[184:187], a[244:247], v[236:239], v[184:187]
    v_cvt_pk_bf16_f32 v214, v252, v214
    v_fma_f32 v252, v249, s24, v251
    v_mfma_f32_16x16x32_bf16 v[180:183], a[240:243], v[236:239], v[180:183]
    ds_read_b128 v[236:239], v253 offset:768
    v_fmac_f32 v251, -4.0, v249
    v_mfma_f32_16x16x32_bf16 v[180:183], a[252:255], v[228:231], v[180:183]
    buffer_load_dwordx4 a[232:235], v254, s[8:11], s42 offen offset:1024 sc1
    v_mfma_f32_16x16x32_bf16 v[184:187], v[240:243], v[228:231], v[184:187]
    s_waitcnt vmcnt(14) lgkmcnt(1)
    v_fma_f32 v249, v248, s24, v250
    v_fmac_f32 v250, -4.0, v248
    v_mfma_f32_16x16x32_bf16 v[188:191], v[244:247], v[228:231], v[188:191]
    ds_read_b128 v[228:231], v253 offset:512
    v_fma_f32 v248, v250, s26, v251
sub16:
    v_mfma_f32_16x16x32_bf16 a[0:3], a[192:195], v[232:235], a[0:3]
    buffer_load_dwordx4 a[236:239], v254, s[8:11], s42 offen offset:2048 sc1
    v_mfma_f32_16x16x32_bf16 a[4:7], a[196:199], v[232:235], a[4:7]
    s_mov_b32 s42, 629760
    v_fmac_f32 v251, s27, v250
    v_fma_f32 v250, v249, 2.0, v252
    v_mfma_f32_16x16x32_bf16 a[8:11], a[200:203], v[232:235], a[8:11]
    ds_read_b128 v[232:235], v253 offset:256
    s_waitcnt vmcnt(12)
    s_waitcnt lgkmcnt(2)
    v_mfma_f32_16x16x32_bf16 a[8:11], a[212:215], v[236:239], a[8:11]
    v_fmac_f32 v252, -2.0, v249
    v_fma_f32 v249, v208, s24, v212
    v_mfma_f32_16x16x32_bf16 a[4:7], a[208:211], v[236:239], a[4:7]
    buffer_load_dwordx4 a[240:243], v254, s[8:11], s42 offen offset:0 sc1
    v_mfma_f32_16x16x32_bf16 a[0:3], a[204:207], v[236:239], a[0:3]
    s_waitcnt vmcnt(10) lgkmcnt(1)
    v_fmac_f32 v212, -4.0, v208
    v_fma_f32 v208, v206, s24, v210
    v_mfma_f32_16x16x32_bf16 a[0:3], a[216:219], v[228:231], a[0:3]
    v_fmac_f32 v210, -4.0, v206
    v_fma_f32 v206, v210, s26, v212
    v_mfma_f32_16x16x32_bf16 a[4:7], a[220:223], v[228:231], a[4:7]
    v_fmac_f32 v212, s27, v210
    v_fma_f32 v210, v208, 2.0, v249
    v_fmac_f32 v249, -2.0, v208
    v_mfma_f32_16x16x32_bf16 a[8:11], a[224:227], v[228:231], a[8:11]
    buffer_load_dwordx4 a[244:247], v254, s[8:11], s42 offen offset:1024 sc1
    v_mfma_f32_16x16x32_bf16 a[12:15], a[192:195], v[236:239], a[12:15]
    v_cvt_pk_bf16_f32 v206, v248, v206
    v_cvt_pk_bf16_f32 v212, v251, v212
    v_mfma_f32_16x16x32_bf16 a[12:15], a[204:207], v[228:231], a[12:15]
    s_waitcnt lgkmcnt(0)
    v_cvt_pk_bf16_f32 v210, v250, v210
    v_cvt_pk_bf16_f32 v208, v252, v249
    v_mfma_f32_16x16x32_bf16 a[12:15], a[216:219], v[232:235], a[12:15]
    v_lshlrev_b32 v248, 16, v207
    v_lshlrev_b32 v249, 16, v209
    v_mfma_f32_16x16x32_bf16 a[16:19], a[220:223], v[232:235], a[16:19]
    buffer_load_dwordx4 a[248:251], v254, s[8:11], s42 offen offset:2048 sc1
    v_mfma_f32_16x16x32_bf16 a[16:19], a[208:211], v[228:231], a[16:19]
    s_mov_b32 s42, 632832
    v_lshlrev_b32 v250, 16, v211
    v_lshlrev_b32 v251, 16, v213
    v_mfma_f32_16x16x32_bf16 a[16:19], a[196:199], v[236:239], a[16:19]
    v_and_b32 v207, s22, v207
    v_and_b32 v209, s22, v209
    v_mfma_f32_16x16x32_bf16 a[20:23], a[200:203], v[236:239], a[20:23]
    ds_read_b128 v[236:239], v253 offset:0
    v_and_b32 v211, s22, v211
    v_mfma_f32_16x16x32_bf16 a[20:23], a[212:215], v[228:231], a[20:23]
    buffer_load_dwordx4 a[252:255], v254, s[8:11], s42 offen offset:0 sc1
    v_mfma_f32_16x16x32_bf16 a[20:23], a[224:227], v[232:235], a[20:23]
    v_and_b32 v213, s22, v213
    v_lshlrev_b32 v252, 16, v205
    v_mfma_f32_16x16x32_bf16 a[24:27], a[192:195], v[228:231], a[24:27]
    v_and_b32 v205, s22, v205
    v_fmac_f32 v252, s25, v251
    v_mfma_f32_16x16x32_bf16 a[24:27], a[204:207], v[232:235], a[24:27]
    s_waitcnt lgkmcnt(0)
    v_fmac_f32 v205, s25, v213
    v_fmac_f32 v252, s28, v249
    v_mfma_f32_16x16x32_bf16 a[24:27], a[216:219], v[236:239], a[24:27]
    v_fmac_f32 v205, s28, v209
    v_cvt_pk_bf16_f32 v205, v252, v205
    v_mfma_f32_16x16x32_bf16 a[28:31], a[220:223], v[236:239], a[28:31]
    buffer_load_dwordx4 v[240:243], v254, s[8:11], s42 offen offset:1024 sc1
    v_mfma_f32_16x16x32_bf16 a[28:31], a[208:211], v[232:235], a[28:31]
    v_lshlrev_b32 v252, 16, v215
    v_and_b32 v215, s22, v215
    v_mfma_f32_16x16x32_bf16 a[28:31], a[196:199], v[228:231], a[28:31]
    v_fmac_f32 v252, s29, v248
    v_fmac_f32 v215, s29, v207
    v_mfma_f32_16x16x32_bf16 a[32:35], a[200:203], v[228:231], a[32:35]
    ds_read_b128 v[228:231], v253 offset:1824
    v_fmac_f32 v252, s23, v250
    v_mfma_f32_16x16x32_bf16 a[32:35], a[212:215], v[232:235], a[32:35]
    buffer_load_dwordx4 v[244:247], v254, s[8:11], s42 offen offset:2048 sc1
    v_mfma_f32_16x16x32_bf16 a[32:35], a[224:227], v[236:239], a[32:35]
    v_fmac_f32 v215, s23, v211
    v_cvt_pk_bf16_f32 v215, v252, v215
    v_mfma_f32_16x16x32_bf16 a[36:39], a[192:195], v[232:235], a[36:39]
    v_and_b32 v203, 0x7fff, v255
    v_fma_f32 v252, v249, s24, v251
    v_fmac_f32 v251, -4.0, v249
    v_mfma_f32_16x16x32_bf16 a[36:39], a[204:207], v[236:239], a[36:39]
    s_waitcnt lgkmcnt(0)
    v_fma_f32 v249, v248, s24, v250
    v_fmac_f32 v250, -4.0, v248
    v_mfma_f32_16x16x32_bf16 a[36:39], a[216:219], v[228:231], a[36:39]
    buffer_load_dwordx2 v[192:193], v203, s[4:7], s16 offen offset:1088
    v_mfma_f32_16x16x32_bf16 a[40:43], a[220:223], v[228:231], a[40:43]
    v_fma_f32 v248, v250, s26, v251
    v_fmac_f32 v251, s27, v250
    v_mfma_f32_16x16x32_bf16 a[40:43], a[208:211], v[236:239], a[40:43]
    v_fma_f32 v250, v249, 2.0, v252
    v_fmac_f32 v252, -2.0, v249
    v_mfma_f32_16x16x32_bf16 a[40:43], a[196:199], v[232:235], a[40:43]
    v_fma_f32 v249, v209, s24, v213
    v_fmac_f32 v213, -4.0, v209
    v_mfma_f32_16x16x32_bf16 a[44:47], a[200:203], v[232:235], a[44:47]
    ds_read_b128 v[232:235], v253 offset:1568
    v_fma_f32 v209, v207, s24, v211
    v_mfma_f32_16x16x32_bf16 a[44:47], a[212:215], v[236:239], a[44:47]
    buffer_load_dwordx2 v[194:195], v203, s[4:7], s17 offen offset:1088
    v_mfma_f32_16x16x32_bf16 a[44:47], a[224:227], v[228:231], a[44:47]
    v_fmac_f32 v211, -4.0, v207
    v_fma_f32 v207, v211, s26, v213
    v_mfma_f32_16x16x32_bf16 a[48:51], a[192:195], v[236:239], a[48:51]
    v_fmac_f32 v213, s27, v211
    v_fma_f32 v211, v209, 2.0, v249
    v_mfma_f32_16x16x32_bf16 a[48:51], a[204:207], v[228:231], a[48:51]
    s_waitcnt lgkmcnt(0)
    v_fmac_f32 v249, -2.0, v209
    v_cvt_pk_bf16_f32 v207, v248, v207
    v_mfma_f32_16x16x32_bf16 a[48:51], a[216:219], v[232:235], a[48:51]
    buffer_load_dwordx2 v[196:197], v203, s[4:7], s18 offen offset:1088
    v_mfma_f32_16x16x32_bf16 a[52:55], a[220:223], v[232:235], a[52:55]
    v_cvt_pk_bf16_f32 v213, v251, v213
    v_cvt_pk_bf16_f32 v211, v250, v211
    v_mfma_f32_16x16x32_bf16 a[52:55], a[208:211], v[228:231], a[52:55]
    v_cvt_pk_bf16_f32 v209, v252, v249
    v_lshrrev_b32 v252, 15, v255
    v_mfma_f32_16x16x32_bf16 a[52:55], a[196:199], v[236:239], a[52:55]
    ds_write_b64 v252, v[206:207] offset:9088
    v_mfma_f32_16x16x32_bf16 a[56:59], a[200:203], v[236:239], a[56:59]
    ds_read_b128 v[236:239], v253 offset:1312
    v_lshrrev_b32 v206, 15, v255
    v_mfma_f32_16x16x32_bf16 a[56:59], a[212:215], v[228:231], a[56:59]
    buffer_load_dwordx2 v[198:199], v203, s[4:7], s19 offen offset:1088
    v_mfma_f32_16x16x32_bf16 a[56:59], a[224:227], v[232:235], a[56:59]
    ds_write_b64 v206, v[212:213] offset:11168
    v_mfma_f32_16x16x32_bf16 a[60:63], a[192:195], v[228:231], a[60:63]
    v_mfma_f32_16x16x32_bf16 a[60:63], a[204:207], v[232:235], a[60:63]
    s_waitcnt lgkmcnt(1)
    s_waitcnt vmcnt(13)
    v_lshlrev_b32 v248, 16, v218
    v_mfma_f32_16x16x32_bf16 a[60:63], a[216:219], v[236:239], a[60:63]
    buffer_load_dwordx2 v[200:201], v203, s[4:7], s20 offen offset:1088
    v_lshlrev_b32 v249, 16, v220
    v_mfma_f32_16x16x32_bf16 a[64:67], a[220:223], v[236:239], a[64:67]
    ds_write_b64 v206, v[210:211] offset:13248
    v_mfma_f32_16x16x32_bf16 a[64:67], a[208:211], v[232:235], a[64:67]
    v_lshlrev_b32 v250, 16, v222
    v_lshlrev_b32 v251, 16, v224
    v_mfma_f32_16x16x32_bf16 a[64:67], a[196:199], v[228:231], a[64:67]
    ds_write_b64 v206, v[204:205] offset:23648
    v_mfma_f32_16x16x32_bf16 a[68:71], a[200:203], v[228:231], a[68:71]
    ds_read_b128 v[228:231], v253 offset:1056
    v_and_b32 v218, s22, v218
    v_mfma_f32_16x16x32_bf16 a[68:71], a[212:215], v[232:235], a[68:71]
    buffer_load_dwordx2 v[202:203], v203, s[4:7], s21 offen offset:1088
    v_mfma_f32_16x16x32_bf16 a[68:71], a[224:227], v[236:239], a[68:71]
    ds_write_b64 v206, v[214:215] offset:31968
    v_mfma_f32_16x16x32_bf16 a[72:75], a[192:195], v[232:235], a[72:75]
    v_and_b32 v220, s22, v220
    v_and_b32 v222, s22, v222
    v_mfma_f32_16x16x32_bf16 a[72:75], a[204:207], v[236:239], a[72:75]
    s_waitcnt lgkmcnt(1)
    v_and_b32 v224, s22, v224
    v_lshlrev_b32 v252, 16, v216
    v_mfma_f32_16x16x32_bf16 a[72:75], a[216:219], v[228:231], a[72:75]
    v_and_b32 v216, s22, v216
    v_fmac_f32 v252, s25, v251
    v_mfma_f32_16x16x32_bf16 a[76:79], a[220:223], v[228:231], a[76:79]
    v_fmac_f32 v216, s25, v224
    v_fmac_f32 v252, s28, v249
    v_mfma_f32_16x16x32_bf16 a[76:79], a[208:211], v[236:239], a[76:79]
    v_fmac_f32 v216, s28, v220
    v_cvt_pk_bf16_f32 v216, v252, v216
    v_mfma_f32_16x16x32_bf16 a[76:79], a[196:199], v[232:235], a[76:79]
    v_lshlrev_b32 v252, 16, v226
    v_and_b32 v226, s22, v226
    v_mfma_f32_16x16x32_bf16 a[80:83], a[200:203], v[232:235], a[80:83]
    ds_read_b128 v[232:235], v253 offset:784
    v_fmac_f32 v252, s29, v248
    v_mfma_f32_16x16x32_bf16 a[80:83], a[212:215], v[236:239], a[80:83]
    v_fmac_f32 v226, s29, v218
    v_fmac_f32 v252, s23, v250
    v_mfma_f32_16x16x32_bf16 a[80:83], a[224:227], v[228:231], a[80:83]
    s_mov_b32 s42, 663552
    v_fmac_f32 v226, s23, v222
    v_cvt_pk_bf16_f32 v226, v252, v226
    v_mfma_f32_16x16x32_bf16 a[84:87], a[192:195], v[236:239], a[84:87]
    s_waitcnt lgkmcnt(0)
    v_fma_f32 v252, v249, s24, v251
    v_fmac_f32 v251, -4.0, v249
    v_mfma_f32_16x16x32_bf16 a[88:91], a[196:199], v[236:239], a[88:91]
    s_barrier
    v_mfma_f32_16x16x32_bf16 a[92:95], a[200:203], v[236:239], a[92:95]
    ds_read_b128 v[236:239], v253 offset:3120
    v_fma_f32 v249, v248, s24, v250
    v_mfma_f32_16x16x32_bf16 a[92:95], a[212:215], v[228:231], a[92:95]
    buffer_load_dwordx4 a[192:195], v254, s[8:11], s42 offen offset:0 sc1
    v_mfma_f32_16x16x32_bf16 a[88:91], a[208:211], v[228:231], a[88:91]
    v_fmac_f32 v250, -4.0, v248
    v_fma_f32 v248, v250, s26, v251
    v_fmac_f32 v251, s27, v250
    v_mfma_f32_16x16x32_bf16 a[84:87], a[204:207], v[228:231], a[84:87]
    ds_read_b128 v[228:231], v253 offset:2848
    v_fma_f32 v250, v249, 2.0, v252
    v_mfma_f32_16x16x32_bf16 a[84:87], a[216:219], v[232:235], a[84:87]
    buffer_load_dwordx4 a[196:199], v254, s[8:11], s42 offen offset:1024 sc1
    v_mfma_f32_16x16x32_bf16 a[88:91], a[220:223], v[232:235], a[88:91]
    s_waitcnt vmcnt(14) lgkmcnt(1)
    v_fmac_f32 v252, -2.0, v249
    v_fma_f32 v249, v220, s24, v224
    v_mfma_f32_16x16x32_bf16 a[92:95], a[224:227], v[232:235], a[92:95]
    ds_read_b128 v[232:235], v253 offset:2592
    v_fmac_f32 v224, -4.0, v220
sub17:
    v_mfma_f32_16x16x32_bf16 a[96:99], a[228:231], v[236:239], a[96:99]
    buffer_load_dwordx4 a[200:203], v254, s[8:11], s42 offen offset:2048 sc1
    v_mfma_f32_16x16x32_bf16 a[100:103], a[232:235], v[236:239], a[100:103]
    s_mov_b32 s42, 666624
    v_fma_f32 v220, v218, s24, v222
    v_fmac_f32 v222, -4.0, v218
    v_mfma_f32_16x16x32_bf16 a[104:107], a[236:239], v[236:239], a[104:107]
    ds_read_b128 v[236:239], v253 offset:2336
    s_waitcnt vmcnt(12)
    s_waitcnt lgkmcnt(2)
    v_mfma_f32_16x16x32_bf16 a[104:107], a[248:251], v[228:231], a[104:107]
    ds_write_b64 v206, v[208:209] offset:768
    v_mfma_f32_16x16x32_bf16 a[100:103], a[244:247], v[228:231], a[100:103]
    buffer_load_dwordx4 a[204:207], v254, s[8:11], s42 offen offset:0 sc1
    v_mfma_f32_16x16x32_bf16 a[96:99], a[240:243], v[228:231], a[96:99]
    s_waitcnt vmcnt(10) lgkmcnt(2)
    v_fma_f32 v218, v222, s26, v224
    v_fmac_f32 v224, s27, v222
    v_mfma_f32_16x16x32_bf16 a[96:99], a[252:255], v[232:235], a[96:99]
    v_fma_f32 v222, v220, 2.0, v249
    v_fmac_f32 v249, -2.0, v220
    v_mfma_f32_16x16x32_bf16 a[100:103], v[240:243], v[232:235], a[100:103]
    v_cvt_pk_bf16_f32 v218, v248, v218
    v_cvt_pk_bf16_f32 v224, v251, v224
    v_mfma_f32_16x16x32_bf16 a[104:107], v[244:247], v[232:235], a[104:107]
    buffer_load_dwordx4 a[208:211], v254, s[8:11], s42 offen offset:1024 sc1
    v_mfma_f32_16x16x32_bf16 a[108:111], a[228:231], v[228:231], a[108:111]
    v_cvt_pk_bf16_f32 v222, v250, v222
    v_cvt_pk_bf16_f32 v220, v252, v249
    v_mfma_f32_16x16x32_bf16 a[108:111], a[240:243], v[232:235], a[108:111]
    s_waitcnt lgkmcnt(1)
    v_lshlrev_b32 v248, 16, v219
    v_lshlrev_b32 v249, 16, v221
    v_mfma_f32_16x16x32_bf16 a[108:111], a[252:255], v[236:239], a[108:111]
    v_lshlrev_b32 v250, 16, v223
    v_lshlrev_b32 v251, 16, v225
    v_mfma_f32_16x16x32_bf16 a[112:115], v[240:243], v[236:239], a[112:115]
    buffer_load_dwordx4 a[212:215], v254, s[8:11], s42 offen offset:2048 sc1
    v_mfma_f32_16x16x32_bf16 a[112:115], a[244:247], v[232:235], a[112:115]
    s_mov_b32 s42, 669696
    v_and_b32 v219, s22, v219
    v_and_b32 v221, s22, v221
    v_mfma_f32_16x16x32_bf16 a[112:115], a[232:235], v[228:231], a[112:115]
    v_and_b32 v223, s22, v223
    v_and_b32 v225, s22, v225
    v_mfma_f32_16x16x32_bf16 a[116:119], a[236:239], v[228:231], a[116:119]
    ds_read_b128 v[228:231], v253 offset:2080
    v_lshlrev_b32 v252, 16, v217
    v_and_b32 v217, s22, v217
    v_mfma_f32_16x16x32_bf16 a[116:119], a[248:251], v[232:235], a[116:119]
    buffer_load_dwordx4 a[216:219], v254, s[8:11], s42 offen offset:0 sc1
    v_mfma_f32_16x16x32_bf16 a[116:119], v[244:247], v[236:239], a[116:119]
    v_fmac_f32 v252, s25, v251
    v_fmac_f32 v217, s25, v225
    v_mfma_f32_16x16x32_bf16 a[120:123], a[228:231], v[232:235], a[120:123]
    v_fmac_f32 v252, s28, v249
    v_fmac_f32 v217, s28, v221
    v_mfma_f32_16x16x32_bf16 a[120:123], a[240:243], v[236:239], a[120:123]
    s_waitcnt lgkmcnt(0)
    v_cvt_pk_bf16_f32 v217, v252, v217
    v_lshlrev_b32 v252, 16, v227
    v_mfma_f32_16x16x32_bf16 a[120:123], a[252:255], v[228:231], a[120:123]
    v_and_b32 v227, s22, v227
    v_fmac_f32 v252, s29, v248
    v_mfma_f32_16x16x32_bf16 a[124:127], v[240:243], v[228:231], a[124:127]
    buffer_load_dwordx4 a[220:223], v254, s[8:11], s42 offen offset:1024 sc1
    v_mfma_f32_16x16x32_bf16 a[124:127], a[244:247], v[236:239], a[124:127]
    v_fmac_f32 v227, s29, v219
    v_fmac_f32 v252, s23, v250
    v_mfma_f32_16x16x32_bf16 a[124:127], a[232:235], v[232:235], a[124:127]
    v_fmac_f32 v227, s23, v223
    v_cvt_pk_bf16_f32 v227, v252, v227
    v_mfma_f32_16x16x32_bf16 a[128:131], a[236:239], v[232:235], a[128:131]
    ds_read_b128 v[232:235], v253 offset:3904
    v_fma_f32 v252, v249, s24, v251
    v_mfma_f32_16x16x32_bf16 a[128:131], a[248:251], v[236:239], a[128:131]
    buffer_load_dwordx4 a[224:227], v254, s[8:11], s42 offen offset:2048 sc1
    v_mfma_f32_16x16x32_bf16 a[128:131], v[244:247], v[228:231], a[128:131]
    v_fmac_f32 v251, -4.0, v249
    v_fma_f32 v249, v248, s24, v250
    v_mfma_f32_16x16x32_bf16 a[132:135], a[228:231], v[236:239], a[132:135]
    v_and_b32 v215, 0x7fff, v255
    v_fmac_f32 v250, -4.0, v248
    v_mfma_f32_16x16x32_bf16 a[132:135], a[240:243], v[228:231], a[132:135]
    s_waitcnt lgkmcnt(0)
    v_fma_f32 v248, v250, s26, v251
    v_fmac_f32 v251, s27, v250
    v_mfma_f32_16x16x32_bf16 a[132:135], a[252:255], v[232:235], a[132:135]
    buffer_load_dwordx2 v[204:205], v215, s[4:7], s16 offen offset:1472
    v_mfma_f32_16x16x32_bf16 a[136:139], v[240:243], v[232:235], a[136:139]
    v_fma_f32 v250, v249, 2.0, v252
    v_fmac_f32 v252, -2.0, v249
    v_mfma_f32_16x16x32_bf16 a[136:139], a[244:247], v[228:231], a[136:139]
    v_fma_f32 v249, v221, s24, v225
    v_fmac_f32 v225, -4.0, v221
    v_mfma_f32_16x16x32_bf16 a[136:139], a[232:235], v[236:239], a[136:139]
    v_fma_f32 v221, v219, s24, v223
    v_fmac_f32 v223, -4.0, v219
    v_mfma_f32_16x16x32_bf16 a[140:143], a[236:239], v[236:239], a[140:143]
    ds_read_b128 v[236:239], v253 offset:3648
    v_fma_f32 v219, v223, s26, v225
    v_mfma_f32_16x16x32_bf16 a[140:143], a[248:251], v[228:231], a[140:143]
    buffer_load_dwordx2 v[206:207], v215, s[4:7], s17 offen offset:1472
    v_mfma_f32_16x16x32_bf16 a[140:143], v[244:247], v[232:235], a[140:143]
    v_fmac_f32 v225, s27, v223
    v_fma_f32 v223, v221, 2.0, v249
    v_fmac_f32 v249, -2.0, v221
    v_mfma_f32_16x16x32_bf16 a[144:147], a[228:231], v[228:231], a[144:147]
    v_cvt_pk_bf16_f32 v219, v248, v219
    v_cvt_pk_bf16_f32 v225, v251, v225
    v_mfma_f32_16x16x32_bf16 a[144:147], a[240:243], v[232:235], a[144:147]
    s_waitcnt lgkmcnt(0)
    v_cvt_pk_bf16_f32 v223, v250, v223
    v_cvt_pk_bf16_f32 v221, v252, v249
    v_mfma_f32_16x16x32_bf16 a[144:147], a[252:255], v[236:239], a[144:147]
    buffer_load_dwordx2 v[208:209], v215, s[4:7], s18 offen offset:1472
    v_mfma_f32_16x16x32_bf16 a[148:151], v[240:243], v[236:239], a[148:151]
    v_lshrrev_b32 v252, 15, v255
    v_mfma_f32_16x16x32_bf16 a[148:151], a[244:247], v[232:235], a[148:151]
    ds_write_b64 v252, v[218:219] offset:8832
    v_mfma_f32_16x16x32_bf16 a[148:151], a[232:235], v[228:231], a[148:151]
    v_lshrrev_b32 v218, 15, v255
    v_mfma_f32_16x16x32_bf16 a[152:155], a[236:239], v[228:231], a[152:155]
    ds_read_b128 v[228:231], v253 offset:3392
    v_mfma_f32_16x16x32_bf16 a[152:155], a[248:251], v[232:235], a[152:155]
    buffer_load_dwordx2 v[210:211], v215, s[4:7], s19 offen offset:1472
    v_mfma_f32_16x16x32_bf16 a[152:155], v[244:247], v[236:239], a[152:155]
pad6:
    s_cbranch_vccnz pad10
    ds_write_b64 v218, v[224:225] offset:10912
    v_mfma_f32_16x16x32_bf16 a[156:159], a[228:231], v[232:235], a[156:159]
    v_mfma_f32_16x16x32_bf16 a[156:159], a[240:243], v[236:239], a[156:159]
    s_waitcnt lgkmcnt(1)
    s_waitcnt vmcnt(13)
    v_lshlrev_b32 v248, 16, v194
    v_mfma_f32_16x16x32_bf16 a[156:159], a[252:255], v[228:231], a[156:159]
    buffer_load_dwordx2 v[212:213], v215, s[4:7], s20 offen offset:1472
    v_mfma_f32_16x16x32_bf16 a[160:163], v[240:243], v[228:231], a[160:163]
    ds_write_b64 v218, v[222:223] offset:12992
    v_mfma_f32_16x16x32_bf16 a[160:163], a[244:247], v[236:239], a[160:163]
    v_lshlrev_b32 v249, 16, v196
    v_lshlrev_b32 v250, 16, v198
    v_mfma_f32_16x16x32_bf16 a[160:163], a[232:235], v[232:235], a[160:163]
    ds_write_b64 v218, v[216:217] offset:23392
    v_mfma_f32_16x16x32_bf16 a[164:167], a[236:239], v[232:235], a[164:167]
    ds_read_b128 v[232:235], v253 offset:3136
    v_lshlrev_b32 v251, 16, v200
    v_mfma_f32_16x16x32_bf16 a[164:167], a[248:251], v[236:239], a[164:167]
    buffer_load_dwordx2 v[214:215], v215, s[4:7], s21 offen offset:1472
    v_mfma_f32_16x16x32_bf16 a[164:167], v[244:247], v[228:231], a[164:167]
    s_add_u32 s49, s49, 8
    v_and_b32 v194, s22, v194
    v_and_b32 v196, s22, v196
    v_mfma_f32_16x16x32_bf16 a[168:171], a[228:231], v[236:239], a[168:171]
    ds_write_b64 v218, v[226:227] offset:31712
    v_mfma_f32_16x16x32_bf16 a[168:171], a[240:243], v[228:231], a[168:171]
    s_waitcnt lgkmcnt(1)
    v_and_b32 v198, s22, v198
    v_and_b32 v200, s22, v200
    v_lshlrev_b32 v252, 16, v192
    v_mfma_f32_16x16x32_bf16 a[168:171], a[252:255], v[232:235], a[168:171]
    s_cmp_eq_u32 s39, 1
    s_cselect_b32 s49, 128, s49
    s_cselect_b32 s36, 2130706432, 0
    v_mfma_f32_16x16x32_bf16 a[172:175], v[240:243], v[232:235], a[172:175]
    ds_write_b64 v218, v[220:221] offset:512
    v_mfma_f32_16x16x32_bf16 a[172:175], a[244:247], v[228:231], a[172:175]
    ds_read_b128 v[216:219], v253 offset:40480
    s_mov_b32 s45, 503518347
    v_mfma_f32_16x16x32_bf16 a[172:175], a[232:235], v[236:239], a[172:175]
    s_mul_i32 s43, s49, 786432
    v_bfe_u32 v220, v254, 5, 3
    v_mul_u32_u24 v221, 5, v220
    v_mfma_f32_16x16x32_bf16 a[176:179], a[236:239], v[236:239], a[176:179]
    ds_read_b128 v[236:239], v253 offset:2864
    v_bfe_u32 v221, s45, v221, 5
    v_mfma_f32_16x16x32_bf16 a[176:179], a[248:251], v[228:231], a[176:179]
    v_mul_u32_u24 v221, 65, v221
    v_sub_u32 v221, v221, v220
    v_mfma_f32_16x16x32_bf16 a[176:179], v[244:247], v[232:235], a[176:179]
    s_mov_b32 s42, 700416
    s_add_u32 s43, s43, s53
    v_lshl_add_u32 v220, v221, 5, v253
    v_mfma_f32_16x16x32_bf16 a[180:183], a[228:231], v[228:231], a[180:183]
    s_waitcnt lgkmcnt(1)
    v_and_b32 v192, s22, v192
    v_fmac_f32 v252, s25, v251
    v_mfma_f32_16x16x32_bf16 a[184:187], a[232:235], v[228:231], a[184:187]
    s_mov_b64 exec, s[46:47]
    ds_write_b128 v220, v[216:219] offset:1024
    s_mov_b64 exec, -1
    v_mfma_f32_16x16x32_bf16 a[188:191], a[236:239], v[228:231], a[188:191]
    ds_read_b128 v[228:231], v253 offset:5200
    v_fmac_f32 v192, s25, v200
    v_mfma_f32_16x16x32_bf16 a[188:191], a[248:251], v[232:235], a[188:191]
    buffer_load_dwordx4 a[228:231], v254, s[8:11], s42 offen offset:0 sc1
    v_mfma_f32_16x16x32_bf16 a[184:187], a[244:247], v[232:235], a[184:187]
    s_waitcnt lgkmcnt(2)
    v_fmac_f32 v252, s28, v249
    v_fmac_f32 v192, s28, v196
    v_mfma_f32_16x16x32_bf16 a[180:183], a[240:243], v[232:235], a[180:183]
    ds_read_b128 v[232:235], v253 offset:4928
    v_cvt_pk_bf16_f32 v192, v252, v192
    v_mfma_f32_16x16x32_bf16 a[180:183], a[252:255], v[236:239], a[180:183]
    buffer_load_dwordx4 a[232:235], v254, s[8:11], s42 offen offset:1024 sc1
    v_mfma_f32_16x16x32_bf16 a[184:187], v[240:243], v[236:239], a[184:187]
    s_waitcnt vmcnt(14) lgkmcnt(1)
    v_lshlrev_b32 v252, 16, v202
    v_and_b32 v202, s22, v202
    v_mfma_f32_16x16x32_bf16 a[188:191], v[244:247], v[236:239], a[188:191]
    ds_read_b128 v[236:239], v253 offset:4672
    v_fmac_f32 v252, s29, v248
sub18:
    v_mfma_f32_16x16x32_bf16 v[0:3], a[192:195], v[228:231], v[0:3]
    buffer_load_dwordx4 a[236:239], v254, s[8:11], s42 offen offset:2048 sc1
    v_mfma_f32_16x16x32_bf16 v[4:7], a[196:199], v[228:231], v[4:7]
    s_mov_b32 s42, 703488
    v_fmac_f32 v202, s29, v194
    v_fmac_f32 v252, s23, v250
    v_mfma_f32_16x16x32_bf16 v[8:11], a[200:203], v[228:231], v[8:11]
    ds_read_b128 v[228:231], v253 offset:4416
    s_waitcnt vmcnt(12)
    s_waitcnt lgkmcnt(2)
    v_mfma_f32_16x16x32_bf16 v[8:11], a[212:215], v[232:235], v[8:11]
    s_cmp_ge_u32 s49, 128
    s_cselect_b32 s43, 2130706432, s43
    s_sub_u32 s16, s43, 196608
    v_fmac_f32 v202, s23, v198
    v_mfma_f32_16x16x32_bf16 v[4:7], a[208:211], v[232:235], v[4:7]
    buffer_load_dwordx4 a[240:243], v254, s[8:11], s42 offen offset:0 sc1
    v_mfma_f32_16x16x32_bf16 v[0:3], a[204:207], v[232:235], v[0:3]
    s_waitcnt vmcnt(10) lgkmcnt(1)
    v_cvt_pk_bf16_f32 v202, v252, v202
    v_fma_f32 v252, v249, s24, v251
    v_mfma_f32_16x16x32_bf16 v[0:3], a[216:219], v[236:239], v[0:3]
    s_cmp_eq_u32 s49, 0
    s_cselect_b32 s16, 2130706432, s16
    s_mov_b32 s17, s43
    v_mfma_f32_16x16x32_bf16 v[4:7], a[220:223], v[236:239], v[4:7]
    s_add_u32 s18, s43, 196608
    v_fmac_f32 v251, -4.0, v249
    v_fma_f32 v249, v248, s24, v250
    v_mfma_f32_16x16x32_bf16 v[8:11], a[224:227], v[236:239], v[8:11]
    buffer_load_dwordx4 a[244:247], v254, s[8:11], s42 offen offset:1024 sc1
    v_mfma_f32_16x16x32_bf16 v[12:15], a[192:195], v[232:235], v[12:15]
    s_add_u32 s19, s43, 393216
    v_fmac_f32 v250, -4.0, v248
    v_fma_f32 v248, v250, s26, v251
    v_mfma_f32_16x16x32_bf16 v[12:15], a[204:207], v[236:239], v[12:15]
    s_waitcnt lgkmcnt(0)
    v_fmac_f32 v251, s27, v250
    v_fma_f32 v250, v249, 2.0, v252
    v_mfma_f32_16x16x32_bf16 v[12:15], a[216:219], v[228:231], v[12:15]
    v_fmac_f32 v252, -2.0, v249
    v_fma_f32 v249, v196, s24, v200
    v_mfma_f32_16x16x32_bf16 v[16:19], a[220:223], v[228:231], v[16:19]
    buffer_load_dwordx4 a[248:251], v254, s[8:11], s42 offen offset:2048 sc1
    v_mfma_f32_16x16x32_bf16 v[16:19], a[208:211], v[236:239], v[16:19]
    s_mov_b32 s42, 706560
    s_add_u32 s20, s43, 589824
    v_fmac_f32 v200, -4.0, v196
    v_mfma_f32_16x16x32_bf16 v[16:19], a[196:199], v[232:235], v[16:19]
    v_fma_f32 v196, v194, s24, v198
    v_fmac_f32 v198, -4.0, v194
    v_mfma_f32_16x16x32_bf16 v[20:23], a[200:203], v[232:235], v[20:23]
    ds_read_b128 v[232:235], v253 offset:4160
    v_fma_f32 v194, v198, s26, v200
    v_mfma_f32_16x16x32_bf16 v[20:23], a[212:215], v[236:239], v[20:23]
    buffer_load_dwordx4 a[252:255], v254, s[8:11], s42 offen offset:0 sc1
    v_mfma_f32_16x16x32_bf16 v[20:23], a[224:227], v[228:231], v[20:23]
    s_add_u32 s21, s43, 786432
    v_fmac_f32 v200, s27, v198
    v_fma_f32 v198, v196, 2.0, v249
    v_mfma_f32_16x16x32_bf16 v[24:27], a[192:195], v[236:239], v[24:27]
    v_fmac_f32 v249, -2.0, v196
    v_cvt_pk_bf16_f32 v194, v248, v194
    v_mfma_f32_16x16x32_bf16 v[24:27], a[204:207], v[228:231], v[24:27]
    s_waitcnt lgkmcnt(0)
    s_add_u32 s100, s43, s101
    v_cvt_pk_bf16_f32 v200, v251, v200
    v_mfma_f32_16x16x32_bf16 v[24:27], a[216:219], v[232:235], v[24:27]
    v_cvt_pk_bf16_f32 v198, v250, v198
    v_cvt_pk_bf16_f32 v196, v252, v249
    v_mfma_f32_16x16x32_bf16 v[28:31], a[220:223], v[232:235], v[28:31]
    buffer_load_dwordx4 v[240:243], v254, s[8:11], s42 offen offset:1024 sc1
    v_mfma_f32_16x16x32_bf16 v[28:31], a[208:211], v[228:231], v[28:31]
    s_add_u32 s37, s43, s33
    v_lshlrev_b32 v248, 16, v195
    v_lshlrev_b32 v249, 16, v197
    v_mfma_f32_16x16x32_bf16 v[28:31], a[196:199], v[236:239], v[28:31]
    v_lshlrev_b32 v250, 16, v199
    v_lshlrev_b32 v251, 16, v201
    v_and_b32 v195, s22, v195
    v_mfma_f32_16x16x32_bf16 v[32:35], a[200:203], v[236:239], v[32:35]
    ds_read_b128 v[236:239], v253 offset:5984
    v_and_b32 v197, s22, v197
    v_mfma_f32_16x16x32_bf16 v[32:35], a[212:215], v[228:231], v[32:35]
    buffer_load_dwordx4 v[244:247], v254, s[8:11], s42 offen offset:2048 sc1
    v_mfma_f32_16x16x32_bf16 v[32:35], a[224:227], v[232:235], v[32:35]
    v_and_b32 v199, s22, v199
    v_and_b32 v201, s22, v201
    v_mfma_f32_16x16x32_bf16 v[36:39], a[192:195], v[228:231], v[36:39]
    v_and_b32 v224, 0x1f0, v254
    v_mul_u32_u24 v224, 96, v224
    v_mfma_f32_16x16x32_bf16 v[36:39], a[204:207], v[232:235], v[36:39]
    s_waitcnt lgkmcnt(0)
    v_lshlrev_b32 v252, 16, v193
    v_and_b32 v193, s22, v193
    v_mfma_f32_16x16x32_bf16 v[36:39], a[216:219], v[236:239], v[36:39]
    buffer_load_dword v224, v224, s[4:7], s100 offen offset:0
    v_mfma_f32_16x16x32_bf16 v[40:43], a[220:223], v[236:239], v[40:43]
    v_and_b32 v227, 0xf0, v254
    v_lshrrev_b32 v227, 1, v227
    v_mfma_f32_16x16x32_bf16 v[40:43], a[208:211], v[232:235], v[40:43]
    v_add_u32 v227, s52, v227
    v_mov_b32 v226, s54
    v_mfma_f32_16x16x32_bf16 v[40:43], a[196:199], v[228:231], v[40:43]
    v_mov_b32 v225, s55
    v_cndmask_b32 v226, v226, v225, s[56:57]
    v_mfma_f32_16x16x32_bf16 v[44:47], a[200:203], v[228:231], v[44:47]
    ds_read_b128 v[228:231], v253 offset:5728
    v_add_u32 v227, v227, v226
    v_mfma_f32_16x16x32_bf16 v[44:47], a[212:215], v[232:235], v[44:47]
    s_sub_u32 s45, s16, s50
    v_fmac_f32 v252, s25, v251
    v_fmac_f32 v193, s25, v201
    v_mfma_f32_16x16x32_bf16 v[44:47], a[224:227], v[236:239], v[44:47]
    buffer_load_dwordx2 v[216:217], v227, s[4:7], s45 offen
    v_mfma_f32_16x16x32_bf16 v[48:51], a[192:195], v[232:235], v[48:51]
    s_sub_u32 s45, s17, s50
    v_fmac_f32 v252, s28, v249
    v_fmac_f32 v193, s28, v197
    v_mfma_f32_16x16x32_bf16 v[48:51], a[204:207], v[236:239], v[48:51]
    s_waitcnt lgkmcnt(0)
    v_cvt_pk_bf16_f32 v193, v252, v193
    v_lshlrev_b32 v252, 16, v203
    v_mfma_f32_16x16x32_bf16 v[48:51], a[216:219], v[228:231], v[48:51]
    v_and_b32 v203, s22, v203
    v_fmac_f32 v252, s29, v248
    v_mfma_f32_16x16x32_bf16 v[52:55], a[220:223], v[228:231], v[52:55]
    buffer_load_dwordx2 v[218:219], v227, s[4:7], s45 offen
    v_mfma_f32_16x16x32_bf16 v[52:55], a[208:211], v[236:239], v[52:55]
    s_sub_u32 s45, s18, s50
    v_fmac_f32 v203, s29, v195
    v_fmac_f32 v252, s23, v250
    v_mfma_f32_16x16x32_bf16 v[52:55], a[196:199], v[232:235], v[52:55]
    v_fmac_f32 v203, s23, v199
    v_cvt_pk_bf16_f32 v203, v252, v203
    v_mfma_f32_16x16x32_bf16 v[56:59], a[200:203], v[232:235], v[56:59]
    ds_read_b128 v[232:235], v253 offset:5472
    v_fma_f32 v252, v249, s24, v251
    v_mfma_f32_16x16x32_bf16 v[56:59], a[212:215], v[236:239], v[56:59]
    buffer_load_dwordx2 v[220:221], v227, s[4:7], s45 offen
    v_fmac_f32 v251, -4.0, v249
    v_mfma_f32_16x16x32_bf16 v[56:59], a[224:227], v[228:231], v[56:59]
    s_sub_u32 s45, s19, s50
    v_fma_f32 v249, v248, s24, v250
    v_fmac_f32 v250, -4.0, v248
    v_mfma_f32_16x16x32_bf16 v[60:63], a[192:195], v[236:239], v[60:63]
    v_fma_f32 v248, v250, s26, v251
    v_fmac_f32 v251, s27, v250
    v_mfma_f32_16x16x32_bf16 v[60:63], a[204:207], v[228:231], v[60:63]
    s_waitcnt lgkmcnt(0)
    v_fma_f32 v250, v249, 2.0, v252
    v_fmac_f32 v252, -2.0, v249
    v_mfma_f32_16x16x32_bf16 v[60:63], a[216:219], v[232:235], v[60:63]
    buffer_load_dwordx2 v[222:223], v227, s[4:7], s45 offen
    v_mfma_f32_16x16x32_bf16 v[64:67], a[220:223], v[232:235], v[64:67]
    s_sub_u32 s45, s20, s50
    v_fma_f32 v249, v197, s24, v201
    v_fmac_f32 v201, -4.0, v197
    v_mfma_f32_16x16x32_bf16 v[64:67], a[208:211], v[228:231], v[64:67]
    v_fma_f32 v197, v195, s24, v199
    v_fmac_f32 v199, -4.0, v195
    v_mfma_f32_16x16x32_bf16 v[64:67], a[196:199], v[236:239], v[64:67]
    v_fma_f32 v195, v199, s26, v201
    v_fmac_f32 v201, s27, v199
    v_mfma_f32_16x16x32_bf16 v[68:71], a[200:203], v[236:239], v[68:71]
    ds_read_b128 v[236:239], v253 offset:5216
    v_fma_f32 v199, v197, 2.0, v249
    v_mfma_f32_16x16x32_bf16 v[68:71], a[212:215], v[228:231], v[68:71]
    buffer_load_dwordx2 v[224:225], v227, s[4:7], s45 offen
    v_mfma_f32_16x16x32_bf16 v[68:71], a[224:227], v[232:235], v[68:71]
    s_sub_u32 s45, s21, s50
    v_fmac_f32 v249, -2.0, v197
    v_cvt_pk_bf16_f32 v195, v248, v195
    v_mfma_f32_16x16x32_bf16 v[72:75], a[192:195], v[228:231], v[72:75]
    v_cvt_pk_bf16_f32 v201, v251, v201
    v_cvt_pk_bf16_f32 v199, v250, v199
    v_mfma_f32_16x16x32_bf16 v[72:75], a[204:207], v[232:235], v[72:75]
    s_waitcnt lgkmcnt(0)
    v_cvt_pk_bf16_f32 v197, v252, v249
    v_lshrrev_b32 v252, 15, v255
    v_mfma_f32_16x16x32_bf16 v[72:75], a[216:219], v[236:239], v[72:75]
    buffer_load_dwordx2 v[226:227], v227, s[4:7], s45 offen
    v_mfma_f32_16x16x32_bf16 v[76:79], a[220:223], v[236:239], v[76:79]
    ds_write_b64 v252, v[194:195] offset:8576
    v_mfma_f32_16x16x32_bf16 v[76:79], a[208:211], v[232:235], v[76:79]
    s_waitcnt vmcnt(16)
    v_lshrrev_b32 v194, 15, v255
    v_lshlrev_b32 v248, 16, v206
    v_mfma_f32_16x16x32_bf16 v[76:79], a[196:199], v[228:231], v[76:79]
    ds_write_b64 v194, v[200:201] offset:10656
    v_mfma_f32_16x16x32_bf16 v[80:83], a[200:203], v[228:231], v[80:83]
    ds_read_b128 v[228:231], v253 offset:4944
    v_lshlrev_b32 v249, 16, v208
    v_mfma_f32_16x16x32_bf16 v[80:83], a[212:215], v[232:235], v[80:83]
    ds_write_b64 v194, v[198:199] offset:12736
    v_mfma_f32_16x16x32_bf16 v[80:83], a[224:227], v[236:239], v[80:83]
    s_mov_b32 s42, 737280
    v_lshlrev_b32 v250, 16, v210
    v_lshlrev_b32 v251, 16, v212
    v_mfma_f32_16x16x32_bf16 v[84:87], a[192:195], v[232:235], v[84:87]
    ds_write_b64 v194, v[192:193] offset:23136
    v_and_b32 v206, s22, v206
    v_mfma_f32_16x16x32_bf16 v[88:91], a[196:199], v[232:235], v[88:91]
    v_and_b32 v208, s22, v208
    v_and_b32 v210, s22, v210
    v_mfma_f32_16x16x32_bf16 v[92:95], a[200:203], v[232:235], v[92:95]
    ds_read_b128 v[232:235], v253 offset:7280
    v_and_b32 v212, s22, v212
    v_mfma_f32_16x16x32_bf16 v[92:95], a[212:215], v[236:239], v[92:95]
    buffer_load_dwordx4 a[192:195], v254, s[8:11], s42 offen offset:0 sc1
    v_mfma_f32_16x16x32_bf16 v[88:91], a[208:211], v[236:239], v[88:91]
    s_waitcnt lgkmcnt(3)
    v_lshlrev_b32 v252, 16, v204
    v_and_b32 v204, s22, v204
    v_mfma_f32_16x16x32_bf16 v[84:87], a[204:207], v[236:239], v[84:87]
    ds_read_b128 v[236:239], v253 offset:7008
    v_fmac_f32 v252, s25, v251
    v_mfma_f32_16x16x32_bf16 v[84:87], a[216:219], v[228:231], v[84:87]
    buffer_load_dwordx4 a[196:199], v254, s[8:11], s42 offen offset:1024 sc1
    v_mfma_f32_16x16x32_bf16 v[88:91], a[220:223], v[228:231], v[88:91]
    s_waitcnt vmcnt(15) lgkmcnt(1)
    v_fmac_f32 v204, s25, v212
    v_fmac_f32 v252, s28, v249
    v_mfma_f32_16x16x32_bf16 v[92:95], a[224:227], v[228:231], v[92:95]
    ds_read_b128 v[228:231], v253 offset:6752
    v_fmac_f32 v204, s28, v208
sub19:
    v_mfma_f32_16x16x32_bf16 v[96:99], a[228:231], v[232:235], v[96:99]
    buffer_load_dwordx4 a[200:203], v254, s[8:11], s42 offen offset:2048 sc1
    v_mfma_f32_16x16x32_bf16 v[100:103], a[232:235], v[232:235], v[100:103]
    s_mov_b32 s42, 740352
    v_cvt_pk_bf16_f32 v204, v252, v204
    v_lshlrev_b32 v252, 16, v214
    v_mfma_f32_16x16x32_bf16 v[104:107], a[236:239], v[232:235], v[104:107]
    ds_read_b128 v[232:235], v253 offset:6496
    s_waitcnt vmcnt(13)
    s_waitcnt lgkmcnt(2)
    v_mfma_f32_16x16x32_bf16 v[104:107], a[248:251], v[236:239], v[104:107]
    ds_write_b64 v194, v[202:203] offset:31456
    v_mfma_f32_16x16x32_bf16 v[100:103], a[244:247], v[236:239], v[100:103]
    buffer_load_dwordx4 a[204:207], v254, s[8:11], s42 offen offset:0 sc1
    v_mfma_f32_16x16x32_bf16 v[96:99], a[240:243], v[236:239], v[96:99]
    s_waitcnt vmcnt(11) lgkmcnt(2)
    v_and_b32 v214, s22, v214
    v_fmac_f32 v252, s29, v248
    v_mfma_f32_16x16x32_bf16 v[96:99], a[252:255], v[228:231], v[96:99]
    ds_write_b64 v194, v[196:197] offset:256
    v_mfma_f32_16x16x32_bf16 v[100:103], v[240:243], v[228:231], v[100:103]
    v_fmac_f32 v214, s29, v206
    v_fmac_f32 v252, s23, v250
    v_mfma_f32_16x16x32_bf16 v[104:107], v[244:247], v[228:231], v[104:107]
    buffer_load_dwordx4 a[208:211], v254, s[8:11], s42 offen offset:1024 sc1
    v_mfma_f32_16x16x32_bf16 v[108:111], a[228:231], v[236:239], v[108:111]
    v_fmac_f32 v214, s23, v210
    v_cvt_pk_bf16_f32 v214, v252, v214
    v_mfma_f32_16x16x32_bf16 v[108:111], a[240:243], v[228:231], v[108:111]
    s_waitcnt lgkmcnt(2)
    v_fma_f32 v252, v249, s24, v251
    v_fmac_f32 v251, -4.0, v249
    v_mfma_f32_16x16x32_bf16 v[108:111], a[252:255], v[232:235], v[108:111]
    v_fma_f32 v249, v248, s24, v250
    v_fmac_f32 v250, -4.0, v248
    v_fma_f32 v248, v250, s26, v251
    v_mfma_f32_16x16x32_bf16 v[112:115], v[240:243], v[232:235], v[112:115]
    buffer_load_dwordx4 a[212:215], v254, s[8:11], s42 offen offset:2048 sc1
    v_mfma_f32_16x16x32_bf16 v[112:115], a[244:247], v[228:231], v[112:115]
    s_mov_b32 s42, 743424
    v_fmac_f32 v251, s27, v250
    v_fma_f32 v250, v249, 2.0, v252
    v_mfma_f32_16x16x32_bf16 v[112:115], a[232:235], v[236:239], v[112:115]
    v_fmac_f32 v252, -2.0, v249
    v_fma_f32 v249, v208, s24, v212
    v_mfma_f32_16x16x32_bf16 v[116:119], a[236:239], v[236:239], v[116:119]
    ds_read_b128 v[236:239], v253 offset:6240
    v_fmac_f32 v212, -4.0, v208
    v_mfma_f32_16x16x32_bf16 v[116:119], a[248:251], v[228:231], v[116:119]
    buffer_load_dwordx4 a[216:219], v254, s[8:11], s42 offen offset:0 sc1
    v_mfma_f32_16x16x32_bf16 v[116:119], v[244:247], v[232:235], v[116:119]
    v_fma_f32 v208, v206, s24, v210
    v_fmac_f32 v210, -4.0, v206
    v_mfma_f32_16x16x32_bf16 v[120:123], a[228:231], v[228:231], v[120:123]
    v_fma_f32 v206, v210, s26, v212
    v_fmac_f32 v212, s27, v210
    v_mfma_f32_16x16x32_bf16 v[120:123], a[240:243], v[232:235], v[120:123]
    s_waitcnt lgkmcnt(0)
    v_fma_f32 v210, v208, 2.0, v249
    v_fmac_f32 v249, -2.0, v208
    v_mfma_f32_16x16x32_bf16 v[120:123], a[252:255], v[236:239], v[120:123]
    v_cvt_pk_bf16_f32 v206, v248, v206
    v_cvt_pk_bf16_f32 v212, v251, v212
    v_mfma_f32_16x16x32_bf16 v[124:127], v[240:243], v[236:239], v[124:127]
    buffer_load_dwordx4 a[220:223], v254, s[8:11], s42 offen offset:1024 sc1
    v_mfma_f32_16x16x32_bf16 v[124:127], a[244:247], v[232:235], v[124:127]
    v_cvt_pk_bf16_f32 v210, v250, v210
    v_cvt_pk_bf16_f32 v208, v252, v249
    v_mfma_f32_16x16x32_bf16 v[124:127], a[232:235], v[228:231], v[124:127]
    v_lshlrev_b32 v248, 16, v207
    v_lshlrev_b32 v249, 16, v209
    v_mfma_f32_16x16x32_bf16 v[128:131], a[236:239], v[228:231], v[128:131]
    ds_read_b128 v[228:231], v253 offset:8064
    v_lshlrev_b32 v250, 16, v211
    v_mfma_f32_16x16x32_bf16 v[128:131], a[248:251], v[232:235], v[128:131]
    buffer_load_dwordx4 a[224:227], v254, s[8:11], s42 offen offset:2048 sc1
    v_mfma_f32_16x16x32_bf16 v[128:131], v[244:247], v[236:239], v[128:131]
    v_lshlrev_b32 v251, 16, v213
    v_and_b32 v207, s22, v207
    v_mfma_f32_16x16x32_bf16 v[132:135], a[228:231], v[232:235], v[132:135]
    v_and_b32 v209, s22, v209
    v_and_b32 v211, s22, v211
    v_mfma_f32_16x16x32_bf16 v[132:135], a[240:243], v[236:239], v[132:135]
    s_waitcnt lgkmcnt(0)
    v_and_b32 v213, s22, v213
    v_lshlrev_b32 v252, 16, v205
    v_mfma_f32_16x16x32_bf16 v[132:135], a[252:255], v[228:231], v[132:135]
    v_and_b32 v205, s22, v205
    v_fmac_f32 v252, s25, v251
    v_mfma_f32_16x16x32_bf16 v[136:139], v[240:243], v[228:231], v[136:139]
    v_fmac_f32 v205, s25, v213
    v_fmac_f32 v252, s28, v249
    v_mfma_f32_16x16x32_bf16 v[136:139], a[244:247], v[236:239], v[136:139]
    v_fmac_f32 v205, s28, v209
    v_cvt_pk_bf16_f32 v205, v252, v205
    v_lshlrev_b32 v252, 16, v215
    v_mfma_f32_16x16x32_bf16 v[136:139], a[232:235], v[232:235], v[136:139]
    v_and_b32 v215, s22, v215
    v_fmac_f32 v252, s29, v248
    v_mfma_f32_16x16x32_bf16 v[140:143], a[236:239], v[232:235], v[140:143]
    ds_read_b128 v[232:235], v253 offset:7808
    v_fmac_f32 v215, s29, v207
    v_mfma_f32_16x16x32_bf16 v[140:143], a[248:251], v[236:239], v[140:143]
    v_fmac_f32 v252, s23, v250
    v_fmac_f32 v215, s23, v211
    v_mfma_f32_16x16x32_bf16 v[140:143], v[244:247], v[228:231], v[140:143]
    v_cvt_pk_bf16_f32 v215, v252, v215
    v_fma_f32 v252, v249, s24, v251
    v_mfma_f32_16x16x32_bf16 v[144:147], a[228:231], v[236:239], v[144:147]
    v_fmac_f32 v251, -4.0, v249
    v_fma_f32 v249, v248, s24, v250
    v_mfma_f32_16x16x32_bf16 v[144:147], a[240:243], v[228:231], v[144:147]
    s_waitcnt lgkmcnt(0)
    v_fmac_f32 v250, -4.0, v248
    v_fma_f32 v248, v250, s26, v251
    v_mfma_f32_16x16x32_bf16 v[144:147], a[252:255], v[232:235], v[144:147]
    v_fmac_f32 v251, s27, v250
    v_fma_f32 v250, v249, 2.0, v252
    v_mfma_f32_16x16x32_bf16 v[148:151], v[240:243], v[232:235], v[148:151]
    v_fmac_f32 v252, -2.0, v249
    v_fma_f32 v249, v209, s24, v213
    v_mfma_f32_16x16x32_bf16 v[148:151], a[244:247], v[228:231], v[148:151]
    v_fmac_f32 v213, -4.0, v209
    v_fma_f32 v209, v207, s24, v211
    v_mfma_f32_16x16x32_bf16 v[148:151], a[232:235], v[236:239], v[148:151]
    v_fmac_f32 v211, -4.0, v207
    v_fma_f32 v207, v211, s26, v213
    v_mfma_f32_16x16x32_bf16 v[152:155], a[236:239], v[236:239], v[152:155]
    ds_read_b128 v[236:239], v253 offset:7552
    v_fmac_f32 v213, s27, v211
    v_mfma_f32_16x16x32_bf16 v[152:155], a[248:251], v[228:231], v[152:155]
    v_fma_f32 v211, v209, 2.0, v249
    v_fmac_f32 v249, -2.0, v209
    v_mfma_f32_16x16x32_bf16 v[152:155], v[244:247], v[232:235], v[152:155]
    v_cvt_pk_bf16_f32 v207, v248, v207
    v_cvt_pk_bf16_f32 v213, v251, v213
    v_mfma_f32_16x16x32_bf16 v[156:159], a[228:231], v[228:231], v[156:159]
    v_cvt_pk_bf16_f32 v211, v250, v211
    v_cvt_pk_bf16_f32 v209, v252, v249
    v_mfma_f32_16x16x32_bf16 v[156:159], a[240:243], v[232:235], v[156:159]
    s_waitcnt lgkmcnt(0)
    v_lshrrev_b32 v252, 15, v255
    v_mfma_f32_16x16x32_bf16 v[156:159], a[252:255], v[236:239], v[156:159]
    ds_write_b64 v252, v[206:207] offset:8320
    v_mfma_f32_16x16x32_bf16 v[160:163], v[240:243], v[236:239], v[160:163]
    v_lshrrev_b32 v206, 15, v255
    v_mfma_f32_16x16x32_bf16 v[160:163], a[244:247], v[232:235], v[160:163]
    ds_write_b64 v206, v[212:213] offset:10400
    v_mfma_f32_16x16x32_bf16 v[160:163], a[232:235], v[228:231], v[160:163]
    s_waitcnt vmcnt(9)
    v_lshlrev_b32 v248, 16, v218
    v_lshlrev_b32 v249, 16, v220
    v_mfma_f32_16x16x32_bf16 v[164:167], a[236:239], v[228:231], v[164:167]
    ds_read_b128 v[228:231], v253 offset:7296
    v_lshlrev_b32 v250, 16, v222
    v_mfma_f32_16x16x32_bf16 v[164:167], a[248:251], v[232:235], v[164:167]
    ds_write_b64 v206, v[210:211] offset:12480
    v_mfma_f32_16x16x32_bf16 v[164:167], v[244:247], v[236:239], v[164:167]
    v_lshlrev_b32 v251, 16, v224
    v_and_b32 v218, s22, v218
    v_mfma_f32_16x16x32_bf16 v[168:171], a[228:231], v[232:235], v[168:171]
    ds_write_b64 v206, v[204:205] offset:22880
    v_mfma_f32_16x16x32_bf16 v[168:171], a[240:243], v[236:239], v[168:171]
    s_waitcnt lgkmcnt(2)
    v_and_b32 v220, s22, v220
    v_and_b32 v222, s22, v222
    v_mfma_f32_16x16x32_bf16 v[168:171], a[252:255], v[228:231], v[168:171]
    ds_write_b64 v206, v[214:215] offset:31200
    v_mfma_f32_16x16x32_bf16 v[172:175], v[240:243], v[228:231], v[172:175]
    v_and_b32 v224, s22, v224
    v_lshlrev_b32 v252, 16, v216
    v_mfma_f32_16x16x32_bf16 v[172:175], a[244:247], v[236:239], v[172:175]
    ds_write_b64 v206, v[208:209] offset:0
    v_mfma_f32_16x16x32_bf16 v[172:175], a[232:235], v[232:235], v[172:175]
    v_and_b32 v216, s22, v216
    v_fmac_f32 v252, s25, v251
    v_mfma_f32_16x16x32_bf16 v[176:179], a[236:239], v[232:235], v[176:179]
    ds_read_b128 v[232:235], v253 offset:7024
    v_fmac_f32 v216, s25, v224
    v_mfma_f32_16x16x32_bf16 v[176:179], a[248:251], v[236:239], v[176:179]
    v_fmac_f32 v252, s28, v249
    v_fmac_f32 v216, s28, v220
    v_mfma_f32_16x16x32_bf16 v[176:179], v[244:247], v[228:231], v[176:179]
    s_mov_b32 s42, 774144
    v_cvt_pk_bf16_f32 v216, v252, v216
    v_lshlrev_b32 v252, 16, v226
    v_mfma_f32_16x16x32_bf16 v[180:183], a[228:231], v[236:239], v[180:183]
    s_waitcnt lgkmcnt(0)
    v_and_b32 v226, s22, v226
    v_fmac_f32 v252, s29, v248
    v_mfma_f32_16x16x32_bf16 v[184:187], a[232:235], v[236:239], v[184:187]
    s_barrier
    v_mfma_f32_16x16x32_bf16 v[188:191], a[236:239], v[236:239], v[188:191]
    ds_read_b128 v[236:239], v253 offset:9360
    v_fmac_f32 v226, s29, v218
    v_mfma_f32_16x16x32_bf16 v[188:191], a[248:251], v[228:231], v[188:191]
    buffer_load_dwordx4 a[228:231], v254, s[8:11], s42 offen offset:0 sc1
    v_mfma_f32_16x16x32_bf16 v[184:187], a[244:247], v[228:231], v[184:187]
    v_fmac_f32 v252, s23, v250
    v_fmac_f32 v226, s23, v222
    v_mfma_f32_16x16x32_bf16 v[180:183], a[240:243], v[228:231], v[180:183]
    ds_read_b128 v[228:231], v253 offset:9088
    v_cvt_pk_bf16_f32 v226, v252, v226
    v_mfma_f32_16x16x32_bf16 v[180:183], a[252:255], v[232:235], v[180:183]
    buffer_load_dwordx4 a[232:235], v254, s[8:11], s42 offen offset:1024 sc1
    v_mfma_f32_16x16x32_bf16 v[184:187], v[240:243], v[232:235], v[184:187]
    s_waitcnt vmcnt(8) lgkmcnt(1)
    v_fma_f32 v252, v249, s24, v251
    v_fmac_f32 v251, -4.0, v249
    v_mfma_f32_16x16x32_bf16 v[188:191], v[244:247], v[232:235], v[188:191]
    ds_read_b128 v[232:235], v253 offset:8832
    v_fma_f32 v249, v248, s24, v250
sub20:
    v_mfma_f32_16x16x32_bf16 a[0:3], a[192:195], v[236:239], a[0:3]
    buffer_load_dwordx4 a[236:239], v254, s[8:11], s42 offen offset:2048 sc1
    v_mfma_f32_16x16x32_bf16 a[4:7], a[196:199], v[236:239], a[4:7]
    s_mov_b32 s42, 777216
    v_fmac_f32 v250, -4.0, v248
    v_fma_f32 v248, v250, s26, v251
    v_mfma_f32_16x16x32_bf16 a[8:11], a[200:203], v[236:239], a[8:11]
    ds_read_b128 v[236:239], v253 offset:8576
    s_waitcnt vmcnt(6)
    s_waitcnt lgkmcnt(2)
    v_mfma_f32_16x16x32_bf16 a[8:11], a[212:215], v[228:231], a[8:11]
    v_fmac_f32 v251, s27, v250
    v_fma_f32 v250, v249, 2.0, v252
    v_mfma_f32_16x16x32_bf16 a[4:7], a[208:211], v[228:231], a[4:7]
    buffer_load_dwordx4 a[240:243], v254, s[8:11], s42 offen offset:0 sc1
    v_mfma_f32_16x16x32_bf16 a[0:3], a[204:207], v[228:231], a[0:3]
    s_waitcnt vmcnt(4) lgkmcnt(1)
    v_fmac_f32 v252, -2.0, v249
    v_fma_f32 v249, v220, s24, v224
    v_mfma_f32_16x16x32_bf16 a[0:3], a[216:219], v[232:235], a[0:3]
    v_fmac_f32 v224, -4.0, v220
    v_fma_f32 v220, v218, s24, v222
    v_mfma_f32_16x16x32_bf16 a[4:7], a[220:223], v[232:235], a[4:7]
    v_fmac_f32 v222, -4.0, v218
    v_fma_f32 v218, v222, s26, v224
    v_mfma_f32_16x16x32_bf16 a[8:11], a[224:227], v[232:235], a[8:11]
    buffer_load_dwordx4 a[244:247], v254, s[8:11], s42 offen offset:1024 sc1
    v_mfma_f32_16x16x32_bf16 a[12:15], a[192:195], v[228:231], a[12:15]
    v_fmac_f32 v224, s27, v222
    v_fma_f32 v222, v220, 2.0, v249
    v_mfma_f32_16x16x32_bf16 a[12:15], a[204:207], v[232:235], a[12:15]
    s_waitcnt lgkmcnt(0)
    v_fmac_f32 v249, -2.0, v220
    v_cvt_pk_bf16_f32 v218, v248, v218
    v_mfma_f32_16x16x32_bf16 a[12:15], a[216:219], v[236:239], a[12:15]
    v_cvt_pk_bf16_f32 v224, v251, v224
    v_cvt_pk_bf16_f32 v222, v250, v222
    v_mfma_f32_16x16x32_bf16 a[16:19], a[220:223], v[236:239], a[16:19]
    buffer_load_dwordx4 a[248:251], v254, s[8:11], s42 offen offset:2048 sc1
    v_mfma_f32_16x16x32_bf16 a[16:19], a[208:211], v[232:235], a[16:19]
    s_mov_b32 s42, 780288
    v_cvt_pk_bf16_f32 v220, v252, v249
    v_lshlrev_b32 v248, 16, v219
    v_mfma_f32_16x16x32_bf16 a[16:19], a[196:199], v[228:231], a[16:19]
    v_lshlrev_b32 v249, 16, v221
    v_lshlrev_b32 v250, 16, v223
    v_mfma_f32_16x16x32_bf16 a[20:23], a[200:203], v[228:231], a[20:23]
    ds_read_b128 v[228:231], v253 offset:8320
    v_lshlrev_b32 v251, 16, v225
    v_mfma_f32_16x16x32_bf16 a[20:23], a[212:215], v[232:235], a[20:23]
    buffer_load_dwordx4 a[252:255], v254, s[8:11], s42 offen offset:0 sc1
    v_mfma_f32_16x16x32_bf16 a[20:23], a[224:227], v[236:239], a[20:23]
    v_and_b32 v219, s22, v219
    v_and_b32 v221, s22, v221
    v_mfma_f32_16x16x32_bf16 a[24:27], a[192:195], v[232:235], a[24:27]
    v_and_b32 v223, s22, v223
    v_and_b32 v225, s22, v225
    v_mfma_f32_16x16x32_bf16 a[24:27], a[204:207], v[236:239], a[24:27]
    s_waitcnt lgkmcnt(0)
    v_lshlrev_b32 v252, 16, v217
    v_and_b32 v217, s22, v217
    v_mfma_f32_16x16x32_bf16 a[24:27], a[216:219], v[228:231], a[24:27]
    v_fmac_f32 v252, s25, v251
    v_fmac_f32 v217, s25, v225
    v_mfma_f32_16x16x32_bf16 a[28:31], a[220:223], v[228:231], a[28:31]
    buffer_load_dwordx4 v[240:243], v254, s[8:11], s42 offen offset:1024 sc1
    v_mfma_f32_16x16x32_bf16 a[28:31], a[208:211], v[236:239], a[28:31]
    v_fmac_f32 v252, s28, v249
    v_fmac_f32 v217, s28, v221
    v_mfma_f32_16x16x32_bf16 a[28:31], a[196:199], v[232:235], a[28:31]
    v_cvt_pk_bf16_f32 v217, v252, v217
    v_lshlrev_b32 v252, 16, v227
    v_mfma_f32_16x16x32_bf16 a[32:35], a[200:203], v[232:235], a[32:35]
    ds_read_b128 v[232:235], v253 offset:10144
    v_and_b32 v227, s22, v227
    v_mfma_f32_16x16x32_bf16 a[32:35], a[212:215], v[236:239], a[32:35]
    buffer_load_dwordx4 v[244:247], v254, s[8:11], s42 offen offset:2048 sc1
    v_mfma_f32_16x16x32_bf16 a[32:35], a[224:227], v[228:231], a[32:35]
    v_fmac_f32 v252, s29, v248
    v_fmac_f32 v227, s29, v219
    v_mfma_f32_16x16x32_bf16 a[36:39], a[192:195], v[236:239], a[36:39]
    v_and_b32 v192, 0x1f0, v254
    v_mul_u32_u24 v192, 96, v192
    v_mfma_f32_16x16x32_bf16 a[36:39], a[204:207], v[228:231], a[36:39]
    s_waitcnt lgkmcnt(0)
    v_fmac_f32 v252, s23, v250
    v_fmac_f32 v227, s23, v223
    v_mfma_f32_16x16x32_bf16 a[36:39], a[216:219], v[232:235], a[36:39]
    buffer_load_dword v192, v192, s[4:7], s100 offen offset:384
    v_mfma_f32_16x16x32_bf16 a[40:43], a[220:223], v[232:235], a[40:43]
    v_cvt_pk_bf16_f32 v227, v252, v227
    v_fma_f32 v252, v249, s24, v251
    v_mfma_f32_16x16x32_bf16 a[40:43], a[208:211], v[228:231], a[40:43]
    v_fmac_f32 v251, -4.0, v249
    v_fma_f32 v249, v248, s24, v250
    v_mfma_f32_16x16x32_bf16 a[40:43], a[196:199], v[236:239], a[40:43]
    v_fmac_f32 v250, -4.0, v248
    v_fma_f32 v248, v250, s26, v251
    v_mfma_f32_16x16x32_bf16 a[44:47], a[200:203], v[236:239], a[44:47]
    ds_read_b128 v[236:239], v253 offset:9888
    v_fmac_f32 v251, s27, v250
    v_mfma_f32_16x16x32_bf16 a[44:47], a[212:215], v[228:231], a[44:47]
    v_fma_f32 v250, v249, 2.0, v252
    v_fmac_f32 v252, -2.0, v249
    v_mfma_f32_16x16x32_bf16 a[44:47], a[224:227], v[232:235], a[44:47]
pad7:
    s_cbranch_vccnz pad11
    v_fma_f32 v249, v221, s24, v225
    v_fmac_f32 v225, -4.0, v221
    v_mfma_f32_16x16x32_bf16 a[48:51], a[192:195], v[228:231], a[48:51]
    v_fma_f32 v221, v219, s24, v223
    v_fmac_f32 v223, -4.0, v219
    v_mfma_f32_16x16x32_bf16 a[48:51], a[204:207], v[232:235], a[48:51]
    s_waitcnt lgkmcnt(0)
    v_fma_f32 v219, v223, s26, v225
    v_fmac_f32 v225, s27, v223
    v_mfma_f32_16x16x32_bf16 a[48:51], a[216:219], v[236:239], a[48:51]
    v_fma_f32 v223, v221, 2.0, v249
    v_fmac_f32 v249, -2.0, v221
    v_mfma_f32_16x16x32_bf16 a[52:55], a[220:223], v[236:239], a[52:55]
    v_cvt_pk_bf16_f32 v219, v248, v219
    v_cvt_pk_bf16_f32 v225, v251, v225
    v_mfma_f32_16x16x32_bf16 a[52:55], a[208:211], v[232:235], a[52:55]
    v_cvt_pk_bf16_f32 v223, v250, v223
    v_cvt_pk_bf16_f32 v221, v252, v249
    v_mfma_f32_16x16x32_bf16 a[52:55], a[196:199], v[228:231], a[52:55]
    v_and_b32 v248, 0xf0, v254
    v_lshrrev_b32 v248, 1, v248
    v_mfma_f32_16x16x32_bf16 a[56:59], a[200:203], v[228:231], a[56:59]
    ds_read_b128 v[228:231], v253 offset:9632
    v_add_u32 v248, s52, v248
    v_mfma_f32_16x16x32_bf16 a[56:59], a[212:215], v[232:235], a[56:59]
    v_and_b32 v252, 8, v248
    v_lshrrev_b32 v249, 6, v248
    v_mfma_f32_16x16x32_bf16 a[56:59], a[224:227], v[236:239], a[56:59]
    v_mul_u32_u24 v249, 192, v249
    v_add_u32 v252, v252, v249
    v_mfma_f32_16x16x32_bf16 a[60:63], a[192:195], v[232:235], a[60:63]
    v_bfe_u32 v249, v248, 5, 1
    v_mul_u32_u24 v249, 40704, v249
    v_mfma_f32_16x16x32_bf16 a[60:63], a[204:207], v[236:239], a[60:63]
    s_waitcnt lgkmcnt(0)
    v_add_u32 v252, v252, v249
    v_bfe_u32 v249, v248, 4, 1
    v_mfma_f32_16x16x32_bf16 a[60:63], a[216:219], v[228:231], a[60:63]
    v_mul_u32_u24 v249, 81472, v249
    v_add_u32 v252, v252, v249
    v_mfma_f32_16x16x32_bf16 a[64:67], a[220:223], v[228:231], a[64:67]
    v_bfe_u32 v249, v254, 8, 1
    v_lshl_add_u32 v252, v249, 4, v252
    v_mfma_f32_16x16x32_bf16 a[64:67], a[208:211], v[236:239], a[64:67]
    v_mov_b32 v249, 123328
    v_cndmask_b32 v252, v249, v252, s[58:59]
    v_mfma_f32_16x16x32_bf16 a[64:67], a[196:199], v[232:235], a[64:67]
    ds_write_b64 v252, v[216:217] offset:39520
    v_mfma_f32_16x16x32_bf16 a[68:71], a[200:203], v[232:235], a[68:71]
    ds_read_b128 v[232:235], v253 offset:9376
    v_mfma_f32_16x16x32_bf16 a[68:71], a[212:215], v[236:239], a[68:71]
    ds_write_b64 v252, v[218:219] offset:39552
    v_mfma_f32_16x16x32_bf16 a[68:71], a[224:227], v[228:231], a[68:71]
    v_mfma_f32_16x16x32_bf16 a[72:75], a[192:195], v[236:239], a[72:75]
    ds_write_b64 v252, v[224:225] offset:39584
    v_mfma_f32_16x16x32_bf16 a[72:75], a[204:207], v[228:231], a[72:75]
    s_waitcnt lgkmcnt(2)
    v_mfma_f32_16x16x32_bf16 a[72:75], a[216:219], v[232:235], a[72:75]
    ds_write_b64 v252, v[222:223] offset:39616
    v_mfma_f32_16x16x32_bf16 a[76:79], a[220:223], v[232:235], a[76:79]
    v_mfma_f32_16x16x32_bf16 a[76:79], a[208:211], v[228:231], a[76:79]
    ds_write_b64 v252, v[220:221] offset:39648
    v_mfma_f32_16x16x32_bf16 a[76:79], a[196:199], v[236:239], a[76:79]
    v_mfma_f32_16x16x32_bf16 a[80:83], a[200:203], v[236:239], a[80:83]
    ds_read_b128 v[236:239], v253 offset:9104
    v_mfma_f32_16x16x32_bf16 a[80:83], a[212:215], v[228:231], a[80:83]
    ds_write_b64 v252, v[226:227] offset:39680
    v_mfma_f32_16x16x32_bf16 a[80:83], a[224:227], v[232:235], a[80:83]
    s_mov_b32 s42, 811008
    v_mfma_f32_16x16x32_bf16 a[84:87], a[192:195], v[228:231], a[84:87]
    v_mfma_f32_16x16x32_bf16 a[88:91], a[196:199], v[228:231], a[88:91]
    v_mfma_f32_16x16x32_bf16 a[92:95], a[200:203], v[228:231], a[92:95]
    ds_read_b128 v[228:231], v253 offset:11440
    v_mfma_f32_16x16x32_bf16 a[92:95], a[212:215], v[232:235], a[92:95]
    buffer_load_dwordx4 a[192:195], v254, s[8:11], s42 offen offset:0 sc1
    v_mfma_f32_16x16x32_bf16 a[88:91], a[208:211], v[232:235], a[88:91]
    s_waitcnt lgkmcnt(2)
    v_mfma_f32_16x16x32_bf16 a[84:87], a[204:207], v[232:235], a[84:87]
    ds_read_b128 v[232:235], v253 offset:11168
    v_mfma_f32_16x16x32_bf16 a[84:87], a[216:219], v[236:239], a[84:87]
    buffer_load_dwordx4 a[196:199], v254, s[8:11], s42 offen offset:1024 sc1
    v_mfma_f32_16x16x32_bf16 a[88:91], a[220:223], v[236:239], a[88:91]
    s_waitcnt vmcnt(9) lgkmcnt(1)
    v_mfma_f32_16x16x32_bf16 a[92:95], a[224:227], v[236:239], a[92:95]
    ds_read_b128 v[236:239], v253 offset:10912
sub21:
    v_mfma_f32_16x16x32_bf16 a[96:99], a[228:231], v[228:231], a[96:99]
    buffer_load_dwordx4 a[200:203], v254, s[8:11], s42 offen offset:2048 sc1
    v_mfma_f32_16x16x32_bf16 a[100:103], a[232:235], v[228:231], a[100:103]
    s_mov_b32 s42, 814080
    v_mfma_f32_16x16x32_bf16 a[104:107], a[236:239], v[228:231], a[104:107]
    ds_read_b128 v[228:231], v253 offset:10656
    s_waitcnt vmcnt(7)
    s_waitcnt lgkmcnt(2)
    v_mfma_f32_16x16x32_bf16 a[104:107], a[248:251], v[232:235], a[104:107]
    v_bfe_u32 v251, v254, 6, 2
    v_mul_u32_u24 v248, 40704, v251
    v_mfma_f32_16x16x32_bf16 a[100:103], a[244:247], v[232:235], a[100:103]
    buffer_load_dwordx4 a[204:207], v254, s[8:11], s42 offen offset:0 sc1
    v_mfma_f32_16x16x32_bf16 a[96:99], a[240:243], v[232:235], a[96:99]
    s_waitcnt vmcnt(5) lgkmcnt(1)
    v_and_b32 v251, 0x80, v254
    v_lshrrev_b32 v251, 1, v251
    v_mfma_f32_16x16x32_bf16 a[96:99], a[252:255], v[236:239], a[96:99]
    v_add_u32 v248, v248, v251
    v_and_b32 v251, 0x40, v254
    v_mfma_f32_16x16x32_bf16 a[100:103], v[240:243], v[236:239], a[100:103]
    v_lshrrev_b32 v251, 2, v251
    v_add_u32 v248, v248, v251
    v_mfma_f32_16x16x32_bf16 a[104:107], v[244:247], v[236:239], a[104:107]
    buffer_load_dwordx4 a[208:211], v254, s[8:11], s42 offen offset:1024 sc1
    v_mfma_f32_16x16x32_bf16 a[108:111], a[228:231], v[232:235], a[108:111]
    v_bfe_u32 v251, v254, 4, 2
    v_mul_u32_u24 v251, 3104, v251
    v_mfma_f32_16x16x32_bf16 a[108:111], a[240:243], v[236:239], a[108:111]
    s_waitcnt lgkmcnt(0)
    v_add_u32 v248, v248, v251
    v_add_u32 v248, s52, v248
    v_mfma_f32_16x16x32_bf16 a[108:111], a[252:255], v[228:231], a[108:111]
    v_lshrrev_b32 v251, 8, v254
    v_lshl_add_u32 v249, v251, 3, v248
    v_mfma_f32_16x16x32_bf16 a[112:115], v[240:243], v[228:231], a[112:115]
    buffer_load_dwordx4 a[212:215], v254, s[8:11], s42 offen offset:2048 sc1
    v_mfma_f32_16x16x32_bf16 a[112:115], a[244:247], v[236:239], a[112:115]
    s_mov_b32 s42, 817152
    v_lshl_add_u32 v248, v251, 4, v248
    v_add_u32 v250, s51, v254
    v_mfma_f32_16x16x32_bf16 a[112:115], a[232:235], v[232:235], a[112:115]
    v_accvgpr_read_b32 v204, a0
    v_accvgpr_read_b32 v205, a1
    v_mfma_f32_16x16x32_bf16 a[116:119], a[236:239], v[232:235], a[116:119]
    ds_read_b128 v[232:235], v253 offset:10400
    v_accvgpr_read_b32 v206, a2
    v_mfma_f32_16x16x32_bf16 a[116:119], a[248:251], v[236:239], a[116:119]
    buffer_load_dwordx4 a[216:219], v254, s[8:11], s42 offen offset:0 sc1
    v_mfma_f32_16x16x32_bf16 a[116:119], v[244:247], v[228:231], a[116:119]
    v_accvgpr_read_b32 v207, a3
    v_accvgpr_read_b32 v208, a96
    v_mfma_f32_16x16x32_bf16 a[120:123], a[228:231], v[236:239], a[120:123]
    v_accvgpr_read_b32 v209, a97
    v_accvgpr_read_b32 v210, a98
    v_mfma_f32_16x16x32_bf16 a[120:123], a[240:243], v[228:231], a[120:123]
    s_waitcnt lgkmcnt(0)
    v_accvgpr_read_b32 v211, a99
    v_add_f32 v212, v204, v208
    v_mfma_f32_16x16x32_bf16 a[120:123], a[252:255], v[232:235], a[120:123]
    v_add_f32 v213, v205, v209
    v_add_f32 v214, v206, v210
    v_mfma_f32_16x16x32_bf16 a[124:127], v[240:243], v[232:235], a[124:127]
    buffer_load_dwordx4 a[220:223], v254, s[8:11], s42 offen offset:1024 sc1
    v_mfma_f32_16x16x32_bf16 a[124:127], a[244:247], v[228:231], a[124:127]
    v_add_f32 v215, v207, v211
    v_sub_f32 v204, v204, v208
    v_mfma_f32_16x16x32_bf16 a[124:127], a[232:235], v[236:239], a[124:127]
    v_sub_f32 v205, v205, v209
    v_sub_f32 v206, v206, v210
    v_mfma_f32_16x16x32_bf16 a[128:131], a[236:239], v[236:239], a[128:131]
    ds_read_b128 v[236:239], v253 offset:12224
    v_sub_f32 v207, v207, v211
    v_mfma_f32_16x16x32_bf16 a[128:131], a[248:251], v[228:231], a[128:131]
    buffer_load_dwordx4 a[224:227], v254, s[8:11], s42 offen offset:2048 sc1
    v_mfma_f32_16x16x32_bf16 a[128:131], v[244:247], v[232:235], a[128:131]
    v_accvgpr_write_b32 a0, v212
    v_accvgpr_write_b32 a1, v213
    v_mfma_f32_16x16x32_bf16 a[132:135], a[228:231], v[228:231], a[132:135]
    v_and_b32 v193, 0x1f0, v254
    v_mul_u32_u24 v193, 96, v193
    v_mfma_f32_16x16x32_bf16 a[132:135], a[240:243], v[232:235], a[132:135]
    s_waitcnt lgkmcnt(0)
    v_accvgpr_write_b32 a2, v214
    v_accvgpr_write_b32 a3, v215
    v_mfma_f32_16x16x32_bf16 a[132:135], a[252:255], v[236:239], a[132:135]
    buffer_load_dword v193, v193, s[4:7], s100 offen offset:768
    v_mfma_f32_16x16x32_bf16 a[136:139], v[240:243], v[236:239], a[136:139]
    v_accvgpr_write_b32 a96, v204
    v_accvgpr_write_b32 a97, v205
    v_mfma_f32_16x16x32_bf16 a[136:139], a[244:247], v[232:235], a[136:139]
    v_accvgpr_write_b32 a98, v206
    v_accvgpr_write_b32 a99, v207
    v_mfma_f32_16x16x32_bf16 a[136:139], a[232:235], v[228:231], a[136:139]
    v_accvgpr_read_b32 v204, a4
    v_accvgpr_read_b32 v205, a5
    v_mfma_f32_16x16x32_bf16 a[140:143], a[236:239], v[228:231], a[140:143]
    ds_read_b128 v[228:231], v253 offset:11968
    v_accvgpr_read_b32 v206, a6
    v_mfma_f32_16x16x32_bf16 a[140:143], a[248:251], v[232:235], a[140:143]
    v_accvgpr_read_b32 v207, a7
    v_accvgpr_read_b32 v208, a100
    v_mfma_f32_16x16x32_bf16 a[140:143], v[244:247], v[236:239], a[140:143]
    v_accvgpr_read_b32 v209, a101
    v_accvgpr_read_b32 v210, a102
    v_mfma_f32_16x16x32_bf16 a[144:147], a[228:231], v[232:235], a[144:147]
    v_accvgpr_read_b32 v211, a103
    v_add_f32 v212, v204, v208
    v_mfma_f32_16x16x32_bf16 a[144:147], a[240:243], v[236:239], a[144:147]
    s_waitcnt lgkmcnt(0)
    v_add_f32 v213, v205, v209
    v_add_f32 v214, v206, v210
    v_mfma_f32_16x16x32_bf16 a[144:147], a[252:255], v[228:231], a[144:147]
    v_add_f32 v215, v207, v211
    v_sub_f32 v204, v204, v208
    v_mfma_f32_16x16x32_bf16 a[148:151], v[240:243], v[228:231], a[148:151]
    v_sub_f32 v205, v205, v209
    v_sub_f32 v206, v206, v210
    v_mfma_f32_16x16x32_bf16 a[148:151], a[244:247], v[236:239], a[148:151]
    v_sub_f32 v207, v207, v211
    v_accvgpr_write_b32 a4, v212
    v_mfma_f32_16x16x32_bf16 a[148:151], a[232:235], v[232:235], a[148:151]
    v_accvgpr_write_b32 a5, v213
    v_accvgpr_write_b32 a6, v214
    v_mfma_f32_16x16x32_bf16 a[152:155], a[236:239], v[232:235], a[152:155]
    ds_read_b128 v[232:235], v253 offset:11712
    v_accvgpr_write_b32 a7, v215
    v_mfma_f32_16x16x32_bf16 a[152:155], a[248:251], v[236:239], a[152:155]
    v_accvgpr_write_b32 a100, v204
    v_accvgpr_write_b32 a101, v205
    v_mfma_f32_16x16x32_bf16 a[152:155], v[244:247], v[228:231], a[152:155]
    v_accvgpr_write_b32 a102, v206
    v_accvgpr_write_b32 a103, v207
    v_mfma_f32_16x16x32_bf16 a[156:159], a[228:231], v[236:239], a[156:159]
    v_accvgpr_read_b32 v204, a8
    v_accvgpr_read_b32 v205, a9
    v_mfma_f32_16x16x32_bf16 a[156:159], a[240:243], v[228:231], a[156:159]
    s_waitcnt lgkmcnt(0)
    v_accvgpr_read_b32 v206, a10
    v_accvgpr_read_b32 v207, a11
    v_mfma_f32_16x16x32_bf16 a[156:159], a[252:255], v[232:235], a[156:159]
    v_accvgpr_read_b32 v208, a104
    v_accvgpr_read_b32 v209, a105
    v_mfma_f32_16x16x32_bf16 a[160:163], v[240:243], v[232:235], a[160:163]
    v_accvgpr_read_b32 v210, a106
    v_accvgpr_read_b32 v211, a107
    v_mfma_f32_16x16x32_bf16 a[160:163], a[244:247], v[228:231], a[160:163]
    v_add_f32 v212, v204, v208
    v_add_f32 v213, v205, v209
    v_mfma_f32_16x16x32_bf16 a[160:163], a[232:235], v[236:239], a[160:163]
    v_add_f32 v214, v206, v210
    v_add_f32 v215, v207, v211
    v_mfma_f32_16x16x32_bf16 a[164:167], a[236:239], v[236:239], a[164:167]
    ds_read_b128 v[236:239], v253 offset:11456
    v_sub_f32 v204, v204, v208
    v_mfma_f32_16x16x32_bf16 a[164:167], a[248:251], v[228:231], a[164:167]
    v_sub_f32 v205, v205, v209
    v_sub_f32 v206, v206, v210
    v_mfma_f32_16x16x32_bf16 a[164:167], v[244:247], v[232:235], a[164:167]
    v_sub_f32 v207, v207, v211
    v_accvgpr_write_b32 a8, v212
    v_mfma_f32_16x16x32_bf16 a[168:171], a[228:231], v[228:231], a[168:171]
    v_accvgpr_write_b32 a9, v213
    v_accvgpr_write_b32 a10, v214
    v_mfma_f32_16x16x32_bf16 a[168:171], a[240:243], v[232:235], a[168:171]
    s_waitcnt lgkmcnt(0)
    v_accvgpr_write_b32 a11, v215
    v_accvgpr_write_b32 a104, v204
    v_mfma_f32_16x16x32_bf16 a[168:171], a[252:255], v[236:239], a[168:171]
    v_accvgpr_write_b32 a105, v205
    v_accvgpr_write_b32 a106, v206
    v_mfma_f32_16x16x32_bf16 a[172:175], v[240:243], v[236:239], a[172:175]
    v_accvgpr_write_b32 a107, v207
    v_accvgpr_read_b32 v204, a12
    v_mfma_f32_16x16x32_bf16 a[172:175], a[244:247], v[232:235], a[172:175]
    v_accvgpr_read_b32 v205, a13
    v_accvgpr_read_b32 v206, a14
    v_mfma_f32_16x16x32_bf16 a[172:175], a[232:235], v[228:231], a[172:175]
    v_accvgpr_read_b32 v207, a15
    v_accvgpr_read_b32 v208, a108
    v_mfma_f32_16x16x32_bf16 a[176:179], a[236:239], v[228:231], a[176:179]
    ds_read_b128 v[228:231], v253 offset:11184
    v_accvgpr_read_b32 v209, a109
    v_mfma_f32_16x16x32_bf16 a[176:179], a[248:251], v[232:235], a[176:179]
    v_accvgpr_read_b32 v210, a110
    v_accvgpr_read_b32 v211, a111
    v_mfma_f32_16x16x32_bf16 a[176:179], v[244:247], v[236:239], a[176:179]
    s_mov_b32 s42, 847872
    v_add_f32 v212, v204, v208
    v_add_f32 v213, v205, v209
    v_mfma_f32_16x16x32_bf16 a[180:183], a[228:231], v[232:235], a[180:183]
    v_add_f32 v214, v206, v210
    v_add_f32 v215, v207, v211
    v_mfma_f32_16x16x32_bf16 a[184:187], a[232:235], v[232:235], a[184:187]
    v_sub_f32 v204, v204, v208
    v_sub_f32 v205, v205, v209
    v_mfma_f32_16x16x32_bf16 a[188:191], a[236:239], v[232:235], a[188:191]
    ds_read_b128 v[232:235], v253 offset:13520
    v_sub_f32 v206, v206, v210
    v_mfma_f32_16x16x32_bf16 a[188:191], a[248:251], v[236:239], a[188:191]
    buffer_load_dwordx4 a[228:231], v254, s[8:11], s42 offen offset:0 sc1
    v_mfma_f32_16x16x32_bf16 a[184:187], a[244:247], v[236:239], a[184:187]
    s_waitcnt lgkmcnt(1)
    v_sub_f32 v207, v207, v211
    v_accvgpr_write_b32 a12, v212
    v_mfma_f32_16x16x32_bf16 a[180:183], a[240:243], v[236:239], a[180:183]
    ds_read_b128 v[236:239], v253 offset:13248
    v_accvgpr_write_b32 a13, v213
    v_mfma_f32_16x16x32_bf16 a[180:183], a[252:255], v[228:231], a[180:183]
    buffer_load_dwordx4 a[232:235], v254, s[8:11], s42 offen offset:1024 sc1
    v_mfma_f32_16x16x32_bf16 a[184:187], v[240:243], v[228:231], a[184:187]
    s_waitcnt vmcnt(9) lgkmcnt(1)
    v_accvgpr_write_b32 a14, v214
    v_accvgpr_write_b32 a15, v215
    v_mfma_f32_16x16x32_bf16 a[188:191], v[244:247], v[228:231], a[188:191]
    ds_read_b128 v[228:231], v253 offset:12992
    v_accvgpr_write_b32 a108, v204
sub22:
    v_mfma_f32_16x16x32_bf16 v[0:3], a[192:195], v[232:235], v[0:3]
    buffer_load_dwordx4 a[236:239], v254, s[8:11], s42 offen offset:2048 sc1
    v_mfma_f32_16x16x32_bf16 v[4:7], a[196:199], v[232:235], v[4:7]
    s_mov_b32 s42, 850944
    v_accvgpr_write_b32 a109, v205
    v_accvgpr_write_b32 a110, v206
    v_mfma_f32_16x16x32_bf16 v[8:11], a[200:203], v[232:235], v[8:11]
    ds_read_b128 v[232:235], v253 offset:12736
    s_waitcnt vmcnt(7)
    s_waitcnt lgkmcnt(2)
    v_mfma_f32_16x16x32_bf16 v[8:11], a[212:215], v[236:239], v[8:11]
    v_accvgpr_write_b32 a111, v207
    v_accvgpr_read_b32 v204, a16
    v_mfma_f32_16x16x32_bf16 v[4:7], a[208:211], v[236:239], v[4:7]
    buffer_load_dwordx4 a[240:243], v254, s[8:11], s42 offen offset:0 sc1
    v_mfma_f32_16x16x32_bf16 v[0:3], a[204:207], v[236:239], v[0:3]
    s_waitcnt vmcnt(5) lgkmcnt(1)
    v_accvgpr_read_b32 v205, a17
    v_accvgpr_read_b32 v206, a18
    v_mfma_f32_16x16x32_bf16 v[0:3], a[216:219], v[228:231], v[0:3]
    v_accvgpr_read_b32 v207, a19
    v_accvgpr_read_b32 v208, a112
    v_mfma_f32_16x16x32_bf16 v[4:7], a[220:223], v[228:231], v[4:7]
    v_accvgpr_read_b32 v209, a113
    v_accvgpr_read_b32 v210, a114
    v_mfma_f32_16x16x32_bf16 v[8:11], a[224:227], v[228:231], v[8:11]
    buffer_load_dwordx4 a[244:247], v254, s[8:11], s42 offen offset:1024 sc1
    v_mfma_f32_16x16x32_bf16 v[12:15], a[192:195], v[236:239], v[12:15]
    v_accvgpr_read_b32 v211, a115
    v_add_f32 v212, v204, v208
    v_mfma_f32_16x16x32_bf16 v[12:15], a[204:207], v[228:231], v[12:15]
    s_waitcnt lgkmcnt(0)
    v_add_f32 v213, v205, v209
    v_add_f32 v214, v206, v210
    v_mfma_f32_16x16x32_bf16 v[12:15], a[216:219], v[232:235], v[12:15]
    v_add_f32 v215, v207, v211
    v_sub_f32 v204, v204, v208
    v_mfma_f32_16x16x32_bf16 v[16:19], a[220:223], v[232:235], v[16:19]
    buffer_load_dwordx4 a[248:251], v254, s[8:11], s42 offen offset:2048 sc1
    v_mfma_f32_16x16x32_bf16 v[16:19], a[208:211], v[228:231], v[16:19]
    s_mov_b32 s42, 854016
    v_sub_f32 v205, v205, v209
    v_sub_f32 v206, v206, v210
    v_mfma_f32_16x16x32_bf16 v[16:19], a[196:199], v[236:239], v[16:19]
    v_sub_f32 v207, v207, v211
    v_accvgpr_write_b32 a16, v212
    v_mfma_f32_16x16x32_bf16 v[20:23], a[200:203], v[236:239], v[20:23]
    ds_read_b128 v[236:239], v253 offset:12480
    v_accvgpr_write_b32 a17, v213
    v_mfma_f32_16x16x32_bf16 v[20:23], a[212:215], v[228:231], v[20:23]
    buffer_load_dwordx4 a[252:255], v254, s[8:11], s42 offen offset:0 sc1
    v_mfma_f32_16x16x32_bf16 v[20:23], a[224:227], v[232:235], v[20:23]
    v_accvgpr_write_b32 a18, v214
    v_accvgpr_write_b32 a19, v215
    v_mfma_f32_16x16x32_bf16 v[24:27], a[192:195], v[228:231], v[24:27]
    v_accvgpr_write_b32 a112, v204
    v_accvgpr_write_b32 a113, v205
    v_mfma_f32_16x16x32_bf16 v[24:27], a[204:207], v[232:235], v[24:27]
    s_waitcnt lgkmcnt(0)
    v_accvgpr_write_b32 a114, v206
    v_accvgpr_write_b32 a115, v207
    v_mfma_f32_16x16x32_bf16 v[24:27], a[216:219], v[236:239], v[24:27]
    v_accvgpr_read_b32 v204, a20
    v_accvgpr_read_b32 v205, a21
    v_mfma_f32_16x16x32_bf16 v[28:31], a[220:223], v[236:239], v[28:31]
    buffer_load_dwordx4 v[240:243], v254, s[8:11], s42 offen offset:1024 sc1
    v_mfma_f32_16x16x32_bf16 v[28:31], a[208:211], v[232:235], v[28:31]
    v_accvgpr_read_b32 v206, a22
    v_accvgpr_read_b32 v207, a23
    v_mfma_f32_16x16x32_bf16 v[28:31], a[196:199], v[228:231], v[28:31]
    v_accvgpr_read_b32 v208, a116
    v_accvgpr_read_b32 v209, a117
    v_mfma_f32_16x16x32_bf16 v[32:35], a[200:203], v[228:231], v[32:35]
    ds_read_b128 v[228:231], v253 offset:14304
    v_accvgpr_read_b32 v210, a118
    v_mfma_f32_16x16x32_bf16 v[32:35], a[212:215], v[232:235], v[32:35]
    buffer_load_dwordx4 v[244:247], v254, s[8:11], s42 offen offset:2048 sc1
    v_mfma_f32_16x16x32_bf16 v[32:35], a[224:227], v[236:239], v[32:35]
    v_accvgpr_read_b32 v211, a119
    v_add_f32 v212, v204, v208
    v_mfma_f32_16x16x32_bf16 v[36:39], a[192:195], v[232:235], v[36:39]
    v_add_f32 v213, v205, v209
    v_add_f32 v214, v206, v210
    v_mfma_f32_16x16x32_bf16 v[36:39], a[204:207], v[236:239], v[36:39]
    s_waitcnt lgkmcnt(0)
    v_add_f32 v215, v207, v211
    v_sub_f32 v204, v204, v208
    v_mfma_f32_16x16x32_bf16 v[36:39], a[216:219], v[228:231], v[36:39]
    v_sub_f32 v205, v205, v209
    v_sub_f32 v206, v206, v210
    v_mfma_f32_16x16x32_bf16 v[40:43], a[220:223], v[228:231], v[40:43]
    v_sub_f32 v207, v207, v211
    v_accvgpr_write_b32 a20, v212
    v_mfma_f32_16x16x32_bf16 v[40:43], a[208:211], v[236:239], v[40:43]
    v_accvgpr_write_b32 a21, v213
    v_accvgpr_write_b32 a22, v214
    v_mfma_f32_16x16x32_bf16 v[40:43], a[196:199], v[232:235], v[40:43]
    v_accvgpr_write_b32 a23, v215
    v_accvgpr_write_b32 a116, v204
    v_mfma_f32_16x16x32_bf16 v[44:47], a[200:203], v[232:235], v[44:47]
    ds_read_b128 v[232:235], v253 offset:14048
    v_accvgpr_write_b32 a117, v205
    v_mfma_f32_16x16x32_bf16 v[44:47], a[212:215], v[236:239], v[44:47]
    v_accvgpr_write_b32 a118, v206
    v_accvgpr_write_b32 a119, v207
    v_mfma_f32_16x16x32_bf16 v[44:47], a[224:227], v[228:231], v[44:47]
    v_accvgpr_read_b32 v204, a24
    v_accvgpr_read_b32 v205, a25
    v_mfma_f32_16x16x32_bf16 v[48:51], a[192:195], v[236:239], v[48:51]
    v_accvgpr_read_b32 v206, a26
    v_accvgpr_read_b32 v207, a27
    v_mfma_f32_16x16x32_bf16 v[48:51], a[204:207], v[228:231], v[48:51]
    s_waitcnt lgkmcnt(0)
    v_accvgpr_read_b32 v208, a120
    v_accvgpr_read_b32 v209, a121
    v_mfma_f32_16x16x32_bf16 v[48:51], a[216:219], v[232:235], v[48:51]
    v_accvgpr_read_b32 v210, a122
    v_accvgpr_read_b32 v211, a123
    v_mfma_f32_16x16x32_bf16 v[52:55], a[220:223], v[232:235], v[52:55]
    v_add_f32 v212, v204, v208
    v_add_f32 v213, v205, v209
    v_mfma_f32_16x16x32_bf16 v[52:55], a[208:211], v[228:231], v[52:55]
    v_add_f32 v214, v206, v210
    v_add_f32 v215, v207, v211
    v_mfma_f32_16x16x32_bf16 v[52:55], a[196:199], v[236:239], v[52:55]
    v_sub_f32 v204, v204, v208
    v_sub_f32 v205, v205, v209
    v_mfma_f32_16x16x32_bf16 v[56:59], a[200:203], v[236:239], v[56:59]
    ds_read_b128 v[236:239], v253 offset:13792
    v_sub_f32 v206, v206, v210
    v_mfma_f32_16x16x32_bf16 v[56:59], a[212:215], v[228:231], v[56:59]
    v_sub_f32 v207, v207, v211
    v_accvgpr_write_b32 a24, v212
    v_mfma_f32_16x16x32_bf16 v[56:59], a[224:227], v[232:235], v[56:59]
    v_accvgpr_write_b32 a25, v213
    v_accvgpr_write_b32 a26, v214
    v_mfma_f32_16x16x32_bf16 v[60:63], a[192:195], v[228:231], v[60:63]
    v_accvgpr_write_b32 a27, v215
    v_accvgpr_write_b32 a120, v204
    v_mfma_f32_16x16x32_bf16 v[60:63], a[204:207], v[232:235], v[60:63]
    s_waitcnt lgkmcnt(0)
    v_accvgpr_write_b32 a121, v205
    v_accvgpr_write_b32 a122, v206
    v_mfma_f32_16x16x32_bf16 v[60:63], a[216:219], v[236:239], v[60:63]
    v_accvgpr_write_b32 a123, v207
    v_accvgpr_read_b32 v204, a84
    v_mfma_f32_16x16x32_bf16 v[64:67], a[220:223], v[236:239], v[64:67]
    v_accvgpr_read_b32 v205, a85
    v_accvgpr_read_b32 v206, a86
    v_mfma_f32_16x16x32_bf16 v[64:67], a[208:211], v[232:235], v[64:67]
    v_accvgpr_read_b32 v207, a87
    v_accvgpr_read_b32 v208, a180
    v_mfma_f32_16x16x32_bf16 v[64:67], a[196:199], v[228:231], v[64:67]
    v_accvgpr_read_b32 v209, a181
    v_accvgpr_read_b32 v210, a182
    v_mfma_f32_16x16x32_bf16 v[68:71], a[200:203], v[228:231], v[68:71]
    ds_read_b128 v[228:231], v253 offset:13536
    v_accvgpr_read_b32 v211, a183
    v_mfma_f32_16x16x32_bf16 v[68:71], a[212:215], v[232:235], v[68:71]
    v_add_f32 v212, v204, v208
    v_add_f32 v213, v205, v209
    v_mfma_f32_16x16x32_bf16 v[68:71], a[224:227], v[236:239], v[68:71]
    v_add_f32 v214, v206, v210
    v_add_f32 v215, v207, v211
    v_mfma_f32_16x16x32_bf16 v[72:75], a[192:195], v[232:235], v[72:75]
    v_sub_f32 v204, v204, v208
    v_sub_f32 v205, v205, v209
    v_mfma_f32_16x16x32_bf16 v[72:75], a[204:207], v[236:239], v[72:75]
    s_waitcnt lgkmcnt(0)
    v_sub_f32 v206, v206, v210
    v_sub_f32 v207, v207, v211
    v_mfma_f32_16x16x32_bf16 v[72:75], a[216:219], v[228:231], v[72:75]
    v_accvgpr_write_b32 a84, v212
    v_accvgpr_write_b32 a85, v213
    v_mfma_f32_16x16x32_bf16 v[76:79], a[220:223], v[228:231], v[76:79]
    v_accvgpr_write_b32 a86, v214
    v_accvgpr_write_b32 a87, v215
    v_mfma_f32_16x16x32_bf16 v[76:79], a[208:211], v[236:239], v[76:79]
    v_accvgpr_write_b32 a180, v204
    v_accvgpr_write_b32 a181, v205
    v_mfma_f32_16x16x32_bf16 v[76:79], a[196:199], v[232:235], v[76:79]
    v_accvgpr_write_b32 a182, v206
    v_accvgpr_write_b32 a183, v207
    v_mfma_f32_16x16x32_bf16 v[80:83], a[200:203], v[232:235], v[80:83]
    ds_read_b128 v[232:235], v253 offset:13264
    v_accvgpr_read_b32 v204, a88
    v_mfma_f32_16x16x32_bf16 v[80:83], a[212:215], v[236:239], v[80:83]
    v_accvgpr_read_b32 v205, a89
    v_accvgpr_read_b32 v206, a90
    v_mfma_f32_16x16x32_bf16 v[80:83], a[224:227], v[228:231], v[80:83]
    s_mov_b32 s42, 921600
    v_accvgpr_read_b32 v207, a91
    v_accvgpr_read_b32 v208, a184
    v_mfma_f32_16x16x32_bf16 v[84:87], a[192:195], v[236:239], v[84:87]
    v_accvgpr_read_b32 v209, a185
    v_accvgpr_read_b32 v210, a186
    v_mfma_f32_16x16x32_bf16 v[88:91], a[196:199], v[236:239], v[88:91]
    v_accvgpr_read_b32 v211, a187
    v_add_f32 v212, v204, v208
    v_mfma_f32_16x16x32_bf16 v[92:95], a[200:203], v[236:239], v[92:95]
    ds_read_b128 v[236:239], v253 offset:1040
    v_add_f32 v213, v205, v209
    v_mfma_f32_16x16x32_bf16 v[92:95], a[212:215], v[228:231], v[92:95]
    buffer_load_dwordx4 a[192:195], v254, s[8:11], s42 offen offset:0 sc1
    v_mfma_f32_16x16x32_bf16 v[88:91], a[208:211], v[228:231], v[88:91]
    s_waitcnt lgkmcnt(1)
    v_add_f32 v214, v206, v210
    v_add_f32 v215, v207, v211
    v_mfma_f32_16x16x32_bf16 v[84:87], a[204:207], v[228:231], v[84:87]
    ds_read_b128 v[228:231], v253 offset:768
    v_sub_f32 v204, v204, v208
    v_mfma_f32_16x16x32_bf16 v[84:87], a[216:219], v[232:235], v[84:87]
    buffer_load_dwordx4 a[196:199], v254, s[8:11], s42 offen offset:1024 sc1
    v_mfma_f32_16x16x32_bf16 v[88:91], a[220:223], v[232:235], v[88:91]
    s_waitcnt vmcnt(8) lgkmcnt(1)
    v_sub_f32 v205, v205, v209
    v_sub_f32 v206, v206, v210
    v_mfma_f32_16x16x32_bf16 v[92:95], a[224:227], v[232:235], v[92:95]
    ds_read_b128 v[232:235], v253 offset:512
    v_sub_f32 v207, v207, v211
sub23:
    v_mfma_f32_16x16x32_bf16 v[96:99], a[228:231], v[236:239], v[96:99]
    buffer_load_dwordx4 a[200:203], v254, s[8:11], s42 offen offset:2048 sc1
    v_mfma_f32_16x16x32_bf16 v[100:103], a[232:235], v[236:239], v[100:103]
    s_mov_b32 s42, 924672
    v_accvgpr_write_b32 a88, v212
    v_accvgpr_write_b32 a89, v213
    v_mfma_f32_16x16x32_bf16 v[104:107], a[236:239], v[236:239], v[104:107]
    ds_read_b128 v[236:239], v253 offset:256
    s_waitcnt vmcnt(6)
    s_waitcnt lgkmcnt(2)
    v_mfma_f32_16x16x32_bf16 v[104:107], a[248:251], v[228:231], v[104:107]
    v_accvgpr_write_b32 a90, v214
    v_accvgpr_write_b32 a91, v215
    v_mfma_f32_16x16x32_bf16 v[100:103], a[244:247], v[228:231], v[100:103]
    buffer_load_dwordx4 a[204:207], v254, s[8:11], s42 offen offset:0 sc1
    v_mfma_f32_16x16x32_bf16 v[96:99], a[240:243], v[228:231], v[96:99]
    s_waitcnt vmcnt(4) lgkmcnt(1)
    v_accvgpr_write_b32 a184, v204
    v_accvgpr_write_b32 a185, v205
    v_mfma_f32_16x16x32_bf16 v[96:99], a[252:255], v[232:235], v[96:99]
    v_accvgpr_write_b32 a186, v206
    v_accvgpr_write_b32 a187, v207
    v_mfma_f32_16x16x32_bf16 v[100:103], v[240:243], v[232:235], v[100:103]
    v_accvgpr_read_b32 v204, a92
    v_accvgpr_read_b32 v205, a93
    v_mfma_f32_16x16x32_bf16 v[104:107], v[244:247], v[232:235], v[104:107]
    buffer_load_dwordx4 a[208:211], v254, s[8:11], s42 offen offset:1024 sc1
    v_mfma_f32_16x16x32_bf16 v[108:111], a[228:231], v[228:231], v[108:111]
    v_accvgpr_read_b32 v206, a94
    v_accvgpr_read_b32 v207, a95
    v_mfma_f32_16x16x32_bf16 v[108:111], a[240:243], v[232:235], v[108:111]
    s_waitcnt lgkmcnt(0)
    v_accvgpr_read_b32 v208, a188
    v_accvgpr_read_b32 v209, a189
    v_mfma_f32_16x16x32_bf16 v[108:111], a[252:255], v[236:239], v[108:111]
    v_accvgpr_read_b32 v210, a190
    v_accvgpr_read_b32 v211, a191
    v_mfma_f32_16x16x32_bf16 v[112:115], v[240:243], v[236:239], v[112:115]
    buffer_load_dwordx4 a[212:215], v254, s[8:11], s42 offen offset:2048 sc1
    v_mfma_f32_16x16x32_bf16 v[112:115], a[244:247], v[232:235], v[112:115]
    s_mov_b32 s42, 927744
    v_add_f32 v212, v204, v208
    v_add_f32 v213, v205, v209
    v_mfma_f32_16x16x32_bf16 v[112:115], a[232:235], v[228:231], v[112:115]
    v_add_f32 v214, v206, v210
    v_add_f32 v215, v207, v211
    v_mfma_f32_16x16x32_bf16 v[116:119], a[236:239], v[228:231], v[116:119]
    ds_read_b128 v[228:231], v253 offset:0
    v_sub_f32 v204, v204, v208
    v_mfma_f32_16x16x32_bf16 v[116:119], a[248:251], v[232:235], v[116:119]
    buffer_load_dwordx4 a[216:219], v254, s[8:11], s42 offen offset:0 sc1
    v_mfma_f32_16x16x32_bf16 v[116:119], v[244:247], v[236:239], v[116:119]
    v_sub_f32 v205, v205, v209
    v_sub_f32 v206, v206, v210
    v_mfma_f32_16x16x32_bf16 v[120:123], a[228:231], v[232:235], v[120:123]
pad8:
    s_cbranch_vccnz pad12
    v_sub_f32 v207, v207, v211
    v_accvgpr_write_b32 a92, v212
    v_mfma_f32_16x16x32_bf16 v[120:123], a[240:243], v[236:239], v[120:123]
    s_waitcnt lgkmcnt(0)
    v_accvgpr_write_b32 a93, v213
    v_accvgpr_write_b32 a94, v214
    v_mfma_f32_16x16x32_bf16 v[120:123], a[252:255], v[228:231], v[120:123]
    v_accvgpr_write_b32 a95, v215
    v_accvgpr_write_b32 a188, v204
    v_mfma_f32_16x16x32_bf16 v[124:127], v[240:243], v[228:231], v[124:127]
    buffer_load_dwordx4 a[220:223], v254, s[8:11], s42 offen offset:1024 sc1
    v_mfma_f32_16x16x32_bf16 v[124:127], a[244:247], v[236:239], v[124:127]
    v_accvgpr_write_b32 a189, v205
    v_accvgpr_write_b32 a190, v206
    v_mfma_f32_16x16x32_bf16 v[124:127], a[232:235], v[232:235], v[124:127]
    v_accvgpr_write_b32 a191, v207
    v_accvgpr_read_b32 v204, a0
    v_mfma_f32_16x16x32_bf16 v[128:131], a[236:239], v[232:235], v[128:131]
    ds_read_b128 v[232:235], v253 offset:1824
    v_accvgpr_read_b32 v205, a1
    v_mfma_f32_16x16x32_bf16 v[128:131], a[248:251], v[236:239], v[128:131]
    buffer_load_dwordx4 a[224:227], v254, s[8:11], s42 offen offset:2048 sc1
    v_mfma_f32_16x16x32_bf16 v[128:131], v[244:247], v[228:231], v[128:131]
    v_accvgpr_read_b32 v206, a2
    v_accvgpr_read_b32 v207, a3
    v_mfma_f32_16x16x32_bf16 v[132:135], a[228:231], v[236:239], v[132:135]
    v_and_b32 v252, 0x1f0, v254
    v_mul_u32_u24 v252, 96, v252
    v_mfma_f32_16x16x32_bf16 v[132:135], a[240:243], v[228:231], v[132:135]
    s_waitcnt lgkmcnt(0)
    v_add_f32 v208, v0, v96
    v_add_f32 v209, v1, v97
    v_mfma_f32_16x16x32_bf16 v[132:135], a[252:255], v[232:235], v[132:135]
    buffer_load_dword v252, v252, s[4:7], s100 offen offset:1152
    v_mfma_f32_16x16x32_bf16 v[136:139], v[240:243], v[232:235], v[136:139]
    v_add_f32 v210, v2, v98
    v_add_f32 v211, v3, v99
    v_mfma_f32_16x16x32_bf16 v[136:139], a[244:247], v[228:231], v[136:139]
    v_sub_f32 v96, v0, v96
    v_sub_f32 v97, v1, v97
    v_mfma_f32_16x16x32_bf16 v[136:139], a[232:235], v[236:239], v[136:139]
    v_sub_f32 v98, v2, v98
    v_sub_f32 v99, v3, v99
    v_mfma_f32_16x16x32_bf16 v[140:143], a[236:239], v[236:239], v[140:143]
    ds_read_b128 v[236:239], v253 offset:1568
    v_fma_f32 v0, v208, s31, v204
    v_mfma_f32_16x16x32_bf16 v[140:143], a[248:251], v[228:231], v[140:143]
    v_fma_f32 v1, v209, s31, v205
    v_fma_f32 v2, v210, s31, v206
    v_mfma_f32_16x16x32_bf16 v[140:143], v[244:247], v[232:235], v[140:143]
    v_fma_f32 v3, v211, s31, v207
    v_fmac_f32 v208, s30, v204
    v_mfma_f32_16x16x32_bf16 v[144:147], a[228:231], v[228:231], v[144:147]
    v_fmac_f32 v209, s30, v205
    v_fmac_f32 v210, s30, v206
    v_mfma_f32_16x16x32_bf16 v[144:147], a[240:243], v[232:235], v[144:147]
    s_waitcnt lgkmcnt(0)
    v_fmac_f32 v211, s30, v207
    v_cvt_pk_bf16_f32 v194, v208, v209
    v_mfma_f32_16x16x32_bf16 v[144:147], a[252:255], v[236:239], v[144:147]
    v_cvt_pk_bf16_f32 v195, v210, v211
    v_accvgpr_read_b32 v204, a4
    v_mfma_f32_16x16x32_bf16 v[148:151], v[240:243], v[236:239], v[148:151]
    v_accvgpr_read_b32 v205, a5
    v_accvgpr_read_b32 v206, a6
    v_mfma_f32_16x16x32_bf16 v[148:151], a[244:247], v[232:235], v[148:151]
    v_accvgpr_read_b32 v207, a7
    v_add_f32 v208, v4, v100
    v_mfma_f32_16x16x32_bf16 v[148:151], a[232:235], v[228:231], v[148:151]
    v_add_f32 v209, v5, v101
    v_add_f32 v210, v6, v102
    v_mfma_f32_16x16x32_bf16 v[152:155], a[236:239], v[228:231], v[152:155]
    ds_read_b128 v[228:231], v253 offset:1312
    v_add_f32 v211, v7, v103
    v_mfma_f32_16x16x32_bf16 v[152:155], a[248:251], v[232:235], v[152:155]
    v_sub_f32 v100, v4, v100
    v_sub_f32 v101, v5, v101
    v_mfma_f32_16x16x32_bf16 v[152:155], v[244:247], v[236:239], v[152:155]
    v_sub_f32 v102, v6, v102
    v_sub_f32 v103, v7, v103
    v_mfma_f32_16x16x32_bf16 v[156:159], a[228:231], v[232:235], v[156:159]
    v_fma_f32 v4, v208, s31, v204
    v_fma_f32 v5, v209, s31, v205
    v_mfma_f32_16x16x32_bf16 v[156:159], a[240:243], v[236:239], v[156:159]
    s_waitcnt lgkmcnt(0)
    v_fma_f32 v6, v210, s31, v206
    v_fma_f32 v7, v211, s31, v207
    v_mfma_f32_16x16x32_bf16 v[156:159], a[252:255], v[228:231], v[156:159]
    v_fmac_f32 v208, s30, v204
    v_fmac_f32 v209, s30, v205
    v_mfma_f32_16x16x32_bf16 v[160:163], v[240:243], v[228:231], v[160:163]
    v_fmac_f32 v210, s30, v206
    v_fmac_f32 v211, s30, v207
    v_mfma_f32_16x16x32_bf16 v[160:163], a[244:247], v[236:239], v[160:163]
    v_cvt_pk_bf16_f32 v196, v208, v209
    v_cvt_pk_bf16_f32 v197, v210, v211
    v_mfma_f32_16x16x32_bf16 v[160:163], a[232:235], v[232:235], v[160:163]
    v_accvgpr_read_b32 v204, a8
    v_accvgpr_read_b32 v205, a9
    v_mfma_f32_16x16x32_bf16 v[164:167], a[236:239], v[232:235], v[164:167]
    ds_read_b128 v[232:235], v253 offset:1056
    v_accvgpr_read_b32 v206, a10
    v_mfma_f32_16x16x32_bf16 v[164:167], a[248:251], v[236:239], v[164:167]
    v_accvgpr_read_b32 v207, a11
    v_add_f32 v208, v8, v104
    v_mfma_f32_16x16x32_bf16 v[164:167], v[244:247], v[228:231], v[164:167]
    v_add_f32 v209, v9, v105
    v_add_f32 v210, v10, v106
    v_mfma_f32_16x16x32_bf16 v[168:171], a[228:231], v[236:239], v[168:171]
    v_add_f32 v211, v11, v107
    v_sub_f32 v104, v8, v104
    v_mfma_f32_16x16x32_bf16 v[168:171], a[240:243], v[228:231], v[168:171]
    s_waitcnt lgkmcnt(0)
    v_sub_f32 v105, v9, v105
    v_sub_f32 v106, v10, v106
    v_mfma_f32_16x16x32_bf16 v[168:171], a[252:255], v[232:235], v[168:171]
    v_sub_f32 v107, v11, v107
    v_fma_f32 v8, v208, s31, v204
    v_mfma_f32_16x16x32_bf16 v[172:175], v[240:243], v[232:235], v[172:175]
    v_fma_f32 v9, v209, s31, v205
    v_fma_f32 v10, v210, s31, v206
    v_mfma_f32_16x16x32_bf16 v[172:175], a[244:247], v[228:231], v[172:175]
    v_fma_f32 v11, v211, s31, v207
    v_fmac_f32 v208, s30, v204
    v_mfma_f32_16x16x32_bf16 v[172:175], a[232:235], v[236:239], v[172:175]
    v_fmac_f32 v209, s30, v205
    v_fmac_f32 v210, s30, v206
    v_mfma_f32_16x16x32_bf16 v[176:179], a[236:239], v[236:239], v[176:179]
    ds_read_b128 v[236:239], v253 offset:784
    v_fmac_f32 v211, s30, v207
    v_mfma_f32_16x16x32_bf16 v[176:179], a[248:251], v[228:231], v[176:179]
    v_cvt_pk_bf16_f32 v198, v208, v209
    v_cvt_pk_bf16_f32 v199, v210, v211
    v_mfma_f32_16x16x32_bf16 v[176:179], v[244:247], v[232:235], v[176:179]
    s_mov_b32 s42, 958464
    v_mfma_f32_16x16x32_bf16 v[180:183], a[228:231], v[228:231], v[180:183]
    s_waitcnt lgkmcnt(0)
    v_mfma_f32_16x16x32_bf16 v[184:187], a[232:235], v[228:231], v[184:187]
    s_barrier
    v_mfma_f32_16x16x32_bf16 v[188:191], a[236:239], v[228:231], v[188:191]
    ds_read_b128 v[228:231], v253 offset:15600
    v_mfma_f32_16x16x32_bf16 v[188:191], a[248:251], v[232:235], v[188:191]
    buffer_load_dwordx4 a[228:231], v254, s[8:11], s42 offen offset:0 sc1
    v_mfma_f32_16x16x32_bf16 v[184:187], a[244:247], v[232:235], v[184:187]
    v_mfma_f32_16x16x32_bf16 v[180:183], a[240:243], v[232:235], v[180:183]
    ds_read_b128 v[232:235], v253 offset:15328
    v_mfma_f32_16x16x32_bf16 v[180:183], a[252:255], v[236:239], v[180:183]
    buffer_load_dwordx4 a[232:235], v254, s[8:11], s42 offen offset:1024 sc1
    v_mfma_f32_16x16x32_bf16 v[184:187], v[240:243], v[236:239], v[184:187]
    s_waitcnt vmcnt(9) lgkmcnt(1)
    v_mfma_f32_16x16x32_bf16 v[188:191], v[244:247], v[236:239], v[188:191]
    ds_read_b128 v[236:239], v253 offset:15072
    s_nop 0
    ds_write_b128 v248, v[194:197] offset:0
    v_accvgpr_read_b32 v204, a12
    v_accvgpr_read_b32 v205, a13
    v_accvgpr_read_b32 v206, a14
    v_accvgpr_read_b32 v207, a15
    v_pk_add_f32 v[208:209], v[12:13], v[108:109]
    v_pk_add_f32 v[210:211], v[14:15], v[110:111]
    v_pk_add_f32 v[108:109], v[12:13], v[108:109] neg_lo:[0,1] neg_hi:[0,1]
    v_pk_add_f32 v[110:111], v[14:15], v[110:111] neg_lo:[0,1] neg_hi:[0,1]
    v_pk_fma_f32 v[12:13], v[208:209], s[30:31], v[204:205] op_sel:[0,1,0]
    v_pk_fma_f32 v[14:15], v[210:211], s[30:31], v[206:207] op_sel:[0,1,0]
    v_pk_fma_f32 v[204:205], v[204:205], s[30:31], v[208:209] op_sel_hi:[1,0,1]
    v_pk_fma_f32 v[206:207], v[206:207], s[30:31], v[210:211] op_sel_hi:[1,0,1]
    v_cvt_pk_bf16_f32 v220, v204, v205
    v_cvt_pk_bf16_f32 v221, v206, v207
    ds_write_b64 v249, v[198:199] offset:64
    v_accvgpr_read_b32 v212, a16
    v_accvgpr_read_b32 v213, a17
    v_accvgpr_read_b32 v214, a18
    v_accvgpr_read_b32 v215, a19
    v_pk_add_f32 v[216:217], v[16:17], v[112:113]
    v_pk_add_f32 v[218:219], v[18:19], v[114:115]
    v_pk_add_f32 v[112:113], v[16:17], v[112:113] neg_lo:[0,1] neg_hi:[0,1]
    v_pk_add_f32 v[114:115], v[18:19], v[114:115] neg_lo:[0,1] neg_hi:[0,1]
    v_pk_fma_f32 v[16:17], v[216:217], s[30:31], v[212:213] op_sel:[0,1,0]
    v_pk_fma_f32 v[18:19], v[218:219], s[30:31], v[214:215] op_sel:[0,1,0]
    v_pk_fma_f32 v[212:213], v[212:213], s[30:31], v[216:217] op_sel_hi:[1,0,1]
    v_pk_fma_f32 v[214:215], v[214:215], s[30:31], v[218:219] op_sel_hi:[1,0,1]
    v_cvt_pk_bf16_f32 v222, v212, v213
    v_cvt_pk_bf16_f32 v223, v214, v215
    ds_write_b128 v248, v[220:223] offset:384
    v_accvgpr_read_b32 v204, a20
    v_accvgpr_read_b32 v205, a21
    v_accvgpr_read_b32 v206, a22
    v_accvgpr_read_b32 v207, a23
    v_pk_add_f32 v[208:209], v[20:21], v[116:117]
    v_pk_add_f32 v[210:211], v[22:23], v[118:119]
    v_pk_add_f32 v[116:117], v[20:21], v[116:117] neg_lo:[0,1] neg_hi:[0,1]
    v_pk_add_f32 v[118:119], v[22:23], v[118:119] neg_lo:[0,1] neg_hi:[0,1]
    v_pk_fma_f32 v[20:21], v[208:209], s[30:31], v[204:205] op_sel:[0,1,0]
    v_pk_fma_f32 v[22:23], v[210:211], s[30:31], v[206:207] op_sel:[0,1,0]
    v_pk_fma_f32 v[204:205], v[204:205], s[30:31], v[208:209] op_sel_hi:[1,0,1]
    v_pk_fma_f32 v[206:207], v[206:207], s[30:31], v[210:211] op_sel_hi:[1,0,1]
    v_cvt_pk_bf16_f32 v224, v204, v205
    v_cvt_pk_bf16_f32 v225, v206, v207
    v_accvgpr_read_b32 v204, a24
    v_accvgpr_read_b32 v205, a25
    v_accvgpr_read_b32 v206, a26
    v_accvgpr_read_b32 v207, a27
    v_pk_add_f32 v[208:209], v[24:25], v[120:121]
    v_pk_add_f32 v[210:211], v[26:27], v[122:123]
    v_pk_add_f32 v[120:121], v[24:25], v[120:121] neg_lo:[0,1] neg_hi:[0,1]
    v_pk_add_f32 v[122:123], v[26:27], v[122:123] neg_lo:[0,1] neg_hi:[0,1]
    v_pk_fma_f32 v[24:25], v[208:209], s[30:31], v[204:205] op_sel:[0,1,0]
    v_pk_fma_f32 v[26:27], v[210:211], s[30:31], v[206:207] op_sel:[0,1,0]
    v_pk_fma_f32 v[204:205], v[204:205], s[30:31], v[208:209] op_sel_hi:[1,0,1]
    v_pk_fma_f32 v[206:207], v[206:207], s[30:31], v[210:211] op_sel_hi:[1,0,1]
    v_cvt_pk_bf16_f32 v194, v204, v205
    v_cvt_pk_bf16_f32 v195, v206, v207
    ds_write_b64 v249, v[224:225] offset:448
    v_accvgpr_read_b32 v212, a28
    v_accvgpr_read_b32 v213, a29
    v_accvgpr_read_b32 v214, a30
    v_accvgpr_read_b32 v215, a31
    v_accvgpr_read_b32 v216, a124
    v_accvgpr_read_b32 v217, a125
    v_accvgpr_read_b32 v218, a126
    v_accvgpr_read_b32 v219, a127
    v_pk_add_f32 v[212:213], v[212:213], v[216:217]
    v_pk_add_f32 v[214:215], v[214:215], v[218:219]
    v_pk_add_f32 v[216:217], v[28:29], v[124:125]
    v_pk_add_f32 v[218:219], v[30:31], v[126:127]
    v_pk_add_f32 v[124:125], v[28:29], v[124:125] neg_lo:[0,1] neg_hi:[0,1]
    v_pk_add_f32 v[126:127], v[30:31], v[126:127] neg_lo:[0,1] neg_hi:[0,1]
    v_pk_fma_f32 v[28:29], v[216:217], s[30:31], v[212:213] op_sel:[0,1,0]
    v_pk_fma_f32 v[30:31], v[218:219], s[30:31], v[214:215] op_sel:[0,1,0]
    v_pk_fma_f32 v[212:213], v[212:213], s[30:31], v[216:217] op_sel_hi:[1,0,1]
    v_pk_fma_f32 v[214:215], v[214:215], s[30:31], v[218:219] op_sel_hi:[1,0,1]
    v_cvt_pk_bf16_f32 v196, v212, v213
    v_cvt_pk_bf16_f32 v197, v214, v215
    ds_write_b128 v248, v[194:197] offset:768
    v_accvgpr_read_b32 v204, a32
    v_accvgpr_read_b32 v205, a33
    v_accvgpr_read_b32 v206, a34
    v_accvgpr_read_b32 v207, a35
    v_accvgpr_read_b32 v208, a128
    v_accvgpr_read_b32 v209, a129
    v_accvgpr_read_b32 v210, a130
    v_accvgpr_read_b32 v211, a131
    v_pk_add_f32 v[204:205], v[204:205], v[208:209]
    v_pk_add_f32 v[206:207], v[206:207], v[210:211]
    v_pk_add_f32 v[208:209], v[32:33], v[128:129]
    v_pk_add_f32 v[210:211], v[34:35], v[130:131]
    v_pk_add_f32 v[128:129], v[32:33], v[128:129] neg_lo:[0,1] neg_hi:[0,1]
    v_pk_add_f32 v[130:131], v[34:35], v[130:131] neg_lo:[0,1] neg_hi:[0,1]
    v_pk_fma_f32 v[32:33], v[208:209], s[30:31], v[204:205] op_sel:[0,1,0]
    v_pk_fma_f32 v[34:35], v[210:211], s[30:31], v[206:207] op_sel:[0,1,0]
    v_pk_fma_f32 v[204:205], v[204:205], s[30:31], v[208:209] op_sel_hi:[1,0,1]
    v_pk_fma_f32 v[206:207], v[206:207], s[30:31], v[210:211] op_sel_hi:[1,0,1]
    v_cvt_pk_bf16_f32 v198, v204, v205
    v_cvt_pk_bf16_f32 v199, v206, v207
    v_accvgpr_read_b32 v204, a36
    v_accvgpr_read_b32 v205, a37
    v_accvgpr_read_b32 v206, a38
    v_accvgpr_read_b32 v207, a39
    v_accvgpr_read_b32 v208, a132
    v_accvgpr_read_b32 v209, a133
    v_accvgpr_read_b32 v210, a134
    v_accvgpr_read_b32 v211, a135
    v_pk_add_f32 v[204:205], v[204:205], v[208:209]
    v_pk_add_f32 v[206:207], v[206:207], v[210:211]
    v_pk_add_f32 v[208:209], v[36:37], v[132:133]
    v_pk_add_f32 v[210:211], v[38:39], v[134:135]
    v_pk_add_f32 v[132:133], v[36:37], v[132:133] neg_lo:[0,1] neg_hi:[0,1]
    v_pk_add_f32 v[134:135], v[38:39], v[134:135] neg_lo:[0,1] neg_hi:[0,1]
    v_pk_fma_f32 v[36:37], v[208:209], s[30:31], v[204:205] op_sel:[0,1,0]
    v_pk_fma_f32 v[38:39], v[210:211], s[30:31], v[206:207] op_sel:[0,1,0]
    v_pk_fma_f32 v[204:205], v[204:205], s[30:31], v[208:209] op_sel_hi:[1,0,1]
    v_pk_fma_f32 v[206:207], v[206:207], s[30:31], v[210:211] op_sel_hi:[1,0,1]
    v_cvt_pk_bf16_f32 v220, v204, v205
    v_cvt_pk_bf16_f32 v221, v206, v207
    ds_write_b64 v249, v[198:199] offset:832
    v_accvgpr_read_b32 v212, a40
    v_accvgpr_read_b32 v213, a41
    v_accvgpr_read_b32 v214, a42
    v_accvgpr_read_b32 v215, a43
    v_accvgpr_read_b32 v216, a136
    v_accvgpr_read_b32 v217, a137
    v_accvgpr_read_b32 v218, a138
    v_accvgpr_read_b32 v219, a139
    v_pk_add_f32 v[212:213], v[212:213], v[216:217]
    v_pk_add_f32 v[214:215], v[214:215], v[218:219]
    v_pk_add_f32 v[216:217], v[40:41], v[136:137]
    v_pk_add_f32 v[218:219], v[42:43], v[138:139]
    v_pk_add_f32 v[136:137], v[40:41], v[136:137] neg_lo:[0,1] neg_hi:[0,1]
    v_pk_add_f32 v[138:139], v[42:43], v[138:139] neg_lo:[0,1] neg_hi:[0,1]
    v_pk_fma_f32 v[40:41], v[216:217], s[30:31], v[212:213] op_sel:[0,1,0]
    v_pk_fma_f32 v[42:43], v[218:219], s[30:31], v[214:215] op_sel:[0,1,0]
    v_pk_fma_f32 v[212:213], v[212:213], s[30:31], v[216:217] op_sel_hi:[1,0,1]
    v_pk_fma_f32 v[214:215], v[214:215], s[30:31], v[218:219] op_sel_hi:[1,0,1]
    v_cvt_pk_bf16_f32 v222, v212, v213
    v_cvt_pk_bf16_f32 v223, v214, v215
    ds_write_b128 v248, v[220:223] offset:1152
    v_accvgpr_read_b32 v204, a44
    v_accvgpr_read_b32 v205, a45
    v_accvgpr_read_b32 v206, a46
    v_accvgpr_read_b32 v207, a47
    v_accvgpr_read_b32 v208, a140
    v_accvgpr_read_b32 v209, a141
    v_accvgpr_read_b32 v210, a142
    v_accvgpr_read_b32 v211, a143
    v_pk_add_f32 v[204:205], v[204:205], v[208:209]
    v_pk_add_f32 v[206:207], v[206:207], v[210:211]
    v_pk_add_f32 v[208:209], v[44:45], v[140:141]
    v_pk_add_f32 v[210:211], v[46:47], v[142:143]
    v_pk_add_f32 v[140:141], v[44:45], v[140:141] neg_lo:[0,1] neg_hi:[0,1]
    v_pk_add_f32 v[142:143], v[46:47], v[142:143] neg_lo:[0,1] neg_hi:[0,1]
    v_pk_fma_f32 v[44:45], v[208:209], s[30:31], v[204:205] op_sel:[0,1,0]
    v_pk_fma_f32 v[46:47], v[210:211], s[30:31], v[206:207] op_sel:[0,1,0]
    v_pk_fma_f32 v[204:205], v[204:205], s[30:31], v[208:209] op_sel_hi:[1,0,1]
    v_pk_fma_f32 v[206:207], v[206:207], s[30:31], v[210:211] op_sel_hi:[1,0,1]
    v_cvt_pk_bf16_f32 v224, v204, v205
    v_cvt_pk_bf16_f32 v225, v206, v207
    v_accvgpr_read_b32 v204, a48
    v_accvgpr_read_b32 v205, a49
    v_accvgpr_read_b32 v206, a50
    v_accvgpr_read_b32 v207, a51
    v_accvgpr_read_b32 v208, a144
    v_accvgpr_read_b32 v209, a145
    v_accvgpr_read_b32 v210, a146
    v_accvgpr_read_b32 v211, a147
    v_pk_add_f32 v[204:205], v[204:205], v[208:209]
    v_pk_add_f32 v[206:207], v[206:207], v[210:211]
    v_pk_add_f32 v[208:209], v[48:49], v[144:145]
    v_pk_add_f32 v[210:211], v[50:51], v[146:147]
    v_pk_add_f32 v[144:145], v[48:49], v[144:145] neg_lo:[0,1] neg_hi:[0,1]
    v_pk_add_f32 v[146:147], v[50:51], v[146:147] neg_lo:[0,1] neg_hi:[0,1]
    v_pk_fma_f32 v[48:49], v[208:209], s[30:31], v[204:205] op_sel:[0,1,0]
    v_pk_fma_f32 v[50:51], v[210:211], s[30:31], v[206:207] op_sel:[0,1,0]
    v_pk_fma_f32 v[204:205], v[204:205], s[30:31], v[208:209] op_sel_hi:[1,0,1]
    v_pk_fma_f32 v[206:207], v[206:207], s[30:31], v[210:211] op_sel_hi:[1,0,1]
    v_cvt_pk_bf16_f32 v194, v204, v205
    v_cvt_pk_bf16_f32 v195, v206, v207
    ds_write_b64 v249, v[224:225] offset:1216
    v_accvgpr_read_b32 v212, a52
    v_accvgpr_read_b32 v213, a53
    v_accvgpr_read_b32 v214, a54
    v_accvgpr_read_b32 v215, a55
    v_accvgpr_read_b32 v216, a148
    v_accvgpr_read_b32 v217, a149
    v_accvgpr_read_b32 v218, a150
    v_accvgpr_read_b32 v219, a151
    v_pk_add_f32 v[212:213], v[212:213], v[216:217]
    v_pk_add_f32 v[214:215], v[214:215], v[218:219]
    v_pk_add_f32 v[216:217], v[52:53], v[148:149]
    v_pk_add_f32 v[218:219], v[54:55], v[150:151]
    v_pk_add_f32 v[148:149], v[52:53], v[148:149] neg_lo:[0,1] neg_hi:[0,1]
    v_pk_add_f32 v[150:151], v[54:55], v[150:151] neg_lo:[0,1] neg_hi:[0,1]
    v_pk_fma_f32 v[52:53], v[216:217], s[30:31], v[212:213] op_sel:[0,1,0]
    v_pk_fma_f32 v[54:55], v[218:219], s[30:31], v[214:215] op_sel:[0,1,0]
    v_pk_fma_f32 v[212:213], v[212:213], s[30:31], v[216:217] op_sel_hi:[1,0,1]
    v_pk_fma_f32 v[214:215], v[214:215], s[30:31], v[218:219] op_sel_hi:[1,0,1]
    v_cvt_pk_bf16_f32 v196, v212, v213
    v_cvt_pk_bf16_f32 v197, v214, v215
    ds_write_b128 v248, v[194:197] offset:1536
    v_accvgpr_read_b32 v204, a56
    v_accvgpr_read_b32 v205, a57
    v_accvgpr_read_b32 v206, a58
    v_accvgpr_read_b32 v207, a59
    v_accvgpr_read_b32 v208, a152
    v_accvgpr_read_b32 v209, a153
    v_accvgpr_read_b32 v210, a154
    v_accvgpr_read_b32 v211, a155
    v_pk_add_f32 v[204:205], v[204:205], v[208:209]
    v_pk_add_f32 v[206:207], v[206:207], v[210:211]
    v_pk_add_f32 v[208:209], v[56:57], v[152:153]
    v_pk_add_f32 v[210:211], v[58:59], v[154:155]
    v_pk_add_f32 v[152:153], v[56:57], v[152:153] neg_lo:[0,1] neg_hi:[0,1]
    v_pk_add_f32 v[154:155], v[58:59], v[154:155] neg_lo:[0,1] neg_hi:[0,1]
    v_pk_fma_f32 v[56:57], v[208:209], s[30:31], v[204:205] op_sel:[0,1,0]
    v_pk_fma_f32 v[58:59], v[210:211], s[30:31], v[206:207] op_sel:[0,1,0]
    v_pk_fma_f32 v[204:205], v[204:205], s[30:31], v[208:209] op_sel_hi:[1,0,1]
    v_pk_fma_f32 v[206:207], v[206:207], s[30:31], v[210:211] op_sel_hi:[1,0,1]
    v_cvt_pk_bf16_f32 v198, v204, v205
    v_cvt_pk_bf16_f32 v199, v206, v207
    v_accvgpr_read_b32 v204, a60
    v_accvgpr_read_b32 v205, a61
    v_accvgpr_read_b32 v206, a62
    v_accvgpr_read_b32 v207, a63
    v_accvgpr_read_b32 v208, a156
    v_accvgpr_read_b32 v209, a157
    v_accvgpr_read_b32 v210, a158
    v_accvgpr_read_b32 v211, a159
    v_pk_add_f32 v[204:205], v[204:205], v[208:209]
    v_pk_add_f32 v[206:207], v[206:207], v[210:211]
    v_pk_add_f32 v[208:209], v[60:61], v[156:157]
    v_pk_add_f32 v[210:211], v[62:63], v[158:159]
    v_pk_add_f32 v[156:157], v[60:61], v[156:157] neg_lo:[0,1] neg_hi:[0,1]
    v_pk_add_f32 v[158:159], v[62:63], v[158:159] neg_lo:[0,1] neg_hi:[0,1]
    v_pk_fma_f32 v[60:61], v[208:209], s[30:31], v[204:205] op_sel:[0,1,0]
    v_pk_fma_f32 v[62:63], v[210:211], s[30:31], v[206:207] op_sel:[0,1,0]
    v_pk_fma_f32 v[204:205], v[204:205], s[30:31], v[208:209] op_sel_hi:[1,0,1]
    v_pk_fma_f32 v[206:207], v[206:207], s[30:31], v[210:211] op_sel_hi:[1,0,1]
    v_cvt_pk_bf16_f32 v220, v204, v205
    v_cvt_pk_bf16_f32 v221, v206, v207
    ds_write_b64 v249, v[198:199] offset:1600
    v_accvgpr_read_b32 v212, a64
    v_accvgpr_read_b32 v213, a65
    v_accvgpr_read_b32 v214, a66
    v_accvgpr_read_b32 v215, a67
    v_accvgpr_read_b32 v216, a160
    v_accvgpr_read_b32 v217, a161
    v_accvgpr_read_b32 v218, a162
    v_accvgpr_read_b32 v219, a163
    v_pk_add_f32 v[212:213], v[212:213], v[216:217]
    v_pk_add_f32 v[214:215], v[214:215], v[218:219]
    v_pk_add_f32 v[216:217], v[64:65], v[160:161]
    v_pk_add_f32 v[218:219], v[66:67], v[162:163]
    v_pk_add_f32 v[160:161], v[64:65], v[160:161] neg_lo:[0,1] neg_hi:[0,1]
    v_pk_add_f32 v[162:163], v[66:67], v[162:163] neg_lo:[0,1] neg_hi:[0,1]
    v_pk_fma_f32 v[64:65], v[216:217], s[30:31], v[212:213] op_sel:[0,1,0]
    v_pk_fma_f32 v[66:67], v[218:219], s[30:31], v[214:215] op_sel:[0,1,0]
    v_pk_fma_f32 v[212:213], v[212:213], s[30:31], v[216:217] op_sel_hi:[1,0,1]
    v_pk_fma_f32 v[214:215], v[214:215], s[30:31], v[218:219] op_sel_hi:[1,0,1]
    v_cvt_pk_bf16_f32 v222, v212, v213
    v_cvt_pk_bf16_f32 v223, v214, v215
    ds_write_b128 v248, v[220:223] offset:1920
    v_accvgpr_read_b32 v204, a68
    v_accvgpr_read_b32 v205, a69
    v_accvgpr_read_b32 v206, a70
    v_accvgpr_read_b32 v207, a71
    v_accvgpr_read_b32 v208, a164
    v_accvgpr_read_b32 v209, a165
    v_accvgpr_read_b32 v210, a166
    v_accvgpr_read_b32 v211, a167
    v_pk_add_f32 v[204:205], v[204:205], v[208:209]
    v_pk_add_f32 v[206:207], v[206:207], v[210:211]
    v_pk_add_f32 v[208:209], v[68:69], v[164:165]
    v_pk_add_f32 v[210:211], v[70:71], v[166:167]
    v_pk_add_f32 v[164:165], v[68:69], v[164:165] neg_lo:[0,1] neg_hi:[0,1]
    v_pk_add_f32 v[166:167], v[70:71], v[166:167] neg_lo:[0,1] neg_hi:[0,1]
    v_pk_fma_f32 v[68:69], v[208:209], s[30:31], v[204:205] op_sel:[0,1,0]
    v_pk_fma_f32 v[70:71], v[210:211], s[30:31], v[206:207] op_sel:[0,1,0]
    v_pk_fma_f32 v[204:205], v[204:205], s[30:31], v[208:209] op_sel_hi:[1,0,1]
    v_pk_fma_f32 v[206:207], v[206:207], s[30:31], v[210:211] op_sel_hi:[1,0,1]
    v_cvt_pk_bf16_f32 v224, v204, v205
    v_cvt_pk_bf16_f32 v225, v206, v207
    v_accvgpr_read_b32 v204, a72
    v_accvgpr_read_b32 v205, a73
    v_accvgpr_read_b32 v206, a74
    v_accvgpr_read_b32 v207, a75
    v_accvgpr_read_b32 v208, a168
    v_accvgpr_read_b32 v209, a169
    v_accvgpr_read_b32 v210, a170
    v_accvgpr_read_b32 v211, a171
    v_pk_add_f32 v[204:205], v[204:205], v[208:209]
    v_pk_add_f32 v[206:207], v[206:207], v[210:211]
    v_pk_add_f32 v[208:209], v[72:73], v[168:169]
    v_pk_add_f32 v[210:211], v[74:75], v[170:171]
    v_pk_add_f32 v[168:169], v[72:73], v[168:169] neg_lo:[0,1] neg_hi:[0,1]
    v_pk_add_f32 v[170:171], v[74:75], v[170:171] neg_lo:[0,1] neg_hi:[0,1]
    v_pk_fma_f32 v[72:73], v[208:209], s[30:31], v[204:205] op_sel:[0,1,0]
    v_pk_fma_f32 v[74:75], v[210:211], s[30:31], v[206:207] op_sel:[0,1,0]
    v_pk_fma_f32 v[204:205], v[204:205], s[30:31], v[208:209] op_sel_hi:[1,0,1]
    v_pk_fma_f32 v[206:207], v[206:207], s[30:31], v[210:211] op_sel_hi:[1,0,1]
    v_cvt_pk_bf16_f32 v194, v204, v205
    v_cvt_pk_bf16_f32 v195, v206, v207
    ds_write_b64 v249, v[224:225] offset:1984
    v_accvgpr_read_b32 v212, a76
    v_accvgpr_read_b32 v213, a77
    v_accvgpr_read_b32 v214, a78
    v_accvgpr_read_b32 v215, a79
    v_accvgpr_read_b32 v216, a172
    v_accvgpr_read_b32 v217, a173
    v_accvgpr_read_b32 v218, a174
    v_accvgpr_read_b32 v219, a175
    v_pk_add_f32 v[212:213], v[212:213], v[216:217]
    v_pk_add_f32 v[214:215], v[214:215], v[218:219]
    v_pk_add_f32 v[216:217], v[76:77], v[172:173]
    v_pk_add_f32 v[218:219], v[78:79], v[174:175]
    v_pk_add_f32 v[172:173], v[76:77], v[172:173] neg_lo:[0,1] neg_hi:[0,1]
    v_pk_add_f32 v[174:175], v[78:79], v[174:175] neg_lo:[0,1] neg_hi:[0,1]
    v_pk_fma_f32 v[76:77], v[216:217], s[30:31], v[212:213] op_sel:[0,1,0]
    v_pk_fma_f32 v[78:79], v[218:219], s[30:31], v[214:215] op_sel:[0,1,0]
    v_pk_fma_f32 v[212:213], v[212:213], s[30:31], v[216:217] op_sel_hi:[1,0,1]
    v_pk_fma_f32 v[214:215], v[214:215], s[30:31], v[218:219] op_sel_hi:[1,0,1]
    v_cvt_pk_bf16_f32 v196, v212, v213
    v_cvt_pk_bf16_f32 v197, v214, v215
    ds_write_b128 v248, v[194:197] offset:2304
    v_accvgpr_read_b32 v204, a80
    v_accvgpr_read_b32 v205, a81
    v_accvgpr_read_b32 v206, a82
    v_accvgpr_read_b32 v207, a83
    v_accvgpr_read_b32 v208, a176
    v_accvgpr_read_b32 v209, a177
    v_accvgpr_read_b32 v210, a178
    v_accvgpr_read_b32 v211, a179
    v_pk_add_f32 v[204:205], v[204:205], v[208:209]
    v_pk_add_f32 v[206:207], v[206:207], v[210:211]
    v_pk_add_f32 v[208:209], v[80:81], v[176:177]
    v_pk_add_f32 v[210:211], v[82:83], v[178:179]
    v_pk_add_f32 v[176:177], v[80:81], v[176:177] neg_lo:[0,1] neg_hi:[0,1]
    v_pk_add_f32 v[178:179], v[82:83], v[178:179] neg_lo:[0,1] neg_hi:[0,1]
    v_pk_fma_f32 v[80:81], v[208:209], s[30:31], v[204:205] op_sel:[0,1,0]
    v_pk_fma_f32 v[82:83], v[210:211], s[30:31], v[206:207] op_sel:[0,1,0]
    v_pk_fma_f32 v[204:205], v[204:205], s[30:31], v[208:209] op_sel_hi:[1,0,1]
    v_pk_fma_f32 v[206:207], v[206:207], s[30:31], v[210:211] op_sel_hi:[1,0,1]
    v_cvt_pk_bf16_f32 v198, v204, v205
    v_cvt_pk_bf16_f32 v199, v206, v207
    ds_write_b64 v249, v[198:199] offset:2368
    s_waitcnt lgkmcnt(0)
    s_barrier
sub24:
    v_mfma_f32_16x16x32_bf16 v[0:3], a[192:195], v[228:231], v[0:3]
    buffer_load_dwordx4 a[236:239], v254, s[8:11], s42 offen offset:2048 sc1
    v_mfma_f32_16x16x32_bf16 v[4:7], a[196:199], v[228:231], v[4:7]
    s_mov_b32 s42, 961536
    v_accvgpr_read_b32 v204, a84
    v_accvgpr_read_b32 v205, a85
    v_mfma_f32_16x16x32_bf16 v[8:11], a[200:203], v[228:231], v[8:11]
    ds_read_b128 v[228:231], v253 offset:14816
    s_waitcnt vmcnt(7)
    v_mfma_f32_16x16x32_bf16 v[8:11], a[212:215], v[232:235], v[8:11]
    ds_read_b128 v[212:215], v250 offset:0
    v_accvgpr_read_b32 v206, a86
    v_mfma_f32_16x16x32_bf16 v[4:7], a[208:211], v[232:235], v[4:7]
    buffer_load_dwordx4 a[240:243], v254, s[8:11], s42 offen offset:0 sc1
    v_mfma_f32_16x16x32_bf16 v[0:3], a[204:207], v[232:235], v[0:3]
    s_waitcnt vmcnt(5)
    v_accvgpr_read_b32 v207, a87
    v_add_f32 v208, v84, v180
    v_mfma_f32_16x16x32_bf16 v[0:3], a[216:219], v[236:239], v[0:3]
    ds_read_b128 v[216:219], v250 offset:3104
    v_add_f32 v209, v85, v181
    v_mfma_f32_16x16x32_bf16 v[4:7], a[220:223], v[236:239], v[4:7]
    ds_read_b128 v[220:223], v250 offset:6208
    s_add_u32 s44, s40, 393216
    v_mfma_f32_16x16x32_bf16 v[8:11], a[224:227], v[236:239], v[8:11]
    buffer_load_dwordx4 a[244:247], v254, s[8:11], s42 offen offset:1024 sc1
    v_mfma_f32_16x16x32_bf16 v[12:15], a[192:195], v[232:235], v[12:15]
    ds_read_b128 v[224:227], v250 offset:9312
    v_add_f32 v210, v86, v182
    v_mfma_f32_16x16x32_bf16 v[12:15], a[204:207], v[236:239], v[12:15]
    s_waitcnt lgkmcnt(4)
    v_add_f32 v211, v87, v183
    v_sub_f32 v180, v84, v180
    v_mfma_f32_16x16x32_bf16 v[12:15], a[216:219], v[228:231], v[12:15]
pad9:
    s_cbranch_vccnz pad13
    s_waitcnt lgkmcnt(3)
    v_sub_f32 v181, v85, v181
    v_sub_f32 v182, v86, v182
    v_mfma_f32_16x16x32_bf16 v[16:19], a[220:223], v[228:231], v[16:19]
    buffer_load_dwordx4 a[248:251], v254, s[8:11], s42 offen offset:2048 sc1
    v_mfma_f32_16x16x32_bf16 v[16:19], a[208:211], v[236:239], v[16:19]
    s_mov_b32 s42, 964608
    v_sub_f32 v183, v87, v183
    v_fma_f32 v84, v208, s31, v204
    v_mfma_f32_16x16x32_bf16 v[16:19], a[196:199], v[232:235], v[16:19]
    v_fma_f32 v85, v209, s31, v205
    v_fma_f32 v86, v210, s31, v206
    v_mfma_f32_16x16x32_bf16 v[20:23], a[200:203], v[232:235], v[20:23]
    ds_read_b128 v[232:235], v253 offset:14560
    v_fma_f32 v87, v211, s31, v207
    v_mfma_f32_16x16x32_bf16 v[20:23], a[212:215], v[236:239], v[20:23]
    buffer_load_dwordx4 a[252:255], v254, s[8:11], s42 offen offset:0 sc1
    v_mfma_f32_16x16x32_bf16 v[20:23], a[224:227], v[228:231], v[20:23]
    v_fmac_f32 v208, s30, v204
    v_fmac_f32 v209, s30, v205
    v_mfma_f32_16x16x32_bf16 v[24:27], a[192:195], v[236:239], v[24:27]
    v_fmac_f32 v210, s30, v206
    v_fmac_f32 v211, s30, v207
    v_mfma_f32_16x16x32_bf16 v[24:27], a[204:207], v[228:231], v[24:27]
    s_waitcnt lgkmcnt(0)
    v_cvt_pk_bf16_f32 v192, v208, v209
    v_cvt_pk_bf16_f32 v193, v210, v211
    v_mfma_f32_16x16x32_bf16 v[24:27], a[216:219], v[232:235], v[24:27]
    v_accvgpr_read_b32 v204, a88
    v_accvgpr_read_b32 v205, a89
    v_mfma_f32_16x16x32_bf16 v[28:31], a[220:223], v[232:235], v[28:31]
    buffer_load_dwordx4 v[240:243], v254, s[8:11], s42 offen offset:1024 sc1
    v_mfma_f32_16x16x32_bf16 v[28:31], a[208:211], v[228:231], v[28:31]
    v_accvgpr_read_b32 v206, a90
    v_accvgpr_read_b32 v207, a91
    v_mfma_f32_16x16x32_bf16 v[28:31], a[196:199], v[236:239], v[28:31]
    v_add_f32 v208, v88, v184
    v_add_f32 v209, v89, v185
    v_mfma_f32_16x16x32_bf16 v[32:35], a[200:203], v[236:239], v[32:35]
    ds_read_b128 v[236:239], v253 offset:16384
    v_add_f32 v210, v90, v186
    v_mfma_f32_16x16x32_bf16 v[32:35], a[212:215], v[228:231], v[32:35]
    buffer_load_dwordx4 v[244:247], v254, s[8:11], s42 offen offset:2048 sc1
    v_mfma_f32_16x16x32_bf16 v[32:35], a[224:227], v[232:235], v[32:35]
    v_add_f32 v211, v91, v187
    v_sub_f32 v184, v88, v184
    v_mfma_f32_16x16x32_bf16 v[36:39], a[192:195], v[228:231], v[36:39]
    v_sub_f32 v185, v89, v185
    v_sub_f32 v186, v90, v186
    v_mfma_f32_16x16x32_bf16 v[36:39], a[204:207], v[232:235], v[36:39]
    s_waitcnt lgkmcnt(0)
    v_sub_f32 v187, v91, v187
    v_fma_f32 v88, v208, s31, v204
    v_mfma_f32_16x16x32_bf16 v[36:39], a[216:219], v[236:239], v[36:39]
    buffer_store_dwordx4 v[212:215], v254, s[12:15], s44 offen nt
    s_add_u32 s44, s40, 396288
    v_mfma_f32_16x16x32_bf16 v[40:43], a[220:223], v[236:239], v[40:43]
    v_fma_f32 v89, v209, s31, v205
    v_fma_f32 v90, v210, s31, v206
    v_mfma_f32_16x16x32_bf16 v[40:43], a[208:211], v[232:235], v[40:43]
    v_fma_f32 v91, v211, s31, v207
    v_fmac_f32 v208, s30, v204
    v_mfma_f32_16x16x32_bf16 v[40:43], a[196:199], v[228:231], v[40:43]
    buffer_store_dwordx4 v[216:219], v254, s[12:15], s44 offen nt
    v_fmac_f32 v209, s30, v205
    v_fmac_f32 v210, s30, v206
    v_mfma_f32_16x16x32_bf16 v[44:47], a[200:203], v[228:231], v[44:47]
    ds_read_b128 v[228:231], v253 offset:16128
    v_fmac_f32 v211, s30, v207
    v_mfma_f32_16x16x32_bf16 v[44:47], a[212:215], v[232:235], v[44:47]
    ds_read_b128 v[212:215], v250 offset:1024
    v_cvt_pk_bf16_f32 v194, v208, v209
    v_mfma_f32_16x16x32_bf16 v[44:47], a[224:227], v[236:239], v[44:47]
    s_add_u32 s44, s40, 399360
    v_cvt_pk_bf16_f32 v195, v210, v211
    v_accvgpr_read_b32 v204, a92
    v_mfma_f32_16x16x32_bf16 v[48:51], a[192:195], v[232:235], v[48:51]
    ds_read_b128 v[216:219], v250 offset:4128
    v_accvgpr_read_b32 v205, a93
    v_mfma_f32_16x16x32_bf16 v[48:51], a[204:207], v[236:239], v[48:51]
    s_waitcnt lgkmcnt(2)
    v_accvgpr_read_b32 v206, a94
    v_accvgpr_read_b32 v207, a95
    v_mfma_f32_16x16x32_bf16 v[48:51], a[216:219], v[228:231], v[48:51]
    v_add_f32 v208, v92, v188
    v_add_f32 v209, v93, v189
    v_mfma_f32_16x16x32_bf16 v[52:55], a[220:223], v[228:231], v[52:55]
    v_add_f32 v210, v94, v190
    v_add_f32 v211, v95, v191
    v_mfma_f32_16x16x32_bf16 v[52:55], a[208:211], v[236:239], v[52:55]
    v_sub_f32 v188, v92, v188
    v_sub_f32 v189, v93, v189
    v_mfma_f32_16x16x32_bf16 v[52:55], a[196:199], v[232:235], v[52:55]
    v_sub_f32 v190, v94, v190
    v_sub_f32 v191, v95, v191
    v_mfma_f32_16x16x32_bf16 v[56:59], a[200:203], v[232:235], v[56:59]
    ds_read_b128 v[232:235], v253 offset:15872
    v_fma_f32 v92, v208, s31, v204
    v_mfma_f32_16x16x32_bf16 v[56:59], a[212:215], v[236:239], v[56:59]
    v_fma_f32 v93, v209, s31, v205
    v_fma_f32 v94, v210, s31, v206
    v_mfma_f32_16x16x32_bf16 v[56:59], a[224:227], v[228:231], v[56:59]
    buffer_store_dwordx4 v[220:223], v254, s[12:15], s44 offen nt
    v_fma_f32 v95, v211, s31, v207
    v_fmac_f32 v208, s30, v204
    v_mfma_f32_16x16x32_bf16 v[60:63], a[192:195], v[236:239], v[60:63]
    v_fmac_f32 v209, s30, v205
    v_fmac_f32 v210, s30, v206
    v_mfma_f32_16x16x32_bf16 v[60:63], a[204:207], v[228:231], v[60:63]
    s_waitcnt lgkmcnt(0)
    v_fmac_f32 v211, s30, v207
    v_cvt_pk_bf16_f32 v196, v208, v209
    v_mfma_f32_16x16x32_bf16 v[60:63], a[216:219], v[232:235], v[60:63]
    v_cvt_pk_bf16_f32 v197, v210, v211
    v_accvgpr_read_b32 v204, a96
    v_mfma_f32_16x16x32_bf16 v[64:67], a[220:223], v[232:235], v[64:67]
    ds_write_b64 v249, v[196:197] offset:2752
    v_mfma_f32_16x16x32_bf16 v[64:67], a[208:211], v[228:231], v[64:67]
    s_add_u32 s44, s40, 402432
    v_accvgpr_read_b32 v205, a97
    v_accvgpr_read_b32 v206, a98
    v_mfma_f32_16x16x32_bf16 v[64:67], a[196:199], v[236:239], v[64:67]
    ds_write_b128 v248, v[192:195] offset:2688
    v_mfma_f32_16x16x32_bf16 v[68:71], a[200:203], v[236:239], v[68:71]
    ds_read_b128 v[236:239], v253 offset:15616
    v_accvgpr_read_b32 v207, a99
    v_fma_f32 v208, v204, s34, v96 div:2
    v_mfma_f32_16x16x32_bf16 v[68:71], a[212:215], v[228:231], v[68:71]
    v_fma_f32 v209, v205, s34, v97 div:2
    v_fma_f32 v210, v206, s34, v98 div:2
    v_mfma_f32_16x16x32_bf16 v[68:71], a[224:227], v[232:235], v[68:71]
    v_fma_f32 v211, v207, s34, v99 div:2
    v_fma_f32 v96, v204, s35, v96 mul:2
    v_mfma_f32_16x16x32_bf16 v[72:75], a[192:195], v[228:231], v[72:75]
    v_fma_f32 v97, v205, s35, v97 mul:2
    v_fma_f32 v98, v206, s35, v98 mul:2
    v_mfma_f32_16x16x32_bf16 v[72:75], a[204:207], v[232:235], v[72:75]
    s_waitcnt lgkmcnt(0)
    v_fma_f32 v99, v207, s35, v99 mul:2
    v_cvt_pk_bf16_f32 v198, v208, v209
    v_mfma_f32_16x16x32_bf16 v[72:75], a[216:219], v[236:239], v[72:75]
    v_cvt_pk_bf16_f32 v199, v210, v211
    v_accvgpr_write_b32 a0, v198
    v_mfma_f32_16x16x32_bf16 v[76:79], a[220:223], v[236:239], v[76:79]
    v_accvgpr_write_b32 a1, v199
    v_accvgpr_read_b32 v204, a100
    v_mfma_f32_16x16x32_bf16 v[76:79], a[208:211], v[232:235], v[76:79]
    buffer_store_dwordx4 v[224:227], v254, s[12:15], s44 offen nt
    v_accvgpr_read_b32 v205, a101
    v_accvgpr_read_b32 v206, a102
    v_mfma_f32_16x16x32_bf16 v[76:79], a[196:199], v[228:231], v[76:79]
    v_accvgpr_read_b32 v207, a103
    v_fma_f32 v208, v204, s34, v100 div:2
    v_mfma_f32_16x16x32_bf16 v[80:83], a[200:203], v[228:231], v[80:83]
    ds_read_b128 v[228:231], v253 offset:15344
    v_fma_f32 v209, v205, s34, v101 div:2
    v_mfma_f32_16x16x32_bf16 v[80:83], a[212:215], v[232:235], v[80:83]
    v_fma_f32 v210, v206, s34, v102 div:2
    v_fma_f32 v211, v207, s34, v103 div:2
    v_fma_f32 v100, v204, s35, v100 mul:2
    v_mfma_f32_16x16x32_bf16 v[80:83], a[224:227], v[236:239], v[80:83]
    s_mov_b32 s42, 995328
    v_fma_f32 v101, v205, s35, v101 mul:2
    v_fma_f32 v102, v206, s35, v102 mul:2
    v_mfma_f32_16x16x32_bf16 v[84:87], a[192:195], v[232:235], v[84:87]
    s_waitcnt lgkmcnt(0)
    v_fma_f32 v103, v207, s35, v103 mul:2
    v_cvt_pk_bf16_f32 v200, v208, v209
    v_mfma_f32_16x16x32_bf16 v[88:91], a[196:199], v[232:235], v[88:91]
    s_barrier
    v_mfma_f32_16x16x32_bf16 v[92:95], a[200:203], v[232:235], v[92:95]
    ds_read_b128 v[232:235], v253 offset:17680
    v_cvt_pk_bf16_f32 v201, v210, v211
    v_mfma_f32_16x16x32_bf16 v[92:95], a[212:215], v[236:239], v[92:95]
    buffer_load_dwordx4 a[192:195], v254, s[8:11], s42 offen offset:0 sc1
    v_mfma_f32_16x16x32_bf16 v[88:91], a[208:211], v[236:239], v[88:91]
    v_accvgpr_write_b32 a2, v200
    v_accvgpr_write_b32 a3, v201
    v_mfma_f32_16x16x32_bf16 v[84:87], a[204:207], v[236:239], v[84:87]
    ds_read_b128 v[236:239], v253 offset:17408
    v_accvgpr_read_b32 v204, a104
    v_mfma_f32_16x16x32_bf16 v[84:87], a[216:219], v[228:231], v[84:87]
    buffer_load_dwordx4 a[196:199], v254, s[8:11], s42 offen offset:1024 sc1
    v_mfma_f32_16x16x32_bf16 v[88:91], a[220:223], v[228:231], v[88:91]
    s_waitcnt vmcnt(12) lgkmcnt(1)
    v_accvgpr_read_b32 v205, a105
    v_accvgpr_read_b32 v206, a106
    v_mfma_f32_16x16x32_bf16 v[92:95], a[224:227], v[228:231], v[92:95]
    ds_read_b128 v[228:231], v253 offset:17152
    v_accvgpr_read_b32 v207, a107
    v_fma_f32 v208, v204, s34, v104 div:2
sub25:
    v_mfma_f32_16x16x32_bf16 v[0:3], a[228:231], v[232:235], v[0:3]
    buffer_load_dwordx4 a[200:203], v254, s[8:11], s42 offen offset:2048 sc1
    v_mfma_f32_16x16x32_bf16 v[4:7], a[232:235], v[232:235], v[4:7]
    s_mov_b32 s42, 998400
    v_fma_f32 v209, v205, s34, v105 div:2
    v_fma_f32 v210, v206, s34, v106 div:2
    v_mfma_f32_16x16x32_bf16 v[8:11], a[236:239], v[232:235], v[8:11]
    ds_read_b128 v[232:235], v253 offset:16896
    s_waitcnt vmcnt(10)
    s_waitcnt lgkmcnt(2)
    v_mfma_f32_16x16x32_bf16 v[8:11], a[248:251], v[236:239], v[8:11]
    v_fma_f32 v211, v207, s34, v107 div:2
    v_fma_f32 v104, v204, s35, v104 mul:2
    v_mfma_f32_16x16x32_bf16 v[4:7], a[244:247], v[236:239], v[4:7]
    buffer_load_dwordx4 a[204:207], v254, s[8:11], s42 offen offset:0 sc1
    v_mfma_f32_16x16x32_bf16 v[0:3], a[240:243], v[236:239], v[0:3]
    s_waitcnt vmcnt(8) lgkmcnt(1)
    v_fma_f32 v105, v205, s35, v105 mul:2
    v_fma_f32 v106, v206, s35, v106 mul:2
    v_mfma_f32_16x16x32_bf16 v[0:3], a[252:255], v[228:231], v[0:3]
    s_add_u32 s44, s40, 394240
    v_fma_f32 v107, v207, s35, v107 mul:2
    v_cvt_pk_bf16_f32 v202, v208, v209
    v_mfma_f32_16x16x32_bf16 v[4:7], v[240:243], v[228:231], v[4:7]
    v_cvt_pk_bf16_f32 v203, v210, v211
    v_accvgpr_write_b32 a4, v202
    v_mfma_f32_16x16x32_bf16 v[8:11], v[244:247], v[228:231], v[8:11]
    buffer_load_dwordx4 a[208:211], v254, s[8:11], s42 offen offset:1024 sc1
    v_mfma_f32_16x16x32_bf16 v[12:15], a[228:231], v[236:239], v[12:15]
    v_accvgpr_write_b32 a5, v203
    v_accvgpr_read_b32 v204, a108
    v_accvgpr_read_b32 v205, a109
    v_mfma_f32_16x16x32_bf16 v[12:15], a[240:243], v[228:231], v[12:15]
    s_waitcnt lgkmcnt(0)
    v_accvgpr_read_b32 v206, a110
    v_accvgpr_read_b32 v207, a111
    v_mfma_f32_16x16x32_bf16 v[12:15], a[252:255], v[232:235], v[12:15]
    v_fma_f32 v208, v204, s34, v108 div:2
    v_fma_f32 v209, v205, s34, v109 div:2
    v_mfma_f32_16x16x32_bf16 v[16:19], v[240:243], v[232:235], v[16:19]
    buffer_load_dwordx4 a[212:215], v254, s[8:11], s42 offen offset:2048 sc1
    v_mfma_f32_16x16x32_bf16 v[16:19], a[244:247], v[228:231], v[16:19]
    s_mov_b32 s42, 1001472
    v_fma_f32 v210, v206, s34, v110 div:2
    v_fma_f32 v211, v207, s34, v111 div:2
    v_mfma_f32_16x16x32_bf16 v[16:19], a[232:235], v[236:239], v[16:19]
    v_fma_f32 v108, v204, s35, v108 mul:2
    v_fma_f32 v109, v205, s35, v109 mul:2
    v_mfma_f32_16x16x32_bf16 v[20:23], a[236:239], v[236:239], v[20:23]
    ds_read_b128 v[236:239], v253 offset:16640
    v_fma_f32 v110, v206, s35, v110 mul:2
    v_mfma_f32_16x16x32_bf16 v[20:23], a[248:251], v[228:231], v[20:23]
    buffer_load_dwordx4 a[216:219], v254, s[8:11], s42 offen offset:0 sc1
    v_mfma_f32_16x16x32_bf16 v[20:23], v[244:247], v[232:235], v[20:23]
    v_fma_f32 v111, v207, s35, v111 mul:2
    v_cvt_pk_bf16_f32 v192, v208, v209
    v_mfma_f32_16x16x32_bf16 v[24:27], a[228:231], v[228:231], v[24:27]
    v_cvt_pk_bf16_f32 v193, v210, v211
    v_accvgpr_write_b32 a12, v192
    v_mfma_f32_16x16x32_bf16 v[24:27], a[240:243], v[232:235], v[24:27]
    s_waitcnt lgkmcnt(0)
    v_accvgpr_write_b32 a13, v193
    v_accvgpr_read_b32 v204, a112
    v_accvgpr_read_b32 v205, a113
    v_mfma_f32_16x16x32_bf16 v[24:27], a[252:255], v[236:239], v[24:27]
    ds_read_b128 a[84:87], v250 offset:7232
    v_accvgpr_read_b32 v206, a114
    v_mfma_f32_16x16x32_bf16 v[28:31], v[240:243], v[236:239], v[28:31]
    buffer_load_dwordx4 a[220:223], v254, s[8:11], s42 offen offset:1024 sc1
    v_mfma_f32_16x16x32_bf16 v[28:31], a[244:247], v[232:235], v[28:31]
    v_accvgpr_read_b32 v207, a115
    v_fma_f32 v208, v204, s34, v112 div:2
    v_mfma_f32_16x16x32_bf16 v[28:31], a[232:235], v[228:231], v[28:31]
    v_fma_f32 v209, v205, s34, v113 div:2
    v_fma_f32 v210, v206, s34, v114 div:2
    v_mfma_f32_16x16x32_bf16 v[32:35], a[236:239], v[228:231], v[32:35]
    ds_read_b128 v[228:231], v253 offset:18464
    v_fma_f32 v211, v207, s34, v115 div:2
    v_mfma_f32_16x16x32_bf16 v[32:35], a[248:251], v[232:235], v[32:35]
    buffer_load_dwordx4 a[224:227], v254, s[8:11], s42 offen offset:2048 sc1
    v_mfma_f32_16x16x32_bf16 v[32:35], v[244:247], v[236:239], v[32:35]
    ds_read_b128 a[88:91], v250 offset:10336
    v_fma_f32 v112, v204, s35, v112 mul:2
    v_mfma_f32_16x16x32_bf16 v[36:39], a[228:231], v[232:235], v[36:39]
    v_fma_f32 v113, v205, s35, v113 mul:2
    v_fma_f32 v114, v206, s35, v114 mul:2
    v_mfma_f32_16x16x32_bf16 v[36:39], a[240:243], v[236:239], v[36:39]
    s_waitcnt lgkmcnt(1)
    v_fma_f32 v115, v207, s35, v115 mul:2
    v_cvt_pk_bf16_f32 v194, v208, v209
    v_mfma_f32_16x16x32_bf16 v[36:39], a[252:255], v[228:231], v[36:39]
    buffer_store_dwordx4 v[212:215], v254, s[12:15], s44 offen nt
    s_add_u32 s44, s40, 397312
    v_cvt_pk_bf16_f32 v195, v210, v211
    v_mfma_f32_16x16x32_bf16 v[40:43], v[240:243], v[228:231], v[40:43]
    v_accvgpr_write_b32 a14, v194
    v_accvgpr_write_b32 a15, v195
    v_mfma_f32_16x16x32_bf16 v[40:43], a[244:247], v[236:239], v[40:43]
    v_accvgpr_read_b32 v204, a116
    v_accvgpr_read_b32 v205, a117
    v_mfma_f32_16x16x32_bf16 v[40:43], a[232:235], v[232:235], v[40:43]
    buffer_store_dwordx4 v[216:219], v254, s[12:15], s44 offen nt
    v_accvgpr_read_b32 v206, a118
    v_accvgpr_read_b32 v207, a119
    v_mfma_f32_16x16x32_bf16 v[44:47], a[236:239], v[232:235], v[44:47]
    ds_read_b128 v[232:235], v253 offset:18208
    v_fma_f32 v208, v204, s34, v116 div:2
    v_mfma_f32_16x16x32_bf16 v[44:47], a[248:251], v[236:239], v[44:47]
    ds_read_b128 a[92:95], v250 offset:2048
    v_fma_f32 v209, v205, s34, v117 div:2
    v_mfma_f32_16x16x32_bf16 v[44:47], v[244:247], v[228:231], v[44:47]
    v_fma_f32 v210, v206, s34, v118 div:2
    v_fma_f32 v211, v207, s34, v119 div:2
    v_mfma_f32_16x16x32_bf16 v[48:51], a[228:231], v[236:239], v[48:51]
    v_fma_f32 v116, v204, s35, v116 mul:2
    v_fma_f32 v117, v205, s35, v117 mul:2
    v_mfma_f32_16x16x32_bf16 v[48:51], a[240:243], v[228:231], v[48:51]
    s_waitcnt lgkmcnt(1)
    s_add_u32 s44, s40, 400384
    v_fma_f32 v118, v206, s35, v118 mul:2
    v_mfma_f32_16x16x32_bf16 v[48:51], a[252:255], v[232:235], v[48:51]
    v_fma_f32 v119, v207, s35, v119 mul:2
    v_cvt_pk_bf16_f32 v196, v208, v209
    v_mfma_f32_16x16x32_bf16 v[52:55], v[240:243], v[232:235], v[52:55]
    ds_read_b128 a[96:99], v250 offset:5152
    v_cvt_pk_bf16_f32 v197, v210, v211
    v_accvgpr_write_b32 a16, v196
    v_mfma_f32_16x16x32_bf16 v[52:55], a[244:247], v[228:231], v[52:55]
    v_accvgpr_write_b32 a17, v197
    v_accvgpr_read_b32 v204, a120
    v_mfma_f32_16x16x32_bf16 v[52:55], a[232:235], v[236:239], v[52:55]
    v_accvgpr_read_b32 v205, a121
    v_accvgpr_read_b32 v206, a122
    v_mfma_f32_16x16x32_bf16 v[56:59], a[236:239], v[236:239], v[56:59]
    ds_read_b128 v[236:239], v253 offset:17952
    v_mfma_f32_16x16x32_bf16 v[56:59], a[248:251], v[228:231], v[56:59]
    v_accvgpr_read_b32 v207, a123
    v_fma_f32 v208, v204, s34, v120 div:2
    v_mfma_f32_16x16x32_bf16 v[56:59], v[244:247], v[232:235], v[56:59]
    v_fma_f32 v209, v205, s34, v121 div:2
    v_fma_f32 v210, v206, s34, v122 div:2
    v_mfma_f32_16x16x32_bf16 v[60:63], a[228:231], v[228:231], v[60:63]
    v_fma_f32 v211, v207, s34, v123 div:2
    v_fma_f32 v120, v204, s35, v120 mul:2
    v_mfma_f32_16x16x32_bf16 v[60:63], a[240:243], v[232:235], v[60:63]
    s_waitcnt lgkmcnt(0)
    v_fma_f32 v121, v205, s35, v121 mul:2
    v_fma_f32 v122, v206, s35, v122 mul:2
    v_mfma_f32_16x16x32_bf16 v[60:63], a[252:255], v[236:239], v[60:63]
    ds_read_b128 a[100:103], v250 offset:8256
    v_fma_f32 v123, v207, s35, v123 mul:2
    v_mfma_f32_16x16x32_bf16 v[64:67], v[240:243], v[236:239], v[64:67]
    buffer_store_dwordx4 a[84:87], v254, s[12:15], s44 offen nt
    v_cvt_pk_bf16_f32 v198, v208, v209
    v_cvt_pk_bf16_f32 v199, v210, v211
    v_mfma_f32_16x16x32_bf16 v[64:67], a[244:247], v[232:235], v[64:67]
    v_accvgpr_read_b32 v204, a28
    v_accvgpr_read_b32 v205, a29
    v_accvgpr_read_b32 v206, a30
    v_mfma_f32_16x16x32_bf16 v[64:67], a[232:235], v[228:231], v[64:67]
    v_accvgpr_read_b32 v207, a31
    v_accvgpr_read_b32 v208, a124
    v_mfma_f32_16x16x32_bf16 v[68:71], a[236:239], v[228:231], v[68:71]
    ds_read_b128 v[228:231], v253 offset:17696
    v_accvgpr_read_b32 v209, a125
    v_mfma_f32_16x16x32_bf16 v[68:71], a[248:251], v[232:235], v[68:71]
    ds_read_b128 a[104:107], v250 offset:11360
    s_add_u32 s44, s40, 403456
    v_mfma_f32_16x16x32_bf16 v[68:71], v[244:247], v[236:239], v[68:71]
    v_accvgpr_read_b32 v210, a126
    v_accvgpr_read_b32 v211, a127
    v_mfma_f32_16x16x32_bf16 v[72:75], a[228:231], v[232:235], v[72:75]
    v_sub_f32 v204, v204, v208
    v_sub_f32 v205, v205, v209
    v_mfma_f32_16x16x32_bf16 v[72:75], a[240:243], v[236:239], v[72:75]
    s_waitcnt lgkmcnt(1)
    v_sub_f32 v206, v206, v210
    v_sub_f32 v207, v207, v211
    v_mfma_f32_16x16x32_bf16 v[72:75], a[252:255], v[228:231], v[72:75]
    v_fma_f32 v208, v204, s34, v124 div:2
    v_fma_f32 v209, v205, s34, v125 div:2
    v_mfma_f32_16x16x32_bf16 v[76:79], v[240:243], v[228:231], v[76:79]
    v_fma_f32 v210, v206, s34, v126 div:2
    v_fma_f32 v211, v207, s34, v127 div:2
    v_mfma_f32_16x16x32_bf16 v[76:79], a[244:247], v[236:239], v[76:79]
    v_fma_f32 v124, v204, s35, v124 mul:2
    v_fma_f32 v125, v205, s35, v125 mul:2
    v_mfma_f32_16x16x32_bf16 v[76:79], a[232:235], v[232:235], v[76:79]
    v_fma_f32 v126, v206, s35, v126 mul:2
    v_fma_f32 v127, v207, s35, v127 mul:2
    v_cvt_pk_bf16_f32 v200, v208, v209
    v_mfma_f32_16x16x32_bf16 v[80:83], a[236:239], v[232:235], v[80:83]
    ds_read_b128 v[232:235], v253 offset:17424
    v_cvt_pk_bf16_f32 v201, v210, v211
    v_mfma_f32_16x16x32_bf16 v[80:83], a[248:251], v[236:239], v[80:83]
    v_accvgpr_read_b32 v204, a32
    v_accvgpr_read_b32 v205, a33
    v_mfma_f32_16x16x32_bf16 v[80:83], v[244:247], v[228:231], v[80:83]
    s_mov_b32 s42, 1032192
    v_accvgpr_read_b32 v206, a34
    v_accvgpr_read_b32 v207, a35
    v_mfma_f32_16x16x32_bf16 v[84:87], a[228:231], v[236:239], v[84:87]
    s_waitcnt lgkmcnt(0)
    v_accvgpr_read_b32 v208, a128
    v_accvgpr_read_b32 v209, a129
    v_mfma_f32_16x16x32_bf16 v[88:91], a[232:235], v[236:239], v[88:91]
    s_barrier
    v_mfma_f32_16x16x32_bf16 v[92:95], a[236:239], v[236:239], v[92:95]
    ds_read_b128 v[236:239], v253 offset:19760
    v_accvgpr_read_b32 v210, a130
    v_mfma_f32_16x16x32_bf16 v[92:95], a[248:251], v[228:231], v[92:95]
    buffer_load_dwordx4 a[228:231], v254, s[8:11], s42 offen offset:0 sc1
    v_mfma_f32_16x16x32_bf16 v[88:91], a[244:247], v[228:231], v[88:91]
    v_accvgpr_read_b32 v211, a131
    v_sub_f32 v204, v204, v208
    v_mfma_f32_16x16x32_bf16 v[84:87], a[240:243], v[228:231], v[84:87]
    ds_read_b128 v[228:231], v253 offset:19488
    v_sub_f32 v205, v205, v209
    v_mfma_f32_16x16x32_bf16 v[84:87], a[252:255], v[232:235], v[84:87]
    buffer_load_dwordx4 a[232:235], v254, s[8:11], s42 offen offset:1024 sc1
    v_sub_f32 v206, v206, v210
    v_mfma_f32_16x16x32_bf16 v[88:91], v[240:243], v[232:235], v[88:91]
    s_waitcnt vmcnt(11) lgkmcnt(1)
    v_sub_f32 v207, v207, v211
    v_fma_f32 v208, v204, s34, v128 div:2
    v_mfma_f32_16x16x32_bf16 v[92:95], v[244:247], v[232:235], v[92:95]
    ds_read_b128 v[232:235], v253 offset:19232
    v_fma_f32 v209, v205, s34, v129 div:2
sub26:
    v_mfma_f32_16x16x32_bf16 v[0:3], a[192:195], v[236:239], v[0:3]
    buffer_load_dwordx4 a[236:239], v254, s[8:11], s42 offen offset:2048 sc1
    v_mfma_f32_16x16x32_bf16 v[4:7], a[196:199], v[236:239], v[4:7]
    s_mov_b32 s42, 1035264
    v_fma_f32 v210, v206, s34, v130 div:2
    v_fma_f32 v211, v207, s34, v131 div:2
    v_mfma_f32_16x16x32_bf16 v[8:11], a[200:203], v[236:239], v[8:11]
    ds_read_b128 v[236:239], v253 offset:18976
    s_waitcnt vmcnt(9)
    s_waitcnt lgkmcnt(2)
    v_mfma_f32_16x16x32_bf16 v[8:11], a[212:215], v[228:231], v[8:11]
    ds_write_b128 v248, a[0:3] offset:0
    v_mfma_f32_16x16x32_bf16 v[4:7], a[208:211], v[228:231], v[4:7]
    buffer_load_dwordx4 a[240:243], v254, s[8:11], s42 offen offset:0 sc1
    v_mfma_f32_16x16x32_bf16 v[0:3], a[204:207], v[228:231], v[0:3]
    s_waitcnt vmcnt(7) lgkmcnt(2)
    v_fma_f32 v128, v204, s35, v128 mul:2
    v_fma_f32 v129, v205, s35, v129 mul:2
    v_mfma_f32_16x16x32_bf16 v[0:3], a[216:219], v[232:235], v[0:3]
    v_fma_f32 v130, v206, s35, v130 mul:2
    v_fma_f32 v131, v207, s35, v131 mul:2
    v_mfma_f32_16x16x32_bf16 v[4:7], a[220:223], v[232:235], v[4:7]
    ds_write_b64 v249, a[4:5] offset:64
    v_cvt_pk_bf16_f32 v202, v208, v209
    v_mfma_f32_16x16x32_bf16 v[8:11], a[224:227], v[232:235], v[8:11]
    buffer_load_dwordx4 a[244:247], v254, s[8:11], s42 offen offset:1024 sc1
    v_mfma_f32_16x16x32_bf16 v[12:15], a[192:195], v[228:231], v[12:15]
    ds_write_b128 v248, v[198:201] offset:768
    v_mfma_f32_16x16x32_bf16 v[12:15], a[204:207], v[232:235], v[12:15]
    s_waitcnt lgkmcnt(3)
    v_cvt_pk_bf16_f32 v203, v210, v211
    v_accvgpr_read_b32 v204, a36
    v_mfma_f32_16x16x32_bf16 v[12:15], a[216:219], v[236:239], v[12:15]
    v_accvgpr_read_b32 v205, a37
    v_accvgpr_read_b32 v206, a38
    v_mfma_f32_16x16x32_bf16 v[16:19], a[220:223], v[236:239], v[16:19]
    buffer_load_dwordx4 a[248:251], v254, s[8:11], s42 offen offset:2048 sc1
    v_mfma_f32_16x16x32_bf16 v[16:19], a[208:211], v[232:235], v[16:19]
    s_mov_b32 s42, 1038336
    v_accvgpr_read_b32 v207, a39
    v_accvgpr_read_b32 v208, a132
    v_mfma_f32_16x16x32_bf16 v[16:19], a[196:199], v[228:231], v[16:19]
    ds_write_b128 v248, a[12:15] offset:384
    v_mfma_f32_16x16x32_bf16 v[20:23], a[200:203], v[228:231], v[20:23]
    ds_read_b128 v[228:231], v253 offset:18720
    v_accvgpr_read_b32 v209, a133
    v_mfma_f32_16x16x32_bf16 v[20:23], a[212:215], v[232:235], v[20:23]
    buffer_load_dwordx4 a[252:255], v254, s[8:11], s42 offen offset:0 sc1
    v_mfma_f32_16x16x32_bf16 v[20:23], a[224:227], v[236:239], v[20:23]
    v_accvgpr_read_b32 v210, a134
    v_accvgpr_read_b32 v211, a135
    v_sub_f32 v204, v204, v208
    v_mfma_f32_16x16x32_bf16 v[24:27], a[192:195], v[232:235], v[24:27]
    ds_write_b64 v249, v[202:203] offset:832
    v_mfma_f32_16x16x32_bf16 v[24:27], a[204:207], v[236:239], v[24:27]
    s_waitcnt lgkmcnt(1)
    v_sub_f32 v205, v205, v209
    v_sub_f32 v206, v206, v210
    v_mfma_f32_16x16x32_bf16 v[24:27], a[216:219], v[228:231], v[24:27]
    v_sub_f32 v207, v207, v211
    v_fma_f32 v208, v204, s34, v132 div:2
    v_mfma_f32_16x16x32_bf16 v[28:31], a[220:223], v[228:231], v[28:31]
    buffer_load_dwordx4 v[240:243], v254, s[8:11], s42 offen offset:1024 sc1
    v_mfma_f32_16x16x32_bf16 v[28:31], a[208:211], v[236:239], v[28:31]
    ds_write_b64 v249, a[16:17] offset:448
    v_mfma_f32_16x16x32_bf16 v[28:31], a[196:199], v[232:235], v[28:31]
    v_fma_f32 v209, v205, s34, v133 div:2
    v_fma_f32 v210, v206, s34, v134 div:2
    v_mfma_f32_16x16x32_bf16 v[32:35], a[200:203], v[232:235], v[32:35]
    ds_read_b128 v[232:235], v253 offset:20544
    v_fma_f32 v211, v207, s34, v135 div:2
    v_mfma_f32_16x16x32_bf16 v[32:35], a[212:215], v[236:239], v[32:35]
    buffer_load_dwordx4 v[244:247], v254, s[8:11], s42 offen offset:2048 sc1
    v_mfma_f32_16x16x32_bf16 v[32:35], a[224:227], v[228:231], v[32:35]
    v_fma_f32 v132, v204, s35, v132 mul:2
    v_fma_f32 v133, v205, s35, v133 mul:2
    v_mfma_f32_16x16x32_bf16 v[36:39], a[192:195], v[236:239], v[36:39]
    v_fma_f32 v134, v206, s35, v134 mul:2
    v_fma_f32 v135, v207, s35, v135 mul:2
    v_cvt_pk_bf16_f32 v192, v208, v209
    v_mfma_f32_16x16x32_bf16 v[36:39], a[204:207], v[228:231], v[36:39]
    s_waitcnt lgkmcnt(0)
    v_cvt_pk_bf16_f32 v193, v210, v211
    v_accvgpr_read_b32 v204, a40
    v_mfma_f32_16x16x32_bf16 v[36:39], a[216:219], v[232:235], v[36:39]
    buffer_store_dwordx4 a[88:91], v254, s[12:15], s44 offen nt
    s_add_u32 s44, s40, 395264
    v_mfma_f32_16x16x32_bf16 v[40:43], a[220:223], v[232:235], v[40:43]
    v_accvgpr_read_b32 v205, a41
    v_accvgpr_read_b32 v206, a42
    v_mfma_f32_16x16x32_bf16 v[40:43], a[208:211], v[228:231], v[40:43]
    v_accvgpr_read_b32 v207, a43
    v_accvgpr_read_b32 v208, a136
    v_mfma_f32_16x16x32_bf16 v[40:43], a[196:199], v[236:239], v[40:43]
    buffer_store_dwordx4 a[92:95], v254, s[12:15], s44 offen nt
    s_add_u32 s44, s40, 398336
    v_mfma_f32_16x16x32_bf16 v[44:47], a[200:203], v[236:239], v[44:47]
    ds_read_b128 v[236:239], v253 offset:20288
    v_accvgpr_read_b32 v209, a137
    v_mfma_f32_16x16x32_bf16 v[44:47], a[212:215], v[228:231], v[44:47]
    v_accvgpr_read_b32 v210, a138
    v_accvgpr_read_b32 v211, a139
    v_mfma_f32_16x16x32_bf16 v[44:47], a[224:227], v[232:235], v[44:47]
    buffer_store_dwordx4 a[96:99], v254, s[12:15], s44 offen nt
    s_add_u32 s44, s40, 401408
    v_mfma_f32_16x16x32_bf16 v[48:51], a[192:195], v[228:231], v[48:51]
    v_sub_f32 v204, v204, v208
    v_sub_f32 v205, v205, v209
    v_mfma_f32_16x16x32_bf16 v[48:51], a[204:207], v[232:235], v[48:51]
    s_waitcnt lgkmcnt(0)
    v_sub_f32 v206, v206, v210
    v_sub_f32 v207, v207, v211
    v_fma_f32 v208, v204, s34, v136 div:2
    v_mfma_f32_16x16x32_bf16 v[48:51], a[216:219], v[236:239], v[48:51]
    buffer_store_dwordx4 a[100:103], v254, s[12:15], s44 offen nt
    v_fma_f32 v209, v205, s34, v137 div:2
    v_fma_f32 v210, v206, s34, v138 div:2
    v_mfma_f32_16x16x32_bf16 v[52:55], a[220:223], v[236:239], v[52:55]
    v_fma_f32 v211, v207, s34, v139 div:2
    v_fma_f32 v136, v204, s35, v136 mul:2
    v_mfma_f32_16x16x32_bf16 v[52:55], a[208:211], v[232:235], v[52:55]
    v_fma_f32 v137, v205, s35, v137 mul:2
    v_fma_f32 v138, v206, s35, v138 mul:2
    v_mfma_f32_16x16x32_bf16 v[52:55], a[196:199], v[228:231], v[52:55]
    v_fma_f32 v139, v207, s35, v139 mul:2
    v_cvt_pk_bf16_f32 v194, v208, v209
    v_mfma_f32_16x16x32_bf16 v[56:59], a[200:203], v[228:231], v[56:59]
    ds_read_b128 v[228:231], v253 offset:20032
    s_add_u32 s44, s40, 404480
    v_mfma_f32_16x16x32_bf16 v[56:59], a[212:215], v[232:235], v[56:59]
pad10:
    s_cbranch_vccnz warm_ret
    v_cvt_pk_bf16_f32 v195, v210, v211
    v_accvgpr_read_b32 v204, a44
    v_mfma_f32_16x16x32_bf16 v[56:59], a[224:227], v[236:239], v[56:59]
    ds_write_b128 v248, v[192:195] offset:1152
    v_mfma_f32_16x16x32_bf16 v[60:63], a[192:195], v[232:235], v[60:63]
    v_accvgpr_read_b32 v205, a45
    v_accvgpr_read_b32 v206, a46
    v_mfma_f32_16x16x32_bf16 v[60:63], a[204:207], v[236:239], v[60:63]
    s_waitcnt lgkmcnt(1)
    v_accvgpr_read_b32 v207, a47
    v_accvgpr_read_b32 v208, a140
    v_mfma_f32_16x16x32_bf16 v[60:63], a[216:219], v[228:231], v[60:63]
    v_accvgpr_read_b32 v209, a141
    v_accvgpr_read_b32 v210, a142
    v_accvgpr_read_b32 v211, a143
    v_mfma_f32_16x16x32_bf16 v[64:67], a[220:223], v[228:231], v[64:67]
    v_sub_f32 v204, v204, v208
    v_sub_f32 v205, v205, v209
    v_mfma_f32_16x16x32_bf16 v[64:67], a[208:211], v[236:239], v[64:67]
    v_sub_f32 v206, v206, v210
    v_sub_f32 v207, v207, v211
    v_mfma_f32_16x16x32_bf16 v[64:67], a[196:199], v[232:235], v[64:67]
    v_fma_f32 v208, v204, s34, v140 div:2
    v_fma_f32 v209, v205, s34, v141 div:2
    v_mfma_f32_16x16x32_bf16 v[68:71], a[200:203], v[232:235], v[68:71]
    ds_read_b128 v[232:235], v253 offset:19776
    v_fma_f32 v210, v206, s34, v142 div:2
    v_mfma_f32_16x16x32_bf16 v[68:71], a[212:215], v[236:239], v[68:71]
    v_fma_f32 v211, v207, s34, v143 div:2
    v_fma_f32 v140, v204, s35, v140 mul:2
    v_mfma_f32_16x16x32_bf16 v[68:71], a[224:227], v[228:231], v[68:71]
    buffer_store_dwordx4 a[104:107], v254, s[12:15], s44 offen nt
    v_fma_f32 v141, v205, s35, v141 mul:2
    v_fma_f32 v142, v206, s35, v142 mul:2
    v_mfma_f32_16x16x32_bf16 v[72:75], a[192:195], v[236:239], v[72:75]
    v_fma_f32 v143, v207, s35, v143 mul:2
    v_cvt_pk_bf16_f32 v196, v208, v209
    v_mfma_f32_16x16x32_bf16 v[72:75], a[204:207], v[228:231], v[72:75]
    s_waitcnt lgkmcnt(0)
    v_cvt_pk_bf16_f32 v197, v210, v211
    v_accvgpr_read_b32 v204, a48
    v_mfma_f32_16x16x32_bf16 v[72:75], a[216:219], v[232:235], v[72:75]
    ds_write_b64 v249, v[196:197] offset:1216
    v_mfma_f32_16x16x32_bf16 v[76:79], a[220:223], v[232:235], v[76:79]
    v_accvgpr_read_b32 v205, a49
    v_accvgpr_read_b32 v206, a50
    v_accvgpr_read_b32 v207, a51
    v_mfma_f32_16x16x32_bf16 v[76:79], a[208:211], v[228:231], v[76:79]
    v_accvgpr_read_b32 v208, a144
    v_accvgpr_read_b32 v209, a145
    v_mfma_f32_16x16x32_bf16 v[76:79], a[196:199], v[236:239], v[76:79]
    v_accvgpr_read_b32 v210, a146
    v_accvgpr_read_b32 v211, a147
    v_mfma_f32_16x16x32_bf16 v[80:83], a[200:203], v[236:239], v[80:83]
    ds_read_b128 v[236:239], v253 offset:19504
    v_sub_f32 v204, v204, v208
    v_mfma_f32_16x16x32_bf16 v[80:83], a[212:215], v[228:231], v[80:83]
    v_sub_f32 v205, v205, v209
    v_sub_f32 v206, v206, v210
    v_mfma_f32_16x16x32_bf16 v[80:83], a[224:227], v[232:235], v[80:83]
    s_mov_b32 s42, 1069056
    v_sub_f32 v207, v207, v211
    v_fma_f32 v208, v204, s34, v144 div:2
    v_mfma_f32_16x16x32_bf16 v[84:87], a[192:195], v[228:231], v[84:87]
    s_waitcnt lgkmcnt(0)
    v_fma_f32 v209, v205, s34, v145 div:2
    v_fma_f32 v210, v206, s34, v146 div:2
    v_mfma_f32_16x16x32_bf16 v[88:91], a[196:199], v[228:231], v[88:91]
    s_barrier
    v_mfma_f32_16x16x32_bf16 v[92:95], a[200:203], v[228:231], v[92:95]
    ds_read_b128 v[228:231], v253 offset:21840
    v_fma_f32 v211, v207, s34, v147 div:2
    v_mfma_f32_16x16x32_bf16 v[92:95], a[212:215], v[232:235], v[92:95]
    buffer_load_dwordx4 a[192:195], v254, s[8:11], s42 offen offset:0 sc1
    v_mfma_f32_16x16x32_bf16 v[88:91], a[208:211], v[232:235], v[88:91]
    v_fma_f32 v144, v204, s35, v144 mul:2
    v_fma_f32 v145, v205, s35, v145 mul:2
    v_fma_f32 v146, v206, s35, v146 mul:2
    v_mfma_f32_16x16x32_bf16 v[84:87], a[204:207], v[232:235], v[84:87]
    ds_read_b128 v[232:235], v253 offset:21568
    v_fma_f32 v147, v207, s35, v147 mul:2
    v_mfma_f32_16x16x32_bf16 v[84:87], a[216:219], v[236:239], v[84:87]
    buffer_load_dwordx4 a[196:199], v254, s[8:11], s42 offen offset:1024 sc1
    v_mfma_f32_16x16x32_bf16 v[88:91], a[220:223], v[236:239], v[88:91]
    s_waitcnt vmcnt(13) lgkmcnt(1)
    v_cvt_pk_bf16_f32 v198, v208, v209
    v_cvt_pk_bf16_f32 v199, v210, v211
    v_mfma_f32_16x16x32_bf16 v[92:95], a[224:227], v[236:239], v[92:95]
    ds_read_b128 v[236:239], v253 offset:21312
    v_accvgpr_read_b32 v204, a52
sub27:
    v_mfma_f32_16x16x32_bf16 v[0:3], a[228:231], v[228:231], v[0:3]
    buffer_load_dwordx4 a[200:203], v254, s[8:11], s42 offen offset:2048 sc1
    v_mfma_f32_16x16x32_bf16 v[4:7], a[232:235], v[228:231], v[4:7]
    s_mov_b32 s42, 1072128
    s_add_u32 s44, s40, 196608
    v_accvgpr_read_b32 v205, a53
    v_mfma_f32_16x16x32_bf16 v[8:11], a[236:239], v[228:231], v[8:11]
    ds_read_b128 v[228:231], v253 offset:21056
    s_waitcnt vmcnt(11)
    s_waitcnt lgkmcnt(2)
    v_mfma_f32_16x16x32_bf16 v[8:11], a[248:251], v[232:235], v[8:11]
    ds_read_b128 a[108:111], v250 offset:0
    v_accvgpr_read_b32 v206, a54
    v_mfma_f32_16x16x32_bf16 v[4:7], a[244:247], v[232:235], v[4:7]
    buffer_load_dwordx4 a[204:207], v254, s[8:11], s42 offen offset:0 sc1
    v_mfma_f32_16x16x32_bf16 v[0:3], a[240:243], v[232:235], v[0:3]
    s_waitcnt vmcnt(9) lgkmcnt(2)
    v_accvgpr_read_b32 v207, a55
    v_accvgpr_read_b32 v208, a148
    v_accvgpr_read_b32 v209, a149
    v_mfma_f32_16x16x32_bf16 v[0:3], a[252:255], v[236:239], v[0:3]
    ds_read_b128 a[112:115], v250 offset:3104
    v_accvgpr_read_b32 v210, a150
    v_mfma_f32_16x16x32_bf16 v[4:7], v[240:243], v[236:239], v[4:7]
    v_accvgpr_read_b32 v211, a151
    v_sub_f32 v204, v204, v208
    v_mfma_f32_16x16x32_bf16 v[8:11], v[244:247], v[236:239], v[8:11]
    buffer_load_dwordx4 a[208:211], v254, s[8:11], s42 offen offset:1024 sc1
    v_mfma_f32_16x16x32_bf16 v[12:15], a[228:231], v[232:235], v[12:15]
    s_waitcnt lgkmcnt(1)
    v_sub_f32 v205, v205, v209
    v_sub_f32 v206, v206, v210
    v_mfma_f32_16x16x32_bf16 v[12:15], a[240:243], v[236:239], v[12:15]
    v_sub_f32 v207, v207, v211
    v_fma_f32 v208, v204, s34, v148 div:2
    v_mfma_f32_16x16x32_bf16 v[12:15], a[252:255], v[228:231], v[12:15]
    v_fma_f32 v209, v205, s34, v149 div:2
    v_fma_f32 v210, v206, s34, v150 div:2
    v_mfma_f32_16x16x32_bf16 v[16:19], v[240:243], v[228:231], v[16:19]
    buffer_load_dwordx4 a[212:215], v254, s[8:11], s42 offen offset:2048 sc1
    v_mfma_f32_16x16x32_bf16 v[16:19], a[244:247], v[236:239], v[16:19]
    s_mov_b32 s42, 1075200
    v_fma_f32 v211, v207, s34, v151 div:2
    v_fma_f32 v148, v204, s35, v148 mul:2
    v_mfma_f32_16x16x32_bf16 v[16:19], a[232:235], v[232:235], v[16:19]
    ds_read_b128 a[116:119], v250 offset:6208
    v_fma_f32 v149, v205, s35, v149 mul:2
    v_mfma_f32_16x16x32_bf16 v[20:23], a[236:239], v[232:235], v[20:23]
    ds_read_b128 v[232:235], v253 offset:20800
    v_fma_f32 v150, v206, s35, v150 mul:2
    v_fma_f32 v151, v207, s35, v151 mul:2
    v_mfma_f32_16x16x32_bf16 v[20:23], a[248:251], v[236:239], v[20:23]
    buffer_load_dwordx4 a[216:219], v254, s[8:11], s42 offen offset:0 sc1
    v_mfma_f32_16x16x32_bf16 v[20:23], v[244:247], v[228:231], v[20:23]
    v_cvt_pk_bf16_f32 v200, v208, v209
    v_cvt_pk_bf16_f32 v201, v210, v211
    v_mfma_f32_16x16x32_bf16 v[24:27], a[228:231], v[236:239], v[24:27]
    ds_write_b128 v248, v[198:201] offset:1536
    v_mfma_f32_16x16x32_bf16 v[24:27], a[240:243], v[228:231], v[24:27]
    s_waitcnt lgkmcnt(1)
    v_accvgpr_read_b32 v204, a56
    v_accvgpr_read_b32 v205, a57
    v_mfma_f32_16x16x32_bf16 v[24:27], a[252:255], v[232:235], v[24:27]
    v_accvgpr_read_b32 v206, a58
    v_accvgpr_read_b32 v207, a59
    v_mfma_f32_16x16x32_bf16 v[28:31], v[240:243], v[232:235], v[28:31]
    buffer_load_dwordx4 a[220:223], v254, s[8:11], s42 offen offset:1024 sc1
    v_mfma_f32_16x16x32_bf16 v[28:31], a[244:247], v[228:231], v[28:31]
    ds_read_b128 a[120:123], v250 offset:9312
    v_accvgpr_read_b32 v208, a152
    v_mfma_f32_16x16x32_bf16 v[28:31], a[232:235], v[236:239], v[28:31]
    v_accvgpr_read_b32 v209, a153
    v_accvgpr_read_b32 v210, a154
    v_mfma_f32_16x16x32_bf16 v[32:35], a[236:239], v[236:239], v[32:35]
    ds_read_b128 v[236:239], v253 offset:22624
    v_accvgpr_read_b32 v211, a155
    v_mfma_f32_16x16x32_bf16 v[32:35], a[248:251], v[228:231], v[32:35]
    buffer_load_dwordx4 a[224:227], v254, s[8:11], s42 offen offset:2048 sc1
    v_sub_f32 v204, v204, v208
    v_mfma_f32_16x16x32_bf16 v[32:35], v[244:247], v[232:235], v[32:35]
    v_sub_f32 v205, v205, v209
    v_sub_f32 v206, v206, v210
    v_mfma_f32_16x16x32_bf16 v[36:39], a[228:231], v[228:231], v[36:39]
    v_sub_f32 v207, v207, v211
    v_fma_f32 v208, v204, s34, v152 div:2
    v_mfma_f32_16x16x32_bf16 v[36:39], a[240:243], v[232:235], v[36:39]
    s_waitcnt lgkmcnt(0)
    v_fma_f32 v209, v205, s34, v153 div:2
    v_fma_f32 v210, v206, s34, v154 div:2
    v_mfma_f32_16x16x32_bf16 v[36:39], a[252:255], v[236:239], v[36:39]
    buffer_store_dwordx4 a[108:111], v254, s[12:15], s44 offen nt
    s_add_u32 s44, s40, 199680
    v_fma_f32 v211, v207, s34, v155 div:2
    v_mfma_f32_16x16x32_bf16 v[40:43], v[240:243], v[236:239], v[40:43]
    v_fma_f32 v152, v204, s35, v152 mul:2
    v_fma_f32 v153, v205, s35, v153 mul:2
    v_mfma_f32_16x16x32_bf16 v[40:43], a[244:247], v[232:235], v[40:43]
    v_fma_f32 v154, v206, s35, v154 mul:2
    v_fma_f32 v155, v207, s35, v155 mul:2
    v_mfma_f32_16x16x32_bf16 v[40:43], a[232:235], v[228:231], v[40:43]
    v_cvt_pk_bf16_f32 v202, v208, v209
    v_cvt_pk_bf16_f32 v203, v210, v211
    v_mfma_f32_16x16x32_bf16 v[44:47], a[236:239], v[228:231], v[44:47]
    ds_read_b128 v[228:231], v253 offset:22368
    v_mfma_f32_16x16x32_bf16 v[44:47], a[248:251], v[232:235], v[44:47]
    ds_write_b64 v249, v[202:203] offset:1600
    v_mfma_f32_16x16x32_bf16 v[44:47], v[244:247], v[236:239], v[44:47]
    v_accvgpr_read_b32 v204, a60
    v_accvgpr_read_b32 v205, a61
    v_accvgpr_read_b32 v206, a62
    v_mfma_f32_16x16x32_bf16 v[48:51], a[228:231], v[232:235], v[48:51]
    v_accvgpr_read_b32 v207, a63
    v_accvgpr_read_b32 v208, a156
    v_mfma_f32_16x16x32_bf16 v[48:51], a[240:243], v[236:239], v[48:51]
    s_waitcnt lgkmcnt(1)
    v_accvgpr_read_b32 v209, a157
    v_accvgpr_read_b32 v210, a158
    v_mfma_f32_16x16x32_bf16 v[48:51], a[252:255], v[228:231], v[48:51]
    v_accvgpr_read_b32 v211, a159
    v_sub_f32 v204, v204, v208
    v_mfma_f32_16x16x32_bf16 v[52:55], v[240:243], v[228:231], v[52:55]
    v_sub_f32 v205, v205, v209
    v_sub_f32 v206, v206, v210
    v_mfma_f32_16x16x32_bf16 v[52:55], a[244:247], v[236:239], v[52:55]
    v_sub_f32 v207, v207, v211
    v_fma_f32 v208, v204, s34, v156 div:2
    v_mfma_f32_16x16x32_bf16 v[52:55], a[232:235], v[232:235], v[52:55]
    buffer_store_dwordx4 a[112:115], v254, s[12:15], s44 offen nt
    v_fma_f32 v209, v205, s34, v157 div:2
    v_fma_f32 v210, v206, s34, v158 div:2
    v_mfma_f32_16x16x32_bf16 v[56:59], a[236:239], v[232:235], v[56:59]
    ds_read_b128 v[232:235], v253 offset:22112
    v_fma_f32 v211, v207, s34, v159 div:2
    v_mfma_f32_16x16x32_bf16 v[56:59], a[248:251], v[236:239], v[56:59]
    v_fma_f32 v156, v204, s35, v156 mul:2
    v_fma_f32 v157, v205, s35, v157 mul:2
    v_mfma_f32_16x16x32_bf16 v[56:59], v[244:247], v[228:231], v[56:59]
    v_fma_f32 v158, v206, s35, v158 mul:2
    v_fma_f32 v159, v207, s35, v159 mul:2
    v_mfma_f32_16x16x32_bf16 v[60:63], a[228:231], v[236:239], v[60:63]
    v_cvt_pk_bf16_f32 v192, v208, v209
    v_cvt_pk_bf16_f32 v193, v210, v211
    v_accvgpr_read_b32 v204, a64
    v_mfma_f32_16x16x32_bf16 v[60:63], a[240:243], v[228:231], v[60:63]
    s_waitcnt lgkmcnt(0)
    v_accvgpr_read_b32 v205, a65
    v_accvgpr_read_b32 v206, a66
    v_mfma_f32_16x16x32_bf16 v[60:63], a[252:255], v[232:235], v[60:63]
    v_accvgpr_read_b32 v207, a67
    v_accvgpr_read_b32 v208, a160
    v_mfma_f32_16x16x32_bf16 v[64:67], v[240:243], v[232:235], v[64:67]
    v_accvgpr_read_b32 v209, a161
    v_accvgpr_read_b32 v210, a162
    v_mfma_f32_16x16x32_bf16 v[64:67], a[244:247], v[228:231], v[64:67]
    v_accvgpr_read_b32 v211, a163
    v_sub_f32 v204, v204, v208
    v_mfma_f32_16x16x32_bf16 v[64:67], a[232:235], v[236:239], v[64:67]
    s_add_u32 s44, s40, 202752
    v_sub_f32 v205, v205, v209
    v_sub_f32 v206, v206, v210
    v_mfma_f32_16x16x32_bf16 v[68:71], a[236:239], v[236:239], v[68:71]
    ds_read_b128 v[236:239], v253 offset:21856
    v_sub_f32 v207, v207, v211
    v_mfma_f32_16x16x32_bf16 v[68:71], a[248:251], v[228:231], v[68:71]
    v_fma_f32 v208, v204, s34, v160 div:2
    v_fma_f32 v209, v205, s34, v161 div:2
    v_mfma_f32_16x16x32_bf16 v[68:71], v[244:247], v[232:235], v[68:71]
    v_fma_f32 v210, v206, s34, v162 div:2
    v_fma_f32 v211, v207, s34, v163 div:2
    v_mfma_f32_16x16x32_bf16 v[72:75], a[228:231], v[228:231], v[72:75]
    v_fma_f32 v160, v204, s35, v160 mul:2
    v_fma_f32 v161, v205, s35, v161 mul:2
    v_mfma_f32_16x16x32_bf16 v[72:75], a[240:243], v[232:235], v[72:75]
    s_waitcnt lgkmcnt(0)
    v_fma_f32 v162, v206, s35, v162 mul:2
    v_fma_f32 v163, v207, s35, v163 mul:2
    v_cvt_pk_bf16_f32 v194, v208, v209
    v_mfma_f32_16x16x32_bf16 v[72:75], a[252:255], v[236:239], v[72:75]
    v_cvt_pk_bf16_f32 v195, v210, v211
    v_accvgpr_read_b32 v204, a68
    v_mfma_f32_16x16x32_bf16 v[76:79], v[240:243], v[236:239], v[76:79]
    ds_write_b128 v248, v[192:195] offset:1920
    v_mfma_f32_16x16x32_bf16 v[76:79], a[244:247], v[232:235], v[76:79]
    v_accvgpr_read_b32 v205, a69
    v_accvgpr_read_b32 v206, a70
    v_mfma_f32_16x16x32_bf16 v[76:79], a[232:235], v[228:231], v[76:79]
    v_accvgpr_read_b32 v207, a71
    v_accvgpr_read_b32 v208, a164
    v_mfma_f32_16x16x32_bf16 v[80:83], a[236:239], v[228:231], v[80:83]
    ds_read_b128 v[228:231], v253 offset:21584
    v_accvgpr_read_b32 v209, a165
    v_mfma_f32_16x16x32_bf16 v[80:83], a[248:251], v[232:235], v[80:83]
    v_accvgpr_read_b32 v210, a166
    v_accvgpr_read_b32 v211, a167
    v_mfma_f32_16x16x32_bf16 v[80:83], v[244:247], v[236:239], v[80:83]
    s_mov_b32 s42, 884736
    v_sub_f32 v204, v204, v208
    v_sub_f32 v205, v205, v209
    v_mfma_f32_16x16x32_bf16 v[84:87], a[228:231], v[232:235], v[84:87]
    v_sub_f32 v206, v206, v210
    v_sub_f32 v207, v207, v211
    v_mfma_f32_16x16x32_bf16 v[88:91], a[232:235], v[232:235], v[88:91]
    v_fma_f32 v208, v204, s34, v164 div:2
    v_fma_f32 v209, v205, s34, v165 div:2
    v_mfma_f32_16x16x32_bf16 v[92:95], a[236:239], v[232:235], v[92:95]
    ds_read_b128 v[232:235], v253 offset:23920
    v_fma_f32 v210, v206, s34, v166 div:2
    v_fma_f32 v211, v207, s34, v167 div:2
    v_mfma_f32_16x16x32_bf16 v[92:95], a[248:251], v[236:239], v[92:95]
    buffer_load_dwordx4 a[228:231], v254, s[8:11], s42 offen offset:0 sc1
    v_mfma_f32_16x16x32_bf16 v[88:91], a[244:247], v[236:239], v[88:91]
    s_waitcnt lgkmcnt(1)
    v_fma_f32 v164, v204, s35, v164 mul:2
    v_fma_f32 v165, v205, s35, v165 mul:2
    v_mfma_f32_16x16x32_bf16 v[84:87], a[240:243], v[236:239], v[84:87]
    ds_read_b128 v[236:239], v253 offset:23648
    v_fma_f32 v166, v206, s35, v166 mul:2
    v_mfma_f32_16x16x32_bf16 v[84:87], a[252:255], v[228:231], v[84:87]
    buffer_load_dwordx4 a[232:235], v254, s[8:11], s42 offen offset:1024 sc1
    v_mfma_f32_16x16x32_bf16 v[88:91], v[240:243], v[228:231], v[88:91]
    s_waitcnt vmcnt(10) lgkmcnt(1)
    v_fma_f32 v167, v207, s35, v167 mul:2
    v_cvt_pk_bf16_f32 v196, v208, v209
    v_mfma_f32_16x16x32_bf16 v[92:95], v[244:247], v[228:231], v[92:95]
    ds_read_b128 v[228:231], v253 offset:23392
    v_cvt_pk_bf16_f32 v197, v210, v211
sub28:
    v_mfma_f32_16x16x32_bf16 v[0:3], a[192:195], v[232:235], v[0:3]
    buffer_load_dwordx4 a[236:239], v254, s[8:11], s42 offen offset:2048 sc1
    v_mfma_f32_16x16x32_bf16 v[4:7], a[196:199], v[232:235], v[4:7]
    s_mov_b32 s42, 887808
    v_accvgpr_read_b32 v204, a72
    v_accvgpr_read_b32 v205, a73
    v_mfma_f32_16x16x32_bf16 v[8:11], a[200:203], v[232:235], v[8:11]
    ds_read_b128 v[232:235], v253 offset:23136
    s_waitcnt vmcnt(8)
    s_waitcnt lgkmcnt(2)
    v_mfma_f32_16x16x32_bf16 v[8:11], a[212:215], v[236:239], v[8:11]
    ds_write_b64 v249, v[196:197] offset:1984
    v_accvgpr_read_b32 v206, a74
    v_mfma_f32_16x16x32_bf16 v[4:7], a[208:211], v[236:239], v[4:7]
    buffer_load_dwordx4 a[240:243], v254, s[8:11], s42 offen offset:0 sc1
    v_mfma_f32_16x16x32_bf16 v[0:3], a[204:207], v[236:239], v[0:3]
    s_waitcnt vmcnt(6) lgkmcnt(2)
    v_accvgpr_read_b32 v207, a75
    v_accvgpr_read_b32 v208, a168
    v_mfma_f32_16x16x32_bf16 v[0:3], a[216:219], v[228:231], v[0:3]
    v_accvgpr_read_b32 v209, a169
    v_accvgpr_read_b32 v210, a170
    v_mfma_f32_16x16x32_bf16 v[4:7], a[220:223], v[228:231], v[4:7]
    v_accvgpr_read_b32 v211, a171
    v_sub_f32 v204, v204, v208
    v_mfma_f32_16x16x32_bf16 v[8:11], a[224:227], v[228:231], v[8:11]
    buffer_load_dwordx4 a[244:247], v254, s[8:11], s42 offen offset:1024 sc1
    v_mfma_f32_16x16x32_bf16 v[12:15], a[192:195], v[236:239], v[12:15]
    v_sub_f32 v205, v205, v209
    v_sub_f32 v206, v206, v210
    v_mfma_f32_16x16x32_bf16 v[12:15], a[204:207], v[228:231], v[12:15]
    s_waitcnt lgkmcnt(1)
    v_sub_f32 v207, v207, v211
    v_fma_f32 v208, v204, s34, v168 div:2
    v_mfma_f32_16x16x32_bf16 v[12:15], a[216:219], v[232:235], v[12:15]
    v_fma_f32 v209, v205, s34, v169 div:2
    v_fma_f32 v210, v206, s34, v170 div:2
    v_mfma_f32_16x16x32_bf16 v[16:19], a[220:223], v[232:235], v[16:19]
    buffer_load_dwordx4 a[248:251], v254, s[8:11], s42 offen offset:2048 sc1
    v_mfma_f32_16x16x32_bf16 v[16:19], a[208:211], v[228:231], v[16:19]
    s_mov_b32 s42, 890880
    v_fma_f32 v211, v207, s34, v171 div:2
    v_fma_f32 v168, v204, s35, v168 mul:2
    v_fma_f32 v169, v205, s35, v169 mul:2
    v_mfma_f32_16x16x32_bf16 v[16:19], a[196:199], v[236:239], v[16:19]
    v_fma_f32 v170, v206, s35, v170 mul:2
    v_fma_f32 v171, v207, s35, v171 mul:2
    v_mfma_f32_16x16x32_bf16 v[20:23], a[200:203], v[236:239], v[20:23]
    ds_read_b128 v[236:239], v253 offset:22880
    v_cvt_pk_bf16_f32 v198, v208, v209
    v_mfma_f32_16x16x32_bf16 v[20:23], a[212:215], v[228:231], v[20:23]
    buffer_load_dwordx4 a[252:255], v254, s[8:11], s42 offen offset:0 sc1
    v_mfma_f32_16x16x32_bf16 v[20:23], a[224:227], v[232:235], v[20:23]
    v_cvt_pk_bf16_f32 v199, v210, v211
    v_accvgpr_read_b32 v204, a76
    v_mfma_f32_16x16x32_bf16 v[24:27], a[192:195], v[228:231], v[24:27]
    v_accvgpr_read_b32 v205, a77
    v_accvgpr_read_b32 v206, a78
    v_mfma_f32_16x16x32_bf16 v[24:27], a[204:207], v[232:235], v[24:27]
    s_waitcnt lgkmcnt(0)
    v_accvgpr_read_b32 v207, a79
    v_accvgpr_read_b32 v208, a172
    v_mfma_f32_16x16x32_bf16 v[24:27], a[216:219], v[236:239], v[24:27]
    v_accvgpr_read_b32 v209, a173
    v_accvgpr_read_b32 v210, a174
    v_mfma_f32_16x16x32_bf16 v[28:31], a[220:223], v[236:239], v[28:31]
    buffer_load_dwordx4 v[240:243], v254, s[8:11], s42 offen offset:1024 sc1
    v_mfma_f32_16x16x32_bf16 v[28:31], a[208:211], v[232:235], v[28:31]
    v_accvgpr_read_b32 v211, a175
    v_sub_f32 v204, v204, v208
    v_mfma_f32_16x16x32_bf16 v[28:31], a[196:199], v[228:231], v[28:31]
    v_sub_f32 v205, v205, v209
    v_sub_f32 v206, v206, v210
    v_sub_f32 v207, v207, v211
    v_mfma_f32_16x16x32_bf16 v[32:35], a[200:203], v[228:231], v[32:35]
    ds_read_b128 v[228:231], v253 offset:24704
    v_fma_f32 v208, v204, s34, v172 div:2
    v_mfma_f32_16x16x32_bf16 v[32:35], a[212:215], v[232:235], v[32:35]
    buffer_load_dwordx4 v[244:247], v254, s[8:11], s42 offen offset:2048 sc1
    v_mfma_f32_16x16x32_bf16 v[32:35], a[224:227], v[236:239], v[32:35]
    v_fma_f32 v209, v205, s34, v173 div:2
    v_fma_f32 v210, v206, s34, v174 div:2
    v_mfma_f32_16x16x32_bf16 v[36:39], a[192:195], v[232:235], v[36:39]
    v_fma_f32 v211, v207, s34, v175 div:2
    v_fma_f32 v172, v204, s35, v172 mul:2
    v_mfma_f32_16x16x32_bf16 v[36:39], a[204:207], v[236:239], v[36:39]
    s_waitcnt lgkmcnt(0)
    v_fma_f32 v173, v205, s35, v173 mul:2
    v_fma_f32 v174, v206, s35, v174 mul:2
    v_mfma_f32_16x16x32_bf16 v[36:39], a[216:219], v[228:231], v[36:39]
    buffer_store_dwordx4 a[116:119], v254, s[12:15], s44 offen nt
    s_add_u32 s44, s40, 205824
    v_mfma_f32_16x16x32_bf16 v[40:43], a[220:223], v[228:231], v[40:43]
    v_fma_f32 v175, v207, s35, v175 mul:2
    v_cvt_pk_bf16_f32 v200, v208, v209
    v_mfma_f32_16x16x32_bf16 v[40:43], a[208:211], v[236:239], v[40:43]
    v_cvt_pk_bf16_f32 v201, v210, v211
    v_accvgpr_read_b32 v204, a80
    v_mfma_f32_16x16x32_bf16 v[40:43], a[196:199], v[232:235], v[40:43]
    buffer_store_dwordx4 a[120:123], v254, s[12:15], s44 offen nt
    s_add_u32 s44, s40, 197632
    v_accvgpr_read_b32 v205, a81
    v_mfma_f32_16x16x32_bf16 v[44:47], a[200:203], v[232:235], v[44:47]
    ds_read_b128 v[232:235], v253 offset:24448
    v_accvgpr_read_b32 v206, a82
    v_accvgpr_read_b32 v207, a83
    v_mfma_f32_16x16x32_bf16 v[44:47], a[212:215], v[236:239], v[44:47]
    ds_write_b128 v248, v[198:201] offset:2304
    v_mfma_f32_16x16x32_bf16 v[44:47], a[224:227], v[228:231], v[44:47]
    v_accvgpr_read_b32 v208, a176
    v_accvgpr_read_b32 v209, a177
    v_mfma_f32_16x16x32_bf16 v[48:51], a[192:195], v[236:239], v[48:51]
    v_accvgpr_read_b32 v210, a178
    v_accvgpr_read_b32 v211, a179
    v_mfma_f32_16x16x32_bf16 v[48:51], a[204:207], v[228:231], v[48:51]
    s_waitcnt lgkmcnt(1)
    v_sub_f32 v204, v204, v208
    v_sub_f32 v205, v205, v209
    v_mfma_f32_16x16x32_bf16 v[48:51], a[216:219], v[232:235], v[48:51]
    v_sub_f32 v206, v206, v210
    v_sub_f32 v207, v207, v211
    v_mfma_f32_16x16x32_bf16 v[52:55], a[220:223], v[232:235], v[52:55]
    v_fma_f32 v208, v204, s34, v176 div:2
    v_fma_f32 v209, v205, s34, v177 div:2
    v_mfma_f32_16x16x32_bf16 v[52:55], a[208:211], v[228:231], v[52:55]
    v_fma_f32 v210, v206, s34, v178 div:2
    v_fma_f32 v211, v207, s34, v179 div:2
    v_mfma_f32_16x16x32_bf16 v[52:55], a[196:199], v[236:239], v[52:55]
    v_fma_f32 v176, v204, s35, v176 mul:2
    v_fma_f32 v177, v205, s35, v177 mul:2
    v_mfma_f32_16x16x32_bf16 v[56:59], a[200:203], v[236:239], v[56:59]
    ds_read_b128 v[236:239], v253 offset:24192
    v_fma_f32 v178, v206, s35, v178 mul:2
    v_mfma_f32_16x16x32_bf16 v[56:59], a[212:215], v[228:231], v[56:59]
    v_fma_f32 v179, v207, s35, v179 mul:2
    v_cvt_pk_bf16_f32 v202, v208, v209
    v_cvt_pk_bf16_f32 v203, v210, v211
    v_mfma_f32_16x16x32_bf16 v[56:59], a[224:227], v[232:235], v[56:59]
    ds_write_b64 v249, v[202:203] offset:2368
    v_mfma_f32_16x16x32_bf16 v[60:63], a[192:195], v[228:231], v[60:63]
    v_accvgpr_read_b32 v204, a180
    v_accvgpr_read_b32 v205, a181
    v_mfma_f32_16x16x32_bf16 v[60:63], a[204:207], v[232:235], v[60:63]
    s_waitcnt lgkmcnt(1)
    v_accvgpr_read_b32 v206, a182
    v_accvgpr_read_b32 v207, a183
    v_mfma_f32_16x16x32_bf16 v[60:63], a[216:219], v[236:239], v[60:63]
    v_fma_f32 v208, v204, s34, v180 div:2
    v_fma_f32 v209, v205, s34, v181 div:2
    v_mfma_f32_16x16x32_bf16 v[64:67], a[220:223], v[236:239], v[64:67]
    v_fma_f32 v210, v206, s34, v182 div:2
    v_fma_f32 v211, v207, s34, v183 div:2
    v_mfma_f32_16x16x32_bf16 v[64:67], a[208:211], v[232:235], v[64:67]
    v_fma_f32 v180, v204, s35, v180 mul:2
    v_fma_f32 v181, v205, s35, v181 mul:2
    v_mfma_f32_16x16x32_bf16 v[64:67], a[196:199], v[228:231], v[64:67]
    v_fma_f32 v182, v206, s35, v182 mul:2
    v_fma_f32 v183, v207, s35, v183 mul:2
    v_mfma_f32_16x16x32_bf16 v[68:71], a[200:203], v[228:231], v[68:71]
    ds_read_b128 v[228:231], v253 offset:23936
    v_cvt_pk_bf16_f32 v192, v208, v209
    v_mfma_f32_16x16x32_bf16 v[68:71], a[212:215], v[232:235], v[68:71]
    v_cvt_pk_bf16_f32 v193, v210, v211
    v_accvgpr_read_b32 v204, a184
    v_mfma_f32_16x16x32_bf16 v[68:71], a[224:227], v[236:239], v[68:71]
    v_accvgpr_read_b32 v205, a185
    v_accvgpr_read_b32 v206, a186
    v_accvgpr_read_b32 v207, a187
    v_mfma_f32_16x16x32_bf16 v[72:75], a[192:195], v[232:235], v[72:75]
    v_fma_f32 v208, v204, s34, v184 div:2
    v_fma_f32 v209, v205, s34, v185 div:2
    v_mfma_f32_16x16x32_bf16 v[72:75], a[204:207], v[236:239], v[72:75]
    s_waitcnt lgkmcnt(0)
    v_fma_f32 v210, v206, s34, v186 div:2
    v_fma_f32 v211, v207, s34, v187 div:2
    v_mfma_f32_16x16x32_bf16 v[72:75], a[216:219], v[228:231], v[72:75]
    v_fma_f32 v184, v204, s35, v184 mul:2
    v_fma_f32 v185, v205, s35, v185 mul:2
    v_mfma_f32_16x16x32_bf16 v[76:79], a[220:223], v[228:231], v[76:79]
    v_fma_f32 v186, v206, s35, v186 mul:2
    v_fma_f32 v187, v207, s35, v187 mul:2
    v_mfma_f32_16x16x32_bf16 v[76:79], a[208:211], v[236:239], v[76:79]
    v_cvt_pk_bf16_f32 v194, v208, v209
    v_cvt_pk_bf16_f32 v195, v210, v211
    v_mfma_f32_16x16x32_bf16 v[76:79], a[196:199], v[232:235], v[76:79]
    ds_write_b128 v248, v[192:195] offset:2688
    v_mfma_f32_16x16x32_bf16 v[80:83], a[200:203], v[232:235], v[80:83]
    ds_read_b128 v[232:235], v253 offset:23664
    v_accvgpr_read_b32 v204, a188
    v_mfma_f32_16x16x32_bf16 v[80:83], a[212:215], v[236:239], v[80:83]
    v_accvgpr_read_b32 v205, a189
    v_accvgpr_read_b32 v206, a190
    v_mfma_f32_16x16x32_bf16 v[80:83], a[224:227], v[228:231], v[80:83]
    s_mov_b32 s42, 1105920
    v_accvgpr_read_b32 v207, a191
    v_fma_f32 v208, v204, s34, v188 div:2
    v_mfma_f32_16x16x32_bf16 v[84:87], a[192:195], v[236:239], v[84:87]
    s_waitcnt lgkmcnt(0)
    v_fma_f32 v209, v205, s34, v189 div:2
    v_fma_f32 v210, v206, s34, v190 div:2
    v_fma_f32 v211, v207, s34, v191 div:2
    v_mfma_f32_16x16x32_bf16 v[88:91], a[196:199], v[236:239], v[88:91]
    s_barrier
    v_mfma_f32_16x16x32_bf16 v[92:95], a[200:203], v[236:239], v[92:95]
    ds_read_b128 v[236:239], v253 offset:34320
    v_fma_f32 v188, v204, s35, v188 mul:2
    v_mfma_f32_16x16x32_bf16 v[92:95], a[212:215], v[228:231], v[92:95]
    buffer_load_dwordx4 a[192:195], v254, s[8:11], s42 offen offset:0 sc1
    v_mfma_f32_16x16x32_bf16 v[88:91], a[208:211], v[228:231], v[88:91]
    v_fma_f32 v189, v205, s35, v189 mul:2
    v_fma_f32 v190, v206, s35, v190 mul:2
    v_mfma_f32_16x16x32_bf16 v[84:87], a[204:207], v[228:231], v[84:87]
    ds_read_b128 v[228:231], v253 offset:34048
    v_fma_f32 v191, v207, s35, v191 mul:2
    v_mfma_f32_16x16x32_bf16 v[84:87], a[216:219], v[232:235], v[84:87]
    buffer_load_dwordx4 a[196:199], v254, s[8:11], s42 offen offset:1024 sc1
    v_mfma_f32_16x16x32_bf16 v[88:91], a[220:223], v[232:235], v[88:91]
    s_waitcnt vmcnt(10) lgkmcnt(1)
    v_cvt_pk_bf16_f32 v196, v208, v209
    v_cvt_pk_bf16_f32 v197, v210, v211
    v_mfma_f32_16x16x32_bf16 v[92:95], a[224:227], v[232:235], v[92:95]
    ds_read_b128 v[232:235], v253 offset:33792
sub29:
    v_mfma_f32_16x16x32_bf16 v[0:3], a[228:231], v[236:239], v[0:3]
    buffer_load_dwordx4 a[200:203], v254, s[8:11], s42 offen offset:2048 sc1
    v_mfma_f32_16x16x32_bf16 v[4:7], a[232:235], v[236:239], v[4:7]
    s_mov_b32 s42, 1108992
    v_mfma_f32_16x16x32_bf16 v[8:11], a[236:239], v[236:239], v[8:11]
    ds_read_b128 v[236:239], v253 offset:33536
    s_waitcnt vmcnt(8)
    s_waitcnt lgkmcnt(2)
    v_mfma_f32_16x16x32_bf16 v[8:11], a[248:251], v[228:231], v[8:11]
pad11:
    s_cbranch_vccnz warm_ret
    ds_read_b128 a[124:127], v250 offset:1024
    v_mfma_f32_16x16x32_bf16 v[4:7], a[244:247], v[228:231], v[4:7]
    buffer_load_dwordx4 a[204:207], v254, s[8:11], s42 offen offset:0 sc1
    v_mfma_f32_16x16x32_bf16 v[0:3], a[240:243], v[228:231], v[0:3]
    s_waitcnt vmcnt(6) lgkmcnt(2)
    v_mfma_f32_16x16x32_bf16 v[0:3], a[252:255], v[232:235], v[0:3]
    ds_write_b64 v249, v[196:197] offset:2752
    v_mfma_f32_16x16x32_bf16 v[4:7], v[240:243], v[232:235], v[4:7]
    ds_read_b128 a[128:131], v250 offset:4128
    v_mfma_f32_16x16x32_bf16 v[8:11], v[244:247], v[232:235], v[8:11]
    buffer_load_dwordx4 a[208:211], v254, s[8:11], s42 offen offset:1024 sc1
    v_mfma_f32_16x16x32_bf16 v[12:15], a[228:231], v[228:231], v[12:15]
    ds_read_b128 a[132:135], v250 offset:7232
    s_waitcnt lgkmcnt(3)
    v_mfma_f32_16x16x32_bf16 v[12:15], a[240:243], v[232:235], v[12:15]
    v_mfma_f32_16x16x32_bf16 v[12:15], a[252:255], v[236:239], v[12:15]
    v_mfma_f32_16x16x32_bf16 v[16:19], v[240:243], v[236:239], v[16:19]
    buffer_load_dwordx4 a[212:215], v254, s[8:11], s42 offen offset:2048 sc1
    v_mfma_f32_16x16x32_bf16 v[16:19], a[244:247], v[232:235], v[16:19]
    s_mov_b32 s42, 1112064
    v_mfma_f32_16x16x32_bf16 v[16:19], a[232:235], v[228:231], v[16:19]
    buffer_store_dwordx4 a[124:127], v254, s[12:15], s44 offen nt
    s_add_u32 s44, s40, 200704
    s_waitcnt lgkmcnt(1)
    v_mfma_f32_16x16x32_bf16 v[20:23], a[236:239], v[228:231], v[20:23]
    ds_read_b128 v[228:231], v253 offset:33280
    v_mfma_f32_16x16x32_bf16 v[20:23], a[248:251], v[232:235], v[20:23]
    buffer_load_dwordx4 a[216:219], v254, s[8:11], s42 offen offset:0 sc1
    v_mfma_f32_16x16x32_bf16 v[20:23], v[244:247], v[236:239], v[20:23]
    ds_read_b128 a[136:139], v250 offset:10336
    v_mfma_f32_16x16x32_bf16 v[24:27], a[228:231], v[232:235], v[24:27]
    buffer_store_dwordx4 a[128:131], v254, s[12:15], s44 offen nt
    s_add_u32 s44, s40, 203776
    s_waitcnt lgkmcnt(2)
    v_mfma_f32_16x16x32_bf16 v[24:27], a[240:243], v[236:239], v[24:27]
    s_waitcnt lgkmcnt(1)
    v_mfma_f32_16x16x32_bf16 v[24:27], a[252:255], v[228:231], v[24:27]
    v_cvt_pk_bf16_f32 v8, v8, v9
    v_cvt_pk_bf16_f32 v9, v10, v11
    v_mfma_f32_16x16x32_bf16 v[28:31], v[240:243], v[228:231], v[28:31]
    buffer_load_dwordx4 a[220:223], v254, s[8:11], s42 offen offset:1024 sc1
    v_mfma_f32_16x16x32_bf16 v[28:31], a[244:247], v[236:239], v[28:31]
    ds_write_b64 v249, v[8:9] offset:12544
    v_mfma_f32_16x16x32_bf16 v[28:31], a[232:235], v[232:235], v[28:31]
    v_cvt_pk_bf16_f32 v0, v0, v1
    v_cvt_pk_bf16_f32 v1, v2, v3
    v_mfma_f32_16x16x32_bf16 v[32:35], a[236:239], v[232:235], v[32:35]
    ds_read_b128 v[232:235], v253 offset:35104
    v_cvt_pk_bf16_f32 v2, v4, v5
    v_mfma_f32_16x16x32_bf16 v[32:35], a[248:251], v[236:239], v[32:35]
    buffer_load_dwordx4 a[224:227], v254, s[8:11], s42 offen offset:2048 sc1
    v_mfma_f32_16x16x32_bf16 v[32:35], v[244:247], v[228:231], v[32:35]
    v_cvt_pk_bf16_f32 v3, v6, v7
    v_mov_b32 v4, v248
    v_mfma_f32_16x16x32_bf16 v[36:39], a[228:231], v[236:239], v[36:39]
    buffer_store_dwordx4 a[132:135], v254, s[12:15], s44 offen nt
    v_and_b32 v227, 0x7fff, v255
    v_mov_b32 v5, v249
    v_mfma_f32_16x16x32_bf16 v[36:39], a[240:243], v[228:231], v[36:39]
    s_waitcnt lgkmcnt(0)
    s_add_u32 s44, s40, 206848
    v_mov_b32 v6, v250
    v_mfma_f32_16x16x32_bf16 v[36:39], a[252:255], v[232:235], v[36:39]
    buffer_load_dwordx2 v[216:217], v227, s[4:7], s16 offen offset:0
    v_mfma_f32_16x16x32_bf16 v[40:43], v[240:243], v[232:235], v[40:43]
    ds_write_b128 v248, v[0:3] offset:12480
    v_mfma_f32_16x16x32_bf16 v[40:43], a[244:247], v[228:231], v[40:43]
    v_cvt_pk_bf16_f32 v20, v20, v21
    v_cvt_pk_bf16_f32 v21, v22, v23
    v_mfma_f32_16x16x32_bf16 v[40:43], a[232:235], v[236:239], v[40:43]
    v_cvt_pk_bf16_f32 v12, v12, v13
    v_cvt_pk_bf16_f32 v13, v14, v15
    v_mfma_f32_16x16x32_bf16 v[44:47], a[236:239], v[236:239], v[44:47]
    ds_read_b128 v[236:239], v253 offset:34848
    v_cvt_pk_bf16_f32 v14, v16, v17
    v_mfma_f32_16x16x32_bf16 v[44:47], a[248:251], v[228:231], v[44:47]
    buffer_load_dwordx2 v[218:219], v227, s[4:7], s17 offen offset:0
    v_mfma_f32_16x16x32_bf16 v[44:47], v[244:247], v[232:235], v[44:47]
    ds_write_b64 v5, v[20:21] offset:12928
    v_mfma_f32_16x16x32_bf16 v[48:51], a[228:231], v[228:231], v[48:51]
    v_cvt_pk_bf16_f32 v15, v18, v19
    v_cvt_pk_bf16_f32 v32, v32, v33
    v_mfma_f32_16x16x32_bf16 v[48:51], a[240:243], v[232:235], v[48:51]
    s_waitcnt lgkmcnt(1)
    v_cvt_pk_bf16_f32 v33, v34, v35
    v_cvt_pk_bf16_f32 v24, v24, v25
    v_mfma_f32_16x16x32_bf16 v[48:51], a[252:255], v[236:239], v[48:51]
    buffer_load_dwordx2 v[220:221], v227, s[4:7], s18 offen offset:0
    v_mfma_f32_16x16x32_bf16 v[52:55], v[240:243], v[236:239], v[52:55]
    ds_write_b128 v4, v[12:15] offset:12864
    v_mfma_f32_16x16x32_bf16 v[52:55], a[244:247], v[232:235], v[52:55]
    v_cvt_pk_bf16_f32 v25, v26, v27
    v_cvt_pk_bf16_f32 v26, v28, v29
    v_mfma_f32_16x16x32_bf16 v[52:55], a[232:235], v[228:231], v[52:55]
    v_cvt_pk_bf16_f32 v27, v30, v31
    v_cvt_pk_bf16_f32 v44, v44, v45
    v_mfma_f32_16x16x32_bf16 v[56:59], a[236:239], v[228:231], v[56:59]
    ds_read_b128 v[228:231], v253 offset:34592
    v_cvt_pk_bf16_f32 v45, v46, v47
    v_mfma_f32_16x16x32_bf16 v[56:59], a[248:251], v[232:235], v[56:59]
    buffer_load_dwordx2 v[222:223], v227, s[4:7], s19 offen offset:0
    v_mfma_f32_16x16x32_bf16 v[56:59], v[244:247], v[236:239], v[56:59]
    ds_write_b64 v5, v[32:33] offset:13312
    v_mfma_f32_16x16x32_bf16 v[60:63], a[228:231], v[232:235], v[60:63]
    v_cvt_pk_bf16_f32 v36, v36, v37
    v_cvt_pk_bf16_f32 v37, v38, v39
    v_mfma_f32_16x16x32_bf16 v[60:63], a[240:243], v[236:239], v[60:63]
    s_waitcnt lgkmcnt(1)
    v_cvt_pk_bf16_f32 v38, v40, v41
    v_cvt_pk_bf16_f32 v39, v42, v43
    v_mfma_f32_16x16x32_bf16 v[60:63], a[252:255], v[228:231], v[60:63]
    buffer_load_dwordx2 v[224:225], v227, s[4:7], s20 offen offset:0
    v_mfma_f32_16x16x32_bf16 v[64:67], v[240:243], v[228:231], v[64:67]
    ds_write_b128 v4, v[24:27] offset:13248
    v_mfma_f32_16x16x32_bf16 v[64:67], a[244:247], v[236:239], v[64:67]
    v_mfma_f32_16x16x32_bf16 v[64:67], a[232:235], v[232:235], v[64:67]
    v_cvt_pk_bf16_f32 v56, v56, v57
    v_cvt_pk_bf16_f32 v57, v58, v59
    v_mfma_f32_16x16x32_bf16 v[68:71], a[236:239], v[232:235], v[68:71]
    ds_read_b128 v[232:235], v253 offset:34336
    v_cvt_pk_bf16_f32 v48, v48, v49
    v_mfma_f32_16x16x32_bf16 v[68:71], a[248:251], v[236:239], v[68:71]
    buffer_load_dwordx2 v[226:227], v227, s[4:7], s21 offen offset:0
    v_mfma_f32_16x16x32_bf16 v[68:71], v[244:247], v[228:231], v[68:71]
    ds_write_b64 v5, v[44:45] offset:13696
    v_mfma_f32_16x16x32_bf16 v[72:75], a[228:231], v[236:239], v[72:75]
    buffer_store_dwordx4 a[136:139], v254, s[12:15], s44 offen nt
    s_add_u32 s44, s40, 198656
    v_cvt_pk_bf16_f32 v49, v50, v51
    v_mfma_f32_16x16x32_bf16 v[72:75], a[240:243], v[228:231], v[72:75]
    s_waitcnt lgkmcnt(1)
    v_cvt_pk_bf16_f32 v50, v52, v53
    v_cvt_pk_bf16_f32 v51, v54, v55
    v_mfma_f32_16x16x32_bf16 v[72:75], a[252:255], v[232:235], v[72:75]
    ds_write_b128 v4, v[36:39] offset:13632
    v_mfma_f32_16x16x32_bf16 v[76:79], v[240:243], v[232:235], v[76:79]
    v_mfma_f32_16x16x32_bf16 v[76:79], a[244:247], v[228:231], v[76:79]
    v_mfma_f32_16x16x32_bf16 v[76:79], a[232:235], v[236:239], v[76:79]
    v_cvt_pk_bf16_f32 v68, v68, v69
    v_cvt_pk_bf16_f32 v69, v70, v71
    v_mfma_f32_16x16x32_bf16 v[80:83], a[236:239], v[236:239], v[80:83]
    ds_read_b128 v[236:239], v253 offset:34064
    v_cvt_pk_bf16_f32 v60, v60, v61
    v_mfma_f32_16x16x32_bf16 v[80:83], a[248:251], v[228:231], v[80:83]
    v_cvt_pk_bf16_f32 v61, v62, v63
    v_cvt_pk_bf16_f32 v62, v64, v65
    v_mfma_f32_16x16x32_bf16 v[80:83], v[244:247], v[232:235], v[80:83]
    s_mov_b32 s42, 1142784
    v_cvt_pk_bf16_f32 v63, v66, v67
    v_mfma_f32_16x16x32_bf16 v[84:87], a[228:231], v[228:231], v[84:87]
    s_waitcnt lgkmcnt(0)
    v_mfma_f32_16x16x32_bf16 v[88:91], a[232:235], v[228:231], v[88:91]
    s_barrier
    v_mfma_f32_16x16x32_bf16 v[92:95], a[236:239], v[228:231], v[92:95]
    ds_read_b128 v[228:231], v253 offset:36400
    v_mfma_f32_16x16x32_bf16 v[92:95], a[248:251], v[232:235], v[92:95]
    buffer_load_dwordx4 a[228:231], v254, s[8:11], s42 offen offset:0 sc1
    v_mfma_f32_16x16x32_bf16 v[88:91], a[244:247], v[232:235], v[88:91]
    v_mfma_f32_16x16x32_bf16 v[84:87], a[240:243], v[232:235], v[84:87]
    ds_read_b128 v[232:235], v253 offset:36128
    v_cvt_pk_bf16_f32 v80, v80, v81
    v_mfma_f32_16x16x32_bf16 v[84:87], a[252:255], v[236:239], v[84:87]
    buffer_load_dwordx4 a[232:235], v254, s[8:11], s42 offen offset:1024 sc1
    v_mfma_f32_16x16x32_bf16 v[88:91], v[240:243], v[236:239], v[88:91]
    s_waitcnt vmcnt(18) lgkmcnt(1)
    v_cvt_pk_bf16_f32 v81, v82, v83
    v_cvt_pk_bf16_f32 v72, v72, v73
    v_mfma_f32_16x16x32_bf16 v[92:95], v[244:247], v[236:239], v[92:95]
    ds_read_b128 v[236:239], v253 offset:35872
    v_cvt_pk_bf16_f32 v73, v74, v75
sub30:
    v_mfma_f32_16x16x32_bf16 v[96:99], a[192:195], v[228:231], v[96:99]
    buffer_load_dwordx4 a[236:239], v254, s[8:11], s42 offen offset:2048 sc1
    v_mfma_f32_16x16x32_bf16 v[100:103], a[196:199], v[228:231], v[100:103]
    s_mov_b32 s42, 1145856
    v_cvt_pk_bf16_f32 v74, v76, v77
    v_cvt_pk_bf16_f32 v75, v78, v79
    v_mfma_f32_16x16x32_bf16 v[104:107], a[200:203], v[228:231], v[104:107]
    ds_read_b128 v[228:231], v253 offset:35616
    s_waitcnt vmcnt(16)
    s_waitcnt lgkmcnt(2)
    v_mfma_f32_16x16x32_bf16 v[104:107], a[212:215], v[232:235], v[104:107]
    ds_read_b128 a[140:143], v6 offset:2048
    v_mfma_f32_16x16x32_bf16 v[100:103], a[208:211], v[232:235], v[100:103]
    buffer_load_dwordx4 a[240:243], v254, s[8:11], s42 offen offset:0 sc1
    v_mfma_f32_16x16x32_bf16 v[96:99], a[204:207], v[232:235], v[96:99]
    s_waitcnt vmcnt(12) lgkmcnt(2)
    v_cvt_pk_bf16_f32 v92, v92, v93
    v_cvt_pk_bf16_f32 v93, v94, v95
    v_mfma_f32_16x16x32_bf16 v[96:99], a[216:219], v[236:239], v[96:99]
    v_cvt_pk_bf16_f32 v84, v84, v85
    v_cvt_pk_bf16_f32 v85, v86, v87
    v_mfma_f32_16x16x32_bf16 v[100:103], a[220:223], v[236:239], v[100:103]
    ds_read_b128 a[144:147], v6 offset:5152
    v_cvt_pk_bf16_f32 v86, v88, v89
    v_mfma_f32_16x16x32_bf16 v[104:107], a[224:227], v[236:239], v[104:107]
    buffer_load_dwordx4 a[244:247], v254, s[8:11], s42 offen offset:1024 sc1
    v_mfma_f32_16x16x32_bf16 v[108:111], a[192:195], v[232:235], v[108:111]
    s_waitcnt lgkmcnt(1)
    v_cvt_pk_bf16_f32 v87, v90, v91
    v_mfma_f32_16x16x32_bf16 v[108:111], a[204:207], v[236:239], v[108:111]
    v_mfma_f32_16x16x32_bf16 v[108:111], a[216:219], v[228:231], v[108:111]
    ds_write_b64 v5, v[56:57] offset:14080
    v_mfma_f32_16x16x32_bf16 v[112:115], a[220:223], v[228:231], v[112:115]
    buffer_load_dwordx4 a[248:251], v254, s[8:11], s42 offen offset:2048 sc1
    v_mfma_f32_16x16x32_bf16 v[112:115], a[208:211], v[236:239], v[112:115]
    s_mov_b32 s42, 1148928
    v_mfma_f32_16x16x32_bf16 v[112:115], a[196:199], v[232:235], v[112:115]
    buffer_store_dwordx4 a[140:143], v254, s[12:15], s44 offen nt
    s_add_u32 s44, s40, 201728
    s_waitcnt lgkmcnt(1)
    v_mfma_f32_16x16x32_bf16 v[116:119], a[200:203], v[232:235], v[116:119]
    ds_read_b128 v[232:235], v253 offset:35360
    v_mfma_f32_16x16x32_bf16 v[116:119], a[212:215], v[236:239], v[116:119]
    buffer_load_dwordx4 a[252:255], v254, s[8:11], s42 offen offset:0 sc1
    v_mfma_f32_16x16x32_bf16 v[116:119], a[224:227], v[228:231], v[116:119]
    ds_read_b128 a[148:151], v6 offset:8256
    v_mfma_f32_16x16x32_bf16 v[120:123], a[192:195], v[236:239], v[120:123]
    v_mfma_f32_16x16x32_bf16 v[120:123], a[204:207], v[228:231], v[120:123]
    s_waitcnt lgkmcnt(1)
    v_mfma_f32_16x16x32_bf16 v[120:123], a[216:219], v[232:235], v[120:123]
    ds_write_b128 v4, v[48:51] offset:14016
    v_mfma_f32_16x16x32_bf16 v[124:127], a[220:223], v[232:235], v[124:127]
    buffer_load_dwordx4 v[240:243], v254, s[8:11], s42 offen offset:1024 sc1
    v_mfma_f32_16x16x32_bf16 v[124:127], a[208:211], v[228:231], v[124:127]
    ds_read_b128 a[152:155], v6 offset:11360
    v_mfma_f32_16x16x32_bf16 v[124:127], a[196:199], v[236:239], v[124:127]
    v_mfma_f32_16x16x32_bf16 v[128:131], a[200:203], v[236:239], v[128:131]
    ds_read_b128 v[236:239], v253 offset:37184
    v_mfma_f32_16x16x32_bf16 v[128:131], a[212:215], v[228:231], v[128:131]
    buffer_load_dwordx4 v[244:247], v254, s[8:11], s42 offen offset:2048 sc1
    v_mfma_f32_16x16x32_bf16 v[128:131], a[224:227], v[232:235], v[128:131]
    ds_write_b64 v5, v[68:69] offset:14464
    v_mfma_f32_16x16x32_bf16 v[132:135], a[192:195], v[228:231], v[132:135]
    buffer_store_dwordx4 a[144:147], v254, s[12:15], s44 offen nt
    v_and_b32 v203, 0x7fff, v255
    s_waitcnt vmcnt(12)
    v_mfma_f32_16x16x32_bf16 v[132:135], a[204:207], v[232:235], v[132:135]
    s_waitcnt lgkmcnt(1)
    v_lshlrev_b32 v248, 16, v218
    v_lshlrev_b32 v249, 16, v220
    v_mfma_f32_16x16x32_bf16 v[132:135], a[216:219], v[236:239], v[132:135]
    buffer_load_dwordx2 v[192:193], v203, s[4:7], s16 offen offset:384
    v_mfma_f32_16x16x32_bf16 v[136:139], a[220:223], v[236:239], v[136:139]
    s_add_u32 s44, s40, 204800
    v_lshlrev_b32 v250, 16, v222
    v_lshlrev_b32 v251, 16, v224
    v_mfma_f32_16x16x32_bf16 v[136:139], a[208:211], v[232:235], v[136:139]
    ds_write_b128 v4, v[60:63] offset:14400
    v_mfma_f32_16x16x32_bf16 v[136:139], a[196:199], v[228:231], v[136:139]
    v_and_b32 v218, s22, v218
    v_and_b32 v220, s22, v220
    v_mfma_f32_16x16x32_bf16 v[140:143], a[200:203], v[228:231], v[140:143]
    ds_read_b128 v[228:231], v253 offset:36928
    v_and_b32 v222, s22, v222
    v_mfma_f32_16x16x32_bf16 v[140:143], a[212:215], v[232:235], v[140:143]
    buffer_load_dwordx2 v[194:195], v203, s[4:7], s17 offen offset:384
    v_mfma_f32_16x16x32_bf16 v[140:143], a[224:227], v[236:239], v[140:143]
    ds_write_b64 v5, v[80:81] offset:14848
    v_mfma_f32_16x16x32_bf16 v[144:147], a[192:195], v[232:235], v[144:147]
    v_and_b32 v224, s22, v224
    v_lshlrev_b32 v252, 16, v216
    v_mfma_f32_16x16x32_bf16 v[144:147], a[204:207], v[236:239], v[144:147]
    s_waitcnt lgkmcnt(1)
    v_and_b32 v216, s22, v216
    v_fmac_f32 v252, s25, v251
    v_mfma_f32_16x16x32_bf16 v[144:147], a[216:219], v[228:231], v[144:147]
    buffer_load_dwordx2 v[196:197], v203, s[4:7], s18 offen offset:384
    v_mfma_f32_16x16x32_bf16 v[148:151], a[220:223], v[228:231], v[148:151]
    v_fmac_f32 v216, s25, v224
    v_fmac_f32 v252, s28, v249
    v_mfma_f32_16x16x32_bf16 v[148:151], a[208:211], v[236:239], v[148:151]
    ds_write_b128 v4, v[72:75] offset:14784
    v_mfma_f32_16x16x32_bf16 v[148:151], a[196:199], v[232:235], v[148:151]
    v_fmac_f32 v216, s28, v220
    v_cvt_pk_bf16_f32 v216, v252, v216
    v_mfma_f32_16x16x32_bf16 v[152:155], a[200:203], v[232:235], v[152:155]
    ds_read_b128 v[232:235], v253 offset:36672
    v_lshlrev_b32 v252, 16, v226
    v_mfma_f32_16x16x32_bf16 v[152:155], a[212:215], v[236:239], v[152:155]
    buffer_load_dwordx2 v[198:199], v203, s[4:7], s19 offen offset:384
    v_mfma_f32_16x16x32_bf16 v[152:155], a[224:227], v[228:231], v[152:155]
    ds_write_b64 v5, v[92:93] offset:15232
    v_mfma_f32_16x16x32_bf16 v[156:159], a[192:195], v[236:239], v[156:159]
    v_and_b32 v226, s22, v226
    v_fmac_f32 v252, s29, v248
    v_mfma_f32_16x16x32_bf16 v[156:159], a[204:207], v[228:231], v[156:159]
    s_waitcnt lgkmcnt(1)
    v_fmac_f32 v226, s29, v218
    v_fmac_f32 v252, s23, v250
    v_mfma_f32_16x16x32_bf16 v[156:159], a[216:219], v[232:235], v[156:159]
    buffer_load_dwordx2 v[200:201], v203, s[4:7], s20 offen offset:384
    v_mfma_f32_16x16x32_bf16 v[160:163], a[220:223], v[232:235], v[160:163]
    ds_write_b128 v4, v[84:87] offset:15168
    v_mfma_f32_16x16x32_bf16 v[160:163], a[208:211], v[228:231], v[160:163]
    v_fmac_f32 v226, s23, v222
    v_cvt_pk_bf16_f32 v226, v252, v226
    v_mfma_f32_16x16x32_bf16 v[160:163], a[196:199], v[236:239], v[160:163]
    v_fma_f32 v252, v249, s24, v251
    v_fmac_f32 v251, -4.0, v249
    v_mfma_f32_16x16x32_bf16 v[164:167], a[200:203], v[236:239], v[164:167]
    ds_read_b128 v[236:239], v253 offset:36416
    v_fma_f32 v249, v248, s24, v250
    v_mfma_f32_16x16x32_bf16 v[164:167], a[212:215], v[228:231], v[164:167]
    buffer_load_dwordx2 v[202:203], v203, s[4:7], s21 offen offset:384
    v_mfma_f32_16x16x32_bf16 v[164:167], a[224:227], v[232:235], v[164:167]
    v_fmac_f32 v250, -4.0, v248
    v_fma_f32 v248, v250, s26, v251
    v_mfma_f32_16x16x32_bf16 v[168:171], a[192:195], v[228:231], v[168:171]
    buffer_store_dwordx4 a[148:151], v254, s[12:15], s44 offen nt
    s_add_u32 s44, s40, 207872
    v_fmac_f32 v251, s27, v250
    v_mfma_f32_16x16x32_bf16 v[168:171], a[204:207], v[232:235], v[168:171]
    s_waitcnt lgkmcnt(0)
    v_fma_f32 v250, v249, 2.0, v252
    v_fmac_f32 v252, -2.0, v249
    v_mfma_f32_16x16x32_bf16 v[168:171], a[216:219], v[236:239], v[168:171]
    v_fma_f32 v249, v220, s24, v224
    v_fmac_f32 v224, -4.0, v220
    v_mfma_f32_16x16x32_bf16 v[172:175], a[220:223], v[236:239], v[172:175]
    v_fma_f32 v220, v218, s24, v222
    v_fmac_f32 v222, -4.0, v218
    v_mfma_f32_16x16x32_bf16 v[172:175], a[208:211], v[232:235], v[172:175]
    v_fma_f32 v218, v222, s26, v224
    v_fmac_f32 v224, s27, v222
    v_mfma_f32_16x16x32_bf16 v[172:175], a[196:199], v[228:231], v[172:175]
    v_fma_f32 v222, v220, 2.0, v249
    v_fmac_f32 v249, -2.0, v220
    v_mfma_f32_16x16x32_bf16 v[176:179], a[200:203], v[228:231], v[176:179]
    ds_read_b128 v[228:231], v253 offset:36144
    v_cvt_pk_bf16_f32 v218, v248, v218
    v_mfma_f32_16x16x32_bf16 v[176:179], a[212:215], v[232:235], v[176:179]
    v_cvt_pk_bf16_f32 v224, v251, v224
    v_cvt_pk_bf16_f32 v222, v250, v222
    v_mfma_f32_16x16x32_bf16 v[176:179], a[224:227], v[236:239], v[176:179]
    s_mov_b32 s42, 1179648
    v_cvt_pk_bf16_f32 v220, v252, v249
    v_mfma_f32_16x16x32_bf16 v[180:183], a[192:195], v[232:235], v[180:183]
    s_waitcnt lgkmcnt(0)
    v_lshlrev_b32 v248, 16, v219
    v_lshlrev_b32 v249, 16, v221
    v_mfma_f32_16x16x32_bf16 v[184:187], a[196:199], v[232:235], v[184:187]
    s_barrier
    v_mfma_f32_16x16x32_bf16 v[188:191], a[200:203], v[232:235], v[188:191]
    ds_read_b128 v[232:235], v253 offset:38480
    v_lshlrev_b32 v250, 16, v223
    v_mfma_f32_16x16x32_bf16 v[188:191], a[212:215], v[236:239], v[188:191]
    buffer_load_dwordx4 a[192:195], v254, s[8:11], s42 offen offset:0 sc1
    v_mfma_f32_16x16x32_bf16 v[184:187], a[208:211], v[236:239], v[184:187]
    v_lshlrev_b32 v251, 16, v225
    v_and_b32 v219, s22, v219
    v_mfma_f32_16x16x32_bf16 v[180:183], a[204:207], v[236:239], v[180:183]
    ds_read_b128 v[236:239], v253 offset:38208
    v_and_b32 v221, s22, v221
    v_mfma_f32_16x16x32_bf16 v[180:183], a[216:219], v[228:231], v[180:183]
    buffer_load_dwordx4 a[196:199], v254, s[8:11], s42 offen offset:1024 sc1
    v_mfma_f32_16x16x32_bf16 v[184:187], a[220:223], v[228:231], v[184:187]
    s_waitcnt vmcnt(17) lgkmcnt(1)
    v_and_b32 v223, s22, v223
    v_and_b32 v225, s22, v225
    v_mfma_f32_16x16x32_bf16 v[188:191], a[224:227], v[228:231], v[188:191]
    ds_read_b128 v[228:231], v253 offset:37952
    v_lshlrev_b32 v252, 16, v217
sub31:
    v_mfma_f32_16x16x32_bf16 v[96:99], a[228:231], v[232:235], v[96:99]
    buffer_load_dwordx4 a[200:203], v254, s[8:11], s42 offen offset:2048 sc1
    v_mfma_f32_16x16x32_bf16 v[100:103], a[232:235], v[232:235], v[100:103]
    s_mov_b32 s42, 1182720
    v_and_b32 v217, s22, v217
    v_fmac_f32 v252, s25, v251
    v_mfma_f32_16x16x32_bf16 v[104:107], a[236:239], v[232:235], v[104:107]
    ds_read_b128 v[232:235], v253 offset:37696
    s_waitcnt vmcnt(15)
    s_waitcnt lgkmcnt(2)
    v_mfma_f32_16x16x32_bf16 v[104:107], a[248:251], v[236:239], v[104:107]
    ds_read_b128 a[0:3], v6 offset:12480
    v_fmac_f32 v217, s25, v225
    v_mfma_f32_16x16x32_bf16 v[100:103], a[244:247], v[236:239], v[100:103]
    buffer_load_dwordx4 a[204:207], v254, s[8:11], s42 offen offset:0 sc1
    v_mfma_f32_16x16x32_bf16 v[96:99], a[240:243], v[236:239], v[96:99]
    s_waitcnt vmcnt(12) lgkmcnt(2)
    v_fmac_f32 v252, s28, v249
    v_fmac_f32 v217, s28, v221
    v_mfma_f32_16x16x32_bf16 v[96:99], a[252:255], v[228:231], v[96:99]
    buffer_store_dwordx4 a[152:155], v254, s[12:15], s44 offen nt
    v_cvt_pk_bf16_f32 v217, v252, v217
    v_lshlrev_b32 v252, 16, v227
    v_mfma_f32_16x16x32_bf16 v[100:103], v[240:243], v[228:231], v[100:103]
    v_and_b32 v227, s22, v227
    v_fmac_f32 v252, s29, v248
    v_mfma_f32_16x16x32_bf16 v[104:107], v[244:247], v[228:231], v[104:107]
    buffer_load_dwordx4 a[208:211], v254, s[8:11], s42 offen offset:1024 sc1
    v_mfma_f32_16x16x32_bf16 v[108:111], a[228:231], v[236:239], v[108:111]
    ds_read_b128 a[4:7], v6 offset:13504
    s_add_u32 s44, s40, 0
    v_mfma_f32_16x16x32_bf16 v[108:111], a[240:243], v[228:231], v[108:111]
    s_waitcnt lgkmcnt(2)
    v_fmac_f32 v227, s29, v219
    v_fmac_f32 v252, s23, v250
    v_mfma_f32_16x16x32_bf16 v[108:111], a[252:255], v[232:235], v[108:111]
    v_fmac_f32 v227, s23, v223
    v_cvt_pk_bf16_f32 v227, v252, v227
    v_mfma_f32_16x16x32_bf16 v[112:115], v[240:243], v[232:235], v[112:115]
    buffer_load_dwordx4 a[212:215], v254, s[8:11], s42 offen offset:2048 sc1
    v_mfma_f32_16x16x32_bf16 v[112:115], a[244:247], v[228:231], v[112:115]
    s_mov_b32 s42, 1185792
    v_fma_f32 v252, v249, s24, v251
    v_fmac_f32 v251, -4.0, v249
    v_mfma_f32_16x16x32_bf16 v[112:115], a[232:235], v[236:239], v[112:115]
    s_waitcnt lgkmcnt(1)
    v_fma_f32 v249, v248, s24, v250
    v_mfma_f32_16x16x32_bf16 v[116:119], a[236:239], v[236:239], v[116:119]
    ds_read_b128 v[236:239], v253 offset:37440
    v_fmac_f32 v250, -4.0, v248
    v_mfma_f32_16x16x32_bf16 v[116:119], a[248:251], v[228:231], v[116:119]
    buffer_load_dwordx4 a[216:219], v254, s[8:11], s42 offen offset:0 sc1
    v_mfma_f32_16x16x32_bf16 v[116:119], v[244:247], v[232:235], v[116:119]
    v_fma_f32 v248, v250, s26, v251
    v_fmac_f32 v251, s27, v250
    v_mfma_f32_16x16x32_bf16 v[120:123], a[228:231], v[228:231], v[120:123]
    v_fma_f32 v250, v249, 2.0, v252
    v_fmac_f32 v252, -2.0, v249
    v_mfma_f32_16x16x32_bf16 v[120:123], a[240:243], v[232:235], v[120:123]
    s_waitcnt lgkmcnt(0)
    v_fma_f32 v249, v221, s24, v225
    v_fmac_f32 v225, -4.0, v221
    v_mfma_f32_16x16x32_bf16 v[120:123], a[252:255], v[236:239], v[120:123]
    v_fma_f32 v221, v219, s24, v223
    v_fmac_f32 v223, -4.0, v219
    v_mfma_f32_16x16x32_bf16 v[124:127], v[240:243], v[236:239], v[124:127]
    buffer_load_dwordx4 a[220:223], v254, s[8:11], s42 offen offset:1024 sc1
    v_mfma_f32_16x16x32_bf16 v[124:127], a[244:247], v[232:235], v[124:127]
    ds_read_b128 a[8:11], v6 offset:14528
    v_fma_f32 v219, v223, s26, v225
    v_mfma_f32_16x16x32_bf16 v[124:127], a[232:235], v[228:231], v[124:127]
    v_fmac_f32 v225, s27, v223
    v_fma_f32 v223, v221, 2.0, v249
    v_mfma_f32_16x16x32_bf16 v[128:131], a[236:239], v[228:231], v[128:131]
    ds_read_b128 v[228:231], v253 offset:39264
    v_fmac_f32 v249, -2.0, v221
    v_mfma_f32_16x16x32_bf16 v[128:131], a[248:251], v[232:235], v[128:131]
    buffer_load_dwordx4 a[224:227], v254, s[8:11], s42 offen offset:2048 sc1
    v_mfma_f32_16x16x32_bf16 v[128:131], v[244:247], v[236:239], v[128:131]
    v_cvt_pk_bf16_f32 v219, v248, v219
    v_cvt_pk_bf16_f32 v225, v251, v225
    v_mfma_f32_16x16x32_bf16 v[132:135], a[228:231], v[232:235], v[132:135]
    buffer_store_dwordx4 a[0:3], v254, s[12:15], s44 offen nt
    v_and_b32 v215, 0x7fff, v255
    v_cvt_pk_bf16_f32 v223, v250, v223
    v_mfma_f32_16x16x32_bf16 v[132:135], a[240:243], v[236:239], v[132:135]
    s_waitcnt lgkmcnt(0)
    s_add_u32 s44, s40, 1024
    v_cvt_pk_bf16_f32 v221, v252, v249
    v_mfma_f32_16x16x32_bf16 v[132:135], a[252:255], v[228:231], v[132:135]
    buffer_load_dwordx2 v[204:205], v215, s[4:7], s16 offen offset:768
    v_mfma_f32_16x16x32_bf16 v[136:139], v[240:243], v[228:231], v[136:139]
    v_lshrrev_b32 v252, 15, v255
    v_mfma_f32_16x16x32_bf16 v[136:139], a[244:247], v[236:239], v[136:139]
    ds_write_b64 v252, v[218:219] offset:768
    v_mfma_f32_16x16x32_bf16 v[136:139], a[232:235], v[232:235], v[136:139]
    s_waitcnt vmcnt(13)
    v_lshrrev_b32 v218, 15, v255
    v_lshlrev_b32 v248, 16, v194
    v_mfma_f32_16x16x32_bf16 v[140:143], a[236:239], v[232:235], v[140:143]
    ds_read_b128 v[232:235], v253 offset:39008
    v_lshlrev_b32 v249, 16, v196
    v_mfma_f32_16x16x32_bf16 v[140:143], a[248:251], v[236:239], v[140:143]
    buffer_load_dwordx2 v[206:207], v215, s[4:7], s17 offen offset:768
    v_mfma_f32_16x16x32_bf16 v[140:143], v[244:247], v[228:231], v[140:143]
    v_lshlrev_b32 v250, 16, v198
    v_lshlrev_b32 v251, 16, v200
    v_mfma_f32_16x16x32_bf16 v[144:147], a[228:231], v[236:239], v[144:147]
    ds_read_b128 a[12:15], v6 offset:15584
    v_and_b32 v194, s22, v194
    v_mfma_f32_16x16x32_bf16 v[144:147], a[240:243], v[228:231], v[144:147]
    s_waitcnt lgkmcnt(1)
    v_and_b32 v196, s22, v196
    v_and_b32 v198, s22, v198
    v_mfma_f32_16x16x32_bf16 v[144:147], a[252:255], v[232:235], v[144:147]
    buffer_load_dwordx2 v[208:209], v215, s[4:7], s18 offen offset:768
    v_mfma_f32_16x16x32_bf16 v[148:151], v[240:243], v[232:235], v[148:151]
    ds_write_b64 v218, v[224:225] offset:2848
    v_mfma_f32_16x16x32_bf16 v[148:151], a[244:247], v[228:231], v[148:151]
    v_and_b32 v200, s22, v200
    v_lshlrev_b32 v252, 16, v192
    v_mfma_f32_16x16x32_bf16 v[148:151], a[232:235], v[236:239], v[148:151]
    ds_write_b64 v218, v[222:223] offset:4928
    v_mfma_f32_16x16x32_bf16 v[152:155], a[236:239], v[236:239], v[152:155]
    ds_read_b128 v[236:239], v253 offset:38752
    v_and_b32 v192, s22, v192
    v_mfma_f32_16x16x32_bf16 v[152:155], a[248:251], v[228:231], v[152:155]
    buffer_load_dwordx2 v[210:211], v215, s[4:7], s19 offen offset:768
    v_mfma_f32_16x16x32_bf16 v[152:155], v[244:247], v[232:235], v[152:155]
    ds_write_b64 v218, v[216:217] offset:34048
    v_mfma_f32_16x16x32_bf16 v[156:159], a[228:231], v[228:231], v[156:159]
    v_fmac_f32 v252, s25, v251
    v_fmac_f32 v192, s25, v200
    v_mfma_f32_16x16x32_bf16 v[156:159], a[240:243], v[232:235], v[156:159]
    s_waitcnt lgkmcnt(1)
    v_fmac_f32 v252, s28, v249
    v_fmac_f32 v192, s28, v196
    v_mfma_f32_16x16x32_bf16 v[156:159], a[252:255], v[236:239], v[156:159]
    buffer_load_dwordx2 v[212:213], v215, s[4:7], s20 offen offset:768
    v_mfma_f32_16x16x32_bf16 v[160:163], v[240:243], v[236:239], v[160:163]
    ds_write_b64 v218, v[226:227] offset:36128
    v_mfma_f32_16x16x32_bf16 v[160:163], a[244:247], v[232:235], v[160:163]
    v_cvt_pk_bf16_f32 v192, v252, v192
    v_lshlrev_b32 v252, 16, v202
    v_mfma_f32_16x16x32_bf16 v[160:163], a[232:235], v[228:231], v[160:163]
    ds_read_b128 a[16:19], v6 offset:16608
    v_and_b32 v202, s22, v202
    v_mfma_f32_16x16x32_bf16 v[164:167], a[236:239], v[228:231], v[164:167]
    ds_read_b128 v[228:231], v253 offset:38496
    v_fmac_f32 v252, s29, v248
    v_mfma_f32_16x16x32_bf16 v[164:167], a[248:251], v[232:235], v[164:167]
    buffer_load_dwordx2 v[214:215], v215, s[4:7], s21 offen offset:768
    v_mfma_f32_16x16x32_bf16 v[164:167], v[244:247], v[236:239], v[164:167]
    ds_write_b64 v218, v[220:221] offset:7008
    v_mfma_f32_16x16x32_bf16 v[168:171], a[228:231], v[232:235], v[168:171]
    buffer_store_dwordx4 a[4:7], v254, s[12:15], s44 offen nt
    s_add_u32 s44, s40, 2048
    v_fmac_f32 v202, s29, v194
    v_mfma_f32_16x16x32_bf16 v[168:171], a[240:243], v[236:239], v[168:171]
    s_waitcnt lgkmcnt(1)
    v_fmac_f32 v252, s23, v250
    v_fmac_f32 v202, s23, v198
    v_mfma_f32_16x16x32_bf16 v[168:171], a[252:255], v[228:231], v[168:171]
    v_cvt_pk_bf16_f32 v202, v252, v202
    v_fma_f32 v252, v249, s24, v251
    v_mfma_f32_16x16x32_bf16 v[172:175], v[240:243], v[228:231], v[172:175]
    v_fmac_f32 v251, -4.0, v249
    v_fma_f32 v249, v248, s24, v250
    v_mfma_f32_16x16x32_bf16 v[172:175], a[244:247], v[236:239], v[172:175]
    v_fmac_f32 v250, -4.0, v248
    v_fma_f32 v248, v250, s26, v251
    v_mfma_f32_16x16x32_bf16 v[172:175], a[232:235], v[232:235], v[172:175]
    v_fmac_f32 v251, s27, v250
    v_fma_f32 v250, v249, 2.0, v252
    v_mfma_f32_16x16x32_bf16 v[176:179], a[236:239], v[232:235], v[176:179]
    ds_read_b128 v[232:235], v253 offset:38224
    v_fmac_f32 v252, -2.0, v249
    v_mfma_f32_16x16x32_bf16 v[176:179], a[248:251], v[236:239], v[176:179]
    v_fma_f32 v249, v196, s24, v200
    v_fmac_f32 v200, -4.0, v196
    v_mfma_f32_16x16x32_bf16 v[176:179], v[244:247], v[228:231], v[176:179]
    s_mov_b32 s42, 1216512
    v_fma_f32 v196, v194, s24, v198
    v_fmac_f32 v198, -4.0, v194
    v_mfma_f32_16x16x32_bf16 v[180:183], a[228:231], v[236:239], v[180:183]
    v_fma_f32 v194, v198, s26, v200
    v_fmac_f32 v200, s27, v198
    v_mfma_f32_16x16x32_bf16 v[184:187], a[232:235], v[236:239], v[184:187]
    ds_read_b128 a[20:23], v6 offset:17632
    v_fma_f32 v198, v196, 2.0, v249
    v_mfma_f32_16x16x32_bf16 v[188:191], a[236:239], v[236:239], v[188:191]
    ds_read_b128 v[236:239], v253 offset:26000
    v_fmac_f32 v249, -2.0, v196
    v_mfma_f32_16x16x32_bf16 v[188:191], a[248:251], v[228:231], v[188:191]
    buffer_load_dwordx4 a[228:231], v254, s[8:11], s42 offen offset:0 sc1
    v_mfma_f32_16x16x32_bf16 v[184:187], a[244:247], v[228:231], v[184:187]
    s_waitcnt lgkmcnt(2)
    v_cvt_pk_bf16_f32 v194, v248, v194
    v_cvt_pk_bf16_f32 v200, v251, v200
    v_mfma_f32_16x16x32_bf16 v[180:183], a[240:243], v[228:231], v[180:183]
    ds_read_b128 v[228:231], v253 offset:25728
    v_cvt_pk_bf16_f32 v198, v250, v198
    v_mfma_f32_16x16x32_bf16 v[180:183], a[252:255], v[232:235], v[180:183]
    buffer_load_dwordx4 a[232:235], v254, s[8:11], s42 offen offset:1024 sc1
    v_mfma_f32_16x16x32_bf16 v[184:187], v[240:243], v[232:235], v[184:187]
    s_waitcnt vmcnt(17) lgkmcnt(1)
    v_cvt_pk_bf16_f32 v196, v252, v249
    v_lshlrev_b32 v248, 16, v195
    v_mfma_f32_16x16x32_bf16 v[188:191], v[244:247], v[232:235], v[188:191]
    ds_read_b128 v[232:235], v253 offset:25472
    v_lshlrev_b32 v249, 16, v197
sub32:
    v_mfma_f32_16x16x32_bf16 v[96:99], a[192:195], v[236:239], v[96:99]
    buffer_load_dwordx4 a[236:239], v254, s[8:11], s42 offen offset:2048 sc1
    v_mfma_f32_16x16x32_bf16 v[100:103], a[196:199], v[236:239], v[100:103]
pad12:
    s_cbranch_vccnz warm_ret
    s_mov_b32 s42, 1219584
    v_lshlrev_b32 v250, 16, v199
    v_lshlrev_b32 v251, 16, v201
    v_mfma_f32_16x16x32_bf16 v[104:107], a[200:203], v[236:239], v[104:107]
    ds_read_b128 v[236:239], v253 offset:25216
    s_waitcnt vmcnt(14)
    s_waitcnt lgkmcnt(2)
    v_mfma_f32_16x16x32_bf16 v[104:107], a[212:215], v[228:231], v[104:107]
    v_and_b32 v195, s22, v195
    v_and_b32 v197, s22, v197
    v_mfma_f32_16x16x32_bf16 v[100:103], a[208:211], v[228:231], v[100:103]
    buffer_load_dwordx4 a[240:243], v254, s[8:11], s42 offen offset:0 sc1
    v_mfma_f32_16x16x32_bf16 v[96:99], a[204:207], v[228:231], v[96:99]
    s_waitcnt vmcnt(12) lgkmcnt(1)
    v_and_b32 v199, s22, v199
    v_and_b32 v201, s22, v201
    v_mfma_f32_16x16x32_bf16 v[96:99], a[216:219], v[232:235], v[96:99]
    buffer_store_dwordx4 a[8:11], v254, s[12:15], s44 offen nt
    s_add_u32 s44, s40, 3072
    v_mfma_f32_16x16x32_bf16 v[100:103], a[220:223], v[232:235], v[100:103]
    ds_read_b128 a[24:27], v6 offset:18688
    v_lshlrev_b32 v252, 16, v193
    v_mfma_f32_16x16x32_bf16 v[104:107], a[224:227], v[232:235], v[104:107]
    buffer_load_dwordx4 a[244:247], v254, s[8:11], s42 offen offset:1024 sc1
    v_mfma_f32_16x16x32_bf16 v[108:111], a[192:195], v[228:231], v[108:111]
    v_and_b32 v193, s22, v193
    v_fmac_f32 v252, s25, v251
    v_mfma_f32_16x16x32_bf16 v[108:111], a[204:207], v[232:235], v[108:111]
    s_waitcnt lgkmcnt(1)
    v_fmac_f32 v193, s25, v201
    v_fmac_f32 v252, s28, v249
    v_mfma_f32_16x16x32_bf16 v[108:111], a[216:219], v[236:239], v[108:111]
    v_fmac_f32 v193, s28, v197
    v_cvt_pk_bf16_f32 v193, v252, v193
    v_mfma_f32_16x16x32_bf16 v[112:115], a[220:223], v[236:239], v[112:115]
    buffer_load_dwordx4 a[248:251], v254, s[8:11], s42 offen offset:2048 sc1
    v_mfma_f32_16x16x32_bf16 v[112:115], a[208:211], v[232:235], v[112:115]
    s_mov_b32 s42, 1222656
    v_lshlrev_b32 v252, 16, v203
    v_and_b32 v203, s22, v203
    v_mfma_f32_16x16x32_bf16 v[112:115], a[196:199], v[228:231], v[112:115]
    buffer_store_dwordx4 a[12:15], v254, s[12:15], s44 offen nt
    v_fmac_f32 v252, s29, v248
    v_fmac_f32 v203, s29, v195
    v_mfma_f32_16x16x32_bf16 v[116:119], a[200:203], v[228:231], v[116:119]
    ds_read_b128 v[228:231], v253 offset:24960
    v_fmac_f32 v252, s23, v250
    v_mfma_f32_16x16x32_bf16 v[116:119], a[212:215], v[232:235], v[116:119]
    buffer_load_dwordx4 a[252:255], v254, s[8:11], s42 offen offset:0 sc1
    v_mfma_f32_16x16x32_bf16 v[116:119], a[224:227], v[236:239], v[116:119]
    v_fmac_f32 v203, s23, v199
    v_cvt_pk_bf16_f32 v203, v252, v203
    v_mfma_f32_16x16x32_bf16 v[120:123], a[192:195], v[232:235], v[120:123]
    v_fma_f32 v252, v249, s24, v251
    v_fmac_f32 v251, -4.0, v249
    v_mfma_f32_16x16x32_bf16 v[120:123], a[204:207], v[236:239], v[120:123]
    s_waitcnt lgkmcnt(0)
    s_add_u32 s44, s40, 4096
    v_fma_f32 v249, v248, s24, v250
    v_mfma_f32_16x16x32_bf16 v[120:123], a[216:219], v[228:231], v[120:123]
    ds_read_b128 a[28:31], v6 offset:19712
    v_fmac_f32 v250, -4.0, v248
    v_mfma_f32_16x16x32_bf16 v[124:127], a[220:223], v[228:231], v[124:127]
    buffer_load_dwordx4 v[240:243], v254, s[8:11], s42 offen offset:1024 sc1
    v_mfma_f32_16x16x32_bf16 v[124:127], a[208:211], v[236:239], v[124:127]
    v_fma_f32 v248, v250, s26, v251
    v_fmac_f32 v251, s27, v250
    v_mfma_f32_16x16x32_bf16 v[124:127], a[196:199], v[232:235], v[124:127]
    v_fma_f32 v250, v249, 2.0, v252
    v_fmac_f32 v252, -2.0, v249
    v_mfma_f32_16x16x32_bf16 v[128:131], a[200:203], v[232:235], v[128:131]
    ds_read_b128 v[232:235], v253 offset:26784
    v_fma_f32 v249, v197, s24, v201
    v_mfma_f32_16x16x32_bf16 v[128:131], a[212:215], v[236:239], v[128:131]
    buffer_load_dwordx4 v[244:247], v254, s[8:11], s42 offen offset:2048 sc1
    v_mfma_f32_16x16x32_bf16 v[128:131], a[224:227], v[228:231], v[128:131]
    v_fmac_f32 v201, -4.0, v197
    v_fma_f32 v197, v195, s24, v199
    v_mfma_f32_16x16x32_bf16 v[132:135], a[192:195], v[236:239], v[132:135]
    v_and_b32 v227, 0x7fff, v255
    v_fmac_f32 v199, -4.0, v195
    v_mfma_f32_16x16x32_bf16 v[132:135], a[204:207], v[228:231], v[132:135]
    s_waitcnt lgkmcnt(0)
    v_fma_f32 v195, v199, s26, v201
    v_fmac_f32 v201, s27, v199
    v_mfma_f32_16x16x32_bf16 v[132:135], a[216:219], v[232:235], v[132:135]
    buffer_load_dwordx2 v[216:217], v227, s[4:7], s16 offen offset:1152
    v_mfma_f32_16x16x32_bf16 v[136:139], a[220:223], v[232:235], v[136:139]
    v_fma_f32 v199, v197, 2.0, v249
    v_fmac_f32 v249, -2.0, v197
    v_mfma_f32_16x16x32_bf16 v[136:139], a[208:211], v[228:231], v[136:139]
    v_cvt_pk_bf16_f32 v195, v248, v195
    v_cvt_pk_bf16_f32 v201, v251, v201
    v_mfma_f32_16x16x32_bf16 v[136:139], a[196:199], v[236:239], v[136:139]
    v_cvt_pk_bf16_f32 v199, v250, v199
    v_cvt_pk_bf16_f32 v197, v252, v249
    v_mfma_f32_16x16x32_bf16 v[140:143], a[200:203], v[236:239], v[140:143]
    ds_read_b128 v[236:239], v253 offset:26528
    v_lshrrev_b32 v252, 15, v255
    v_mfma_f32_16x16x32_bf16 v[140:143], a[212:215], v[228:231], v[140:143]
    buffer_load_dwordx2 v[218:219], v227, s[4:7], s17 offen offset:1152
    v_mfma_f32_16x16x32_bf16 v[140:143], a[224:227], v[232:235], v[140:143]
    ds_read_b128 a[32:35], v6 offset:20736
    v_mfma_f32_16x16x32_bf16 v[144:147], a[192:195], v[228:231], v[144:147]
    ds_write_b64 v252, v[194:195] offset:512
    v_mfma_f32_16x16x32_bf16 v[144:147], a[204:207], v[232:235], v[144:147]
    s_waitcnt lgkmcnt(2)
    v_lshrrev_b32 v194, 15, v255
    s_waitcnt vmcnt(14)
    v_mfma_f32_16x16x32_bf16 v[144:147], a[216:219], v[236:239], v[144:147]
    buffer_load_dwordx2 v[220:221], v227, s[4:7], s18 offen offset:1152
    v_mfma_f32_16x16x32_bf16 v[148:151], a[220:223], v[236:239], v[148:151]
    ds_write_b64 v194, v[200:201] offset:2592
    v_mfma_f32_16x16x32_bf16 v[148:151], a[208:211], v[232:235], v[148:151]
    v_lshlrev_b32 v248, 16, v206
    v_lshlrev_b32 v249, 16, v208
    v_mfma_f32_16x16x32_bf16 v[148:151], a[196:199], v[228:231], v[148:151]
    ds_write_b64 v194, v[198:199] offset:4672
    v_mfma_f32_16x16x32_bf16 v[152:155], a[200:203], v[228:231], v[152:155]
    ds_read_b128 v[228:231], v253 offset:26272
    v_lshlrev_b32 v250, 16, v210
    v_mfma_f32_16x16x32_bf16 v[152:155], a[212:215], v[232:235], v[152:155]
    buffer_load_dwordx2 v[222:223], v227, s[4:7], s19 offen offset:1152
    v_mfma_f32_16x16x32_bf16 v[152:155], a[224:227], v[236:239], v[152:155]
    ds_write_b64 v194, v[192:193] offset:33792
    v_mfma_f32_16x16x32_bf16 v[156:159], a[192:195], v[232:235], v[156:159]
    v_lshlrev_b32 v251, 16, v212
    v_and_b32 v206, s22, v206
    v_mfma_f32_16x16x32_bf16 v[156:159], a[204:207], v[236:239], v[156:159]
    s_waitcnt lgkmcnt(1)
    v_and_b32 v208, s22, v208
    v_and_b32 v210, s22, v210
    v_mfma_f32_16x16x32_bf16 v[156:159], a[216:219], v[228:231], v[156:159]
    buffer_load_dwordx2 v[224:225], v227, s[4:7], s20 offen offset:1152
    v_mfma_f32_16x16x32_bf16 v[160:163], a[220:223], v[228:231], v[160:163]
    ds_read_b128 a[36:39], v6 offset:21792
    v_and_b32 v212, s22, v212
    v_mfma_f32_16x16x32_bf16 v[160:163], a[208:211], v[236:239], v[160:163]
    ds_write_b64 v194, v[202:203] offset:35872
    v_mfma_f32_16x16x32_bf16 v[160:163], a[196:199], v[232:235], v[160:163]
    v_lshlrev_b32 v252, 16, v204
    v_and_b32 v204, s22, v204
    v_mfma_f32_16x16x32_bf16 v[164:167], a[200:203], v[232:235], v[164:167]
    ds_read_b128 v[232:235], v253 offset:26016
    v_fmac_f32 v252, s25, v251
    v_mfma_f32_16x16x32_bf16 v[164:167], a[212:215], v[236:239], v[164:167]
    buffer_load_dwordx2 v[226:227], v227, s[4:7], s21 offen offset:1152
    v_mfma_f32_16x16x32_bf16 v[164:167], a[224:227], v[228:231], v[164:167]
    ds_write_b64 v194, v[196:197] offset:6752
    v_mfma_f32_16x16x32_bf16 v[168:171], a[192:195], v[236:239], v[168:171]
    buffer_store_dwordx4 a[16:19], v254, s[12:15], s44 offen nt
    s_add_u32 s44, s40, 5120
    v_mfma_f32_16x16x32_bf16 v[168:171], a[204:207], v[228:231], v[168:171]
    s_waitcnt lgkmcnt(1)
    v_fmac_f32 v204, s25, v212
    v_fmac_f32 v252, s28, v249
    v_mfma_f32_16x16x32_bf16 v[168:171], a[216:219], v[232:235], v[168:171]
    ds_read_b128 v[192:195], v253 offset:39520
    s_mov_b32 s45, 573637648
    v_mfma_f32_16x16x32_bf16 v[172:175], a[220:223], v[232:235], v[172:175]
    buffer_store_dwordx4 a[20:23], v254, s[12:15], s44 offen nt
    v_bfe_u32 v196, v254, 5, 3
    v_mul_u32_u24 v197, 5, v196
    v_mfma_f32_16x16x32_bf16 v[172:175], a[208:211], v[228:231], v[172:175]
    v_bfe_u32 v197, s45, v197, 5
    v_mul_u32_u24 v197, 65, v197
    v_mfma_f32_16x16x32_bf16 v[172:175], a[196:199], v[236:239], v[172:175]
    v_sub_u32 v197, v197, v196
    v_lshl_add_u32 v196, v197, 5, v253
    v_mfma_f32_16x16x32_bf16 v[176:179], a[200:203], v[236:239], v[176:179]
    ds_read_b128 v[236:239], v253 offset:25744
    s_waitcnt lgkmcnt(1)
    v_mfma_f32_16x16x32_bf16 v[176:179], a[212:215], v[228:231], v[176:179]
    s_add_u32 s44, s40, 6144
    v_fmac_f32 v204, s28, v208
    v_mfma_f32_16x16x32_bf16 v[176:179], a[224:227], v[232:235], v[176:179]
    s_mov_b32 s42, 1253376
    v_cvt_pk_bf16_f32 v204, v252, v204
    v_lshlrev_b32 v252, 16, v214
    v_mfma_f32_16x16x32_bf16 v[180:183], a[192:195], v[228:231], v[180:183]
    ds_read_b128 a[40:43], v6 offset:22816
    v_and_b32 v214, s22, v214
    v_mfma_f32_16x16x32_bf16 v[184:187], a[196:199], v[228:231], v[184:187]
    s_mov_b64 exec, s[46:47]
    ds_write_b128 v196, v[192:195] offset:1024
    s_mov_b64 exec, -1
    v_mfma_f32_16x16x32_bf16 v[188:191], a[200:203], v[228:231], v[188:191]
    ds_read_b128 v[228:231], v253 offset:28080
    v_fmac_f32 v252, s29, v248
    v_mfma_f32_16x16x32_bf16 v[188:191], a[212:215], v[232:235], v[188:191]
    buffer_load_dwordx4 a[96:99], v254, s[8:11], s42 offen offset:0 sc1
    v_mfma_f32_16x16x32_bf16 v[184:187], a[208:211], v[232:235], v[184:187]
    s_waitcnt lgkmcnt(3)
    v_fmac_f32 v214, s29, v206
    v_fmac_f32 v252, s23, v250
    v_mfma_f32_16x16x32_bf16 v[180:183], a[204:207], v[232:235], v[180:183]
    ds_read_b128 v[232:235], v253 offset:27808
    v_mfma_f32_16x16x32_bf16 v[180:183], a[216:219], v[236:239], v[180:183]
    buffer_load_dwordx4 a[100:103], v254, s[8:11], s42 offen offset:1024 sc1
    v_mfma_f32_16x16x32_bf16 v[184:187], a[220:223], v[236:239], v[184:187]
    s_waitcnt vmcnt(18) lgkmcnt(1)
    v_fmac_f32 v214, s23, v210
    v_cvt_pk_bf16_f32 v214, v252, v214
    v_mfma_f32_16x16x32_bf16 v[188:191], a[224:227], v[236:239], v[188:191]
    ds_read_b128 v[236:239], v253 offset:27552
    v_fma_f32 v252, v249, s24, v251
sub33:
    v_mfma_f32_16x16x32_bf16 v[96:99], a[228:231], v[228:231], v[96:99]
    buffer_load_dwordx4 a[104:107], v254, s[8:11], s42 offen offset:2048 sc1
    v_mfma_f32_16x16x32_bf16 v[100:103], a[232:235], v[228:231], v[100:103]
    s_mov_b32 s42, 1256448
    v_fmac_f32 v251, -4.0, v249
    v_fma_f32 v249, v248, s24, v250
    v_mfma_f32_16x16x32_bf16 v[104:107], a[236:239], v[228:231], v[104:107]
    ds_read_b128 v[228:231], v253 offset:27296
    s_waitcnt vmcnt(15)
    s_waitcnt lgkmcnt(2)
    v_mfma_f32_16x16x32_bf16 v[104:107], a[248:251], v[232:235], v[104:107]
    v_fmac_f32 v250, -4.0, v248
    v_fma_f32 v248, v250, s26, v251
    v_mfma_f32_16x16x32_bf16 v[100:103], a[244:247], v[232:235], v[100:103]
    buffer_load_dwordx4 a[108:111], v254, s[8:11], s42 offen offset:0 sc1
    v_mfma_f32_16x16x32_bf16 v[96:99], a[240:243], v[232:235], v[96:99]
    s_waitcnt vmcnt(12) lgkmcnt(1)
    v_fmac_f32 v251, s27, v250
    v_fma_f32 v250, v249, 2.0, v252
    v_mfma_f32_16x16x32_bf16 v[96:99], a[252:255], v[236:239], v[96:99]
    buffer_store_dwordx4 a[24:27], v254, s[12:15], s44 offen nt
    v_fmac_f32 v252, -2.0, v249
    v_fma_f32 v249, v208, s24, v212
    v_mfma_f32_16x16x32_bf16 v[100:103], v[240:243], v[236:239], v[100:103]
    ds_read_b128 a[44:47], v6 offset:23840
    v_fmac_f32 v212, -4.0, v208
    v_mfma_f32_16x16x32_bf16 v[104:107], v[244:247], v[236:239], v[104:107]
    buffer_load_dwordx4 a[112:115], v254, s[8:11], s42 offen offset:1024 sc1
    v_mfma_f32_16x16x32_bf16 v[108:111], a[228:231], v[232:235], v[108:111]
    s_add_u32 s44, s40, 7168
    v_fma_f32 v208, v206, s24, v210
    v_fmac_f32 v210, -4.0, v206
    v_mfma_f32_16x16x32_bf16 v[108:111], a[240:243], v[236:239], v[108:111]
    s_waitcnt lgkmcnt(1)
    v_fma_f32 v206, v210, s26, v212
    v_fmac_f32 v212, s27, v210
    v_mfma_f32_16x16x32_bf16 v[108:111], a[252:255], v[228:231], v[108:111]
    v_fma_f32 v210, v208, 2.0, v249
    v_fmac_f32 v249, -2.0, v208
    v_mfma_f32_16x16x32_bf16 v[112:115], v[240:243], v[228:231], v[112:115]
    buffer_load_dwordx4 a[116:119], v254, s[8:11], s42 offen offset:2048 sc1
    v_mfma_f32_16x16x32_bf16 v[112:115], a[244:247], v[236:239], v[112:115]
    s_mov_b32 s42, 1259520
    v_cvt_pk_bf16_f32 v206, v248, v206
    v_cvt_pk_bf16_f32 v212, v251, v212
    v_mfma_f32_16x16x32_bf16 v[112:115], a[232:235], v[232:235], v[112:115]
    v_cvt_pk_bf16_f32 v210, v250, v210
    v_cvt_pk_bf16_f32 v208, v252, v249
    v_mfma_f32_16x16x32_bf16 v[116:119], a[236:239], v[232:235], v[116:119]
    ds_read_b128 v[232:235], v253 offset:27040
    v_lshlrev_b32 v248, 16, v207
    v_mfma_f32_16x16x32_bf16 v[116:119], a[248:251], v[236:239], v[116:119]
    buffer_load_dwordx4 a[120:123], v254, s[8:11], s42 offen offset:0 sc1
    v_mfma_f32_16x16x32_bf16 v[116:119], v[244:247], v[228:231], v[116:119]
    v_lshlrev_b32 v249, 16, v209
    v_lshlrev_b32 v250, 16, v211
    v_mfma_f32_16x16x32_bf16 v[120:123], a[228:231], v[236:239], v[120:123]
    v_lshlrev_b32 v251, 16, v213
    v_and_b32 v207, s22, v207
    v_mfma_f32_16x16x32_bf16 v[120:123], a[240:243], v[228:231], v[120:123]
    s_waitcnt lgkmcnt(0)
    v_and_b32 v209, s22, v209
    v_and_b32 v211, s22, v211
    v_mfma_f32_16x16x32_bf16 v[120:123], a[252:255], v[232:235], v[120:123]
    v_and_b32 v213, s22, v213
    v_lshlrev_b32 v252, 16, v205
    v_mfma_f32_16x16x32_bf16 v[124:127], v[240:243], v[232:235], v[124:127]
    buffer_load_dwordx4 a[124:127], v254, s[8:11], s42 offen offset:1024 sc1
    v_mfma_f32_16x16x32_bf16 v[124:127], a[244:247], v[228:231], v[124:127]
    v_and_b32 v205, s22, v205
    v_fmac_f32 v252, s25, v251
    v_mfma_f32_16x16x32_bf16 v[124:127], a[232:235], v[236:239], v[124:127]
    v_fmac_f32 v205, s25, v213
    v_fmac_f32 v252, s28, v249
    v_mfma_f32_16x16x32_bf16 v[128:131], a[236:239], v[236:239], v[128:131]
    ds_read_b128 v[236:239], v253 offset:28864
    v_fmac_f32 v205, s28, v209
    v_mfma_f32_16x16x32_bf16 v[128:131], a[248:251], v[228:231], v[128:131]
    buffer_load_dwordx4 a[128:131], v254, s[8:11], s42 offen offset:2048 sc1
    v_mfma_f32_16x16x32_bf16 v[128:131], v[244:247], v[232:235], v[128:131]
    s_mov_b32 s42, 1290240
    v_cvt_pk_bf16_f32 v205, v252, v205
    v_lshlrev_b32 v252, 16, v215
    v_mfma_f32_16x16x32_bf16 v[132:135], a[228:231], v[228:231], v[132:135]
    ds_read_b128 a[48:51], v253 offset:30160
    v_and_b32 v215, s22, v215
    v_mfma_f32_16x16x32_bf16 v[132:135], a[240:243], v[232:235], v[132:135]
    s_waitcnt lgkmcnt(1)
    v_fmac_f32 v252, s29, v248
    v_fmac_f32 v215, s29, v207
    v_mfma_f32_16x16x32_bf16 v[132:135], a[252:255], v[236:239], v[132:135]
    buffer_load_dwordx4 a[132:135], v254, s[8:11], s42 offen offset:0 sc1
    v_mfma_f32_16x16x32_bf16 v[136:139], v[240:243], v[236:239], v[136:139]
    v_fmac_f32 v252, s23, v250
    v_fmac_f32 v215, s23, v211
    v_mfma_f32_16x16x32_bf16 v[136:139], a[244:247], v[232:235], v[136:139]
    ds_read_b128 a[64:67], v253 offset:32240
    v_cvt_pk_bf16_f32 v215, v252, v215
    v_mfma_f32_16x16x32_bf16 v[136:139], a[232:235], v[228:231], v[136:139]
    buffer_load_dwordx4 a[136:139], v254, s[8:11], s42 offen offset:1024 sc1
    v_mfma_f32_16x16x32_bf16 v[140:143], a[236:239], v[228:231], v[140:143]
    ds_read_b128 v[228:231], v253 offset:28608
    v_fma_f32 v252, v249, s24, v251
    v_mfma_f32_16x16x32_bf16 v[140:143], a[248:251], v[232:235], v[140:143]
    v_fmac_f32 v251, -4.0, v249
    v_fma_f32 v249, v248, s24, v250
    v_mfma_f32_16x16x32_bf16 v[140:143], v[244:247], v[236:239], v[140:143]
    ds_read_b128 a[52:55], v253 offset:29888
    v_fmac_f32 v250, -4.0, v248
    v_mfma_f32_16x16x32_bf16 v[144:147], a[228:231], v[232:235], v[144:147]
    buffer_load_dwordx4 a[140:143], v254, s[8:11], s42 offen offset:2048 sc1
    v_mfma_f32_16x16x32_bf16 v[144:147], a[240:243], v[236:239], v[144:147]
    s_mov_b32 s42, 1293312
    s_waitcnt lgkmcnt(1)
    v_fma_f32 v248, v250, s26, v251
    v_mfma_f32_16x16x32_bf16 v[144:147], a[252:255], v[228:231], v[144:147]
    v_fmac_f32 v251, s27, v250
    v_fma_f32 v250, v249, 2.0, v252
    v_mfma_f32_16x16x32_bf16 v[148:151], v[240:243], v[228:231], v[148:151]
    ds_read_b128 a[68:71], v253 offset:31968
    v_fmac_f32 v252, -2.0, v249
    v_mfma_f32_16x16x32_bf16 v[148:151], a[244:247], v[236:239], v[148:151]
    buffer_load_dwordx4 a[144:147], v254, s[8:11], s42 offen offset:0 sc1
    v_mfma_f32_16x16x32_bf16 v[148:151], a[232:235], v[232:235], v[148:151]
    v_fma_f32 v249, v209, s24, v213
    v_fmac_f32 v213, -4.0, v209
    v_mfma_f32_16x16x32_bf16 v[152:155], a[236:239], v[232:235], v[152:155]
    ds_read_b128 v[232:235], v253 offset:28352
    v_fma_f32 v209, v207, s24, v211
    v_mfma_f32_16x16x32_bf16 v[152:155], a[248:251], v[236:239], v[152:155]
    ds_read_b128 a[56:59], v253 offset:29632
    v_fmac_f32 v211, -4.0, v207
    v_mfma_f32_16x16x32_bf16 v[152:155], v[244:247], v[228:231], v[152:155]
    buffer_load_dwordx4 a[148:151], v254, s[8:11], s42 offen offset:1024 sc1
    v_mfma_f32_16x16x32_bf16 v[156:159], a[228:231], v[236:239], v[156:159]
    v_fma_f32 v207, v211, s26, v213
    v_fmac_f32 v213, s27, v211
    v_mfma_f32_16x16x32_bf16 v[156:159], a[240:243], v[228:231], v[156:159]
    s_waitcnt lgkmcnt(1)
    v_fma_f32 v211, v209, 2.0, v249
    v_fmac_f32 v249, -2.0, v209
    v_mfma_f32_16x16x32_bf16 v[156:159], a[252:255], v[232:235], v[156:159]
    ds_read_b128 a[72:75], v253 offset:31712
    v_cvt_pk_bf16_f32 v207, v248, v207
    v_mfma_f32_16x16x32_bf16 v[160:163], v[240:243], v[232:235], v[160:163]
    buffer_load_dwordx4 a[152:155], v254, s[8:11], s42 offen offset:2048 sc1
    v_mfma_f32_16x16x32_bf16 v[160:163], a[244:247], v[228:231], v[160:163]
    s_mov_b32 s42, 1296384
    v_cvt_pk_bf16_f32 v213, v251, v213
    v_cvt_pk_bf16_f32 v211, v250, v211
    v_mfma_f32_16x16x32_bf16 v[160:163], a[232:235], v[236:239], v[160:163]
    v_cvt_pk_bf16_f32 v209, v252, v249
    v_lshrrev_b32 v252, 15, v255
    v_mfma_f32_16x16x32_bf16 v[164:167], a[236:239], v[236:239], v[164:167]
    ds_read_b128 v[236:239], v253 offset:28096
    v_mfma_f32_16x16x32_bf16 v[164:167], a[248:251], v[228:231], v[164:167]
    buffer_load_dwordx4 a[156:159], v254, s[8:11], s42 offen offset:0 sc1
    v_mfma_f32_16x16x32_bf16 v[164:167], v[244:247], v[232:235], v[164:167]
    ds_read_b128 a[60:63], v253 offset:29376
    v_mfma_f32_16x16x32_bf16 v[168:171], a[228:231], v[228:231], v[168:171]
    buffer_store_dwordx4 a[28:31], v254, s[12:15], s44 offen nt
    s_add_u32 s44, s40, 8192
    v_mfma_f32_16x16x32_bf16 v[168:171], a[240:243], v[232:235], v[168:171]
    buffer_load_dwordx4 a[160:163], v254, s[8:11], s42 offen offset:1024 sc1
    s_waitcnt lgkmcnt(1)
    v_mfma_f32_16x16x32_bf16 v[168:171], a[252:255], v[236:239], v[168:171]
    ds_write_b64 v252, v[206:207] offset:256
    v_mfma_f32_16x16x32_bf16 v[172:175], v[240:243], v[236:239], v[172:175]
    ds_read_b128 a[76:79], v253 offset:31456
    v_lshrrev_b32 v206, 15, v255
    v_mfma_f32_16x16x32_bf16 v[172:175], a[244:247], v[232:235], v[172:175]
    ds_write_b64 v206, v[212:213] offset:2336
    s_waitcnt vmcnt(21)
    v_mfma_f32_16x16x32_bf16 v[172:175], a[232:235], v[228:231], v[172:175]
    buffer_load_dwordx4 a[164:167], v254, s[8:11], s42 offen offset:2048 sc1
    v_mfma_f32_16x16x32_bf16 v[176:179], a[236:239], v[228:231], v[176:179]
    ds_read_b128 v[228:231], v253 offset:27824
    v_lshlrev_b32 v248, 16, v218
    v_mfma_f32_16x16x32_bf16 v[176:179], a[248:251], v[232:235], v[176:179]
    buffer_store_dwordx4 a[32:35], v254, s[12:15], s44 offen nt
    s_add_u32 s44, s40, 9216
    v_mfma_f32_16x16x32_bf16 v[176:179], v[244:247], v[236:239], v[176:179]
    s_add_u32 s42, s36, 0
    v_lshlrev_b32 v249, 16, v220
    v_lshlrev_b32 v250, 16, v222
    v_mfma_f32_16x16x32_bf16 v[180:183], a[228:231], v[232:235], v[180:183]
    s_waitcnt lgkmcnt(0)
    v_lshlrev_b32 v251, 16, v224
    v_and_b32 v218, s22, v218
    v_and_b32 v220, s22, v220
    v_mfma_f32_16x16x32_bf16 v[184:187], a[232:235], v[232:235], v[184:187]
    s_barrier
    v_mfma_f32_16x16x32_bf16 v[188:191], a[236:239], v[232:235], v[188:191]
    ds_write_b64 v206, v[210:211] offset:4416
    v_mfma_f32_16x16x32_bf16 v[188:191], a[248:251], v[236:239], v[188:191]
    buffer_load_dwordx4 a[192:195], v254, s[8:11], s42 offen offset:0 sc1
    v_mfma_f32_16x16x32_bf16 v[184:187], a[244:247], v[236:239], v[184:187]
    ds_write_b64 v206, v[204:205] offset:33536
    v_mfma_f32_16x16x32_bf16 v[180:183], a[240:243], v[236:239], v[180:183]
    v_and_b32 v222, s22, v222
    v_and_b32 v224, s22, v224
    v_lshlrev_b32 v252, 16, v216
    v_mfma_f32_16x16x32_bf16 v[180:183], a[252:255], v[228:231], v[180:183]
    buffer_load_dwordx4 a[196:199], v254, s[8:11], s42 offen offset:1024 sc1
    v_mfma_f32_16x16x32_bf16 v[184:187], v[240:243], v[228:231], v[184:187]
    ds_write_b64 v206, v[214:215] offset:35616
    v_mfma_f32_16x16x32_bf16 v[188:191], v[244:247], v[228:231], v[188:191]
    s_waitcnt vmcnt(13)
    v_and_b32 v216, s22, v216
    v_fmac_f32 v252, s25, v251
sub34:
    v_mfma_f32_16x16x32_bf16 v[96:99], a[96:99], a[48:51], v[96:99]
    buffer_load_dwordx4 a[200:203], v254, s[8:11], s42 offen offset:2048 sc1
    v_mfma_f32_16x16x32_bf16 v[96:99], a[108:111], a[52:55], v[96:99]
    s_add_u32 s42, s36, 3072
    v_fmac_f32 v216, s25, v224
    v_fmac_f32 v252, s28, v249
    v_fmac_f32 v216, s28, v220
    v_mfma_f32_16x16x32_bf16 v[96:99], a[120:123], a[56:59], v[96:99]
    ds_write_b64 v206, v[208:209] offset:6496
    v_mfma_f32_16x16x32_bf16 v[100:103], a[124:127], a[56:59], v[100:103]
    v_cvt_pk_bf16_f32 v216, v252, v216
    v_lshlrev_b32 v252, 16, v226
    v_mfma_f32_16x16x32_bf16 v[100:103], a[112:115], a[52:55], v[100:103]
    buffer_load_dwordx4 a[204:207], v254, s[8:11], s42 offen offset:0 sc1
    v_mfma_f32_16x16x32_bf16 v[100:103], a[100:103], a[48:51], v[100:103]
    v_and_b32 v226, s22, v226
    v_fmac_f32 v252, s29, v248
    v_mfma_f32_16x16x32_bf16 v[104:107], a[104:107], a[48:51], v[104:107]
    ds_read_b128 a[48:51], v253 offset:29120
    v_fmac_f32 v226, s29, v218
    v_fmac_f32 v252, s23, v250
    v_mfma_f32_16x16x32_bf16 v[104:107], a[116:119], a[52:55], v[104:107]
    v_fmac_f32 v226, s23, v222
    v_cvt_pk_bf16_f32 v226, v252, v226
    v_mfma_f32_16x16x32_bf16 v[104:107], a[128:131], a[56:59], v[104:107]
    buffer_load_dwordx4 a[208:211], v254, s[8:11], s42 offen offset:1024 sc1
    v_mfma_f32_16x16x32_bf16 v[108:111], a[96:99], a[52:55], v[108:111]
    v_fma_f32 v252, v249, s24, v251
    v_fmac_f32 v251, -4.0, v249
    v_mfma_f32_16x16x32_bf16 v[108:111], a[108:111], a[56:59], v[108:111]
    v_fma_f32 v249, v248, s24, v250
    v_fmac_f32 v250, -4.0, v248
    v_mfma_f32_16x16x32_bf16 v[108:111], a[120:123], a[60:63], v[108:111]
    v_fma_f32 v248, v250, s26, v251
    v_fmac_f32 v251, s27, v250
    v_fma_f32 v250, v249, 2.0, v252
    v_mfma_f32_16x16x32_bf16 v[112:115], a[124:127], a[60:63], v[112:115]
    buffer_load_dwordx4 a[212:215], v254, s[8:11], s42 offen offset:2048 sc1
    v_mfma_f32_16x16x32_bf16 v[112:115], a[112:115], a[56:59], v[112:115]
    s_add_u32 s42, s36, 6144
    v_fmac_f32 v252, -2.0, v249
    v_fma_f32 v249, v220, s24, v224
    v_mfma_f32_16x16x32_bf16 v[112:115], a[100:103], a[52:55], v[112:115]
    buffer_store_dwordx4 a[36:39], v254, s[12:15], s44 offen nt
    s_add_u32 s44, s40, 10240
    v_mfma_f32_16x16x32_bf16 v[116:119], a[104:107], a[52:55], v[116:119]
    ds_read_b128 a[52:55], v253 offset:30944
    v_fmac_f32 v224, -4.0, v220
    v_mfma_f32_16x16x32_bf16 v[116:119], a[116:119], a[56:59], v[116:119]
    buffer_load_dwordx4 a[216:219], v254, s[8:11], s42 offen offset:0 sc1
    v_fma_f32 v220, v218, s24, v222
    v_mfma_f32_16x16x32_bf16 v[116:119], a[128:131], a[60:63], v[116:119]
    s_waitcnt vmcnt(16)
    v_fmac_f32 v222, -4.0, v218
    v_fma_f32 v218, v222, s26, v224
    v_mfma_f32_16x16x32_bf16 v[96:99], a[132:135], a[64:67], v[96:99]
    s_waitcnt vmcnt(13)
    v_fmac_f32 v224, s27, v222
    v_fma_f32 v222, v220, 2.0, v249
    v_mfma_f32_16x16x32_bf16 v[96:99], a[144:147], a[68:71], v[96:99]
    s_waitcnt vmcnt(9)
    v_fmac_f32 v249, -2.0, v220
    v_cvt_pk_bf16_f32 v218, v248, v218
    v_mfma_f32_16x16x32_bf16 v[96:99], a[156:159], a[72:75], v[96:99]
    v_cvt_pk_bf16_f32 v224, v251, v224
    v_cvt_pk_bf16_f32 v222, v250, v222
    v_mfma_f32_16x16x32_bf16 v[100:103], a[160:163], a[72:75], v[100:103]
    buffer_load_dwordx4 a[220:223], v254, s[8:11], s42 offen offset:1024 sc1
    v_cvt_pk_bf16_f32 v220, v252, v249
    v_mfma_f32_16x16x32_bf16 v[100:103], a[148:151], a[68:71], v[100:103]
    v_lshlrev_b32 v248, 16, v219
    v_lshlrev_b32 v249, 16, v221
    v_mfma_f32_16x16x32_bf16 v[100:103], a[136:139], a[64:67], v[100:103]
    v_lshlrev_b32 v250, 16, v223
    v_lshlrev_b32 v251, 16, v225
    v_mfma_f32_16x16x32_bf16 v[104:107], a[140:143], a[64:67], v[104:107]
    ds_read_b128 a[64:67], v253 offset:31200
    v_and_b32 v219, s22, v219
    v_mfma_f32_16x16x32_bf16 v[104:107], a[152:155], a[68:71], v[104:107]
    buffer_load_dwordx4 a[224:227], v254, s[8:11], s42 offen offset:2048 sc1
    v_mfma_f32_16x16x32_bf16 v[104:107], a[164:167], a[72:75], v[104:107]
    v_and_b32 v221, s22, v221
    v_and_b32 v223, s22, v223
    v_and_b32 v225, s22, v225
    v_mfma_f32_16x16x32_bf16 v[108:111], a[132:135], a[68:71], v[108:111]
    buffer_store_dwordx4 a[40:43], v254, s[12:15], s44 offen nt
    v_and_b32 v203, 0x7fff, v255
    s_add_u32 s44, s40, 11264
    v_mfma_f32_16x16x32_bf16 v[108:111], a[144:147], a[72:75], v[108:111]
    v_lshlrev_b32 v252, 16, v217
    v_mfma_f32_16x16x32_bf16 v[108:111], a[156:159], a[76:79], v[108:111]
    buffer_load_dwordx2 v[192:193], v203, s[4:7], s16 offen offset:64
    v_mfma_f32_16x16x32_bf16 v[112:115], a[160:163], a[76:79], v[112:115]
    v_and_b32 v217, s22, v217
    v_fmac_f32 v252, s25, v251
    v_mfma_f32_16x16x32_bf16 v[112:115], a[148:151], a[72:75], v[112:115]
    v_cvt_pk_bf16_f32 v96, v96, v97
    v_cvt_pk_bf16_f32 v97, v98, v99
    v_fmac_f32 v217, s25, v225
    v_mfma_f32_16x16x32_bf16 v[112:115], a[136:139], a[68:71], v[112:115]
    v_cvt_pk_bf16_f32 v98, v100, v101
    v_cvt_pk_bf16_f32 v99, v102, v103
    v_mfma_f32_16x16x32_bf16 v[116:119], a[140:143], a[68:71], v[116:119]
    ds_read_b128 a[68:71], v253 offset:33024
    v_fmac_f32 v252, s28, v249
    v_mfma_f32_16x16x32_bf16 v[116:119], a[152:155], a[72:75], v[116:119]
    buffer_load_dwordx2 v[194:195], v203, s[4:7], s17 offen offset:64
    v_mfma_f32_16x16x32_bf16 v[116:119], a[164:167], a[76:79], v[116:119]
    ds_write_b128 v4, v[96:99] offset:16640
    v_mfma_f32_16x16x32_bf16 v[120:123], a[96:99], a[56:59], v[120:123]
    v_fmac_f32 v217, s28, v221
    v_cvt_pk_bf16_f32 v217, v252, v217
    v_lshlrev_b32 v252, 16, v227
    v_mfma_f32_16x16x32_bf16 v[120:123], a[108:111], a[60:63], v[120:123]
    s_waitcnt lgkmcnt(4)
    v_cvt_pk_bf16_f32 v104, v104, v105
    v_cvt_pk_bf16_f32 v105, v106, v107
    v_mfma_f32_16x16x32_bf16 v[120:123], a[120:123], a[48:51], v[120:123]
    buffer_load_dwordx2 v[196:197], v203, s[4:7], s18 offen offset:64
    v_mfma_f32_16x16x32_bf16 v[120:123], a[132:135], a[72:75], v[120:123]
    ds_write_b64 v5, v[104:105] offset:16704
    v_mfma_f32_16x16x32_bf16 v[120:123], a[144:147], a[76:79], v[120:123]
    s_waitcnt lgkmcnt(3)
    v_cvt_pk_bf16_f32 v108, v108, v109
    v_cvt_pk_bf16_f32 v109, v110, v111
    v_mfma_f32_16x16x32_bf16 v[120:123], a[156:159], a[64:67], v[120:123]
    v_cvt_pk_bf16_f32 v110, v112, v113
    v_cvt_pk_bf16_f32 v111, v114, v115
    v_and_b32 v227, s22, v227
    v_mfma_f32_16x16x32_bf16 v[124:127], a[160:163], a[64:67], v[124:127]
    buffer_load_dwordx2 v[198:199], v203, s[4:7], s19 offen offset:64
    v_mfma_f32_16x16x32_bf16 v[124:127], a[148:151], a[76:79], v[124:127]
    ds_write_b128 v4, v[108:111] offset:17024
    v_mfma_f32_16x16x32_bf16 v[124:127], a[136:139], a[72:75], v[124:127]
    v_fmac_f32 v252, s29, v248
    v_fmac_f32 v227, s29, v219
    v_mfma_f32_16x16x32_bf16 v[124:127], a[124:127], a[48:51], v[124:127]
    v_fmac_f32 v252, s23, v250
    v_fmac_f32 v227, s23, v223
    v_mfma_f32_16x16x32_bf16 v[124:127], a[112:115], a[60:63], v[124:127]
    buffer_load_dwordx2 v[200:201], v203, s[4:7], s20 offen offset:64
    v_cvt_pk_bf16_f32 v227, v252, v227
    v_mfma_f32_16x16x32_bf16 v[124:127], a[100:103], a[56:59], v[124:127]
    v_cvt_pk_bf16_f32 v116, v116, v117
    v_cvt_pk_bf16_f32 v117, v118, v119
    v_mfma_f32_16x16x32_bf16 v[128:131], a[104:107], a[56:59], v[128:131]
    ds_read_b128 a[56:59], v253 offset:30688
    v_fma_f32 v252, v249, s24, v251
    v_mfma_f32_16x16x32_bf16 v[128:131], a[116:119], a[60:63], v[128:131]
    ds_write_b64 v5, v[116:117] offset:17088
    v_mfma_f32_16x16x32_bf16 v[128:131], a[128:131], a[48:51], v[128:131]
    buffer_load_dwordx2 v[202:203], v203, s[4:7], s21 offen offset:64
    v_mfma_f32_16x16x32_bf16 v[128:131], a[140:143], a[72:75], v[128:131]
    ds_read_b128 a[72:75], v253 offset:32768
    v_fmac_f32 v251, -4.0, v249
    v_fma_f32 v249, v248, s24, v250
    v_mfma_f32_16x16x32_bf16 v[128:131], a[152:155], a[76:79], v[128:131]
    v_fmac_f32 v250, -4.0, v248
    v_fma_f32 v248, v250, s26, v251
    v_mfma_f32_16x16x32_bf16 v[128:131], a[164:167], a[64:67], v[128:131]
    v_fmac_f32 v251, s27, v250
    v_fma_f32 v250, v249, 2.0, v252
    v_mfma_f32_16x16x32_bf16 v[132:135], a[96:99], a[60:63], v[132:135]
    buffer_store_dwordx4 a[44:47], v254, s[12:15], s44 offen nt
    v_fmac_f32 v252, -2.0, v249
    v_fma_f32 v249, v221, s24, v225
    v_mfma_f32_16x16x32_bf16 v[132:135], a[108:111], a[48:51], v[132:135]
    v_cvt_pk_bf16_f32 v120, v120, v121
    v_cvt_pk_bf16_f32 v121, v122, v123
    v_mfma_f32_16x16x32_bf16 v[132:135], a[120:123], a[52:55], v[132:135]
    v_cvt_pk_bf16_f32 v122, v124, v125
    v_cvt_pk_bf16_f32 v123, v126, v127
    v_fmac_f32 v225, -4.0, v221
    v_mfma_f32_16x16x32_bf16 v[132:135], a[132:135], a[76:79], v[132:135]
    v_fma_f32 v221, v219, s24, v223
    v_fmac_f32 v223, -4.0, v219
    v_mfma_f32_16x16x32_bf16 v[132:135], a[144:147], a[64:67], v[132:135]
    s_waitcnt lgkmcnt(6)
    v_fma_f32 v219, v223, s26, v225
    v_fmac_f32 v225, s27, v223
    v_mfma_f32_16x16x32_bf16 v[132:135], a[156:159], a[68:71], v[132:135]
    ds_write_b128 v4, v[120:123] offset:17408
    v_mfma_f32_16x16x32_bf16 v[136:139], a[160:163], a[68:71], v[136:139]
    v_fma_f32 v223, v221, 2.0, v249
    v_fmac_f32 v249, -2.0, v221
    v_mfma_f32_16x16x32_bf16 v[136:139], a[148:151], a[64:67], v[136:139]
pad13:
    s_cbranch_vccnz warm_ret
    v_cvt_pk_bf16_f32 v128, v128, v129
    v_cvt_pk_bf16_f32 v129, v130, v131
    v_cvt_pk_bf16_f32 v219, v248, v219
    v_mfma_f32_16x16x32_bf16 v[136:139], a[136:139], a[76:79], v[136:139]
    s_add_u32 s42, s36, 36864
    v_cvt_pk_bf16_f32 v225, v251, v225
    v_cvt_pk_bf16_f32 v223, v250, v223
    v_mfma_f32_16x16x32_bf16 v[136:139], a[124:127], a[52:55], v[136:139]
    ds_write_b64 v5, v[128:129] offset:17472
    v_mfma_f32_16x16x32_bf16 v[136:139], a[112:115], a[48:51], v[136:139]
    v_cvt_pk_bf16_f32 v221, v252, v249
    v_lshrrev_b32 v252, 15, v255
    v_mfma_f32_16x16x32_bf16 v[136:139], a[100:103], a[60:63], v[136:139]
    ds_write_b64 v252, v[218:219] offset:0
    v_mfma_f32_16x16x32_bf16 v[140:143], a[104:107], a[60:63], v[140:143]
    buffer_load_dwordx4 a[228:231], v254, s[8:11], s42 offen offset:0 sc1
    v_mfma_f32_16x16x32_bf16 v[140:143], a[116:119], a[48:51], v[140:143]
    ds_read_b128 a[60:63], v253 offset:30432
    v_lshrrev_b32 v218, 15, v255
    v_mfma_f32_16x16x32_bf16 v[140:143], a[128:131], a[52:55], v[140:143]
    ds_write_b64 v218, v[224:225] offset:2080
    v_mfma_f32_16x16x32_bf16 v[140:143], a[140:143], a[76:79], v[140:143]
    buffer_load_dwordx4 a[232:235], v254, s[8:11], s42 offen offset:1024 sc1
    v_mfma_f32_16x16x32_bf16 v[140:143], a[152:155], a[64:67], v[140:143]
    ds_read_b128 a[76:79], v253 offset:32512
    v_mfma_f32_16x16x32_bf16 v[140:143], a[164:167], a[68:71], v[140:143]
    s_waitcnt lgkmcnt(6)
    s_add_u32 s44, s40, 589824
sub35:
    v_mfma_f32_16x16x32_bf16 v[144:147], a[96:99], a[48:51], v[144:147]
    buffer_load_dwordx4 a[236:239], v254, s[8:11], s42 offen offset:2048 sc1
    v_mfma_f32_16x16x32_bf16 v[144:147], a[108:111], a[52:55], v[144:147]
    s_add_u32 s42, s36, 39936
    v_mfma_f32_16x16x32_bf16 v[144:147], a[120:123], a[56:59], v[144:147]
    s_waitcnt lgkmcnt(0)
    v_mfma_f32_16x16x32_bf16 v[144:147], a[132:135], a[64:67], v[144:147]
    s_barrier
    v_mfma_f32_16x16x32_bf16 v[144:147], a[144:147], a[68:71], v[144:147]
    buffer_load_dwordx4 a[240:243], v254, s[8:11], s42 offen offset:0 sc1
    v_mfma_f32_16x16x32_bf16 v[144:147], a[156:159], a[72:75], v[144:147]
    v_cvt_pk_bf16_f32 v132, v132, v133
    v_cvt_pk_bf16_f32 v133, v134, v135
    v_mfma_f32_16x16x32_bf16 v[148:151], a[160:163], a[72:75], v[148:151]
    v_cvt_pk_bf16_f32 v134, v136, v137
    v_cvt_pk_bf16_f32 v135, v138, v139
    v_mfma_f32_16x16x32_bf16 v[148:151], a[148:151], a[68:71], v[148:151]
    ds_write_b128 v4, v[132:135] offset:17792
    v_mfma_f32_16x16x32_bf16 v[148:151], a[136:139], a[64:67], v[148:151]
    buffer_load_dwordx4 a[244:247], v254, s[8:11], s42 offen offset:1024 sc1
    v_mfma_f32_16x16x32_bf16 v[148:151], a[124:127], a[56:59], v[148:151]
    ds_read_b128 v[96:99], v6 offset:16640
    v_cvt_pk_bf16_f32 v140, v140, v141
    v_cvt_pk_bf16_f32 v141, v142, v143
    v_mfma_f32_16x16x32_bf16 v[148:151], a[112:115], a[52:55], v[148:151]
    ds_read_b128 v[100:103], v6 offset:19744
    v_mfma_f32_16x16x32_bf16 v[148:151], a[100:103], a[48:51], v[148:151]
    ds_write_b64 v5, v[140:141] offset:17856
    v_mfma_f32_16x16x32_bf16 v[152:155], a[104:107], a[48:51], v[152:155]
    buffer_load_dwordx4 a[248:251], v254, s[8:11], s42 offen offset:2048 sc1
    v_mfma_f32_16x16x32_bf16 v[152:155], a[116:119], a[52:55], v[152:155]
    s_add_u32 s42, s36, 43008
    v_mfma_f32_16x16x32_bf16 v[152:155], a[128:131], a[56:59], v[152:155]
    ds_read_b128 a[48:51], v253 offset:30176
    s_waitcnt lgkmcnt(3)
    v_mfma_f32_16x16x32_bf16 v[152:155], a[140:143], a[64:67], v[152:155]
    ds_read_b128 a[64:67], v253 offset:32256
    v_mfma_f32_16x16x32_bf16 v[152:155], a[152:155], a[68:71], v[152:155]
    buffer_load_dwordx4 a[252:255], v254, s[8:11], s42 offen offset:0 sc1
    v_mfma_f32_16x16x32_bf16 v[152:155], a[164:167], a[72:75], v[152:155]
    ds_read_b128 v[104:107], v6 offset:22848
    v_mfma_f32_16x16x32_bf16 v[156:159], a[96:99], a[52:55], v[156:159]
    buffer_store_dwordx4 v[96:99], v254, s[12:15], s44 offen nt
    s_add_u32 s44, s40, 592896
    s_waitcnt lgkmcnt(4)
    v_mfma_f32_16x16x32_bf16 v[156:159], a[108:111], a[56:59], v[156:159]
    v_cvt_pk_bf16_f32 v144, v144, v145
    v_cvt_pk_bf16_f32 v145, v146, v147
    v_mfma_f32_16x16x32_bf16 v[156:159], a[120:123], a[60:63], v[156:159]
    v_cvt_pk_bf16_f32 v146, v148, v149
    v_cvt_pk_bf16_f32 v147, v150, v151
    v_mfma_f32_16x16x32_bf16 v[156:159], a[132:135], a[68:71], v[156:159]
    buffer_load_dwordx4 v[240:243], v254, s[8:11], s42 offen offset:1024 sc1
    v_mfma_f32_16x16x32_bf16 v[156:159], a[144:147], a[72:75], v[156:159]
    v_mfma_f32_16x16x32_bf16 v[156:159], a[156:159], a[76:79], v[156:159]
    ds_write_b128 v4, v[144:147] offset:18176
    v_mfma_f32_16x16x32_bf16 v[160:163], a[160:163], a[76:79], v[160:163]
    ds_read_b128 v[108:111], v6 offset:25952
    v_mfma_f32_16x16x32_bf16 v[160:163], a[148:151], a[72:75], v[160:163]
    buffer_load_dwordx4 v[244:247], v254, s[8:11], s42 offen offset:2048 sc1
    v_mfma_f32_16x16x32_bf16 v[160:163], a[136:139], a[68:71], v[160:163]
    v_cvt_pk_bf16_f32 v152, v152, v153
    v_cvt_pk_bf16_f32 v153, v154, v155
    v_mfma_f32_16x16x32_bf16 v[160:163], a[124:127], a[60:63], v[160:163]
    buffer_store_dwordx4 v[100:103], v254, s[12:15], s44 offen nt
    v_and_b32 v215, 0x7fff, v255
    s_add_u32 s44, s40, 595968
    v_mfma_f32_16x16x32_bf16 v[160:163], a[112:115], a[56:59], v[160:163]
    buffer_load_dwordx2 v[204:205], v215, s[4:7], s16 offen offset:448
    v_mfma_f32_16x16x32_bf16 v[160:163], a[100:103], a[52:55], v[160:163]
    ds_write_b64 v5, v[152:153] offset:18240
    v_mfma_f32_16x16x32_bf16 v[164:167], a[104:107], a[52:55], v[164:167]
    ds_read_b128 a[52:55], v253 offset:29904
    s_waitcnt lgkmcnt(4)
    v_mfma_f32_16x16x32_bf16 v[164:167], a[116:119], a[56:59], v[164:167]
    ds_write_b64 v218, v[222:223] offset:4160
    v_mfma_f32_16x16x32_bf16 v[164:167], a[128:131], a[60:63], v[164:167]
    buffer_load_dwordx2 v[206:207], v215, s[4:7], s17 offen offset:448
    v_mfma_f32_16x16x32_bf16 v[164:167], a[140:143], a[68:71], v[164:167]
    ds_read_b128 a[68:71], v253 offset:31984
    v_mfma_f32_16x16x32_bf16 v[164:167], a[152:155], a[72:75], v[164:167]
    ds_write_b64 v218, v[216:217] offset:33280
    v_mfma_f32_16x16x32_bf16 v[164:167], a[164:167], a[76:79], v[164:167]
    v_mfma_f32_16x16x32_bf16 v[168:171], a[96:99], a[56:59], v[168:171]
    buffer_load_dwordx2 v[208:209], v215, s[4:7], s18 offen offset:448
    v_mfma_f32_16x16x32_bf16 v[168:171], a[108:111], a[60:63], v[168:171]
    v_cvt_pk_bf16_f32 v156, v156, v157
    v_cvt_pk_bf16_f32 v157, v158, v159
    v_mfma_f32_16x16x32_bf16 v[168:171], a[120:123], a[48:51], v[168:171]
    v_cvt_pk_bf16_f32 v158, v160, v161
    v_cvt_pk_bf16_f32 v159, v162, v163
    v_mfma_f32_16x16x32_bf16 v[168:171], a[132:135], a[72:75], v[168:171]
    ds_write_b128 v4, v[156:159] offset:18560
    v_mfma_f32_16x16x32_bf16 v[168:171], a[144:147], a[76:79], v[168:171]
    v_mfma_f32_16x16x32_bf16 v[168:171], a[156:159], a[64:67], v[168:171]
    buffer_load_dwordx2 v[210:211], v215, s[4:7], s19 offen offset:448
    v_mfma_f32_16x16x32_bf16 v[172:175], a[160:163], a[64:67], v[172:175]
    v_mfma_f32_16x16x32_bf16 v[172:175], a[148:151], a[76:79], v[172:175]
    v_cvt_pk_bf16_f32 v164, v164, v165
    v_cvt_pk_bf16_f32 v165, v166, v167
    v_mfma_f32_16x16x32_bf16 v[172:175], a[136:139], a[72:75], v[172:175]
    ds_write_b64 v5, v[164:165] offset:18624
    v_mfma_f32_16x16x32_bf16 v[172:175], a[124:127], a[48:51], v[172:175]
    buffer_load_dwordx2 v[212:213], v215, s[4:7], s20 offen offset:448
    v_mfma_f32_16x16x32_bf16 v[172:175], a[112:115], a[60:63], v[172:175]
    ds_write_b64 v218, v[226:227] offset:35360
    v_mfma_f32_16x16x32_bf16 v[172:175], a[100:103], a[56:59], v[172:175]
    v_mfma_f32_16x16x32_bf16 v[176:179], a[104:107], a[56:59], v[176:179]
    ds_write_b64 v218, v[220:221] offset:6240
    v_mfma_f32_16x16x32_bf16 v[176:179], a[116:119], a[60:63], v[176:179]
    buffer_load_dwordx2 v[214:215], v215, s[4:7], s21 offen offset:448
    v_mfma_f32_16x16x32_bf16 v[176:179], a[128:131], a[48:51], v[176:179]
    s_waitcnt lgkmcnt(0)
    v_mfma_f32_16x16x32_bf16 v[176:179], a[140:143], a[72:75], v[176:179]
    s_barrier
    v_mfma_f32_16x16x32_bf16 v[176:179], a[152:155], a[76:79], v[176:179]
    ds_read_b128 v[228:231], v253 offset:1040
    v_mfma_f32_16x16x32_bf16 v[176:179], a[164:167], a[64:67], v[176:179]
    ds_read_b128 v[232:235], v253 offset:768
    v_mfma_f32_16x16x32_bf16 v[180:183], a[96:99], a[60:63], v[180:183]
    ds_read_b128 v[236:239], v253 offset:512
    v_mfma_f32_16x16x32_bf16 v[180:183], a[108:111], a[48:51], v[180:183]
    v_cvt_pk_bf16_f32 v168, v168, v169
    v_cvt_pk_bf16_f32 v169, v170, v171
    v_mfma_f32_16x16x32_bf16 v[180:183], a[120:123], a[52:55], v[180:183]
    buffer_store_dwordx4 v[104:107], v254, s[12:15], s44 offen nt
    v_cvt_pk_bf16_f32 v170, v172, v173
    v_cvt_pk_bf16_f32 v171, v174, v175
    v_mfma_f32_16x16x32_bf16 v[180:183], a[132:135], a[76:79], v[180:183]
    ds_write_b128 v4, v[168:171] offset:18944
    v_mfma_f32_16x16x32_bf16 v[180:183], a[144:147], a[64:67], v[180:183]
    s_add_u32 s44, s40, 599040
    v_mfma_f32_16x16x32_bf16 v[180:183], a[156:159], a[68:71], v[180:183]
    ds_read_b128 v[112:115], v6 offset:17664
    v_mfma_f32_16x16x32_bf16 v[184:187], a[160:163], a[68:71], v[184:187]
    ds_read_b128 v[116:119], v6 offset:20768
    v_mfma_f32_16x16x32_bf16 v[184:187], a[148:151], a[64:67], v[184:187]
    buffer_store_dwordx4 v[108:111], v254, s[12:15], s44 offen nt
    v_cvt_pk_bf16_f32 v176, v176, v177
    v_cvt_pk_bf16_f32 v177, v178, v179
    v_mfma_f32_16x16x32_bf16 v[184:187], a[136:139], a[76:79], v[184:187]
    ds_write_b64 v5, v[176:177] offset:19008
    v_mfma_f32_16x16x32_bf16 v[184:187], a[124:127], a[52:55], v[184:187]
    ds_read_b128 v[120:123], v6 offset:23872
    s_add_u32 s44, s40, 590848
    v_mfma_f32_16x16x32_bf16 v[184:187], a[112:115], a[48:51], v[184:187]
    ds_read_b128 v[124:127], v6 offset:26976
    s_waitcnt lgkmcnt(4)
    v_mfma_f32_16x16x32_bf16 v[184:187], a[100:103], a[60:63], v[184:187]
    buffer_store_dwordx4 v[112:115], v254, s[12:15], s44 offen nt
    s_add_u32 s44, s40, 593920
    s_waitcnt lgkmcnt(3)
    v_mfma_f32_16x16x32_bf16 v[188:191], a[104:107], a[60:63], v[188:191]
    v_mfma_f32_16x16x32_bf16 v[188:191], a[116:119], a[48:51], v[188:191]
    buffer_store_dwordx4 v[116:119], v254, s[12:15], s44 offen nt
    s_add_u32 s44, s40, 596992
    v_mfma_f32_16x16x32_bf16 v[188:191], a[128:131], a[52:55], v[188:191]
    s_waitcnt lgkmcnt(1)
    v_mfma_f32_16x16x32_bf16 v[188:191], a[140:143], a[76:79], v[188:191]
    buffer_store_dwordx4 v[120:123], v254, s[12:15], s44 offen nt
    v_mfma_f32_16x16x32_bf16 v[188:191], a[152:155], a[64:67], v[188:191]
    v_mfma_f32_16x16x32_bf16 v[188:191], a[164:167], a[68:71], v[188:191]
    s_waitcnt vmcnt(37)
    s_add_u32 s41, s40, 589824
    s_add_u32 s40, s40, 6291456
    s_add_u32 s39, s39, 1
    s_cmp_lt_u32 s39, 2
    s_cbranch_scc1 blk_loop
    s_add_u32 s44, s41, 10240
    s_waitcnt lgkmcnt(0)
    buffer_store_dwordx4 v[124:127], v254, s[12:15], s44 offen nt
    v_cvt_pk_bf16_f32 v180, v180, v181
    v_cvt_pk_bf16_f32 v181, v182, v183
    v_cvt_pk_bf16_f32 v182, v184, v185
    v_cvt_pk_bf16_f32 v183, v186, v187
    ds_write_b128 v4, v[180:183] offset:19328
    v_cvt_pk_bf16_f32 v188, v188, v189
    v_cvt_pk_bf16_f32 v189, v190, v191
    ds_write_b64 v5, v[188:189] offset:19392
    s_waitcnt lgkmcnt(0)
    s_barrier
    ds_read_b128 v[32:35], v6 offset:18688
    ds_read_b128 v[36:39], v6 offset:21792
    ds_read_b128 v[40:43], v6 offset:24896
    ds_read_b128 v[44:47], v6 offset:28000
    s_add_u32 s44, s41, 2048
    s_waitcnt lgkmcnt(3)
    buffer_store_dwordx4 v[32:35], v254, s[12:15], s44 offen nt
    s_add_u32 s44, s41, 5120
    s_waitcnt lgkmcnt(2)
    buffer_store_dwordx4 v[36:39], v254, s[12:15], s44 offen nt
    s_add_u32 s44, s41, 8192
    s_waitcnt lgkmcnt(1)
    buffer_store_dwordx4 v[40:43], v254, s[12:15], s44 offen nt
    s_add_u32 s44, s41, 11264
    s_waitcnt lgkmcnt(0)
    buffer_store_dwordx4 v[44:47], v254, s[12:15], s44 offen nt
main_done:
    s_endpgm
code_end:
wt_loop:
    s_mul_i32 s73, s70, 43691
    s_lshr_b32 s73, s73, 17
    s_mul_i32 s74, s73, 3
    s_sub_u32 s74, s70, s74
    s_mul_i32 s75, s73, 43691
    s_lshr_b32 s75, s75, 17
    s_mul_i32 s76, s75, 3
    s_sub_u32 s76, s73, s76
    v_and_b32 v101, 14, v2
    v_lshrrev_b32 v102, 5, v2
    v_lshrrev_b32 v104, 3, v2
    v_and_or_b32 v102, v104, 2, v102
    v_and_b32 v103, 12, v101
    v_and_b32 v105, 1, v2
    s_lshl_b32 s78, s74, 2
    s_cmp_lt_u32 s74, 2
    s_cselect_b32 s77, 1, 0
    s_cselect_b32 s78, s78, 32
    v_mul_u32_u24 v103, s77, v103
    v_add_u32 v103, v103, v101
    v_add_u32 v103, s78, v103
    v_lshl_add_u32 v103, v103, 1, s52
    v_lshl_add_u32 v102, v102, 1, v105
    v_mul_u32_u24 v104, 1536, v102
    v_add_u32 v103, v103, v104
    s_mul_i32 s79, s76, 73728
    s_mul_i32 s80, s75, 12288
    s_add_u32 s79, s79, s80
    s_add_u32 s80, s79, 221184
    s_add_u32 s81, s79, 442368
    buffer_load_dword v136, v103, s[60:63], s79 offen offset:0
    buffer_load_dword v137, v103, s[60:63], s79 offen offset:384
    buffer_load_dword v138, v103, s[60:63], s79 offen offset:768
    buffer_load_dword v139, v103, s[60:63], s79 offen offset:1152
    buffer_load_dword v140, v103, s[60:63], s80 offen offset:0
    buffer_load_dword v141, v103, s[60:63], s80 offen offset:384
    buffer_load_dword v142, v103, s[60:63], s80 offen offset:768
    buffer_load_dword v143, v103, s[60:63], s80 offen offset:1152
    buffer_load_dword v144, v103, s[60:63], s81 offen offset:0
    buffer_load_dword v145, v103, s[60:63], s81 offen offset:384
    buffer_load_dword v146, v103, s[60:63], s81 offen offset:768
    buffer_load_dword v147, v103, s[60:63], s81 offen offset:1152
    v_mul_u32_u24 v106, 0x0202, v105
    v_sub_u32 v106, 0x0504, v106
    v_mul_u32_u24 v107, 0x0606, v105
    v_add_u32 v107, 0x0100, v107
    v_mov_b32 v108, 0x0c0c
    v_lshl_or_b32 v106, v106, 16, v108
    v_lshl_or_b32 v107, v107, 16, v108
    s_mul_i32 s82, s76, 3072
    s_lshl_b32 s83, s74, 10
    s_add_u32 s82, s82, s83
    s_mul_i32 s83, s75, 36864
    s_lshl_b32 s84, s83, 2
    s_add_u32 s83, s83, s82
    s_add_u32 s84, s84, s82
    s_waitcnt vmcnt(0)
    v_mov_b32_dpp v152, v136 quad_perm:[1,0,3,2] row_mask:0xf bank_mask:0xf
    v_mov_b32_dpp v153, v137 quad_perm:[1,0,3,2] row_mask:0xf bank_mask:0xf
    v_mov_b32_dpp v154, v138 quad_perm:[1,0,3,2] row_mask:0xf bank_mask:0xf
    v_mov_b32_dpp v155, v139 quad_perm:[1,0,3,2] row_mask:0xf bank_mask:0xf
    v_mov_b32_dpp v156, v140 quad_perm:[1,0,3,2] row_mask:0xf bank_mask:0xf
    v_mov_b32_dpp v157, v141 quad_perm:[1,0,3,2] row_mask:0xf bank_mask:0xf
    v_mov_b32_dpp v158, v142 quad_perm:[1,0,3,2] row_mask:0xf bank_mask:0xf
    v_mov_b32_dpp v159, v143 quad_perm:[1,0,3,2] row_mask:0xf bank_mask:0xf
    v_mov_b32_dpp v160, v144 quad_perm:[1,0,3,2] row_mask:0xf bank_mask:0xf
    v_mov_b32_dpp v161, v145 quad_perm:[1,0,3,2] row_mask:0xf bank_mask:0xf
    v_mov_b32_dpp v162, v146 quad_perm:[1,0,3,2] row_mask:0xf bank_mask:0xf
    v_mov_b32_dpp v163, v147 quad_perm:[1,0,3,2] row_mask:0xf bank_mask:0xf
    v_perm_b32 v110, v136, v152, v106
    v_perm_b32 v114, v136, v152, v107
    v_perm_b32 v111, v137, v153, v106
    v_perm_b32 v115, v137, v153, v107
    v_perm_b32 v112, v138, v154, v106
    v_perm_b32 v116, v138, v154, v107
    v_perm_b32 v113, v139, v155, v106
    v_perm_b32 v117, v139, v155, v107
    v_perm_b32 v118, v140, v156, v106
    v_perm_b32 v122, v140, v156, v107
    v_perm_b32 v119, v141, v157, v106
    v_perm_b32 v123, v141, v157, v107
    v_perm_b32 v120, v142, v158, v106
    v_perm_b32 v124, v142, v158, v107
    v_perm_b32 v121, v143, v159, v106
    v_perm_b32 v125, v143, v159, v107
    v_perm_b32 v126, v144, v160, v106
    v_perm_b32 v130, v144, v160, v107
    v_perm_b32 v127, v145, v161, v106
    v_perm_b32 v131, v145, v161, v107
    v_perm_b32 v128, v146, v162, v106
    v_perm_b32 v132, v146, v162, v107
    v_perm_b32 v129, v147, v163, v106
    v_perm_b32 v133, v147, v163, v107
    v_mul_f32 v136, 0xbedba55c, v110
    v_fmac_f32 v136, 0xbe0afea5, v126
    v_fmamk_f32 v144, v118, 0xbe771a08, v136
    v_fmac_f32 v136, 0x3e771a08, v118
    v_mul_f32 v137, 0xbedba55c, v111
    v_fmac_f32 v137, 0xbe0afea5, v127
    v_fmamk_f32 v145, v119, 0xbe771a08, v137
    v_fmac_f32 v137, 0x3e771a08, v119
    v_mul_f32 v138, 0xbedba55c, v112
    v_fmac_f32 v138, 0xbe0afea5, v128
    v_fmamk_f32 v146, v120, 0xbe771a08, v138
    v_fmac_f32 v138, 0x3e771a08, v120
    v_mul_f32 v139, 0xbedba55c, v113
    v_fmac_f32 v139, 0xbe0afea5, v129
    v_fmamk_f32 v147, v121, 0xbe771a08, v139
    v_fmac_f32 v139, 0x3e771a08, v121
    v_mul_f32 v140, 0xbedba55c, v114
    v_fmac_f32 v140, 0xbe0afea5, v130
    v_fmamk_f32 v148, v122, 0xbe771a08, v140
    v_fmac_f32 v140, 0x3e771a08, v122
    v_mul_f32 v141, 0xbedba55c, v115
    v_fmac_f32 v141, 0xbe0afea5, v131
    v_fmamk_f32 v149, v123, 0xbe771a08, v141
    v_fmac_f32 v141, 0x3e771a08, v123
    v_mul_f32 v142, 0xbedba55c, v116
    v_fmac_f32 v142, 0xbe0afea5, v132
    v_fmamk_f32 v150, v124, 0xbe771a08, v142
    v_fmac_f32 v142, 0x3e771a08, v124
    v_mul_f32 v143, 0xbedba55c, v117
    v_fmac_f32 v143, 0xbe0afea5, v133
    v_fmamk_f32 v151, v125, 0xbe771a08, v143
    v_fmac_f32 v143, 0x3e771a08, v125
    v_cvt_pk_bf16_f32 v156, v144, v145
    v_cvt_pk_bf16_f32 v157, v146, v147
    v_cvt_pk_bf16_f32 v158, v148, v149
    v_cvt_pk_bf16_f32 v159, v150, v151
    s_add_u32 s85, s84, 0
    buffer_store_dwordx4 v[156:159], v254, s[8:11], s85 offen sc1
    v_cvt_pk_bf16_f32 v160, v136, v137
    v_cvt_pk_bf16_f32 v161, v138, v139
    v_cvt_pk_bf16_f32 v162, v140, v141
    v_cvt_pk_bf16_f32 v163, v142, v143
    s_add_u32 s85, s84, 36864
    buffer_store_dwordx4 v[160:163], v254, s[8:11], s85 offen sc1
    v_mul_f32 v136, 0x3e0afea5, v110
    v_fmac_f32 v136, 0x3f0afea5, v126
    v_fmamk_f32 v144, v118, 0x3e8afea5, v136
    v_fmac_f32 v136, 0xbe8afea5, v118
    v_mul_f32 v137, 0x3e0afea5, v111
    v_fmac_f32 v137, 0x3f0afea5, v127
    v_fmamk_f32 v145, v119, 0x3e8afea5, v137
    v_fmac_f32 v137, 0xbe8afea5, v119
    v_mul_f32 v138, 0x3e0afea5, v112
    v_fmac_f32 v138, 0x3f0afea5, v128
    v_fmamk_f32 v146, v120, 0x3e8afea5, v138
    v_fmac_f32 v138, 0xbe8afea5, v120
    v_mul_f32 v139, 0x3e0afea5, v113
    v_fmac_f32 v139, 0x3f0afea5, v129
    v_fmamk_f32 v147, v121, 0x3e8afea5, v139
    v_fmac_f32 v139, 0xbe8afea5, v121
    v_mul_f32 v140, 0x3e0afea5, v114
    v_fmac_f32 v140, 0x3f0afea5, v130
    v_fmamk_f32 v148, v122, 0x3e8afea5, v140
    v_fmac_f32 v140, 0xbe8afea5, v122
    v_mul_f32 v141, 0x3e0afea5, v115
    v_fmac_f32 v141, 0x3f0afea5, v131
    v_fmamk_f32 v149, v123, 0x3e8afea5, v141
    v_fmac_f32 v141, 0xbe8afea5, v123
    v_mul_f32 v142, 0x3e0afea5, v116
    v_fmac_f32 v142, 0x3f0afea5, v132
    v_fmamk_f32 v150, v124, 0x3e8afea5, v142
    v_fmac_f32 v142, 0xbe8afea5, v124
    v_mul_f32 v143, 0x3e0afea5, v117
    v_fmac_f32 v143, 0x3f0afea5, v133
    v_fmamk_f32 v151, v125, 0x3e8afea5, v143
    v_fmac_f32 v143, 0xbe8afea5, v125
    v_cvt_pk_bf16_f32 v164, v144, v145
    v_cvt_pk_bf16_f32 v165, v146, v147
    v_cvt_pk_bf16_f32 v166, v148, v149
    v_cvt_pk_bf16_f32 v167, v150, v151
    s_add_u32 s85, s84, 73728
    buffer_store_dwordx4 v[164:167], v254, s[8:11], s85 offen sc1
    v_cvt_pk_bf16_f32 v168, v136, v137
    v_cvt_pk_bf16_f32 v169, v138, v139
    v_cvt_pk_bf16_f32 v170, v140, v141
    v_cvt_pk_bf16_f32 v171, v142, v143
    s_add_u32 s85, s84, 110592
    buffer_store_dwordx4 v[168:171], v254, s[8:11], s85 offen sc1
    v_cvt_pk_bf16_f32 v152, v110, v111
    v_cvt_pk_bf16_f32 v153, v112, v113
    v_cvt_pk_bf16_f32 v154, v114, v115
    v_cvt_pk_bf16_f32 v155, v116, v117
    s_add_u32 s85, s83, 884736
    buffer_store_dwordx4 v[152:155], v254, s[8:11], s85 offen sc1
    v_cvt_pk_bf16_f32 v172, v126, v127
    v_cvt_pk_bf16_f32 v173, v128, v129
    v_cvt_pk_bf16_f32 v174, v130, v131
    v_cvt_pk_bf16_f32 v175, v132, v133
    s_add_u32 s85, s83, 1105920
    buffer_store_dwordx4 v[172:175], v254, s[8:11], s85 offen sc1
    s_add_u32 s70, s70, 1
    s_cmp_lt_u32 s70, 54
    s_cbranch_scc1 wt_loop
    s_waitcnt vmcnt(0)
    s_branch u_ready
.section .rodata,"a"
.p2align 6
.amdhsa_kernel standalone__winograd__vision_kernel
  .amdhsa_next_free_vgpr 512
  .amdhsa_next_free_sgpr 102
  .amdhsa_accum_offset 256
  .amdhsa_group_segment_fixed_size 0
  .amdhsa_kernarg_size 40
  .amdhsa_user_sgpr_count 2
  .amdhsa_user_sgpr_kernarg_segment_ptr 1
  .amdhsa_system_sgpr_workgroup_id_x 1
  .amdhsa_ieee_mode 0
.end_amdhsa_kernel
```
